```python
import torch

def _softmax(x, axis=-1):
    return torch.softmax(x, dim=axis)
def _gelu(x):
    return torch.nn.functional.gelu(x, approximate="tanh")
def _silu(x):
    return torch.nn.functional.silu(x)
def _sigmoid(x):
    return torch.sigmoid(x)
def _layernorm(x, axis=-1, eps=1e-5):
    m = x.mean(dim=axis, keepdim=True)
    v = x.var(dim=axis, keepdim=True, unbiased=False)
    return (x - m) / torch.sqrt(v + eps)
def _scatter_add(tgt, idx, src, axis=0):
    return tgt.clone().index_add_(axis, idx, src)
def _segment_sum(src, seg, n):
    out = torch.zeros((n,) + src.shape[1:], dtype=src.dtype)
    return out.index_add_(0, seg, src)
def _pad(x, pw):
    flat = tuple(v for pair in reversed(pw) for v in pair)
    return torch.nn.functional.pad(x, flat)

kernel_name = 'gated_mix__compressed_kv_cla__glu_gated_swiglu__prompt'

def setup_inputs():

    _w = (lambda a: (lambda t: t.to(torch.bfloat16) if t.is_floating_point() else t)(torch.as_tensor(a)))
    def _A_setup():
        B, H, Sq, Sk, D, M = 1, 16, 2048, 2048, 256, 448
        Dc = 4 * D
        return {
            "x": _w((lambda *s: torch.randn(*s, dtype=torch.bfloat16) * 0.05)(B, Sq, M)),
            "c_kv": _w((lambda *s: torch.randn(*s, dtype=torch.bfloat16) * 0.4)(B, Sk, Dc)),
            "w_q": _w((lambda *s: torch.randn(*s, dtype=torch.bfloat16) * 6.4)(M, H, D) * (M ** -0.5)),
            "w_uk": _w((lambda *s: torch.randn(*s, dtype=torch.bfloat16) * 6.4)(Dc, H, D) * (Dc ** -0.5)),
            "w_uv": _w((lambda *s: torch.randn(*s, dtype=torch.bfloat16) * 0.4)(Dc, H, D) * (Dc ** -0.5)),
            "w_o": _w((lambda *s: torch.randn(*s, dtype=torch.bfloat16) * 0.4)(H, D, M) * ((H * D) ** -0.5)),
        }
    _A_in = _A_setup()

    def _B_setup():
        B, S, D, F = 1, 2048, 448, 1792
        return {
            "x": _w((lambda *s: torch.randn(*s, dtype=torch.bfloat16) * 0.05)(B, S, D)),
            "w1": _w((lambda *s: torch.randn(*s, dtype=torch.bfloat16) * 1.6)(D, F) * (2.0 / D) ** 0.5),
            "w3": _w((lambda *s: torch.randn(*s, dtype=torch.bfloat16) * 1.6)(D, F) * (2.0 / D) ** 0.5),
            "w2": _w((lambda *s: torch.randn(*s, dtype=torch.bfloat16) * 1.6)(F, D) * (2.0 / F) ** 0.5),
        }
    _B_in = _B_setup()

    return {
        "A_x": _A_in["x"],
        "A_c_kv": _A_in["c_kv"],
        "A_w_q": _A_in["w_q"],
        "A_w_uk": _A_in["w_uk"],
        "A_w_uv": _A_in["w_uv"],
        "A_w_o": _A_in["w_o"],
        "B_x": _B_in["x"],
        "B_w1": _B_in["w1"],
        "B_w3": _B_in["w3"],
        "B_w2": _B_in["w2"],
        "gate_w": _w((lambda *s: torch.randn(*s, dtype=torch.bfloat16) * 0.05)(448) * 16.0),
    }

def reference(A_x, A_c_kv, A_w_q, A_w_uk, A_w_uv, A_w_o, B_x, B_w1, B_w3, B_w2, gate_w):
    def _A_ref(x, c_kv, w_q, w_uk, w_uv, w_o):
        B, Sq, M = x.shape[0], x.shape[1], x.shape[2]
        Sk = c_kv.shape[1]
        H, D = w_q.shape[1], w_q.shape[2]
        q = torch.einsum("bqm,mhd->bhqd", x, w_q)
        k = torch.einsum("bkc,chd->bhkd", c_kv, w_uk)
        v = torch.einsum("bkc,chd->bhkd", c_kv, w_uv)
        scores = torch.einsum("bhqd,bhkd->bhqk", q, k) * (D ** -0.5)
        off = Sk - Sq
        qi = torch.arange(Sq)[:, None]
        kj = torch.arange(Sk)[None, :]
        cmask = kj <= (qi + off)
        scores = torch.where(cmask[None, None], scores, -1e9)
        p = _softmax(scores, axis=-1)
        ctx = torch.einsum("bhqk,bhkd->bhqd", p, v)
        return torch.einsum("bhqd,hdm->bqm", ctx, w_o)

    def _B_ref(x, w1, w3, w2):
        gate = torch.einsum("bsd,df->bsf", x, w1)
        up = torch.einsum("bsd,df->bsf", x, w3)
        h = _silu(gate) * up
        out = torch.einsum("bsf,fd->bsd", h, w2)
        return out

    x = A_x
    g = _sigmoid((x * gate_w).sum(-1, keepdims=True))
    a = _A_ref(x, A_c_kv, A_w_q, A_w_uk, A_w_uv, A_w_o)
    b = _B_ref(x, B_w1, B_w3, B_w2)
    return g * a + (1 - g) * b
```

```asm
; @launch grid=(256,1,1) block=(256,1,1) lds=163840
.amdgcn_target "amdgcn-amd-amdhsa--gfx950"
.text
.globl gated_mix__compressed_kv_cla__glu_gated_swiglu__prompt_kernel
.p2align 8
.type gated_mix__compressed_kv_cla__glu_gated_swiglu__prompt_kernel,@function
gated_mix__compressed_kv_cla__glu_gated_swiglu__prompt_kernel:
 s_cmp_ge_u32 s2, 256
 s_cbranch_scc1 gated_mix__compressed_kv_cla__glu_gated_swiglu__prompt_kernel_exit
 s_load_dwordx4 s[4:7], s[0:1], 0
 s_load_dwordx4 s[8:11], s[0:1], 16
 s_load_dwordx2 s[12:13], s[0:1], 32
 s_load_dwordx2 s[14:15], s[0:1], 56
 s_load_dwordx2 s[16:17], s[0:1], 64
 s_load_dwordx2 s[56:57], s[0:1], 40
 s_load_dwordx2 s[60:61], s[0:1], 72
 s_load_dwordx2 s[48:49], s[0:1], 80
 s_load_dwordx2 s[44:45], s[0:1], 96
 s_load_dwordx2 s[36:37], s[0:1], 104
 s_getpc_b64 s[100:101]
gated_mix__compressed_kv_cla__glu_gated_swiglu__prompt_kernel_pc:
 v_lshrrev_b32 v23, 6, v0
 s_bfe_u32 s91, s2, 0x30003
 v_lshl_add_u32 v23, s91, 2, v23
 v_mul_u32_u24 v23, ((gated_mix__compressed_kv_cla__glu_gated_swiglu__prompt_kernel_end-gated_mix__compressed_kv_cla__glu_gated_swiglu__prompt_kernel_pc)/4096+1)*128, v23
 v_and_b32 v27, 63, v0
 v_min_u32 v27, (gated_mix__compressed_kv_cla__glu_gated_swiglu__prompt_kernel_end-gated_mix__compressed_kv_cla__glu_gated_swiglu__prompt_kernel_pc)/4096, v27
 v_lshl_add_u32 v27, v27, 7, v23
 v_min_u32 v27, gated_mix__compressed_kv_cla__glu_gated_swiglu__prompt_kernel_end-gated_mix__compressed_kv_cla__glu_gated_swiglu__prompt_kernel_pc-4, v27
 global_load_dword v31, v27, s[100:101]
 v_lshrrev_b32 v23, 6, v0
 v_and_b32 v22, 63, v0
 v_readfirstlane_b32 s68, v23
 s_and_b32 s91, s2, 7
 s_bfe_u32 s83, s2, 0x30003
 s_bfe_u32 s92, s2, 0x10006
 s_lshr_b32 s84, s2, 7
 s_lshl_b32 s82, s91, 1
 s_add_u32 s82, s82, s92
 s_and_b32 s80, s83, 1
 s_lshr_b32 s3, s83, 1
 s_lshl_b32 s92, s84, 2
 s_add_u32 s3, s3, s92
 s_mov_b32 s23, 0x20000
 s_mov_b32 s27, 0x20000
 s_mov_b32 s31, 0x20000
 s_mov_b32 s35, 0x20000
 s_mov_b32 s39, 0x20000
 s_mov_b32 s43, 0x20000
 s_mov_b32 s47, 0x20000
 s_mov_b32 s51, 0x20000
 s_mov_b32 s59, 0x20000
 s_mov_b32 s63, 0x20000
 s_mov_b32 s67, 0x20000
 s_waitcnt lgkmcnt(0)
 s_lshl_b32 s93, s3, 19
 s_add_u32 s20, s6, s93
 s_addc_u32 s21, s7, 0
 s_mov_b32 s22, 524288
 s_cmp_eq_u32 s80, 0
 s_cselect_b32 s24, s10, s12
 s_cselect_b32 s25, s11, s13
 s_lshl_b32 s93, s82, 9
 s_lshl_b32 s94, s68, 7
 s_add_u32 s93, s93, s94
 s_add_u32 s24, s24, s93
 s_addc_u32 s25, s25, 0
 s_sub_u32 s26, 8388608, s93
 s_add_u32 s52, s8, s93
 s_addc_u32 s53, s9, 0
 s_sub_u32 s54, 3670016, s93
 s_mov_b32 s38, 268435456
 s_or_b32 s79, s2, s68
 s_cbranch_scc1 gated_mix__compressed_kv_cla__glu_gated_swiglu__prompt_kernel_noseed
 s_mov_b32 s94, 52428800
 buffer_load_dword v28, off, s[36:39], s94 sc1
gated_mix__compressed_kv_cla__glu_gated_swiglu__prompt_kernel_noseed:
 s_movk_i32 s95, 2048
 s_movk_i32 s96, 8192
 s_lshl_b32 s97, s68, 6
 s_add_u32 s98, s97, 32
 v_lshrrev_b32 v23, 3, v22
 v_mul_lo_u32 v24, v23, s95
 v_lshrrev_b32 v25, 4, v22
 v_xor_b32 v25, v25, v22
 v_and_b32 v25, 7, v25
 v_lshlrev_b32 v25, 4, v25
 s_add_u32 s90, s97, 0
 s_mul_i32 s90, s90, s95
 s_sub_u32 s90, s90, 0
 v_xor_b32 v1, 0, v25
 v_add3_u32 v1, v1, v24, s90
 s_add_u32 s90, s97, 8
 s_mul_i32 s90, s90, s95
 s_sub_u32 s90, s90, 1024
 v_xor_b32 v2, 64, v25
 v_add3_u32 v2, v2, v24, s90
 s_add_u32 s90, s97, 16
 s_mul_i32 s90, s90, s95
 s_sub_u32 s90, s90, 2048
 v_xor_b32 v3, 0, v25
 v_add3_u32 v3, v3, v24, s90
 s_add_u32 s90, s97, 24
 s_mul_i32 s90, s90, s95
 s_sub_u32 s90, s90, 3072
 v_xor_b32 v4, 64, v25
 v_add3_u32 v4, v4, v24, s90
 s_add_u32 s90, s98, 0
 s_mul_i32 s90, s90, s95
 s_sub_u32 s90, s90, 0
 v_xor_b32 v5, 0, v25
 v_add3_u32 v5, v5, v24, s90
 s_add_u32 s90, s98, 8
 s_mul_i32 s90, s90, s95
 s_sub_u32 s90, s90, 1024
 v_xor_b32 v6, 64, v25
 v_add3_u32 v6, v6, v24, s90
 s_add_u32 s90, s98, 16
 s_mul_i32 s90, s90, s95
 s_sub_u32 s90, s90, 2048
 v_xor_b32 v7, 0, v25
 v_add3_u32 v7, v7, v24, s90
 s_add_u32 s90, s98, 24
 s_mul_i32 s90, s90, s95
 s_sub_u32 s90, s90, 3072
 v_xor_b32 v8, 64, v25
 v_add3_u32 v8, v8, v24, s90
 v_mul_lo_u32 v24, v23, s96
 v_bfe_u32 v23, v22, 1, 2
 v_bfe_u32 v25, v22, 4, 1
 v_xor_b32 v23, v23, v25
 v_lshlrev_b32 v23, 5, v23
 v_and_b32 v25, 1, v22
 v_lshl_or_b32 v25, v25, 4, v23
 s_mul_i32 s90, s96, 0
 s_sub_u32 s90, s90, 0
 v_xor_b32 v9, 0, v25
 v_add3_u32 v9, v9, v24, s90
 s_mul_i32 s90, s96, 8
 s_sub_u32 s90, s90, 1024
 v_xor_b32 v10, 64, v25
 v_add3_u32 v10, v10, v24, s90
 s_mul_i32 s90, s96, 16
 s_sub_u32 s90, s90, 2048
 v_xor_b32 v11, 0, v25
 v_add3_u32 v11, v11, v24, s90
 s_mul_i32 s90, s96, 24
 s_sub_u32 s90, s90, 3072
 v_xor_b32 v12, 64, v25
 v_add3_u32 v12, v12, v24, s90
 s_mov_b32 s71, 262144
 s_lshl_b32 s78, s68, 12
 s_lshl_b32 s76, s68, 13
 s_add_u32 s76, s76, 65536
 s_add_u32 s77, s76, 4096
 s_add_u32 m0, s76, 0
 s_mov_b32 s69, 0
 buffer_load_dwordx4 v1, s[20:23], s69 offen offset:0 lds
 s_mov_b32 s72, 65536
 s_mov_b32 s73, 0
 s_mov_b32 s74, 32768
 s_movk_i32 s46, 256
 s_movk_i32 s50, 896
 s_mov_b32 s58, 3670016
 s_mov_b32 s64, s36
 s_mov_b32 s65, s37
 s_mov_b32 s66, s38
 s_bitcmp0_b32 s2, 0
 s_cselect_b32 s93, s14, s16
 s_cselect_b32 s94, s15, s17
 buffer_load_dwordx4 v2, s[20:23], s69 offen offset:1024 lds
 s_cmp_eq_u32 s68, 0
 s_cselect_b32 s40, s4, s8
 s_cselect_b32 s41, s5, s9
 s_cmp_eq_u32 s68, 2
 s_cselect_b32 s95, 256, 0
 s_add_u32 s95, s95, s2
 s_lshr_b32 s96, s2, 1
 s_cmp_eq_u32 s68, 3
 s_cselect_b32 s40, s93, s40
 s_cselect_b32 s41, s94, s41
 s_cselect_b32 s95, s96, s95
 s_movk_i32 s42, 7168
 s_cselect_b32 s42, 12544, s42
 s_cselect_b32 s96, 4, 3
 buffer_load_dwordx4 v3, s[20:23], s69 offen offset:2048 lds
 s_mul_i32 s95, s95, s42
 s_add_u32 s40, s40, s95
 s_addc_u32 s41, s41, 0
 v_lshlrev_b32 v124, s96, v22
 s_lshl_b32 s19, 64, s96
 s_cmp_eq_u32 s83, 7
 s_cselect_b32 s81, 2, s84
 buffer_load_dwordx4 v4, s[20:23], s69 offen offset:3072 lds
 s_lshl_b32 s93, s83, 2
 s_sub_u32 s85, 30, s93
 s_min_u32 s85, s85, 29
 s_cmp_eq_u32 s83, 7
 s_cselect_b32 s85, 0, s85
 s_sub_u32 s93, 15, s83
 s_cmp_eq_u32 s84, 0
 s_cselect_b32 s86, s83, s93
 s_cmp_eq_u32 s81, 0
 s_cselect_b32 s97, s93, s86
 s_add_u32 m0, s77, 0
 s_mov_b32 s69, 0
 buffer_load_dwordx4 v5, s[20:23], s69 offen offset:0 lds
 s_lshl_b32 s94, s68, 5
 s_lshl_b32 s97, s97, 7
 s_add_u32 s97, s97, s94
 s_lshl_b32 s98, s86, 7
 s_add_u32 s98, s98, s94
 s_movk_i32 s95, 896
 s_movk_i32 s96, 8192
 v_lshrrev_b32 v23, 3, v22
 v_mul_lo_u32 v24, v23, s95
 v_lshrrev_b32 v25, 4, v22
 v_xor_b32 v25, v25, v22
 v_and_b32 v25, 7, v25
 v_lshlrev_b32 v25, 4, v25
 buffer_load_dwordx4 v6, s[20:23], s69 offen offset:1024 lds
 s_add_u32 s90, s97, 0
 s_mul_i32 s90, s90, s95
 s_sub_u32 s90, s90, 0
 v_xor_b32 v240, 0, v25
 v_add3_u32 v240, v240, v24, s90
 s_add_u32 s90, s97, 8
 s_mul_i32 s90, s90, s95
 s_sub_u32 s90, s90, 1024
 buffer_load_dwordx4 v7, s[20:23], s69 offen offset:2048 lds
 v_xor_b32 v241, 64, v25
 v_add3_u32 v241, v241, v24, s90
 s_add_u32 s90, s97, 16
 s_mul_i32 s90, s90, s95
 s_sub_u32 s90, s90, 2048
 v_xor_b32 v242, 0, v25
 v_add3_u32 v242, v242, v24, s90
 s_add_u32 s90, s97, 24
 s_mul_i32 s90, s90, s95
 s_sub_u32 s90, s90, 3072
 v_xor_b32 v243, 64, v25
 v_add3_u32 v243, v243, v24, s90
 buffer_load_dwordx4 v8, s[20:23], s69 offen offset:3072 lds
 s_add_u32 s90, s98, 0
 s_mul_i32 s90, s90, s95
 s_sub_u32 s90, s90, 0
 v_xor_b32 v244, 0, v25
 v_add3_u32 v244, v244, v24, s90
 s_add_u32 s90, s98, 8
 s_mul_i32 s90, s90, s95
 s_sub_u32 s90, s90, 1024
 v_xor_b32 v245, 64, v25
 v_add3_u32 v245, v245, v24, s90
 s_add_u32 m0, s78, 0
 s_mov_b32 s70, 0
 buffer_load_dwordx4 v9, s[24:27], s70 offen offset:0 nt lds
 s_add_u32 s90, s98, 16
 s_mul_i32 s90, s90, s95
 s_sub_u32 s90, s90, 2048
 v_xor_b32 v246, 0, v25
 v_add3_u32 v246, v246, v24, s90
 s_add_u32 s90, s98, 24
 s_mul_i32 s90, s90, s95
 s_sub_u32 s90, s90, 3072
 v_xor_b32 v247, 64, v25
 v_add3_u32 v247, v247, v24, s90
 buffer_load_dwordx4 v10, s[24:27], s70 offen offset:1024 nt lds
 v_mul_lo_u32 v24, v23, s96
 v_bfe_u32 v23, v22, 1, 2
 v_bfe_u32 v25, v22, 4, 1
 v_xor_b32 v23, v23, v25
 v_lshlrev_b32 v23, 5, v23
 v_and_b32 v25, 1, v22
 v_lshl_or_b32 v25, v25, 4, v23
 s_mul_i32 s90, s96, 0
 s_sub_u32 s90, s90, 0
 v_xor_b32 v248, 0, v25
 v_add3_u32 v248, v248, v24, s90
 buffer_load_dwordx4 v11, s[24:27], s70 offen offset:2048 nt lds
 s_mul_i32 s90, s96, 8
 s_sub_u32 s90, s90, 1024
 v_xor_b32 v249, 64, v25
 v_add3_u32 v249, v249, v24, s90
 s_mul_i32 s90, s96, 16
 s_sub_u32 s90, s90, 2048
 v_xor_b32 v250, 0, v25
 v_add3_u32 v250, v250, v24, s90
 s_mul_i32 s90, s96, 24
 s_sub_u32 s90, s90, 3072
 buffer_load_dwordx4 v12, s[24:27], s70 offen offset:3072 nt lds
 v_xor_b32 v251, 64, v25
 v_add3_u32 v251, v251, v24, s90
 s_lshr_b32 s88, s68, 1
 s_and_b32 s89, s68, 1
 s_mul_i32 s93, s82, 7
 s_min_u32 s94, s83, 6
 s_add_u32 s93, s93, s94
 s_and_b32 s91, s93, 7
 s_lshr_b32 s92, s93, 3
 s_mul_i32 s93, s91, 229376
 s_add_u32 s28, s4, s93
 s_addc_u32 s29, s5, 0
 s_mov_b32 s30, 229376
 s_add_u32 m0, s78, 16384
 s_mov_b32 s70, 262144
 buffer_load_dwordx4 v9, s[24:27], s70 offen offset:0 nt lds
 s_cmp_eq_u32 s89, 0
 s_cselect_b32 s32, s14, s16
 s_cselect_b32 s33, s15, s17
 s_lshl_b32 s93, s92, 8
 s_lshl_b32 s94, s88, 7
 s_add_u32 s93, s93, s94
 s_add_u32 s32, s32, s93
 s_addc_u32 s33, s33, 0
 s_sub_u32 s34, 1605632, s93
 s_mov_b32 s55, 114688
 buffer_load_dwordx4 v10, s[24:27], s70 offen offset:1024 nt lds
 s_lshl_b32 s93, s91, 4
 s_lshl_b32 s94, s88, 3
 s_add_u32 s93, s93, s94
 s_mul_i32 s18, s93, 57344
 s_lshl_b32 s93, s92, 12
 s_lshl_b32 s94, s89, 11
 s_add_u32 s93, s93, s94
 s_add_u32 s18, s18, s93
 s_add_u32 s18, s18, 33554432
 buffer_load_dwordx4 v11, s[24:27], s70 offen offset:2048 nt lds
 s_movk_i32 s96, 3584
 s_lshl_b32 s97, s68, 6
 s_add_u32 s98, s97, 32
 v_lshrrev_b32 v23, 3, v22
 v_mul_lo_u32 v24, v23, s95
 v_lshrrev_b32 v25, 4, v22
 v_xor_b32 v25, v25, v22
 v_and_b32 v25, 7, v25
 v_lshlrev_b32 v25, 4, v25
 s_add_u32 s90, s97, 0
 s_mul_i32 s90, s90, s95
 s_sub_u32 s90, s90, 0
 buffer_load_dwordx4 v12, s[24:27], s70 offen offset:3072 nt lds
 v_xor_b32 v112, 0, v25
 v_add3_u32 v112, v112, v24, s90
 s_add_u32 s90, s97, 8
 s_mul_i32 s90, s90, s95
 s_sub_u32 s90, s90, 1024
 v_xor_b32 v113, 64, v25
 v_add3_u32 v113, v113, v24, s90
 s_add_u32 s90, s97, 16
 s_mul_i32 s90, s90, s95
 s_sub_u32 s90, s90, 2048
 s_add_u32 m0, s76, 32768
 s_mov_b32 s69, 128
 buffer_load_dwordx4 v1, s[20:23], s69 offen offset:0 lds
 v_xor_b32 v114, 0, v25
 v_add3_u32 v114, v114, v24, s90
 s_add_u32 s90, s97, 24
 s_mul_i32 s90, s90, s95
 s_sub_u32 s90, s90, 3072
 v_xor_b32 v115, 64, v25
 v_add3_u32 v115, v115, v24, s90
 s_add_u32 s90, s98, 0
 s_mul_i32 s90, s90, s95
 s_sub_u32 s90, s90, 0
 buffer_load_dwordx4 v2, s[20:23], s69 offen offset:1024 lds
 v_xor_b32 v116, 0, v25
 v_add3_u32 v116, v116, v24, s90
 s_add_u32 s90, s98, 8
 s_mul_i32 s90, s90, s95
 s_sub_u32 s90, s90, 1024
 v_xor_b32 v117, 64, v25
 v_add3_u32 v117, v117, v24, s90
 s_add_u32 s90, s98, 16
 s_mul_i32 s90, s90, s95
 s_sub_u32 s90, s90, 2048
 buffer_load_dwordx4 v3, s[20:23], s69 offen offset:2048 lds
 v_xor_b32 v118, 0, v25
 v_add3_u32 v118, v118, v24, s90
 s_add_u32 s90, s98, 24
 s_mul_i32 s90, s90, s95
 s_sub_u32 s90, s90, 3072
 v_xor_b32 v119, 64, v25
 v_add3_u32 v119, v119, v24, s90
 v_mul_lo_u32 v24, v23, s96
 v_bfe_u32 v23, v22, 1, 2
 v_bfe_u32 v25, v22, 4, 1
 v_xor_b32 v23, v23, v25
 v_lshlrev_b32 v23, 5, v23
 buffer_load_dwordx4 v4, s[20:23], s69 offen offset:3072 lds
 v_and_b32 v25, 1, v22
 v_lshl_or_b32 v25, v25, 4, v23
 s_mul_i32 s90, s96, 0
 s_sub_u32 s90, s90, 0
 v_xor_b32 v120, 0, v25
 v_add3_u32 v120, v120, v24, s90
 s_mul_i32 s90, s96, 8
 s_sub_u32 s90, s90, 1024
 v_xor_b32 v121, 64, v25
 v_add3_u32 v121, v121, v24, s90
 s_add_u32 m0, s77, 32768
 s_mov_b32 s69, 128
 buffer_load_dwordx4 v5, s[20:23], s69 offen offset:0 lds
 s_mul_i32 s90, s96, 16
 s_sub_u32 s90, s90, 2048
 v_xor_b32 v122, 0, v25
 v_add3_u32 v122, v122, v24, s90
 s_mul_i32 s90, s96, 24
 s_sub_u32 s90, s90, 3072
 v_xor_b32 v123, 64, v25
 v_add3_u32 v123, v123, v24, s90
 s_mul_i32 s15, s82, 4352
 s_add_u32 s15, s15, 52432896
 s_lshl_b32 s93, s84, 3
 s_add_u32 s93, s93, s83
 s_lshl_b32 s93, s93, 3
 s_add_u32 s14, s15, s93
 buffer_load_dwordx4 v6, s[20:23], s69 offen offset:1024 lds
 s_mul_i32 s93, s91, 14
 s_add_u32 s93, s93, s92
 s_mul_i32 s93, s93, 384
 s_add_u32 s16, s93, 52559872
 s_cmp_eq_u32 s81, 1
 s_cbranch_scc1 gated_mix__compressed_kv_cla__glu_gated_swiglu__prompt_kernel_isgu
 s_mov_b32 s28, s4
 s_mov_b32 s29, s5
 s_mov_b32 s30, 1835008
 s_mov_b32 s55, 262144
 s_mov_b32 s32, s52
 s_mov_b32 s33, s53
 s_mov_b32 s34, s54
 v_mov_b32 v112, v240
 v_mov_b32 v113, v241
 v_mov_b32 v114, v242
 v_mov_b32 v115, v243
 v_mov_b32 v116, v244
 v_mov_b32 v117, v245
 v_mov_b32 v118, v246
 v_mov_b32 v119, v247
 v_mov_b32 v120, v248
 v_mov_b32 v121, v249
 v_mov_b32 v122, v250
 v_mov_b32 v123, v251
gated_mix__compressed_kv_cla__glu_gated_swiglu__prompt_kernel_isgu:
 buffer_load_dwordx4 v7, s[20:23], s69 offen offset:2048 lds
 buffer_load_dwordx4 v8, s[20:23], s69 offen offset:3072 lds
 s_lshl_b32 s95, s82, 21
 s_lshl_b32 s96, s3, 18
 s_add_u32 s95, s95, s96
 s_lshl_b32 s96, s88, 17
 s_add_u32 s95, s95, s96
 s_add_u32 m0, s78, 32768
 s_mov_b32 s70, 524288
 buffer_load_dwordx4 v9, s[24:27], s70 offen offset:0 nt lds
 s_lshl_b32 s96, s89, 12
 s_lshl_b32 s97, s89, 13
 s_add_u32 s97, s97, 16384
 s_cmp_eq_u32 s80, 0
 s_cselect_b32 s96, s96, s97
 s_movk_i32 s97, 4096
 s_cselect_b32 s97, 8192, s97
 s_add_u32 s95, s95, s96
 buffer_load_dwordx4 v10, s[24:27], s70 offen offset:1024 nt lds
 s_add_u32 s6, s95, 0
 s_add_u32 s7, s6, s97
 s_add_u32 s8, s95, 32768
 s_add_u32 s9, s8, s97
 s_add_u32 s10, s95, 65536
 s_add_u32 s11, s10, s97
 s_add_u32 s12, s95, 98304
 s_add_u32 s13, s12, s97
 v_lshlrev_b32 v21, 4, v22
 v_and_b32 v30, 15, v22
 v_lshl_add_u32 v30, v30, 3, s15
 v_lshrrev_b32 v23, 4, v22
 v_lshlrev_b32 v254, 4, v23
 buffer_load_dwordx4 v11, s[24:27], s70 offen offset:2048 nt lds
 v_bfe_u32 v24, v22, 2, 2
 v_lshl_add_u32 v25, v23, 3, v24
 v_lshlrev_b32 v25, 7, v25
 v_and_b32 v26, 3, v22
 v_lshl_add_u32 v25, v26, 3, v25
 v_lshrrev_b32 v24, 1, v24
 v_bfe_u32 v26, v22, 4, 1
 v_lshl_or_b32 v24, v26, 1, v24
 v_lshl_add_u32 v25, v24, 5, v25
 buffer_load_dwordx4 v12, s[24:27], s70 offen offset:3072 nt lds
 s_lshl_b32 s93, s89, 13
 v_add_u32 v25, s93, v25
 v_xor_b32 v13, 0, v25
 v_xor_b32 v14, 32, v25
 v_xor_b32 v15, 64, v25
 v_xor_b32 v16, 96, v25
 v_and_b32 v24, 15, v22
 v_lshrrev_b32 v25, 1, v24
 v_xor_b32 v25, v25, v23
 v_lshlrev_b32 v25, 4, v25
 v_lshl_add_u32 v25, v24, 7, v25
 s_add_u32 m0, s78, 49152
 s_mov_b32 s70, 786432
 buffer_load_dwordx4 v9, s[24:27], s70 offen offset:0 nt lds
 s_lshl_b32 s93, s88, 14
 s_add_u32 s93, s93, 65536
 v_add_u32 v19, s93, v25
 v_xor_b32 v20, 64, v19
 v_mov_b32 v17, v19
 v_mov_b32 v18, v20
 v_mov_b32 v40, 0
 v_mov_b32 v41, 0
 buffer_load_dwordx4 v10, s[24:27], s70 offen offset:1024 nt lds
 v_mov_b32 v42, 0
 v_mov_b32 v43, 0
 s_nop 1
 v_mfma_f32_32x32x16_bf16 a[0:15], v[40:43], v[40:43], 0
 v_mfma_f32_32x32x16_bf16 a[16:31], v[40:43], v[40:43], 0
 v_mfma_f32_32x32x16_bf16 a[32:47], v[40:43], v[40:43], 0
 v_mfma_f32_32x32x16_bf16 a[48:63], v[40:43], v[40:43], 0
 v_mfma_f32_32x32x16_bf16 a[64:79], v[40:43], v[40:43], 0
 v_mfma_f32_32x32x16_bf16 a[80:95], v[40:43], v[40:43], 0
 v_mfma_f32_32x32x16_bf16 a[96:111], v[40:43], v[40:43], 0
 v_mfma_f32_32x32x16_bf16 a[112:127], v[40:43], v[40:43], 0
 v_mfma_f32_32x32x16_bf16 a[128:143], v[40:43], v[40:43], 0
 v_mfma_f32_32x32x16_bf16 a[144:159], v[40:43], v[40:43], 0
 v_mfma_f32_32x32x16_bf16 a[160:175], v[40:43], v[40:43], 0
 v_mfma_f32_32x32x16_bf16 a[176:191], v[40:43], v[40:43], 0
 v_mfma_f32_32x32x16_bf16 a[192:207], v[40:43], v[40:43], 0
 v_mfma_f32_32x32x16_bf16 a[208:223], v[40:43], v[40:43], 0
 v_mfma_f32_32x32x16_bf16 a[224:239], v[40:43], v[40:43], 0
 v_mfma_f32_32x32x16_bf16 a[240:255], v[40:43], v[40:43], 0
 s_nop 7
 s_nop 3
 buffer_load_dwordx4 v11, s[24:27], s70 offen offset:2048 nt lds
 buffer_load_dwordx4 v12, s[24:27], s70 offen offset:3072 nt lds
 buffer_load_dword v31, v124, s[40:43], 0 offen
 s_mov_b32 s69, 256
 s_mov_b32 s70, 1048576
 s_waitcnt vmcnt(21)
 s_barrier
 s_cmp_lg_u32 s79, 0
 s_cbranch_scc1 gated_mix__compressed_kv_cla__glu_gated_swiglu__prompt_kernel_notag
 s_mov_b32 s93, 0x9e3779b1
 s_mov_b32 s94, 52428800
 v_mul_lo_u32 v28, v28, s93
 v_add_u32 v28, 0x7f4a7c15, v28
 v_mov_b32 v29, 1
 s_mov_b64 exec, 1
 buffer_store_dwordx2 v[28:29], off, s[44:47], 0 sc1
 buffer_store_dword v28, off, s[36:39], s94 sc1
 s_mov_b64 exec, -1
gated_mix__compressed_kv_cla__glu_gated_swiglu__prompt_kernel_notag:
 ds_read_b64_tr_b16 v[48:49], v13 offset:0
 ds_read_b64_tr_b16 v[50:51], v13 offset:512
 ds_read_b64_tr_b16 v[52:53], v14 offset:0
 ds_read_b64_tr_b16 v[54:55], v14 offset:512
 ds_read_b64_tr_b16 v[56:57], v15 offset:0
 ds_read_b64_tr_b16 v[58:59], v15 offset:512
 ds_read_b64_tr_b16 v[60:61], v16 offset:0
 ds_read_b64_tr_b16 v[62:63], v16 offset:512
 ds_read_b64_tr_b16 v[64:65], v13 offset:4096
 ds_read_b64_tr_b16 v[66:67], v13 offset:4608
 ds_read_b64_tr_b16 v[68:69], v14 offset:4096
 ds_read_b64_tr_b16 v[70:71], v14 offset:4608
 ds_read_b64_tr_b16 v[72:73], v15 offset:4096
 ds_read_b64_tr_b16 v[74:75], v15 offset:4608
 ds_read_b64_tr_b16 v[76:77], v16 offset:4096
 ds_read_b64_tr_b16 v[78:79], v16 offset:4608
 ds_read_b128 v[32:35], v17 offset:0
 ds_read_b128 v[36:39], v17 offset:2048
 s_mov_b32 s79, 0
 s_cmp_lg_u32 s80, 0
 s_waitcnt vmcnt(17) lgkmcnt(1)
 s_cbranch_scc1 gated_mix__compressed_kv_cla__glu_gated_swiglu__prompt_kernel_loopV
.p2align 3
gated_mix__compressed_kv_cla__glu_gated_swiglu__prompt_kernel_loopK:
 v_mfma_f32_16x16x32_bf16 a[0:3], v[48:51], v[32:35], a[0:3]
 s_barrier
 ds_read_b128 v[40:43], v17 offset:4096
 v_mfma_f32_16x16x32_bf16 a[4:7], v[52:55], v[32:35], a[4:7]
 ds_read_b64_tr_b16 v[80:81], v13 offset:16384
 v_mfma_f32_16x16x32_bf16 a[8:11], v[56:59], v[32:35], a[8:11]
 s_add_u32 m0, s72, s76
 v_mfma_f32_16x16x32_bf16 a[12:15], v[60:63], v[32:35], a[12:15]
 ds_read_b64_tr_b16 v[82:83], v13 offset:16896
 v_mfma_f32_16x16x32_bf16 a[16:19], v[64:67], v[32:35], a[16:19]
 buffer_load_dwordx4 v1, s[20:23], s69 offen offset:0 lds
 v_mfma_f32_16x16x32_bf16 a[20:23], v[68:71], v[32:35], a[20:23]
 ds_read_b64_tr_b16 v[84:85], v14 offset:16384
 v_mfma_f32_16x16x32_bf16 a[24:27], v[72:75], v[32:35], a[24:27]
 v_mfma_f32_16x16x32_bf16 a[28:31], v[76:79], v[32:35], a[28:31]
 s_waitcnt lgkmcnt(4)
 v_mfma_f32_16x16x32_bf16 a[60:63], v[76:79], v[36:39], a[60:63]
 ds_read_b128 v[44:47], v17 offset:6144
 v_mfma_f32_16x16x32_bf16 a[56:59], v[72:75], v[36:39], a[56:59]
 ds_read_b64_tr_b16 v[86:87], v14 offset:16896
 v_mfma_f32_16x16x32_bf16 a[52:55], v[68:71], v[36:39], a[52:55]
 v_add_u32 v18, s73, v20
 v_mfma_f32_16x16x32_bf16 a[48:51], v[64:67], v[36:39], a[48:51]
 ds_read_b64_tr_b16 v[88:89], v15 offset:16384
 v_mfma_f32_16x16x32_bf16 a[44:47], v[60:63], v[36:39], a[44:47]
 buffer_load_dwordx4 v2, s[20:23], s69 offen offset:1024 lds
 v_mfma_f32_16x16x32_bf16 a[40:43], v[56:59], v[36:39], a[40:43]
 ds_read_b64_tr_b16 v[90:91], v15 offset:16896
 v_mfma_f32_16x16x32_bf16 a[36:39], v[52:55], v[36:39], a[36:39]
 v_mfma_f32_16x16x32_bf16 a[32:35], v[48:51], v[36:39], a[32:35]
 s_waitcnt lgkmcnt(7)
 v_mfma_f32_16x16x32_bf16 a[64:67], v[48:51], v[40:43], a[64:67]
 ds_read_b128 v[32:35], v17 offset:8192
 v_mfma_f32_16x16x32_bf16 a[68:71], v[52:55], v[40:43], a[68:71]
 ds_read_b64_tr_b16 v[92:93], v16 offset:16384
 v_mfma_f32_16x16x32_bf16 a[72:75], v[56:59], v[40:43], a[72:75]
 v_mfma_f32_16x16x32_bf16 a[76:79], v[60:63], v[40:43], a[76:79]
 ds_read_b64_tr_b16 v[94:95], v16 offset:16896
 v_mfma_f32_16x16x32_bf16 a[80:83], v[64:67], v[40:43], a[80:83]
 buffer_load_dwordx4 v3, s[20:23], s69 offen offset:2048 lds
 v_mfma_f32_16x16x32_bf16 a[84:87], v[68:71], v[40:43], a[84:87]
 ds_read_b64_tr_b16 v[96:97], v13 offset:20480
 v_mfma_f32_16x16x32_bf16 a[88:91], v[72:75], v[40:43], a[88:91]
 v_mfma_f32_16x16x32_bf16 a[92:95], v[76:79], v[40:43], a[92:95]
 s_waitcnt lgkmcnt(7)
 v_mfma_f32_16x16x32_bf16 a[124:127], v[76:79], v[44:47], a[124:127]
 ds_read_b128 v[36:39], v17 offset:10240
 v_mfma_f32_16x16x32_bf16 a[120:123], v[72:75], v[44:47], a[120:123]
 ds_read_b64_tr_b16 v[98:99], v13 offset:20992
 v_mfma_f32_16x16x32_bf16 a[116:119], v[68:71], v[44:47], a[116:119]
 v_mfma_f32_16x16x32_bf16 a[112:115], v[64:67], v[44:47], a[112:115]
 ds_read_b64_tr_b16 v[100:101], v14 offset:20480
 v_mfma_f32_16x16x32_bf16 a[108:111], v[60:63], v[44:47], a[108:111]
 buffer_load_dwordx4 v4, s[20:23], s69 offen offset:3072 lds
 v_mfma_f32_16x16x32_bf16 a[104:107], v[56:59], v[44:47], a[104:107]
 ds_read_b64_tr_b16 v[102:103], v14 offset:20992
 v_mfma_f32_16x16x32_bf16 a[100:103], v[52:55], v[44:47], a[100:103]
 v_mfma_f32_16x16x32_bf16 a[96:99], v[48:51], v[44:47], a[96:99]
 s_waitcnt lgkmcnt(7)
 v_mfma_f32_16x16x32_bf16 a[128:131], v[48:51], v[32:35], a[128:131]
 ds_read_b128 v[40:43], v17 offset:12288
 v_mfma_f32_16x16x32_bf16 a[132:135], v[52:55], v[32:35], a[132:135]
 ds_read_b64_tr_b16 v[104:105], v15 offset:20480
 v_mfma_f32_16x16x32_bf16 a[136:139], v[56:59], v[32:35], a[136:139]
 s_add_u32 m0, s78, 0
 v_mfma_f32_16x16x32_bf16 a[140:143], v[60:63], v[32:35], a[140:143]
 ds_read_b64_tr_b16 v[106:107], v15 offset:20992
 v_mfma_f32_16x16x32_bf16 a[144:147], v[64:67], v[32:35], a[144:147]
 buffer_load_dwordx4 v9, s[24:27], s70 offen offset:0 nt lds
 v_mfma_f32_16x16x32_bf16 a[148:151], v[68:71], v[32:35], a[148:151]
 ds_read_b64_tr_b16 v[108:109], v16 offset:20480
 v_mfma_f32_16x16x32_bf16 a[152:155], v[72:75], v[32:35], a[152:155]
 v_mfma_f32_16x16x32_bf16 a[156:159], v[76:79], v[32:35], a[156:159]
 s_waitcnt lgkmcnt(7)
 v_mfma_f32_16x16x32_bf16 a[188:191], v[76:79], v[36:39], a[188:191]
 ds_read_b128 v[44:47], v17 offset:14336
 v_mfma_f32_16x16x32_bf16 a[184:187], v[72:75], v[36:39], a[184:187]
 ds_read_b64_tr_b16 v[110:111], v16 offset:20992
 v_mfma_f32_16x16x32_bf16 a[180:183], v[68:71], v[36:39], a[180:183]
 v_mfma_f32_16x16x32_bf16 a[176:179], v[64:67], v[36:39], a[176:179]
 v_mfma_f32_16x16x32_bf16 a[172:175], v[60:63], v[36:39], a[172:175]
 buffer_load_dwordx4 v10, s[24:27], s70 offen offset:1024 nt lds
 v_mfma_f32_16x16x32_bf16 a[168:171], v[56:59], v[36:39], a[168:171]
 v_mfma_f32_16x16x32_bf16 a[164:167], v[52:55], v[36:39], a[164:167]
 v_mfma_f32_16x16x32_bf16 a[160:163], v[48:51], v[36:39], a[160:163]
 s_waitcnt lgkmcnt(5)
 v_mfma_f32_16x16x32_bf16 a[192:195], v[48:51], v[40:43], a[192:195]
 ds_read_b128 v[32:35], v18 offset:0
 v_mfma_f32_16x16x32_bf16 a[196:199], v[52:55], v[40:43], a[196:199]
 v_mfma_f32_16x16x32_bf16 a[200:203], v[56:59], v[40:43], a[200:203]
 v_mfma_f32_16x16x32_bf16 a[204:207], v[60:63], v[40:43], a[204:207]
 v_mfma_f32_16x16x32_bf16 a[208:211], v[64:67], v[40:43], a[208:211]
 buffer_load_dwordx4 v11, s[24:27], s70 offen offset:2048 nt lds
 v_mfma_f32_16x16x32_bf16 a[212:215], v[68:71], v[40:43], a[212:215]
 v_mfma_f32_16x16x32_bf16 a[216:219], v[72:75], v[40:43], a[216:219]
 v_mfma_f32_16x16x32_bf16 a[220:223], v[76:79], v[40:43], a[220:223]
 s_waitcnt lgkmcnt(2)
 v_mfma_f32_16x16x32_bf16 a[252:255], v[76:79], v[44:47], a[252:255]
 ds_read_b128 v[36:39], v18 offset:2048
 v_mfma_f32_16x16x32_bf16 a[248:251], v[72:75], v[44:47], a[248:251]
 v_mfma_f32_16x16x32_bf16 a[244:247], v[68:71], v[44:47], a[244:247]
 v_mfma_f32_16x16x32_bf16 a[240:243], v[64:67], v[44:47], a[240:243]
 v_mfma_f32_16x16x32_bf16 a[236:239], v[60:63], v[44:47], a[236:239]
 buffer_load_dwordx4 v12, s[24:27], s70 offen offset:3072 nt lds
 v_mfma_f32_16x16x32_bf16 a[232:235], v[56:59], v[44:47], a[232:235]
 v_mfma_f32_16x16x32_bf16 a[228:231], v[52:55], v[44:47], a[228:231]
 s_add_u32 s70, s70, s71
 v_mfma_f32_16x16x32_bf16 a[224:227], v[48:51], v[44:47], a[224:227]
 s_waitcnt vmcnt(13) lgkmcnt(1)
 v_mfma_f32_16x16x32_bf16 a[0:3], v[80:83], v[32:35], a[0:3]
 s_barrier
 ds_read_b128 v[40:43], v18 offset:4096
 v_mfma_f32_16x16x32_bf16 a[4:7], v[84:87], v[32:35], a[4:7]
 ds_read_b64_tr_b16 v[48:49], v13 offset:32768
 v_mfma_f32_16x16x32_bf16 a[8:11], v[88:91], v[32:35], a[8:11]
 s_add_u32 m0, s72, s77
 v_mfma_f32_16x16x32_bf16 a[12:15], v[92:95], v[32:35], a[12:15]
 ds_read_b64_tr_b16 v[50:51], v13 offset:33280
 v_mfma_f32_16x16x32_bf16 a[16:19], v[96:99], v[32:35], a[16:19]
 buffer_load_dwordx4 v5, s[20:23], s69 offen offset:0 lds
 v_mfma_f32_16x16x32_bf16 a[20:23], v[100:103], v[32:35], a[20:23]
 ds_read_b64_tr_b16 v[52:53], v14 offset:32768
 v_mfma_f32_16x16x32_bf16 a[24:27], v[104:107], v[32:35], a[24:27]
 v_mfma_f32_16x16x32_bf16 a[28:31], v[108:111], v[32:35], a[28:31]
 s_waitcnt lgkmcnt(4)
 v_mfma_f32_16x16x32_bf16 a[60:63], v[108:111], v[36:39], a[60:63]
 ds_read_b128 v[44:47], v18 offset:6144
 v_mfma_f32_16x16x32_bf16 a[56:59], v[104:107], v[36:39], a[56:59]
 ds_read_b64_tr_b16 v[54:55], v14 offset:33280
 v_mfma_f32_16x16x32_bf16 a[52:55], v[100:103], v[36:39], a[52:55]
 v_add_u32 v17, s74, v19
 v_mfma_f32_16x16x32_bf16 a[48:51], v[96:99], v[36:39], a[48:51]
 ds_read_b64_tr_b16 v[56:57], v15 offset:32768
 v_mfma_f32_16x16x32_bf16 a[44:47], v[92:95], v[36:39], a[44:47]
 buffer_load_dwordx4 v6, s[20:23], s69 offen offset:1024 lds
 v_mfma_f32_16x16x32_bf16 a[40:43], v[88:91], v[36:39], a[40:43]
 ds_read_b64_tr_b16 v[58:59], v15 offset:33280
 v_mfma_f32_16x16x32_bf16 a[36:39], v[84:87], v[36:39], a[36:39]
 v_mfma_f32_16x16x32_bf16 a[32:35], v[80:83], v[36:39], a[32:35]
 s_waitcnt lgkmcnt(7)
 v_mfma_f32_16x16x32_bf16 a[64:67], v[80:83], v[40:43], a[64:67]
 ds_read_b128 v[32:35], v18 offset:8192
 v_mfma_f32_16x16x32_bf16 a[68:71], v[84:87], v[40:43], a[68:71]
 ds_read_b64_tr_b16 v[60:61], v16 offset:32768
 v_mfma_f32_16x16x32_bf16 a[72:75], v[88:91], v[40:43], a[72:75]
 v_mfma_f32_16x16x32_bf16 a[76:79], v[92:95], v[40:43], a[76:79]
 ds_read_b64_tr_b16 v[62:63], v16 offset:33280
 v_mfma_f32_16x16x32_bf16 a[80:83], v[96:99], v[40:43], a[80:83]
 buffer_load_dwordx4 v7, s[20:23], s69 offen offset:2048 lds
 v_mfma_f32_16x16x32_bf16 a[84:87], v[100:103], v[40:43], a[84:87]
 ds_read_b64_tr_b16 v[64:65], v13 offset:36864
 v_mfma_f32_16x16x32_bf16 a[88:91], v[104:107], v[40:43], a[88:91]
 v_mfma_f32_16x16x32_bf16 a[92:95], v[108:111], v[40:43], a[92:95]
 s_waitcnt lgkmcnt(7)
 v_mfma_f32_16x16x32_bf16 a[124:127], v[108:111], v[44:47], a[124:127]
 ds_read_b128 v[36:39], v18 offset:10240
 v_mfma_f32_16x16x32_bf16 a[120:123], v[104:107], v[44:47], a[120:123]
 ds_read_b64_tr_b16 v[66:67], v13 offset:37376
 v_mfma_f32_16x16x32_bf16 a[116:119], v[100:103], v[44:47], a[116:119]
 v_mfma_f32_16x16x32_bf16 a[112:115], v[96:99], v[44:47], a[112:115]
 ds_read_b64_tr_b16 v[68:69], v14 offset:36864
 v_mfma_f32_16x16x32_bf16 a[108:111], v[92:95], v[44:47], a[108:111]
 buffer_load_dwordx4 v8, s[20:23], s69 offen offset:3072 lds
 v_mfma_f32_16x16x32_bf16 a[104:107], v[88:91], v[44:47], a[104:107]
 ds_read_b64_tr_b16 v[70:71], v14 offset:37376
 v_mfma_f32_16x16x32_bf16 a[100:103], v[84:87], v[44:47], a[100:103]
 s_add_u32 s69, s69, 128
 v_mfma_f32_16x16x32_bf16 a[96:99], v[80:83], v[44:47], a[96:99]
 s_waitcnt lgkmcnt(7)
 v_mfma_f32_16x16x32_bf16 a[128:131], v[80:83], v[32:35], a[128:131]
 ds_read_b128 v[40:43], v18 offset:12288
 v_mfma_f32_16x16x32_bf16 a[132:135], v[84:87], v[32:35], a[132:135]
 ds_read_b64_tr_b16 v[72:73], v15 offset:36864
 v_mfma_f32_16x16x32_bf16 a[136:139], v[88:91], v[32:35], a[136:139]
 s_add_u32 m0, s78, 16384
 v_mfma_f32_16x16x32_bf16 a[140:143], v[92:95], v[32:35], a[140:143]
 ds_read_b64_tr_b16 v[74:75], v15 offset:37376
 v_mfma_f32_16x16x32_bf16 a[144:147], v[96:99], v[32:35], a[144:147]
 buffer_load_dwordx4 v9, s[24:27], s70 offen offset:0 nt lds
 v_mfma_f32_16x16x32_bf16 a[148:151], v[100:103], v[32:35], a[148:151]
 ds_read_b64_tr_b16 v[76:77], v16 offset:36864
 v_mfma_f32_16x16x32_bf16 a[152:155], v[104:107], v[32:35], a[152:155]
 v_mfma_f32_16x16x32_bf16 a[156:159], v[108:111], v[32:35], a[156:159]
 s_waitcnt lgkmcnt(7)
 v_mfma_f32_16x16x32_bf16 a[188:191], v[108:111], v[36:39], a[188:191]
 ds_read_b128 v[44:47], v18 offset:14336
 v_mfma_f32_16x16x32_bf16 a[184:187], v[104:107], v[36:39], a[184:187]
 ds_read_b64_tr_b16 v[78:79], v16 offset:37376
 v_mfma_f32_16x16x32_bf16 a[180:183], v[100:103], v[36:39], a[180:183]
 v_mfma_f32_16x16x32_bf16 a[176:179], v[96:99], v[36:39], a[176:179]
 v_mfma_f32_16x16x32_bf16 a[172:175], v[92:95], v[36:39], a[172:175]
 buffer_load_dwordx4 v10, s[24:27], s70 offen offset:1024 nt lds
 v_mfma_f32_16x16x32_bf16 a[168:171], v[88:91], v[36:39], a[168:171]
 v_mfma_f32_16x16x32_bf16 a[164:167], v[84:87], v[36:39], a[164:167]
 v_mfma_f32_16x16x32_bf16 a[160:163], v[80:83], v[36:39], a[160:163]
 s_waitcnt lgkmcnt(5)
 v_mfma_f32_16x16x32_bf16 a[192:195], v[80:83], v[40:43], a[192:195]
 ds_read_b128 v[32:35], v17 offset:0
 v_mfma_f32_16x16x32_bf16 a[196:199], v[84:87], v[40:43], a[196:199]
 v_mfma_f32_16x16x32_bf16 a[200:203], v[88:91], v[40:43], a[200:203]
 s_mov_b32 s75, s72
 s_mov_b32 s72, s73
 v_mfma_f32_16x16x32_bf16 a[204:207], v[92:95], v[40:43], a[204:207]
 v_mfma_f32_16x16x32_bf16 a[208:211], v[96:99], v[40:43], a[208:211]
 buffer_load_dwordx4 v11, s[24:27], s70 offen offset:2048 nt lds
 v_mfma_f32_16x16x32_bf16 a[212:215], v[100:103], v[40:43], a[212:215]
 v_mfma_f32_16x16x32_bf16 a[216:219], v[104:107], v[40:43], a[216:219]
 v_add_u32 v124, s19, v124
 v_mfma_f32_16x16x32_bf16 a[220:223], v[108:111], v[40:43], a[220:223]
 s_waitcnt lgkmcnt(2)
 v_mfma_f32_16x16x32_bf16 a[252:255], v[108:111], v[44:47], a[252:255]
 ds_read_b128 v[36:39], v17 offset:2048
 v_mfma_f32_16x16x32_bf16 a[248:251], v[104:107], v[44:47], a[248:251]
 v_mfma_f32_16x16x32_bf16 a[244:247], v[100:103], v[44:47], a[244:247]
 s_mov_b32 s73, s74
 s_mov_b32 s74, s75
 v_mfma_f32_16x16x32_bf16 a[240:243], v[96:99], v[44:47], a[240:243]
 v_mfma_f32_16x16x32_bf16 a[236:239], v[92:95], v[44:47], a[236:239]
 buffer_load_dwordx4 v12, s[24:27], s70 offen offset:3072 nt lds
 v_mfma_f32_16x16x32_bf16 a[232:235], v[88:91], v[44:47], a[232:235]
 v_mfma_f32_16x16x32_bf16 a[228:231], v[84:87], v[44:47], a[228:231]
 s_add_u32 s70, s70, s71
 buffer_load_dword v31, v124, s[40:43], 0 offen
 v_mfma_f32_16x16x32_bf16 a[224:227], v[80:83], v[44:47], a[224:227]
 s_cmp_eq_u32 s79, 7
 s_waitcnt vmcnt(18) lgkmcnt(1)
 s_cbranch_scc1 gated_mix__compressed_kv_cla__glu_gated_swiglu__prompt_kernel_doneK
 v_mfma_f32_16x16x32_bf16 a[0:3], v[48:51], v[32:35], a[0:3]
 s_barrier
 ds_read_b128 v[40:43], v17 offset:4096
 v_mfma_f32_16x16x32_bf16 a[4:7], v[52:55], v[32:35], a[4:7]
 ds_read_b64_tr_b16 v[80:81], v13 offset:49152
 v_mfma_f32_16x16x32_bf16 a[8:11], v[56:59], v[32:35], a[8:11]
 s_add_u32 m0, s72, s76
 v_mfma_f32_16x16x32_bf16 a[12:15], v[60:63], v[32:35], a[12:15]
 ds_read_b64_tr_b16 v[82:83], v13 offset:49664
 v_mfma_f32_16x16x32_bf16 a[16:19], v[64:67], v[32:35], a[16:19]
 buffer_load_dwordx4 v1, s[20:23], s69 offen offset:0 lds
 v_mfma_f32_16x16x32_bf16 a[20:23], v[68:71], v[32:35], a[20:23]
 ds_read_b64_tr_b16 v[84:85], v14 offset:49152
 v_mfma_f32_16x16x32_bf16 a[24:27], v[72:75], v[32:35], a[24:27]
 v_mfma_f32_16x16x32_bf16 a[28:31], v[76:79], v[32:35], a[28:31]
 s_waitcnt lgkmcnt(4)
 v_mfma_f32_16x16x32_bf16 a[60:63], v[76:79], v[36:39], a[60:63]
 ds_read_b128 v[44:47], v17 offset:6144
 v_mfma_f32_16x16x32_bf16 a[56:59], v[72:75], v[36:39], a[56:59]
 ds_read_b64_tr_b16 v[86:87], v14 offset:49664
 v_mfma_f32_16x16x32_bf16 a[52:55], v[68:71], v[36:39], a[52:55]
 v_add_u32 v18, s73, v20
 v_mfma_f32_16x16x32_bf16 a[48:51], v[64:67], v[36:39], a[48:51]
 ds_read_b64_tr_b16 v[88:89], v15 offset:49152
 v_mfma_f32_16x16x32_bf16 a[44:47], v[60:63], v[36:39], a[44:47]
 buffer_load_dwordx4 v2, s[20:23], s69 offen offset:1024 lds
 v_mfma_f32_16x16x32_bf16 a[40:43], v[56:59], v[36:39], a[40:43]
 ds_read_b64_tr_b16 v[90:91], v15 offset:49664
 v_mfma_f32_16x16x32_bf16 a[36:39], v[52:55], v[36:39], a[36:39]
 v_mfma_f32_16x16x32_bf16 a[32:35], v[48:51], v[36:39], a[32:35]
 s_waitcnt lgkmcnt(7)
 v_mfma_f32_16x16x32_bf16 a[64:67], v[48:51], v[40:43], a[64:67]
 ds_read_b128 v[32:35], v17 offset:8192
 v_mfma_f32_16x16x32_bf16 a[68:71], v[52:55], v[40:43], a[68:71]
 ds_read_b64_tr_b16 v[92:93], v16 offset:49152
 v_mfma_f32_16x16x32_bf16 a[72:75], v[56:59], v[40:43], a[72:75]
 v_mfma_f32_16x16x32_bf16 a[76:79], v[60:63], v[40:43], a[76:79]
 ds_read_b64_tr_b16 v[94:95], v16 offset:49664
 v_mfma_f32_16x16x32_bf16 a[80:83], v[64:67], v[40:43], a[80:83]
 buffer_load_dwordx4 v3, s[20:23], s69 offen offset:2048 lds
 v_mfma_f32_16x16x32_bf16 a[84:87], v[68:71], v[40:43], a[84:87]
 ds_read_b64_tr_b16 v[96:97], v13 offset:53248
 v_mfma_f32_16x16x32_bf16 a[88:91], v[72:75], v[40:43], a[88:91]
 v_mfma_f32_16x16x32_bf16 a[92:95], v[76:79], v[40:43], a[92:95]
 s_waitcnt lgkmcnt(7)
 v_mfma_f32_16x16x32_bf16 a[124:127], v[76:79], v[44:47], a[124:127]
 ds_read_b128 v[36:39], v17 offset:10240
 v_mfma_f32_16x16x32_bf16 a[120:123], v[72:75], v[44:47], a[120:123]
 ds_read_b64_tr_b16 v[98:99], v13 offset:53760
 v_mfma_f32_16x16x32_bf16 a[116:119], v[68:71], v[44:47], a[116:119]
 v_mfma_f32_16x16x32_bf16 a[112:115], v[64:67], v[44:47], a[112:115]
 ds_read_b64_tr_b16 v[100:101], v14 offset:53248
 v_mfma_f32_16x16x32_bf16 a[108:111], v[60:63], v[44:47], a[108:111]
 buffer_load_dwordx4 v4, s[20:23], s69 offen offset:3072 lds
 v_mfma_f32_16x16x32_bf16 a[104:107], v[56:59], v[44:47], a[104:107]
 ds_read_b64_tr_b16 v[102:103], v14 offset:53760
 v_mfma_f32_16x16x32_bf16 a[100:103], v[52:55], v[44:47], a[100:103]
 v_mfma_f32_16x16x32_bf16 a[96:99], v[48:51], v[44:47], a[96:99]
 s_waitcnt lgkmcnt(7)
 v_mfma_f32_16x16x32_bf16 a[128:131], v[48:51], v[32:35], a[128:131]
 ds_read_b128 v[40:43], v17 offset:12288
 v_mfma_f32_16x16x32_bf16 a[132:135], v[52:55], v[32:35], a[132:135]
 ds_read_b64_tr_b16 v[104:105], v15 offset:53248
 v_mfma_f32_16x16x32_bf16 a[136:139], v[56:59], v[32:35], a[136:139]
 s_add_u32 m0, s78, 32768
 v_mfma_f32_16x16x32_bf16 a[140:143], v[60:63], v[32:35], a[140:143]
 ds_read_b64_tr_b16 v[106:107], v15 offset:53760
 v_mfma_f32_16x16x32_bf16 a[144:147], v[64:67], v[32:35], a[144:147]
 buffer_load_dwordx4 v9, s[24:27], s70 offen offset:0 nt lds
 v_mfma_f32_16x16x32_bf16 a[148:151], v[68:71], v[32:35], a[148:151]
 ds_read_b64_tr_b16 v[108:109], v16 offset:53248
 v_mfma_f32_16x16x32_bf16 a[152:155], v[72:75], v[32:35], a[152:155]
 v_mfma_f32_16x16x32_bf16 a[156:159], v[76:79], v[32:35], a[156:159]
 s_waitcnt lgkmcnt(7)
 v_mfma_f32_16x16x32_bf16 a[188:191], v[76:79], v[36:39], a[188:191]
 ds_read_b128 v[44:47], v17 offset:14336
 v_mfma_f32_16x16x32_bf16 a[184:187], v[72:75], v[36:39], a[184:187]
 ds_read_b64_tr_b16 v[110:111], v16 offset:53760
 v_mfma_f32_16x16x32_bf16 a[180:183], v[68:71], v[36:39], a[180:183]
 v_mfma_f32_16x16x32_bf16 a[176:179], v[64:67], v[36:39], a[176:179]
 v_mfma_f32_16x16x32_bf16 a[172:175], v[60:63], v[36:39], a[172:175]
 buffer_load_dwordx4 v10, s[24:27], s70 offen offset:1024 nt lds
 v_mfma_f32_16x16x32_bf16 a[168:171], v[56:59], v[36:39], a[168:171]
 v_mfma_f32_16x16x32_bf16 a[164:167], v[52:55], v[36:39], a[164:167]
 v_mfma_f32_16x16x32_bf16 a[160:163], v[48:51], v[36:39], a[160:163]
 s_waitcnt lgkmcnt(5)
 v_mfma_f32_16x16x32_bf16 a[192:195], v[48:51], v[40:43], a[192:195]
 ds_read_b128 v[32:35], v18 offset:0
 v_mfma_f32_16x16x32_bf16 a[196:199], v[52:55], v[40:43], a[196:199]
 v_mfma_f32_16x16x32_bf16 a[200:203], v[56:59], v[40:43], a[200:203]
 v_mfma_f32_16x16x32_bf16 a[204:207], v[60:63], v[40:43], a[204:207]
 v_mfma_f32_16x16x32_bf16 a[208:211], v[64:67], v[40:43], a[208:211]
 buffer_load_dwordx4 v11, s[24:27], s70 offen offset:2048 nt lds
 v_mfma_f32_16x16x32_bf16 a[212:215], v[68:71], v[40:43], a[212:215]
 v_mfma_f32_16x16x32_bf16 a[216:219], v[72:75], v[40:43], a[216:219]
 v_mfma_f32_16x16x32_bf16 a[220:223], v[76:79], v[40:43], a[220:223]
 s_waitcnt lgkmcnt(2)
 v_mfma_f32_16x16x32_bf16 a[252:255], v[76:79], v[44:47], a[252:255]
 ds_read_b128 v[36:39], v18 offset:2048
 v_mfma_f32_16x16x32_bf16 a[248:251], v[72:75], v[44:47], a[248:251]
 v_mfma_f32_16x16x32_bf16 a[244:247], v[68:71], v[44:47], a[244:247]
 v_mfma_f32_16x16x32_bf16 a[240:243], v[64:67], v[44:47], a[240:243]
 v_mfma_f32_16x16x32_bf16 a[236:239], v[60:63], v[44:47], a[236:239]
 buffer_load_dwordx4 v12, s[24:27], s70 offen offset:3072 nt lds
 v_mfma_f32_16x16x32_bf16 a[232:235], v[56:59], v[44:47], a[232:235]
 v_mfma_f32_16x16x32_bf16 a[228:231], v[52:55], v[44:47], a[228:231]
 s_add_u32 s70, s70, s71
 v_mfma_f32_16x16x32_bf16 a[224:227], v[48:51], v[44:47], a[224:227]
 s_waitcnt vmcnt(13) lgkmcnt(1)
 v_mfma_f32_16x16x32_bf16 a[0:3], v[80:83], v[32:35], a[0:3]
 s_barrier
 ds_read_b128 v[40:43], v18 offset:4096
 v_mfma_f32_16x16x32_bf16 a[4:7], v[84:87], v[32:35], a[4:7]
 ds_read_b64_tr_b16 v[48:49], v13 offset:0
 v_mfma_f32_16x16x32_bf16 a[8:11], v[88:91], v[32:35], a[8:11]
 s_add_u32 m0, s72, s77
 v_mfma_f32_16x16x32_bf16 a[12:15], v[92:95], v[32:35], a[12:15]
 ds_read_b64_tr_b16 v[50:51], v13 offset:512
 v_mfma_f32_16x16x32_bf16 a[16:19], v[96:99], v[32:35], a[16:19]
 buffer_load_dwordx4 v5, s[20:23], s69 offen offset:0 lds
 v_mfma_f32_16x16x32_bf16 a[20:23], v[100:103], v[32:35], a[20:23]
 ds_read_b64_tr_b16 v[52:53], v14 offset:0
 v_mfma_f32_16x16x32_bf16 a[24:27], v[104:107], v[32:35], a[24:27]
 v_mfma_f32_16x16x32_bf16 a[28:31], v[108:111], v[32:35], a[28:31]
 s_waitcnt lgkmcnt(4)
 v_mfma_f32_16x16x32_bf16 a[60:63], v[108:111], v[36:39], a[60:63]
 ds_read_b128 v[44:47], v18 offset:6144
 v_mfma_f32_16x16x32_bf16 a[56:59], v[104:107], v[36:39], a[56:59]
 ds_read_b64_tr_b16 v[54:55], v14 offset:512
 v_mfma_f32_16x16x32_bf16 a[52:55], v[100:103], v[36:39], a[52:55]
 v_add_u32 v17, s74, v19
 v_mfma_f32_16x16x32_bf16 a[48:51], v[96:99], v[36:39], a[48:51]
 ds_read_b64_tr_b16 v[56:57], v15 offset:0
 v_mfma_f32_16x16x32_bf16 a[44:47], v[92:95], v[36:39], a[44:47]
 buffer_load_dwordx4 v6, s[20:23], s69 offen offset:1024 lds
 v_mfma_f32_16x16x32_bf16 a[40:43], v[88:91], v[36:39], a[40:43]
 ds_read_b64_tr_b16 v[58:59], v15 offset:512
 v_mfma_f32_16x16x32_bf16 a[36:39], v[84:87], v[36:39], a[36:39]
 v_mfma_f32_16x16x32_bf16 a[32:35], v[80:83], v[36:39], a[32:35]
 s_waitcnt lgkmcnt(7)
 v_mfma_f32_16x16x32_bf16 a[64:67], v[80:83], v[40:43], a[64:67]
 ds_read_b128 v[32:35], v18 offset:8192
 v_mfma_f32_16x16x32_bf16 a[68:71], v[84:87], v[40:43], a[68:71]
 ds_read_b64_tr_b16 v[60:61], v16 offset:0
 v_mfma_f32_16x16x32_bf16 a[72:75], v[88:91], v[40:43], a[72:75]
 v_mfma_f32_16x16x32_bf16 a[76:79], v[92:95], v[40:43], a[76:79]
 ds_read_b64_tr_b16 v[62:63], v16 offset:512
 v_mfma_f32_16x16x32_bf16 a[80:83], v[96:99], v[40:43], a[80:83]
 buffer_load_dwordx4 v7, s[20:23], s69 offen offset:2048 lds
 v_mfma_f32_16x16x32_bf16 a[84:87], v[100:103], v[40:43], a[84:87]
 ds_read_b64_tr_b16 v[64:65], v13 offset:4096
 v_mfma_f32_16x16x32_bf16 a[88:91], v[104:107], v[40:43], a[88:91]
 v_mfma_f32_16x16x32_bf16 a[92:95], v[108:111], v[40:43], a[92:95]
 s_waitcnt lgkmcnt(7)
 v_mfma_f32_16x16x32_bf16 a[124:127], v[108:111], v[44:47], a[124:127]
 ds_read_b128 v[36:39], v18 offset:10240
 v_mfma_f32_16x16x32_bf16 a[120:123], v[104:107], v[44:47], a[120:123]
 ds_read_b64_tr_b16 v[66:67], v13 offset:4608
 v_mfma_f32_16x16x32_bf16 a[116:119], v[100:103], v[44:47], a[116:119]
 v_mfma_f32_16x16x32_bf16 a[112:115], v[96:99], v[44:47], a[112:115]
 ds_read_b64_tr_b16 v[68:69], v14 offset:4096
 v_mfma_f32_16x16x32_bf16 a[108:111], v[92:95], v[44:47], a[108:111]
 buffer_load_dwordx4 v8, s[20:23], s69 offen offset:3072 lds
 v_mfma_f32_16x16x32_bf16 a[104:107], v[88:91], v[44:47], a[104:107]
 ds_read_b64_tr_b16 v[70:71], v14 offset:4608
 v_mfma_f32_16x16x32_bf16 a[100:103], v[84:87], v[44:47], a[100:103]
 s_add_u32 s69, s69, 128
 v_mfma_f32_16x16x32_bf16 a[96:99], v[80:83], v[44:47], a[96:99]
 s_waitcnt lgkmcnt(7)
 v_mfma_f32_16x16x32_bf16 a[128:131], v[80:83], v[32:35], a[128:131]
 ds_read_b128 v[40:43], v18 offset:12288
 v_mfma_f32_16x16x32_bf16 a[132:135], v[84:87], v[32:35], a[132:135]
 ds_read_b64_tr_b16 v[72:73], v15 offset:4096
 v_mfma_f32_16x16x32_bf16 a[136:139], v[88:91], v[32:35], a[136:139]
 s_add_u32 m0, s78, 49152
 v_mfma_f32_16x16x32_bf16 a[140:143], v[92:95], v[32:35], a[140:143]
 ds_read_b64_tr_b16 v[74:75], v15 offset:4608
 v_mfma_f32_16x16x32_bf16 a[144:147], v[96:99], v[32:35], a[144:147]
 buffer_load_dwordx4 v9, s[24:27], s70 offen offset:0 nt lds
 v_mfma_f32_16x16x32_bf16 a[148:151], v[100:103], v[32:35], a[148:151]
 ds_read_b64_tr_b16 v[76:77], v16 offset:4096
 v_mfma_f32_16x16x32_bf16 a[152:155], v[104:107], v[32:35], a[152:155]
 v_mfma_f32_16x16x32_bf16 a[156:159], v[108:111], v[32:35], a[156:159]
 s_waitcnt lgkmcnt(7)
 v_mfma_f32_16x16x32_bf16 a[188:191], v[108:111], v[36:39], a[188:191]
 ds_read_b128 v[44:47], v18 offset:14336
 v_mfma_f32_16x16x32_bf16 a[184:187], v[104:107], v[36:39], a[184:187]
 ds_read_b64_tr_b16 v[78:79], v16 offset:4608
 v_mfma_f32_16x16x32_bf16 a[180:183], v[100:103], v[36:39], a[180:183]
 v_mfma_f32_16x16x32_bf16 a[176:179], v[96:99], v[36:39], a[176:179]
 v_mfma_f32_16x16x32_bf16 a[172:175], v[92:95], v[36:39], a[172:175]
 buffer_load_dwordx4 v10, s[24:27], s70 offen offset:1024 nt lds
 v_mfma_f32_16x16x32_bf16 a[168:171], v[88:91], v[36:39], a[168:171]
 v_mfma_f32_16x16x32_bf16 a[164:167], v[84:87], v[36:39], a[164:167]
 v_mfma_f32_16x16x32_bf16 a[160:163], v[80:83], v[36:39], a[160:163]
 s_waitcnt lgkmcnt(5)
 v_mfma_f32_16x16x32_bf16 a[192:195], v[80:83], v[40:43], a[192:195]
 ds_read_b128 v[32:35], v17 offset:0
 v_mfma_f32_16x16x32_bf16 a[196:199], v[84:87], v[40:43], a[196:199]
 v_mfma_f32_16x16x32_bf16 a[200:203], v[88:91], v[40:43], a[200:203]
 s_mov_b32 s75, s72
 s_mov_b32 s72, s73
 v_mfma_f32_16x16x32_bf16 a[204:207], v[92:95], v[40:43], a[204:207]
 v_mfma_f32_16x16x32_bf16 a[208:211], v[96:99], v[40:43], a[208:211]
 buffer_load_dwordx4 v11, s[24:27], s70 offen offset:2048 nt lds
 v_mfma_f32_16x16x32_bf16 a[212:215], v[100:103], v[40:43], a[212:215]
 v_mfma_f32_16x16x32_bf16 a[216:219], v[104:107], v[40:43], a[216:219]
 v_add_u32 v124, s19, v124
 v_mfma_f32_16x16x32_bf16 a[220:223], v[108:111], v[40:43], a[220:223]
 s_waitcnt lgkmcnt(2)
 v_mfma_f32_16x16x32_bf16 a[252:255], v[108:111], v[44:47], a[252:255]
 ds_read_b128 v[36:39], v17 offset:2048
 v_mfma_f32_16x16x32_bf16 a[248:251], v[104:107], v[44:47], a[248:251]
 v_mfma_f32_16x16x32_bf16 a[244:247], v[100:103], v[44:47], a[244:247]
 s_mov_b32 s73, s74
 s_mov_b32 s74, s75
 v_mfma_f32_16x16x32_bf16 a[240:243], v[96:99], v[44:47], a[240:243]
 v_mfma_f32_16x16x32_bf16 a[236:239], v[92:95], v[44:47], a[236:239]
 buffer_load_dwordx4 v12, s[24:27], s70 offen offset:3072 nt lds
 v_mfma_f32_16x16x32_bf16 a[232:235], v[88:91], v[44:47], a[232:235]
 v_mfma_f32_16x16x32_bf16 a[228:231], v[84:87], v[44:47], a[228:231]
 s_add_u32 s70, s70, s71
 buffer_load_dword v31, v124, s[40:43], 0 offen
 v_mfma_f32_16x16x32_bf16 a[224:227], v[80:83], v[44:47], a[224:227]
 s_add_u32 s79, s79, 1
 s_cmp_lt_u32 s79, 7
 s_waitcnt vmcnt(18) lgkmcnt(1)
 s_cbranch_scc1 gated_mix__compressed_kv_cla__glu_gated_swiglu__prompt_kernel_loopK
 v_mov_b32 v1, v112
 v_mov_b32 v2, v113
 v_mov_b32 v3, v114
 v_mov_b32 v4, v115
 v_mov_b32 v5, v116
 v_mov_b32 v6, v117
 v_mov_b32 v7, v118
 v_mov_b32 v8, v119
 v_mov_b32 v9, v120
 v_mov_b32 v10, v121
 v_mov_b32 v11, v122
 v_mov_b32 v12, v123
 s_mov_b32 s20, s28
 s_mov_b32 s24, s32
 s_mov_b32 s21, s29
 s_mov_b32 s25, s33
 s_mov_b32 s22, s30
 s_mov_b32 s26, s34
 s_getpc_b64 s[96:97]
gated_mix__compressed_kv_cla__glu_gated_swiglu__prompt_kernel_pc1:
 s_sub_u32 s96, s96, gated_mix__compressed_kv_cla__glu_gated_swiglu__prompt_kernel_pc1-gated_mix__compressed_kv_cla__glu_gated_swiglu__prompt_kernel_pc
 s_subb_u32 s97, s97, 0
 global_load_dword v31, v27, s[96:97]
 buffer_load_dwordx2 v[28:29], off, s[44:47], 0 sc1
 s_mov_b32 s69, 0
 s_mov_b32 s70, 0
 s_mov_b32 s71, s55
 s_branch gated_mix__compressed_kv_cla__glu_gated_swiglu__prompt_kernel_loopK
gated_mix__compressed_kv_cla__glu_gated_swiglu__prompt_kernel_doneK:
 v_mfma_f32_16x16x32_bf16 a[0:3], v[48:51], v[32:35], a[0:3]
 s_barrier
 v_add_u32 v18, s73, v20
 ds_read_b64_tr_b16 v[80:81], v13 offset:49152
 v_mfma_f32_16x16x32_bf16 a[4:7], v[52:55], v[32:35], a[4:7]
 ds_read_b128 v[40:43], v18 offset:0
 ds_read_b64_tr_b16 v[82:83], v13 offset:49664
 v_mfma_f32_16x16x32_bf16 a[8:11], v[56:59], v[32:35], a[8:11]
 ds_read_b64_tr_b16 v[84:85], v14 offset:49152
 v_mfma_f32_16x16x32_bf16 a[12:15], v[60:63], v[32:35], a[12:15]
 ds_read_b64_tr_b16 v[86:87], v14 offset:49664
 v_mfma_f32_16x16x32_bf16 a[16:19], v[64:67], v[32:35], a[16:19]
 ds_read_b64_tr_b16 v[88:89], v15 offset:49152
 v_mfma_f32_16x16x32_bf16 a[20:23], v[68:71], v[32:35], a[20:23]
 ds_read_b64_tr_b16 v[90:91], v15 offset:49664
 v_mfma_f32_16x16x32_bf16 a[24:27], v[72:75], v[32:35], a[24:27]
 ds_read_b64_tr_b16 v[92:93], v16 offset:49152
 ds_read_b64_tr_b16 v[104:105], v15 offset:53248
 v_mfma_f32_16x16x32_bf16 a[28:31], v[76:79], v[32:35], a[28:31]
 s_waitcnt lgkmcnt(9)
 ds_read_b64_tr_b16 v[94:95], v16 offset:49664
 ds_read_b64_tr_b16 v[106:107], v15 offset:53760
 v_mfma_f32_16x16x32_bf16 a[60:63], v[76:79], v[36:39], a[60:63]
 ds_read_b64_tr_b16 v[96:97], v13 offset:53248
 ds_read_b64_tr_b16 v[108:109], v16 offset:53248
 v_mfma_f32_16x16x32_bf16 a[56:59], v[72:75], v[36:39], a[56:59]
 ds_read_b128 v[44:47], v18 offset:2048
 ds_read_b64_tr_b16 v[98:99], v13 offset:53760
 ds_read_b64_tr_b16 v[110:111], v16 offset:53760
 v_mfma_f32_16x16x32_bf16 a[52:55], v[68:71], v[36:39], a[52:55]
 ds_read_b64_tr_b16 v[100:101], v14 offset:53248
 v_mfma_f32_16x16x32_bf16 a[48:51], v[64:67], v[36:39], a[48:51]
 ds_read_b64_tr_b16 v[102:103], v14 offset:53760
 v_mfma_f32_16x16x32_bf16 a[44:47], v[60:63], v[36:39], a[44:47]
 v_mfma_f32_16x16x32_bf16 a[40:43], v[56:59], v[36:39], a[40:43]
 v_mfma_f32_16x16x32_bf16 a[36:39], v[52:55], v[36:39], a[36:39]
 s_add_u32 m0, s72, s76
 v_mfma_f32_16x16x32_bf16 a[32:35], v[48:51], v[36:39], a[32:35]
 s_waitcnt lgkmcnt(0)
 v_mfma_f32_16x16x32_bf16 a[0:3], v[80:83], v[40:43], a[0:3]
 buffer_load_dwordx4 v1, s[20:23], s69 offen offset:0 lds
 v_mfma_f32_16x16x32_bf16 a[4:7], v[84:87], v[40:43], a[4:7]
 ds_read_b128 v[32:35], v17 offset:4096
 v_mfma_f32_16x16x32_bf16 a[8:11], v[88:91], v[40:43], a[8:11]
 v_mfma_f32_16x16x32_bf16 a[12:15], v[92:95], v[40:43], a[12:15]
 v_mfma_f32_16x16x32_bf16 a[16:19], v[96:99], v[40:43], a[16:19]
 v_mfma_f32_16x16x32_bf16 a[20:23], v[100:103], v[40:43], a[20:23]
 v_mfma_f32_16x16x32_bf16 a[24:27], v[104:107], v[40:43], a[24:27]
 buffer_load_dwordx4 v2, s[20:23], s69 offen offset:1024 lds
 v_mfma_f32_16x16x32_bf16 a[28:31], v[108:111], v[40:43], a[28:31]
 v_mfma_f32_16x16x32_bf16 a[60:63], v[108:111], v[44:47], a[60:63]
 v_mfma_f32_16x16x32_bf16 a[56:59], v[104:107], v[44:47], a[56:59]
 ds_read_b128 v[36:39], v17 offset:6144
 v_mfma_f32_16x16x32_bf16 a[52:55], v[100:103], v[44:47], a[52:55]
 v_mfma_f32_16x16x32_bf16 a[48:51], v[96:99], v[44:47], a[48:51]
 v_mfma_f32_16x16x32_bf16 a[44:47], v[92:95], v[44:47], a[44:47]
 buffer_load_dwordx4 v3, s[20:23], s69 offen offset:2048 lds
 v_mfma_f32_16x16x32_bf16 a[40:43], v[88:91], v[44:47], a[40:43]
 v_mfma_f32_16x16x32_bf16 a[36:39], v[84:87], v[44:47], a[36:39]
 v_mfma_f32_16x16x32_bf16 a[32:35], v[80:83], v[44:47], a[32:35]
 s_waitcnt lgkmcnt(1)
 v_mfma_f32_16x16x32_bf16 a[64:67], v[48:51], v[32:35], a[64:67]
 v_mfma_f32_16x16x32_bf16 a[68:71], v[52:55], v[32:35], a[68:71]
 ds_read_b128 v[40:43], v18 offset:4096
 v_mfma_f32_16x16x32_bf16 a[72:75], v[56:59], v[32:35], a[72:75]
 buffer_load_dwordx4 v4, s[20:23], s69 offen offset:3072 lds
 v_mfma_f32_16x16x32_bf16 a[76:79], v[60:63], v[32:35], a[76:79]
 v_accvgpr_read_b32 v224, a0
 v_accvgpr_read_b32 v225, a1
 v_accvgpr_read_b32 v226, a2
 v_accvgpr_read_b32 v227, a3
 v_mfma_f32_16x16x32_bf16 a[80:83], v[64:67], v[32:35], a[80:83]
 v_accvgpr_read_b32 v228, a4
 v_accvgpr_read_b32 v229, a5
 v_accvgpr_read_b32 v230, a6
 v_accvgpr_read_b32 v231, a7
 v_mfma_f32_16x16x32_bf16 a[84:87], v[68:71], v[32:35], a[84:87]
 v_cvt_pk_bf16_f32 v112, v224, v225
 v_cvt_pk_bf16_f32 v113, v226, v227
 v_cvt_pk_bf16_f32 v114, v228, v229
 v_cvt_pk_bf16_f32 v115, v230, v231
 v_mfma_f32_16x16x32_bf16 a[88:91], v[72:75], v[32:35], a[88:91]
 s_add_u32 m0, s78, 32768
 v_accvgpr_read_b32 v240, a8
 v_accvgpr_read_b32 v241, a9
 v_accvgpr_read_b32 v242, a10
 v_accvgpr_read_b32 v243, a11
 v_mfma_f32_16x16x32_bf16 a[92:95], v[76:79], v[32:35], a[92:95]
 s_waitcnt lgkmcnt(1)
 v_accvgpr_read_b32 v244, a12
 v_accvgpr_read_b32 v245, a13
 v_accvgpr_read_b32 v246, a14
 v_accvgpr_read_b32 v247, a15
 v_mfma_f32_16x16x32_bf16 a[124:127], v[76:79], v[36:39], a[124:127]
 buffer_load_dwordx4 v9, s[24:27], s70 offen offset:0 lds
 v_mfma_f32_16x16x32_bf16 a[120:123], v[72:75], v[36:39], a[120:123]
 ds_read_b128 v[44:47], v18 offset:6144
 v_cvt_pk_bf16_f32 v116, v240, v241
 v_cvt_pk_bf16_f32 v117, v242, v243
 v_cvt_pk_bf16_f32 v118, v244, v245
 v_cvt_pk_bf16_f32 v119, v246, v247
 v_mfma_f32_16x16x32_bf16 a[116:119], v[68:71], v[36:39], a[116:119]
 v_accvgpr_read_b32 v224, a16
 v_accvgpr_read_b32 v225, a17
 v_accvgpr_read_b32 v226, a18
 v_mfma_f32_16x16x32_bf16 a[112:115], v[64:67], v[36:39], a[112:115]
 v_accvgpr_read_b32 v227, a19
 v_accvgpr_read_b32 v228, a20
 v_accvgpr_read_b32 v229, a21
 v_accvgpr_read_b32 v230, a22
 v_mfma_f32_16x16x32_bf16 a[108:111], v[60:63], v[36:39], a[108:111]
 v_accvgpr_read_b32 v231, a23
 v_cvt_pk_bf16_f32 v120, v224, v225
 v_cvt_pk_bf16_f32 v121, v226, v227
 v_cvt_pk_bf16_f32 v122, v228, v229
 v_mfma_f32_16x16x32_bf16 a[104:107], v[56:59], v[36:39], a[104:107]
 v_cvt_pk_bf16_f32 v123, v230, v231
 v_accvgpr_read_b32 v240, a24
 v_accvgpr_read_b32 v241, a25
 v_accvgpr_read_b32 v242, a26
 v_mfma_f32_16x16x32_bf16 a[100:103], v[52:55], v[36:39], a[100:103]
 buffer_load_dwordx4 v10, s[24:27], s70 offen offset:1024 lds
 v_mfma_f32_16x16x32_bf16 a[96:99], v[48:51], v[36:39], a[96:99]
 s_waitcnt lgkmcnt(1)
 v_accvgpr_read_b32 v243, a27
 v_accvgpr_read_b32 v244, a28
 v_accvgpr_read_b32 v245, a29
 v_accvgpr_read_b32 v246, a30
 v_mfma_f32_16x16x32_bf16 a[64:67], v[80:83], v[40:43], a[64:67]
 v_accvgpr_read_b32 v247, a31
 v_cvt_pk_bf16_f32 v124, v240, v241
 v_cvt_pk_bf16_f32 v125, v242, v243
 v_cvt_pk_bf16_f32 v126, v244, v245
 v_mfma_f32_16x16x32_bf16 a[68:71], v[84:87], v[40:43], a[68:71]
 ds_read_b128 v[32:35], v17 offset:8192
 v_cvt_pk_bf16_f32 v127, v246, v247
 v_accvgpr_read_b32 v224, a32
 v_accvgpr_read_b32 v225, a33
 v_mfma_f32_16x16x32_bf16 a[72:75], v[88:91], v[40:43], a[72:75]
 v_accvgpr_read_b32 v226, a34
 v_accvgpr_read_b32 v227, a35
 v_accvgpr_read_b32 v228, a36
 v_accvgpr_read_b32 v229, a37
 v_mfma_f32_16x16x32_bf16 a[76:79], v[92:95], v[40:43], a[76:79]
 v_accvgpr_read_b32 v230, a38
 v_accvgpr_read_b32 v231, a39
 v_cvt_pk_bf16_f32 v128, v224, v225
 v_cvt_pk_bf16_f32 v129, v226, v227
 v_mfma_f32_16x16x32_bf16 a[80:83], v[96:99], v[40:43], a[80:83]
 buffer_load_dwordx4 v11, s[24:27], s70 offen offset:2048 lds
 v_mfma_f32_16x16x32_bf16 a[84:87], v[100:103], v[40:43], a[84:87]
 v_cvt_pk_bf16_f32 v130, v228, v229
 v_cvt_pk_bf16_f32 v131, v230, v231
 v_accvgpr_read_b32 v240, a40
 v_accvgpr_read_b32 v241, a41
 v_mfma_f32_16x16x32_bf16 a[88:91], v[104:107], v[40:43], a[88:91]
 v_accvgpr_read_b32 v242, a42
 v_accvgpr_read_b32 v243, a43
 v_accvgpr_read_b32 v244, a44
 v_accvgpr_read_b32 v245, a45
 v_mfma_f32_16x16x32_bf16 a[92:95], v[108:111], v[40:43], a[92:95]
 s_waitcnt lgkmcnt(1)
 v_accvgpr_read_b32 v246, a46
 v_accvgpr_read_b32 v247, a47
 v_cvt_pk_bf16_f32 v132, v240, v241
 v_cvt_pk_bf16_f32 v133, v242, v243
 v_mfma_f32_16x16x32_bf16 a[124:127], v[108:111], v[44:47], a[124:127]
 v_cvt_pk_bf16_f32 v134, v244, v245
 v_cvt_pk_bf16_f32 v135, v246, v247
 v_accvgpr_read_b32 v224, a48
 v_mfma_f32_16x16x32_bf16 a[120:123], v[104:107], v[44:47], a[120:123]
 ds_read_b128 v[36:39], v17 offset:10240
 v_accvgpr_read_b32 v225, a49
 v_accvgpr_read_b32 v226, a50
 v_accvgpr_read_b32 v227, a51
 v_accvgpr_read_b32 v228, a52
 v_mfma_f32_16x16x32_bf16 a[116:119], v[100:103], v[44:47], a[116:119]
 buffer_load_dwordx4 v12, s[24:27], s70 offen offset:3072 lds
 v_mfma_f32_16x16x32_bf16 a[112:115], v[96:99], v[44:47], a[112:115]
 v_accvgpr_read_b32 v229, a53
 v_accvgpr_read_b32 v230, a54
 v_accvgpr_read_b32 v231, a55
 v_cvt_pk_bf16_f32 v136, v224, v225
 v_mfma_f32_16x16x32_bf16 a[108:111], v[92:95], v[44:47], a[108:111]
 s_add_u32 s70, s70, s71
 v_cvt_pk_bf16_f32 v137, v226, v227
 v_cvt_pk_bf16_f32 v138, v228, v229
 v_cvt_pk_bf16_f32 v139, v230, v231
 v_accvgpr_read_b32 v240, a56
 v_mfma_f32_16x16x32_bf16 a[104:107], v[88:91], v[44:47], a[104:107]
 v_accvgpr_read_b32 v241, a57
 v_accvgpr_read_b32 v242, a58
 v_accvgpr_read_b32 v243, a59
 v_accvgpr_read_b32 v244, a60
 v_mfma_f32_16x16x32_bf16 a[100:103], v[84:87], v[44:47], a[100:103]
 s_waitcnt vmcnt(13)
 s_barrier
 v_accvgpr_read_b32 v245, a61
 v_accvgpr_read_b32 v246, a62
 v_accvgpr_read_b32 v247, a63
 v_cvt_pk_bf16_f32 v140, v240, v241
 v_mfma_f32_16x16x32_bf16 a[96:99], v[80:83], v[44:47], a[96:99]
 s_waitcnt lgkmcnt(1)
 v_cvt_pk_bf16_f32 v141, v242, v243
 v_cvt_pk_bf16_f32 v142, v244, v245
 v_cvt_pk_bf16_f32 v143, v246, v247
 v_mfma_f32_16x16x32_bf16 a[128:131], v[48:51], v[32:35], a[128:131]
 v_mfma_f32_16x16x32_bf16 a[132:135], v[52:55], v[32:35], a[132:135]
 ds_read_b128 v[40:43], v18 offset:8192
 v_mfma_f32_16x16x32_bf16 a[136:139], v[56:59], v[32:35], a[136:139]
 v_mfma_f32_16x16x32_bf16 a[140:143], v[60:63], v[32:35], a[140:143]
 v_accvgpr_read_b32 v224, a64
 v_accvgpr_read_b32 v225, a65
 v_accvgpr_read_b32 v226, a66
 v_accvgpr_read_b32 v227, a67
 v_mfma_f32_16x16x32_bf16 a[144:147], v[64:67], v[32:35], a[144:147]
 v_accvgpr_read_b32 v228, a68
 v_accvgpr_read_b32 v229, a69
 v_accvgpr_read_b32 v230, a70
 v_accvgpr_read_b32 v231, a71
 v_mfma_f32_16x16x32_bf16 a[148:151], v[68:71], v[32:35], a[148:151]
 v_cvt_pk_bf16_f32 v144, v224, v225
 v_cvt_pk_bf16_f32 v145, v226, v227
 v_cvt_pk_bf16_f32 v146, v228, v229
 v_cvt_pk_bf16_f32 v147, v230, v231
 v_mfma_f32_16x16x32_bf16 a[152:155], v[72:75], v[32:35], a[152:155]
 v_accvgpr_read_b32 v240, a72
 v_accvgpr_read_b32 v241, a73
 v_accvgpr_read_b32 v242, a74
 v_mfma_f32_16x16x32_bf16 a[156:159], v[76:79], v[32:35], a[156:159]
 s_waitcnt lgkmcnt(1)
 v_accvgpr_read_b32 v243, a75
 v_accvgpr_read_b32 v244, a76
 v_accvgpr_read_b32 v245, a77
 v_accvgpr_read_b32 v246, a78
 v_mfma_f32_16x16x32_bf16 a[188:191], v[76:79], v[36:39], a[188:191]
 v_accvgpr_read_b32 v247, a79
 v_cvt_pk_bf16_f32 v148, v240, v241
 v_cvt_pk_bf16_f32 v149, v242, v243
 v_cvt_pk_bf16_f32 v150, v244, v245
 v_mfma_f32_16x16x32_bf16 a[184:187], v[72:75], v[36:39], a[184:187]
 ds_read_b128 v[44:47], v18 offset:10240
 v_cvt_pk_bf16_f32 v151, v246, v247
 v_accvgpr_read_b32 v224, a80
 v_accvgpr_read_b32 v225, a81
 v_mfma_f32_16x16x32_bf16 a[180:183], v[68:71], v[36:39], a[180:183]
 v_accvgpr_read_b32 v226, a82
 v_accvgpr_read_b32 v227, a83
 v_accvgpr_read_b32 v228, a84
 v_accvgpr_read_b32 v229, a85
 v_mfma_f32_16x16x32_bf16 a[176:179], v[64:67], v[36:39], a[176:179]
 v_accvgpr_read_b32 v230, a86
 v_accvgpr_read_b32 v231, a87
 v_cvt_pk_bf16_f32 v152, v224, v225
 v_cvt_pk_bf16_f32 v153, v226, v227
 v_mfma_f32_16x16x32_bf16 a[172:175], v[60:63], v[36:39], a[172:175]
 v_cvt_pk_bf16_f32 v154, v228, v229
 v_cvt_pk_bf16_f32 v155, v230, v231
 v_accvgpr_read_b32 v240, a88
 v_mfma_f32_16x16x32_bf16 a[168:171], v[56:59], v[36:39], a[168:171]
 v_accvgpr_read_b32 v241, a89
 v_accvgpr_read_b32 v242, a90
 v_accvgpr_read_b32 v243, a91
 v_accvgpr_read_b32 v244, a92
 v_mfma_f32_16x16x32_bf16 a[164:167], v[52:55], v[36:39], a[164:167]
 s_add_u32 m0, s72, s77
 v_accvgpr_read_b32 v245, a93
 v_accvgpr_read_b32 v246, a94
 v_accvgpr_read_b32 v247, a95
 v_cvt_pk_bf16_f32 v156, v240, v241
 v_mfma_f32_16x16x32_bf16 a[160:163], v[48:51], v[36:39], a[160:163]
 s_waitcnt lgkmcnt(1)
 v_cvt_pk_bf16_f32 v157, v242, v243
 v_cvt_pk_bf16_f32 v158, v244, v245
 v_cvt_pk_bf16_f32 v159, v246, v247
 v_mfma_f32_16x16x32_bf16 a[128:131], v[80:83], v[40:43], a[128:131]
 buffer_load_dwordx4 v5, s[20:23], s69 offen offset:0 lds
 v_mfma_f32_16x16x32_bf16 a[132:135], v[84:87], v[40:43], a[132:135]
 ds_read_b128 v[32:35], v17 offset:12288
 v_accvgpr_read_b32 v224, a96
 v_accvgpr_read_b32 v225, a97
 v_accvgpr_read_b32 v226, a98
 v_accvgpr_read_b32 v227, a99
 v_mfma_f32_16x16x32_bf16 a[136:139], v[88:91], v[40:43], a[136:139]
 v_accvgpr_read_b32 v228, a100
 v_accvgpr_read_b32 v229, a101
 v_accvgpr_read_b32 v230, a102
 v_accvgpr_read_b32 v231, a103
 v_mfma_f32_16x16x32_bf16 a[140:143], v[92:95], v[40:43], a[140:143]
 v_cvt_pk_bf16_f32 v160, v224, v225
 v_cvt_pk_bf16_f32 v161, v226, v227
 v_cvt_pk_bf16_f32 v162, v228, v229
 v_cvt_pk_bf16_f32 v163, v230, v231
 v_mfma_f32_16x16x32_bf16 a[144:147], v[96:99], v[40:43], a[144:147]
 v_accvgpr_read_b32 v240, a104
 v_accvgpr_read_b32 v241, a105
 v_accvgpr_read_b32 v242, a106
 v_mfma_f32_16x16x32_bf16 a[148:151], v[100:103], v[40:43], a[148:151]
 v_accvgpr_read_b32 v243, a107
 v_accvgpr_read_b32 v244, a108
 v_accvgpr_read_b32 v245, a109
 v_accvgpr_read_b32 v246, a110
 v_mfma_f32_16x16x32_bf16 a[152:155], v[104:107], v[40:43], a[152:155]
 buffer_load_dwordx4 v6, s[20:23], s69 offen offset:1024 lds
 v_mfma_f32_16x16x32_bf16 a[156:159], v[108:111], v[40:43], a[156:159]
 s_waitcnt lgkmcnt(1)
 v_accvgpr_read_b32 v247, a111
 v_cvt_pk_bf16_f32 v164, v240, v241
 v_cvt_pk_bf16_f32 v165, v242, v243
 v_cvt_pk_bf16_f32 v166, v244, v245
 v_mfma_f32_16x16x32_bf16 a[188:191], v[108:111], v[44:47], a[188:191]
 v_cvt_pk_bf16_f32 v167, v246, v247
 v_accvgpr_read_b32 v224, a112
 v_accvgpr_read_b32 v225, a113
 v_mfma_f32_16x16x32_bf16 a[184:187], v[104:107], v[44:47], a[184:187]
 ds_read_b128 v[36:39], v17 offset:14336
 v_accvgpr_read_b32 v226, a114
 v_accvgpr_read_b32 v227, a115
 v_accvgpr_read_b32 v228, a116
 v_accvgpr_read_b32 v229, a117
 v_mfma_f32_16x16x32_bf16 a[180:183], v[100:103], v[44:47], a[180:183]
 v_accvgpr_read_b32 v230, a118
 v_accvgpr_read_b32 v231, a119
 v_cvt_pk_bf16_f32 v168, v224, v225
 v_cvt_pk_bf16_f32 v169, v226, v227
 v_mfma_f32_16x16x32_bf16 a[176:179], v[96:99], v[44:47], a[176:179]
 v_cvt_pk_bf16_f32 v170, v228, v229
 v_cvt_pk_bf16_f32 v171, v230, v231
 v_accvgpr_read_b32 v240, a120
 v_mfma_f32_16x16x32_bf16 a[172:175], v[92:95], v[44:47], a[172:175]
 buffer_load_dwordx4 v7, s[20:23], s69 offen offset:2048 lds
 v_mfma_f32_16x16x32_bf16 a[168:171], v[88:91], v[44:47], a[168:171]
 v_accvgpr_read_b32 v241, a121
 v_accvgpr_read_b32 v242, a122
 v_accvgpr_read_b32 v243, a123
 v_accvgpr_read_b32 v244, a124
 v_mfma_f32_16x16x32_bf16 a[164:167], v[84:87], v[44:47], a[164:167]
 v_accvgpr_read_b32 v245, a125
 v_accvgpr_read_b32 v246, a126
 v_accvgpr_read_b32 v247, a127
 v_cvt_pk_bf16_f32 v172, v240, v241
 v_mfma_f32_16x16x32_bf16 a[160:163], v[80:83], v[44:47], a[160:163]
 s_waitcnt lgkmcnt(1)
 v_cvt_pk_bf16_f32 v173, v242, v243
 v_cvt_pk_bf16_f32 v174, v244, v245
 v_cvt_pk_bf16_f32 v175, v246, v247
 v_mfma_f32_16x16x32_bf16 a[192:195], v[48:51], v[32:35], a[192:195]
 v_mfma_f32_16x16x32_bf16 a[196:199], v[52:55], v[32:35], a[196:199]
 ds_read_b128 v[40:43], v18 offset:12288
 v_mfma_f32_16x16x32_bf16 a[200:203], v[56:59], v[32:35], a[200:203]
 buffer_load_dwordx4 v8, s[20:23], s69 offen offset:3072 lds
 v_mfma_f32_16x16x32_bf16 a[204:207], v[60:63], v[32:35], a[204:207]
 v_accvgpr_read_b32 v224, a128
 v_accvgpr_read_b32 v225, a129
 v_accvgpr_read_b32 v226, a130
 v_accvgpr_read_b32 v227, a131
 v_mfma_f32_16x16x32_bf16 a[208:211], v[64:67], v[32:35], a[208:211]
 v_accvgpr_read_b32 v228, a132
 v_accvgpr_read_b32 v229, a133
 v_accvgpr_read_b32 v230, a134
 v_accvgpr_read_b32 v231, a135
 v_mfma_f32_16x16x32_bf16 a[212:215], v[68:71], v[32:35], a[212:215]
 v_cvt_pk_bf16_f32 v176, v224, v225
 v_cvt_pk_bf16_f32 v177, v226, v227
 v_cvt_pk_bf16_f32 v178, v228, v229
 v_cvt_pk_bf16_f32 v179, v230, v231
 v_mfma_f32_16x16x32_bf16 a[216:219], v[72:75], v[32:35], a[216:219]
 s_add_u32 m0, s78, 49152
 v_accvgpr_read_b32 v240, a136
 v_accvgpr_read_b32 v241, a137
 v_accvgpr_read_b32 v242, a138
 v_accvgpr_read_b32 v243, a139
 v_mfma_f32_16x16x32_bf16 a[220:223], v[76:79], v[32:35], a[220:223]
 s_waitcnt lgkmcnt(1)
 v_accvgpr_read_b32 v244, a140
 v_accvgpr_read_b32 v245, a141
 v_accvgpr_read_b32 v246, a142
 v_accvgpr_read_b32 v247, a143
 v_mfma_f32_16x16x32_bf16 a[252:255], v[76:79], v[36:39], a[252:255]
 buffer_load_dwordx4 v9, s[24:27], s70 offen offset:0 lds
 v_mfma_f32_16x16x32_bf16 a[248:251], v[72:75], v[36:39], a[248:251]
 ds_read_b128 v[44:47], v18 offset:14336
 v_cvt_pk_bf16_f32 v180, v240, v241
 v_cvt_pk_bf16_f32 v181, v242, v243
 v_cvt_pk_bf16_f32 v182, v244, v245
 v_cvt_pk_bf16_f32 v183, v246, v247
 v_mfma_f32_16x16x32_bf16 a[244:247], v[68:71], v[36:39], a[244:247]
 v_accvgpr_read_b32 v224, a144
 v_accvgpr_read_b32 v225, a145
 v_accvgpr_read_b32 v226, a146
 v_mfma_f32_16x16x32_bf16 a[240:243], v[64:67], v[36:39], a[240:243]
 v_accvgpr_read_b32 v227, a147
 v_accvgpr_read_b32 v228, a148
 v_accvgpr_read_b32 v229, a149
 v_accvgpr_read_b32 v230, a150
 v_mfma_f32_16x16x32_bf16 a[236:239], v[60:63], v[36:39], a[236:239]
 v_accvgpr_read_b32 v231, a151
 v_cvt_pk_bf16_f32 v184, v224, v225
 v_cvt_pk_bf16_f32 v185, v226, v227
 v_cvt_pk_bf16_f32 v186, v228, v229
 v_mfma_f32_16x16x32_bf16 a[232:235], v[56:59], v[36:39], a[232:235]
 v_cvt_pk_bf16_f32 v187, v230, v231
 v_accvgpr_read_b32 v240, a152
 v_accvgpr_read_b32 v241, a153
 v_accvgpr_read_b32 v242, a154
 v_mfma_f32_16x16x32_bf16 a[228:231], v[52:55], v[36:39], a[228:231]
 s_add_u32 s69, s69, 128
 buffer_load_dwordx4 v10, s[24:27], s70 offen offset:1024 lds
 v_mfma_f32_16x16x32_bf16 a[224:227], v[48:51], v[36:39], a[224:227]
 s_waitcnt lgkmcnt(1)
 v_accvgpr_read_b32 v243, a155
 v_accvgpr_read_b32 v244, a156
 v_accvgpr_read_b32 v245, a157
 v_accvgpr_read_b32 v246, a158
 v_mfma_f32_16x16x32_bf16 a[192:195], v[80:83], v[40:43], a[192:195]
 v_accvgpr_read_b32 v247, a159
 v_cvt_pk_bf16_f32 v188, v240, v241
 v_cvt_pk_bf16_f32 v189, v242, v243
 v_cvt_pk_bf16_f32 v190, v244, v245
 v_mfma_f32_16x16x32_bf16 a[196:199], v[84:87], v[40:43], a[196:199]
 v_cvt_pk_bf16_f32 v191, v246, v247
 v_accvgpr_read_b32 v224, a160
 v_accvgpr_read_b32 v225, a161
 v_mfma_f32_16x16x32_bf16 a[200:203], v[88:91], v[40:43], a[200:203]
 v_accvgpr_read_b32 v226, a162
 v_accvgpr_read_b32 v227, a163
 v_accvgpr_read_b32 v228, a164
 v_accvgpr_read_b32 v229, a165
 v_mfma_f32_16x16x32_bf16 a[204:207], v[92:95], v[40:43], a[204:207]
 v_accvgpr_read_b32 v230, a166
 v_accvgpr_read_b32 v231, a167
 v_cvt_pk_bf16_f32 v192, v224, v225
 v_cvt_pk_bf16_f32 v193, v226, v227
 v_mfma_f32_16x16x32_bf16 a[208:211], v[96:99], v[40:43], a[208:211]
 s_mov_b32 s75, s72
 buffer_load_dwordx4 v11, s[24:27], s70 offen offset:2048 lds
 v_mfma_f32_16x16x32_bf16 a[212:215], v[100:103], v[40:43], a[212:215]
 v_cvt_pk_bf16_f32 v194, v228, v229
 v_cvt_pk_bf16_f32 v195, v230, v231
 v_accvgpr_read_b32 v240, a168
 v_accvgpr_read_b32 v241, a169
 v_mfma_f32_16x16x32_bf16 a[216:219], v[104:107], v[40:43], a[216:219]
 s_mov_b32 s72, s73
 v_accvgpr_read_b32 v242, a170
 v_accvgpr_read_b32 v243, a171
 v_accvgpr_read_b32 v244, a172
 v_accvgpr_read_b32 v245, a173
 v_mfma_f32_16x16x32_bf16 a[220:223], v[108:111], v[40:43], a[220:223]
 s_waitcnt lgkmcnt(0)
 v_accvgpr_read_b32 v246, a174
 v_accvgpr_read_b32 v247, a175
 v_cvt_pk_bf16_f32 v196, v240, v241
 v_cvt_pk_bf16_f32 v197, v242, v243
 v_mfma_f32_16x16x32_bf16 a[252:255], v[108:111], v[44:47], a[252:255]
 s_mov_b32 s73, s74
 v_cvt_pk_bf16_f32 v198, v244, v245
 v_cvt_pk_bf16_f32 v199, v246, v247
 v_accvgpr_read_b32 v224, a176
 v_mfma_f32_16x16x32_bf16 a[248:251], v[104:107], v[44:47], a[248:251]
 v_accvgpr_read_b32 v225, a177
 v_accvgpr_read_b32 v226, a178
 v_accvgpr_read_b32 v227, a179
 v_accvgpr_read_b32 v228, a180
 v_mfma_f32_16x16x32_bf16 a[244:247], v[100:103], v[44:47], a[244:247]
 s_mov_b32 s74, s75
 buffer_load_dwordx4 v12, s[24:27], s70 offen offset:3072 lds
 v_mfma_f32_16x16x32_bf16 a[240:243], v[96:99], v[44:47], a[240:243]
 v_accvgpr_read_b32 v229, a181
 v_accvgpr_read_b32 v230, a182
 v_accvgpr_read_b32 v231, a183
 v_cvt_pk_bf16_f32 v200, v224, v225
 v_mfma_f32_16x16x32_bf16 a[236:239], v[92:95], v[44:47], a[236:239]
 s_add_u32 s70, s70, s71
 v_cvt_pk_bf16_f32 v201, v226, v227
 v_cvt_pk_bf16_f32 v202, v228, v229
 v_cvt_pk_bf16_f32 v203, v230, v231
 v_accvgpr_read_b32 v240, a184
 v_mfma_f32_16x16x32_bf16 a[232:235], v[88:91], v[44:47], a[232:235]
 v_accvgpr_read_b32 v241, a185
 v_accvgpr_read_b32 v242, a186
 v_accvgpr_read_b32 v243, a187
 v_accvgpr_read_b32 v244, a188
 v_mfma_f32_16x16x32_bf16 a[228:231], v[84:87], v[44:47], a[228:231]
 v_accvgpr_read_b32 v245, a189
 v_accvgpr_read_b32 v246, a190
 v_accvgpr_read_b32 v247, a191
 v_cvt_pk_bf16_f32 v204, v240, v241
 v_mfma_f32_16x16x32_bf16 a[224:227], v[80:83], v[44:47], a[224:227]
 v_cvt_pk_bf16_f32 v205, v242, v243
 v_cvt_pk_bf16_f32 v206, v244, v245
 v_cvt_pk_bf16_f32 v207, v246, v247
 v_add_u32 v17, s73, v19
 ds_read_b64_tr_b16 v[48:49], v13 offset:0
 ds_read_b64_tr_b16 v[50:51], v13 offset:512
 ds_read_b64_tr_b16 v[52:53], v14 offset:0
 ds_read_b64_tr_b16 v[54:55], v14 offset:512
 ds_read_b64_tr_b16 v[56:57], v15 offset:0
 ds_read_b64_tr_b16 v[58:59], v15 offset:512
 ds_read_b64_tr_b16 v[60:61], v16 offset:0
 ds_read_b64_tr_b16 v[62:63], v16 offset:512
 v_accvgpr_read_b32 v80, a192
 v_accvgpr_read_b32 v81, a193
 v_accvgpr_read_b32 v82, a194
 v_accvgpr_read_b32 v83, a195
 v_accvgpr_read_b32 v84, a196
 v_accvgpr_read_b32 v85, a197
 v_accvgpr_read_b32 v86, a198
 v_accvgpr_read_b32 v87, a199
 v_cvt_pk_bf16_f32 v208, v80, v81
 v_cvt_pk_bf16_f32 v209, v82, v83
 v_cvt_pk_bf16_f32 v210, v84, v85
 v_cvt_pk_bf16_f32 v211, v86, v87
 ds_read_b64_tr_b16 v[64:65], v13 offset:4096
 ds_read_b64_tr_b16 v[66:67], v13 offset:4608
 v_accvgpr_read_b32 v88, a200
 v_accvgpr_read_b32 v89, a201
 v_accvgpr_read_b32 v90, a202
 v_accvgpr_read_b32 v91, a203
 v_accvgpr_read_b32 v92, a204
 v_accvgpr_read_b32 v93, a205
 v_accvgpr_read_b32 v94, a206
 v_accvgpr_read_b32 v95, a207
 v_cvt_pk_bf16_f32 v212, v88, v89
 v_cvt_pk_bf16_f32 v213, v90, v91
 v_cvt_pk_bf16_f32 v214, v92, v93
 v_cvt_pk_bf16_f32 v215, v94, v95
 ds_read_b64_tr_b16 v[68:69], v14 offset:4096
 ds_read_b64_tr_b16 v[70:71], v14 offset:4608
 v_accvgpr_read_b32 v96, a208
 v_accvgpr_read_b32 v97, a209
 v_accvgpr_read_b32 v98, a210
 v_accvgpr_read_b32 v99, a211
 v_accvgpr_read_b32 v100, a212
 v_accvgpr_read_b32 v101, a213
 v_accvgpr_read_b32 v102, a214
 v_accvgpr_read_b32 v103, a215
 v_cvt_pk_bf16_f32 v216, v96, v97
 v_cvt_pk_bf16_f32 v217, v98, v99
 v_cvt_pk_bf16_f32 v218, v100, v101
 v_cvt_pk_bf16_f32 v219, v102, v103
 ds_read_b64_tr_b16 v[72:73], v15 offset:4096
 ds_read_b64_tr_b16 v[74:75], v15 offset:4608
 v_accvgpr_read_b32 v104, a216
 v_accvgpr_read_b32 v105, a217
 v_accvgpr_read_b32 v106, a218
 v_accvgpr_read_b32 v107, a219
 v_accvgpr_read_b32 v108, a220
 v_accvgpr_read_b32 v109, a221
 v_accvgpr_read_b32 v110, a222
 v_accvgpr_read_b32 v111, a223
 v_cvt_pk_bf16_f32 v220, v104, v105
 v_cvt_pk_bf16_f32 v221, v106, v107
 v_cvt_pk_bf16_f32 v222, v108, v109
 v_cvt_pk_bf16_f32 v223, v110, v111
 ds_read_b64_tr_b16 v[76:77], v16 offset:4096
 ds_read_b64_tr_b16 v[78:79], v16 offset:4608
 v_accvgpr_read_b32 v80, a224
 v_accvgpr_read_b32 v81, a225
 v_accvgpr_read_b32 v82, a226
 v_accvgpr_read_b32 v83, a227
 v_accvgpr_read_b32 v84, a228
 v_accvgpr_read_b32 v85, a229
 v_accvgpr_read_b32 v86, a230
 v_accvgpr_read_b32 v87, a231
 v_cvt_pk_bf16_f32 v224, v80, v81
 v_cvt_pk_bf16_f32 v225, v82, v83
 v_cvt_pk_bf16_f32 v226, v84, v85
 v_cvt_pk_bf16_f32 v227, v86, v87
 ds_read_b128 v[32:35], v17 offset:0
 ds_read_b128 v[36:39], v17 offset:2048
 v_accvgpr_read_b32 v88, a232
 v_accvgpr_read_b32 v89, a233
 v_accvgpr_read_b32 v90, a234
 v_accvgpr_read_b32 v91, a235
 v_accvgpr_read_b32 v92, a236
 v_accvgpr_read_b32 v93, a237
 v_accvgpr_read_b32 v94, a238
 v_accvgpr_read_b32 v95, a239
 v_cvt_pk_bf16_f32 v228, v88, v89
 v_cvt_pk_bf16_f32 v229, v90, v91
 v_cvt_pk_bf16_f32 v230, v92, v93
 v_cvt_pk_bf16_f32 v231, v94, v95
 v_accvgpr_read_b32 v96, a240
 v_accvgpr_read_b32 v97, a241
 v_accvgpr_read_b32 v98, a242
 v_accvgpr_read_b32 v99, a243
 v_accvgpr_read_b32 v100, a244
 v_accvgpr_read_b32 v101, a245
 v_accvgpr_read_b32 v102, a246
 v_accvgpr_read_b32 v103, a247
 v_cvt_pk_bf16_f32 v232, v96, v97
 v_cvt_pk_bf16_f32 v233, v98, v99
 v_cvt_pk_bf16_f32 v234, v100, v101
 v_cvt_pk_bf16_f32 v235, v102, v103
 v_accvgpr_read_b32 v104, a248
 v_accvgpr_read_b32 v105, a249
 v_accvgpr_read_b32 v106, a250
 v_accvgpr_read_b32 v107, a251
 v_accvgpr_read_b32 v108, a252
 v_accvgpr_read_b32 v109, a253
 v_accvgpr_read_b32 v110, a254
 v_accvgpr_read_b32 v111, a255
 v_cvt_pk_bf16_f32 v236, v104, v105
 v_cvt_pk_bf16_f32 v237, v106, v107
 v_cvt_pk_bf16_f32 v238, v108, v109
 v_cvt_pk_bf16_f32 v239, v110, v111
 s_waitcnt vmcnt(17) lgkmcnt(1)
 s_branch gated_mix__compressed_kv_cla__glu_gated_swiglu__prompt_kernel_p2
.p2align 3
gated_mix__compressed_kv_cla__glu_gated_swiglu__prompt_kernel_loopV:
 v_mfma_f32_16x16x32_bf16 a[0:3], v[32:35], v[48:51], a[0:3]
 s_barrier
 ds_read_b128 v[40:43], v17 offset:4096
 v_mfma_f32_16x16x32_bf16 a[4:7], v[32:35], v[52:55], a[4:7]
 ds_read_b64_tr_b16 v[80:81], v13 offset:16384
 v_mfma_f32_16x16x32_bf16 a[8:11], v[32:35], v[56:59], a[8:11]
 s_add_u32 m0, s72, s76
 v_mfma_f32_16x16x32_bf16 a[12:15], v[32:35], v[60:63], a[12:15]
 ds_read_b64_tr_b16 v[82:83], v13 offset:16896
 v_mfma_f32_16x16x32_bf16 a[16:19], v[32:35], v[64:67], a[16:19]
 buffer_load_dwordx4 v1, s[20:23], s69 offen offset:0 lds
 v_mfma_f32_16x16x32_bf16 a[20:23], v[32:35], v[68:71], a[20:23]
 ds_read_b64_tr_b16 v[84:85], v14 offset:16384
 v_mfma_f32_16x16x32_bf16 a[24:27], v[32:35], v[72:75], a[24:27]
 v_mfma_f32_16x16x32_bf16 a[28:31], v[32:35], v[76:79], a[28:31]
 s_waitcnt lgkmcnt(4)
 v_mfma_f32_16x16x32_bf16 a[60:63], v[36:39], v[76:79], a[60:63]
 ds_read_b128 v[44:47], v17 offset:6144
 v_mfma_f32_16x16x32_bf16 a[56:59], v[36:39], v[72:75], a[56:59]
 ds_read_b64_tr_b16 v[86:87], v14 offset:16896
 v_mfma_f32_16x16x32_bf16 a[52:55], v[36:39], v[68:71], a[52:55]
 v_add_u32 v18, s73, v20
 v_mfma_f32_16x16x32_bf16 a[48:51], v[36:39], v[64:67], a[48:51]
 ds_read_b64_tr_b16 v[88:89], v15 offset:16384
 v_mfma_f32_16x16x32_bf16 a[44:47], v[36:39], v[60:63], a[44:47]
 buffer_load_dwordx4 v2, s[20:23], s69 offen offset:1024 lds
 v_mfma_f32_16x16x32_bf16 a[40:43], v[36:39], v[56:59], a[40:43]
 ds_read_b64_tr_b16 v[90:91], v15 offset:16896
 v_mfma_f32_16x16x32_bf16 a[36:39], v[36:39], v[52:55], a[36:39]
 v_mfma_f32_16x16x32_bf16 a[32:35], v[36:39], v[48:51], a[32:35]
 s_waitcnt lgkmcnt(7)
 v_mfma_f32_16x16x32_bf16 a[64:67], v[40:43], v[48:51], a[64:67]
 ds_read_b128 v[32:35], v17 offset:8192
 v_mfma_f32_16x16x32_bf16 a[68:71], v[40:43], v[52:55], a[68:71]
 ds_read_b64_tr_b16 v[92:93], v16 offset:16384
 v_mfma_f32_16x16x32_bf16 a[72:75], v[40:43], v[56:59], a[72:75]
 v_mfma_f32_16x16x32_bf16 a[76:79], v[40:43], v[60:63], a[76:79]
 ds_read_b64_tr_b16 v[94:95], v16 offset:16896
 v_mfma_f32_16x16x32_bf16 a[80:83], v[40:43], v[64:67], a[80:83]
 buffer_load_dwordx4 v3, s[20:23], s69 offen offset:2048 lds
 v_mfma_f32_16x16x32_bf16 a[84:87], v[40:43], v[68:71], a[84:87]
 ds_read_b64_tr_b16 v[96:97], v13 offset:20480
 v_mfma_f32_16x16x32_bf16 a[88:91], v[40:43], v[72:75], a[88:91]
 v_mfma_f32_16x16x32_bf16 a[92:95], v[40:43], v[76:79], a[92:95]
 s_waitcnt lgkmcnt(7)
 v_mfma_f32_16x16x32_bf16 a[124:127], v[44:47], v[76:79], a[124:127]
 ds_read_b128 v[36:39], v17 offset:10240
 v_mfma_f32_16x16x32_bf16 a[120:123], v[44:47], v[72:75], a[120:123]
 ds_read_b64_tr_b16 v[98:99], v13 offset:20992
 v_mfma_f32_16x16x32_bf16 a[116:119], v[44:47], v[68:71], a[116:119]
 v_mfma_f32_16x16x32_bf16 a[112:115], v[44:47], v[64:67], a[112:115]
 ds_read_b64_tr_b16 v[100:101], v14 offset:20480
 v_mfma_f32_16x16x32_bf16 a[108:111], v[44:47], v[60:63], a[108:111]
 buffer_load_dwordx4 v4, s[20:23], s69 offen offset:3072 lds
 v_mfma_f32_16x16x32_bf16 a[104:107], v[44:47], v[56:59], a[104:107]
 ds_read_b64_tr_b16 v[102:103], v14 offset:20992
 v_mfma_f32_16x16x32_bf16 a[100:103], v[44:47], v[52:55], a[100:103]
 v_mfma_f32_16x16x32_bf16 a[96:99], v[44:47], v[48:51], a[96:99]
 s_waitcnt lgkmcnt(7)
 v_mfma_f32_16x16x32_bf16 a[128:131], v[32:35], v[48:51], a[128:131]
 ds_read_b128 v[40:43], v17 offset:12288
 v_mfma_f32_16x16x32_bf16 a[132:135], v[32:35], v[52:55], a[132:135]
 ds_read_b64_tr_b16 v[104:105], v15 offset:20480
 v_mfma_f32_16x16x32_bf16 a[136:139], v[32:35], v[56:59], a[136:139]
 s_add_u32 m0, s78, 0
 v_mfma_f32_16x16x32_bf16 a[140:143], v[32:35], v[60:63], a[140:143]
 ds_read_b64_tr_b16 v[106:107], v15 offset:20992
 v_mfma_f32_16x16x32_bf16 a[144:147], v[32:35], v[64:67], a[144:147]
 buffer_load_dwordx4 v9, s[24:27], s70 offen offset:0 nt lds
 v_mfma_f32_16x16x32_bf16 a[148:151], v[32:35], v[68:71], a[148:151]
 ds_read_b64_tr_b16 v[108:109], v16 offset:20480
 v_mfma_f32_16x16x32_bf16 a[152:155], v[32:35], v[72:75], a[152:155]
 v_mfma_f32_16x16x32_bf16 a[156:159], v[32:35], v[76:79], a[156:159]
 s_waitcnt lgkmcnt(7)
 v_mfma_f32_16x16x32_bf16 a[188:191], v[36:39], v[76:79], a[188:191]
 ds_read_b128 v[44:47], v17 offset:14336
 v_mfma_f32_16x16x32_bf16 a[184:187], v[36:39], v[72:75], a[184:187]
 ds_read_b64_tr_b16 v[110:111], v16 offset:20992
 v_mfma_f32_16x16x32_bf16 a[180:183], v[36:39], v[68:71], a[180:183]
 v_mfma_f32_16x16x32_bf16 a[176:179], v[36:39], v[64:67], a[176:179]
 v_mfma_f32_16x16x32_bf16 a[172:175], v[36:39], v[60:63], a[172:175]
 buffer_load_dwordx4 v10, s[24:27], s70 offen offset:1024 nt lds
 v_mfma_f32_16x16x32_bf16 a[168:171], v[36:39], v[56:59], a[168:171]
 v_mfma_f32_16x16x32_bf16 a[164:167], v[36:39], v[52:55], a[164:167]
 v_mfma_f32_16x16x32_bf16 a[160:163], v[36:39], v[48:51], a[160:163]
 s_waitcnt lgkmcnt(5)
 v_mfma_f32_16x16x32_bf16 a[192:195], v[40:43], v[48:51], a[192:195]
 ds_read_b128 v[32:35], v18 offset:0
 v_mfma_f32_16x16x32_bf16 a[196:199], v[40:43], v[52:55], a[196:199]
 v_mfma_f32_16x16x32_bf16 a[200:203], v[40:43], v[56:59], a[200:203]
 v_mfma_f32_16x16x32_bf16 a[204:207], v[40:43], v[60:63], a[204:207]
 v_mfma_f32_16x16x32_bf16 a[208:211], v[40:43], v[64:67], a[208:211]
 buffer_load_dwordx4 v11, s[24:27], s70 offen offset:2048 nt lds
 v_mfma_f32_16x16x32_bf16 a[212:215], v[40:43], v[68:71], a[212:215]
 v_mfma_f32_16x16x32_bf16 a[216:219], v[40:43], v[72:75], a[216:219]
 v_mfma_f32_16x16x32_bf16 a[220:223], v[40:43], v[76:79], a[220:223]
 s_waitcnt lgkmcnt(2)
 v_mfma_f32_16x16x32_bf16 a[252:255], v[44:47], v[76:79], a[252:255]
 ds_read_b128 v[36:39], v18 offset:2048
 v_mfma_f32_16x16x32_bf16 a[248:251], v[44:47], v[72:75], a[248:251]
 v_mfma_f32_16x16x32_bf16 a[244:247], v[44:47], v[68:71], a[244:247]
 v_mfma_f32_16x16x32_bf16 a[240:243], v[44:47], v[64:67], a[240:243]
 v_mfma_f32_16x16x32_bf16 a[236:239], v[44:47], v[60:63], a[236:239]
 buffer_load_dwordx4 v12, s[24:27], s70 offen offset:3072 nt lds
 v_mfma_f32_16x16x32_bf16 a[232:235], v[44:47], v[56:59], a[232:235]
 v_mfma_f32_16x16x32_bf16 a[228:231], v[44:47], v[52:55], a[228:231]
 s_add_u32 s70, s70, s71
 v_mfma_f32_16x16x32_bf16 a[224:227], v[44:47], v[48:51], a[224:227]
 s_waitcnt vmcnt(13) lgkmcnt(1)
 v_mfma_f32_16x16x32_bf16 a[0:3], v[32:35], v[80:83], a[0:3]
 s_barrier
 ds_read_b128 v[40:43], v18 offset:4096
 v_mfma_f32_16x16x32_bf16 a[4:7], v[32:35], v[84:87], a[4:7]
 ds_read_b64_tr_b16 v[48:49], v13 offset:32768
 v_mfma_f32_16x16x32_bf16 a[8:11], v[32:35], v[88:91], a[8:11]
 s_add_u32 m0, s72, s77
 v_mfma_f32_16x16x32_bf16 a[12:15], v[32:35], v[92:95], a[12:15]
 ds_read_b64_tr_b16 v[50:51], v13 offset:33280
 v_mfma_f32_16x16x32_bf16 a[16:19], v[32:35], v[96:99], a[16:19]
 buffer_load_dwordx4 v5, s[20:23], s69 offen offset:0 lds
 v_mfma_f32_16x16x32_bf16 a[20:23], v[32:35], v[100:103], a[20:23]
 ds_read_b64_tr_b16 v[52:53], v14 offset:32768
 v_mfma_f32_16x16x32_bf16 a[24:27], v[32:35], v[104:107], a[24:27]
 v_mfma_f32_16x16x32_bf16 a[28:31], v[32:35], v[108:111], a[28:31]
 s_waitcnt lgkmcnt(4)
 v_mfma_f32_16x16x32_bf16 a[60:63], v[36:39], v[108:111], a[60:63]
 ds_read_b128 v[44:47], v18 offset:6144
 v_mfma_f32_16x16x32_bf16 a[56:59], v[36:39], v[104:107], a[56:59]
 ds_read_b64_tr_b16 v[54:55], v14 offset:33280
 v_mfma_f32_16x16x32_bf16 a[52:55], v[36:39], v[100:103], a[52:55]
 v_add_u32 v17, s74, v19
 v_mfma_f32_16x16x32_bf16 a[48:51], v[36:39], v[96:99], a[48:51]
 ds_read_b64_tr_b16 v[56:57], v15 offset:32768
 v_mfma_f32_16x16x32_bf16 a[44:47], v[36:39], v[92:95], a[44:47]
 buffer_load_dwordx4 v6, s[20:23], s69 offen offset:1024 lds
 v_mfma_f32_16x16x32_bf16 a[40:43], v[36:39], v[88:91], a[40:43]
 ds_read_b64_tr_b16 v[58:59], v15 offset:33280
 v_mfma_f32_16x16x32_bf16 a[36:39], v[36:39], v[84:87], a[36:39]
 v_mfma_f32_16x16x32_bf16 a[32:35], v[36:39], v[80:83], a[32:35]
 s_waitcnt lgkmcnt(7)
 v_mfma_f32_16x16x32_bf16 a[64:67], v[40:43], v[80:83], a[64:67]
 ds_read_b128 v[32:35], v18 offset:8192
 v_mfma_f32_16x16x32_bf16 a[68:71], v[40:43], v[84:87], a[68:71]
 ds_read_b64_tr_b16 v[60:61], v16 offset:32768
 v_mfma_f32_16x16x32_bf16 a[72:75], v[40:43], v[88:91], a[72:75]
 v_mfma_f32_16x16x32_bf16 a[76:79], v[40:43], v[92:95], a[76:79]
 ds_read_b64_tr_b16 v[62:63], v16 offset:33280
 v_mfma_f32_16x16x32_bf16 a[80:83], v[40:43], v[96:99], a[80:83]
 buffer_load_dwordx4 v7, s[20:23], s69 offen offset:2048 lds
 v_mfma_f32_16x16x32_bf16 a[84:87], v[40:43], v[100:103], a[84:87]
 ds_read_b64_tr_b16 v[64:65], v13 offset:36864
 v_mfma_f32_16x16x32_bf16 a[88:91], v[40:43], v[104:107], a[88:91]
 v_mfma_f32_16x16x32_bf16 a[92:95], v[40:43], v[108:111], a[92:95]
 s_waitcnt lgkmcnt(7)
 v_mfma_f32_16x16x32_bf16 a[124:127], v[44:47], v[108:111], a[124:127]
 ds_read_b128 v[36:39], v18 offset:10240
 v_mfma_f32_16x16x32_bf16 a[120:123], v[44:47], v[104:107], a[120:123]
 ds_read_b64_tr_b16 v[66:67], v13 offset:37376
 v_mfma_f32_16x16x32_bf16 a[116:119], v[44:47], v[100:103], a[116:119]
 v_mfma_f32_16x16x32_bf16 a[112:115], v[44:47], v[96:99], a[112:115]
 ds_read_b64_tr_b16 v[68:69], v14 offset:36864
 v_mfma_f32_16x16x32_bf16 a[108:111], v[44:47], v[92:95], a[108:111]
 buffer_load_dwordx4 v8, s[20:23], s69 offen offset:3072 lds
 v_mfma_f32_16x16x32_bf16 a[104:107], v[44:47], v[88:91], a[104:107]
 ds_read_b64_tr_b16 v[70:71], v14 offset:37376
 v_mfma_f32_16x16x32_bf16 a[100:103], v[44:47], v[84:87], a[100:103]
 s_add_u32 s69, s69, 128
 v_mfma_f32_16x16x32_bf16 a[96:99], v[44:47], v[80:83], a[96:99]
 s_waitcnt lgkmcnt(7)
 v_mfma_f32_16x16x32_bf16 a[128:131], v[32:35], v[80:83], a[128:131]
 ds_read_b128 v[40:43], v18 offset:12288
 v_mfma_f32_16x16x32_bf16 a[132:135], v[32:35], v[84:87], a[132:135]
 ds_read_b64_tr_b16 v[72:73], v15 offset:36864
 v_mfma_f32_16x16x32_bf16 a[136:139], v[32:35], v[88:91], a[136:139]
 s_add_u32 m0, s78, 16384
 v_mfma_f32_16x16x32_bf16 a[140:143], v[32:35], v[92:95], a[140:143]
 ds_read_b64_tr_b16 v[74:75], v15 offset:37376
 v_mfma_f32_16x16x32_bf16 a[144:147], v[32:35], v[96:99], a[144:147]
 buffer_load_dwordx4 v9, s[24:27], s70 offen offset:0 nt lds
 v_mfma_f32_16x16x32_bf16 a[148:151], v[32:35], v[100:103], a[148:151]
 ds_read_b64_tr_b16 v[76:77], v16 offset:36864
 v_mfma_f32_16x16x32_bf16 a[152:155], v[32:35], v[104:107], a[152:155]
 v_mfma_f32_16x16x32_bf16 a[156:159], v[32:35], v[108:111], a[156:159]
 s_waitcnt lgkmcnt(7)
 v_mfma_f32_16x16x32_bf16 a[188:191], v[36:39], v[108:111], a[188:191]
 ds_read_b128 v[44:47], v18 offset:14336
 v_mfma_f32_16x16x32_bf16 a[184:187], v[36:39], v[104:107], a[184:187]
 ds_read_b64_tr_b16 v[78:79], v16 offset:37376
 v_mfma_f32_16x16x32_bf16 a[180:183], v[36:39], v[100:103], a[180:183]
 v_mfma_f32_16x16x32_bf16 a[176:179], v[36:39], v[96:99], a[176:179]
 v_mfma_f32_16x16x32_bf16 a[172:175], v[36:39], v[92:95], a[172:175]
 buffer_load_dwordx4 v10, s[24:27], s70 offen offset:1024 nt lds
 v_mfma_f32_16x16x32_bf16 a[168:171], v[36:39], v[88:91], a[168:171]
 v_mfma_f32_16x16x32_bf16 a[164:167], v[36:39], v[84:87], a[164:167]
 v_mfma_f32_16x16x32_bf16 a[160:163], v[36:39], v[80:83], a[160:163]
 s_waitcnt lgkmcnt(5)
 v_mfma_f32_16x16x32_bf16 a[192:195], v[40:43], v[80:83], a[192:195]
 ds_read_b128 v[32:35], v17 offset:0
 v_mfma_f32_16x16x32_bf16 a[196:199], v[40:43], v[84:87], a[196:199]
 v_mfma_f32_16x16x32_bf16 a[200:203], v[40:43], v[88:91], a[200:203]
 s_mov_b32 s75, s72
 s_mov_b32 s72, s73
 v_mfma_f32_16x16x32_bf16 a[204:207], v[40:43], v[92:95], a[204:207]
 v_mfma_f32_16x16x32_bf16 a[208:211], v[40:43], v[96:99], a[208:211]
 buffer_load_dwordx4 v11, s[24:27], s70 offen offset:2048 nt lds
 v_mfma_f32_16x16x32_bf16 a[212:215], v[40:43], v[100:103], a[212:215]
 v_mfma_f32_16x16x32_bf16 a[216:219], v[40:43], v[104:107], a[216:219]
 v_add_u32 v124, s19, v124
 v_mfma_f32_16x16x32_bf16 a[220:223], v[40:43], v[108:111], a[220:223]
 s_waitcnt lgkmcnt(2)
 v_mfma_f32_16x16x32_bf16 a[252:255], v[44:47], v[108:111], a[252:255]
 ds_read_b128 v[36:39], v17 offset:2048
 v_mfma_f32_16x16x32_bf16 a[248:251], v[44:47], v[104:107], a[248:251]
 v_mfma_f32_16x16x32_bf16 a[244:247], v[44:47], v[100:103], a[244:247]
 s_mov_b32 s73, s74
 s_mov_b32 s74, s75
 v_mfma_f32_16x16x32_bf16 a[240:243], v[44:47], v[96:99], a[240:243]
 v_mfma_f32_16x16x32_bf16 a[236:239], v[44:47], v[92:95], a[236:239]
 buffer_load_dwordx4 v12, s[24:27], s70 offen offset:3072 nt lds
 v_mfma_f32_16x16x32_bf16 a[232:235], v[44:47], v[88:91], a[232:235]
 v_mfma_f32_16x16x32_bf16 a[228:231], v[44:47], v[84:87], a[228:231]
 s_add_u32 s70, s70, s71
 buffer_load_dword v31, v124, s[40:43], 0 offen
 v_mfma_f32_16x16x32_bf16 a[224:227], v[44:47], v[80:83], a[224:227]
 s_cmp_eq_u32 s79, 7
 s_waitcnt vmcnt(18) lgkmcnt(1)
 s_cbranch_scc1 gated_mix__compressed_kv_cla__glu_gated_swiglu__prompt_kernel_doneV
 v_mfma_f32_16x16x32_bf16 a[0:3], v[32:35], v[48:51], a[0:3]
 s_barrier
 ds_read_b128 v[40:43], v17 offset:4096
 v_mfma_f32_16x16x32_bf16 a[4:7], v[32:35], v[52:55], a[4:7]
 ds_read_b64_tr_b16 v[80:81], v13 offset:49152
 v_mfma_f32_16x16x32_bf16 a[8:11], v[32:35], v[56:59], a[8:11]
 s_add_u32 m0, s72, s76
 v_mfma_f32_16x16x32_bf16 a[12:15], v[32:35], v[60:63], a[12:15]
 ds_read_b64_tr_b16 v[82:83], v13 offset:49664
 v_mfma_f32_16x16x32_bf16 a[16:19], v[32:35], v[64:67], a[16:19]
 buffer_load_dwordx4 v1, s[20:23], s69 offen offset:0 lds
 v_mfma_f32_16x16x32_bf16 a[20:23], v[32:35], v[68:71], a[20:23]
 ds_read_b64_tr_b16 v[84:85], v14 offset:49152
 v_mfma_f32_16x16x32_bf16 a[24:27], v[32:35], v[72:75], a[24:27]
 v_mfma_f32_16x16x32_bf16 a[28:31], v[32:35], v[76:79], a[28:31]
 s_waitcnt lgkmcnt(4)
 v_mfma_f32_16x16x32_bf16 a[60:63], v[36:39], v[76:79], a[60:63]
 ds_read_b128 v[44:47], v17 offset:6144
 v_mfma_f32_16x16x32_bf16 a[56:59], v[36:39], v[72:75], a[56:59]
 ds_read_b64_tr_b16 v[86:87], v14 offset:49664
 v_mfma_f32_16x16x32_bf16 a[52:55], v[36:39], v[68:71], a[52:55]
 v_add_u32 v18, s73, v20
 v_mfma_f32_16x16x32_bf16 a[48:51], v[36:39], v[64:67], a[48:51]
 ds_read_b64_tr_b16 v[88:89], v15 offset:49152
 v_mfma_f32_16x16x32_bf16 a[44:47], v[36:39], v[60:63], a[44:47]
 buffer_load_dwordx4 v2, s[20:23], s69 offen offset:1024 lds
 v_mfma_f32_16x16x32_bf16 a[40:43], v[36:39], v[56:59], a[40:43]
 ds_read_b64_tr_b16 v[90:91], v15 offset:49664
 v_mfma_f32_16x16x32_bf16 a[36:39], v[36:39], v[52:55], a[36:39]
 v_mfma_f32_16x16x32_bf16 a[32:35], v[36:39], v[48:51], a[32:35]
 s_waitcnt lgkmcnt(7)
 v_mfma_f32_16x16x32_bf16 a[64:67], v[40:43], v[48:51], a[64:67]
 ds_read_b128 v[32:35], v17 offset:8192
 v_mfma_f32_16x16x32_bf16 a[68:71], v[40:43], v[52:55], a[68:71]
 ds_read_b64_tr_b16 v[92:93], v16 offset:49152
 v_mfma_f32_16x16x32_bf16 a[72:75], v[40:43], v[56:59], a[72:75]
 v_mfma_f32_16x16x32_bf16 a[76:79], v[40:43], v[60:63], a[76:79]
 ds_read_b64_tr_b16 v[94:95], v16 offset:49664
 v_mfma_f32_16x16x32_bf16 a[80:83], v[40:43], v[64:67], a[80:83]
 buffer_load_dwordx4 v3, s[20:23], s69 offen offset:2048 lds
 v_mfma_f32_16x16x32_bf16 a[84:87], v[40:43], v[68:71], a[84:87]
 ds_read_b64_tr_b16 v[96:97], v13 offset:53248
 v_mfma_f32_16x16x32_bf16 a[88:91], v[40:43], v[72:75], a[88:91]
 v_mfma_f32_16x16x32_bf16 a[92:95], v[40:43], v[76:79], a[92:95]
 s_waitcnt lgkmcnt(7)
 v_mfma_f32_16x16x32_bf16 a[124:127], v[44:47], v[76:79], a[124:127]
 ds_read_b128 v[36:39], v17 offset:10240
 v_mfma_f32_16x16x32_bf16 a[120:123], v[44:47], v[72:75], a[120:123]
 ds_read_b64_tr_b16 v[98:99], v13 offset:53760
 v_mfma_f32_16x16x32_bf16 a[116:119], v[44:47], v[68:71], a[116:119]
 v_mfma_f32_16x16x32_bf16 a[112:115], v[44:47], v[64:67], a[112:115]
 ds_read_b64_tr_b16 v[100:101], v14 offset:53248
 v_mfma_f32_16x16x32_bf16 a[108:111], v[44:47], v[60:63], a[108:111]
 buffer_load_dwordx4 v4, s[20:23], s69 offen offset:3072 lds
 v_mfma_f32_16x16x32_bf16 a[104:107], v[44:47], v[56:59], a[104:107]
 ds_read_b64_tr_b16 v[102:103], v14 offset:53760
 v_mfma_f32_16x16x32_bf16 a[100:103], v[44:47], v[52:55], a[100:103]
 v_mfma_f32_16x16x32_bf16 a[96:99], v[44:47], v[48:51], a[96:99]
 s_waitcnt lgkmcnt(7)
 v_mfma_f32_16x16x32_bf16 a[128:131], v[32:35], v[48:51], a[128:131]
 ds_read_b128 v[40:43], v17 offset:12288
 v_mfma_f32_16x16x32_bf16 a[132:135], v[32:35], v[52:55], a[132:135]
 ds_read_b64_tr_b16 v[104:105], v15 offset:53248
 v_mfma_f32_16x16x32_bf16 a[136:139], v[32:35], v[56:59], a[136:139]
 s_add_u32 m0, s78, 32768
 v_mfma_f32_16x16x32_bf16 a[140:143], v[32:35], v[60:63], a[140:143]
 ds_read_b64_tr_b16 v[106:107], v15 offset:53760
 v_mfma_f32_16x16x32_bf16 a[144:147], v[32:35], v[64:67], a[144:147]
 buffer_load_dwordx4 v9, s[24:27], s70 offen offset:0 nt lds
 v_mfma_f32_16x16x32_bf16 a[148:151], v[32:35], v[68:71], a[148:151]
 ds_read_b64_tr_b16 v[108:109], v16 offset:53248
 v_mfma_f32_16x16x32_bf16 a[152:155], v[32:35], v[72:75], a[152:155]
 v_mfma_f32_16x16x32_bf16 a[156:159], v[32:35], v[76:79], a[156:159]
 s_waitcnt lgkmcnt(7)
 v_mfma_f32_16x16x32_bf16 a[188:191], v[36:39], v[76:79], a[188:191]
 ds_read_b128 v[44:47], v17 offset:14336
 v_mfma_f32_16x16x32_bf16 a[184:187], v[36:39], v[72:75], a[184:187]
 ds_read_b64_tr_b16 v[110:111], v16 offset:53760
 v_mfma_f32_16x16x32_bf16 a[180:183], v[36:39], v[68:71], a[180:183]
 v_mfma_f32_16x16x32_bf16 a[176:179], v[36:39], v[64:67], a[176:179]
 v_mfma_f32_16x16x32_bf16 a[172:175], v[36:39], v[60:63], a[172:175]
 buffer_load_dwordx4 v10, s[24:27], s70 offen offset:1024 nt lds
 v_mfma_f32_16x16x32_bf16 a[168:171], v[36:39], v[56:59], a[168:171]
 v_mfma_f32_16x16x32_bf16 a[164:167], v[36:39], v[52:55], a[164:167]
 v_mfma_f32_16x16x32_bf16 a[160:163], v[36:39], v[48:51], a[160:163]
 s_waitcnt lgkmcnt(5)
 v_mfma_f32_16x16x32_bf16 a[192:195], v[40:43], v[48:51], a[192:195]
 ds_read_b128 v[32:35], v18 offset:0
 v_mfma_f32_16x16x32_bf16 a[196:199], v[40:43], v[52:55], a[196:199]
 v_mfma_f32_16x16x32_bf16 a[200:203], v[40:43], v[56:59], a[200:203]
 v_mfma_f32_16x16x32_bf16 a[204:207], v[40:43], v[60:63], a[204:207]
 v_mfma_f32_16x16x32_bf16 a[208:211], v[40:43], v[64:67], a[208:211]
 buffer_load_dwordx4 v11, s[24:27], s70 offen offset:2048 nt lds
 v_mfma_f32_16x16x32_bf16 a[212:215], v[40:43], v[68:71], a[212:215]
 v_mfma_f32_16x16x32_bf16 a[216:219], v[40:43], v[72:75], a[216:219]
 v_mfma_f32_16x16x32_bf16 a[220:223], v[40:43], v[76:79], a[220:223]
 s_waitcnt lgkmcnt(2)
 v_mfma_f32_16x16x32_bf16 a[252:255], v[44:47], v[76:79], a[252:255]
 ds_read_b128 v[36:39], v18 offset:2048
 v_mfma_f32_16x16x32_bf16 a[248:251], v[44:47], v[72:75], a[248:251]
 v_mfma_f32_16x16x32_bf16 a[244:247], v[44:47], v[68:71], a[244:247]
 v_mfma_f32_16x16x32_bf16 a[240:243], v[44:47], v[64:67], a[240:243]
 v_mfma_f32_16x16x32_bf16 a[236:239], v[44:47], v[60:63], a[236:239]
 buffer_load_dwordx4 v12, s[24:27], s70 offen offset:3072 nt lds
 v_mfma_f32_16x16x32_bf16 a[232:235], v[44:47], v[56:59], a[232:235]
 v_mfma_f32_16x16x32_bf16 a[228:231], v[44:47], v[52:55], a[228:231]
 s_add_u32 s70, s70, s71
 v_mfma_f32_16x16x32_bf16 a[224:227], v[44:47], v[48:51], a[224:227]
 s_waitcnt vmcnt(13) lgkmcnt(1)
 v_mfma_f32_16x16x32_bf16 a[0:3], v[32:35], v[80:83], a[0:3]
 s_barrier
 ds_read_b128 v[40:43], v18 offset:4096
 v_mfma_f32_16x16x32_bf16 a[4:7], v[32:35], v[84:87], a[4:7]
 ds_read_b64_tr_b16 v[48:49], v13 offset:0
 v_mfma_f32_16x16x32_bf16 a[8:11], v[32:35], v[88:91], a[8:11]
 s_add_u32 m0, s72, s77
 v_mfma_f32_16x16x32_bf16 a[12:15], v[32:35], v[92:95], a[12:15]
 ds_read_b64_tr_b16 v[50:51], v13 offset:512
 v_mfma_f32_16x16x32_bf16 a[16:19], v[32:35], v[96:99], a[16:19]
 buffer_load_dwordx4 v5, s[20:23], s69 offen offset:0 lds
 v_mfma_f32_16x16x32_bf16 a[20:23], v[32:35], v[100:103], a[20:23]
 ds_read_b64_tr_b16 v[52:53], v14 offset:0
 v_mfma_f32_16x16x32_bf16 a[24:27], v[32:35], v[104:107], a[24:27]
 v_mfma_f32_16x16x32_bf16 a[28:31], v[32:35], v[108:111], a[28:31]
 s_waitcnt lgkmcnt(4)
 v_mfma_f32_16x16x32_bf16 a[60:63], v[36:39], v[108:111], a[60:63]
 ds_read_b128 v[44:47], v18 offset:6144
 v_mfma_f32_16x16x32_bf16 a[56:59], v[36:39], v[104:107], a[56:59]
 ds_read_b64_tr_b16 v[54:55], v14 offset:512
 v_mfma_f32_16x16x32_bf16 a[52:55], v[36:39], v[100:103], a[52:55]
 v_add_u32 v17, s74, v19
 v_mfma_f32_16x16x32_bf16 a[48:51], v[36:39], v[96:99], a[48:51]
 ds_read_b64_tr_b16 v[56:57], v15 offset:0
 v_mfma_f32_16x16x32_bf16 a[44:47], v[36:39], v[92:95], a[44:47]
 buffer_load_dwordx4 v6, s[20:23], s69 offen offset:1024 lds
 v_mfma_f32_16x16x32_bf16 a[40:43], v[36:39], v[88:91], a[40:43]
 ds_read_b64_tr_b16 v[58:59], v15 offset:512
 v_mfma_f32_16x16x32_bf16 a[36:39], v[36:39], v[84:87], a[36:39]
 v_mfma_f32_16x16x32_bf16 a[32:35], v[36:39], v[80:83], a[32:35]
 s_waitcnt lgkmcnt(7)
 v_mfma_f32_16x16x32_bf16 a[64:67], v[40:43], v[80:83], a[64:67]
 ds_read_b128 v[32:35], v18 offset:8192
 v_mfma_f32_16x16x32_bf16 a[68:71], v[40:43], v[84:87], a[68:71]
 ds_read_b64_tr_b16 v[60:61], v16 offset:0
 v_mfma_f32_16x16x32_bf16 a[72:75], v[40:43], v[88:91], a[72:75]
 v_mfma_f32_16x16x32_bf16 a[76:79], v[40:43], v[92:95], a[76:79]
 ds_read_b64_tr_b16 v[62:63], v16 offset:512
 v_mfma_f32_16x16x32_bf16 a[80:83], v[40:43], v[96:99], a[80:83]
 buffer_load_dwordx4 v7, s[20:23], s69 offen offset:2048 lds
 v_mfma_f32_16x16x32_bf16 a[84:87], v[40:43], v[100:103], a[84:87]
 ds_read_b64_tr_b16 v[64:65], v13 offset:4096
 v_mfma_f32_16x16x32_bf16 a[88:91], v[40:43], v[104:107], a[88:91]
 v_mfma_f32_16x16x32_bf16 a[92:95], v[40:43], v[108:111], a[92:95]
 s_waitcnt lgkmcnt(7)
 v_mfma_f32_16x16x32_bf16 a[124:127], v[44:47], v[108:111], a[124:127]
 ds_read_b128 v[36:39], v18 offset:10240
 v_mfma_f32_16x16x32_bf16 a[120:123], v[44:47], v[104:107], a[120:123]
 ds_read_b64_tr_b16 v[66:67], v13 offset:4608
 v_mfma_f32_16x16x32_bf16 a[116:119], v[44:47], v[100:103], a[116:119]
 v_mfma_f32_16x16x32_bf16 a[112:115], v[44:47], v[96:99], a[112:115]
 ds_read_b64_tr_b16 v[68:69], v14 offset:4096
 v_mfma_f32_16x16x32_bf16 a[108:111], v[44:47], v[92:95], a[108:111]
 buffer_load_dwordx4 v8, s[20:23], s69 offen offset:3072 lds
 v_mfma_f32_16x16x32_bf16 a[104:107], v[44:47], v[88:91], a[104:107]
 ds_read_b64_tr_b16 v[70:71], v14 offset:4608
 v_mfma_f32_16x16x32_bf16 a[100:103], v[44:47], v[84:87], a[100:103]
 s_add_u32 s69, s69, 128
 v_mfma_f32_16x16x32_bf16 a[96:99], v[44:47], v[80:83], a[96:99]
 s_waitcnt lgkmcnt(7)
 v_mfma_f32_16x16x32_bf16 a[128:131], v[32:35], v[80:83], a[128:131]
 ds_read_b128 v[40:43], v18 offset:12288
 v_mfma_f32_16x16x32_bf16 a[132:135], v[32:35], v[84:87], a[132:135]
 ds_read_b64_tr_b16 v[72:73], v15 offset:4096
 v_mfma_f32_16x16x32_bf16 a[136:139], v[32:35], v[88:91], a[136:139]
 s_add_u32 m0, s78, 49152
 v_mfma_f32_16x16x32_bf16 a[140:143], v[32:35], v[92:95], a[140:143]
 ds_read_b64_tr_b16 v[74:75], v15 offset:4608
 v_mfma_f32_16x16x32_bf16 a[144:147], v[32:35], v[96:99], a[144:147]
 buffer_load_dwordx4 v9, s[24:27], s70 offen offset:0 nt lds
 v_mfma_f32_16x16x32_bf16 a[148:151], v[32:35], v[100:103], a[148:151]
 ds_read_b64_tr_b16 v[76:77], v16 offset:4096
 v_mfma_f32_16x16x32_bf16 a[152:155], v[32:35], v[104:107], a[152:155]
 v_mfma_f32_16x16x32_bf16 a[156:159], v[32:35], v[108:111], a[156:159]
 s_waitcnt lgkmcnt(7)
 v_mfma_f32_16x16x32_bf16 a[188:191], v[36:39], v[108:111], a[188:191]
 ds_read_b128 v[44:47], v18 offset:14336
 v_mfma_f32_16x16x32_bf16 a[184:187], v[36:39], v[104:107], a[184:187]
 ds_read_b64_tr_b16 v[78:79], v16 offset:4608
 v_mfma_f32_16x16x32_bf16 a[180:183], v[36:39], v[100:103], a[180:183]
 v_mfma_f32_16x16x32_bf16 a[176:179], v[36:39], v[96:99], a[176:179]
 v_mfma_f32_16x16x32_bf16 a[172:175], v[36:39], v[92:95], a[172:175]
 buffer_load_dwordx4 v10, s[24:27], s70 offen offset:1024 nt lds
 v_mfma_f32_16x16x32_bf16 a[168:171], v[36:39], v[88:91], a[168:171]
 v_mfma_f32_16x16x32_bf16 a[164:167], v[36:39], v[84:87], a[164:167]
 v_mfma_f32_16x16x32_bf16 a[160:163], v[36:39], v[80:83], a[160:163]
 s_waitcnt lgkmcnt(5)
 v_mfma_f32_16x16x32_bf16 a[192:195], v[40:43], v[80:83], a[192:195]
 ds_read_b128 v[32:35], v17 offset:0
 v_mfma_f32_16x16x32_bf16 a[196:199], v[40:43], v[84:87], a[196:199]
 v_mfma_f32_16x16x32_bf16 a[200:203], v[40:43], v[88:91], a[200:203]
 s_mov_b32 s75, s72
 s_mov_b32 s72, s73
 v_mfma_f32_16x16x32_bf16 a[204:207], v[40:43], v[92:95], a[204:207]
 v_mfma_f32_16x16x32_bf16 a[208:211], v[40:43], v[96:99], a[208:211]
 buffer_load_dwordx4 v11, s[24:27], s70 offen offset:2048 nt lds
 v_mfma_f32_16x16x32_bf16 a[212:215], v[40:43], v[100:103], a[212:215]
 v_mfma_f32_16x16x32_bf16 a[216:219], v[40:43], v[104:107], a[216:219]
 v_add_u32 v124, s19, v124
 v_mfma_f32_16x16x32_bf16 a[220:223], v[40:43], v[108:111], a[220:223]
 s_waitcnt lgkmcnt(2)
 v_mfma_f32_16x16x32_bf16 a[252:255], v[44:47], v[108:111], a[252:255]
 ds_read_b128 v[36:39], v17 offset:2048
 v_mfma_f32_16x16x32_bf16 a[248:251], v[44:47], v[104:107], a[248:251]
 v_mfma_f32_16x16x32_bf16 a[244:247], v[44:47], v[100:103], a[244:247]
 s_mov_b32 s73, s74
 s_mov_b32 s74, s75
 v_mfma_f32_16x16x32_bf16 a[240:243], v[44:47], v[96:99], a[240:243]
 v_mfma_f32_16x16x32_bf16 a[236:239], v[44:47], v[92:95], a[236:239]
 buffer_load_dwordx4 v12, s[24:27], s70 offen offset:3072 nt lds
 v_mfma_f32_16x16x32_bf16 a[232:235], v[44:47], v[88:91], a[232:235]
 v_mfma_f32_16x16x32_bf16 a[228:231], v[44:47], v[84:87], a[228:231]
 s_add_u32 s70, s70, s71
 buffer_load_dword v31, v124, s[40:43], 0 offen
 v_mfma_f32_16x16x32_bf16 a[224:227], v[44:47], v[80:83], a[224:227]
 s_add_u32 s79, s79, 1
 s_cmp_lt_u32 s79, 7
 s_waitcnt vmcnt(18) lgkmcnt(1)
 s_cbranch_scc1 gated_mix__compressed_kv_cla__glu_gated_swiglu__prompt_kernel_loopV
 v_mov_b32 v1, v112
 v_mov_b32 v2, v113
 v_mov_b32 v3, v114
 v_mov_b32 v4, v115
 v_mov_b32 v5, v116
 v_mov_b32 v6, v117
 v_mov_b32 v7, v118
 v_mov_b32 v8, v119
 v_mov_b32 v9, v120
 v_mov_b32 v10, v121
 v_mov_b32 v11, v122
 v_mov_b32 v12, v123
 s_mov_b32 s20, s28
 s_mov_b32 s24, s32
 s_mov_b32 s21, s29
 s_mov_b32 s25, s33
 s_mov_b32 s22, s30
 s_mov_b32 s26, s34
 s_getpc_b64 s[96:97]
gated_mix__compressed_kv_cla__glu_gated_swiglu__prompt_kernel_pc2:
 s_sub_u32 s96, s96, gated_mix__compressed_kv_cla__glu_gated_swiglu__prompt_kernel_pc2-gated_mix__compressed_kv_cla__glu_gated_swiglu__prompt_kernel_pc
 s_subb_u32 s97, s97, 0
 global_load_dword v31, v27, s[96:97]
 buffer_load_dwordx2 v[28:29], off, s[44:47], 0 sc1
 s_mov_b32 s69, 0
 s_mov_b32 s70, 0
 s_mov_b32 s71, s55
 s_branch gated_mix__compressed_kv_cla__glu_gated_swiglu__prompt_kernel_loopV
gated_mix__compressed_kv_cla__glu_gated_swiglu__prompt_kernel_doneV:
 v_mfma_f32_16x16x32_bf16 a[0:3], v[32:35], v[48:51], a[0:3]
 s_barrier
 v_add_u32 v18, s73, v20
 ds_read_b64_tr_b16 v[80:81], v13 offset:49152
 v_mfma_f32_16x16x32_bf16 a[4:7], v[32:35], v[52:55], a[4:7]
 ds_read_b128 v[40:43], v18 offset:0
 ds_read_b64_tr_b16 v[82:83], v13 offset:49664
 v_mfma_f32_16x16x32_bf16 a[8:11], v[32:35], v[56:59], a[8:11]
 ds_read_b64_tr_b16 v[84:85], v14 offset:49152
 v_mfma_f32_16x16x32_bf16 a[12:15], v[32:35], v[60:63], a[12:15]
 ds_read_b64_tr_b16 v[86:87], v14 offset:49664
 v_mfma_f32_16x16x32_bf16 a[16:19], v[32:35], v[64:67], a[16:19]
 ds_read_b64_tr_b16 v[88:89], v15 offset:49152
 v_mfma_f32_16x16x32_bf16 a[20:23], v[32:35], v[68:71], a[20:23]
 ds_read_b64_tr_b16 v[90:91], v15 offset:49664
 v_mfma_f32_16x16x32_bf16 a[24:27], v[32:35], v[72:75], a[24:27]
 ds_read_b64_tr_b16 v[92:93], v16 offset:49152
 ds_read_b64_tr_b16 v[104:105], v15 offset:53248
 v_mfma_f32_16x16x32_bf16 a[28:31], v[32:35], v[76:79], a[28:31]
 s_waitcnt lgkmcnt(9)
 ds_read_b64_tr_b16 v[94:95], v16 offset:49664
 ds_read_b64_tr_b16 v[106:107], v15 offset:53760
 v_mfma_f32_16x16x32_bf16 a[60:63], v[36:39], v[76:79], a[60:63]
 ds_read_b64_tr_b16 v[96:97], v13 offset:53248
 ds_read_b64_tr_b16 v[108:109], v16 offset:53248
 v_mfma_f32_16x16x32_bf16 a[56:59], v[36:39], v[72:75], a[56:59]
 ds_read_b128 v[44:47], v18 offset:2048
 ds_read_b64_tr_b16 v[98:99], v13 offset:53760
 ds_read_b64_tr_b16 v[110:111], v16 offset:53760
 v_mfma_f32_16x16x32_bf16 a[52:55], v[36:39], v[68:71], a[52:55]
 ds_read_b64_tr_b16 v[100:101], v14 offset:53248
 v_mfma_f32_16x16x32_bf16 a[48:51], v[36:39], v[64:67], a[48:51]
 ds_read_b64_tr_b16 v[102:103], v14 offset:53760
 v_mfma_f32_16x16x32_bf16 a[44:47], v[36:39], v[60:63], a[44:47]
 v_mfma_f32_16x16x32_bf16 a[40:43], v[36:39], v[56:59], a[40:43]
 v_mfma_f32_16x16x32_bf16 a[36:39], v[36:39], v[52:55], a[36:39]
 s_add_u32 m0, s72, s76
 v_mfma_f32_16x16x32_bf16 a[32:35], v[36:39], v[48:51], a[32:35]
 s_waitcnt lgkmcnt(0)
 v_mfma_f32_16x16x32_bf16 a[0:3], v[40:43], v[80:83], a[0:3]
 buffer_load_dwordx4 v1, s[20:23], s69 offen offset:0 lds
 v_mfma_f32_16x16x32_bf16 a[4:7], v[40:43], v[84:87], a[4:7]
 ds_read_b128 v[32:35], v17 offset:4096
 v_mfma_f32_16x16x32_bf16 a[8:11], v[40:43], v[88:91], a[8:11]
 v_mfma_f32_16x16x32_bf16 a[12:15], v[40:43], v[92:95], a[12:15]
 v_mfma_f32_16x16x32_bf16 a[16:19], v[40:43], v[96:99], a[16:19]
 v_mfma_f32_16x16x32_bf16 a[20:23], v[40:43], v[100:103], a[20:23]
 v_mfma_f32_16x16x32_bf16 a[24:27], v[40:43], v[104:107], a[24:27]
 buffer_load_dwordx4 v2, s[20:23], s69 offen offset:1024 lds
 v_mfma_f32_16x16x32_bf16 a[28:31], v[40:43], v[108:111], a[28:31]
 v_mfma_f32_16x16x32_bf16 a[60:63], v[44:47], v[108:111], a[60:63]
 v_mfma_f32_16x16x32_bf16 a[56:59], v[44:47], v[104:107], a[56:59]
 ds_read_b128 v[36:39], v17 offset:6144
 v_mfma_f32_16x16x32_bf16 a[52:55], v[44:47], v[100:103], a[52:55]
 v_mfma_f32_16x16x32_bf16 a[48:51], v[44:47], v[96:99], a[48:51]
 v_mfma_f32_16x16x32_bf16 a[44:47], v[44:47], v[92:95], a[44:47]
 buffer_load_dwordx4 v3, s[20:23], s69 offen offset:2048 lds
 v_mfma_f32_16x16x32_bf16 a[40:43], v[44:47], v[88:91], a[40:43]
 v_mfma_f32_16x16x32_bf16 a[36:39], v[44:47], v[84:87], a[36:39]
 v_mfma_f32_16x16x32_bf16 a[32:35], v[44:47], v[80:83], a[32:35]
 s_waitcnt lgkmcnt(1)
 v_mfma_f32_16x16x32_bf16 a[64:67], v[32:35], v[48:51], a[64:67]
 v_mfma_f32_16x16x32_bf16 a[68:71], v[32:35], v[52:55], a[68:71]
 ds_read_b128 v[40:43], v18 offset:4096
 v_mfma_f32_16x16x32_bf16 a[72:75], v[32:35], v[56:59], a[72:75]
 buffer_load_dwordx4 v4, s[20:23], s69 offen offset:3072 lds
 v_mfma_f32_16x16x32_bf16 a[76:79], v[32:35], v[60:63], a[76:79]
 v_accvgpr_read_b32 v224, a28
 v_accvgpr_read_b32 v225, a29
 v_accvgpr_read_b32 v226, a30
 v_accvgpr_read_b32 v227, a31
 v_mfma_f32_16x16x32_bf16 a[80:83], v[32:35], v[64:67], a[80:83]
 v_accvgpr_read_b32 v228, a60
 v_accvgpr_read_b32 v229, a61
 v_accvgpr_read_b32 v230, a62
 v_accvgpr_read_b32 v231, a63
 v_mfma_f32_16x16x32_bf16 a[84:87], v[32:35], v[68:71], a[84:87]
 v_cvt_pk_bf16_f32 v140, v224, v225
 v_cvt_pk_bf16_f32 v141, v226, v227
 v_cvt_pk_bf16_f32 v142, v228, v229
 v_cvt_pk_bf16_f32 v143, v230, v231
 v_mfma_f32_16x16x32_bf16 a[88:91], v[32:35], v[72:75], a[88:91]
 s_add_u32 m0, s78, 32768
 v_accvgpr_read_b32 v240, a24
 v_accvgpr_read_b32 v241, a25
 v_accvgpr_read_b32 v242, a26
 v_accvgpr_read_b32 v243, a27
 v_mfma_f32_16x16x32_bf16 a[92:95], v[32:35], v[76:79], a[92:95]
 s_waitcnt lgkmcnt(1)
 v_accvgpr_read_b32 v244, a56
 v_accvgpr_read_b32 v245, a57
 v_accvgpr_read_b32 v246, a58
 v_accvgpr_read_b32 v247, a59
 v_mfma_f32_16x16x32_bf16 a[124:127], v[36:39], v[76:79], a[124:127]
 buffer_load_dwordx4 v9, s[24:27], s70 offen offset:0 lds
 v_mfma_f32_16x16x32_bf16 a[120:123], v[36:39], v[72:75], a[120:123]
 ds_read_b128 v[44:47], v18 offset:6144
 v_cvt_pk_bf16_f32 v136, v240, v241
 v_cvt_pk_bf16_f32 v137, v242, v243
 v_cvt_pk_bf16_f32 v138, v244, v245
 v_cvt_pk_bf16_f32 v139, v246, v247
 v_mfma_f32_16x16x32_bf16 a[116:119], v[36:39], v[68:71], a[116:119]
 v_accvgpr_read_b32 v224, a20
 v_accvgpr_read_b32 v225, a21
 v_accvgpr_read_b32 v226, a22
 v_mfma_f32_16x16x32_bf16 a[112:115], v[36:39], v[64:67], a[112:115]
 v_accvgpr_read_b32 v227, a23
 v_accvgpr_read_b32 v228, a52
 v_accvgpr_read_b32 v229, a53
 v_accvgpr_read_b32 v230, a54
 v_mfma_f32_16x16x32_bf16 a[108:111], v[36:39], v[60:63], a[108:111]
 v_accvgpr_read_b32 v231, a55
 v_cvt_pk_bf16_f32 v132, v224, v225
 v_cvt_pk_bf16_f32 v133, v226, v227
 v_cvt_pk_bf16_f32 v134, v228, v229
 v_mfma_f32_16x16x32_bf16 a[104:107], v[36:39], v[56:59], a[104:107]
 v_cvt_pk_bf16_f32 v135, v230, v231
 v_accvgpr_read_b32 v240, a16
 v_accvgpr_read_b32 v241, a17
 v_accvgpr_read_b32 v242, a18
 v_mfma_f32_16x16x32_bf16 a[100:103], v[36:39], v[52:55], a[100:103]
 buffer_load_dwordx4 v10, s[24:27], s70 offen offset:1024 lds
 v_mfma_f32_16x16x32_bf16 a[96:99], v[36:39], v[48:51], a[96:99]
 s_waitcnt lgkmcnt(1)
 v_accvgpr_read_b32 v243, a19
 v_accvgpr_read_b32 v244, a48
 v_accvgpr_read_b32 v245, a49
 v_accvgpr_read_b32 v246, a50
 v_mfma_f32_16x16x32_bf16 a[64:67], v[40:43], v[80:83], a[64:67]
 v_accvgpr_read_b32 v247, a51
 v_cvt_pk_bf16_f32 v128, v240, v241
 v_cvt_pk_bf16_f32 v129, v242, v243
 v_cvt_pk_bf16_f32 v130, v244, v245
 v_mfma_f32_16x16x32_bf16 a[68:71], v[40:43], v[84:87], a[68:71]
 ds_read_b128 v[32:35], v17 offset:8192
 v_cvt_pk_bf16_f32 v131, v246, v247
 v_accvgpr_read_b32 v224, a12
 v_accvgpr_read_b32 v225, a13
 v_mfma_f32_16x16x32_bf16 a[72:75], v[40:43], v[88:91], a[72:75]
 v_accvgpr_read_b32 v226, a14
 v_accvgpr_read_b32 v227, a15
 v_accvgpr_read_b32 v228, a44
 v_accvgpr_read_b32 v229, a45
 v_mfma_f32_16x16x32_bf16 a[76:79], v[40:43], v[92:95], a[76:79]
 v_accvgpr_read_b32 v230, a46
 v_accvgpr_read_b32 v231, a47
 v_cvt_pk_bf16_f32 v124, v224, v225
 v_cvt_pk_bf16_f32 v125, v226, v227
 v_mfma_f32_16x16x32_bf16 a[80:83], v[40:43], v[96:99], a[80:83]
 buffer_load_dwordx4 v11, s[24:27], s70 offen offset:2048 lds
 v_mfma_f32_16x16x32_bf16 a[84:87], v[40:43], v[100:103], a[84:87]
 v_cvt_pk_bf16_f32 v126, v228, v229
 v_cvt_pk_bf16_f32 v127, v230, v231
 v_accvgpr_read_b32 v240, a8
 v_accvgpr_read_b32 v241, a9
 v_mfma_f32_16x16x32_bf16 a[88:91], v[40:43], v[104:107], a[88:91]
 v_accvgpr_read_b32 v242, a10
 v_accvgpr_read_b32 v243, a11
 v_accvgpr_read_b32 v244, a40
 v_accvgpr_read_b32 v245, a41
 v_mfma_f32_16x16x32_bf16 a[92:95], v[40:43], v[108:111], a[92:95]
 s_waitcnt lgkmcnt(1)
 v_accvgpr_read_b32 v246, a42
 v_accvgpr_read_b32 v247, a43
 v_cvt_pk_bf16_f32 v120, v240, v241
 v_cvt_pk_bf16_f32 v121, v242, v243
 v_mfma_f32_16x16x32_bf16 a[124:127], v[44:47], v[108:111], a[124:127]
 v_cvt_pk_bf16_f32 v122, v244, v245
 v_cvt_pk_bf16_f32 v123, v246, v247
 v_accvgpr_read_b32 v224, a4
 v_mfma_f32_16x16x32_bf16 a[120:123], v[44:47], v[104:107], a[120:123]
 ds_read_b128 v[36:39], v17 offset:10240
 v_accvgpr_read_b32 v225, a5
 v_accvgpr_read_b32 v226, a6
 v_accvgpr_read_b32 v227, a7
 v_accvgpr_read_b32 v228, a36
 v_mfma_f32_16x16x32_bf16 a[116:119], v[44:47], v[100:103], a[116:119]
 buffer_load_dwordx4 v12, s[24:27], s70 offen offset:3072 lds
 v_mfma_f32_16x16x32_bf16 a[112:115], v[44:47], v[96:99], a[112:115]
 v_accvgpr_read_b32 v229, a37
 v_accvgpr_read_b32 v230, a38
 v_accvgpr_read_b32 v231, a39
 v_cvt_pk_bf16_f32 v116, v224, v225
 v_mfma_f32_16x16x32_bf16 a[108:111], v[44:47], v[92:95], a[108:111]
 s_add_u32 s70, s70, s71
 v_cvt_pk_bf16_f32 v117, v226, v227
 v_cvt_pk_bf16_f32 v118, v228, v229
 v_cvt_pk_bf16_f32 v119, v230, v231
 v_accvgpr_read_b32 v240, a0
 v_mfma_f32_16x16x32_bf16 a[104:107], v[44:47], v[88:91], a[104:107]
 v_accvgpr_read_b32 v241, a1
 v_accvgpr_read_b32 v242, a2
 v_accvgpr_read_b32 v243, a3
 v_accvgpr_read_b32 v244, a32
 v_mfma_f32_16x16x32_bf16 a[100:103], v[44:47], v[84:87], a[100:103]
 s_waitcnt vmcnt(13)
 s_barrier
 v_accvgpr_read_b32 v245, a33
 v_accvgpr_read_b32 v246, a34
 v_accvgpr_read_b32 v247, a35
 v_cvt_pk_bf16_f32 v112, v240, v241
 v_mfma_f32_16x16x32_bf16 a[96:99], v[44:47], v[80:83], a[96:99]
 s_waitcnt lgkmcnt(1)
 v_cvt_pk_bf16_f32 v113, v242, v243
 v_cvt_pk_bf16_f32 v114, v244, v245
 v_cvt_pk_bf16_f32 v115, v246, v247
 v_mfma_f32_16x16x32_bf16 a[128:131], v[32:35], v[48:51], a[128:131]
 v_mfma_f32_16x16x32_bf16 a[132:135], v[32:35], v[52:55], a[132:135]
 ds_read_b128 v[40:43], v18 offset:8192
 v_mfma_f32_16x16x32_bf16 a[136:139], v[32:35], v[56:59], a[136:139]
 v_mfma_f32_16x16x32_bf16 a[140:143], v[32:35], v[60:63], a[140:143]
 v_accvgpr_read_b32 v224, a92
 v_accvgpr_read_b32 v225, a93
 v_accvgpr_read_b32 v226, a94
 v_accvgpr_read_b32 v227, a95
 v_mfma_f32_16x16x32_bf16 a[144:147], v[32:35], v[64:67], a[144:147]
 v_accvgpr_read_b32 v228, a124
 v_accvgpr_read_b32 v229, a125
 v_accvgpr_read_b32 v230, a126
 v_accvgpr_read_b32 v231, a127
 v_mfma_f32_16x16x32_bf16 a[148:151], v[32:35], v[68:71], a[148:151]
 v_cvt_pk_bf16_f32 v172, v224, v225
 v_cvt_pk_bf16_f32 v173, v226, v227
 v_cvt_pk_bf16_f32 v174, v228, v229
 v_cvt_pk_bf16_f32 v175, v230, v231
 v_mfma_f32_16x16x32_bf16 a[152:155], v[32:35], v[72:75], a[152:155]
 v_accvgpr_read_b32 v240, a88
 v_accvgpr_read_b32 v241, a89
 v_accvgpr_read_b32 v242, a90
 v_mfma_f32_16x16x32_bf16 a[156:159], v[32:35], v[76:79], a[156:159]
 s_waitcnt lgkmcnt(1)
 v_accvgpr_read_b32 v243, a91
 v_accvgpr_read_b32 v244, a120
 v_accvgpr_read_b32 v245, a121
 v_accvgpr_read_b32 v246, a122
 v_mfma_f32_16x16x32_bf16 a[188:191], v[36:39], v[76:79], a[188:191]
 v_accvgpr_read_b32 v247, a123
 v_cvt_pk_bf16_f32 v168, v240, v241
 v_cvt_pk_bf16_f32 v169, v242, v243
 v_cvt_pk_bf16_f32 v170, v244, v245
 v_mfma_f32_16x16x32_bf16 a[184:187], v[36:39], v[72:75], a[184:187]
 ds_read_b128 v[44:47], v18 offset:10240
 v_cvt_pk_bf16_f32 v171, v246, v247
 v_accvgpr_read_b32 v224, a84
 v_accvgpr_read_b32 v225, a85
 v_mfma_f32_16x16x32_bf16 a[180:183], v[36:39], v[68:71], a[180:183]
 v_accvgpr_read_b32 v226, a86
 v_accvgpr_read_b32 v227, a87
 v_accvgpr_read_b32 v228, a116
 v_accvgpr_read_b32 v229, a117
 v_mfma_f32_16x16x32_bf16 a[176:179], v[36:39], v[64:67], a[176:179]
 v_accvgpr_read_b32 v230, a118
 v_accvgpr_read_b32 v231, a119
 v_cvt_pk_bf16_f32 v164, v224, v225
 v_cvt_pk_bf16_f32 v165, v226, v227
 v_mfma_f32_16x16x32_bf16 a[172:175], v[36:39], v[60:63], a[172:175]
 v_cvt_pk_bf16_f32 v166, v228, v229
 v_cvt_pk_bf16_f32 v167, v230, v231
 v_accvgpr_read_b32 v240, a80
 v_mfma_f32_16x16x32_bf16 a[168:171], v[36:39], v[56:59], a[168:171]
 v_accvgpr_read_b32 v241, a81
 v_accvgpr_read_b32 v242, a82
 v_accvgpr_read_b32 v243, a83
 v_accvgpr_read_b32 v244, a112
 v_mfma_f32_16x16x32_bf16 a[164:167], v[36:39], v[52:55], a[164:167]
 s_add_u32 m0, s72, s77
 v_accvgpr_read_b32 v245, a113
 v_accvgpr_read_b32 v246, a114
 v_accvgpr_read_b32 v247, a115
 v_cvt_pk_bf16_f32 v160, v240, v241
 v_mfma_f32_16x16x32_bf16 a[160:163], v[36:39], v[48:51], a[160:163]
 s_waitcnt lgkmcnt(1)
 v_cvt_pk_bf16_f32 v161, v242, v243
 v_cvt_pk_bf16_f32 v162, v244, v245
 v_cvt_pk_bf16_f32 v163, v246, v247
 v_mfma_f32_16x16x32_bf16 a[128:131], v[40:43], v[80:83], a[128:131]
 buffer_load_dwordx4 v5, s[20:23], s69 offen offset:0 lds
 v_mfma_f32_16x16x32_bf16 a[132:135], v[40:43], v[84:87], a[132:135]
 ds_read_b128 v[32:35], v17 offset:12288
 v_accvgpr_read_b32 v224, a76
 v_accvgpr_read_b32 v225, a77
 v_accvgpr_read_b32 v226, a78
 v_accvgpr_read_b32 v227, a79
 v_mfma_f32_16x16x32_bf16 a[136:139], v[40:43], v[88:91], a[136:139]
 v_accvgpr_read_b32 v228, a108
 v_accvgpr_read_b32 v229, a109
 v_accvgpr_read_b32 v230, a110
 v_accvgpr_read_b32 v231, a111
 v_mfma_f32_16x16x32_bf16 a[140:143], v[40:43], v[92:95], a[140:143]
 v_cvt_pk_bf16_f32 v156, v224, v225
 v_cvt_pk_bf16_f32 v157, v226, v227
 v_cvt_pk_bf16_f32 v158, v228, v229
 v_cvt_pk_bf16_f32 v159, v230, v231
 v_mfma_f32_16x16x32_bf16 a[144:147], v[40:43], v[96:99], a[144:147]
 v_accvgpr_read_b32 v240, a72
 v_accvgpr_read_b32 v241, a73
 v_accvgpr_read_b32 v242, a74
 v_mfma_f32_16x16x32_bf16 a[148:151], v[40:43], v[100:103], a[148:151]
 v_accvgpr_read_b32 v243, a75
 v_accvgpr_read_b32 v244, a104
 v_accvgpr_read_b32 v245, a105
 v_accvgpr_read_b32 v246, a106
 v_mfma_f32_16x16x32_bf16 a[152:155], v[40:43], v[104:107], a[152:155]
 buffer_load_dwordx4 v6, s[20:23], s69 offen offset:1024 lds
 v_mfma_f32_16x16x32_bf16 a[156:159], v[40:43], v[108:111], a[156:159]
 s_waitcnt lgkmcnt(1)
 v_accvgpr_read_b32 v247, a107
 v_cvt_pk_bf16_f32 v152, v240, v241
 v_cvt_pk_bf16_f32 v153, v242, v243
 v_cvt_pk_bf16_f32 v154, v244, v245
 v_mfma_f32_16x16x32_bf16 a[188:191], v[44:47], v[108:111], a[188:191]
 v_cvt_pk_bf16_f32 v155, v246, v247
 v_accvgpr_read_b32 v224, a68
 v_accvgpr_read_b32 v225, a69
 v_mfma_f32_16x16x32_bf16 a[184:187], v[44:47], v[104:107], a[184:187]
 ds_read_b128 v[36:39], v17 offset:14336
 v_accvgpr_read_b32 v226, a70
 v_accvgpr_read_b32 v227, a71
 v_accvgpr_read_b32 v228, a100
 v_accvgpr_read_b32 v229, a101
 v_mfma_f32_16x16x32_bf16 a[180:183], v[44:47], v[100:103], a[180:183]
 v_accvgpr_read_b32 v230, a102
 v_accvgpr_read_b32 v231, a103
 v_cvt_pk_bf16_f32 v148, v224, v225
 v_cvt_pk_bf16_f32 v149, v226, v227
 v_mfma_f32_16x16x32_bf16 a[176:179], v[44:47], v[96:99], a[176:179]
 v_cvt_pk_bf16_f32 v150, v228, v229
 v_cvt_pk_bf16_f32 v151, v230, v231
 v_accvgpr_read_b32 v240, a64
 v_mfma_f32_16x16x32_bf16 a[172:175], v[44:47], v[92:95], a[172:175]
 buffer_load_dwordx4 v7, s[20:23], s69 offen offset:2048 lds
 v_mfma_f32_16x16x32_bf16 a[168:171], v[44:47], v[88:91], a[168:171]
 v_accvgpr_read_b32 v241, a65
 v_accvgpr_read_b32 v242, a66
 v_accvgpr_read_b32 v243, a67
 v_accvgpr_read_b32 v244, a96
 v_mfma_f32_16x16x32_bf16 a[164:167], v[44:47], v[84:87], a[164:167]
 v_accvgpr_read_b32 v245, a97
 v_accvgpr_read_b32 v246, a98
 v_accvgpr_read_b32 v247, a99
 v_cvt_pk_bf16_f32 v144, v240, v241
 v_mfma_f32_16x16x32_bf16 a[160:163], v[44:47], v[80:83], a[160:163]
 s_waitcnt lgkmcnt(1)
 v_cvt_pk_bf16_f32 v145, v242, v243
 v_cvt_pk_bf16_f32 v146, v244, v245
 v_cvt_pk_bf16_f32 v147, v246, v247
 v_mfma_f32_16x16x32_bf16 a[192:195], v[32:35], v[48:51], a[192:195]
 v_mfma_f32_16x16x32_bf16 a[196:199], v[32:35], v[52:55], a[196:199]
 ds_read_b128 v[40:43], v18 offset:12288
 v_mfma_f32_16x16x32_bf16 a[200:203], v[32:35], v[56:59], a[200:203]
 buffer_load_dwordx4 v8, s[20:23], s69 offen offset:3072 lds
 v_mfma_f32_16x16x32_bf16 a[204:207], v[32:35], v[60:63], a[204:207]
 v_accvgpr_read_b32 v224, a156
 v_accvgpr_read_b32 v225, a157
 v_accvgpr_read_b32 v226, a158
 v_accvgpr_read_b32 v227, a159
 v_mfma_f32_16x16x32_bf16 a[208:211], v[32:35], v[64:67], a[208:211]
 v_accvgpr_read_b32 v228, a188
 v_accvgpr_read_b32 v229, a189
 v_accvgpr_read_b32 v230, a190
 v_accvgpr_read_b32 v231, a191
 v_mfma_f32_16x16x32_bf16 a[212:215], v[32:35], v[68:71], a[212:215]
 v_cvt_pk_bf16_f32 v204, v224, v225
 v_cvt_pk_bf16_f32 v205, v226, v227
 v_cvt_pk_bf16_f32 v206, v228, v229
 v_cvt_pk_bf16_f32 v207, v230, v231
 v_mfma_f32_16x16x32_bf16 a[216:219], v[32:35], v[72:75], a[216:219]
 s_add_u32 m0, s78, 49152
 v_accvgpr_read_b32 v240, a152
 v_accvgpr_read_b32 v241, a153
 v_accvgpr_read_b32 v242, a154
 v_accvgpr_read_b32 v243, a155
 v_mfma_f32_16x16x32_bf16 a[220:223], v[32:35], v[76:79], a[220:223]
 s_waitcnt lgkmcnt(1)
 v_accvgpr_read_b32 v244, a184
 v_accvgpr_read_b32 v245, a185
 v_accvgpr_read_b32 v246, a186
 v_accvgpr_read_b32 v247, a187
 v_mfma_f32_16x16x32_bf16 a[252:255], v[36:39], v[76:79], a[252:255]
 buffer_load_dwordx4 v9, s[24:27], s70 offen offset:0 lds
 v_mfma_f32_16x16x32_bf16 a[248:251], v[36:39], v[72:75], a[248:251]
 ds_read_b128 v[44:47], v18 offset:14336
 v_cvt_pk_bf16_f32 v200, v240, v241
 v_cvt_pk_bf16_f32 v201, v242, v243
 v_cvt_pk_bf16_f32 v202, v244, v245
 v_cvt_pk_bf16_f32 v203, v246, v247
 v_mfma_f32_16x16x32_bf16 a[244:247], v[36:39], v[68:71], a[244:247]
 v_accvgpr_read_b32 v224, a148
 v_accvgpr_read_b32 v225, a149
 v_accvgpr_read_b32 v226, a150
 v_mfma_f32_16x16x32_bf16 a[240:243], v[36:39], v[64:67], a[240:243]
 v_accvgpr_read_b32 v227, a151
 v_accvgpr_read_b32 v228, a180
 v_accvgpr_read_b32 v229, a181
 v_accvgpr_read_b32 v230, a182
 v_mfma_f32_16x16x32_bf16 a[236:239], v[36:39], v[60:63], a[236:239]
 v_accvgpr_read_b32 v231, a183
 v_cvt_pk_bf16_f32 v196, v224, v225
 v_cvt_pk_bf16_f32 v197, v226, v227
 v_cvt_pk_bf16_f32 v198, v228, v229
 v_mfma_f32_16x16x32_bf16 a[232:235], v[36:39], v[56:59], a[232:235]
 v_cvt_pk_bf16_f32 v199, v230, v231
 v_accvgpr_read_b32 v240, a144
 v_accvgpr_read_b32 v241, a145
 v_accvgpr_read_b32 v242, a146
 v_mfma_f32_16x16x32_bf16 a[228:231], v[36:39], v[52:55], a[228:231]
 s_add_u32 s69, s69, 128
 buffer_load_dwordx4 v10, s[24:27], s70 offen offset:1024 lds
 v_mfma_f32_16x16x32_bf16 a[224:227], v[36:39], v[48:51], a[224:227]
 s_waitcnt lgkmcnt(1)
 v_accvgpr_read_b32 v243, a147
 v_accvgpr_read_b32 v244, a176
 v_accvgpr_read_b32 v245, a177
 v_accvgpr_read_b32 v246, a178
 v_mfma_f32_16x16x32_bf16 a[192:195], v[40:43], v[80:83], a[192:195]
 v_accvgpr_read_b32 v247, a179
 v_cvt_pk_bf16_f32 v192, v240, v241
 v_cvt_pk_bf16_f32 v193, v242, v243
 v_cvt_pk_bf16_f32 v194, v244, v245
 v_mfma_f32_16x16x32_bf16 a[196:199], v[40:43], v[84:87], a[196:199]
 v_cvt_pk_bf16_f32 v195, v246, v247
 v_accvgpr_read_b32 v224, a140
 v_accvgpr_read_b32 v225, a141
 v_mfma_f32_16x16x32_bf16 a[200:203], v[40:43], v[88:91], a[200:203]
 v_accvgpr_read_b32 v226, a142
 v_accvgpr_read_b32 v227, a143
 v_accvgpr_read_b32 v228, a172
 v_accvgpr_read_b32 v229, a173
 v_mfma_f32_16x16x32_bf16 a[204:207], v[40:43], v[92:95], a[204:207]
 v_accvgpr_read_b32 v230, a174
 v_accvgpr_read_b32 v231, a175
 v_cvt_pk_bf16_f32 v188, v224, v225
 v_cvt_pk_bf16_f32 v189, v226, v227
 v_mfma_f32_16x16x32_bf16 a[208:211], v[40:43], v[96:99], a[208:211]
 s_mov_b32 s75, s72
 buffer_load_dwordx4 v11, s[24:27], s70 offen offset:2048 lds
 v_mfma_f32_16x16x32_bf16 a[212:215], v[40:43], v[100:103], a[212:215]
 v_cvt_pk_bf16_f32 v190, v228, v229
 v_cvt_pk_bf16_f32 v191, v230, v231
 v_accvgpr_read_b32 v240, a136
 v_accvgpr_read_b32 v241, a137
 v_mfma_f32_16x16x32_bf16 a[216:219], v[40:43], v[104:107], a[216:219]
 s_mov_b32 s72, s73
 v_accvgpr_read_b32 v242, a138
 v_accvgpr_read_b32 v243, a139
 v_accvgpr_read_b32 v244, a168
 v_accvgpr_read_b32 v245, a169
 v_mfma_f32_16x16x32_bf16 a[220:223], v[40:43], v[108:111], a[220:223]
 s_waitcnt lgkmcnt(0)
 v_accvgpr_read_b32 v246, a170
 v_accvgpr_read_b32 v247, a171
 v_cvt_pk_bf16_f32 v184, v240, v241
 v_cvt_pk_bf16_f32 v185, v242, v243
 v_mfma_f32_16x16x32_bf16 a[252:255], v[44:47], v[108:111], a[252:255]
 s_mov_b32 s73, s74
 v_cvt_pk_bf16_f32 v186, v244, v245
 v_cvt_pk_bf16_f32 v187, v246, v247
 v_accvgpr_read_b32 v224, a132
 v_mfma_f32_16x16x32_bf16 a[248:251], v[44:47], v[104:107], a[248:251]
 v_accvgpr_read_b32 v225, a133
 v_accvgpr_read_b32 v226, a134
 v_accvgpr_read_b32 v227, a135
 v_accvgpr_read_b32 v228, a164
 v_mfma_f32_16x16x32_bf16 a[244:247], v[44:47], v[100:103], a[244:247]
 s_mov_b32 s74, s75
 buffer_load_dwordx4 v12, s[24:27], s70 offen offset:3072 lds
 v_mfma_f32_16x16x32_bf16 a[240:243], v[44:47], v[96:99], a[240:243]
 v_accvgpr_read_b32 v229, a165
 v_accvgpr_read_b32 v230, a166
 v_accvgpr_read_b32 v231, a167
 v_cvt_pk_bf16_f32 v180, v224, v225
 v_mfma_f32_16x16x32_bf16 a[236:239], v[44:47], v[92:95], a[236:239]
 s_add_u32 s70, s70, s71
 v_cvt_pk_bf16_f32 v181, v226, v227
 v_cvt_pk_bf16_f32 v182, v228, v229
 v_cvt_pk_bf16_f32 v183, v230, v231
 v_accvgpr_read_b32 v240, a128
 v_mfma_f32_16x16x32_bf16 a[232:235], v[44:47], v[88:91], a[232:235]
 v_accvgpr_read_b32 v241, a129
 v_accvgpr_read_b32 v242, a130
 v_accvgpr_read_b32 v243, a131
 v_accvgpr_read_b32 v244, a160
 v_mfma_f32_16x16x32_bf16 a[228:231], v[44:47], v[84:87], a[228:231]
 v_accvgpr_read_b32 v245, a161
 v_accvgpr_read_b32 v246, a162
 v_accvgpr_read_b32 v247, a163
 v_cvt_pk_bf16_f32 v176, v240, v241
 v_mfma_f32_16x16x32_bf16 a[224:227], v[44:47], v[80:83], a[224:227]
 v_cvt_pk_bf16_f32 v177, v242, v243
 v_cvt_pk_bf16_f32 v178, v244, v245
 v_cvt_pk_bf16_f32 v179, v246, v247
 v_add_u32 v17, s73, v19
 ds_read_b64_tr_b16 v[48:49], v13 offset:0
 ds_read_b64_tr_b16 v[50:51], v13 offset:512
 ds_read_b64_tr_b16 v[52:53], v14 offset:0
 ds_read_b64_tr_b16 v[54:55], v14 offset:512
 ds_read_b64_tr_b16 v[56:57], v15 offset:0
 ds_read_b64_tr_b16 v[58:59], v15 offset:512
 ds_read_b64_tr_b16 v[60:61], v16 offset:0
 ds_read_b64_tr_b16 v[62:63], v16 offset:512
 v_accvgpr_read_b32 v80, a220
 v_accvgpr_read_b32 v81, a221
 v_accvgpr_read_b32 v82, a222
 v_accvgpr_read_b32 v83, a223
 v_accvgpr_read_b32 v84, a252
 v_accvgpr_read_b32 v85, a253
 v_accvgpr_read_b32 v86, a254
 v_accvgpr_read_b32 v87, a255
 v_cvt_pk_bf16_f32 v236, v80, v81
 v_cvt_pk_bf16_f32 v237, v82, v83
 v_cvt_pk_bf16_f32 v238, v84, v85
 v_cvt_pk_bf16_f32 v239, v86, v87
 ds_read_b64_tr_b16 v[64:65], v13 offset:4096
 ds_read_b64_tr_b16 v[66:67], v13 offset:4608
 v_accvgpr_read_b32 v88, a216
 v_accvgpr_read_b32 v89, a217
 v_accvgpr_read_b32 v90, a218
 v_accvgpr_read_b32 v91, a219
 v_accvgpr_read_b32 v92, a248
 v_accvgpr_read_b32 v93, a249
 v_accvgpr_read_b32 v94, a250
 v_accvgpr_read_b32 v95, a251
 v_cvt_pk_bf16_f32 v232, v88, v89
 v_cvt_pk_bf16_f32 v233, v90, v91
 v_cvt_pk_bf16_f32 v234, v92, v93
 v_cvt_pk_bf16_f32 v235, v94, v95
 ds_read_b64_tr_b16 v[68:69], v14 offset:4096
 ds_read_b64_tr_b16 v[70:71], v14 offset:4608
 v_accvgpr_read_b32 v96, a212
 v_accvgpr_read_b32 v97, a213
 v_accvgpr_read_b32 v98, a214
 v_accvgpr_read_b32 v99, a215
 v_accvgpr_read_b32 v100, a244
 v_accvgpr_read_b32 v101, a245
 v_accvgpr_read_b32 v102, a246
 v_accvgpr_read_b32 v103, a247
 v_cvt_pk_bf16_f32 v228, v96, v97
 v_cvt_pk_bf16_f32 v229, v98, v99
 v_cvt_pk_bf16_f32 v230, v100, v101
 v_cvt_pk_bf16_f32 v231, v102, v103
 ds_read_b64_tr_b16 v[72:73], v15 offset:4096
 ds_read_b64_tr_b16 v[74:75], v15 offset:4608
 v_accvgpr_read_b32 v104, a208
 v_accvgpr_read_b32 v105, a209
 v_accvgpr_read_b32 v106, a210
 v_accvgpr_read_b32 v107, a211
 v_accvgpr_read_b32 v108, a240
 v_accvgpr_read_b32 v109, a241
 v_accvgpr_read_b32 v110, a242
 v_accvgpr_read_b32 v111, a243
 v_cvt_pk_bf16_f32 v224, v104, v105
 v_cvt_pk_bf16_f32 v225, v106, v107
 v_cvt_pk_bf16_f32 v226, v108, v109
 v_cvt_pk_bf16_f32 v227, v110, v111
 ds_read_b64_tr_b16 v[76:77], v16 offset:4096
 ds_read_b64_tr_b16 v[78:79], v16 offset:4608
 v_accvgpr_read_b32 v80, a204
 v_accvgpr_read_b32 v81, a205
 v_accvgpr_read_b32 v82, a206
 v_accvgpr_read_b32 v83, a207
 v_accvgpr_read_b32 v84, a236
 v_accvgpr_read_b32 v85, a237
 v_accvgpr_read_b32 v86, a238
 v_accvgpr_read_b32 v87, a239
 v_cvt_pk_bf16_f32 v220, v80, v81
 v_cvt_pk_bf16_f32 v221, v82, v83
 v_cvt_pk_bf16_f32 v222, v84, v85
 v_cvt_pk_bf16_f32 v223, v86, v87
 ds_read_b128 v[32:35], v17 offset:0
 ds_read_b128 v[36:39], v17 offset:2048
 v_accvgpr_read_b32 v88, a200
 v_accvgpr_read_b32 v89, a201
 v_accvgpr_read_b32 v90, a202
 v_accvgpr_read_b32 v91, a203
 v_accvgpr_read_b32 v92, a232
 v_accvgpr_read_b32 v93, a233
 v_accvgpr_read_b32 v94, a234
 v_accvgpr_read_b32 v95, a235
 v_cvt_pk_bf16_f32 v216, v88, v89
 v_cvt_pk_bf16_f32 v217, v90, v91
 v_cvt_pk_bf16_f32 v218, v92, v93
 v_cvt_pk_bf16_f32 v219, v94, v95
 v_accvgpr_read_b32 v96, a196
 v_accvgpr_read_b32 v97, a197
 v_accvgpr_read_b32 v98, a198
 v_accvgpr_read_b32 v99, a199
 v_accvgpr_read_b32 v100, a228
 v_accvgpr_read_b32 v101, a229
 v_accvgpr_read_b32 v102, a230
 v_accvgpr_read_b32 v103, a231
 v_cvt_pk_bf16_f32 v212, v96, v97
 v_cvt_pk_bf16_f32 v213, v98, v99
 v_cvt_pk_bf16_f32 v214, v100, v101
 v_cvt_pk_bf16_f32 v215, v102, v103
 v_accvgpr_read_b32 v104, a192
 v_accvgpr_read_b32 v105, a193
 v_accvgpr_read_b32 v106, a194
 v_accvgpr_read_b32 v107, a195
 v_accvgpr_read_b32 v108, a224
 v_accvgpr_read_b32 v109, a225
 v_accvgpr_read_b32 v110, a226
 v_accvgpr_read_b32 v111, a227
 v_cvt_pk_bf16_f32 v208, v104, v105
 v_cvt_pk_bf16_f32 v209, v106, v107
 v_cvt_pk_bf16_f32 v210, v108, v109
 v_cvt_pk_bf16_f32 v211, v110, v111
 s_waitcnt vmcnt(17) lgkmcnt(1)
gated_mix__compressed_kv_cla__glu_gated_swiglu__prompt_kernel_p2:
 s_mov_b32 s94, 1048576
gated_mix__compressed_kv_cla__glu_gated_swiglu__prompt_kernel_tagtop:
 v_readfirstlane_b32 s93, v29
 s_nop 3
 s_cmp_eq_u32 s93, 1
 s_cbranch_scc1 gated_mix__compressed_kv_cla__glu_gated_swiglu__prompt_kernel_tagok
 s_sub_u32 s94, s94, 1
 s_cbranch_scc1 gated_mix__compressed_kv_cla__glu_gated_swiglu__prompt_kernel_tagok
 s_sleep 12
 buffer_load_dwordx2 v[28:29], off, s[44:47], 0 sc1
 s_waitcnt vmcnt(0)
 s_branch gated_mix__compressed_kv_cla__glu_gated_swiglu__prompt_kernel_tagtop
gated_mix__compressed_kv_cla__glu_gated_swiglu__prompt_kernel_tagok:
 v_not_b32 v29, v28
 s_getpc_b64 s[96:97]
gated_mix__compressed_kv_cla__glu_gated_swiglu__prompt_kernel_pc3:
 s_sub_u32 s96, s96, gated_mix__compressed_kv_cla__glu_gated_swiglu__prompt_kernel_pc3-gated_mix__compressed_kv_cla__glu_gated_swiglu__prompt_kernel_pc
 s_subb_u32 s97, s97, 0
 global_load_dword v31, v27, s[96:97]
 s_lshl_b32 s91, s82, 3
 s_add_u32 s91, s91, s83
 s_mul_i32 s54, s91, 384
 s_add_u32 s54, s54, 52953088
 s_lshl_b32 s91, s91, 2
 s_add_u32 s91, s91, s68
 s_mul_i32 s55, s91, 20480
 s_add_u32 s55, s55, 88080384
 s_cmp_eq_u32 s81, 0
 s_cbranch_scc1 gated_mix__compressed_kv_cla__glu_gated_swiglu__prompt_kernel_qq
 s_cmp_eq_u32 s81, 2
 s_cbranch_scc1 gated_mix__compressed_kv_cla__glu_gated_swiglu__prompt_kernel_qdirect
 v_mfma_f32_16x16x32_bf16 a[0:3], v[48:51], v[32:35], 0
 s_barrier
 ds_read_b128 v[40:43], v17 offset:4096
 v_mfma_f32_16x16x32_bf16 a[4:7], v[52:55], v[32:35], 0
 ds_read_b64_tr_b16 v[80:81], v13 offset:16384
 v_mfma_f32_16x16x32_bf16 a[8:11], v[56:59], v[32:35], 0
 s_add_u32 m0, s72, s76
 v_mfma_f32_16x16x32_bf16 a[12:15], v[60:63], v[32:35], 0
 ds_read_b64_tr_b16 v[82:83], v13 offset:16896
 v_mfma_f32_16x16x32_bf16 a[16:19], v[64:67], v[32:35], 0
 buffer_load_dwordx4 v1, s[20:23], s69 offen offset:0 lds
 v_mfma_f32_16x16x32_bf16 a[20:23], v[68:71], v[32:35], 0
 ds_read_b64_tr_b16 v[84:85], v14 offset:16384
 v_mfma_f32_16x16x32_bf16 a[24:27], v[72:75], v[32:35], 0
 v_mfma_f32_16x16x32_bf16 a[28:31], v[76:79], v[32:35], 0
 s_waitcnt lgkmcnt(4)
 v_mfma_f32_16x16x32_bf16 a[60:63], v[76:79], v[36:39], 0
 ds_read_b128 v[44:47], v17 offset:6144
 v_mfma_f32_16x16x32_bf16 a[56:59], v[72:75], v[36:39], 0
 ds_read_b64_tr_b16 v[86:87], v14 offset:16896
 v_mfma_f32_16x16x32_bf16 a[52:55], v[68:71], v[36:39], 0
 v_add_u32 v18, s73, v20
 v_mfma_f32_16x16x32_bf16 a[48:51], v[64:67], v[36:39], 0
 ds_read_b64_tr_b16 v[88:89], v15 offset:16384
 v_mfma_f32_16x16x32_bf16 a[44:47], v[60:63], v[36:39], 0
 buffer_load_dwordx4 v2, s[20:23], s69 offen offset:1024 lds
 v_mfma_f32_16x16x32_bf16 a[40:43], v[56:59], v[36:39], 0
 ds_read_b64_tr_b16 v[90:91], v15 offset:16896
 v_mfma_f32_16x16x32_bf16 a[36:39], v[52:55], v[36:39], 0
 v_mfma_f32_16x16x32_bf16 a[32:35], v[48:51], v[36:39], 0
 s_waitcnt lgkmcnt(7)
 v_mfma_f32_16x16x32_bf16 a[64:67], v[48:51], v[40:43], 0
 ds_read_b128 v[32:35], v17 offset:8192
 v_mfma_f32_16x16x32_bf16 a[68:71], v[52:55], v[40:43], 0
 ds_read_b64_tr_b16 v[92:93], v16 offset:16384
 v_mfma_f32_16x16x32_bf16 a[72:75], v[56:59], v[40:43], 0
 v_mfma_f32_16x16x32_bf16 a[76:79], v[60:63], v[40:43], 0
 ds_read_b64_tr_b16 v[94:95], v16 offset:16896
 v_mfma_f32_16x16x32_bf16 a[80:83], v[64:67], v[40:43], 0
 buffer_load_dwordx4 v3, s[20:23], s69 offen offset:2048 lds
 v_mfma_f32_16x16x32_bf16 a[84:87], v[68:71], v[40:43], 0
 ds_read_b64_tr_b16 v[96:97], v13 offset:20480
 v_mfma_f32_16x16x32_bf16 a[88:91], v[72:75], v[40:43], 0
 v_mfma_f32_16x16x32_bf16 a[92:95], v[76:79], v[40:43], 0
 s_waitcnt lgkmcnt(7)
 v_mfma_f32_16x16x32_bf16 a[124:127], v[76:79], v[44:47], 0
 ds_read_b128 v[36:39], v17 offset:10240
 v_mfma_f32_16x16x32_bf16 a[120:123], v[72:75], v[44:47], 0
 ds_read_b64_tr_b16 v[98:99], v13 offset:20992
 v_mfma_f32_16x16x32_bf16 a[116:119], v[68:71], v[44:47], 0
 v_mfma_f32_16x16x32_bf16 a[112:115], v[64:67], v[44:47], 0
 ds_read_b64_tr_b16 v[100:101], v14 offset:20480
 v_mfma_f32_16x16x32_bf16 a[108:111], v[60:63], v[44:47], 0
 buffer_load_dwordx4 v4, s[20:23], s69 offen offset:3072 lds
 v_mfma_f32_16x16x32_bf16 a[104:107], v[56:59], v[44:47], 0
 ds_read_b64_tr_b16 v[102:103], v14 offset:20992
 v_mfma_f32_16x16x32_bf16 a[100:103], v[52:55], v[44:47], 0
 v_mfma_f32_16x16x32_bf16 a[96:99], v[48:51], v[44:47], 0
 s_waitcnt lgkmcnt(7)
 v_mfma_f32_16x16x32_bf16 a[128:131], v[48:51], v[32:35], 0
 ds_read_b128 v[40:43], v17 offset:12288
 v_mfma_f32_16x16x32_bf16 a[132:135], v[52:55], v[32:35], 0
 ds_read_b64_tr_b16 v[104:105], v15 offset:20480
 v_mfma_f32_16x16x32_bf16 a[136:139], v[56:59], v[32:35], 0
 s_add_u32 m0, s78, 0
 v_mfma_f32_16x16x32_bf16 a[140:143], v[60:63], v[32:35], 0
 ds_read_b64_tr_b16 v[106:107], v15 offset:20992
 v_mfma_f32_16x16x32_bf16 a[144:147], v[64:67], v[32:35], 0
 buffer_load_dwordx4 v9, s[24:27], s70 offen offset:0  lds
 v_mfma_f32_16x16x32_bf16 a[148:151], v[68:71], v[32:35], 0
 ds_read_b64_tr_b16 v[108:109], v16 offset:20480
 v_mfma_f32_16x16x32_bf16 a[152:155], v[72:75], v[32:35], 0
 v_mfma_f32_16x16x32_bf16 a[156:159], v[76:79], v[32:35], 0
 s_waitcnt lgkmcnt(7)
 v_mfma_f32_16x16x32_bf16 a[188:191], v[76:79], v[36:39], 0
 ds_read_b128 v[44:47], v17 offset:14336
 v_mfma_f32_16x16x32_bf16 a[184:187], v[72:75], v[36:39], 0
 ds_read_b64_tr_b16 v[110:111], v16 offset:20992
 v_mfma_f32_16x16x32_bf16 a[180:183], v[68:71], v[36:39], 0
 v_mfma_f32_16x16x32_bf16 a[176:179], v[64:67], v[36:39], 0
 v_mfma_f32_16x16x32_bf16 a[172:175], v[60:63], v[36:39], 0
 buffer_load_dwordx4 v10, s[24:27], s70 offen offset:1024  lds
 v_mfma_f32_16x16x32_bf16 a[168:171], v[56:59], v[36:39], 0
 v_mfma_f32_16x16x32_bf16 a[164:167], v[52:55], v[36:39], 0
 v_mfma_f32_16x16x32_bf16 a[160:163], v[48:51], v[36:39], 0
 s_waitcnt lgkmcnt(5)
 v_mfma_f32_16x16x32_bf16 a[192:195], v[48:51], v[40:43], 0
 ds_read_b128 v[32:35], v18 offset:0
 v_mfma_f32_16x16x32_bf16 a[196:199], v[52:55], v[40:43], 0
 v_mfma_f32_16x16x32_bf16 a[200:203], v[56:59], v[40:43], 0
 v_mfma_f32_16x16x32_bf16 a[204:207], v[60:63], v[40:43], 0
 v_mfma_f32_16x16x32_bf16 a[208:211], v[64:67], v[40:43], 0
 buffer_load_dwordx4 v11, s[24:27], s70 offen offset:2048  lds
 v_mfma_f32_16x16x32_bf16 a[212:215], v[68:71], v[40:43], 0
 v_mfma_f32_16x16x32_bf16 a[216:219], v[72:75], v[40:43], 0
 v_mfma_f32_16x16x32_bf16 a[220:223], v[76:79], v[40:43], 0
 s_waitcnt lgkmcnt(2)
 v_mfma_f32_16x16x32_bf16 a[252:255], v[76:79], v[44:47], 0
 ds_read_b128 v[36:39], v18 offset:2048
 v_mfma_f32_16x16x32_bf16 a[248:251], v[72:75], v[44:47], 0
 v_mfma_f32_16x16x32_bf16 a[244:247], v[68:71], v[44:47], 0
 v_mfma_f32_16x16x32_bf16 a[240:243], v[64:67], v[44:47], 0
 v_mfma_f32_16x16x32_bf16 a[236:239], v[60:63], v[44:47], 0
 buffer_load_dwordx4 v12, s[24:27], s70 offen offset:3072  lds
 v_mfma_f32_16x16x32_bf16 a[232:235], v[56:59], v[44:47], 0
 v_mfma_f32_16x16x32_bf16 a[228:231], v[52:55], v[44:47], 0
 s_add_u32 s70, s70, s71
 v_mfma_f32_16x16x32_bf16 a[224:227], v[48:51], v[44:47], 0
 s_waitcnt vmcnt(12) lgkmcnt(1)
 v_mfma_f32_16x16x32_bf16 a[0:3], v[80:83], v[32:35], a[0:3]
 s_barrier
 ds_read_b128 v[40:43], v18 offset:4096
 v_mfma_f32_16x16x32_bf16 a[4:7], v[84:87], v[32:35], a[4:7]
 ds_read_b64_tr_b16 v[48:49], v13 offset:32768
 v_mfma_f32_16x16x32_bf16 a[8:11], v[88:91], v[32:35], a[8:11]
 s_add_u32 m0, s72, s77
 v_mfma_f32_16x16x32_bf16 a[12:15], v[92:95], v[32:35], a[12:15]
 ds_read_b64_tr_b16 v[50:51], v13 offset:33280
 v_mfma_f32_16x16x32_bf16 a[16:19], v[96:99], v[32:35], a[16:19]
 buffer_load_dwordx4 v5, s[20:23], s69 offen offset:0 lds
 v_mfma_f32_16x16x32_bf16 a[20:23], v[100:103], v[32:35], a[20:23]
 ds_read_b64_tr_b16 v[52:53], v14 offset:32768
 v_mfma_f32_16x16x32_bf16 a[24:27], v[104:107], v[32:35], a[24:27]
 v_mfma_f32_16x16x32_bf16 a[28:31], v[108:111], v[32:35], a[28:31]
 s_waitcnt lgkmcnt(4)
 v_mfma_f32_16x16x32_bf16 a[60:63], v[108:111], v[36:39], a[60:63]
 ds_read_b128 v[44:47], v18 offset:6144
 v_mfma_f32_16x16x32_bf16 a[56:59], v[104:107], v[36:39], a[56:59]
 ds_read_b64_tr_b16 v[54:55], v14 offset:33280
 v_mfma_f32_16x16x32_bf16 a[52:55], v[100:103], v[36:39], a[52:55]
 v_add_u32 v17, s74, v19
 v_mfma_f32_16x16x32_bf16 a[48:51], v[96:99], v[36:39], a[48:51]
 ds_read_b64_tr_b16 v[56:57], v15 offset:32768
 v_mfma_f32_16x16x32_bf16 a[44:47], v[92:95], v[36:39], a[44:47]
 buffer_load_dwordx4 v6, s[20:23], s69 offen offset:1024 lds
 v_mfma_f32_16x16x32_bf16 a[40:43], v[88:91], v[36:39], a[40:43]
 ds_read_b64_tr_b16 v[58:59], v15 offset:33280
 v_mfma_f32_16x16x32_bf16 a[36:39], v[84:87], v[36:39], a[36:39]
 v_mfma_f32_16x16x32_bf16 a[32:35], v[80:83], v[36:39], a[32:35]
 s_waitcnt lgkmcnt(7)
 v_mfma_f32_16x16x32_bf16 a[64:67], v[80:83], v[40:43], a[64:67]
 ds_read_b128 v[32:35], v18 offset:8192
 v_mfma_f32_16x16x32_bf16 a[68:71], v[84:87], v[40:43], a[68:71]
 ds_read_b64_tr_b16 v[60:61], v16 offset:32768
 v_mfma_f32_16x16x32_bf16 a[72:75], v[88:91], v[40:43], a[72:75]
 v_mfma_f32_16x16x32_bf16 a[76:79], v[92:95], v[40:43], a[76:79]
 ds_read_b64_tr_b16 v[62:63], v16 offset:33280
 v_mfma_f32_16x16x32_bf16 a[80:83], v[96:99], v[40:43], a[80:83]
 buffer_load_dwordx4 v7, s[20:23], s69 offen offset:2048 lds
 v_mfma_f32_16x16x32_bf16 a[84:87], v[100:103], v[40:43], a[84:87]
 ds_read_b64_tr_b16 v[64:65], v13 offset:36864
 v_mfma_f32_16x16x32_bf16 a[88:91], v[104:107], v[40:43], a[88:91]
 v_mfma_f32_16x16x32_bf16 a[92:95], v[108:111], v[40:43], a[92:95]
 s_waitcnt lgkmcnt(7)
 v_mfma_f32_16x16x32_bf16 a[124:127], v[108:111], v[44:47], a[124:127]
 ds_read_b128 v[36:39], v18 offset:10240
 v_mfma_f32_16x16x32_bf16 a[120:123], v[104:107], v[44:47], a[120:123]
 ds_read_b64_tr_b16 v[66:67], v13 offset:37376
 v_mfma_f32_16x16x32_bf16 a[116:119], v[100:103], v[44:47], a[116:119]
 v_mfma_f32_16x16x32_bf16 a[112:115], v[96:99], v[44:47], a[112:115]
 ds_read_b64_tr_b16 v[68:69], v14 offset:36864
 v_mfma_f32_16x16x32_bf16 a[108:111], v[92:95], v[44:47], a[108:111]
 buffer_load_dwordx4 v8, s[20:23], s69 offen offset:3072 lds
 v_mfma_f32_16x16x32_bf16 a[104:107], v[88:91], v[44:47], a[104:107]
 ds_read_b64_tr_b16 v[70:71], v14 offset:37376
 v_mfma_f32_16x16x32_bf16 a[100:103], v[84:87], v[44:47], a[100:103]
 s_add_u32 s69, s69, 128
 v_mfma_f32_16x16x32_bf16 a[96:99], v[80:83], v[44:47], a[96:99]
 s_waitcnt lgkmcnt(7)
 v_mfma_f32_16x16x32_bf16 a[128:131], v[80:83], v[32:35], a[128:131]
 ds_read_b128 v[40:43], v18 offset:12288
 v_mfma_f32_16x16x32_bf16 a[132:135], v[84:87], v[32:35], a[132:135]
 ds_read_b64_tr_b16 v[72:73], v15 offset:36864
 v_mfma_f32_16x16x32_bf16 a[136:139], v[88:91], v[32:35], a[136:139]
 s_add_u32 m0, s78, 16384
 v_mfma_f32_16x16x32_bf16 a[140:143], v[92:95], v[32:35], a[140:143]
 ds_read_b64_tr_b16 v[74:75], v15 offset:37376
 v_mfma_f32_16x16x32_bf16 a[144:147], v[96:99], v[32:35], a[144:147]
 buffer_load_dwordx4 v9, s[24:27], s70 offen offset:0  lds
 v_mfma_f32_16x16x32_bf16 a[148:151], v[100:103], v[32:35], a[148:151]
 ds_read_b64_tr_b16 v[76:77], v16 offset:36864
 v_mfma_f32_16x16x32_bf16 a[152:155], v[104:107], v[32:35], a[152:155]
 v_mfma_f32_16x16x32_bf16 a[156:159], v[108:111], v[32:35], a[156:159]
 s_waitcnt lgkmcnt(7)
 v_mfma_f32_16x16x32_bf16 a[188:191], v[108:111], v[36:39], a[188:191]
 ds_read_b128 v[44:47], v18 offset:14336
 v_mfma_f32_16x16x32_bf16 a[184:187], v[104:107], v[36:39], a[184:187]
 ds_read_b64_tr_b16 v[78:79], v16 offset:37376
 v_mfma_f32_16x16x32_bf16 a[180:183], v[100:103], v[36:39], a[180:183]
 v_mfma_f32_16x16x32_bf16 a[176:179], v[96:99], v[36:39], a[176:179]
 v_mfma_f32_16x16x32_bf16 a[172:175], v[92:95], v[36:39], a[172:175]
 buffer_load_dwordx4 v10, s[24:27], s70 offen offset:1024  lds
 v_mfma_f32_16x16x32_bf16 a[168:171], v[88:91], v[36:39], a[168:171]
 v_mfma_f32_16x16x32_bf16 a[164:167], v[84:87], v[36:39], a[164:167]
 v_mfma_f32_16x16x32_bf16 a[160:163], v[80:83], v[36:39], a[160:163]
 s_waitcnt lgkmcnt(5)
 v_mfma_f32_16x16x32_bf16 a[192:195], v[80:83], v[40:43], a[192:195]
 ds_read_b128 v[32:35], v17 offset:0
 v_mfma_f32_16x16x32_bf16 a[196:199], v[84:87], v[40:43], a[196:199]
 v_mfma_f32_16x16x32_bf16 a[200:203], v[88:91], v[40:43], a[200:203]
 s_mov_b32 s75, s72
 s_mov_b32 s72, s73
 v_mfma_f32_16x16x32_bf16 a[204:207], v[92:95], v[40:43], a[204:207]
 v_mfma_f32_16x16x32_bf16 a[208:211], v[96:99], v[40:43], a[208:211]
 buffer_load_dwordx4 v11, s[24:27], s70 offen offset:2048  lds
 v_mfma_f32_16x16x32_bf16 a[212:215], v[100:103], v[40:43], a[212:215]
 v_mfma_f32_16x16x32_bf16 a[216:219], v[104:107], v[40:43], a[216:219]
 v_mfma_f32_16x16x32_bf16 a[220:223], v[108:111], v[40:43], a[220:223]
 s_waitcnt lgkmcnt(2)
 v_mfma_f32_16x16x32_bf16 a[252:255], v[108:111], v[44:47], a[252:255]
 ds_read_b128 v[36:39], v17 offset:2048
 v_mfma_f32_16x16x32_bf16 a[248:251], v[104:107], v[44:47], a[248:251]
 v_mfma_f32_16x16x32_bf16 a[244:247], v[100:103], v[44:47], a[244:247]
 s_mov_b32 s73, s74
 s_mov_b32 s74, s75
 v_mfma_f32_16x16x32_bf16 a[240:243], v[96:99], v[44:47], a[240:243]
 v_mfma_f32_16x16x32_bf16 a[236:239], v[92:95], v[44:47], a[236:239]
 buffer_load_dwordx4 v12, s[24:27], s70 offen offset:3072  lds
 v_mfma_f32_16x16x32_bf16 a[232:235], v[88:91], v[44:47], a[232:235]
 v_mfma_f32_16x16x32_bf16 a[228:231], v[84:87], v[44:47], a[228:231]
 s_add_u32 s70, s70, s71
 v_mfma_f32_16x16x32_bf16 a[224:227], v[80:83], v[44:47], a[224:227]
 s_waitcnt vmcnt(16) lgkmcnt(1)
 v_mfma_f32_16x16x32_bf16 a[0:3], v[48:51], v[32:35], a[0:3]
 s_barrier
 ds_read_b128 v[40:43], v17 offset:4096
 v_mfma_f32_16x16x32_bf16 a[4:7], v[52:55], v[32:35], a[4:7]
 ds_read_b64_tr_b16 v[80:81], v13 offset:49152
 v_mfma_f32_16x16x32_bf16 a[8:11], v[56:59], v[32:35], a[8:11]
 s_add_u32 m0, s72, s76
 v_mfma_f32_16x16x32_bf16 a[12:15], v[60:63], v[32:35], a[12:15]
 ds_read_b64_tr_b16 v[82:83], v13 offset:49664
 v_mfma_f32_16x16x32_bf16 a[16:19], v[64:67], v[32:35], a[16:19]
 buffer_load_dwordx4 v1, s[20:23], s69 offen offset:0 lds
 v_mfma_f32_16x16x32_bf16 a[20:23], v[68:71], v[32:35], a[20:23]
 ds_read_b64_tr_b16 v[84:85], v14 offset:49152
 v_mfma_f32_16x16x32_bf16 a[24:27], v[72:75], v[32:35], a[24:27]
 v_mfma_f32_16x16x32_bf16 a[28:31], v[76:79], v[32:35], a[28:31]
 s_waitcnt lgkmcnt(4)
 v_mfma_f32_16x16x32_bf16 a[60:63], v[76:79], v[36:39], a[60:63]
 ds_read_b128 v[44:47], v17 offset:6144
 v_mfma_f32_16x16x32_bf16 a[56:59], v[72:75], v[36:39], a[56:59]
 ds_read_b64_tr_b16 v[86:87], v14 offset:49664
 v_mfma_f32_16x16x32_bf16 a[52:55], v[68:71], v[36:39], a[52:55]
 v_add_u32 v18, s73, v20
 v_mfma_f32_16x16x32_bf16 a[48:51], v[64:67], v[36:39], a[48:51]
 ds_read_b64_tr_b16 v[88:89], v15 offset:49152
 v_mfma_f32_16x16x32_bf16 a[44:47], v[60:63], v[36:39], a[44:47]
 buffer_load_dwordx4 v2, s[20:23], s69 offen offset:1024 lds
 v_mfma_f32_16x16x32_bf16 a[40:43], v[56:59], v[36:39], a[40:43]
 ds_read_b64_tr_b16 v[90:91], v15 offset:49664
 v_mfma_f32_16x16x32_bf16 a[36:39], v[52:55], v[36:39], a[36:39]
 v_mfma_f32_16x16x32_bf16 a[32:35], v[48:51], v[36:39], a[32:35]
 s_waitcnt lgkmcnt(7)
 v_mfma_f32_16x16x32_bf16 a[64:67], v[48:51], v[40:43], a[64:67]
 ds_read_b128 v[32:35], v17 offset:8192
 v_mfma_f32_16x16x32_bf16 a[68:71], v[52:55], v[40:43], a[68:71]
 ds_read_b64_tr_b16 v[92:93], v16 offset:49152
 v_mfma_f32_16x16x32_bf16 a[72:75], v[56:59], v[40:43], a[72:75]
 v_mfma_f32_16x16x32_bf16 a[76:79], v[60:63], v[40:43], a[76:79]
 ds_read_b64_tr_b16 v[94:95], v16 offset:49664
 v_mfma_f32_16x16x32_bf16 a[80:83], v[64:67], v[40:43], a[80:83]
 buffer_load_dwordx4 v3, s[20:23], s69 offen offset:2048 lds
 v_mfma_f32_16x16x32_bf16 a[84:87], v[68:71], v[40:43], a[84:87]
 ds_read_b64_tr_b16 v[96:97], v13 offset:53248
 v_mfma_f32_16x16x32_bf16 a[88:91], v[72:75], v[40:43], a[88:91]
 v_mfma_f32_16x16x32_bf16 a[92:95], v[76:79], v[40:43], a[92:95]
 s_waitcnt lgkmcnt(7)
 v_mfma_f32_16x16x32_bf16 a[124:127], v[76:79], v[44:47], a[124:127]
 ds_read_b128 v[36:39], v17 offset:10240
 v_mfma_f32_16x16x32_bf16 a[120:123], v[72:75], v[44:47], a[120:123]
 ds_read_b64_tr_b16 v[98:99], v13 offset:53760
 v_mfma_f32_16x16x32_bf16 a[116:119], v[68:71], v[44:47], a[116:119]
 v_mfma_f32_16x16x32_bf16 a[112:115], v[64:67], v[44:47], a[112:115]
 ds_read_b64_tr_b16 v[100:101], v14 offset:53248
 v_mfma_f32_16x16x32_bf16 a[108:111], v[60:63], v[44:47], a[108:111]
 buffer_load_dwordx4 v4, s[20:23], s69 offen offset:3072 lds
 v_mfma_f32_16x16x32_bf16 a[104:107], v[56:59], v[44:47], a[104:107]
 ds_read_b64_tr_b16 v[102:103], v14 offset:53760
 v_mfma_f32_16x16x32_bf16 a[100:103], v[52:55], v[44:47], a[100:103]
 v_mfma_f32_16x16x32_bf16 a[96:99], v[48:51], v[44:47], a[96:99]
 s_waitcnt lgkmcnt(7)
 v_mfma_f32_16x16x32_bf16 a[128:131], v[48:51], v[32:35], a[128:131]
 ds_read_b128 v[40:43], v17 offset:12288
 v_mfma_f32_16x16x32_bf16 a[132:135], v[52:55], v[32:35], a[132:135]
 ds_read_b64_tr_b16 v[104:105], v15 offset:53248
 v_mfma_f32_16x16x32_bf16 a[136:139], v[56:59], v[32:35], a[136:139]
 s_add_u32 m0, s78, 32768
 v_mfma_f32_16x16x32_bf16 a[140:143], v[60:63], v[32:35], a[140:143]
 ds_read_b64_tr_b16 v[106:107], v15 offset:53760
 v_mfma_f32_16x16x32_bf16 a[144:147], v[64:67], v[32:35], a[144:147]
 buffer_load_dwordx4 v9, s[24:27], s70 offen offset:0  lds
 v_mfma_f32_16x16x32_bf16 a[148:151], v[68:71], v[32:35], a[148:151]
 ds_read_b64_tr_b16 v[108:109], v16 offset:53248
 v_mfma_f32_16x16x32_bf16 a[152:155], v[72:75], v[32:35], a[152:155]
 v_mfma_f32_16x16x32_bf16 a[156:159], v[76:79], v[32:35], a[156:159]
 s_waitcnt lgkmcnt(7)
 v_mfma_f32_16x16x32_bf16 a[188:191], v[76:79], v[36:39], a[188:191]
 ds_read_b128 v[44:47], v17 offset:14336
 v_mfma_f32_16x16x32_bf16 a[184:187], v[72:75], v[36:39], a[184:187]
 ds_read_b64_tr_b16 v[110:111], v16 offset:53760
 v_mfma_f32_16x16x32_bf16 a[180:183], v[68:71], v[36:39], a[180:183]
 v_mfma_f32_16x16x32_bf16 a[176:179], v[64:67], v[36:39], a[176:179]
 v_mfma_f32_16x16x32_bf16 a[172:175], v[60:63], v[36:39], a[172:175]
 buffer_load_dwordx4 v10, s[24:27], s70 offen offset:1024  lds
 v_mfma_f32_16x16x32_bf16 a[168:171], v[56:59], v[36:39], a[168:171]
 v_mfma_f32_16x16x32_bf16 a[164:167], v[52:55], v[36:39], a[164:167]
 v_mfma_f32_16x16x32_bf16 a[160:163], v[48:51], v[36:39], a[160:163]
 s_waitcnt lgkmcnt(5)
 v_mfma_f32_16x16x32_bf16 a[192:195], v[48:51], v[40:43], a[192:195]
 ds_read_b128 v[32:35], v18 offset:0
 v_mfma_f32_16x16x32_bf16 a[196:199], v[52:55], v[40:43], a[196:199]
 v_mfma_f32_16x16x32_bf16 a[200:203], v[56:59], v[40:43], a[200:203]
 v_mfma_f32_16x16x32_bf16 a[204:207], v[60:63], v[40:43], a[204:207]
 v_mfma_f32_16x16x32_bf16 a[208:211], v[64:67], v[40:43], a[208:211]
 buffer_load_dwordx4 v11, s[24:27], s70 offen offset:2048  lds
 v_mfma_f32_16x16x32_bf16 a[212:215], v[68:71], v[40:43], a[212:215]
 v_mfma_f32_16x16x32_bf16 a[216:219], v[72:75], v[40:43], a[216:219]
 v_mfma_f32_16x16x32_bf16 a[220:223], v[76:79], v[40:43], a[220:223]
 s_waitcnt lgkmcnt(2)
 v_mfma_f32_16x16x32_bf16 a[252:255], v[76:79], v[44:47], a[252:255]
 ds_read_b128 v[36:39], v18 offset:2048
 v_mfma_f32_16x16x32_bf16 a[248:251], v[72:75], v[44:47], a[248:251]
 v_mfma_f32_16x16x32_bf16 a[244:247], v[68:71], v[44:47], a[244:247]
 v_mfma_f32_16x16x32_bf16 a[240:243], v[64:67], v[44:47], a[240:243]
 v_mfma_f32_16x16x32_bf16 a[236:239], v[60:63], v[44:47], a[236:239]
 buffer_load_dwordx4 v12, s[24:27], s70 offen offset:3072  lds
 v_mfma_f32_16x16x32_bf16 a[232:235], v[56:59], v[44:47], a[232:235]
 v_mfma_f32_16x16x32_bf16 a[228:231], v[52:55], v[44:47], a[228:231]
 s_add_u32 s70, s70, s71
 v_mfma_f32_16x16x32_bf16 a[224:227], v[48:51], v[44:47], a[224:227]
 s_waitcnt vmcnt(12) lgkmcnt(1)
 v_mfma_f32_16x16x32_bf16 a[0:3], v[80:83], v[32:35], a[0:3]
 s_barrier
 ds_read_b128 v[40:43], v18 offset:4096
 v_mfma_f32_16x16x32_bf16 a[4:7], v[84:87], v[32:35], a[4:7]
 ds_read_b64_tr_b16 v[48:49], v13 offset:0
 v_mfma_f32_16x16x32_bf16 a[8:11], v[88:91], v[32:35], a[8:11]
 s_add_u32 m0, s72, s77
 v_mfma_f32_16x16x32_bf16 a[12:15], v[92:95], v[32:35], a[12:15]
 ds_read_b64_tr_b16 v[50:51], v13 offset:512
 v_mfma_f32_16x16x32_bf16 a[16:19], v[96:99], v[32:35], a[16:19]
 buffer_load_dwordx4 v5, s[20:23], s69 offen offset:0 lds
 v_mfma_f32_16x16x32_bf16 a[20:23], v[100:103], v[32:35], a[20:23]
 ds_read_b64_tr_b16 v[52:53], v14 offset:0
 v_mfma_f32_16x16x32_bf16 a[24:27], v[104:107], v[32:35], a[24:27]
 v_mfma_f32_16x16x32_bf16 a[28:31], v[108:111], v[32:35], a[28:31]
 s_waitcnt lgkmcnt(4)
 v_mfma_f32_16x16x32_bf16 a[60:63], v[108:111], v[36:39], a[60:63]
 ds_read_b128 v[44:47], v18 offset:6144
 v_mfma_f32_16x16x32_bf16 a[56:59], v[104:107], v[36:39], a[56:59]
 ds_read_b64_tr_b16 v[54:55], v14 offset:512
 v_mfma_f32_16x16x32_bf16 a[52:55], v[100:103], v[36:39], a[52:55]
 v_add_u32 v17, s74, v19
 v_mfma_f32_16x16x32_bf16 a[48:51], v[96:99], v[36:39], a[48:51]
 ds_read_b64_tr_b16 v[56:57], v15 offset:0
 v_mfma_f32_16x16x32_bf16 a[44:47], v[92:95], v[36:39], a[44:47]
 buffer_load_dwordx4 v6, s[20:23], s69 offen offset:1024 lds
 v_mfma_f32_16x16x32_bf16 a[40:43], v[88:91], v[36:39], a[40:43]
 ds_read_b64_tr_b16 v[58:59], v15 offset:512
 v_mfma_f32_16x16x32_bf16 a[36:39], v[84:87], v[36:39], a[36:39]
 v_mfma_f32_16x16x32_bf16 a[32:35], v[80:83], v[36:39], a[32:35]
 s_waitcnt lgkmcnt(7)
 v_mfma_f32_16x16x32_bf16 a[64:67], v[80:83], v[40:43], a[64:67]
 ds_read_b128 v[32:35], v18 offset:8192
 v_mfma_f32_16x16x32_bf16 a[68:71], v[84:87], v[40:43], a[68:71]
 ds_read_b64_tr_b16 v[60:61], v16 offset:0
 v_mfma_f32_16x16x32_bf16 a[72:75], v[88:91], v[40:43], a[72:75]
 v_mfma_f32_16x16x32_bf16 a[76:79], v[92:95], v[40:43], a[76:79]
 ds_read_b64_tr_b16 v[62:63], v16 offset:512
 v_mfma_f32_16x16x32_bf16 a[80:83], v[96:99], v[40:43], a[80:83]
 buffer_load_dwordx4 v7, s[20:23], s69 offen offset:2048 lds
 v_mfma_f32_16x16x32_bf16 a[84:87], v[100:103], v[40:43], a[84:87]
 ds_read_b64_tr_b16 v[64:65], v13 offset:4096
 v_mfma_f32_16x16x32_bf16 a[88:91], v[104:107], v[40:43], a[88:91]
 v_mfma_f32_16x16x32_bf16 a[92:95], v[108:111], v[40:43], a[92:95]
 s_waitcnt lgkmcnt(7)
 v_mfma_f32_16x16x32_bf16 a[124:127], v[108:111], v[44:47], a[124:127]
 ds_read_b128 v[36:39], v18 offset:10240
 v_mfma_f32_16x16x32_bf16 a[120:123], v[104:107], v[44:47], a[120:123]
 ds_read_b64_tr_b16 v[66:67], v13 offset:4608
 v_mfma_f32_16x16x32_bf16 a[116:119], v[100:103], v[44:47], a[116:119]
 v_mfma_f32_16x16x32_bf16 a[112:115], v[96:99], v[44:47], a[112:115]
 ds_read_b64_tr_b16 v[68:69], v14 offset:4096
 v_mfma_f32_16x16x32_bf16 a[108:111], v[92:95], v[44:47], a[108:111]
 buffer_load_dwordx4 v8, s[20:23], s69 offen offset:3072 lds
 v_mfma_f32_16x16x32_bf16 a[104:107], v[88:91], v[44:47], a[104:107]
 ds_read_b64_tr_b16 v[70:71], v14 offset:4608
 v_mfma_f32_16x16x32_bf16 a[100:103], v[84:87], v[44:47], a[100:103]
 s_add_u32 s69, s69, 128
 v_mfma_f32_16x16x32_bf16 a[96:99], v[80:83], v[44:47], a[96:99]
 s_waitcnt lgkmcnt(7)
 v_mfma_f32_16x16x32_bf16 a[128:131], v[80:83], v[32:35], a[128:131]
 ds_read_b128 v[40:43], v18 offset:12288
 v_mfma_f32_16x16x32_bf16 a[132:135], v[84:87], v[32:35], a[132:135]
 ds_read_b64_tr_b16 v[72:73], v15 offset:4096
 v_mfma_f32_16x16x32_bf16 a[136:139], v[88:91], v[32:35], a[136:139]
 s_add_u32 m0, s78, 49152
 v_mfma_f32_16x16x32_bf16 a[140:143], v[92:95], v[32:35], a[140:143]
 ds_read_b64_tr_b16 v[74:75], v15 offset:4608
 v_mfma_f32_16x16x32_bf16 a[144:147], v[96:99], v[32:35], a[144:147]
 buffer_load_dwordx4 v9, s[24:27], s70 offen offset:0  lds
 v_mfma_f32_16x16x32_bf16 a[148:151], v[100:103], v[32:35], a[148:151]
 ds_read_b64_tr_b16 v[76:77], v16 offset:4096
 v_mfma_f32_16x16x32_bf16 a[152:155], v[104:107], v[32:35], a[152:155]
 v_mfma_f32_16x16x32_bf16 a[156:159], v[108:111], v[32:35], a[156:159]
 s_waitcnt lgkmcnt(7)
 v_mfma_f32_16x16x32_bf16 a[188:191], v[108:111], v[36:39], a[188:191]
 ds_read_b128 v[44:47], v18 offset:14336
 v_mfma_f32_16x16x32_bf16 a[184:187], v[104:107], v[36:39], a[184:187]
 ds_read_b64_tr_b16 v[78:79], v16 offset:4608
 v_mfma_f32_16x16x32_bf16 a[180:183], v[100:103], v[36:39], a[180:183]
 v_mfma_f32_16x16x32_bf16 a[176:179], v[96:99], v[36:39], a[176:179]
 v_mfma_f32_16x16x32_bf16 a[172:175], v[92:95], v[36:39], a[172:175]
 buffer_load_dwordx4 v10, s[24:27], s70 offen offset:1024  lds
 v_mfma_f32_16x16x32_bf16 a[168:171], v[88:91], v[36:39], a[168:171]
 v_mfma_f32_16x16x32_bf16 a[164:167], v[84:87], v[36:39], a[164:167]
 v_mfma_f32_16x16x32_bf16 a[160:163], v[80:83], v[36:39], a[160:163]
 s_waitcnt lgkmcnt(5)
 v_mfma_f32_16x16x32_bf16 a[192:195], v[80:83], v[40:43], a[192:195]
 ds_read_b128 v[32:35], v17 offset:0
 v_mfma_f32_16x16x32_bf16 a[196:199], v[84:87], v[40:43], a[196:199]
 v_mfma_f32_16x16x32_bf16 a[200:203], v[88:91], v[40:43], a[200:203]
 s_mov_b32 s75, s72
 s_mov_b32 s72, s73
 v_mfma_f32_16x16x32_bf16 a[204:207], v[92:95], v[40:43], a[204:207]
 v_mfma_f32_16x16x32_bf16 a[208:211], v[96:99], v[40:43], a[208:211]
 buffer_load_dwordx4 v11, s[24:27], s70 offen offset:2048  lds
 v_mfma_f32_16x16x32_bf16 a[212:215], v[100:103], v[40:43], a[212:215]
 v_mfma_f32_16x16x32_bf16 a[216:219], v[104:107], v[40:43], a[216:219]
 v_mfma_f32_16x16x32_bf16 a[220:223], v[108:111], v[40:43], a[220:223]
 s_waitcnt lgkmcnt(2)
 v_mfma_f32_16x16x32_bf16 a[252:255], v[108:111], v[44:47], a[252:255]
 ds_read_b128 v[36:39], v17 offset:2048
 v_mfma_f32_16x16x32_bf16 a[248:251], v[104:107], v[44:47], a[248:251]
 v_mfma_f32_16x16x32_bf16 a[244:247], v[100:103], v[44:47], a[244:247]
 s_mov_b32 s73, s74
 s_mov_b32 s74, s75
 v_mfma_f32_16x16x32_bf16 a[240:243], v[96:99], v[44:47], a[240:243]
 v_mfma_f32_16x16x32_bf16 a[236:239], v[92:95], v[44:47], a[236:239]
 buffer_load_dwordx4 v12, s[24:27], s70 offen offset:3072  lds
 v_mfma_f32_16x16x32_bf16 a[232:235], v[88:91], v[44:47], a[232:235]
 v_mfma_f32_16x16x32_bf16 a[228:231], v[84:87], v[44:47], a[228:231]
 s_add_u32 s70, s70, s71
 v_mfma_f32_16x16x32_bf16 a[224:227], v[80:83], v[44:47], a[224:227]
 s_waitcnt vmcnt(16) lgkmcnt(1)
 v_mfma_f32_16x16x32_bf16 a[0:3], v[48:51], v[32:35], a[0:3]
 s_barrier
 ds_read_b128 v[40:43], v17 offset:4096
 v_mfma_f32_16x16x32_bf16 a[4:7], v[52:55], v[32:35], a[4:7]
 ds_read_b64_tr_b16 v[80:81], v13 offset:16384
 v_mfma_f32_16x16x32_bf16 a[8:11], v[56:59], v[32:35], a[8:11]
 s_add_u32 m0, s72, s76
 v_mfma_f32_16x16x32_bf16 a[12:15], v[60:63], v[32:35], a[12:15]
 ds_read_b64_tr_b16 v[82:83], v13 offset:16896
 v_mfma_f32_16x16x32_bf16 a[16:19], v[64:67], v[32:35], a[16:19]
 buffer_load_dwordx4 v1, s[20:23], s69 offen offset:0 lds
 v_mfma_f32_16x16x32_bf16 a[20:23], v[68:71], v[32:35], a[20:23]
 ds_read_b64_tr_b16 v[84:85], v14 offset:16384
 v_mfma_f32_16x16x32_bf16 a[24:27], v[72:75], v[32:35], a[24:27]
 v_mfma_f32_16x16x32_bf16 a[28:31], v[76:79], v[32:35], a[28:31]
 s_waitcnt lgkmcnt(4)
 v_mfma_f32_16x16x32_bf16 a[60:63], v[76:79], v[36:39], a[60:63]
 ds_read_b128 v[44:47], v17 offset:6144
 v_mfma_f32_16x16x32_bf16 a[56:59], v[72:75], v[36:39], a[56:59]
 ds_read_b64_tr_b16 v[86:87], v14 offset:16896
 v_mfma_f32_16x16x32_bf16 a[52:55], v[68:71], v[36:39], a[52:55]
 v_add_u32 v18, s73, v20
 v_mfma_f32_16x16x32_bf16 a[48:51], v[64:67], v[36:39], a[48:51]
 ds_read_b64_tr_b16 v[88:89], v15 offset:16384
 v_mfma_f32_16x16x32_bf16 a[44:47], v[60:63], v[36:39], a[44:47]
 buffer_load_dwordx4 v2, s[20:23], s69 offen offset:1024 lds
 v_mfma_f32_16x16x32_bf16 a[40:43], v[56:59], v[36:39], a[40:43]
 ds_read_b64_tr_b16 v[90:91], v15 offset:16896
 v_mfma_f32_16x16x32_bf16 a[36:39], v[52:55], v[36:39], a[36:39]
 v_mfma_f32_16x16x32_bf16 a[32:35], v[48:51], v[36:39], a[32:35]
 s_waitcnt lgkmcnt(7)
 v_mfma_f32_16x16x32_bf16 a[64:67], v[48:51], v[40:43], a[64:67]
 ds_read_b128 v[32:35], v17 offset:8192
 v_mfma_f32_16x16x32_bf16 a[68:71], v[52:55], v[40:43], a[68:71]
 ds_read_b64_tr_b16 v[92:93], v16 offset:16384
 v_mfma_f32_16x16x32_bf16 a[72:75], v[56:59], v[40:43], a[72:75]
 v_mfma_f32_16x16x32_bf16 a[76:79], v[60:63], v[40:43], a[76:79]
 ds_read_b64_tr_b16 v[94:95], v16 offset:16896
 v_mfma_f32_16x16x32_bf16 a[80:83], v[64:67], v[40:43], a[80:83]
 buffer_load_dwordx4 v3, s[20:23], s69 offen offset:2048 lds
 v_mfma_f32_16x16x32_bf16 a[84:87], v[68:71], v[40:43], a[84:87]
 ds_read_b64_tr_b16 v[96:97], v13 offset:20480
 v_mfma_f32_16x16x32_bf16 a[88:91], v[72:75], v[40:43], a[88:91]
 v_mfma_f32_16x16x32_bf16 a[92:95], v[76:79], v[40:43], a[92:95]
 s_waitcnt lgkmcnt(7)
 v_mfma_f32_16x16x32_bf16 a[124:127], v[76:79], v[44:47], a[124:127]
 ds_read_b128 v[36:39], v17 offset:10240
 v_mfma_f32_16x16x32_bf16 a[120:123], v[72:75], v[44:47], a[120:123]
 ds_read_b64_tr_b16 v[98:99], v13 offset:20992
 v_mfma_f32_16x16x32_bf16 a[116:119], v[68:71], v[44:47], a[116:119]
 v_mfma_f32_16x16x32_bf16 a[112:115], v[64:67], v[44:47], a[112:115]
 ds_read_b64_tr_b16 v[100:101], v14 offset:20480
 v_mfma_f32_16x16x32_bf16 a[108:111], v[60:63], v[44:47], a[108:111]
 buffer_load_dwordx4 v4, s[20:23], s69 offen offset:3072 lds
 v_mfma_f32_16x16x32_bf16 a[104:107], v[56:59], v[44:47], a[104:107]
 ds_read_b64_tr_b16 v[102:103], v14 offset:20992
 v_mfma_f32_16x16x32_bf16 a[100:103], v[52:55], v[44:47], a[100:103]
 v_mfma_f32_16x16x32_bf16 a[96:99], v[48:51], v[44:47], a[96:99]
 s_waitcnt lgkmcnt(7)
 v_mfma_f32_16x16x32_bf16 a[128:131], v[48:51], v[32:35], a[128:131]
 ds_read_b128 v[40:43], v17 offset:12288
 v_mfma_f32_16x16x32_bf16 a[132:135], v[52:55], v[32:35], a[132:135]
 ds_read_b64_tr_b16 v[104:105], v15 offset:20480
 v_mfma_f32_16x16x32_bf16 a[136:139], v[56:59], v[32:35], a[136:139]
 s_add_u32 m0, s78, 0
 v_mfma_f32_16x16x32_bf16 a[140:143], v[60:63], v[32:35], a[140:143]
 ds_read_b64_tr_b16 v[106:107], v15 offset:20992
 v_mfma_f32_16x16x32_bf16 a[144:147], v[64:67], v[32:35], a[144:147]
 buffer_load_dwordx4 v9, s[24:27], s70 offen offset:0  lds
 v_mfma_f32_16x16x32_bf16 a[148:151], v[68:71], v[32:35], a[148:151]
 ds_read_b64_tr_b16 v[108:109], v16 offset:20480
 v_mfma_f32_16x16x32_bf16 a[152:155], v[72:75], v[32:35], a[152:155]
 v_mfma_f32_16x16x32_bf16 a[156:159], v[76:79], v[32:35], a[156:159]
 s_waitcnt lgkmcnt(7)
 v_mfma_f32_16x16x32_bf16 a[188:191], v[76:79], v[36:39], a[188:191]
 ds_read_b128 v[44:47], v17 offset:14336
 v_mfma_f32_16x16x32_bf16 a[184:187], v[72:75], v[36:39], a[184:187]
 ds_read_b64_tr_b16 v[110:111], v16 offset:20992
 v_mfma_f32_16x16x32_bf16 a[180:183], v[68:71], v[36:39], a[180:183]
 v_mfma_f32_16x16x32_bf16 a[176:179], v[64:67], v[36:39], a[176:179]
 v_mfma_f32_16x16x32_bf16 a[172:175], v[60:63], v[36:39], a[172:175]
 buffer_load_dwordx4 v10, s[24:27], s70 offen offset:1024  lds
 v_mfma_f32_16x16x32_bf16 a[168:171], v[56:59], v[36:39], a[168:171]
 v_mfma_f32_16x16x32_bf16 a[164:167], v[52:55], v[36:39], a[164:167]
 v_mfma_f32_16x16x32_bf16 a[160:163], v[48:51], v[36:39], a[160:163]
 s_waitcnt lgkmcnt(5)
 v_mfma_f32_16x16x32_bf16 a[192:195], v[48:51], v[40:43], a[192:195]
 ds_read_b128 v[32:35], v18 offset:0
 v_mfma_f32_16x16x32_bf16 a[196:199], v[52:55], v[40:43], a[196:199]
 v_mfma_f32_16x16x32_bf16 a[200:203], v[56:59], v[40:43], a[200:203]
 v_mfma_f32_16x16x32_bf16 a[204:207], v[60:63], v[40:43], a[204:207]
 v_mfma_f32_16x16x32_bf16 a[208:211], v[64:67], v[40:43], a[208:211]
 buffer_load_dwordx4 v11, s[24:27], s70 offen offset:2048  lds
 v_mfma_f32_16x16x32_bf16 a[212:215], v[68:71], v[40:43], a[212:215]
 v_mfma_f32_16x16x32_bf16 a[216:219], v[72:75], v[40:43], a[216:219]
 v_mfma_f32_16x16x32_bf16 a[220:223], v[76:79], v[40:43], a[220:223]
 s_waitcnt lgkmcnt(2)
 v_mfma_f32_16x16x32_bf16 a[252:255], v[76:79], v[44:47], a[252:255]
 ds_read_b128 v[36:39], v18 offset:2048
 v_mfma_f32_16x16x32_bf16 a[248:251], v[72:75], v[44:47], a[248:251]
 v_mfma_f32_16x16x32_bf16 a[244:247], v[68:71], v[44:47], a[244:247]
 v_mfma_f32_16x16x32_bf16 a[240:243], v[64:67], v[44:47], a[240:243]
 v_mfma_f32_16x16x32_bf16 a[236:239], v[60:63], v[44:47], a[236:239]
 buffer_load_dwordx4 v12, s[24:27], s70 offen offset:3072  lds
 v_mfma_f32_16x16x32_bf16 a[232:235], v[56:59], v[44:47], a[232:235]
 v_mfma_f32_16x16x32_bf16 a[228:231], v[52:55], v[44:47], a[228:231]
 s_add_u32 s70, s70, s71
 v_mfma_f32_16x16x32_bf16 a[224:227], v[48:51], v[44:47], a[224:227]
 s_waitcnt vmcnt(12) lgkmcnt(1)
 v_mfma_f32_16x16x32_bf16 a[0:3], v[80:83], v[32:35], a[0:3]
 s_barrier
 ds_read_b128 v[40:43], v18 offset:4096
 v_mfma_f32_16x16x32_bf16 a[4:7], v[84:87], v[32:35], a[4:7]
 ds_read_b64_tr_b16 v[48:49], v13 offset:32768
 v_mfma_f32_16x16x32_bf16 a[8:11], v[88:91], v[32:35], a[8:11]
 s_add_u32 m0, s72, s77
 v_mfma_f32_16x16x32_bf16 a[12:15], v[92:95], v[32:35], a[12:15]
 ds_read_b64_tr_b16 v[50:51], v13 offset:33280
 v_mfma_f32_16x16x32_bf16 a[16:19], v[96:99], v[32:35], a[16:19]
 buffer_load_dwordx4 v5, s[20:23], s69 offen offset:0 lds
 v_mfma_f32_16x16x32_bf16 a[20:23], v[100:103], v[32:35], a[20:23]
 ds_read_b64_tr_b16 v[52:53], v14 offset:32768
 v_mfma_f32_16x16x32_bf16 a[24:27], v[104:107], v[32:35], a[24:27]
 v_mfma_f32_16x16x32_bf16 a[28:31], v[108:111], v[32:35], a[28:31]
 s_waitcnt lgkmcnt(4)
 v_mfma_f32_16x16x32_bf16 a[60:63], v[108:111], v[36:39], a[60:63]
 ds_read_b128 v[44:47], v18 offset:6144
 v_mfma_f32_16x16x32_bf16 a[56:59], v[104:107], v[36:39], a[56:59]
 ds_read_b64_tr_b16 v[54:55], v14 offset:33280
 v_mfma_f32_16x16x32_bf16 a[52:55], v[100:103], v[36:39], a[52:55]
 v_add_u32 v17, s74, v19
 v_mfma_f32_16x16x32_bf16 a[48:51], v[96:99], v[36:39], a[48:51]
 ds_read_b64_tr_b16 v[56:57], v15 offset:32768
 v_mfma_f32_16x16x32_bf16 a[44:47], v[92:95], v[36:39], a[44:47]
 buffer_load_dwordx4 v6, s[20:23], s69 offen offset:1024 lds
 v_mfma_f32_16x16x32_bf16 a[40:43], v[88:91], v[36:39], a[40:43]
 ds_read_b64_tr_b16 v[58:59], v15 offset:33280
 v_mfma_f32_16x16x32_bf16 a[36:39], v[84:87], v[36:39], a[36:39]
 v_mfma_f32_16x16x32_bf16 a[32:35], v[80:83], v[36:39], a[32:35]
 s_waitcnt lgkmcnt(7)
 v_mfma_f32_16x16x32_bf16 a[64:67], v[80:83], v[40:43], a[64:67]
 ds_read_b128 v[32:35], v18 offset:8192
 v_mfma_f32_16x16x32_bf16 a[68:71], v[84:87], v[40:43], a[68:71]
 ds_read_b64_tr_b16 v[60:61], v16 offset:32768
 v_mfma_f32_16x16x32_bf16 a[72:75], v[88:91], v[40:43], a[72:75]
 v_mfma_f32_16x16x32_bf16 a[76:79], v[92:95], v[40:43], a[76:79]
 ds_read_b64_tr_b16 v[62:63], v16 offset:33280
 v_mfma_f32_16x16x32_bf16 a[80:83], v[96:99], v[40:43], a[80:83]
 buffer_load_dwordx4 v7, s[20:23], s69 offen offset:2048 lds
 v_mfma_f32_16x16x32_bf16 a[84:87], v[100:103], v[40:43], a[84:87]
 ds_read_b64_tr_b16 v[64:65], v13 offset:36864
 v_mfma_f32_16x16x32_bf16 a[88:91], v[104:107], v[40:43], a[88:91]
 v_mfma_f32_16x16x32_bf16 a[92:95], v[108:111], v[40:43], a[92:95]
 s_waitcnt lgkmcnt(7)
 v_mfma_f32_16x16x32_bf16 a[124:127], v[108:111], v[44:47], a[124:127]
 ds_read_b128 v[36:39], v18 offset:10240
 v_mfma_f32_16x16x32_bf16 a[120:123], v[104:107], v[44:47], a[120:123]
 ds_read_b64_tr_b16 v[66:67], v13 offset:37376
 v_mfma_f32_16x16x32_bf16 a[116:119], v[100:103], v[44:47], a[116:119]
 v_mfma_f32_16x16x32_bf16 a[112:115], v[96:99], v[44:47], a[112:115]
 ds_read_b64_tr_b16 v[68:69], v14 offset:36864
 v_mfma_f32_16x16x32_bf16 a[108:111], v[92:95], v[44:47], a[108:111]
 buffer_load_dwordx4 v8, s[20:23], s69 offen offset:3072 lds
 v_mfma_f32_16x16x32_bf16 a[104:107], v[88:91], v[44:47], a[104:107]
 ds_read_b64_tr_b16 v[70:71], v14 offset:37376
 v_mfma_f32_16x16x32_bf16 a[100:103], v[84:87], v[44:47], a[100:103]
 s_add_u32 s69, s69, 128
 v_mfma_f32_16x16x32_bf16 a[96:99], v[80:83], v[44:47], a[96:99]
 s_waitcnt lgkmcnt(7)
 v_mfma_f32_16x16x32_bf16 a[128:131], v[80:83], v[32:35], a[128:131]
 ds_read_b128 v[40:43], v18 offset:12288
 v_mfma_f32_16x16x32_bf16 a[132:135], v[84:87], v[32:35], a[132:135]
 ds_read_b64_tr_b16 v[72:73], v15 offset:36864
 v_mfma_f32_16x16x32_bf16 a[136:139], v[88:91], v[32:35], a[136:139]
 s_add_u32 m0, s78, 16384
 v_mfma_f32_16x16x32_bf16 a[140:143], v[92:95], v[32:35], a[140:143]
 ds_read_b64_tr_b16 v[74:75], v15 offset:37376
 v_mfma_f32_16x16x32_bf16 a[144:147], v[96:99], v[32:35], a[144:147]
 buffer_load_dwordx4 v9, s[24:27], s70 offen offset:0  lds
 v_mfma_f32_16x16x32_bf16 a[148:151], v[100:103], v[32:35], a[148:151]
 ds_read_b64_tr_b16 v[76:77], v16 offset:36864
 v_mfma_f32_16x16x32_bf16 a[152:155], v[104:107], v[32:35], a[152:155]
 v_mfma_f32_16x16x32_bf16 a[156:159], v[108:111], v[32:35], a[156:159]
 s_waitcnt lgkmcnt(7)
 v_mfma_f32_16x16x32_bf16 a[188:191], v[108:111], v[36:39], a[188:191]
 ds_read_b128 v[44:47], v18 offset:14336
 v_mfma_f32_16x16x32_bf16 a[184:187], v[104:107], v[36:39], a[184:187]
 ds_read_b64_tr_b16 v[78:79], v16 offset:37376
 v_mfma_f32_16x16x32_bf16 a[180:183], v[100:103], v[36:39], a[180:183]
 v_mfma_f32_16x16x32_bf16 a[176:179], v[96:99], v[36:39], a[176:179]
 v_mfma_f32_16x16x32_bf16 a[172:175], v[92:95], v[36:39], a[172:175]
 buffer_load_dwordx4 v10, s[24:27], s70 offen offset:1024  lds
 v_mfma_f32_16x16x32_bf16 a[168:171], v[88:91], v[36:39], a[168:171]
 v_mfma_f32_16x16x32_bf16 a[164:167], v[84:87], v[36:39], a[164:167]
 v_mfma_f32_16x16x32_bf16 a[160:163], v[80:83], v[36:39], a[160:163]
 s_waitcnt lgkmcnt(5)
 v_mfma_f32_16x16x32_bf16 a[192:195], v[80:83], v[40:43], a[192:195]
 ds_read_b128 v[32:35], v17 offset:0
 v_mfma_f32_16x16x32_bf16 a[196:199], v[84:87], v[40:43], a[196:199]
 v_mfma_f32_16x16x32_bf16 a[200:203], v[88:91], v[40:43], a[200:203]
 s_mov_b32 s75, s72
 s_mov_b32 s72, s73
 v_mfma_f32_16x16x32_bf16 a[204:207], v[92:95], v[40:43], a[204:207]
 v_mfma_f32_16x16x32_bf16 a[208:211], v[96:99], v[40:43], a[208:211]
 buffer_load_dwordx4 v11, s[24:27], s70 offen offset:2048  lds
 v_mfma_f32_16x16x32_bf16 a[212:215], v[100:103], v[40:43], a[212:215]
 v_mfma_f32_16x16x32_bf16 a[216:219], v[104:107], v[40:43], a[216:219]
 v_mfma_f32_16x16x32_bf16 a[220:223], v[108:111], v[40:43], a[220:223]
 s_waitcnt lgkmcnt(2)
 v_mfma_f32_16x16x32_bf16 a[252:255], v[108:111], v[44:47], a[252:255]
 ds_read_b128 v[36:39], v17 offset:2048
 v_mfma_f32_16x16x32_bf16 a[248:251], v[104:107], v[44:47], a[248:251]
 v_mfma_f32_16x16x32_bf16 a[244:247], v[100:103], v[44:47], a[244:247]
 s_mov_b32 s73, s74
 s_mov_b32 s74, s75
 v_mfma_f32_16x16x32_bf16 a[240:243], v[96:99], v[44:47], a[240:243]
 v_mfma_f32_16x16x32_bf16 a[236:239], v[92:95], v[44:47], a[236:239]
 buffer_load_dwordx4 v12, s[24:27], s70 offen offset:3072  lds
 v_mfma_f32_16x16x32_bf16 a[232:235], v[88:91], v[44:47], a[232:235]
 v_mfma_f32_16x16x32_bf16 a[228:231], v[84:87], v[44:47], a[228:231]
 s_add_u32 s70, s70, s71
 v_mfma_f32_16x16x32_bf16 a[224:227], v[80:83], v[44:47], a[224:227]
 s_waitcnt vmcnt(16) lgkmcnt(1)
 v_mfma_f32_16x16x32_bf16 a[0:3], v[48:51], v[32:35], a[0:3]
 s_barrier
 ds_read_b128 v[40:43], v17 offset:4096
 v_mfma_f32_16x16x32_bf16 a[4:7], v[52:55], v[32:35], a[4:7]
 ds_read_b64_tr_b16 v[80:81], v13 offset:49152
 v_mfma_f32_16x16x32_bf16 a[8:11], v[56:59], v[32:35], a[8:11]
 s_add_u32 m0, s72, s76
 v_mfma_f32_16x16x32_bf16 a[12:15], v[60:63], v[32:35], a[12:15]
 ds_read_b64_tr_b16 v[82:83], v13 offset:49664
 v_mfma_f32_16x16x32_bf16 a[16:19], v[64:67], v[32:35], a[16:19]
 buffer_load_dwordx4 v1, s[20:23], s69 offen offset:0 lds
 v_mfma_f32_16x16x32_bf16 a[20:23], v[68:71], v[32:35], a[20:23]
 ds_read_b64_tr_b16 v[84:85], v14 offset:49152
 v_mfma_f32_16x16x32_bf16 a[24:27], v[72:75], v[32:35], a[24:27]
 v_mfma_f32_16x16x32_bf16 a[28:31], v[76:79], v[32:35], a[28:31]
 s_waitcnt lgkmcnt(4)
 buffer_store_dwordx4 v[112:115], v21, s[36:39], s6 offen offset:0 sc1
 v_mfma_f32_16x16x32_bf16 a[60:63], v[76:79], v[36:39], a[60:63]
 ds_read_b128 v[44:47], v17 offset:6144
 v_mfma_f32_16x16x32_bf16 a[56:59], v[72:75], v[36:39], a[56:59]
 ds_read_b64_tr_b16 v[86:87], v14 offset:49664
 v_mfma_f32_16x16x32_bf16 a[52:55], v[68:71], v[36:39], a[52:55]
 v_add_u32 v18, s73, v20
 v_mfma_f32_16x16x32_bf16 a[48:51], v[64:67], v[36:39], a[48:51]
 ds_read_b64_tr_b16 v[88:89], v15 offset:49152
 v_mfma_f32_16x16x32_bf16 a[44:47], v[60:63], v[36:39], a[44:47]
 buffer_load_dwordx4 v2, s[20:23], s69 offen offset:1024 lds
 v_mfma_f32_16x16x32_bf16 a[40:43], v[56:59], v[36:39], a[40:43]
 ds_read_b64_tr_b16 v[90:91], v15 offset:49664
 v_mfma_f32_16x16x32_bf16 a[36:39], v[52:55], v[36:39], a[36:39]
 v_mfma_f32_16x16x32_bf16 a[32:35], v[48:51], v[36:39], a[32:35]
 s_waitcnt lgkmcnt(7)
 v_mfma_f32_16x16x32_bf16 a[64:67], v[48:51], v[40:43], a[64:67]
 ds_read_b128 v[32:35], v17 offset:8192
 v_mfma_f32_16x16x32_bf16 a[68:71], v[52:55], v[40:43], a[68:71]
 ds_read_b64_tr_b16 v[92:93], v16 offset:49152
 v_mfma_f32_16x16x32_bf16 a[72:75], v[56:59], v[40:43], a[72:75]
 v_mfma_f32_16x16x32_bf16 a[76:79], v[60:63], v[40:43], a[76:79]
 ds_read_b64_tr_b16 v[94:95], v16 offset:49664
 v_mfma_f32_16x16x32_bf16 a[80:83], v[64:67], v[40:43], a[80:83]
 buffer_load_dwordx4 v3, s[20:23], s69 offen offset:2048 lds
 v_mfma_f32_16x16x32_bf16 a[84:87], v[68:71], v[40:43], a[84:87]
 ds_read_b64_tr_b16 v[96:97], v13 offset:53248
 v_mfma_f32_16x16x32_bf16 a[88:91], v[72:75], v[40:43], a[88:91]
 v_mfma_f32_16x16x32_bf16 a[92:95], v[76:79], v[40:43], a[92:95]
 s_waitcnt lgkmcnt(7)
 buffer_store_dwordx4 v[120:123], v21, s[36:39], s6 offen offset:2048 sc1
 v_mfma_f32_16x16x32_bf16 a[124:127], v[76:79], v[44:47], a[124:127]
 ds_read_b128 v[36:39], v17 offset:10240
 v_mfma_f32_16x16x32_bf16 a[120:123], v[72:75], v[44:47], a[120:123]
 ds_read_b64_tr_b16 v[98:99], v13 offset:53760
 v_mfma_f32_16x16x32_bf16 a[116:119], v[68:71], v[44:47], a[116:119]
 v_mfma_f32_16x16x32_bf16 a[112:115], v[64:67], v[44:47], a[112:115]
 ds_read_b64_tr_b16 v[100:101], v14 offset:53248
 v_mfma_f32_16x16x32_bf16 a[108:111], v[60:63], v[44:47], a[108:111]
 buffer_load_dwordx4 v4, s[20:23], s69 offen offset:3072 lds
 v_mfma_f32_16x16x32_bf16 a[104:107], v[56:59], v[44:47], a[104:107]
 ds_read_b64_tr_b16 v[102:103], v14 offset:53760
 v_mfma_f32_16x16x32_bf16 a[100:103], v[52:55], v[44:47], a[100:103]
 v_mfma_f32_16x16x32_bf16 a[96:99], v[48:51], v[44:47], a[96:99]
 s_waitcnt lgkmcnt(7)
 v_mfma_f32_16x16x32_bf16 a[128:131], v[48:51], v[32:35], a[128:131]
 ds_read_b128 v[40:43], v17 offset:12288
 v_mfma_f32_16x16x32_bf16 a[132:135], v[52:55], v[32:35], a[132:135]
 ds_read_b64_tr_b16 v[104:105], v15 offset:53248
 v_mfma_f32_16x16x32_bf16 a[136:139], v[56:59], v[32:35], a[136:139]
 s_add_u32 m0, s78, 32768
 v_mfma_f32_16x16x32_bf16 a[140:143], v[60:63], v[32:35], a[140:143]
 ds_read_b64_tr_b16 v[106:107], v15 offset:53760
 v_mfma_f32_16x16x32_bf16 a[144:147], v[64:67], v[32:35], a[144:147]
 buffer_load_dwordx4 v9, s[24:27], s70 offen offset:0  lds
 v_mfma_f32_16x16x32_bf16 a[148:151], v[68:71], v[32:35], a[148:151]
 ds_read_b64_tr_b16 v[108:109], v16 offset:53248
 v_mfma_f32_16x16x32_bf16 a[152:155], v[72:75], v[32:35], a[152:155]
 v_mfma_f32_16x16x32_bf16 a[156:159], v[76:79], v[32:35], a[156:159]
 s_waitcnt lgkmcnt(7)
 buffer_store_dwordx4 v[116:119], v21, s[36:39], s6 offen offset:1024 sc1
 v_mfma_f32_16x16x32_bf16 a[188:191], v[76:79], v[36:39], a[188:191]
 ds_read_b128 v[44:47], v17 offset:14336
 v_mfma_f32_16x16x32_bf16 a[184:187], v[72:75], v[36:39], a[184:187]
 ds_read_b64_tr_b16 v[110:111], v16 offset:53760
 v_mfma_f32_16x16x32_bf16 a[180:183], v[68:71], v[36:39], a[180:183]
 v_mfma_f32_16x16x32_bf16 a[176:179], v[64:67], v[36:39], a[176:179]
 v_mfma_f32_16x16x32_bf16 a[172:175], v[60:63], v[36:39], a[172:175]
 buffer_load_dwordx4 v10, s[24:27], s70 offen offset:1024  lds
 v_mfma_f32_16x16x32_bf16 a[168:171], v[56:59], v[36:39], a[168:171]
 v_mfma_f32_16x16x32_bf16 a[164:167], v[52:55], v[36:39], a[164:167]
 v_mfma_f32_16x16x32_bf16 a[160:163], v[48:51], v[36:39], a[160:163]
 s_waitcnt lgkmcnt(5)
 v_mfma_f32_16x16x32_bf16 a[192:195], v[48:51], v[40:43], a[192:195]
 ds_read_b128 v[32:35], v18 offset:0
 v_mfma_f32_16x16x32_bf16 a[196:199], v[52:55], v[40:43], a[196:199]
 v_mfma_f32_16x16x32_bf16 a[200:203], v[56:59], v[40:43], a[200:203]
 v_mfma_f32_16x16x32_bf16 a[204:207], v[60:63], v[40:43], a[204:207]
 v_mfma_f32_16x16x32_bf16 a[208:211], v[64:67], v[40:43], a[208:211]
 buffer_load_dwordx4 v11, s[24:27], s70 offen offset:2048  lds
 v_mfma_f32_16x16x32_bf16 a[212:215], v[68:71], v[40:43], a[212:215]
 v_mfma_f32_16x16x32_bf16 a[216:219], v[72:75], v[40:43], a[216:219]
 v_mfma_f32_16x16x32_bf16 a[220:223], v[76:79], v[40:43], a[220:223]
 s_waitcnt lgkmcnt(2)
 buffer_store_dwordx4 v[124:127], v21, s[36:39], s6 offen offset:3072 sc1
 v_mfma_f32_16x16x32_bf16 a[252:255], v[76:79], v[44:47], a[252:255]
 ds_read_b128 v[36:39], v18 offset:2048
 v_mfma_f32_16x16x32_bf16 a[248:251], v[72:75], v[44:47], a[248:251]
 v_mfma_f32_16x16x32_bf16 a[244:247], v[68:71], v[44:47], a[244:247]
 v_mfma_f32_16x16x32_bf16 a[240:243], v[64:67], v[44:47], a[240:243]
 v_mfma_f32_16x16x32_bf16 a[236:239], v[60:63], v[44:47], a[236:239]
 buffer_load_dwordx4 v12, s[24:27], s70 offen offset:3072  lds
 v_mfma_f32_16x16x32_bf16 a[232:235], v[56:59], v[44:47], a[232:235]
 v_mfma_f32_16x16x32_bf16 a[228:231], v[52:55], v[44:47], a[228:231]
 s_add_u32 s70, s70, s71
 v_mfma_f32_16x16x32_bf16 a[224:227], v[48:51], v[44:47], a[224:227]
 s_waitcnt vmcnt(16) lgkmcnt(1)
 v_mfma_f32_16x16x32_bf16 a[0:3], v[80:83], v[32:35], a[0:3]
 s_barrier
 ds_read_b128 v[40:43], v18 offset:4096
 v_mfma_f32_16x16x32_bf16 a[4:7], v[84:87], v[32:35], a[4:7]
 ds_read_b64_tr_b16 v[48:49], v13 offset:0
 v_mfma_f32_16x16x32_bf16 a[8:11], v[88:91], v[32:35], a[8:11]
 s_add_u32 m0, s72, s77
 v_mfma_f32_16x16x32_bf16 a[12:15], v[92:95], v[32:35], a[12:15]
 ds_read_b64_tr_b16 v[50:51], v13 offset:512
 v_mfma_f32_16x16x32_bf16 a[16:19], v[96:99], v[32:35], a[16:19]
 buffer_load_dwordx4 v5, s[20:23], s69 offen offset:0 lds
 v_mfma_f32_16x16x32_bf16 a[20:23], v[100:103], v[32:35], a[20:23]
 ds_read_b64_tr_b16 v[52:53], v14 offset:0
 v_mfma_f32_16x16x32_bf16 a[24:27], v[104:107], v[32:35], a[24:27]
 v_mfma_f32_16x16x32_bf16 a[28:31], v[108:111], v[32:35], a[28:31]
 s_waitcnt lgkmcnt(4)
 buffer_store_dwordx4 v[128:131], v21, s[36:39], s7 offen offset:0 sc1
 v_mfma_f32_16x16x32_bf16 a[60:63], v[108:111], v[36:39], a[60:63]
 ds_read_b128 v[44:47], v18 offset:6144
 v_mfma_f32_16x16x32_bf16 a[56:59], v[104:107], v[36:39], a[56:59]
 ds_read_b64_tr_b16 v[54:55], v14 offset:512
 v_mfma_f32_16x16x32_bf16 a[52:55], v[100:103], v[36:39], a[52:55]
 v_add_u32 v17, s74, v19
 v_mfma_f32_16x16x32_bf16 a[48:51], v[96:99], v[36:39], a[48:51]
 ds_read_b64_tr_b16 v[56:57], v15 offset:0
 v_mfma_f32_16x16x32_bf16 a[44:47], v[92:95], v[36:39], a[44:47]
 buffer_load_dwordx4 v6, s[20:23], s69 offen offset:1024 lds
 v_mfma_f32_16x16x32_bf16 a[40:43], v[88:91], v[36:39], a[40:43]
 ds_read_b64_tr_b16 v[58:59], v15 offset:512
 v_mfma_f32_16x16x32_bf16 a[36:39], v[84:87], v[36:39], a[36:39]
 v_mfma_f32_16x16x32_bf16 a[32:35], v[80:83], v[36:39], a[32:35]
 s_waitcnt lgkmcnt(7)
 v_mfma_f32_16x16x32_bf16 a[64:67], v[80:83], v[40:43], a[64:67]
 ds_read_b128 v[32:35], v18 offset:8192
 v_mfma_f32_16x16x32_bf16 a[68:71], v[84:87], v[40:43], a[68:71]
 ds_read_b64_tr_b16 v[60:61], v16 offset:0
 v_mfma_f32_16x16x32_bf16 a[72:75], v[88:91], v[40:43], a[72:75]
 v_mfma_f32_16x16x32_bf16 a[76:79], v[92:95], v[40:43], a[76:79]
 ds_read_b64_tr_b16 v[62:63], v16 offset:512
 v_mfma_f32_16x16x32_bf16 a[80:83], v[96:99], v[40:43], a[80:83]
 buffer_load_dwordx4 v7, s[20:23], s69 offen offset:2048 lds
 v_mfma_f32_16x16x32_bf16 a[84:87], v[100:103], v[40:43], a[84:87]
 ds_read_b64_tr_b16 v[64:65], v13 offset:4096
 v_mfma_f32_16x16x32_bf16 a[88:91], v[104:107], v[40:43], a[88:91]
 v_mfma_f32_16x16x32_bf16 a[92:95], v[108:111], v[40:43], a[92:95]
 s_waitcnt lgkmcnt(7)
 buffer_store_dwordx4 v[136:139], v21, s[36:39], s7 offen offset:2048 sc1
 v_mfma_f32_16x16x32_bf16 a[124:127], v[108:111], v[44:47], a[124:127]
 ds_read_b128 v[36:39], v18 offset:10240
 v_mfma_f32_16x16x32_bf16 a[120:123], v[104:107], v[44:47], a[120:123]
 ds_read_b64_tr_b16 v[66:67], v13 offset:4608
 v_mfma_f32_16x16x32_bf16 a[116:119], v[100:103], v[44:47], a[116:119]
 v_mfma_f32_16x16x32_bf16 a[112:115], v[96:99], v[44:47], a[112:115]
 ds_read_b64_tr_b16 v[68:69], v14 offset:4096
 v_mfma_f32_16x16x32_bf16 a[108:111], v[92:95], v[44:47], a[108:111]
 buffer_load_dwordx4 v8, s[20:23], s69 offen offset:3072 lds
 v_mfma_f32_16x16x32_bf16 a[104:107], v[88:91], v[44:47], a[104:107]
 ds_read_b64_tr_b16 v[70:71], v14 offset:4608
 v_mfma_f32_16x16x32_bf16 a[100:103], v[84:87], v[44:47], a[100:103]
 s_add_u32 s69, s69, 128
 v_mfma_f32_16x16x32_bf16 a[96:99], v[80:83], v[44:47], a[96:99]
 s_waitcnt lgkmcnt(7)
 v_mfma_f32_16x16x32_bf16 a[128:131], v[80:83], v[32:35], a[128:131]
 ds_read_b128 v[40:43], v18 offset:12288
 v_mfma_f32_16x16x32_bf16 a[132:135], v[84:87], v[32:35], a[132:135]
 ds_read_b64_tr_b16 v[72:73], v15 offset:4096
 v_mfma_f32_16x16x32_bf16 a[136:139], v[88:91], v[32:35], a[136:139]
 s_add_u32 m0, s78, 49152
 v_mfma_f32_16x16x32_bf16 a[140:143], v[92:95], v[32:35], a[140:143]
 ds_read_b64_tr_b16 v[74:75], v15 offset:4608
 v_mfma_f32_16x16x32_bf16 a[144:147], v[96:99], v[32:35], a[144:147]
 buffer_load_dwordx4 v9, s[24:27], s70 offen offset:0  lds
 v_mfma_f32_16x16x32_bf16 a[148:151], v[100:103], v[32:35], a[148:151]
 ds_read_b64_tr_b16 v[76:77], v16 offset:4096
 v_mfma_f32_16x16x32_bf16 a[152:155], v[104:107], v[32:35], a[152:155]
 v_mfma_f32_16x16x32_bf16 a[156:159], v[108:111], v[32:35], a[156:159]
 s_waitcnt lgkmcnt(7)
 buffer_store_dwordx4 v[132:135], v21, s[36:39], s7 offen offset:1024 sc1
 v_mfma_f32_16x16x32_bf16 a[188:191], v[108:111], v[36:39], a[188:191]
 ds_read_b128 v[44:47], v18 offset:14336
 v_mfma_f32_16x16x32_bf16 a[184:187], v[104:107], v[36:39], a[184:187]
 ds_read_b64_tr_b16 v[78:79], v16 offset:4608
 v_mfma_f32_16x16x32_bf16 a[180:183], v[100:103], v[36:39], a[180:183]
 v_mfma_f32_16x16x32_bf16 a[176:179], v[96:99], v[36:39], a[176:179]
 v_mfma_f32_16x16x32_bf16 a[172:175], v[92:95], v[36:39], a[172:175]
 buffer_load_dwordx4 v10, s[24:27], s70 offen offset:1024  lds
 v_mfma_f32_16x16x32_bf16 a[168:171], v[88:91], v[36:39], a[168:171]
 v_mfma_f32_16x16x32_bf16 a[164:167], v[84:87], v[36:39], a[164:167]
 v_mfma_f32_16x16x32_bf16 a[160:163], v[80:83], v[36:39], a[160:163]
 s_waitcnt lgkmcnt(5)
 v_mfma_f32_16x16x32_bf16 a[192:195], v[80:83], v[40:43], a[192:195]
 ds_read_b128 v[32:35], v17 offset:0
 v_mfma_f32_16x16x32_bf16 a[196:199], v[84:87], v[40:43], a[196:199]
 v_mfma_f32_16x16x32_bf16 a[200:203], v[88:91], v[40:43], a[200:203]
 s_mov_b32 s75, s72
 s_mov_b32 s72, s73
 v_mfma_f32_16x16x32_bf16 a[204:207], v[92:95], v[40:43], a[204:207]
 v_mfma_f32_16x16x32_bf16 a[208:211], v[96:99], v[40:43], a[208:211]
 buffer_load_dwordx4 v11, s[24:27], s70 offen offset:2048  lds
 v_mfma_f32_16x16x32_bf16 a[212:215], v[100:103], v[40:43], a[212:215]
 v_mfma_f32_16x16x32_bf16 a[216:219], v[104:107], v[40:43], a[216:219]
 v_mfma_f32_16x16x32_bf16 a[220:223], v[108:111], v[40:43], a[220:223]
 s_waitcnt lgkmcnt(2)
 buffer_store_dwordx4 v[140:143], v21, s[36:39], s7 offen offset:3072 sc1
 v_mfma_f32_16x16x32_bf16 a[252:255], v[108:111], v[44:47], a[252:255]
 ds_read_b128 v[36:39], v17 offset:2048
 v_mfma_f32_16x16x32_bf16 a[248:251], v[104:107], v[44:47], a[248:251]
 v_mfma_f32_16x16x32_bf16 a[244:247], v[100:103], v[44:47], a[244:247]
 s_mov_b32 s73, s74
 s_mov_b32 s74, s75
 v_mfma_f32_16x16x32_bf16 a[240:243], v[96:99], v[44:47], a[240:243]
 v_mfma_f32_16x16x32_bf16 a[236:239], v[92:95], v[44:47], a[236:239]
 buffer_load_dwordx4 v12, s[24:27], s70 offen offset:3072  lds
 v_mfma_f32_16x16x32_bf16 a[232:235], v[88:91], v[44:47], a[232:235]
 v_mfma_f32_16x16x32_bf16 a[228:231], v[84:87], v[44:47], a[228:231]
 s_add_u32 s70, s70, s71
 v_mfma_f32_16x16x32_bf16 a[224:227], v[80:83], v[44:47], a[224:227]
 s_waitcnt vmcnt(24) lgkmcnt(1)
 v_mfma_f32_16x16x32_bf16 a[0:3], v[48:51], v[32:35], a[0:3]
 s_barrier
 ds_read_b128 v[40:43], v17 offset:4096
 v_mfma_f32_16x16x32_bf16 a[4:7], v[52:55], v[32:35], a[4:7]
 ds_read_b64_tr_b16 v[80:81], v13 offset:16384
 v_mfma_f32_16x16x32_bf16 a[8:11], v[56:59], v[32:35], a[8:11]
 s_add_u32 m0, s72, s76
 v_mfma_f32_16x16x32_bf16 a[12:15], v[60:63], v[32:35], a[12:15]
 ds_read_b64_tr_b16 v[82:83], v13 offset:16896
 v_mfma_f32_16x16x32_bf16 a[16:19], v[64:67], v[32:35], a[16:19]
 buffer_load_dwordx4 v1, s[20:23], s69 offen offset:0 lds
 v_mfma_f32_16x16x32_bf16 a[20:23], v[68:71], v[32:35], a[20:23]
 ds_read_b64_tr_b16 v[84:85], v14 offset:16384
 v_mfma_f32_16x16x32_bf16 a[24:27], v[72:75], v[32:35], a[24:27]
 v_mfma_f32_16x16x32_bf16 a[28:31], v[76:79], v[32:35], a[28:31]
 s_waitcnt lgkmcnt(4)
 buffer_store_dwordx4 v[144:147], v21, s[36:39], s8 offen offset:0 sc1
 v_mfma_f32_16x16x32_bf16 a[60:63], v[76:79], v[36:39], a[60:63]
 ds_read_b128 v[44:47], v17 offset:6144
 v_mfma_f32_16x16x32_bf16 a[56:59], v[72:75], v[36:39], a[56:59]
 ds_read_b64_tr_b16 v[86:87], v14 offset:16896
 v_mfma_f32_16x16x32_bf16 a[52:55], v[68:71], v[36:39], a[52:55]
 v_add_u32 v18, s73, v20
 v_mfma_f32_16x16x32_bf16 a[48:51], v[64:67], v[36:39], a[48:51]
 ds_read_b64_tr_b16 v[88:89], v15 offset:16384
 v_mfma_f32_16x16x32_bf16 a[44:47], v[60:63], v[36:39], a[44:47]
 buffer_load_dwordx4 v2, s[20:23], s69 offen offset:1024 lds
 v_mfma_f32_16x16x32_bf16 a[40:43], v[56:59], v[36:39], a[40:43]
 ds_read_b64_tr_b16 v[90:91], v15 offset:16896
 v_mfma_f32_16x16x32_bf16 a[36:39], v[52:55], v[36:39], a[36:39]
 v_mfma_f32_16x16x32_bf16 a[32:35], v[48:51], v[36:39], a[32:35]
 s_waitcnt lgkmcnt(7)
 v_mfma_f32_16x16x32_bf16 a[64:67], v[48:51], v[40:43], a[64:67]
 ds_read_b128 v[32:35], v17 offset:8192
 v_mfma_f32_16x16x32_bf16 a[68:71], v[52:55], v[40:43], a[68:71]
 ds_read_b64_tr_b16 v[92:93], v16 offset:16384
 v_mfma_f32_16x16x32_bf16 a[72:75], v[56:59], v[40:43], a[72:75]
 v_mfma_f32_16x16x32_bf16 a[76:79], v[60:63], v[40:43], a[76:79]
 ds_read_b64_tr_b16 v[94:95], v16 offset:16896
 v_mfma_f32_16x16x32_bf16 a[80:83], v[64:67], v[40:43], a[80:83]
 buffer_load_dwordx4 v3, s[20:23], s69 offen offset:2048 lds
 v_mfma_f32_16x16x32_bf16 a[84:87], v[68:71], v[40:43], a[84:87]
 ds_read_b64_tr_b16 v[96:97], v13 offset:20480
 v_mfma_f32_16x16x32_bf16 a[88:91], v[72:75], v[40:43], a[88:91]
 v_mfma_f32_16x16x32_bf16 a[92:95], v[76:79], v[40:43], a[92:95]
 s_waitcnt lgkmcnt(7)
 buffer_store_dwordx4 v[152:155], v21, s[36:39], s8 offen offset:2048 sc1
 v_mfma_f32_16x16x32_bf16 a[124:127], v[76:79], v[44:47], a[124:127]
 ds_read_b128 v[36:39], v17 offset:10240
 v_mfma_f32_16x16x32_bf16 a[120:123], v[72:75], v[44:47], a[120:123]
 ds_read_b64_tr_b16 v[98:99], v13 offset:20992
 v_mfma_f32_16x16x32_bf16 a[116:119], v[68:71], v[44:47], a[116:119]
 v_mfma_f32_16x16x32_bf16 a[112:115], v[64:67], v[44:47], a[112:115]
 ds_read_b64_tr_b16 v[100:101], v14 offset:20480
 v_mfma_f32_16x16x32_bf16 a[108:111], v[60:63], v[44:47], a[108:111]
 buffer_load_dwordx4 v4, s[20:23], s69 offen offset:3072 lds
 v_mfma_f32_16x16x32_bf16 a[104:107], v[56:59], v[44:47], a[104:107]
 ds_read_b64_tr_b16 v[102:103], v14 offset:20992
 v_mfma_f32_16x16x32_bf16 a[100:103], v[52:55], v[44:47], a[100:103]
 v_mfma_f32_16x16x32_bf16 a[96:99], v[48:51], v[44:47], a[96:99]
 s_waitcnt lgkmcnt(7)
 v_mfma_f32_16x16x32_bf16 a[128:131], v[48:51], v[32:35], a[128:131]
 ds_read_b128 v[40:43], v17 offset:12288
 v_mfma_f32_16x16x32_bf16 a[132:135], v[52:55], v[32:35], a[132:135]
 ds_read_b64_tr_b16 v[104:105], v15 offset:20480
 v_mfma_f32_16x16x32_bf16 a[136:139], v[56:59], v[32:35], a[136:139]
 s_add_u32 m0, s78, 0
 v_mfma_f32_16x16x32_bf16 a[140:143], v[60:63], v[32:35], a[140:143]
 ds_read_b64_tr_b16 v[106:107], v15 offset:20992
 v_mfma_f32_16x16x32_bf16 a[144:147], v[64:67], v[32:35], a[144:147]
 buffer_load_dwordx4 v9, s[24:27], s70 offen offset:0  lds
 v_mfma_f32_16x16x32_bf16 a[148:151], v[68:71], v[32:35], a[148:151]
 ds_read_b64_tr_b16 v[108:109], v16 offset:20480
 v_mfma_f32_16x16x32_bf16 a[152:155], v[72:75], v[32:35], a[152:155]
 v_mfma_f32_16x16x32_bf16 a[156:159], v[76:79], v[32:35], a[156:159]
 s_waitcnt lgkmcnt(7)
 buffer_store_dwordx4 v[148:151], v21, s[36:39], s8 offen offset:1024 sc1
 v_mfma_f32_16x16x32_bf16 a[188:191], v[76:79], v[36:39], a[188:191]
 ds_read_b128 v[44:47], v17 offset:14336
 v_mfma_f32_16x16x32_bf16 a[184:187], v[72:75], v[36:39], a[184:187]
 ds_read_b64_tr_b16 v[110:111], v16 offset:20992
 v_mfma_f32_16x16x32_bf16 a[180:183], v[68:71], v[36:39], a[180:183]
 v_mfma_f32_16x16x32_bf16 a[176:179], v[64:67], v[36:39], a[176:179]
 v_mfma_f32_16x16x32_bf16 a[172:175], v[60:63], v[36:39], a[172:175]
 buffer_load_dwordx4 v10, s[24:27], s70 offen offset:1024  lds
 v_mfma_f32_16x16x32_bf16 a[168:171], v[56:59], v[36:39], a[168:171]
 v_mfma_f32_16x16x32_bf16 a[164:167], v[52:55], v[36:39], a[164:167]
 v_mfma_f32_16x16x32_bf16 a[160:163], v[48:51], v[36:39], a[160:163]
 s_waitcnt lgkmcnt(5)
 v_mfma_f32_16x16x32_bf16 a[192:195], v[48:51], v[40:43], a[192:195]
 ds_read_b128 v[32:35], v18 offset:0
 v_mfma_f32_16x16x32_bf16 a[196:199], v[52:55], v[40:43], a[196:199]
 v_mfma_f32_16x16x32_bf16 a[200:203], v[56:59], v[40:43], a[200:203]
 v_mfma_f32_16x16x32_bf16 a[204:207], v[60:63], v[40:43], a[204:207]
 v_mfma_f32_16x16x32_bf16 a[208:211], v[64:67], v[40:43], a[208:211]
 buffer_load_dwordx4 v11, s[24:27], s70 offen offset:2048  lds
 v_mfma_f32_16x16x32_bf16 a[212:215], v[68:71], v[40:43], a[212:215]
 v_mfma_f32_16x16x32_bf16 a[216:219], v[72:75], v[40:43], a[216:219]
 v_mfma_f32_16x16x32_bf16 a[220:223], v[76:79], v[40:43], a[220:223]
 s_waitcnt lgkmcnt(2)
 buffer_store_dwordx4 v[156:159], v21, s[36:39], s8 offen offset:3072 sc1
 v_mfma_f32_16x16x32_bf16 a[252:255], v[76:79], v[44:47], a[252:255]
 ds_read_b128 v[36:39], v18 offset:2048
 v_mfma_f32_16x16x32_bf16 a[248:251], v[72:75], v[44:47], a[248:251]
 v_mfma_f32_16x16x32_bf16 a[244:247], v[68:71], v[44:47], a[244:247]
 v_mfma_f32_16x16x32_bf16 a[240:243], v[64:67], v[44:47], a[240:243]
 v_mfma_f32_16x16x32_bf16 a[236:239], v[60:63], v[44:47], a[236:239]
 buffer_load_dwordx4 v12, s[24:27], s70 offen offset:3072  lds
 v_mfma_f32_16x16x32_bf16 a[232:235], v[56:59], v[44:47], a[232:235]
 v_mfma_f32_16x16x32_bf16 a[228:231], v[52:55], v[44:47], a[228:231]
 s_add_u32 s70, s70, s71
 v_mfma_f32_16x16x32_bf16 a[224:227], v[48:51], v[44:47], a[224:227]
 s_waitcnt vmcnt(18) lgkmcnt(1)
 v_mfma_f32_16x16x32_bf16 a[0:3], v[80:83], v[32:35], a[0:3]
 s_barrier
 ds_read_b128 v[40:43], v18 offset:4096
 v_mfma_f32_16x16x32_bf16 a[4:7], v[84:87], v[32:35], a[4:7]
 ds_read_b64_tr_b16 v[48:49], v13 offset:32768
 v_mfma_f32_16x16x32_bf16 a[8:11], v[88:91], v[32:35], a[8:11]
 s_add_u32 m0, s72, s77
 v_mfma_f32_16x16x32_bf16 a[12:15], v[92:95], v[32:35], a[12:15]
 ds_read_b64_tr_b16 v[50:51], v13 offset:33280
 v_mfma_f32_16x16x32_bf16 a[16:19], v[96:99], v[32:35], a[16:19]
 buffer_load_dwordx4 v5, s[20:23], s69 offen offset:0 lds
 v_mfma_f32_16x16x32_bf16 a[20:23], v[100:103], v[32:35], a[20:23]
 ds_read_b64_tr_b16 v[52:53], v14 offset:32768
 v_mfma_f32_16x16x32_bf16 a[24:27], v[104:107], v[32:35], a[24:27]
 v_mfma_f32_16x16x32_bf16 a[28:31], v[108:111], v[32:35], a[28:31]
 s_waitcnt lgkmcnt(4)
 buffer_store_dwordx4 v[160:163], v21, s[36:39], s9 offen offset:0 sc1
 v_mfma_f32_16x16x32_bf16 a[60:63], v[108:111], v[36:39], a[60:63]
 ds_read_b128 v[44:47], v18 offset:6144
 v_mfma_f32_16x16x32_bf16 a[56:59], v[104:107], v[36:39], a[56:59]
 ds_read_b64_tr_b16 v[54:55], v14 offset:33280
 v_mfma_f32_16x16x32_bf16 a[52:55], v[100:103], v[36:39], a[52:55]
 v_add_u32 v17, s74, v19
 v_mfma_f32_16x16x32_bf16 a[48:51], v[96:99], v[36:39], a[48:51]
 ds_read_b64_tr_b16 v[56:57], v15 offset:32768
 v_mfma_f32_16x16x32_bf16 a[44:47], v[92:95], v[36:39], a[44:47]
 buffer_load_dwordx4 v6, s[20:23], s69 offen offset:1024 lds
 v_mfma_f32_16x16x32_bf16 a[40:43], v[88:91], v[36:39], a[40:43]
 ds_read_b64_tr_b16 v[58:59], v15 offset:33280
 v_mfma_f32_16x16x32_bf16 a[36:39], v[84:87], v[36:39], a[36:39]
 v_mfma_f32_16x16x32_bf16 a[32:35], v[80:83], v[36:39], a[32:35]
 s_waitcnt lgkmcnt(7)
 v_mfma_f32_16x16x32_bf16 a[64:67], v[80:83], v[40:43], a[64:67]
 ds_read_b128 v[32:35], v18 offset:8192
 v_mfma_f32_16x16x32_bf16 a[68:71], v[84:87], v[40:43], a[68:71]
 ds_read_b64_tr_b16 v[60:61], v16 offset:32768
 v_mfma_f32_16x16x32_bf16 a[72:75], v[88:91], v[40:43], a[72:75]
 v_mfma_f32_16x16x32_bf16 a[76:79], v[92:95], v[40:43], a[76:79]
 ds_read_b64_tr_b16 v[62:63], v16 offset:33280
 v_mfma_f32_16x16x32_bf16 a[80:83], v[96:99], v[40:43], a[80:83]
 buffer_load_dwordx4 v7, s[20:23], s69 offen offset:2048 lds
 v_mfma_f32_16x16x32_bf16 a[84:87], v[100:103], v[40:43], a[84:87]
 ds_read_b64_tr_b16 v[64:65], v13 offset:36864
 v_mfma_f32_16x16x32_bf16 a[88:91], v[104:107], v[40:43], a[88:91]
 v_mfma_f32_16x16x32_bf16 a[92:95], v[108:111], v[40:43], a[92:95]
 s_waitcnt lgkmcnt(7)
 buffer_store_dwordx4 v[168:171], v21, s[36:39], s9 offen offset:2048 sc1
 v_mfma_f32_16x16x32_bf16 a[124:127], v[108:111], v[44:47], a[124:127]
 ds_read_b128 v[36:39], v18 offset:10240
 v_mfma_f32_16x16x32_bf16 a[120:123], v[104:107], v[44:47], a[120:123]
 ds_read_b64_tr_b16 v[66:67], v13 offset:37376
 v_mfma_f32_16x16x32_bf16 a[116:119], v[100:103], v[44:47], a[116:119]
 v_mfma_f32_16x16x32_bf16 a[112:115], v[96:99], v[44:47], a[112:115]
 ds_read_b64_tr_b16 v[68:69], v14 offset:36864
 v_mfma_f32_16x16x32_bf16 a[108:111], v[92:95], v[44:47], a[108:111]
 buffer_load_dwordx4 v8, s[20:23], s69 offen offset:3072 lds
 v_mfma_f32_16x16x32_bf16 a[104:107], v[88:91], v[44:47], a[104:107]
 ds_read_b64_tr_b16 v[70:71], v14 offset:37376
 v_mfma_f32_16x16x32_bf16 a[100:103], v[84:87], v[44:47], a[100:103]
 s_add_u32 s69, s69, 128
 v_mfma_f32_16x16x32_bf16 a[96:99], v[80:83], v[44:47], a[96:99]
 s_waitcnt lgkmcnt(7)
 v_mfma_f32_16x16x32_bf16 a[128:131], v[80:83], v[32:35], a[128:131]
 ds_read_b128 v[40:43], v18 offset:12288
 v_mfma_f32_16x16x32_bf16 a[132:135], v[84:87], v[32:35], a[132:135]
 ds_read_b64_tr_b16 v[72:73], v15 offset:36864
 v_mfma_f32_16x16x32_bf16 a[136:139], v[88:91], v[32:35], a[136:139]
 s_add_u32 m0, s78, 16384
 v_mfma_f32_16x16x32_bf16 a[140:143], v[92:95], v[32:35], a[140:143]
 ds_read_b64_tr_b16 v[74:75], v15 offset:37376
 v_mfma_f32_16x16x32_bf16 a[144:147], v[96:99], v[32:35], a[144:147]
 buffer_load_dwordx4 v9, s[24:27], s70 offen offset:0  lds
 v_mfma_f32_16x16x32_bf16 a[148:151], v[100:103], v[32:35], a[148:151]
 ds_read_b64_tr_b16 v[76:77], v16 offset:36864
 v_mfma_f32_16x16x32_bf16 a[152:155], v[104:107], v[32:35], a[152:155]
 v_mfma_f32_16x16x32_bf16 a[156:159], v[108:111], v[32:35], a[156:159]
 s_waitcnt lgkmcnt(7)
 buffer_store_dwordx4 v[164:167], v21, s[36:39], s9 offen offset:1024 sc1
 v_mfma_f32_16x16x32_bf16 a[188:191], v[108:111], v[36:39], a[188:191]
 ds_read_b128 v[44:47], v18 offset:14336
 v_mfma_f32_16x16x32_bf16 a[184:187], v[104:107], v[36:39], a[184:187]
 ds_read_b64_tr_b16 v[78:79], v16 offset:37376
 v_mfma_f32_16x16x32_bf16 a[180:183], v[100:103], v[36:39], a[180:183]
 v_mfma_f32_16x16x32_bf16 a[176:179], v[96:99], v[36:39], a[176:179]
 v_mfma_f32_16x16x32_bf16 a[172:175], v[92:95], v[36:39], a[172:175]
 buffer_load_dwordx4 v10, s[24:27], s70 offen offset:1024  lds
 v_mfma_f32_16x16x32_bf16 a[168:171], v[88:91], v[36:39], a[168:171]
 v_mfma_f32_16x16x32_bf16 a[164:167], v[84:87], v[36:39], a[164:167]
 v_mfma_f32_16x16x32_bf16 a[160:163], v[80:83], v[36:39], a[160:163]
 s_waitcnt lgkmcnt(5)
 v_mfma_f32_16x16x32_bf16 a[192:195], v[80:83], v[40:43], a[192:195]
 ds_read_b128 v[32:35], v17 offset:0
 v_mfma_f32_16x16x32_bf16 a[196:199], v[84:87], v[40:43], a[196:199]
 v_mfma_f32_16x16x32_bf16 a[200:203], v[88:91], v[40:43], a[200:203]
 s_mov_b32 s75, s72
 s_mov_b32 s72, s73
 v_mfma_f32_16x16x32_bf16 a[204:207], v[92:95], v[40:43], a[204:207]
 v_mfma_f32_16x16x32_bf16 a[208:211], v[96:99], v[40:43], a[208:211]
 buffer_load_dwordx4 v11, s[24:27], s70 offen offset:2048  lds
 v_mfma_f32_16x16x32_bf16 a[212:215], v[100:103], v[40:43], a[212:215]
 v_mfma_f32_16x16x32_bf16 a[216:219], v[104:107], v[40:43], a[216:219]
 v_mfma_f32_16x16x32_bf16 a[220:223], v[108:111], v[40:43], a[220:223]
 s_waitcnt lgkmcnt(2)
 buffer_store_dwordx4 v[172:175], v21, s[36:39], s9 offen offset:3072 sc1
 v_mfma_f32_16x16x32_bf16 a[252:255], v[108:111], v[44:47], a[252:255]
 ds_read_b128 v[36:39], v17 offset:2048
 v_mfma_f32_16x16x32_bf16 a[248:251], v[104:107], v[44:47], a[248:251]
 v_mfma_f32_16x16x32_bf16 a[244:247], v[100:103], v[44:47], a[244:247]
 s_mov_b32 s73, s74
 s_mov_b32 s74, s75
 v_mfma_f32_16x16x32_bf16 a[240:243], v[96:99], v[44:47], a[240:243]
 v_mfma_f32_16x16x32_bf16 a[236:239], v[92:95], v[44:47], a[236:239]
 buffer_load_dwordx4 v12, s[24:27], s70 offen offset:3072  lds
 v_mfma_f32_16x16x32_bf16 a[232:235], v[88:91], v[44:47], a[232:235]
 v_mfma_f32_16x16x32_bf16 a[228:231], v[84:87], v[44:47], a[228:231]
 s_add_u32 s70, s70, s71
 v_mfma_f32_16x16x32_bf16 a[224:227], v[80:83], v[44:47], a[224:227]
 s_waitcnt vmcnt(24) lgkmcnt(1)
 v_mfma_f32_16x16x32_bf16 a[0:3], v[48:51], v[32:35], a[0:3]
 s_barrier
 ds_read_b128 v[40:43], v17 offset:4096
 v_mfma_f32_16x16x32_bf16 a[4:7], v[52:55], v[32:35], a[4:7]
 ds_read_b64_tr_b16 v[80:81], v13 offset:49152
 v_mfma_f32_16x16x32_bf16 a[8:11], v[56:59], v[32:35], a[8:11]
 s_add_u32 m0, s72, s76
 v_mfma_f32_16x16x32_bf16 a[12:15], v[60:63], v[32:35], a[12:15]
 ds_read_b64_tr_b16 v[82:83], v13 offset:49664
 v_mfma_f32_16x16x32_bf16 a[16:19], v[64:67], v[32:35], a[16:19]
 v_mfma_f32_16x16x32_bf16 a[20:23], v[68:71], v[32:35], a[20:23]
 ds_read_b64_tr_b16 v[84:85], v14 offset:49152
 v_mfma_f32_16x16x32_bf16 a[24:27], v[72:75], v[32:35], a[24:27]
 v_mfma_f32_16x16x32_bf16 a[28:31], v[76:79], v[32:35], a[28:31]
 s_waitcnt lgkmcnt(4)
 buffer_store_dwordx4 v[176:179], v21, s[36:39], s10 offen offset:0 sc1
 v_mfma_f32_16x16x32_bf16 a[60:63], v[76:79], v[36:39], a[60:63]
 ds_read_b128 v[44:47], v17 offset:6144
 v_mfma_f32_16x16x32_bf16 a[56:59], v[72:75], v[36:39], a[56:59]
 ds_read_b64_tr_b16 v[86:87], v14 offset:49664
 v_mfma_f32_16x16x32_bf16 a[52:55], v[68:71], v[36:39], a[52:55]
 v_add_u32 v18, s73, v20
 v_mfma_f32_16x16x32_bf16 a[48:51], v[64:67], v[36:39], a[48:51]
 ds_read_b64_tr_b16 v[88:89], v15 offset:49152
 v_mfma_f32_16x16x32_bf16 a[44:47], v[60:63], v[36:39], a[44:47]
 v_mfma_f32_16x16x32_bf16 a[40:43], v[56:59], v[36:39], a[40:43]
 ds_read_b64_tr_b16 v[90:91], v15 offset:49664
 v_mfma_f32_16x16x32_bf16 a[36:39], v[52:55], v[36:39], a[36:39]
 v_mfma_f32_16x16x32_bf16 a[32:35], v[48:51], v[36:39], a[32:35]
 s_waitcnt lgkmcnt(7)
 v_mfma_f32_16x16x32_bf16 a[64:67], v[48:51], v[40:43], a[64:67]
 ds_read_b128 v[32:35], v17 offset:8192
 v_mfma_f32_16x16x32_bf16 a[68:71], v[52:55], v[40:43], a[68:71]
 ds_read_b64_tr_b16 v[92:93], v16 offset:49152
 v_mfma_f32_16x16x32_bf16 a[72:75], v[56:59], v[40:43], a[72:75]
 v_mfma_f32_16x16x32_bf16 a[76:79], v[60:63], v[40:43], a[76:79]
 ds_read_b64_tr_b16 v[94:95], v16 offset:49664
 v_mfma_f32_16x16x32_bf16 a[80:83], v[64:67], v[40:43], a[80:83]
 v_mfma_f32_16x16x32_bf16 a[84:87], v[68:71], v[40:43], a[84:87]
 ds_read_b64_tr_b16 v[96:97], v13 offset:53248
 v_mfma_f32_16x16x32_bf16 a[88:91], v[72:75], v[40:43], a[88:91]
 v_mfma_f32_16x16x32_bf16 a[92:95], v[76:79], v[40:43], a[92:95]
 s_waitcnt lgkmcnt(7)
 buffer_store_dwordx4 v[184:187], v21, s[36:39], s10 offen offset:2048 sc1
 v_mfma_f32_16x16x32_bf16 a[124:127], v[76:79], v[44:47], a[124:127]
 ds_read_b128 v[36:39], v17 offset:10240
 v_mfma_f32_16x16x32_bf16 a[120:123], v[72:75], v[44:47], a[120:123]
 ds_read_b64_tr_b16 v[98:99], v13 offset:53760
 v_mfma_f32_16x16x32_bf16 a[116:119], v[68:71], v[44:47], a[116:119]
 v_mfma_f32_16x16x32_bf16 a[112:115], v[64:67], v[44:47], a[112:115]
 ds_read_b64_tr_b16 v[100:101], v14 offset:53248
 v_mfma_f32_16x16x32_bf16 a[108:111], v[60:63], v[44:47], a[108:111]
 v_mfma_f32_16x16x32_bf16 a[104:107], v[56:59], v[44:47], a[104:107]
 ds_read_b64_tr_b16 v[102:103], v14 offset:53760
 v_mfma_f32_16x16x32_bf16 a[100:103], v[52:55], v[44:47], a[100:103]
 v_mfma_f32_16x16x32_bf16 a[96:99], v[48:51], v[44:47], a[96:99]
 s_waitcnt lgkmcnt(7)
 v_mfma_f32_16x16x32_bf16 a[128:131], v[48:51], v[32:35], a[128:131]
 ds_read_b128 v[40:43], v17 offset:12288
 v_mfma_f32_16x16x32_bf16 a[132:135], v[52:55], v[32:35], a[132:135]
 ds_read_b64_tr_b16 v[104:105], v15 offset:53248
 v_mfma_f32_16x16x32_bf16 a[136:139], v[56:59], v[32:35], a[136:139]
 s_add_u32 m0, s78, 32768
 v_mfma_f32_16x16x32_bf16 a[140:143], v[60:63], v[32:35], a[140:143]
 ds_read_b64_tr_b16 v[106:107], v15 offset:53760
 v_mfma_f32_16x16x32_bf16 a[144:147], v[64:67], v[32:35], a[144:147]
 v_mfma_f32_16x16x32_bf16 a[148:151], v[68:71], v[32:35], a[148:151]
 ds_read_b64_tr_b16 v[108:109], v16 offset:53248
 v_mfma_f32_16x16x32_bf16 a[152:155], v[72:75], v[32:35], a[152:155]
 v_mfma_f32_16x16x32_bf16 a[156:159], v[76:79], v[32:35], a[156:159]
 s_waitcnt lgkmcnt(7)
 buffer_store_dwordx4 v[180:183], v21, s[36:39], s10 offen offset:1024 sc1
 v_mfma_f32_16x16x32_bf16 a[188:191], v[76:79], v[36:39], a[188:191]
 ds_read_b128 v[44:47], v17 offset:14336
 v_mfma_f32_16x16x32_bf16 a[184:187], v[72:75], v[36:39], a[184:187]
 ds_read_b64_tr_b16 v[110:111], v16 offset:53760
 v_mfma_f32_16x16x32_bf16 a[180:183], v[68:71], v[36:39], a[180:183]
 v_mfma_f32_16x16x32_bf16 a[176:179], v[64:67], v[36:39], a[176:179]
 v_mfma_f32_16x16x32_bf16 a[172:175], v[60:63], v[36:39], a[172:175]
 v_mfma_f32_16x16x32_bf16 a[168:171], v[56:59], v[36:39], a[168:171]
 v_mfma_f32_16x16x32_bf16 a[164:167], v[52:55], v[36:39], a[164:167]
 v_mfma_f32_16x16x32_bf16 a[160:163], v[48:51], v[36:39], a[160:163]
 s_waitcnt lgkmcnt(5)
 v_mfma_f32_16x16x32_bf16 a[192:195], v[48:51], v[40:43], a[192:195]
 ds_read_b128 v[32:35], v18 offset:0
 v_mfma_f32_16x16x32_bf16 a[196:199], v[52:55], v[40:43], a[196:199]
 v_mfma_f32_16x16x32_bf16 a[200:203], v[56:59], v[40:43], a[200:203]
 v_mfma_f32_16x16x32_bf16 a[204:207], v[60:63], v[40:43], a[204:207]
 v_mfma_f32_16x16x32_bf16 a[208:211], v[64:67], v[40:43], a[208:211]
 v_mfma_f32_16x16x32_bf16 a[212:215], v[68:71], v[40:43], a[212:215]
 v_mfma_f32_16x16x32_bf16 a[216:219], v[72:75], v[40:43], a[216:219]
 v_mfma_f32_16x16x32_bf16 a[220:223], v[76:79], v[40:43], a[220:223]
 s_waitcnt lgkmcnt(2)
 buffer_store_dwordx4 v[188:191], v21, s[36:39], s10 offen offset:3072 sc1
 v_mfma_f32_16x16x32_bf16 a[252:255], v[76:79], v[44:47], a[252:255]
 ds_read_b128 v[36:39], v18 offset:2048
 v_mfma_f32_16x16x32_bf16 a[248:251], v[72:75], v[44:47], a[248:251]
 v_mfma_f32_16x16x32_bf16 a[244:247], v[68:71], v[44:47], a[244:247]
 v_mfma_f32_16x16x32_bf16 a[240:243], v[64:67], v[44:47], a[240:243]
 v_mfma_f32_16x16x32_bf16 a[236:239], v[60:63], v[44:47], a[236:239]
 v_mfma_f32_16x16x32_bf16 a[232:235], v[56:59], v[44:47], a[232:235]
 v_mfma_f32_16x16x32_bf16 a[228:231], v[52:55], v[44:47], a[228:231]
 s_add_u32 s70, s70, s71
 v_mfma_f32_16x16x32_bf16 a[224:227], v[48:51], v[44:47], a[224:227]
 s_waitcnt vmcnt(10) lgkmcnt(1)
 v_mfma_f32_16x16x32_bf16 a[0:3], v[80:83], v[32:35], a[0:3]
 s_barrier
 ds_read_b128 v[40:43], v18 offset:4096
 v_mfma_f32_16x16x32_bf16 a[4:7], v[84:87], v[32:35], a[4:7]
 ds_read_b64_tr_b16 v[48:49], v13 offset:0
 v_mfma_f32_16x16x32_bf16 a[8:11], v[88:91], v[32:35], a[8:11]
 s_add_u32 m0, s72, s77
 v_mfma_f32_16x16x32_bf16 a[12:15], v[92:95], v[32:35], a[12:15]
 ds_read_b64_tr_b16 v[50:51], v13 offset:512
 v_mfma_f32_16x16x32_bf16 a[16:19], v[96:99], v[32:35], a[16:19]
 v_mfma_f32_16x16x32_bf16 a[20:23], v[100:103], v[32:35], a[20:23]
 ds_read_b64_tr_b16 v[52:53], v14 offset:0
 v_mfma_f32_16x16x32_bf16 a[24:27], v[104:107], v[32:35], a[24:27]
 v_mfma_f32_16x16x32_bf16 a[28:31], v[108:111], v[32:35], a[28:31]
 s_waitcnt lgkmcnt(4)
 buffer_store_dwordx4 v[192:195], v21, s[36:39], s11 offen offset:0 sc1
 v_mfma_f32_16x16x32_bf16 a[60:63], v[108:111], v[36:39], a[60:63]
 ds_read_b128 v[44:47], v18 offset:6144
 v_mfma_f32_16x16x32_bf16 a[56:59], v[104:107], v[36:39], a[56:59]
 ds_read_b64_tr_b16 v[54:55], v14 offset:512
 v_mfma_f32_16x16x32_bf16 a[52:55], v[100:103], v[36:39], a[52:55]
 v_add_u32 v17, s74, v19
 v_mfma_f32_16x16x32_bf16 a[48:51], v[96:99], v[36:39], a[48:51]
 ds_read_b64_tr_b16 v[56:57], v15 offset:0
 v_mfma_f32_16x16x32_bf16 a[44:47], v[92:95], v[36:39], a[44:47]
 v_mfma_f32_16x16x32_bf16 a[40:43], v[88:91], v[36:39], a[40:43]
 ds_read_b64_tr_b16 v[58:59], v15 offset:512
 v_mfma_f32_16x16x32_bf16 a[36:39], v[84:87], v[36:39], a[36:39]
 v_mfma_f32_16x16x32_bf16 a[32:35], v[80:83], v[36:39], a[32:35]
 s_waitcnt lgkmcnt(7)
 v_mfma_f32_16x16x32_bf16 a[64:67], v[80:83], v[40:43], a[64:67]
 ds_read_b128 v[32:35], v18 offset:8192
 v_mfma_f32_16x16x32_bf16 a[68:71], v[84:87], v[40:43], a[68:71]
 ds_read_b64_tr_b16 v[60:61], v16 offset:0
 v_mfma_f32_16x16x32_bf16 a[72:75], v[88:91], v[40:43], a[72:75]
 v_mfma_f32_16x16x32_bf16 a[76:79], v[92:95], v[40:43], a[76:79]
 ds_read_b64_tr_b16 v[62:63], v16 offset:512
 v_mfma_f32_16x16x32_bf16 a[80:83], v[96:99], v[40:43], a[80:83]
 v_mfma_f32_16x16x32_bf16 a[84:87], v[100:103], v[40:43], a[84:87]
 ds_read_b64_tr_b16 v[64:65], v13 offset:4096
 v_mfma_f32_16x16x32_bf16 a[88:91], v[104:107], v[40:43], a[88:91]
 v_mfma_f32_16x16x32_bf16 a[92:95], v[108:111], v[40:43], a[92:95]
 s_waitcnt lgkmcnt(7)
 buffer_store_dwordx4 v[200:203], v21, s[36:39], s11 offen offset:2048 sc1
 v_mfma_f32_16x16x32_bf16 a[124:127], v[108:111], v[44:47], a[124:127]
 ds_read_b128 v[36:39], v18 offset:10240
 v_mfma_f32_16x16x32_bf16 a[120:123], v[104:107], v[44:47], a[120:123]
 ds_read_b64_tr_b16 v[66:67], v13 offset:4608
 v_mfma_f32_16x16x32_bf16 a[116:119], v[100:103], v[44:47], a[116:119]
 v_mfma_f32_16x16x32_bf16 a[112:115], v[96:99], v[44:47], a[112:115]
 ds_read_b64_tr_b16 v[68:69], v14 offset:4096
 v_mfma_f32_16x16x32_bf16 a[108:111], v[92:95], v[44:47], a[108:111]
 v_mfma_f32_16x16x32_bf16 a[104:107], v[88:91], v[44:47], a[104:107]
 ds_read_b64_tr_b16 v[70:71], v14 offset:4608
 v_mfma_f32_16x16x32_bf16 a[100:103], v[84:87], v[44:47], a[100:103]
 s_add_u32 s69, s69, 128
 v_mfma_f32_16x16x32_bf16 a[96:99], v[80:83], v[44:47], a[96:99]
 s_waitcnt lgkmcnt(7)
 v_mfma_f32_16x16x32_bf16 a[128:131], v[80:83], v[32:35], a[128:131]
 ds_read_b128 v[40:43], v18 offset:12288
 v_mfma_f32_16x16x32_bf16 a[132:135], v[84:87], v[32:35], a[132:135]
 ds_read_b64_tr_b16 v[72:73], v15 offset:4096
 v_mfma_f32_16x16x32_bf16 a[136:139], v[88:91], v[32:35], a[136:139]
 s_add_u32 m0, s78, 49152
 v_mfma_f32_16x16x32_bf16 a[140:143], v[92:95], v[32:35], a[140:143]
 ds_read_b64_tr_b16 v[74:75], v15 offset:4608
 v_mfma_f32_16x16x32_bf16 a[144:147], v[96:99], v[32:35], a[144:147]
 v_mfma_f32_16x16x32_bf16 a[148:151], v[100:103], v[32:35], a[148:151]
 ds_read_b64_tr_b16 v[76:77], v16 offset:4096
 v_mfma_f32_16x16x32_bf16 a[152:155], v[104:107], v[32:35], a[152:155]
 v_mfma_f32_16x16x32_bf16 a[156:159], v[108:111], v[32:35], a[156:159]
 s_waitcnt lgkmcnt(7)
 buffer_store_dwordx4 v[196:199], v21, s[36:39], s11 offen offset:1024 sc1
 v_mfma_f32_16x16x32_bf16 a[188:191], v[108:111], v[36:39], a[188:191]
 ds_read_b128 v[44:47], v18 offset:14336
 v_mfma_f32_16x16x32_bf16 a[184:187], v[104:107], v[36:39], a[184:187]
 ds_read_b64_tr_b16 v[78:79], v16 offset:4608
 v_mfma_f32_16x16x32_bf16 a[180:183], v[100:103], v[36:39], a[180:183]
 v_mfma_f32_16x16x32_bf16 a[176:179], v[96:99], v[36:39], a[176:179]
 v_mfma_f32_16x16x32_bf16 a[172:175], v[92:95], v[36:39], a[172:175]
 v_mfma_f32_16x16x32_bf16 a[168:171], v[88:91], v[36:39], a[168:171]
 v_mfma_f32_16x16x32_bf16 a[164:167], v[84:87], v[36:39], a[164:167]
 v_mfma_f32_16x16x32_bf16 a[160:163], v[80:83], v[36:39], a[160:163]
 s_waitcnt lgkmcnt(5)
 v_mfma_f32_16x16x32_bf16 a[192:195], v[80:83], v[40:43], a[192:195]
 ds_read_b128 v[32:35], v17 offset:0
 v_mfma_f32_16x16x32_bf16 a[196:199], v[84:87], v[40:43], a[196:199]
 v_mfma_f32_16x16x32_bf16 a[200:203], v[88:91], v[40:43], a[200:203]
 s_mov_b32 s75, s72
 s_mov_b32 s72, s73
 v_mfma_f32_16x16x32_bf16 a[204:207], v[92:95], v[40:43], a[204:207]
 v_mfma_f32_16x16x32_bf16 a[208:211], v[96:99], v[40:43], a[208:211]
 v_mfma_f32_16x16x32_bf16 a[212:215], v[100:103], v[40:43], a[212:215]
 v_mfma_f32_16x16x32_bf16 a[216:219], v[104:107], v[40:43], a[216:219]
 v_mfma_f32_16x16x32_bf16 a[220:223], v[108:111], v[40:43], a[220:223]
 s_waitcnt lgkmcnt(2)
 buffer_store_dwordx4 v[204:207], v21, s[36:39], s11 offen offset:3072 sc1
 v_mfma_f32_16x16x32_bf16 a[252:255], v[108:111], v[44:47], a[252:255]
 ds_read_b128 v[36:39], v17 offset:2048
 v_mfma_f32_16x16x32_bf16 a[248:251], v[104:107], v[44:47], a[248:251]
 v_mfma_f32_16x16x32_bf16 a[244:247], v[100:103], v[44:47], a[244:247]
 s_mov_b32 s73, s74
 s_mov_b32 s74, s75
 v_mfma_f32_16x16x32_bf16 a[240:243], v[96:99], v[44:47], a[240:243]
 v_mfma_f32_16x16x32_bf16 a[236:239], v[92:95], v[44:47], a[236:239]
 v_mfma_f32_16x16x32_bf16 a[232:235], v[88:91], v[44:47], a[232:235]
 v_mfma_f32_16x16x32_bf16 a[228:231], v[84:87], v[44:47], a[228:231]
 s_add_u32 s70, s70, s71
 v_mfma_f32_16x16x32_bf16 a[224:227], v[80:83], v[44:47], a[224:227]
 s_waitcnt vmcnt(8) lgkmcnt(1)
 v_mfma_f32_16x16x32_bf16 a[0:3], v[48:51], v[32:35], a[0:3]
 s_barrier
 ds_read_b128 v[40:43], v17 offset:4096
 v_mfma_f32_16x16x32_bf16 a[4:7], v[52:55], v[32:35], a[4:7]
 ds_read_b64_tr_b16 v[80:81], v13 offset:16384
 v_mfma_f32_16x16x32_bf16 a[8:11], v[56:59], v[32:35], a[8:11]
 s_add_u32 m0, s72, s76
 v_mfma_f32_16x16x32_bf16 a[12:15], v[60:63], v[32:35], a[12:15]
 ds_read_b64_tr_b16 v[82:83], v13 offset:16896
 v_mfma_f32_16x16x32_bf16 a[16:19], v[64:67], v[32:35], a[16:19]
 v_mfma_f32_16x16x32_bf16 a[20:23], v[68:71], v[32:35], a[20:23]
 ds_read_b64_tr_b16 v[84:85], v14 offset:16384
 v_mfma_f32_16x16x32_bf16 a[24:27], v[72:75], v[32:35], a[24:27]
 v_mfma_f32_16x16x32_bf16 a[28:31], v[76:79], v[32:35], a[28:31]
 s_waitcnt lgkmcnt(4)
 buffer_store_dwordx4 v[208:211], v21, s[36:39], s12 offen offset:0 sc1
 v_mfma_f32_16x16x32_bf16 a[60:63], v[76:79], v[36:39], a[60:63]
 ds_read_b128 v[44:47], v17 offset:6144
 v_mfma_f32_16x16x32_bf16 a[56:59], v[72:75], v[36:39], a[56:59]
 ds_read_b64_tr_b16 v[86:87], v14 offset:16896
 v_mfma_f32_16x16x32_bf16 a[52:55], v[68:71], v[36:39], a[52:55]
 v_add_u32 v18, s73, v20
 v_mfma_f32_16x16x32_bf16 a[48:51], v[64:67], v[36:39], a[48:51]
 ds_read_b64_tr_b16 v[88:89], v15 offset:16384
 v_mfma_f32_16x16x32_bf16 a[44:47], v[60:63], v[36:39], a[44:47]
 v_mfma_f32_16x16x32_bf16 a[40:43], v[56:59], v[36:39], a[40:43]
 ds_read_b64_tr_b16 v[90:91], v15 offset:16896
 v_mfma_f32_16x16x32_bf16 a[36:39], v[52:55], v[36:39], a[36:39]
 v_mfma_f32_16x16x32_bf16 a[32:35], v[48:51], v[36:39], a[32:35]
 s_waitcnt lgkmcnt(7)
 v_mfma_f32_16x16x32_bf16 a[64:67], v[48:51], v[40:43], a[64:67]
 ds_read_b128 v[32:35], v17 offset:8192
 v_mfma_f32_16x16x32_bf16 a[68:71], v[52:55], v[40:43], a[68:71]
 ds_read_b64_tr_b16 v[92:93], v16 offset:16384
 v_mfma_f32_16x16x32_bf16 a[72:75], v[56:59], v[40:43], a[72:75]
 v_mfma_f32_16x16x32_bf16 a[76:79], v[60:63], v[40:43], a[76:79]
 ds_read_b64_tr_b16 v[94:95], v16 offset:16896
 v_mfma_f32_16x16x32_bf16 a[80:83], v[64:67], v[40:43], a[80:83]
 v_mfma_f32_16x16x32_bf16 a[84:87], v[68:71], v[40:43], a[84:87]
 ds_read_b64_tr_b16 v[96:97], v13 offset:20480
 v_mfma_f32_16x16x32_bf16 a[88:91], v[72:75], v[40:43], a[88:91]
 v_mfma_f32_16x16x32_bf16 a[92:95], v[76:79], v[40:43], a[92:95]
 s_waitcnt lgkmcnt(7)
 buffer_store_dwordx4 v[216:219], v21, s[36:39], s12 offen offset:2048 sc1
 v_mfma_f32_16x16x32_bf16 a[124:127], v[76:79], v[44:47], a[124:127]
 ds_read_b128 v[36:39], v17 offset:10240
 v_mfma_f32_16x16x32_bf16 a[120:123], v[72:75], v[44:47], a[120:123]
 ds_read_b64_tr_b16 v[98:99], v13 offset:20992
 v_mfma_f32_16x16x32_bf16 a[116:119], v[68:71], v[44:47], a[116:119]
 v_mfma_f32_16x16x32_bf16 a[112:115], v[64:67], v[44:47], a[112:115]
 ds_read_b64_tr_b16 v[100:101], v14 offset:20480
 v_mfma_f32_16x16x32_bf16 a[108:111], v[60:63], v[44:47], a[108:111]
 v_mfma_f32_16x16x32_bf16 a[104:107], v[56:59], v[44:47], a[104:107]
 ds_read_b64_tr_b16 v[102:103], v14 offset:20992
 v_mfma_f32_16x16x32_bf16 a[100:103], v[52:55], v[44:47], a[100:103]
 v_mfma_f32_16x16x32_bf16 a[96:99], v[48:51], v[44:47], a[96:99]
 s_waitcnt lgkmcnt(7)
 v_mfma_f32_16x16x32_bf16 a[128:131], v[48:51], v[32:35], a[128:131]
 ds_read_b128 v[40:43], v17 offset:12288
 v_mfma_f32_16x16x32_bf16 a[132:135], v[52:55], v[32:35], a[132:135]
 ds_read_b64_tr_b16 v[104:105], v15 offset:20480
 v_mfma_f32_16x16x32_bf16 a[136:139], v[56:59], v[32:35], a[136:139]
 s_add_u32 m0, s78, 0
 v_mfma_f32_16x16x32_bf16 a[140:143], v[60:63], v[32:35], a[140:143]
 ds_read_b64_tr_b16 v[106:107], v15 offset:20992
 v_mfma_f32_16x16x32_bf16 a[144:147], v[64:67], v[32:35], a[144:147]
 v_mfma_f32_16x16x32_bf16 a[148:151], v[68:71], v[32:35], a[148:151]
 ds_read_b64_tr_b16 v[108:109], v16 offset:20480
 v_mfma_f32_16x16x32_bf16 a[152:155], v[72:75], v[32:35], a[152:155]
 v_mfma_f32_16x16x32_bf16 a[156:159], v[76:79], v[32:35], a[156:159]
 s_waitcnt lgkmcnt(7)
 buffer_store_dwordx4 v[212:215], v21, s[36:39], s12 offen offset:1024 sc1
 v_mfma_f32_16x16x32_bf16 a[188:191], v[76:79], v[36:39], a[188:191]
 ds_read_b128 v[44:47], v17 offset:14336
 v_mfma_f32_16x16x32_bf16 a[184:187], v[72:75], v[36:39], a[184:187]
 ds_read_b64_tr_b16 v[110:111], v16 offset:20992
 v_mfma_f32_16x16x32_bf16 a[180:183], v[68:71], v[36:39], a[180:183]
 v_mfma_f32_16x16x32_bf16 a[176:179], v[64:67], v[36:39], a[176:179]
 v_mfma_f32_16x16x32_bf16 a[172:175], v[60:63], v[36:39], a[172:175]
 v_mfma_f32_16x16x32_bf16 a[168:171], v[56:59], v[36:39], a[168:171]
 v_mfma_f32_16x16x32_bf16 a[164:167], v[52:55], v[36:39], a[164:167]
 v_mfma_f32_16x16x32_bf16 a[160:163], v[48:51], v[36:39], a[160:163]
 s_waitcnt lgkmcnt(5)
 v_mfma_f32_16x16x32_bf16 a[192:195], v[48:51], v[40:43], a[192:195]
 ds_read_b128 v[32:35], v18 offset:0
 v_mfma_f32_16x16x32_bf16 a[196:199], v[52:55], v[40:43], a[196:199]
 v_mfma_f32_16x16x32_bf16 a[200:203], v[56:59], v[40:43], a[200:203]
 v_mfma_f32_16x16x32_bf16 a[204:207], v[60:63], v[40:43], a[204:207]
 v_mfma_f32_16x16x32_bf16 a[208:211], v[64:67], v[40:43], a[208:211]
 v_mfma_f32_16x16x32_bf16 a[212:215], v[68:71], v[40:43], a[212:215]
 v_mfma_f32_16x16x32_bf16 a[216:219], v[72:75], v[40:43], a[216:219]
 v_mfma_f32_16x16x32_bf16 a[220:223], v[76:79], v[40:43], a[220:223]
 s_waitcnt lgkmcnt(2)
 buffer_store_dwordx4 v[220:223], v21, s[36:39], s12 offen offset:3072 sc1
 v_mfma_f32_16x16x32_bf16 a[252:255], v[76:79], v[44:47], a[252:255]
 ds_read_b128 v[36:39], v18 offset:2048
 v_mfma_f32_16x16x32_bf16 a[248:251], v[72:75], v[44:47], a[248:251]
 v_mfma_f32_16x16x32_bf16 a[244:247], v[68:71], v[44:47], a[244:247]
 v_mfma_f32_16x16x32_bf16 a[240:243], v[64:67], v[44:47], a[240:243]
 v_mfma_f32_16x16x32_bf16 a[236:239], v[60:63], v[44:47], a[236:239]
 v_mfma_f32_16x16x32_bf16 a[232:235], v[56:59], v[44:47], a[232:235]
 v_mfma_f32_16x16x32_bf16 a[228:231], v[52:55], v[44:47], a[228:231]
 s_add_u32 s70, s70, s71
 v_mfma_f32_16x16x32_bf16 a[224:227], v[48:51], v[44:47], a[224:227]
 s_waitcnt lgkmcnt(1)
 v_mfma_f32_16x16x32_bf16 a[0:3], v[80:83], v[32:35], a[0:3]
 s_barrier
 ds_read_b128 v[40:43], v18 offset:4096
 v_mfma_f32_16x16x32_bf16 a[4:7], v[84:87], v[32:35], a[4:7]
 v_mfma_f32_16x16x32_bf16 a[8:11], v[88:91], v[32:35], a[8:11]
 s_add_u32 m0, s72, s77
 v_mfma_f32_16x16x32_bf16 a[12:15], v[92:95], v[32:35], a[12:15]
 v_mfma_f32_16x16x32_bf16 a[16:19], v[96:99], v[32:35], a[16:19]
 v_mfma_f32_16x16x32_bf16 a[20:23], v[100:103], v[32:35], a[20:23]
 v_mfma_f32_16x16x32_bf16 a[24:27], v[104:107], v[32:35], a[24:27]
 v_mfma_f32_16x16x32_bf16 a[28:31], v[108:111], v[32:35], a[28:31]
 s_waitcnt lgkmcnt(1)
 buffer_store_dwordx4 v[224:227], v21, s[36:39], s13 offen offset:0 sc1
 v_mfma_f32_16x16x32_bf16 a[60:63], v[108:111], v[36:39], a[60:63]
 ds_read_b128 v[44:47], v18 offset:6144
 v_mfma_f32_16x16x32_bf16 a[56:59], v[104:107], v[36:39], a[56:59]
 v_mfma_f32_16x16x32_bf16 a[52:55], v[100:103], v[36:39], a[52:55]
 v_add_u32 v17, s74, v19
 v_mfma_f32_16x16x32_bf16 a[48:51], v[96:99], v[36:39], a[48:51]
 v_mfma_f32_16x16x32_bf16 a[44:47], v[92:95], v[36:39], a[44:47]
 s_cmp_lg_u32 s68, 0
 s_cbranch_scc1 gated_mix__compressed_kv_cla__glu_gated_swiglu__prompt_kernel_np4
 buffer_load_dwordx2 v[22:23], v30, s[36:39], 0 offen sc1
gated_mix__compressed_kv_cla__glu_gated_swiglu__prompt_kernel_np4:
 v_mfma_f32_16x16x32_bf16 a[40:43], v[88:91], v[36:39], a[40:43]
 v_mfma_f32_16x16x32_bf16 a[36:39], v[84:87], v[36:39], a[36:39]
 v_mfma_f32_16x16x32_bf16 a[32:35], v[80:83], v[36:39], a[32:35]
 s_waitcnt lgkmcnt(1)
 v_mfma_f32_16x16x32_bf16 a[64:67], v[80:83], v[40:43], a[64:67]
 ds_read_b128 v[32:35], v18 offset:8192
 v_mfma_f32_16x16x32_bf16 a[68:71], v[84:87], v[40:43], a[68:71]
 v_mfma_f32_16x16x32_bf16 a[72:75], v[88:91], v[40:43], a[72:75]
 v_mfma_f32_16x16x32_bf16 a[76:79], v[92:95], v[40:43], a[76:79]
 v_mfma_f32_16x16x32_bf16 a[80:83], v[96:99], v[40:43], a[80:83]
 v_mfma_f32_16x16x32_bf16 a[84:87], v[100:103], v[40:43], a[84:87]
 v_mfma_f32_16x16x32_bf16 a[88:91], v[104:107], v[40:43], a[88:91]
 v_mfma_f32_16x16x32_bf16 a[92:95], v[108:111], v[40:43], a[92:95]
 s_waitcnt lgkmcnt(1)
 buffer_store_dwordx4 v[232:235], v21, s[36:39], s13 offen offset:2048 sc1
 v_mfma_f32_16x16x32_bf16 a[124:127], v[108:111], v[44:47], a[124:127]
 ds_read_b128 v[36:39], v18 offset:10240
 v_mfma_f32_16x16x32_bf16 a[120:123], v[104:107], v[44:47], a[120:123]
 v_mfma_f32_16x16x32_bf16 a[116:119], v[100:103], v[44:47], a[116:119]
 v_mfma_f32_16x16x32_bf16 a[112:115], v[96:99], v[44:47], a[112:115]
 v_mfma_f32_16x16x32_bf16 a[108:111], v[92:95], v[44:47], a[108:111]
 v_mfma_f32_16x16x32_bf16 a[104:107], v[88:91], v[44:47], a[104:107]
 v_mfma_f32_16x16x32_bf16 a[100:103], v[84:87], v[44:47], a[100:103]
 s_add_u32 s69, s69, 128
 v_mfma_f32_16x16x32_bf16 a[96:99], v[80:83], v[44:47], a[96:99]
 s_waitcnt lgkmcnt(1)
 v_mfma_f32_16x16x32_bf16 a[128:131], v[80:83], v[32:35], a[128:131]
 ds_read_b128 v[40:43], v18 offset:12288
 v_mfma_f32_16x16x32_bf16 a[132:135], v[84:87], v[32:35], a[132:135]
 v_mfma_f32_16x16x32_bf16 a[136:139], v[88:91], v[32:35], a[136:139]
 s_add_u32 m0, s78, 16384
 v_mfma_f32_16x16x32_bf16 a[140:143], v[92:95], v[32:35], a[140:143]
 v_mfma_f32_16x16x32_bf16 a[144:147], v[96:99], v[32:35], a[144:147]
 v_mfma_f32_16x16x32_bf16 a[148:151], v[100:103], v[32:35], a[148:151]
 v_mfma_f32_16x16x32_bf16 a[152:155], v[104:107], v[32:35], a[152:155]
 v_mfma_f32_16x16x32_bf16 a[156:159], v[108:111], v[32:35], a[156:159]
 s_waitcnt lgkmcnt(1)
 buffer_store_dwordx4 v[228:231], v21, s[36:39], s13 offen offset:1024 sc1
 v_mfma_f32_16x16x32_bf16 a[188:191], v[108:111], v[36:39], a[188:191]
 ds_read_b128 v[44:47], v18 offset:14336
 v_mfma_f32_16x16x32_bf16 a[184:187], v[104:107], v[36:39], a[184:187]
 v_mfma_f32_16x16x32_bf16 a[180:183], v[100:103], v[36:39], a[180:183]
 v_mfma_f32_16x16x32_bf16 a[176:179], v[96:99], v[36:39], a[176:179]
 v_mfma_f32_16x16x32_bf16 a[172:175], v[92:95], v[36:39], a[172:175]
 v_mfma_f32_16x16x32_bf16 a[168:171], v[88:91], v[36:39], a[168:171]
 v_mfma_f32_16x16x32_bf16 a[164:167], v[84:87], v[36:39], a[164:167]
 v_mfma_f32_16x16x32_bf16 a[160:163], v[80:83], v[36:39], a[160:163]
 s_waitcnt lgkmcnt(1)
 v_mfma_f32_16x16x32_bf16 a[192:195], v[80:83], v[40:43], a[192:195]
 v_mfma_f32_16x16x32_bf16 a[196:199], v[84:87], v[40:43], a[196:199]
 v_mfma_f32_16x16x32_bf16 a[200:203], v[88:91], v[40:43], a[200:203]
 s_mov_b32 s75, s72
 s_mov_b32 s72, s73
 v_mfma_f32_16x16x32_bf16 a[204:207], v[92:95], v[40:43], a[204:207]
 v_mfma_f32_16x16x32_bf16 a[208:211], v[96:99], v[40:43], a[208:211]
 v_mfma_f32_16x16x32_bf16 a[212:215], v[100:103], v[40:43], a[212:215]
 v_mfma_f32_16x16x32_bf16 a[216:219], v[104:107], v[40:43], a[216:219]
 v_mfma_f32_16x16x32_bf16 a[220:223], v[108:111], v[40:43], a[220:223]
 s_waitcnt lgkmcnt(0)
 buffer_store_dwordx4 v[236:239], v21, s[36:39], s13 offen offset:3072 sc1
 v_mfma_f32_16x16x32_bf16 a[252:255], v[108:111], v[44:47], a[252:255]
 v_mfma_f32_16x16x32_bf16 a[248:251], v[104:107], v[44:47], a[248:251]
 v_mfma_f32_16x16x32_bf16 a[244:247], v[100:103], v[44:47], a[244:247]
 s_mov_b32 s73, s74
 s_mov_b32 s74, s75
 v_mfma_f32_16x16x32_bf16 a[240:243], v[96:99], v[44:47], a[240:243]
 v_mfma_f32_16x16x32_bf16 a[236:239], v[92:95], v[44:47], a[236:239]
 v_mfma_f32_16x16x32_bf16 a[232:235], v[88:91], v[44:47], a[232:235]
 v_mfma_f32_16x16x32_bf16 a[228:231], v[84:87], v[44:47], a[228:231]
 s_add_u32 s70, s70, s71
 v_mfma_f32_16x16x32_bf16 a[224:227], v[80:83], v[44:47], a[224:227]
 s_cmp_lg_u32 s68, 0
 s_cbranch_scc1 gated_mix__compressed_kv_cla__glu_gated_swiglu__prompt_kernel_np5
 s_waitcnt vmcnt(3)
 s_mov_b32 s99, 1048576
gated_mix__compressed_kv_cla__glu_gated_swiglu__prompt_kernel_poll6:
 v_cmp_eq_u64 vcc, v[22:23], v[28:29]
 s_nop 3
 s_and_b32 vcc_lo, vcc_lo, 0xff
 s_cmp_eq_u32 vcc_lo, 0xff
 s_cbranch_scc1 gated_mix__compressed_kv_cla__glu_gated_swiglu__prompt_kernel_ok7
 s_sub_u32 s99, s99, 1
 s_cbranch_scc1 gated_mix__compressed_kv_cla__glu_gated_swiglu__prompt_kernel_ok7
 s_sleep 12
 buffer_load_dwordx2 v[22:23], v30, s[36:39], 0 offen sc1
 s_waitcnt vmcnt(0)
 s_branch gated_mix__compressed_kv_cla__glu_gated_swiglu__prompt_kernel_poll6
gated_mix__compressed_kv_cla__glu_gated_swiglu__prompt_kernel_ok7:
gated_mix__compressed_kv_cla__glu_gated_swiglu__prompt_kernel_np5:
 s_barrier
 s_mov_b32 s52, s14
 s_mov_b32 s53, s16
 s_getpc_b64 s[96:97]
gated_mix__compressed_kv_cla__glu_gated_swiglu__prompt_kernel_pc8:
 s_sub_u32 s96, s96, gated_mix__compressed_kv_cla__glu_gated_swiglu__prompt_kernel_pc8-gated_mix__compressed_kv_cla__glu_gated_swiglu__prompt_kernel_pc
 s_subb_u32 s97, s97, 0
 global_load_dword v31, v27, s[96:97]
 s_lshl_b32 s91, s82, 21
 s_add_u32 s20, s36, s91
 s_addc_u32 s21, s37, 0
 s_mov_b32 s22, 2097152
 s_mov_b32 s24, s20
 s_mov_b32 s25, s21
 s_lshl_b32 s92, s68, 12
 v_add_u32 v3, s92, v21
 s_add_u32 s76, s92, 0
 s_add_u32 s77, s92, 65536
 s_lshl_b32 s91, s86, 2
 s_add_u32 s93, s91, 4
 s_add_u32 s94, s93, s85
 s_sub_u32 s95, s93, s85
 s_sub_u32 s96, s95, 8
 s_add_u32 s87, s85, 8
 s_cmp_eq_u32 s84, 0
 s_cselect_b32 s7, s94, s95
 s_cselect_b32 s8, s93, s96
 s_cselect_b32 s87, 0, s87
 s_cmp_eq_u32 s81, 0
 s_cselect_b32 s6, 8, 0
 s_cselect_b32 s17, s85, s7
 s_cselect_b32 s71, 0, 1
 s_lshl_b32 s9, s6, 15
 s_mov_b32 s11, 0
 s_mov_b32 m0, s76
 s_mov_b32 s12, 65536
 buffer_load_dwordx4 v3, s[20:23], s9 offen offset:0 sc1 lds
 buffer_load_dwordx4 v3, s[20:23], s9 offen offset:1024 sc1 lds
 buffer_load_dwordx4 v3, s[20:23], s9 offen offset:2048 sc1 lds
 buffer_load_dwordx4 v3, s[20:23], s9 offen offset:3072 sc1 lds
 v_mov_b32 v30, s54
 s_mov_b32 s88, 0xbfb8aa3b
 s_mov_b32 s89, 0xbfb8aa3b
 v_accvgpr_read_b32 v64, a0
 v_accvgpr_read_b32 v65, a1
 v_accvgpr_read_b32 v66, a2
 v_accvgpr_read_b32 v67, a3
 v_accvgpr_read_b32 v68, a4
 v_accvgpr_read_b32 v69, a5
 v_accvgpr_read_b32 v70, a6
 v_accvgpr_read_b32 v71, a7
 v_pk_mul_f32 v[80:81], v[64:65], s[88:89]
 v_pk_mul_f32 v[82:83], v[66:67], s[88:89]
 v_pk_mul_f32 v[84:85], v[68:69], s[88:89]
 v_pk_mul_f32 v[86:87], v[70:71], s[88:89]
 v_exp_f32 v80, v80
 v_exp_f32 v81, v81
 v_exp_f32 v82, v82
 v_exp_f32 v83, v83
 v_exp_f32 v84, v84
 v_exp_f32 v85, v85
 v_exp_f32 v86, v86
 v_exp_f32 v87, v87
 v_accvgpr_read_b32 v72, a16
 v_accvgpr_read_b32 v73, a17
 v_accvgpr_read_b32 v74, a18
 v_accvgpr_read_b32 v75, a19
 v_accvgpr_read_b32 v76, a20
 v_accvgpr_read_b32 v77, a21
 v_accvgpr_read_b32 v78, a22
 v_accvgpr_read_b32 v79, a23
 v_pk_add_f32 v[80:81], v[80:81], 1.0 op_sel_hi:[1,0]
 v_pk_add_f32 v[82:83], v[82:83], 1.0 op_sel_hi:[1,0]
 v_pk_add_f32 v[84:85], v[84:85], 1.0 op_sel_hi:[1,0]
 v_pk_add_f32 v[86:87], v[86:87], 1.0 op_sel_hi:[1,0]
 v_rcp_f32 v80, v80
 v_rcp_f32 v81, v81
 v_rcp_f32 v82, v82
 v_rcp_f32 v83, v83
 v_rcp_f32 v84, v84
 v_rcp_f32 v85, v85
 v_rcp_f32 v86, v86
 v_rcp_f32 v87, v87
 v_pk_mul_f32 v[64:65], v[64:65], v[72:73]
 v_pk_mul_f32 v[66:67], v[66:67], v[74:75]
 v_pk_mul_f32 v[68:69], v[68:69], v[76:77]
 v_pk_mul_f32 v[70:71], v[70:71], v[78:79]
 v_pk_mul_f32 v[64:65], v[64:65], v[80:81]
 v_pk_mul_f32 v[66:67], v[66:67], v[82:83]
 v_pk_mul_f32 v[68:69], v[68:69], v[84:85]
 v_pk_mul_f32 v[70:71], v[70:71], v[86:87]
 v_cvt_pk_bf16_f32 v176, v64, v65
 v_cvt_pk_bf16_f32 v177, v66, v67
 v_cvt_pk_bf16_f32 v178, v68, v69
 v_cvt_pk_bf16_f32 v179, v70, v71
 s_add_u32 s10, s9, 16384
 s_mov_b32 s26, s22
 s_add_u32 s6, s6, 1
 s_sub_u32 s7, s7, 1
 s_cmp_eq_u32 s7, s8
 s_cselect_b32 s6, s87, s6
 s_cmp_gt_i32 s7, 0
 s_cselect_b32 s22, s22, 0
 s_cselect_b32 s6, s6, 0
 s_lshl_b32 s9, s6, 15
 s_add_u32 s11, s11, 16384
 s_and_b32 s11, s11, 0xffff
 s_add_u32 m0, s11, s76
 s_nop 0
 buffer_load_dwordx4 v3, s[20:23], s9 offen offset:0 sc1 lds
 buffer_load_dwordx4 v3, s[20:23], s9 offen offset:1024 sc1 lds
 v_accvgpr_read_b32 v88, a8
 v_accvgpr_read_b32 v89, a9
 v_accvgpr_read_b32 v90, a10
 v_accvgpr_read_b32 v91, a11
 v_accvgpr_read_b32 v92, a12
 v_accvgpr_read_b32 v93, a13
 v_accvgpr_read_b32 v94, a14
 v_accvgpr_read_b32 v95, a15
 v_pk_mul_f32 v[104:105], v[88:89], s[88:89]
 v_pk_mul_f32 v[106:107], v[90:91], s[88:89]
 v_pk_mul_f32 v[108:109], v[92:93], s[88:89]
 v_pk_mul_f32 v[110:111], v[94:95], s[88:89]
 v_exp_f32 v104, v104
 v_exp_f32 v105, v105
 v_exp_f32 v106, v106
 v_exp_f32 v107, v107
 v_exp_f32 v108, v108
 v_exp_f32 v109, v109
 v_exp_f32 v110, v110
 v_exp_f32 v111, v111
 v_accvgpr_read_b32 v96, a24
 v_accvgpr_read_b32 v97, a25
 v_accvgpr_read_b32 v98, a26
 v_accvgpr_read_b32 v99, a27
 v_accvgpr_read_b32 v100, a28
 v_accvgpr_read_b32 v101, a29
 v_accvgpr_read_b32 v102, a30
 v_accvgpr_read_b32 v103, a31
 v_pk_add_f32 v[104:105], v[104:105], 1.0 op_sel_hi:[1,0]
 v_pk_add_f32 v[106:107], v[106:107], 1.0 op_sel_hi:[1,0]
 v_pk_add_f32 v[108:109], v[108:109], 1.0 op_sel_hi:[1,0]
 v_pk_add_f32 v[110:111], v[110:111], 1.0 op_sel_hi:[1,0]
 v_rcp_f32 v104, v104
 v_rcp_f32 v105, v105
 v_rcp_f32 v106, v106
 v_rcp_f32 v107, v107
 v_rcp_f32 v108, v108
 v_rcp_f32 v109, v109
 v_rcp_f32 v110, v110
 v_rcp_f32 v111, v111
 v_pk_mul_f32 v[88:89], v[88:89], v[96:97]
 v_pk_mul_f32 v[90:91], v[90:91], v[98:99]
 v_pk_mul_f32 v[92:93], v[92:93], v[100:101]
 v_pk_mul_f32 v[94:95], v[94:95], v[102:103]
 v_pk_mul_f32 v[88:89], v[88:89], v[104:105]
 v_pk_mul_f32 v[90:91], v[90:91], v[106:107]
 v_pk_mul_f32 v[92:93], v[92:93], v[108:109]
 v_pk_mul_f32 v[94:95], v[94:95], v[110:111]
 v_cvt_pk_bf16_f32 v180, v88, v89
 v_cvt_pk_bf16_f32 v181, v90, v91
 v_cvt_pk_bf16_f32 v182, v92, v93
 v_cvt_pk_bf16_f32 v183, v94, v95
 buffer_load_dwordx4 v3, s[20:23], s9 offen offset:2048 sc1 lds
 buffer_load_dwordx4 v3, s[20:23], s9 offen offset:3072 sc1 lds
 v_accvgpr_read_b32 v64, a32
 v_accvgpr_read_b32 v65, a33
 v_accvgpr_read_b32 v66, a34
 v_accvgpr_read_b32 v67, a35
 v_accvgpr_read_b32 v68, a36
 v_accvgpr_read_b32 v69, a37
 v_accvgpr_read_b32 v70, a38
 v_accvgpr_read_b32 v71, a39
 v_pk_mul_f32 v[80:81], v[64:65], s[88:89]
 v_pk_mul_f32 v[82:83], v[66:67], s[88:89]
 v_pk_mul_f32 v[84:85], v[68:69], s[88:89]
 v_pk_mul_f32 v[86:87], v[70:71], s[88:89]
 v_exp_f32 v80, v80
 v_exp_f32 v81, v81
 v_exp_f32 v82, v82
 v_exp_f32 v83, v83
 v_exp_f32 v84, v84
 v_exp_f32 v85, v85
 v_exp_f32 v86, v86
 v_exp_f32 v87, v87
 v_accvgpr_read_b32 v72, a48
 v_accvgpr_read_b32 v73, a49
 v_accvgpr_read_b32 v74, a50
 v_accvgpr_read_b32 v75, a51
 v_accvgpr_read_b32 v76, a52
 v_accvgpr_read_b32 v77, a53
 v_accvgpr_read_b32 v78, a54
 v_accvgpr_read_b32 v79, a55
 v_pk_add_f32 v[80:81], v[80:81], 1.0 op_sel_hi:[1,0]
 v_pk_add_f32 v[82:83], v[82:83], 1.0 op_sel_hi:[1,0]
 v_pk_add_f32 v[84:85], v[84:85], 1.0 op_sel_hi:[1,0]
 v_pk_add_f32 v[86:87], v[86:87], 1.0 op_sel_hi:[1,0]
 v_rcp_f32 v80, v80
 v_rcp_f32 v81, v81
 v_rcp_f32 v82, v82
 v_rcp_f32 v83, v83
 v_rcp_f32 v84, v84
 v_rcp_f32 v85, v85
 v_rcp_f32 v86, v86
 v_rcp_f32 v87, v87
 v_pk_mul_f32 v[64:65], v[64:65], v[72:73]
 v_pk_mul_f32 v[66:67], v[66:67], v[74:75]
 v_pk_mul_f32 v[68:69], v[68:69], v[76:77]
 v_pk_mul_f32 v[70:71], v[70:71], v[78:79]
 v_pk_mul_f32 v[64:65], v[64:65], v[80:81]
 v_pk_mul_f32 v[66:67], v[66:67], v[82:83]
 v_pk_mul_f32 v[68:69], v[68:69], v[84:85]
 v_pk_mul_f32 v[70:71], v[70:71], v[86:87]
 v_cvt_pk_bf16_f32 v184, v64, v65
 v_cvt_pk_bf16_f32 v185, v66, v67
 v_cvt_pk_bf16_f32 v186, v68, v69
 v_cvt_pk_bf16_f32 v187, v70, v71
 s_add_u32 s12, s12, 16384
 s_cmp_eq_u32 s12, 81920
 s_cselect_b32 s12, 0, s12
 s_add_u32 m0, s12, s77
 s_nop 0
 buffer_load_dwordx4 v3, s[24:27], s10 offen offset:0 sc1 lds
 buffer_load_dwordx4 v3, s[24:27], s10 offen offset:1024 sc1 lds
 v_accvgpr_read_b32 v88, a40
 v_accvgpr_read_b32 v89, a41
 v_accvgpr_read_b32 v90, a42
 v_accvgpr_read_b32 v91, a43
 v_accvgpr_read_b32 v92, a44
 v_accvgpr_read_b32 v93, a45
 v_accvgpr_read_b32 v94, a46
 v_accvgpr_read_b32 v95, a47
 v_pk_mul_f32 v[104:105], v[88:89], s[88:89]
 v_pk_mul_f32 v[106:107], v[90:91], s[88:89]
 v_pk_mul_f32 v[108:109], v[92:93], s[88:89]
 v_pk_mul_f32 v[110:111], v[94:95], s[88:89]
 v_exp_f32 v104, v104
 v_exp_f32 v105, v105
 v_exp_f32 v106, v106
 v_exp_f32 v107, v107
 v_exp_f32 v108, v108
 v_exp_f32 v109, v109
 v_exp_f32 v110, v110
 v_exp_f32 v111, v111
 v_accvgpr_read_b32 v96, a56
 v_accvgpr_read_b32 v97, a57
 v_accvgpr_read_b32 v98, a58
 v_accvgpr_read_b32 v99, a59
 v_accvgpr_read_b32 v100, a60
 v_accvgpr_read_b32 v101, a61
 v_accvgpr_read_b32 v102, a62
 v_accvgpr_read_b32 v103, a63
 v_pk_add_f32 v[104:105], v[104:105], 1.0 op_sel_hi:[1,0]
 v_pk_add_f32 v[106:107], v[106:107], 1.0 op_sel_hi:[1,0]
 v_pk_add_f32 v[108:109], v[108:109], 1.0 op_sel_hi:[1,0]
 v_pk_add_f32 v[110:111], v[110:111], 1.0 op_sel_hi:[1,0]
 v_rcp_f32 v104, v104
 v_rcp_f32 v105, v105
 v_rcp_f32 v106, v106
 v_rcp_f32 v107, v107
 v_rcp_f32 v108, v108
 v_rcp_f32 v109, v109
 v_rcp_f32 v110, v110
 v_rcp_f32 v111, v111
 v_pk_mul_f32 v[88:89], v[88:89], v[96:97]
 v_pk_mul_f32 v[90:91], v[90:91], v[98:99]
 v_pk_mul_f32 v[92:93], v[92:93], v[100:101]
 v_pk_mul_f32 v[94:95], v[94:95], v[102:103]
 v_pk_mul_f32 v[88:89], v[88:89], v[104:105]
 v_pk_mul_f32 v[90:91], v[90:91], v[106:107]
 v_pk_mul_f32 v[92:93], v[92:93], v[108:109]
 v_pk_mul_f32 v[94:95], v[94:95], v[110:111]
 v_cvt_pk_bf16_f32 v188, v88, v89
 v_cvt_pk_bf16_f32 v189, v90, v91
 v_cvt_pk_bf16_f32 v190, v92, v93
 v_cvt_pk_bf16_f32 v191, v94, v95
 buffer_load_dwordx4 v3, s[24:27], s10 offen offset:2048 sc1 lds
 buffer_load_dwordx4 v3, s[24:27], s10 offen offset:3072 sc1 lds
 v_accvgpr_read_b32 v64, a64
 v_accvgpr_read_b32 v65, a65
 v_accvgpr_read_b32 v66, a66
 v_accvgpr_read_b32 v67, a67
 v_accvgpr_read_b32 v68, a68
 v_accvgpr_read_b32 v69, a69
 v_accvgpr_read_b32 v70, a70
 v_accvgpr_read_b32 v71, a71
 v_pk_mul_f32 v[80:81], v[64:65], s[88:89]
 v_pk_mul_f32 v[82:83], v[66:67], s[88:89]
 v_pk_mul_f32 v[84:85], v[68:69], s[88:89]
 v_pk_mul_f32 v[86:87], v[70:71], s[88:89]
 v_exp_f32 v80, v80
 v_exp_f32 v81, v81
 v_exp_f32 v82, v82
 v_exp_f32 v83, v83
 v_exp_f32 v84, v84
 v_exp_f32 v85, v85
 v_exp_f32 v86, v86
 v_exp_f32 v87, v87
 v_accvgpr_read_b32 v72, a80
 v_accvgpr_read_b32 v73, a81
 v_accvgpr_read_b32 v74, a82
 v_accvgpr_read_b32 v75, a83
 v_accvgpr_read_b32 v76, a84
 v_accvgpr_read_b32 v77, a85
 v_accvgpr_read_b32 v78, a86
 v_accvgpr_read_b32 v79, a87
 v_pk_add_f32 v[80:81], v[80:81], 1.0 op_sel_hi:[1,0]
 v_pk_add_f32 v[82:83], v[82:83], 1.0 op_sel_hi:[1,0]
 v_pk_add_f32 v[84:85], v[84:85], 1.0 op_sel_hi:[1,0]
 v_pk_add_f32 v[86:87], v[86:87], 1.0 op_sel_hi:[1,0]
 v_rcp_f32 v80, v80
 v_rcp_f32 v81, v81
 v_rcp_f32 v82, v82
 v_rcp_f32 v83, v83
 v_rcp_f32 v84, v84
 v_rcp_f32 v85, v85
 v_rcp_f32 v86, v86
 v_rcp_f32 v87, v87
 v_pk_mul_f32 v[64:65], v[64:65], v[72:73]
 v_pk_mul_f32 v[66:67], v[66:67], v[74:75]
 v_pk_mul_f32 v[68:69], v[68:69], v[76:77]
 v_pk_mul_f32 v[70:71], v[70:71], v[78:79]
 v_pk_mul_f32 v[64:65], v[64:65], v[80:81]
 v_pk_mul_f32 v[66:67], v[66:67], v[82:83]
 v_pk_mul_f32 v[68:69], v[68:69], v[84:85]
 v_pk_mul_f32 v[70:71], v[70:71], v[86:87]
 v_cvt_pk_bf16_f32 v192, v64, v65
 v_cvt_pk_bf16_f32 v193, v66, v67
 v_cvt_pk_bf16_f32 v194, v68, v69
 v_cvt_pk_bf16_f32 v195, v70, v71
 s_add_u32 s10, s9, 16384
 s_mov_b32 s26, s22
 s_add_u32 s6, s6, 1
 s_sub_u32 s7, s7, 1
 s_cmp_eq_u32 s7, s8
 s_cselect_b32 s6, s87, s6
 s_cmp_gt_i32 s7, 0
 s_cselect_b32 s22, s22, 0
 s_cselect_b32 s6, s6, 0
 s_lshl_b32 s9, s6, 15
 s_add_u32 s11, s11, 16384
 s_and_b32 s11, s11, 0xffff
 s_add_u32 m0, s11, s76
 s_nop 0
 buffer_load_dwordx4 v3, s[20:23], s9 offen offset:0 sc1 lds
 buffer_load_dwordx4 v3, s[20:23], s9 offen offset:1024 sc1 lds
 v_accvgpr_read_b32 v88, a72
 v_accvgpr_read_b32 v89, a73
 v_accvgpr_read_b32 v90, a74
 v_accvgpr_read_b32 v91, a75
 v_accvgpr_read_b32 v92, a76
 v_accvgpr_read_b32 v93, a77
 v_accvgpr_read_b32 v94, a78
 v_accvgpr_read_b32 v95, a79
 v_pk_mul_f32 v[104:105], v[88:89], s[88:89]
 v_pk_mul_f32 v[106:107], v[90:91], s[88:89]
 v_pk_mul_f32 v[108:109], v[92:93], s[88:89]
 v_pk_mul_f32 v[110:111], v[94:95], s[88:89]
 v_exp_f32 v104, v104
 v_exp_f32 v105, v105
 v_exp_f32 v106, v106
 v_exp_f32 v107, v107
 v_exp_f32 v108, v108
 v_exp_f32 v109, v109
 v_exp_f32 v110, v110
 v_exp_f32 v111, v111
 v_accvgpr_read_b32 v96, a88
 v_accvgpr_read_b32 v97, a89
 v_accvgpr_read_b32 v98, a90
 v_accvgpr_read_b32 v99, a91
 v_accvgpr_read_b32 v100, a92
 v_accvgpr_read_b32 v101, a93
 v_accvgpr_read_b32 v102, a94
 v_accvgpr_read_b32 v103, a95
 v_pk_add_f32 v[104:105], v[104:105], 1.0 op_sel_hi:[1,0]
 v_pk_add_f32 v[106:107], v[106:107], 1.0 op_sel_hi:[1,0]
 v_pk_add_f32 v[108:109], v[108:109], 1.0 op_sel_hi:[1,0]
 v_pk_add_f32 v[110:111], v[110:111], 1.0 op_sel_hi:[1,0]
 v_rcp_f32 v104, v104
 v_rcp_f32 v105, v105
 v_rcp_f32 v106, v106
 v_rcp_f32 v107, v107
 v_rcp_f32 v108, v108
 v_rcp_f32 v109, v109
 v_rcp_f32 v110, v110
 v_rcp_f32 v111, v111
 v_pk_mul_f32 v[88:89], v[88:89], v[96:97]
 v_pk_mul_f32 v[90:91], v[90:91], v[98:99]
 v_pk_mul_f32 v[92:93], v[92:93], v[100:101]
 v_pk_mul_f32 v[94:95], v[94:95], v[102:103]
 v_pk_mul_f32 v[88:89], v[88:89], v[104:105]
 v_pk_mul_f32 v[90:91], v[90:91], v[106:107]
 v_pk_mul_f32 v[92:93], v[92:93], v[108:109]
 v_pk_mul_f32 v[94:95], v[94:95], v[110:111]
 v_cvt_pk_bf16_f32 v196, v88, v89
 v_cvt_pk_bf16_f32 v197, v90, v91
 v_cvt_pk_bf16_f32 v198, v92, v93
 v_cvt_pk_bf16_f32 v199, v94, v95
 buffer_load_dwordx4 v3, s[20:23], s9 offen offset:2048 sc1 lds
 buffer_load_dwordx4 v3, s[20:23], s9 offen offset:3072 sc1 lds
 v_accvgpr_read_b32 v64, a96
 v_accvgpr_read_b32 v65, a97
 v_accvgpr_read_b32 v66, a98
 v_accvgpr_read_b32 v67, a99
 v_accvgpr_read_b32 v68, a100
 v_accvgpr_read_b32 v69, a101
 v_accvgpr_read_b32 v70, a102
 v_accvgpr_read_b32 v71, a103
 v_pk_mul_f32 v[80:81], v[64:65], s[88:89]
 v_pk_mul_f32 v[82:83], v[66:67], s[88:89]
 v_pk_mul_f32 v[84:85], v[68:69], s[88:89]
 v_pk_mul_f32 v[86:87], v[70:71], s[88:89]
 v_exp_f32 v80, v80
 v_exp_f32 v81, v81
 v_exp_f32 v82, v82
 v_exp_f32 v83, v83
 v_exp_f32 v84, v84
 v_exp_f32 v85, v85
 v_exp_f32 v86, v86
 v_exp_f32 v87, v87
 v_accvgpr_read_b32 v72, a112
 v_accvgpr_read_b32 v73, a113
 v_accvgpr_read_b32 v74, a114
 v_accvgpr_read_b32 v75, a115
 v_accvgpr_read_b32 v76, a116
 v_accvgpr_read_b32 v77, a117
 v_accvgpr_read_b32 v78, a118
 v_accvgpr_read_b32 v79, a119
 v_pk_add_f32 v[80:81], v[80:81], 1.0 op_sel_hi:[1,0]
 v_pk_add_f32 v[82:83], v[82:83], 1.0 op_sel_hi:[1,0]
 v_pk_add_f32 v[84:85], v[84:85], 1.0 op_sel_hi:[1,0]
 v_pk_add_f32 v[86:87], v[86:87], 1.0 op_sel_hi:[1,0]
 v_rcp_f32 v80, v80
 v_rcp_f32 v81, v81
 v_rcp_f32 v82, v82
 v_rcp_f32 v83, v83
 v_rcp_f32 v84, v84
 v_rcp_f32 v85, v85
 v_rcp_f32 v86, v86
 v_rcp_f32 v87, v87
 v_pk_mul_f32 v[64:65], v[64:65], v[72:73]
 v_pk_mul_f32 v[66:67], v[66:67], v[74:75]
 v_pk_mul_f32 v[68:69], v[68:69], v[76:77]
 v_pk_mul_f32 v[70:71], v[70:71], v[78:79]
 v_pk_mul_f32 v[64:65], v[64:65], v[80:81]
 v_pk_mul_f32 v[66:67], v[66:67], v[82:83]
 v_pk_mul_f32 v[68:69], v[68:69], v[84:85]
 v_pk_mul_f32 v[70:71], v[70:71], v[86:87]
 v_cvt_pk_bf16_f32 v200, v64, v65
 v_cvt_pk_bf16_f32 v201, v66, v67
 v_cvt_pk_bf16_f32 v202, v68, v69
 v_cvt_pk_bf16_f32 v203, v70, v71
 s_add_u32 s12, s12, 16384
 s_cmp_eq_u32 s12, 81920
 s_cselect_b32 s12, 0, s12
 s_add_u32 m0, s12, s77
 s_nop 0
 buffer_load_dwordx4 v3, s[24:27], s10 offen offset:0 sc1 lds
 buffer_load_dwordx4 v3, s[24:27], s10 offen offset:1024 sc1 lds
 v_accvgpr_read_b32 v88, a104
 v_accvgpr_read_b32 v89, a105
 v_accvgpr_read_b32 v90, a106
 v_accvgpr_read_b32 v91, a107
 v_accvgpr_read_b32 v92, a108
 v_accvgpr_read_b32 v93, a109
 v_accvgpr_read_b32 v94, a110
 v_accvgpr_read_b32 v95, a111
 v_pk_mul_f32 v[104:105], v[88:89], s[88:89]
 v_pk_mul_f32 v[106:107], v[90:91], s[88:89]
 v_pk_mul_f32 v[108:109], v[92:93], s[88:89]
 v_pk_mul_f32 v[110:111], v[94:95], s[88:89]
 v_exp_f32 v104, v104
 v_exp_f32 v105, v105
 v_exp_f32 v106, v106
 v_exp_f32 v107, v107
 v_exp_f32 v108, v108
 v_exp_f32 v109, v109
 v_exp_f32 v110, v110
 v_exp_f32 v111, v111
 v_accvgpr_read_b32 v96, a120
 v_accvgpr_read_b32 v97, a121
 v_accvgpr_read_b32 v98, a122
 v_accvgpr_read_b32 v99, a123
 v_accvgpr_read_b32 v100, a124
 v_accvgpr_read_b32 v101, a125
 v_accvgpr_read_b32 v102, a126
 v_accvgpr_read_b32 v103, a127
 v_pk_add_f32 v[104:105], v[104:105], 1.0 op_sel_hi:[1,0]
 v_pk_add_f32 v[106:107], v[106:107], 1.0 op_sel_hi:[1,0]
 v_pk_add_f32 v[108:109], v[108:109], 1.0 op_sel_hi:[1,0]
 v_pk_add_f32 v[110:111], v[110:111], 1.0 op_sel_hi:[1,0]
 v_rcp_f32 v104, v104
 v_rcp_f32 v105, v105
 v_rcp_f32 v106, v106
 v_rcp_f32 v107, v107
 v_rcp_f32 v108, v108
 v_rcp_f32 v109, v109
 v_rcp_f32 v110, v110
 v_rcp_f32 v111, v111
 v_pk_mul_f32 v[88:89], v[88:89], v[96:97]
 v_pk_mul_f32 v[90:91], v[90:91], v[98:99]
 v_pk_mul_f32 v[92:93], v[92:93], v[100:101]
 v_pk_mul_f32 v[94:95], v[94:95], v[102:103]
 v_pk_mul_f32 v[88:89], v[88:89], v[104:105]
 v_pk_mul_f32 v[90:91], v[90:91], v[106:107]
 v_pk_mul_f32 v[92:93], v[92:93], v[108:109]
 v_pk_mul_f32 v[94:95], v[94:95], v[110:111]
 v_cvt_pk_bf16_f32 v204, v88, v89
 v_cvt_pk_bf16_f32 v205, v90, v91
 v_cvt_pk_bf16_f32 v206, v92, v93
 v_cvt_pk_bf16_f32 v207, v94, v95
 buffer_load_dwordx4 v3, s[24:27], s10 offen offset:2048 sc1 lds
 buffer_load_dwordx4 v3, s[24:27], s10 offen offset:3072 sc1 lds
 v_accvgpr_read_b32 v64, a128
 v_accvgpr_read_b32 v65, a129
 v_accvgpr_read_b32 v66, a130
 v_accvgpr_read_b32 v67, a131
 v_accvgpr_read_b32 v68, a132
 v_accvgpr_read_b32 v69, a133
 v_accvgpr_read_b32 v70, a134
 v_accvgpr_read_b32 v71, a135
 v_pk_mul_f32 v[80:81], v[64:65], s[88:89]
 v_pk_mul_f32 v[82:83], v[66:67], s[88:89]
 v_pk_mul_f32 v[84:85], v[68:69], s[88:89]
 v_pk_mul_f32 v[86:87], v[70:71], s[88:89]
 v_exp_f32 v80, v80
 v_exp_f32 v81, v81
 v_exp_f32 v82, v82
 v_exp_f32 v83, v83
 v_exp_f32 v84, v84
 v_exp_f32 v85, v85
 v_exp_f32 v86, v86
 v_exp_f32 v87, v87
 v_accvgpr_read_b32 v72, a144
 v_accvgpr_read_b32 v73, a145
 v_accvgpr_read_b32 v74, a146
 v_accvgpr_read_b32 v75, a147
 v_accvgpr_read_b32 v76, a148
 v_accvgpr_read_b32 v77, a149
 v_accvgpr_read_b32 v78, a150
 v_accvgpr_read_b32 v79, a151
 v_pk_add_f32 v[80:81], v[80:81], 1.0 op_sel_hi:[1,0]
 v_pk_add_f32 v[82:83], v[82:83], 1.0 op_sel_hi:[1,0]
 v_pk_add_f32 v[84:85], v[84:85], 1.0 op_sel_hi:[1,0]
 v_pk_add_f32 v[86:87], v[86:87], 1.0 op_sel_hi:[1,0]
 v_rcp_f32 v80, v80
 v_rcp_f32 v81, v81
 v_rcp_f32 v82, v82
 v_rcp_f32 v83, v83
 v_rcp_f32 v84, v84
 v_rcp_f32 v85, v85
 v_rcp_f32 v86, v86
 v_rcp_f32 v87, v87
 v_pk_mul_f32 v[64:65], v[64:65], v[72:73]
 v_pk_mul_f32 v[66:67], v[66:67], v[74:75]
 v_pk_mul_f32 v[68:69], v[68:69], v[76:77]
 v_pk_mul_f32 v[70:71], v[70:71], v[78:79]
 v_pk_mul_f32 v[64:65], v[64:65], v[80:81]
 v_pk_mul_f32 v[66:67], v[66:67], v[82:83]
 v_pk_mul_f32 v[68:69], v[68:69], v[84:85]
 v_pk_mul_f32 v[70:71], v[70:71], v[86:87]
 v_cvt_pk_bf16_f32 v208, v64, v65
 v_cvt_pk_bf16_f32 v209, v66, v67
 v_cvt_pk_bf16_f32 v210, v68, v69
 v_cvt_pk_bf16_f32 v211, v70, v71
 s_add_u32 s10, s9, 16384
 s_mov_b32 s26, s22
 s_add_u32 s6, s6, 1
 s_sub_u32 s7, s7, 1
 s_cmp_eq_u32 s7, s8
 s_cselect_b32 s6, s87, s6
 s_cmp_gt_i32 s7, 0
 s_cselect_b32 s22, s22, 0
 s_cselect_b32 s6, s6, 0
 s_lshl_b32 s9, s6, 15
 s_add_u32 s11, s11, 16384
 s_and_b32 s11, s11, 0xffff
 s_add_u32 m0, s11, s76
 s_nop 0
 buffer_load_dwordx4 v3, s[20:23], s9 offen offset:0 sc1 lds
 buffer_load_dwordx4 v3, s[20:23], s9 offen offset:1024 sc1 lds
 v_accvgpr_read_b32 v88, a136
 v_accvgpr_read_b32 v89, a137
 v_accvgpr_read_b32 v90, a138
 v_accvgpr_read_b32 v91, a139
 v_accvgpr_read_b32 v92, a140
 v_accvgpr_read_b32 v93, a141
 v_accvgpr_read_b32 v94, a142
 v_accvgpr_read_b32 v95, a143
 v_pk_mul_f32 v[104:105], v[88:89], s[88:89]
 v_pk_mul_f32 v[106:107], v[90:91], s[88:89]
 v_pk_mul_f32 v[108:109], v[92:93], s[88:89]
 v_pk_mul_f32 v[110:111], v[94:95], s[88:89]
 v_exp_f32 v104, v104
 v_exp_f32 v105, v105
 v_exp_f32 v106, v106
 v_exp_f32 v107, v107
 v_exp_f32 v108, v108
 v_exp_f32 v109, v109
 v_exp_f32 v110, v110
 v_exp_f32 v111, v111
 v_accvgpr_read_b32 v96, a152
 v_accvgpr_read_b32 v97, a153
 v_accvgpr_read_b32 v98, a154
 v_accvgpr_read_b32 v99, a155
 v_accvgpr_read_b32 v100, a156
 v_accvgpr_read_b32 v101, a157
 v_accvgpr_read_b32 v102, a158
 v_accvgpr_read_b32 v103, a159
 v_pk_add_f32 v[104:105], v[104:105], 1.0 op_sel_hi:[1,0]
 v_pk_add_f32 v[106:107], v[106:107], 1.0 op_sel_hi:[1,0]
 v_pk_add_f32 v[108:109], v[108:109], 1.0 op_sel_hi:[1,0]
 v_pk_add_f32 v[110:111], v[110:111], 1.0 op_sel_hi:[1,0]
 v_rcp_f32 v104, v104
 v_rcp_f32 v105, v105
 v_rcp_f32 v106, v106
 v_rcp_f32 v107, v107
 v_rcp_f32 v108, v108
 v_rcp_f32 v109, v109
 v_rcp_f32 v110, v110
 v_rcp_f32 v111, v111
 v_pk_mul_f32 v[88:89], v[88:89], v[96:97]
 v_pk_mul_f32 v[90:91], v[90:91], v[98:99]
 v_pk_mul_f32 v[92:93], v[92:93], v[100:101]
 v_pk_mul_f32 v[94:95], v[94:95], v[102:103]
 v_pk_mul_f32 v[88:89], v[88:89], v[104:105]
 v_pk_mul_f32 v[90:91], v[90:91], v[106:107]
 v_pk_mul_f32 v[92:93], v[92:93], v[108:109]
 v_pk_mul_f32 v[94:95], v[94:95], v[110:111]
 v_cvt_pk_bf16_f32 v212, v88, v89
 v_cvt_pk_bf16_f32 v213, v90, v91
 v_cvt_pk_bf16_f32 v214, v92, v93
 v_cvt_pk_bf16_f32 v215, v94, v95
 buffer_load_dwordx4 v3, s[20:23], s9 offen offset:2048 sc1 lds
 buffer_load_dwordx4 v3, s[20:23], s9 offen offset:3072 sc1 lds
 v_accvgpr_read_b32 v64, a160
 v_accvgpr_read_b32 v65, a161
 v_accvgpr_read_b32 v66, a162
 v_accvgpr_read_b32 v67, a163
 v_accvgpr_read_b32 v68, a164
 v_accvgpr_read_b32 v69, a165
 v_accvgpr_read_b32 v70, a166
 v_accvgpr_read_b32 v71, a167
 v_pk_mul_f32 v[80:81], v[64:65], s[88:89]
 v_pk_mul_f32 v[82:83], v[66:67], s[88:89]
 v_pk_mul_f32 v[84:85], v[68:69], s[88:89]
 v_pk_mul_f32 v[86:87], v[70:71], s[88:89]
 v_exp_f32 v80, v80
 v_exp_f32 v81, v81
 v_exp_f32 v82, v82
 v_exp_f32 v83, v83
 v_exp_f32 v84, v84
 v_exp_f32 v85, v85
 v_exp_f32 v86, v86
 v_exp_f32 v87, v87
 v_accvgpr_read_b32 v72, a176
 v_accvgpr_read_b32 v73, a177
 v_accvgpr_read_b32 v74, a178
 v_accvgpr_read_b32 v75, a179
 v_accvgpr_read_b32 v76, a180
 v_accvgpr_read_b32 v77, a181
 v_accvgpr_read_b32 v78, a182
 v_accvgpr_read_b32 v79, a183
 v_pk_add_f32 v[80:81], v[80:81], 1.0 op_sel_hi:[1,0]
 v_pk_add_f32 v[82:83], v[82:83], 1.0 op_sel_hi:[1,0]
 v_pk_add_f32 v[84:85], v[84:85], 1.0 op_sel_hi:[1,0]
 v_pk_add_f32 v[86:87], v[86:87], 1.0 op_sel_hi:[1,0]
 v_rcp_f32 v80, v80
 v_rcp_f32 v81, v81
 v_rcp_f32 v82, v82
 v_rcp_f32 v83, v83
 v_rcp_f32 v84, v84
 v_rcp_f32 v85, v85
 v_rcp_f32 v86, v86
 v_rcp_f32 v87, v87
 v_pk_mul_f32 v[64:65], v[64:65], v[72:73]
 v_pk_mul_f32 v[66:67], v[66:67], v[74:75]
 v_pk_mul_f32 v[68:69], v[68:69], v[76:77]
 v_pk_mul_f32 v[70:71], v[70:71], v[78:79]
 v_pk_mul_f32 v[64:65], v[64:65], v[80:81]
 v_pk_mul_f32 v[66:67], v[66:67], v[82:83]
 v_pk_mul_f32 v[68:69], v[68:69], v[84:85]
 v_pk_mul_f32 v[70:71], v[70:71], v[86:87]
 v_cvt_pk_bf16_f32 v216, v64, v65
 v_cvt_pk_bf16_f32 v217, v66, v67
 v_cvt_pk_bf16_f32 v218, v68, v69
 v_cvt_pk_bf16_f32 v219, v70, v71
 s_add_u32 s12, s12, 16384
 s_cmp_eq_u32 s12, 81920
 s_cselect_b32 s12, 0, s12
 s_add_u32 m0, s12, s77
 s_nop 0
 buffer_load_dwordx4 v3, s[24:27], s10 offen offset:0 sc1 lds
 buffer_load_dwordx4 v3, s[24:27], s10 offen offset:1024 sc1 lds
 v_accvgpr_read_b32 v88, a168
 v_accvgpr_read_b32 v89, a169
 v_accvgpr_read_b32 v90, a170
 v_accvgpr_read_b32 v91, a171
 v_accvgpr_read_b32 v92, a172
 v_accvgpr_read_b32 v93, a173
 v_accvgpr_read_b32 v94, a174
 v_accvgpr_read_b32 v95, a175
 v_pk_mul_f32 v[104:105], v[88:89], s[88:89]
 v_pk_mul_f32 v[106:107], v[90:91], s[88:89]
 v_pk_mul_f32 v[108:109], v[92:93], s[88:89]
 v_pk_mul_f32 v[110:111], v[94:95], s[88:89]
 v_exp_f32 v104, v104
 v_exp_f32 v105, v105
 v_exp_f32 v106, v106
 v_exp_f32 v107, v107
 v_exp_f32 v108, v108
 v_exp_f32 v109, v109
 v_exp_f32 v110, v110
 v_exp_f32 v111, v111
 v_accvgpr_read_b32 v96, a184
 v_accvgpr_read_b32 v97, a185
 v_accvgpr_read_b32 v98, a186
 v_accvgpr_read_b32 v99, a187
 v_accvgpr_read_b32 v100, a188
 v_accvgpr_read_b32 v101, a189
 v_accvgpr_read_b32 v102, a190
 v_accvgpr_read_b32 v103, a191
 v_pk_add_f32 v[104:105], v[104:105], 1.0 op_sel_hi:[1,0]
 v_pk_add_f32 v[106:107], v[106:107], 1.0 op_sel_hi:[1,0]
 v_pk_add_f32 v[108:109], v[108:109], 1.0 op_sel_hi:[1,0]
 v_pk_add_f32 v[110:111], v[110:111], 1.0 op_sel_hi:[1,0]
 v_rcp_f32 v104, v104
 v_rcp_f32 v105, v105
 v_rcp_f32 v106, v106
 v_rcp_f32 v107, v107
 v_rcp_f32 v108, v108
 v_rcp_f32 v109, v109
 v_rcp_f32 v110, v110
 v_rcp_f32 v111, v111
 v_pk_mul_f32 v[88:89], v[88:89], v[96:97]
 v_pk_mul_f32 v[90:91], v[90:91], v[98:99]
 v_pk_mul_f32 v[92:93], v[92:93], v[100:101]
 v_pk_mul_f32 v[94:95], v[94:95], v[102:103]
 v_pk_mul_f32 v[88:89], v[88:89], v[104:105]
 v_pk_mul_f32 v[90:91], v[90:91], v[106:107]
 v_pk_mul_f32 v[92:93], v[92:93], v[108:109]
 v_pk_mul_f32 v[94:95], v[94:95], v[110:111]
 v_cvt_pk_bf16_f32 v220, v88, v89
 v_cvt_pk_bf16_f32 v221, v90, v91
 v_cvt_pk_bf16_f32 v222, v92, v93
 v_cvt_pk_bf16_f32 v223, v94, v95
 buffer_load_dwordx4 v3, s[24:27], s10 offen offset:2048 sc1 lds
 buffer_load_dwordx4 v3, s[24:27], s10 offen offset:3072 sc1 lds
 v_accvgpr_read_b32 v64, a192
 v_accvgpr_read_b32 v65, a193
 v_accvgpr_read_b32 v66, a194
 v_accvgpr_read_b32 v67, a195
 v_accvgpr_read_b32 v68, a196
 v_accvgpr_read_b32 v69, a197
 v_accvgpr_read_b32 v70, a198
 v_accvgpr_read_b32 v71, a199
 v_pk_mul_f32 v[80:81], v[64:65], s[88:89]
 v_pk_mul_f32 v[82:83], v[66:67], s[88:89]
 v_pk_mul_f32 v[84:85], v[68:69], s[88:89]
 v_pk_mul_f32 v[86:87], v[70:71], s[88:89]
 v_exp_f32 v80, v80
 v_exp_f32 v81, v81
 v_exp_f32 v82, v82
 v_exp_f32 v83, v83
 v_exp_f32 v84, v84
 v_exp_f32 v85, v85
 v_exp_f32 v86, v86
 v_exp_f32 v87, v87
 v_accvgpr_read_b32 v72, a208
 v_accvgpr_read_b32 v73, a209
 v_accvgpr_read_b32 v74, a210
 v_accvgpr_read_b32 v75, a211
 v_accvgpr_read_b32 v76, a212
 v_accvgpr_read_b32 v77, a213
 v_accvgpr_read_b32 v78, a214
 v_accvgpr_read_b32 v79, a215
 v_pk_add_f32 v[80:81], v[80:81], 1.0 op_sel_hi:[1,0]
 v_pk_add_f32 v[82:83], v[82:83], 1.0 op_sel_hi:[1,0]
 v_pk_add_f32 v[84:85], v[84:85], 1.0 op_sel_hi:[1,0]
 v_pk_add_f32 v[86:87], v[86:87], 1.0 op_sel_hi:[1,0]
 v_rcp_f32 v80, v80
 v_rcp_f32 v81, v81
 v_rcp_f32 v82, v82
 v_rcp_f32 v83, v83
 v_rcp_f32 v84, v84
 v_rcp_f32 v85, v85
 v_rcp_f32 v86, v86
 v_rcp_f32 v87, v87
 v_pk_mul_f32 v[64:65], v[64:65], v[72:73]
 v_pk_mul_f32 v[66:67], v[66:67], v[74:75]
 v_pk_mul_f32 v[68:69], v[68:69], v[76:77]
 v_pk_mul_f32 v[70:71], v[70:71], v[78:79]
 v_pk_mul_f32 v[64:65], v[64:65], v[80:81]
 v_pk_mul_f32 v[66:67], v[66:67], v[82:83]
 v_pk_mul_f32 v[68:69], v[68:69], v[84:85]
 v_pk_mul_f32 v[70:71], v[70:71], v[86:87]
 v_cvt_pk_bf16_f32 v224, v64, v65
 v_cvt_pk_bf16_f32 v225, v66, v67
 v_cvt_pk_bf16_f32 v226, v68, v69
 v_cvt_pk_bf16_f32 v227, v70, v71
 v_accvgpr_read_b32 v88, a200
 v_accvgpr_read_b32 v89, a201
 v_accvgpr_read_b32 v90, a202
 v_accvgpr_read_b32 v91, a203
 v_accvgpr_read_b32 v92, a204
 v_accvgpr_read_b32 v93, a205
 v_accvgpr_read_b32 v94, a206
 v_accvgpr_read_b32 v95, a207
 v_pk_mul_f32 v[104:105], v[88:89], s[88:89]
 v_pk_mul_f32 v[106:107], v[90:91], s[88:89]
 v_pk_mul_f32 v[108:109], v[92:93], s[88:89]
 v_pk_mul_f32 v[110:111], v[94:95], s[88:89]
 v_exp_f32 v104, v104
 v_exp_f32 v105, v105
 v_exp_f32 v106, v106
 v_exp_f32 v107, v107
 v_exp_f32 v108, v108
 v_exp_f32 v109, v109
 v_exp_f32 v110, v110
 v_exp_f32 v111, v111
 v_accvgpr_read_b32 v96, a216
 v_accvgpr_read_b32 v97, a217
 v_accvgpr_read_b32 v98, a218
 v_accvgpr_read_b32 v99, a219
 v_accvgpr_read_b32 v100, a220
 v_accvgpr_read_b32 v101, a221
 v_accvgpr_read_b32 v102, a222
 v_accvgpr_read_b32 v103, a223
 v_pk_add_f32 v[104:105], v[104:105], 1.0 op_sel_hi:[1,0]
 v_pk_add_f32 v[106:107], v[106:107], 1.0 op_sel_hi:[1,0]
 v_pk_add_f32 v[108:109], v[108:109], 1.0 op_sel_hi:[1,0]
 v_pk_add_f32 v[110:111], v[110:111], 1.0 op_sel_hi:[1,0]
 v_rcp_f32 v104, v104
 v_rcp_f32 v105, v105
 v_rcp_f32 v106, v106
 v_rcp_f32 v107, v107
 v_rcp_f32 v108, v108
 v_rcp_f32 v109, v109
 v_rcp_f32 v110, v110
 v_rcp_f32 v111, v111
 v_pk_mul_f32 v[88:89], v[88:89], v[96:97]
 v_pk_mul_f32 v[90:91], v[90:91], v[98:99]
 v_pk_mul_f32 v[92:93], v[92:93], v[100:101]
 v_pk_mul_f32 v[94:95], v[94:95], v[102:103]
 v_pk_mul_f32 v[88:89], v[88:89], v[104:105]
 v_pk_mul_f32 v[90:91], v[90:91], v[106:107]
 v_pk_mul_f32 v[92:93], v[92:93], v[108:109]
 v_pk_mul_f32 v[94:95], v[94:95], v[110:111]
 v_cvt_pk_bf16_f32 v228, v88, v89
 v_cvt_pk_bf16_f32 v229, v90, v91
 v_cvt_pk_bf16_f32 v230, v92, v93
 v_cvt_pk_bf16_f32 v231, v94, v95
 buffer_load_dwordx2 v[22:23], v30, s[36:39], 0 offen sc1
 v_accvgpr_read_b32 v64, a224
 v_accvgpr_read_b32 v65, a225
 v_accvgpr_read_b32 v66, a226
 v_accvgpr_read_b32 v67, a227
 v_accvgpr_read_b32 v68, a228
 v_accvgpr_read_b32 v69, a229
 v_accvgpr_read_b32 v70, a230
 v_accvgpr_read_b32 v71, a231
 v_pk_mul_f32 v[80:81], v[64:65], s[88:89]
 v_pk_mul_f32 v[82:83], v[66:67], s[88:89]
 v_pk_mul_f32 v[84:85], v[68:69], s[88:89]
 v_pk_mul_f32 v[86:87], v[70:71], s[88:89]
 v_exp_f32 v80, v80
 v_exp_f32 v81, v81
 v_exp_f32 v82, v82
 v_exp_f32 v83, v83
 v_exp_f32 v84, v84
 v_exp_f32 v85, v85
 v_exp_f32 v86, v86
 v_exp_f32 v87, v87
 v_accvgpr_read_b32 v72, a240
 v_accvgpr_read_b32 v73, a241
 v_accvgpr_read_b32 v74, a242
 v_accvgpr_read_b32 v75, a243
 v_accvgpr_read_b32 v76, a244
 v_accvgpr_read_b32 v77, a245
 v_accvgpr_read_b32 v78, a246
 v_accvgpr_read_b32 v79, a247
 v_pk_add_f32 v[80:81], v[80:81], 1.0 op_sel_hi:[1,0]
 v_pk_add_f32 v[82:83], v[82:83], 1.0 op_sel_hi:[1,0]
 v_pk_add_f32 v[84:85], v[84:85], 1.0 op_sel_hi:[1,0]
 v_pk_add_f32 v[86:87], v[86:87], 1.0 op_sel_hi:[1,0]
 v_rcp_f32 v80, v80
 v_rcp_f32 v81, v81
 v_rcp_f32 v82, v82
 v_rcp_f32 v83, v83
 v_rcp_f32 v84, v84
 v_rcp_f32 v85, v85
 v_rcp_f32 v86, v86
 v_rcp_f32 v87, v87
 v_pk_mul_f32 v[64:65], v[64:65], v[72:73]
 v_pk_mul_f32 v[66:67], v[66:67], v[74:75]
 v_pk_mul_f32 v[68:69], v[68:69], v[76:77]
 v_pk_mul_f32 v[70:71], v[70:71], v[78:79]
 v_pk_mul_f32 v[64:65], v[64:65], v[80:81]
 v_pk_mul_f32 v[66:67], v[66:67], v[82:83]
 v_pk_mul_f32 v[68:69], v[68:69], v[84:85]
 v_pk_mul_f32 v[70:71], v[70:71], v[86:87]
 v_cvt_pk_bf16_f32 v232, v64, v65
 v_cvt_pk_bf16_f32 v233, v66, v67
 v_cvt_pk_bf16_f32 v234, v68, v69
 v_cvt_pk_bf16_f32 v235, v70, v71
 v_accvgpr_read_b32 v88, a232
 v_accvgpr_read_b32 v89, a233
 v_accvgpr_read_b32 v90, a234
 v_accvgpr_read_b32 v91, a235
 v_accvgpr_read_b32 v92, a236
 v_accvgpr_read_b32 v93, a237
 v_accvgpr_read_b32 v94, a238
 v_accvgpr_read_b32 v95, a239
 v_pk_mul_f32 v[104:105], v[88:89], s[88:89]
 v_pk_mul_f32 v[106:107], v[90:91], s[88:89]
 v_pk_mul_f32 v[108:109], v[92:93], s[88:89]
 v_pk_mul_f32 v[110:111], v[94:95], s[88:89]
 v_exp_f32 v104, v104
 v_exp_f32 v105, v105
 v_exp_f32 v106, v106
 v_exp_f32 v107, v107
 v_exp_f32 v108, v108
 v_exp_f32 v109, v109
 v_exp_f32 v110, v110
 v_exp_f32 v111, v111
 v_accvgpr_read_b32 v96, a248
 v_accvgpr_read_b32 v97, a249
 v_accvgpr_read_b32 v98, a250
 v_accvgpr_read_b32 v99, a251
 v_accvgpr_read_b32 v100, a252
 v_accvgpr_read_b32 v101, a253
 v_accvgpr_read_b32 v102, a254
 v_accvgpr_read_b32 v103, a255
 v_pk_add_f32 v[104:105], v[104:105], 1.0 op_sel_hi:[1,0]
 v_pk_add_f32 v[106:107], v[106:107], 1.0 op_sel_hi:[1,0]
 v_pk_add_f32 v[108:109], v[108:109], 1.0 op_sel_hi:[1,0]
 v_pk_add_f32 v[110:111], v[110:111], 1.0 op_sel_hi:[1,0]
 v_rcp_f32 v104, v104
 v_rcp_f32 v105, v105
 v_rcp_f32 v106, v106
 v_rcp_f32 v107, v107
 v_rcp_f32 v108, v108
 v_rcp_f32 v109, v109
 v_rcp_f32 v110, v110
 v_rcp_f32 v111, v111
 v_pk_mul_f32 v[88:89], v[88:89], v[96:97]
 v_pk_mul_f32 v[90:91], v[90:91], v[98:99]
 v_pk_mul_f32 v[92:93], v[92:93], v[100:101]
 v_pk_mul_f32 v[94:95], v[94:95], v[102:103]
 v_pk_mul_f32 v[88:89], v[88:89], v[104:105]
 v_pk_mul_f32 v[90:91], v[90:91], v[106:107]
 v_pk_mul_f32 v[92:93], v[92:93], v[108:109]
 v_pk_mul_f32 v[94:95], v[94:95], v[110:111]
 v_cvt_pk_bf16_f32 v236, v88, v89
 v_cvt_pk_bf16_f32 v237, v90, v91
 v_cvt_pk_bf16_f32 v238, v92, v93
 v_cvt_pk_bf16_f32 v239, v94, v95
 s_waitcnt vmcnt(0)
 s_mov_b32 s99, 1048576
gated_mix__compressed_kv_cla__glu_gated_swiglu__prompt_kernel_poll9:
 v_cmp_eq_u64 vcc, v[22:23], v[28:29]
 s_nop 3
 s_cmp_eq_u64 vcc, -1
 s_cbranch_scc1 gated_mix__compressed_kv_cla__glu_gated_swiglu__prompt_kernel_ok10
 s_sub_u32 s99, s99, 1
 s_cbranch_scc1 gated_mix__compressed_kv_cla__glu_gated_swiglu__prompt_kernel_ok10
 s_sleep 12
 buffer_load_dwordx2 v[22:23], v30, s[36:39], 0 offen sc1
 s_waitcnt vmcnt(0)
 s_branch gated_mix__compressed_kv_cla__glu_gated_swiglu__prompt_kernel_poll9
gated_mix__compressed_kv_cla__glu_gated_swiglu__prompt_kernel_ok10:
 s_add_u32 s90, s55, 0
 buffer_load_dwordx4 v[112:115], v21, s[36:39], s90 offen offset:0 sc1
 buffer_load_dwordx4 v[116:119], v21, s[36:39], s90 offen offset:1024 sc1
 buffer_load_dwordx4 v[120:123], v21, s[36:39], s90 offen offset:2048 sc1
 buffer_load_dwordx4 v[124:127], v21, s[36:39], s90 offen offset:3072 sc1
 s_add_u32 s90, s55, 4096
 buffer_load_dwordx4 v[128:131], v21, s[36:39], s90 offen offset:0 sc1
 buffer_load_dwordx4 v[132:135], v21, s[36:39], s90 offen offset:1024 sc1
 buffer_load_dwordx4 v[136:139], v21, s[36:39], s90 offen offset:2048 sc1
 buffer_load_dwordx4 v[140:143], v21, s[36:39], s90 offen offset:3072 sc1
 s_add_u32 s90, s55, 8192
 buffer_load_dwordx4 v[144:147], v21, s[36:39], s90 offen offset:0 sc1
 buffer_load_dwordx4 v[148:151], v21, s[36:39], s90 offen offset:1024 sc1
 buffer_load_dwordx4 v[152:155], v21, s[36:39], s90 offen offset:2048 sc1
 buffer_load_dwordx4 v[156:159], v21, s[36:39], s90 offen offset:3072 sc1
 s_add_u32 s90, s55, 12288
 buffer_load_dwordx4 v[160:163], v21, s[36:39], s90 offen offset:0 sc1
 buffer_load_dwordx4 v[164:167], v21, s[36:39], s90 offen offset:1024 sc1
 buffer_load_dwordx4 v[168:171], v21, s[36:39], s90 offen offset:2048 sc1
 buffer_load_dwordx4 v[172:175], v21, s[36:39], s90 offen offset:3072 sc1
gated_mix__compressed_kv_cla__glu_gated_swiglu__prompt_kernel_qhere:
 s_mov_b32 s19, 57344
 s_branch gated_mix__compressed_kv_cla__glu_gated_swiglu__prompt_kernel_attn
gated_mix__compressed_kv_cla__glu_gated_swiglu__prompt_kernel_qdirect:
 buffer_store_dwordx4 v[112:115], v21, s[36:39], s6 offen offset:0 sc1
 buffer_store_dwordx4 v[116:119], v21, s[36:39], s6 offen offset:1024 sc1
 buffer_store_dwordx4 v[120:123], v21, s[36:39], s6 offen offset:2048 sc1
 buffer_store_dwordx4 v[124:127], v21, s[36:39], s6 offen offset:3072 sc1
 buffer_store_dwordx4 v[128:131], v21, s[36:39], s7 offen offset:0 sc1
 buffer_store_dwordx4 v[132:135], v21, s[36:39], s7 offen offset:1024 sc1
 buffer_store_dwordx4 v[136:139], v21, s[36:39], s7 offen offset:2048 sc1
 buffer_store_dwordx4 v[140:143], v21, s[36:39], s7 offen offset:3072 sc1
 buffer_store_dwordx4 v[144:147], v21, s[36:39], s8 offen offset:0 sc1
 buffer_store_dwordx4 v[148:151], v21, s[36:39], s8 offen offset:1024 sc1
 buffer_store_dwordx4 v[152:155], v21, s[36:39], s8 offen offset:2048 sc1
 buffer_store_dwordx4 v[156:159], v21, s[36:39], s8 offen offset:3072 sc1
 buffer_store_dwordx4 v[160:163], v21, s[36:39], s9 offen offset:0 sc1
 buffer_store_dwordx4 v[164:167], v21, s[36:39], s9 offen offset:1024 sc1
 s_mov_b32 s91, 0
 s_mov_b32 s92, 32768
gated_mix__compressed_kv_cla__glu_gated_swiglu__prompt_kernel_q1:
 s_and_b32 s93, s68, 1
 s_lshl_b32 s93, s93, 13
 s_sub_u32 s94, s92, s93
 s_sub_u32 s95, s91, s93
 v_add_u32 v108, s94, v13
 v_add_u32 v13, s95, v13
 v_add_u32 v109, s94, v14
 v_add_u32 v14, s95, v14
 v_add_u32 v110, s94, v15
 v_add_u32 v15, s95, v15
 v_add_u32 v111, s94, v16
 v_add_u32 v16, s95, v16
 s_add_u32 s87, s78, s92
 s_add_u32 s78, s78, s91
 v_add_u32 v19, s93, v19
 v_add_u32 v20, s93, v20
 v_mov_b32 v24, v254
 v_add_u32 v17, s73, v19
 s_waitcnt vmcnt(34)
 ds_read_b128 v[32:35], v17 offset:0
 ds_read_b128 v[36:39], v17 offset:2048
 ds_read_b64_tr_b16 v[64:65], v13 offset:0
 ds_read_b64_tr_b16 v[66:67], v13 offset:512
 ds_read_b64_tr_b16 v[68:69], v14 offset:0
 ds_read_b64_tr_b16 v[70:71], v14 offset:512
 ds_read_b64_tr_b16 v[72:73], v15 offset:0
 ds_read_b64_tr_b16 v[74:75], v15 offset:512
 ds_read_b64_tr_b16 v[76:77], v16 offset:0
 ds_read_b64_tr_b16 v[78:79], v16 offset:512
 ds_read_b64_tr_b16 v[80:81], v13 offset:4096
 ds_read_b64_tr_b16 v[82:83], v13 offset:4608
 ds_read_b64_tr_b16 v[84:85], v14 offset:4096
 ds_read_b64_tr_b16 v[86:87], v14 offset:4608
 ds_read_b64_tr_b16 v[88:89], v15 offset:4096
 ds_read_b64_tr_b16 v[90:91], v15 offset:4608
 s_waitcnt lgkmcnt(12)
 v_mfma_f32_16x16x32_bf16 a[0:3], v[64:67], v[32:35], 0
 ds_read_b64_tr_b16 v[92:93], v16 offset:4096
 v_mfma_f32_16x16x32_bf16 a[4:7], v[64:67], v[36:39], 0
 s_waitcnt lgkmcnt(11)
 ds_read_b64_tr_b16 v[94:95], v16 offset:4608
 v_mfma_f32_16x16x32_bf16 a[12:15], v[68:71], v[36:39], 0
 ds_read_b64_tr_b16 v[64:65], v13 offset:8192
 v_mfma_f32_16x16x32_bf16 a[8:11], v[68:71], v[32:35], 0
 s_waitcnt lgkmcnt(11)
 ds_read_b64_tr_b16 v[66:67], v13 offset:8704
 v_add_u32 v18, s73, v20
 v_mfma_f32_16x16x32_bf16 a[16:19], v[72:75], v[32:35], 0
 ds_read_b64_tr_b16 v[68:69], v14 offset:8192
 v_mfma_f32_16x16x32_bf16 a[20:23], v[72:75], v[36:39], 0
 s_waitcnt lgkmcnt(11)
 ds_read_b64_tr_b16 v[70:71], v14 offset:8704
 v_mfma_f32_16x16x32_bf16 a[28:31], v[76:79], v[36:39], 0
 ds_read_b64_tr_b16 v[72:73], v15 offset:8192
 v_mfma_f32_16x16x32_bf16 a[24:27], v[76:79], v[32:35], 0
 s_waitcnt lgkmcnt(11)
 ds_read_b64_tr_b16 v[74:75], v15 offset:8704
 v_mfma_f32_16x16x32_bf16 a[32:35], v[80:83], v[32:35], 0
 ds_read_b64_tr_b16 v[76:77], v16 offset:8192
 buffer_store_dwordx4 v[168:171], v21, s[36:39], s9 offen offset:2048 sc1
 v_mfma_f32_16x16x32_bf16 a[36:39], v[80:83], v[36:39], 0
 s_waitcnt lgkmcnt(11)
 ds_read_b64_tr_b16 v[78:79], v16 offset:8704
 v_mfma_f32_16x16x32_bf16 a[44:47], v[84:87], v[36:39], 0
 ds_read_b64_tr_b16 v[80:81], v13 offset:12288
 v_mfma_f32_16x16x32_bf16 a[40:43], v[84:87], v[32:35], 0
 s_waitcnt lgkmcnt(11)
 ds_read_b64_tr_b16 v[82:83], v13 offset:12800
 v_mfma_f32_16x16x32_bf16 a[48:51], v[88:91], v[32:35], 0
 ds_read_b64_tr_b16 v[84:85], v14 offset:12288
 v_mfma_f32_16x16x32_bf16 a[52:55], v[88:91], v[36:39], 0
 s_waitcnt lgkmcnt(11)
 ds_read_b64_tr_b16 v[86:87], v14 offset:12800
 ds_read_b128 v[48:51], v18 offset:0
 v_mfma_f32_16x16x32_bf16 a[60:63], v[92:95], v[36:39], 0
 ds_read_b64_tr_b16 v[88:89], v15 offset:12288
 buffer_store_dwordx4 v[172:175], v21, s[36:39], s9 offen offset:3072 sc1
 v_mfma_f32_16x16x32_bf16 a[56:59], v[92:95], v[32:35], 0
 s_waitcnt lgkmcnt(12)
 ds_read_b64_tr_b16 v[90:91], v15 offset:12800
 ds_read_b128 v[52:55], v18 offset:2048
 v_mfma_f32_16x16x32_bf16 a[64:67], v[64:67], v[32:35], 0
 ds_read_b64_tr_b16 v[92:93], v16 offset:12288
 v_mfma_f32_16x16x32_bf16 a[68:71], v[64:67], v[36:39], 0
 s_waitcnt lgkmcnt(13)
 s_waitcnt vmcnt(32)
 s_barrier
 ds_read_b64_tr_b16 v[94:95], v16 offset:12800
 v_mfma_f32_16x16x32_bf16 a[76:79], v[68:71], v[36:39], 0
 s_add_u32 m0, s72, s76
 ds_read_b64_tr_b16 v[64:65], v13 offset:16384
 v_mfma_f32_16x16x32_bf16 a[72:75], v[68:71], v[32:35], 0
 s_waitcnt lgkmcnt(13)
 ds_read_b64_tr_b16 v[66:67], v13 offset:16896
 buffer_load_dwordx4 v1, s[20:23], s69 offen offset:0 lds
 v_mfma_f32_16x16x32_bf16 a[80:83], v[72:75], v[32:35], 0
 ds_read_b64_tr_b16 v[68:69], v14 offset:16384
 v_mfma_f32_16x16x32_bf16 a[84:87], v[72:75], v[36:39], 0
 s_waitcnt lgkmcnt(13)
 ds_read_b64_tr_b16 v[70:71], v14 offset:16896
 v_mfma_f32_16x16x32_bf16 a[92:95], v[76:79], v[36:39], 0
 ds_read_b64_tr_b16 v[72:73], v15 offset:16384
 v_mfma_f32_16x16x32_bf16 a[88:91], v[76:79], v[32:35], 0
 s_waitcnt lgkmcnt(13)
 ds_read_b64_tr_b16 v[74:75], v15 offset:16896
 buffer_load_dwordx4 v2, s[20:23], s69 offen offset:1024 lds
 v_mfma_f32_16x16x32_bf16 a[96:99], v[80:83], v[32:35], 0
 ds_read_b64_tr_b16 v[76:77], v16 offset:16384
 v_mfma_f32_16x16x32_bf16 a[100:103], v[80:83], v[36:39], 0
 s_waitcnt lgkmcnt(13)
 ds_read_b64_tr_b16 v[78:79], v16 offset:16896
 v_mfma_f32_16x16x32_bf16 a[108:111], v[84:87], v[36:39], 0
 ds_read_b64_tr_b16 v[80:81], v13 offset:20480
 v_mfma_f32_16x16x32_bf16 a[104:107], v[84:87], v[32:35], 0
 s_waitcnt lgkmcnt(12)
 ds_read_b64_tr_b16 v[82:83], v13 offset:20992
 v_mfma_f32_16x16x32_bf16 a[112:115], v[88:91], v[32:35], 0
 ds_read_b64_tr_b16 v[84:85], v14 offset:20480
 v_mfma_f32_16x16x32_bf16 a[116:119], v[88:91], v[36:39], 0
 s_waitcnt lgkmcnt(11)
 ds_read_b64_tr_b16 v[86:87], v14 offset:20992
 v_mfma_f32_16x16x32_bf16 a[124:127], v[92:95], v[36:39], 0
 ds_read_b64_tr_b16 v[88:89], v15 offset:20480
 v_mfma_f32_16x16x32_bf16 a[120:123], v[92:95], v[32:35], 0
 ds_read_b64_tr_b16 v[90:91], v15 offset:20992
 s_waitcnt lgkmcnt(12)
 v_mfma_f32_16x16x32_bf16 a[0:3], v[64:67], v[48:51], a[0:3]
 s_add_u32 m0, s72, s76
 ds_read_b64_tr_b16 v[92:93], v16 offset:20480
 v_mfma_f32_16x16x32_bf16 a[4:7], v[64:67], v[52:55], a[4:7]
 s_waitcnt lgkmcnt(11)
 ds_read_b64_tr_b16 v[94:95], v16 offset:20992
 buffer_load_dwordx4 v3, s[20:23], s69 offen offset:2048 lds
 v_mfma_f32_16x16x32_bf16 a[12:15], v[68:71], v[52:55], a[12:15]
 ds_read_b64_tr_b16 v[64:65], v13 offset:24576
 v_mfma_f32_16x16x32_bf16 a[8:11], v[68:71], v[48:51], a[8:11]
 s_waitcnt lgkmcnt(11)
 ds_read_b64_tr_b16 v[66:67], v13 offset:25088
 v_add_u32 v17, s74, v19
 v_mfma_f32_16x16x32_bf16 a[16:19], v[72:75], v[48:51], a[16:19]
 ds_read_b64_tr_b16 v[68:69], v14 offset:24576
 v_mfma_f32_16x16x32_bf16 a[20:23], v[72:75], v[52:55], a[20:23]
 s_waitcnt lgkmcnt(11)
 ds_read_b64_tr_b16 v[70:71], v14 offset:25088
 buffer_load_dwordx4 v4, s[20:23], s69 offen offset:3072 lds
 v_mfma_f32_16x16x32_bf16 a[28:31], v[76:79], v[52:55], a[28:31]
 ds_read_b64_tr_b16 v[72:73], v15 offset:24576
 v_mfma_f32_16x16x32_bf16 a[24:27], v[76:79], v[48:51], a[24:27]
 s_waitcnt lgkmcnt(11)
 ds_read_b64_tr_b16 v[74:75], v15 offset:25088
 v_mfma_f32_16x16x32_bf16 a[32:35], v[80:83], v[48:51], a[32:35]
 ds_read_b64_tr_b16 v[76:77], v16 offset:24576
 buffer_store_dwordx4 v[176:179], v21, s[36:39], s10 offen offset:0 sc1
 v_mfma_f32_16x16x32_bf16 a[36:39], v[80:83], v[52:55], a[36:39]
 s_waitcnt lgkmcnt(11)
 ds_read_b64_tr_b16 v[78:79], v16 offset:25088
 v_mfma_f32_16x16x32_bf16 a[44:47], v[84:87], v[52:55], a[44:47]
 ds_read_b64_tr_b16 v[80:81], v13 offset:28672
 v_mfma_f32_16x16x32_bf16 a[40:43], v[84:87], v[48:51], a[40:43]
 s_waitcnt lgkmcnt(11)
 ds_read_b64_tr_b16 v[82:83], v13 offset:29184
 v_mfma_f32_16x16x32_bf16 a[48:51], v[88:91], v[48:51], a[48:51]
 s_add_u32 s69, s69, 128
 ds_read_b64_tr_b16 v[84:85], v14 offset:28672
 v_mfma_f32_16x16x32_bf16 a[52:55], v[88:91], v[52:55], a[52:55]
 s_waitcnt lgkmcnt(11)
 s_waitcnt vmcnt(25)
 ds_read_b64_tr_b16 v[86:87], v14 offset:29184
 ds_read_b128 v[32:35], v17 offset:0
 v_mfma_f32_16x16x32_bf16 a[60:63], v[92:95], v[52:55], a[60:63]
 ds_read_b64_tr_b16 v[88:89], v15 offset:28672
 buffer_store_dwordx4 v[180:183], v21, s[36:39], s10 offen offset:1024 sc1
 v_mfma_f32_16x16x32_bf16 a[56:59], v[92:95], v[48:51], a[56:59]
 s_waitcnt lgkmcnt(12)
 ds_read_b64_tr_b16 v[90:91], v15 offset:29184
 ds_read_b128 v[36:39], v17 offset:2048
 v_mfma_f32_16x16x32_bf16 a[64:67], v[64:67], v[48:51], a[64:67]
 ds_read_b64_tr_b16 v[92:93], v16 offset:28672
 v_mfma_f32_16x16x32_bf16 a[68:71], v[64:67], v[52:55], a[68:71]
 s_waitcnt lgkmcnt(13)
 s_barrier
 ds_read_b64_tr_b16 v[94:95], v16 offset:29184
 v_mfma_f32_16x16x32_bf16 a[76:79], v[68:71], v[52:55], a[76:79]
 s_add_u32 m0, s78, 0
 ds_read_b64_tr_b16 v[64:65], v108 offset:0
 v_mfma_f32_16x16x32_bf16 a[72:75], v[68:71], v[48:51], a[72:75]
 s_waitcnt lgkmcnt(13)
 ds_read_b64_tr_b16 v[66:67], v108 offset:512
 buffer_load_dwordx4 v9, s[24:27], s70 offen offset:0 lds
 v_mfma_f32_16x16x32_bf16 a[80:83], v[72:75], v[48:51], a[80:83]
 s_mov_b32 s75, s72
 ds_read_b64_tr_b16 v[68:69], v109 offset:0
 v_mfma_f32_16x16x32_bf16 a[84:87], v[72:75], v[52:55], a[84:87]
 s_waitcnt lgkmcnt(13)
 ds_read_b64_tr_b16 v[70:71], v109 offset:512
 v_mfma_f32_16x16x32_bf16 a[92:95], v[76:79], v[52:55], a[92:95]
 s_mov_b32 s72, s73
 ds_read_b64_tr_b16 v[72:73], v110 offset:0
 v_mfma_f32_16x16x32_bf16 a[88:91], v[76:79], v[48:51], a[88:91]
 s_waitcnt lgkmcnt(13)
 ds_read_b64_tr_b16 v[74:75], v110 offset:512
 buffer_load_dwordx4 v10, s[24:27], s70 offen offset:1024 lds
 v_mfma_f32_16x16x32_bf16 a[96:99], v[80:83], v[48:51], a[96:99]
 s_mov_b32 s73, s74
 ds_read_b64_tr_b16 v[76:77], v111 offset:0
 v_mfma_f32_16x16x32_bf16 a[100:103], v[80:83], v[52:55], a[100:103]
 s_waitcnt lgkmcnt(13)
 ds_read_b64_tr_b16 v[78:79], v111 offset:512
 v_mfma_f32_16x16x32_bf16 a[108:111], v[84:87], v[52:55], a[108:111]
 s_mov_b32 s74, s75
 ds_read_b64_tr_b16 v[80:81], v108 offset:4096
 v_mfma_f32_16x16x32_bf16 a[104:107], v[84:87], v[48:51], a[104:107]
 s_waitcnt lgkmcnt(12)
 ds_read_b64_tr_b16 v[82:83], v108 offset:4608
 buffer_load_dwordx4 v11, s[24:27], s70 offen offset:2048 lds
 v_mfma_f32_16x16x32_bf16 a[112:115], v[88:91], v[48:51], a[112:115]
 ds_read_b64_tr_b16 v[84:85], v109 offset:4096
 v_mfma_f32_16x16x32_bf16 a[116:119], v[88:91], v[52:55], a[116:119]
 s_waitcnt lgkmcnt(11)
 ds_read_b64_tr_b16 v[86:87], v109 offset:4608
 v_mfma_f32_16x16x32_bf16 a[124:127], v[92:95], v[52:55], a[124:127]
 ds_read_b64_tr_b16 v[88:89], v110 offset:4096
 v_mfma_f32_16x16x32_bf16 a[120:123], v[92:95], v[48:51], a[120:123]
 ds_read_b64_tr_b16 v[90:91], v110 offset:4608
 buffer_load_dwordx4 v12, s[24:27], s70 offen offset:3072 lds
 s_add_u32 s70, s70, s71
 s_waitcnt lgkmcnt(12)
 v_mfma_f32_16x16x32_bf16 a[0:3], v[64:67], v[32:35], a[0:3]
 s_add_u32 m0, s72, s76
 ds_read_b64_tr_b16 v[92:93], v111 offset:4096
 v_mfma_f32_16x16x32_bf16 a[4:7], v[64:67], v[36:39], a[4:7]
 s_waitcnt lgkmcnt(11)
 ds_read_b64_tr_b16 v[94:95], v111 offset:4608
 buffer_load_dwordx4 v1, s[20:23], s69 offen offset:0 lds
 v_mfma_f32_16x16x32_bf16 a[12:15], v[68:71], v[36:39], a[12:15]
 ds_read_b64_tr_b16 v[64:65], v108 offset:8192
 v_mfma_f32_16x16x32_bf16 a[8:11], v[68:71], v[32:35], a[8:11]
 s_waitcnt lgkmcnt(11)
 ds_read_b64_tr_b16 v[66:67], v108 offset:8704
 v_add_u32 v18, s73, v20
 v_mfma_f32_16x16x32_bf16 a[16:19], v[72:75], v[32:35], a[16:19]
 ds_read_b64_tr_b16 v[68:69], v109 offset:8192
 v_mfma_f32_16x16x32_bf16 a[20:23], v[72:75], v[36:39], a[20:23]
 s_waitcnt lgkmcnt(11)
 ds_read_b64_tr_b16 v[70:71], v109 offset:8704
 buffer_load_dwordx4 v2, s[20:23], s69 offen offset:1024 lds
 v_mfma_f32_16x16x32_bf16 a[28:31], v[76:79], v[36:39], a[28:31]
 ds_read_b64_tr_b16 v[72:73], v110 offset:8192
 v_mfma_f32_16x16x32_bf16 a[24:27], v[76:79], v[32:35], a[24:27]
 s_waitcnt lgkmcnt(11)
 ds_read_b64_tr_b16 v[74:75], v110 offset:8704
 v_mfma_f32_16x16x32_bf16 a[32:35], v[80:83], v[32:35], a[32:35]
 ds_read_b64_tr_b16 v[76:77], v111 offset:8192
 buffer_store_dwordx4 v[184:187], v21, s[36:39], s10 offen offset:2048 sc1
 v_mfma_f32_16x16x32_bf16 a[36:39], v[80:83], v[36:39], a[36:39]
 s_waitcnt lgkmcnt(11)
 ds_read_b64_tr_b16 v[78:79], v111 offset:8704
 v_mfma_f32_16x16x32_bf16 a[44:47], v[84:87], v[36:39], a[44:47]
 ds_read_b64_tr_b16 v[80:81], v108 offset:12288
 v_mfma_f32_16x16x32_bf16 a[40:43], v[84:87], v[32:35], a[40:43]
 s_waitcnt lgkmcnt(11)
 ds_read_b64_tr_b16 v[82:83], v108 offset:12800
 v_mfma_f32_16x16x32_bf16 a[48:51], v[88:91], v[32:35], a[48:51]
 ds_read_b64_tr_b16 v[84:85], v109 offset:12288
 v_mfma_f32_16x16x32_bf16 a[52:55], v[88:91], v[36:39], a[52:55]
 s_waitcnt lgkmcnt(11)
 ds_read_b64_tr_b16 v[86:87], v109 offset:12800
 ds_read_b128 v[48:51], v18 offset:0
 v_mfma_f32_16x16x32_bf16 a[60:63], v[92:95], v[36:39], a[60:63]
 ds_read_b64_tr_b16 v[88:89], v110 offset:12288
 buffer_store_dwordx4 v[188:191], v21, s[36:39], s10 offen offset:3072 sc1
 v_mfma_f32_16x16x32_bf16 a[56:59], v[92:95], v[32:35], a[56:59]
 s_waitcnt lgkmcnt(12)
 ds_read_b64_tr_b16 v[90:91], v110 offset:12800
 ds_read_b128 v[52:55], v18 offset:2048
 v_mfma_f32_16x16x32_bf16 a[64:67], v[64:67], v[32:35], a[64:67]
 ds_read_b64_tr_b16 v[92:93], v111 offset:12288
 v_mfma_f32_16x16x32_bf16 a[68:71], v[64:67], v[36:39], a[68:71]
 s_waitcnt lgkmcnt(13)
 s_waitcnt vmcnt(30)
 s_barrier
 ds_read_b64_tr_b16 v[94:95], v111 offset:12800
 v_mfma_f32_16x16x32_bf16 a[76:79], v[68:71], v[36:39], a[76:79]
 s_add_u32 m0, s78, 16384
 ds_read_b64_tr_b16 v[64:65], v108 offset:16384
 v_mfma_f32_16x16x32_bf16 a[72:75], v[68:71], v[32:35], a[72:75]
 s_waitcnt lgkmcnt(13)
 ds_read_b64_tr_b16 v[66:67], v108 offset:16896
 buffer_load_dwordx4 v9, s[24:27], s70 offen offset:0 lds
 v_mfma_f32_16x16x32_bf16 a[80:83], v[72:75], v[32:35], a[80:83]
 ds_read_b64_tr_b16 v[68:69], v109 offset:16384
 v_mfma_f32_16x16x32_bf16 a[84:87], v[72:75], v[36:39], a[84:87]
 s_waitcnt lgkmcnt(13)
 ds_read_b64_tr_b16 v[70:71], v109 offset:16896
 v_mfma_f32_16x16x32_bf16 a[92:95], v[76:79], v[36:39], a[92:95]
 ds_read_b64_tr_b16 v[72:73], v110 offset:16384
 v_mfma_f32_16x16x32_bf16 a[88:91], v[76:79], v[32:35], a[88:91]
 s_waitcnt lgkmcnt(13)
 ds_read_b64_tr_b16 v[74:75], v110 offset:16896
 buffer_load_dwordx4 v10, s[24:27], s70 offen offset:1024 lds
 v_mfma_f32_16x16x32_bf16 a[96:99], v[80:83], v[32:35], a[96:99]
 ds_read_b64_tr_b16 v[76:77], v111 offset:16384
 v_mfma_f32_16x16x32_bf16 a[100:103], v[80:83], v[36:39], a[100:103]
 s_waitcnt lgkmcnt(13)
 ds_read_b64_tr_b16 v[78:79], v111 offset:16896
 v_mfma_f32_16x16x32_bf16 a[108:111], v[84:87], v[36:39], a[108:111]
 ds_read_b64_tr_b16 v[80:81], v108 offset:20480
 v_mfma_f32_16x16x32_bf16 a[104:107], v[84:87], v[32:35], a[104:107]
 s_waitcnt lgkmcnt(12)
 ds_read_b64_tr_b16 v[82:83], v108 offset:20992
 buffer_load_dwordx4 v11, s[24:27], s70 offen offset:2048 lds
 v_mfma_f32_16x16x32_bf16 a[112:115], v[88:91], v[32:35], a[112:115]
 ds_read_b64_tr_b16 v[84:85], v109 offset:20480
 v_mfma_f32_16x16x32_bf16 a[116:119], v[88:91], v[36:39], a[116:119]
 s_waitcnt lgkmcnt(11)
 ds_read_b64_tr_b16 v[86:87], v109 offset:20992
 v_mfma_f32_16x16x32_bf16 a[124:127], v[92:95], v[36:39], a[124:127]
 ds_read_b64_tr_b16 v[88:89], v110 offset:20480
 v_mfma_f32_16x16x32_bf16 a[120:123], v[92:95], v[32:35], a[120:123]
 ds_read_b64_tr_b16 v[90:91], v110 offset:20992
 buffer_load_dwordx4 v12, s[24:27], s70 offen offset:3072 lds
 s_add_u32 s70, s70, s71
 s_waitcnt lgkmcnt(12)
 v_mfma_f32_16x16x32_bf16 a[0:3], v[64:67], v[48:51], a[0:3]
 s_add_u32 m0, s72, s76
 ds_read_b64_tr_b16 v[92:93], v111 offset:20480
 v_mfma_f32_16x16x32_bf16 a[4:7], v[64:67], v[52:55], a[4:7]
 s_waitcnt lgkmcnt(11)
 ds_read_b64_tr_b16 v[94:95], v111 offset:20992
 buffer_load_dwordx4 v3, s[20:23], s69 offen offset:2048 lds
 v_mfma_f32_16x16x32_bf16 a[12:15], v[68:71], v[52:55], a[12:15]
 ds_read_b64_tr_b16 v[64:65], v108 offset:24576
 v_mfma_f32_16x16x32_bf16 a[8:11], v[68:71], v[48:51], a[8:11]
 s_waitcnt lgkmcnt(11)
 ds_read_b64_tr_b16 v[66:67], v108 offset:25088
 v_add_u32 v17, s74, v19
 v_mfma_f32_16x16x32_bf16 a[16:19], v[72:75], v[48:51], a[16:19]
 ds_read_b64_tr_b16 v[68:69], v109 offset:24576
 v_mfma_f32_16x16x32_bf16 a[20:23], v[72:75], v[52:55], a[20:23]
 s_waitcnt lgkmcnt(11)
 ds_read_b64_tr_b16 v[70:71], v109 offset:25088
 buffer_load_dwordx4 v4, s[20:23], s69 offen offset:3072 lds
 v_mfma_f32_16x16x32_bf16 a[28:31], v[76:79], v[52:55], a[28:31]
 ds_read_b64_tr_b16 v[72:73], v110 offset:24576
 v_mfma_f32_16x16x32_bf16 a[24:27], v[76:79], v[48:51], a[24:27]
 s_waitcnt lgkmcnt(11)
 ds_read_b64_tr_b16 v[74:75], v110 offset:25088
 v_mfma_f32_16x16x32_bf16 a[32:35], v[80:83], v[48:51], a[32:35]
 ds_read_b64_tr_b16 v[76:77], v111 offset:24576
 buffer_store_dwordx4 v[192:195], v21, s[36:39], s11 offen offset:0 sc1
 v_mfma_f32_16x16x32_bf16 a[36:39], v[80:83], v[52:55], a[36:39]
 s_waitcnt lgkmcnt(11)
 ds_read_b64_tr_b16 v[78:79], v111 offset:25088
 v_mfma_f32_16x16x32_bf16 a[44:47], v[84:87], v[52:55], a[44:47]
 ds_read_b64_tr_b16 v[80:81], v108 offset:28672
 v_mfma_f32_16x16x32_bf16 a[40:43], v[84:87], v[48:51], a[40:43]
 s_waitcnt lgkmcnt(11)
 ds_read_b64_tr_b16 v[82:83], v108 offset:29184
 v_mfma_f32_16x16x32_bf16 a[48:51], v[88:91], v[48:51], a[48:51]
 s_add_u32 s69, s69, 128
 ds_read_b64_tr_b16 v[84:85], v109 offset:28672
 v_mfma_f32_16x16x32_bf16 a[52:55], v[88:91], v[52:55], a[52:55]
 s_waitcnt lgkmcnt(11)
 s_waitcnt vmcnt(17)
 ds_read_b64_tr_b16 v[86:87], v109 offset:29184
 ds_read_b128 v[32:35], v17 offset:0
 v_mfma_f32_16x16x32_bf16 a[60:63], v[92:95], v[52:55], a[60:63]
 ds_read_b64_tr_b16 v[88:89], v110 offset:28672
 buffer_store_dwordx4 v[196:199], v21, s[36:39], s11 offen offset:1024 sc1
 v_mfma_f32_16x16x32_bf16 a[56:59], v[92:95], v[48:51], a[56:59]
 s_waitcnt lgkmcnt(12)
 ds_read_b64_tr_b16 v[90:91], v110 offset:29184
 ds_read_b128 v[36:39], v17 offset:2048
 v_mfma_f32_16x16x32_bf16 a[64:67], v[64:67], v[48:51], a[64:67]
 ds_read_b64_tr_b16 v[92:93], v111 offset:28672
 v_mfma_f32_16x16x32_bf16 a[68:71], v[64:67], v[52:55], a[68:71]
 s_waitcnt lgkmcnt(13)
 s_waitcnt vmcnt(12)
 s_barrier
 ds_read_b64_tr_b16 v[94:95], v111 offset:29184
 v_mfma_f32_16x16x32_bf16 a[76:79], v[68:71], v[52:55], a[76:79]
 s_add_u32 m0, s87, 0
 ds_read_b64_tr_b16 v[64:65], v13 offset:0
 v_mfma_f32_16x16x32_bf16 a[72:75], v[68:71], v[48:51], a[72:75]
 s_waitcnt lgkmcnt(13)
 ds_read_b64_tr_b16 v[66:67], v13 offset:512
 buffer_load_dwordx4 v9, s[24:27], s70 offen offset:0 lds
 v_mfma_f32_16x16x32_bf16 a[80:83], v[72:75], v[48:51], a[80:83]
 s_mov_b32 s75, s72
 ds_read_b64_tr_b16 v[68:69], v14 offset:0
 v_mfma_f32_16x16x32_bf16 a[84:87], v[72:75], v[52:55], a[84:87]
 s_waitcnt lgkmcnt(13)
 ds_read_b64_tr_b16 v[70:71], v14 offset:512
 v_mfma_f32_16x16x32_bf16 a[92:95], v[76:79], v[52:55], a[92:95]
 s_mov_b32 s72, s73
 ds_read_b64_tr_b16 v[72:73], v15 offset:0
 v_mfma_f32_16x16x32_bf16 a[88:91], v[76:79], v[48:51], a[88:91]
 s_waitcnt lgkmcnt(13)
 ds_read_b64_tr_b16 v[74:75], v15 offset:512
 buffer_load_dwordx4 v10, s[24:27], s70 offen offset:1024 lds
 v_mfma_f32_16x16x32_bf16 a[96:99], v[80:83], v[48:51], a[96:99]
 s_mov_b32 s73, s74
 ds_read_b64_tr_b16 v[76:77], v16 offset:0
 v_mfma_f32_16x16x32_bf16 a[100:103], v[80:83], v[52:55], a[100:103]
 s_waitcnt lgkmcnt(13)
 ds_read_b64_tr_b16 v[78:79], v16 offset:512
 v_mfma_f32_16x16x32_bf16 a[108:111], v[84:87], v[52:55], a[108:111]
 s_mov_b32 s74, s75
 ds_read_b64_tr_b16 v[80:81], v13 offset:4096
 v_mfma_f32_16x16x32_bf16 a[104:107], v[84:87], v[48:51], a[104:107]
 s_waitcnt lgkmcnt(12)
 ds_read_b64_tr_b16 v[82:83], v13 offset:4608
 buffer_load_dwordx4 v11, s[24:27], s70 offen offset:2048 lds
 v_mfma_f32_16x16x32_bf16 a[112:115], v[88:91], v[48:51], a[112:115]
 ds_read_b64_tr_b16 v[84:85], v14 offset:4096
 v_mfma_f32_16x16x32_bf16 a[116:119], v[88:91], v[52:55], a[116:119]
 s_waitcnt lgkmcnt(11)
 ds_read_b64_tr_b16 v[86:87], v14 offset:4608
 v_mfma_f32_16x16x32_bf16 a[124:127], v[92:95], v[52:55], a[124:127]
 ds_read_b64_tr_b16 v[88:89], v15 offset:4096
 v_mfma_f32_16x16x32_bf16 a[120:123], v[92:95], v[48:51], a[120:123]
 ds_read_b64_tr_b16 v[90:91], v15 offset:4608
 buffer_load_dwordx4 v12, s[24:27], s70 offen offset:3072 lds
 s_add_u32 s70, s70, s71
 s_waitcnt lgkmcnt(12)
 v_mfma_f32_16x16x32_bf16 a[0:3], v[64:67], v[32:35], a[0:3]
 s_add_u32 m0, s72, s76
 ds_read_b64_tr_b16 v[92:93], v16 offset:4096
 v_mfma_f32_16x16x32_bf16 a[4:7], v[64:67], v[36:39], a[4:7]
 s_waitcnt lgkmcnt(11)
 ds_read_b64_tr_b16 v[94:95], v16 offset:4608
 buffer_load_dwordx4 v1, s[20:23], s69 offen offset:0 lds
 v_mfma_f32_16x16x32_bf16 a[12:15], v[68:71], v[36:39], a[12:15]
 ds_read_b64_tr_b16 v[64:65], v13 offset:8192
 v_mfma_f32_16x16x32_bf16 a[8:11], v[68:71], v[32:35], a[8:11]
 s_waitcnt lgkmcnt(11)
 ds_read_b64_tr_b16 v[66:67], v13 offset:8704
 v_add_u32 v18, s73, v20
 v_mfma_f32_16x16x32_bf16 a[16:19], v[72:75], v[32:35], a[16:19]
 ds_read_b64_tr_b16 v[68:69], v14 offset:8192
 v_mfma_f32_16x16x32_bf16 a[20:23], v[72:75], v[36:39], a[20:23]
 s_waitcnt lgkmcnt(11)
 ds_read_b64_tr_b16 v[70:71], v14 offset:8704
 buffer_load_dwordx4 v2, s[20:23], s69 offen offset:1024 lds
 v_mfma_f32_16x16x32_bf16 a[28:31], v[76:79], v[36:39], a[28:31]
 ds_read_b64_tr_b16 v[72:73], v15 offset:8192
 v_mfma_f32_16x16x32_bf16 a[24:27], v[76:79], v[32:35], a[24:27]
 s_waitcnt lgkmcnt(11)
 ds_read_b64_tr_b16 v[74:75], v15 offset:8704
 v_mfma_f32_16x16x32_bf16 a[32:35], v[80:83], v[32:35], a[32:35]
 ds_read_b64_tr_b16 v[76:77], v16 offset:8192
 buffer_store_dwordx4 v[200:203], v21, s[36:39], s11 offen offset:2048 sc1
 v_mfma_f32_16x16x32_bf16 a[36:39], v[80:83], v[36:39], a[36:39]
 s_waitcnt lgkmcnt(11)
 ds_read_b64_tr_b16 v[78:79], v16 offset:8704
 v_mfma_f32_16x16x32_bf16 a[44:47], v[84:87], v[36:39], a[44:47]
 ds_read_b64_tr_b16 v[80:81], v13 offset:12288
 v_mfma_f32_16x16x32_bf16 a[40:43], v[84:87], v[32:35], a[40:43]
 s_waitcnt lgkmcnt(11)
 ds_read_b64_tr_b16 v[82:83], v13 offset:12800
 v_mfma_f32_16x16x32_bf16 a[48:51], v[88:91], v[32:35], a[48:51]
 ds_read_b64_tr_b16 v[84:85], v14 offset:12288
 v_mfma_f32_16x16x32_bf16 a[52:55], v[88:91], v[36:39], a[52:55]
 s_waitcnt lgkmcnt(11)
 ds_read_b64_tr_b16 v[86:87], v14 offset:12800
 ds_read_b128 v[48:51], v18 offset:0
 v_mfma_f32_16x16x32_bf16 a[60:63], v[92:95], v[36:39], a[60:63]
 ds_read_b64_tr_b16 v[88:89], v15 offset:12288
 buffer_store_dwordx4 v[204:207], v21, s[36:39], s11 offen offset:3072 sc1
 v_mfma_f32_16x16x32_bf16 a[56:59], v[92:95], v[32:35], a[56:59]
 s_waitcnt lgkmcnt(12)
 ds_read_b64_tr_b16 v[90:91], v15 offset:12800
 ds_read_b128 v[52:55], v18 offset:2048
 v_mfma_f32_16x16x32_bf16 a[64:67], v[64:67], v[32:35], a[64:67]
 ds_read_b64_tr_b16 v[92:93], v16 offset:12288
 v_mfma_f32_16x16x32_bf16 a[68:71], v[64:67], v[36:39], a[68:71]
 s_waitcnt lgkmcnt(13)
 s_waitcnt vmcnt(12)
 s_barrier
 ds_read_b64_tr_b16 v[94:95], v16 offset:12800
 v_mfma_f32_16x16x32_bf16 a[76:79], v[68:71], v[36:39], a[76:79]
 s_add_u32 m0, s87, 16384
 ds_read_b64_tr_b16 v[64:65], v13 offset:16384
 v_mfma_f32_16x16x32_bf16 a[72:75], v[68:71], v[32:35], a[72:75]
 s_waitcnt lgkmcnt(13)
 ds_read_b64_tr_b16 v[66:67], v13 offset:16896
 buffer_load_dwordx4 v9, s[24:27], s70 offen offset:0 lds
 v_mfma_f32_16x16x32_bf16 a[80:83], v[72:75], v[32:35], a[80:83]
 ds_read_b64_tr_b16 v[68:69], v14 offset:16384
 v_mfma_f32_16x16x32_bf16 a[84:87], v[72:75], v[36:39], a[84:87]
 s_waitcnt lgkmcnt(13)
 ds_read_b64_tr_b16 v[70:71], v14 offset:16896
 v_mfma_f32_16x16x32_bf16 a[92:95], v[76:79], v[36:39], a[92:95]
 ds_read_b64_tr_b16 v[72:73], v15 offset:16384
 v_mfma_f32_16x16x32_bf16 a[88:91], v[76:79], v[32:35], a[88:91]
 s_waitcnt lgkmcnt(13)
 ds_read_b64_tr_b16 v[74:75], v15 offset:16896
 buffer_load_dwordx4 v10, s[24:27], s70 offen offset:1024 lds
 v_mfma_f32_16x16x32_bf16 a[96:99], v[80:83], v[32:35], a[96:99]
 ds_read_b64_tr_b16 v[76:77], v16 offset:16384
 v_mfma_f32_16x16x32_bf16 a[100:103], v[80:83], v[36:39], a[100:103]
 s_waitcnt lgkmcnt(13)
 ds_read_b64_tr_b16 v[78:79], v16 offset:16896
 v_mfma_f32_16x16x32_bf16 a[108:111], v[84:87], v[36:39], a[108:111]
 ds_read_b64_tr_b16 v[80:81], v13 offset:20480
 v_mfma_f32_16x16x32_bf16 a[104:107], v[84:87], v[32:35], a[104:107]
 s_waitcnt lgkmcnt(12)
 ds_read_b64_tr_b16 v[82:83], v13 offset:20992
 buffer_load_dwordx4 v11, s[24:27], s70 offen offset:2048 lds
 v_mfma_f32_16x16x32_bf16 a[112:115], v[88:91], v[32:35], a[112:115]
 ds_read_b64_tr_b16 v[84:85], v14 offset:20480
 v_mfma_f32_16x16x32_bf16 a[116:119], v[88:91], v[36:39], a[116:119]
 s_waitcnt lgkmcnt(11)
 ds_read_b64_tr_b16 v[86:87], v14 offset:20992
 v_mfma_f32_16x16x32_bf16 a[124:127], v[92:95], v[36:39], a[124:127]
 ds_read_b64_tr_b16 v[88:89], v15 offset:20480
 v_mfma_f32_16x16x32_bf16 a[120:123], v[92:95], v[32:35], a[120:123]
 ds_read_b64_tr_b16 v[90:91], v15 offset:20992
 buffer_load_dwordx4 v12, s[24:27], s70 offen offset:3072 lds
 s_add_u32 s70, s70, s71
 s_waitcnt lgkmcnt(12)
 v_mfma_f32_16x16x32_bf16 a[0:3], v[64:67], v[48:51], a[0:3]
 s_add_u32 m0, s72, s76
 ds_read_b64_tr_b16 v[92:93], v16 offset:20480
 v_mfma_f32_16x16x32_bf16 a[4:7], v[64:67], v[52:55], a[4:7]
 s_waitcnt lgkmcnt(11)
 ds_read_b64_tr_b16 v[94:95], v16 offset:20992
 buffer_load_dwordx4 v3, s[20:23], s69 offen offset:2048 lds
 v_mfma_f32_16x16x32_bf16 a[12:15], v[68:71], v[52:55], a[12:15]
 ds_read_b64_tr_b16 v[64:65], v13 offset:24576
 v_mfma_f32_16x16x32_bf16 a[8:11], v[68:71], v[48:51], a[8:11]
 s_waitcnt lgkmcnt(11)
 ds_read_b64_tr_b16 v[66:67], v13 offset:25088
 v_add_u32 v17, s74, v19
 v_mfma_f32_16x16x32_bf16 a[16:19], v[72:75], v[48:51], a[16:19]
 ds_read_b64_tr_b16 v[68:69], v14 offset:24576
 v_mfma_f32_16x16x32_bf16 a[20:23], v[72:75], v[52:55], a[20:23]
 s_waitcnt lgkmcnt(11)
 ds_read_b64_tr_b16 v[70:71], v14 offset:25088
 buffer_load_dwordx4 v4, s[20:23], s69 offen offset:3072 lds
 v_mfma_f32_16x16x32_bf16 a[28:31], v[76:79], v[52:55], a[28:31]
 ds_read_b64_tr_b16 v[72:73], v15 offset:24576
 v_mfma_f32_16x16x32_bf16 a[24:27], v[76:79], v[48:51], a[24:27]
 s_waitcnt lgkmcnt(11)
 ds_read_b64_tr_b16 v[74:75], v15 offset:25088
 v_mfma_f32_16x16x32_bf16 a[32:35], v[80:83], v[48:51], a[32:35]
 ds_read_b64_tr_b16 v[76:77], v16 offset:24576
 buffer_store_dwordx4 v[208:211], v21, s[36:39], s12 offen offset:0 sc1
 v_mfma_f32_16x16x32_bf16 a[36:39], v[80:83], v[52:55], a[36:39]
 s_waitcnt lgkmcnt(11)
 ds_read_b64_tr_b16 v[78:79], v16 offset:25088
 v_mfma_f32_16x16x32_bf16 a[44:47], v[84:87], v[52:55], a[44:47]
 ds_read_b64_tr_b16 v[80:81], v13 offset:28672
 v_mfma_f32_16x16x32_bf16 a[40:43], v[84:87], v[48:51], a[40:43]
 s_waitcnt lgkmcnt(11)
 ds_read_b64_tr_b16 v[82:83], v13 offset:29184
 v_mfma_f32_16x16x32_bf16 a[48:51], v[88:91], v[48:51], a[48:51]
 s_add_u32 s69, s69, 128
 ds_read_b64_tr_b16 v[84:85], v14 offset:28672
 v_mfma_f32_16x16x32_bf16 a[52:55], v[88:91], v[52:55], a[52:55]
 s_waitcnt lgkmcnt(11)
 s_waitcnt vmcnt(17)
 ds_read_b64_tr_b16 v[86:87], v14 offset:29184
 ds_read_b128 v[32:35], v17 offset:0
 v_mfma_f32_16x16x32_bf16 a[60:63], v[92:95], v[52:55], a[60:63]
 ds_read_b64_tr_b16 v[88:89], v15 offset:28672
 buffer_store_dwordx4 v[212:215], v21, s[36:39], s12 offen offset:1024 sc1
 v_mfma_f32_16x16x32_bf16 a[56:59], v[92:95], v[48:51], a[56:59]
 s_waitcnt lgkmcnt(12)
 ds_read_b64_tr_b16 v[90:91], v15 offset:29184
 ds_read_b128 v[36:39], v17 offset:2048
 v_mfma_f32_16x16x32_bf16 a[64:67], v[64:67], v[48:51], a[64:67]
 ds_read_b64_tr_b16 v[92:93], v16 offset:28672
 v_mfma_f32_16x16x32_bf16 a[68:71], v[64:67], v[52:55], a[68:71]
 s_waitcnt lgkmcnt(13)
 s_waitcnt vmcnt(12)
 s_barrier
 ds_read_b64_tr_b16 v[94:95], v16 offset:29184
 v_mfma_f32_16x16x32_bf16 a[76:79], v[68:71], v[52:55], a[76:79]
 s_add_u32 m0, s78, 0
 ds_read_b64_tr_b16 v[64:65], v108 offset:0
 v_mfma_f32_16x16x32_bf16 a[72:75], v[68:71], v[48:51], a[72:75]
 s_waitcnt lgkmcnt(13)
 ds_read_b64_tr_b16 v[66:67], v108 offset:512
 buffer_load_dwordx4 v9, s[24:27], s70 offen offset:0 lds
 v_mfma_f32_16x16x32_bf16 a[80:83], v[72:75], v[48:51], a[80:83]
 s_mov_b32 s75, s72
 ds_read_b64_tr_b16 v[68:69], v109 offset:0
 v_mfma_f32_16x16x32_bf16 a[84:87], v[72:75], v[52:55], a[84:87]
 s_waitcnt lgkmcnt(13)
 ds_read_b64_tr_b16 v[70:71], v109 offset:512
 v_mfma_f32_16x16x32_bf16 a[92:95], v[76:79], v[52:55], a[92:95]
 s_mov_b32 s72, s73
 ds_read_b64_tr_b16 v[72:73], v110 offset:0
 v_mfma_f32_16x16x32_bf16 a[88:91], v[76:79], v[48:51], a[88:91]
 s_waitcnt lgkmcnt(13)
 ds_read_b64_tr_b16 v[74:75], v110 offset:512
 buffer_load_dwordx4 v10, s[24:27], s70 offen offset:1024 lds
 v_mfma_f32_16x16x32_bf16 a[96:99], v[80:83], v[48:51], a[96:99]
 s_mov_b32 s73, s74
 ds_read_b64_tr_b16 v[76:77], v111 offset:0
 v_mfma_f32_16x16x32_bf16 a[100:103], v[80:83], v[52:55], a[100:103]
 s_waitcnt lgkmcnt(13)
 ds_read_b64_tr_b16 v[78:79], v111 offset:512
 v_mfma_f32_16x16x32_bf16 a[108:111], v[84:87], v[52:55], a[108:111]
 s_mov_b32 s74, s75
 ds_read_b64_tr_b16 v[80:81], v108 offset:4096
 v_mfma_f32_16x16x32_bf16 a[104:107], v[84:87], v[48:51], a[104:107]
 s_waitcnt lgkmcnt(12)
 ds_read_b64_tr_b16 v[82:83], v108 offset:4608
 buffer_load_dwordx4 v11, s[24:27], s70 offen offset:2048 lds
 v_mfma_f32_16x16x32_bf16 a[112:115], v[88:91], v[48:51], a[112:115]
 ds_read_b64_tr_b16 v[84:85], v109 offset:4096
 v_mfma_f32_16x16x32_bf16 a[116:119], v[88:91], v[52:55], a[116:119]
 s_waitcnt lgkmcnt(11)
 ds_read_b64_tr_b16 v[86:87], v109 offset:4608
 v_mfma_f32_16x16x32_bf16 a[124:127], v[92:95], v[52:55], a[124:127]
 ds_read_b64_tr_b16 v[88:89], v110 offset:4096
 v_mfma_f32_16x16x32_bf16 a[120:123], v[92:95], v[48:51], a[120:123]
 ds_read_b64_tr_b16 v[90:91], v110 offset:4608
 buffer_load_dwordx4 v12, s[24:27], s70 offen offset:3072 lds
 s_add_u32 s70, s70, s71
 s_waitcnt lgkmcnt(12)
 v_mfma_f32_16x16x32_bf16 a[0:3], v[64:67], v[32:35], a[0:3]
 s_add_u32 m0, s72, s76
 ds_read_b64_tr_b16 v[92:93], v111 offset:4096
 v_mfma_f32_16x16x32_bf16 a[4:7], v[64:67], v[36:39], a[4:7]
 s_waitcnt lgkmcnt(11)
 ds_read_b64_tr_b16 v[94:95], v111 offset:4608
 buffer_load_dwordx4 v1, s[20:23], s69 offen offset:0 lds
 v_mfma_f32_16x16x32_bf16 a[12:15], v[68:71], v[36:39], a[12:15]
 ds_read_b64_tr_b16 v[64:65], v108 offset:8192
 v_mfma_f32_16x16x32_bf16 a[8:11], v[68:71], v[32:35], a[8:11]
 s_waitcnt lgkmcnt(11)
 ds_read_b64_tr_b16 v[66:67], v108 offset:8704
 v_add_u32 v18, s73, v20
 v_mfma_f32_16x16x32_bf16 a[16:19], v[72:75], v[32:35], a[16:19]
 ds_read_b64_tr_b16 v[68:69], v109 offset:8192
 v_mfma_f32_16x16x32_bf16 a[20:23], v[72:75], v[36:39], a[20:23]
 s_waitcnt lgkmcnt(11)
 ds_read_b64_tr_b16 v[70:71], v109 offset:8704
 buffer_load_dwordx4 v2, s[20:23], s69 offen offset:1024 lds
 v_mfma_f32_16x16x32_bf16 a[28:31], v[76:79], v[36:39], a[28:31]
 ds_read_b64_tr_b16 v[72:73], v110 offset:8192
 v_mfma_f32_16x16x32_bf16 a[24:27], v[76:79], v[32:35], a[24:27]
 s_waitcnt lgkmcnt(11)
 ds_read_b64_tr_b16 v[74:75], v110 offset:8704
 v_mfma_f32_16x16x32_bf16 a[32:35], v[80:83], v[32:35], a[32:35]
 ds_read_b64_tr_b16 v[76:77], v111 offset:8192
 buffer_store_dwordx4 v[216:219], v21, s[36:39], s12 offen offset:2048 sc1
 v_mfma_f32_16x16x32_bf16 a[36:39], v[80:83], v[36:39], a[36:39]
 s_waitcnt lgkmcnt(11)
 ds_read_b64_tr_b16 v[78:79], v111 offset:8704
 v_mfma_f32_16x16x32_bf16 a[44:47], v[84:87], v[36:39], a[44:47]
 ds_read_b64_tr_b16 v[80:81], v108 offset:12288
 v_mfma_f32_16x16x32_bf16 a[40:43], v[84:87], v[32:35], a[40:43]
 s_waitcnt lgkmcnt(11)
 ds_read_b64_tr_b16 v[82:83], v108 offset:12800
 v_mfma_f32_16x16x32_bf16 a[48:51], v[88:91], v[32:35], a[48:51]
 ds_read_b64_tr_b16 v[84:85], v109 offset:12288
 v_mfma_f32_16x16x32_bf16 a[52:55], v[88:91], v[36:39], a[52:55]
 s_waitcnt lgkmcnt(11)
 ds_read_b64_tr_b16 v[86:87], v109 offset:12800
 ds_read_b128 v[48:51], v18 offset:0
 v_mfma_f32_16x16x32_bf16 a[60:63], v[92:95], v[36:39], a[60:63]
 ds_read_b64_tr_b16 v[88:89], v110 offset:12288
 buffer_store_dwordx4 v[220:223], v21, s[36:39], s12 offen offset:3072 sc1
 v_mfma_f32_16x16x32_bf16 a[56:59], v[92:95], v[32:35], a[56:59]
 s_waitcnt lgkmcnt(12)
 ds_read_b64_tr_b16 v[90:91], v110 offset:12800
 ds_read_b128 v[52:55], v18 offset:2048
 v_mfma_f32_16x16x32_bf16 a[64:67], v[64:67], v[32:35], a[64:67]
 ds_read_b64_tr_b16 v[92:93], v111 offset:12288
 v_mfma_f32_16x16x32_bf16 a[68:71], v[64:67], v[36:39], a[68:71]
 s_waitcnt lgkmcnt(13)
 s_waitcnt vmcnt(12)
 s_barrier
 ds_read_b64_tr_b16 v[94:95], v111 offset:12800
 v_mfma_f32_16x16x32_bf16 a[76:79], v[68:71], v[36:39], a[76:79]
 s_add_u32 m0, s78, 16384
 ds_read_b64_tr_b16 v[64:65], v108 offset:16384
 v_mfma_f32_16x16x32_bf16 a[72:75], v[68:71], v[32:35], a[72:75]
 s_waitcnt lgkmcnt(13)
 ds_read_b64_tr_b16 v[66:67], v108 offset:16896
 buffer_load_dwordx4 v9, s[24:27], s70 offen offset:0 lds
 v_mfma_f32_16x16x32_bf16 a[80:83], v[72:75], v[32:35], a[80:83]
 ds_read_b64_tr_b16 v[68:69], v109 offset:16384
 v_mfma_f32_16x16x32_bf16 a[84:87], v[72:75], v[36:39], a[84:87]
 s_waitcnt lgkmcnt(13)
 ds_read_b64_tr_b16 v[70:71], v109 offset:16896
 v_mfma_f32_16x16x32_bf16 a[92:95], v[76:79], v[36:39], a[92:95]
 ds_read_b64_tr_b16 v[72:73], v110 offset:16384
 v_mfma_f32_16x16x32_bf16 a[88:91], v[76:79], v[32:35], a[88:91]
 s_waitcnt lgkmcnt(13)
 ds_read_b64_tr_b16 v[74:75], v110 offset:16896
 buffer_load_dwordx4 v10, s[24:27], s70 offen offset:1024 lds
 v_mfma_f32_16x16x32_bf16 a[96:99], v[80:83], v[32:35], a[96:99]
 ds_read_b64_tr_b16 v[76:77], v111 offset:16384
 v_mfma_f32_16x16x32_bf16 a[100:103], v[80:83], v[36:39], a[100:103]
 s_waitcnt lgkmcnt(13)
 ds_read_b64_tr_b16 v[78:79], v111 offset:16896
 v_mfma_f32_16x16x32_bf16 a[108:111], v[84:87], v[36:39], a[108:111]
 ds_read_b64_tr_b16 v[80:81], v108 offset:20480
 v_mfma_f32_16x16x32_bf16 a[104:107], v[84:87], v[32:35], a[104:107]
 s_waitcnt lgkmcnt(12)
 ds_read_b64_tr_b16 v[82:83], v108 offset:20992
 buffer_load_dwordx4 v11, s[24:27], s70 offen offset:2048 lds
 v_mfma_f32_16x16x32_bf16 a[112:115], v[88:91], v[32:35], a[112:115]
 ds_read_b64_tr_b16 v[84:85], v109 offset:20480
 v_mfma_f32_16x16x32_bf16 a[116:119], v[88:91], v[36:39], a[116:119]
 s_waitcnt lgkmcnt(11)
 ds_read_b64_tr_b16 v[86:87], v109 offset:20992
 v_mfma_f32_16x16x32_bf16 a[124:127], v[92:95], v[36:39], a[124:127]
 ds_read_b64_tr_b16 v[88:89], v110 offset:20480
 v_mfma_f32_16x16x32_bf16 a[120:123], v[92:95], v[32:35], a[120:123]
 ds_read_b64_tr_b16 v[90:91], v110 offset:20992
 buffer_load_dwordx4 v12, s[24:27], s70 offen offset:3072 lds
 s_add_u32 s70, s70, s71
 s_waitcnt lgkmcnt(12)
 v_mfma_f32_16x16x32_bf16 a[0:3], v[64:67], v[48:51], a[0:3]
 s_add_u32 m0, s72, s76
 ds_read_b64_tr_b16 v[92:93], v111 offset:20480
 v_mfma_f32_16x16x32_bf16 a[4:7], v[64:67], v[52:55], a[4:7]
 s_waitcnt lgkmcnt(11)
 ds_read_b64_tr_b16 v[94:95], v111 offset:20992
 buffer_load_dwordx4 v3, s[20:23], s69 offen offset:2048 lds
 v_mfma_f32_16x16x32_bf16 a[12:15], v[68:71], v[52:55], a[12:15]
 ds_read_b64_tr_b16 v[64:65], v108 offset:24576
 v_mfma_f32_16x16x32_bf16 a[8:11], v[68:71], v[48:51], a[8:11]
 s_waitcnt lgkmcnt(11)
 ds_read_b64_tr_b16 v[66:67], v108 offset:25088
 v_add_u32 v17, s74, v19
 v_mfma_f32_16x16x32_bf16 a[16:19], v[72:75], v[48:51], a[16:19]
 ds_read_b64_tr_b16 v[68:69], v109 offset:24576
 v_mfma_f32_16x16x32_bf16 a[20:23], v[72:75], v[52:55], a[20:23]
 s_waitcnt lgkmcnt(11)
 ds_read_b64_tr_b16 v[70:71], v109 offset:25088
 buffer_load_dwordx4 v4, s[20:23], s69 offen offset:3072 lds
 v_mfma_f32_16x16x32_bf16 a[28:31], v[76:79], v[52:55], a[28:31]
 ds_read_b64_tr_b16 v[72:73], v110 offset:24576
 v_mfma_f32_16x16x32_bf16 a[24:27], v[76:79], v[48:51], a[24:27]
 s_waitcnt lgkmcnt(11)
 ds_read_b64_tr_b16 v[74:75], v110 offset:25088
 v_mfma_f32_16x16x32_bf16 a[32:35], v[80:83], v[48:51], a[32:35]
 ds_read_b64_tr_b16 v[76:77], v111 offset:24576
 buffer_store_dwordx4 v[224:227], v21, s[36:39], s13 offen offset:0 sc1
 v_mfma_f32_16x16x32_bf16 a[36:39], v[80:83], v[52:55], a[36:39]
 s_waitcnt lgkmcnt(11)
 ds_read_b64_tr_b16 v[78:79], v111 offset:25088
 v_mfma_f32_16x16x32_bf16 a[44:47], v[84:87], v[52:55], a[44:47]
 ds_read_b64_tr_b16 v[80:81], v108 offset:28672
 v_mfma_f32_16x16x32_bf16 a[40:43], v[84:87], v[48:51], a[40:43]
 s_waitcnt lgkmcnt(11)
 ds_read_b64_tr_b16 v[82:83], v108 offset:29184
 v_mfma_f32_16x16x32_bf16 a[48:51], v[88:91], v[48:51], a[48:51]
 s_add_u32 s69, s69, 128
 ds_read_b64_tr_b16 v[84:85], v109 offset:28672
 v_mfma_f32_16x16x32_bf16 a[52:55], v[88:91], v[52:55], a[52:55]
 s_waitcnt lgkmcnt(11)
 s_waitcnt vmcnt(17)
 ds_read_b64_tr_b16 v[86:87], v109 offset:29184
 ds_read_b128 v[32:35], v17 offset:0
 v_mfma_f32_16x16x32_bf16 a[60:63], v[92:95], v[52:55], a[60:63]
 ds_read_b64_tr_b16 v[88:89], v110 offset:28672
 buffer_store_dwordx4 v[228:231], v21, s[36:39], s13 offen offset:1024 sc1
 v_mfma_f32_16x16x32_bf16 a[56:59], v[92:95], v[48:51], a[56:59]
 s_waitcnt lgkmcnt(12)
 ds_read_b64_tr_b16 v[90:91], v110 offset:29184
 ds_read_b128 v[36:39], v17 offset:2048
 v_mfma_f32_16x16x32_bf16 a[64:67], v[64:67], v[48:51], a[64:67]
 ds_read_b64_tr_b16 v[92:93], v111 offset:28672
 v_mfma_f32_16x16x32_bf16 a[68:71], v[64:67], v[52:55], a[68:71]
 s_waitcnt lgkmcnt(13)
 s_waitcnt vmcnt(12)
 s_barrier
 ds_read_b64_tr_b16 v[94:95], v111 offset:29184
 v_mfma_f32_16x16x32_bf16 a[76:79], v[68:71], v[52:55], a[76:79]
 s_add_u32 m0, s87, 0
 ds_read_b64_tr_b16 v[64:65], v13 offset:0
 v_mfma_f32_16x16x32_bf16 a[72:75], v[68:71], v[48:51], a[72:75]
 s_waitcnt lgkmcnt(13)
 ds_read_b64_tr_b16 v[66:67], v13 offset:512
 buffer_load_dwordx4 v9, s[24:27], s70 offen offset:0 lds
 v_mfma_f32_16x16x32_bf16 a[80:83], v[72:75], v[48:51], a[80:83]
 s_mov_b32 s75, s72
 ds_read_b64_tr_b16 v[68:69], v14 offset:0
 v_mfma_f32_16x16x32_bf16 a[84:87], v[72:75], v[52:55], a[84:87]
 s_waitcnt lgkmcnt(13)
 ds_read_b64_tr_b16 v[70:71], v14 offset:512
 v_mfma_f32_16x16x32_bf16 a[92:95], v[76:79], v[52:55], a[92:95]
 s_mov_b32 s72, s73
 ds_read_b64_tr_b16 v[72:73], v15 offset:0
 v_mfma_f32_16x16x32_bf16 a[88:91], v[76:79], v[48:51], a[88:91]
 s_waitcnt lgkmcnt(13)
 ds_read_b64_tr_b16 v[74:75], v15 offset:512
 buffer_load_dwordx4 v10, s[24:27], s70 offen offset:1024 lds
 v_mfma_f32_16x16x32_bf16 a[96:99], v[80:83], v[48:51], a[96:99]
 s_mov_b32 s73, s74
 ds_read_b64_tr_b16 v[76:77], v16 offset:0
 v_mfma_f32_16x16x32_bf16 a[100:103], v[80:83], v[52:55], a[100:103]
 s_waitcnt lgkmcnt(13)
 ds_read_b64_tr_b16 v[78:79], v16 offset:512
 v_mfma_f32_16x16x32_bf16 a[108:111], v[84:87], v[52:55], a[108:111]
 s_mov_b32 s74, s75
 ds_read_b64_tr_b16 v[80:81], v13 offset:4096
 v_mfma_f32_16x16x32_bf16 a[104:107], v[84:87], v[48:51], a[104:107]
 s_waitcnt lgkmcnt(12)
 ds_read_b64_tr_b16 v[82:83], v13 offset:4608
 buffer_load_dwordx4 v11, s[24:27], s70 offen offset:2048 lds
 v_mfma_f32_16x16x32_bf16 a[112:115], v[88:91], v[48:51], a[112:115]
 ds_read_b64_tr_b16 v[84:85], v14 offset:4096
 v_mfma_f32_16x16x32_bf16 a[116:119], v[88:91], v[52:55], a[116:119]
 s_waitcnt lgkmcnt(11)
 ds_read_b64_tr_b16 v[86:87], v14 offset:4608
 v_mfma_f32_16x16x32_bf16 a[124:127], v[92:95], v[52:55], a[124:127]
 ds_read_b64_tr_b16 v[88:89], v15 offset:4096
 v_mfma_f32_16x16x32_bf16 a[120:123], v[92:95], v[48:51], a[120:123]
 ds_read_b64_tr_b16 v[90:91], v15 offset:4608
 buffer_load_dwordx4 v12, s[24:27], s70 offen offset:3072 lds
 s_add_u32 s70, s70, s71
 s_waitcnt lgkmcnt(12)
 v_mfma_f32_16x16x32_bf16 a[0:3], v[64:67], v[32:35], a[0:3]
 s_add_u32 m0, s72, s76
 ds_read_b64_tr_b16 v[92:93], v16 offset:4096
 v_mfma_f32_16x16x32_bf16 a[4:7], v[64:67], v[36:39], a[4:7]
 s_waitcnt lgkmcnt(11)
 ds_read_b64_tr_b16 v[94:95], v16 offset:4608
 buffer_load_dwordx4 v1, s[20:23], s69 offen offset:0 lds
 v_mfma_f32_16x16x32_bf16 a[12:15], v[68:71], v[36:39], a[12:15]
 ds_read_b64_tr_b16 v[64:65], v13 offset:8192
 v_mfma_f32_16x16x32_bf16 a[8:11], v[68:71], v[32:35], a[8:11]
 s_waitcnt lgkmcnt(11)
 ds_read_b64_tr_b16 v[66:67], v13 offset:8704
 v_add_u32 v18, s73, v20
 v_mfma_f32_16x16x32_bf16 a[16:19], v[72:75], v[32:35], a[16:19]
 ds_read_b64_tr_b16 v[68:69], v14 offset:8192
 v_mfma_f32_16x16x32_bf16 a[20:23], v[72:75], v[36:39], a[20:23]
 s_waitcnt lgkmcnt(11)
 ds_read_b64_tr_b16 v[70:71], v14 offset:8704
 buffer_load_dwordx4 v2, s[20:23], s69 offen offset:1024 lds
 v_mfma_f32_16x16x32_bf16 a[28:31], v[76:79], v[36:39], a[28:31]
 ds_read_b64_tr_b16 v[72:73], v15 offset:8192
 v_mfma_f32_16x16x32_bf16 a[24:27], v[76:79], v[32:35], a[24:27]
 s_waitcnt lgkmcnt(11)
 ds_read_b64_tr_b16 v[74:75], v15 offset:8704
 v_mfma_f32_16x16x32_bf16 a[32:35], v[80:83], v[32:35], a[32:35]
 ds_read_b64_tr_b16 v[76:77], v16 offset:8192
 buffer_store_dwordx4 v[232:235], v21, s[36:39], s13 offen offset:2048 sc1
 v_mfma_f32_16x16x32_bf16 a[36:39], v[80:83], v[36:39], a[36:39]
 s_waitcnt lgkmcnt(11)
 ds_read_b64_tr_b16 v[78:79], v16 offset:8704
 v_mfma_f32_16x16x32_bf16 a[44:47], v[84:87], v[36:39], a[44:47]
 ds_read_b64_tr_b16 v[80:81], v13 offset:12288
 v_mfma_f32_16x16x32_bf16 a[40:43], v[84:87], v[32:35], a[40:43]
 s_waitcnt lgkmcnt(11)
 ds_read_b64_tr_b16 v[82:83], v13 offset:12800
 v_mfma_f32_16x16x32_bf16 a[48:51], v[88:91], v[32:35], a[48:51]
 ds_read_b64_tr_b16 v[84:85], v14 offset:12288
 v_mfma_f32_16x16x32_bf16 a[52:55], v[88:91], v[36:39], a[52:55]
 s_waitcnt lgkmcnt(11)
 ds_read_b64_tr_b16 v[86:87], v14 offset:12800
 ds_read_b128 v[48:51], v18 offset:0
 v_mfma_f32_16x16x32_bf16 a[60:63], v[92:95], v[36:39], a[60:63]
 ds_read_b64_tr_b16 v[88:89], v15 offset:12288
 buffer_store_dwordx4 v[236:239], v21, s[36:39], s13 offen offset:3072 sc1
 v_mfma_f32_16x16x32_bf16 a[56:59], v[92:95], v[32:35], a[56:59]
 s_waitcnt lgkmcnt(12)
 ds_read_b64_tr_b16 v[90:91], v15 offset:12800
 ds_read_b128 v[52:55], v18 offset:2048
 v_mfma_f32_16x16x32_bf16 a[64:67], v[64:67], v[32:35], a[64:67]
 ds_read_b64_tr_b16 v[92:93], v16 offset:12288
 v_mfma_f32_16x16x32_bf16 a[68:71], v[64:67], v[36:39], a[68:71]
 s_waitcnt lgkmcnt(13)
 s_waitcnt vmcnt(12)
 s_barrier
 ds_read_b64_tr_b16 v[94:95], v16 offset:12800
 v_mfma_f32_16x16x32_bf16 a[76:79], v[68:71], v[36:39], a[76:79]
 s_add_u32 m0, s87, 16384
 ds_read_b64_tr_b16 v[64:65], v13 offset:16384
 v_mfma_f32_16x16x32_bf16 a[72:75], v[68:71], v[32:35], a[72:75]
 s_waitcnt lgkmcnt(13)
 ds_read_b64_tr_b16 v[66:67], v13 offset:16896
 buffer_load_dwordx4 v9, s[24:27], s70 offen offset:0 lds
 v_mfma_f32_16x16x32_bf16 a[80:83], v[72:75], v[32:35], a[80:83]
 ds_read_b64_tr_b16 v[68:69], v14 offset:16384
 v_mfma_f32_16x16x32_bf16 a[84:87], v[72:75], v[36:39], a[84:87]
 s_waitcnt lgkmcnt(13)
 ds_read_b64_tr_b16 v[70:71], v14 offset:16896
 v_mfma_f32_16x16x32_bf16 a[92:95], v[76:79], v[36:39], a[92:95]
 ds_read_b64_tr_b16 v[72:73], v15 offset:16384
 v_mfma_f32_16x16x32_bf16 a[88:91], v[76:79], v[32:35], a[88:91]
 s_waitcnt lgkmcnt(13)
 ds_read_b64_tr_b16 v[74:75], v15 offset:16896
 buffer_load_dwordx4 v10, s[24:27], s70 offen offset:1024 lds
 v_mfma_f32_16x16x32_bf16 a[96:99], v[80:83], v[32:35], a[96:99]
 ds_read_b64_tr_b16 v[76:77], v16 offset:16384
 v_mfma_f32_16x16x32_bf16 a[100:103], v[80:83], v[36:39], a[100:103]
 s_waitcnt lgkmcnt(13)
 ds_read_b64_tr_b16 v[78:79], v16 offset:16896
 v_mfma_f32_16x16x32_bf16 a[108:111], v[84:87], v[36:39], a[108:111]
 ds_read_b64_tr_b16 v[80:81], v13 offset:20480
 v_mfma_f32_16x16x32_bf16 a[104:107], v[84:87], v[32:35], a[104:107]
 s_waitcnt lgkmcnt(12)
 ds_read_b64_tr_b16 v[82:83], v13 offset:20992
 buffer_load_dwordx4 v11, s[24:27], s70 offen offset:2048 lds
 v_mfma_f32_16x16x32_bf16 a[112:115], v[88:91], v[32:35], a[112:115]
 ds_read_b64_tr_b16 v[84:85], v14 offset:20480
 v_mfma_f32_16x16x32_bf16 a[116:119], v[88:91], v[36:39], a[116:119]
 s_waitcnt lgkmcnt(11)
 ds_read_b64_tr_b16 v[86:87], v14 offset:20992
 v_mfma_f32_16x16x32_bf16 a[124:127], v[92:95], v[36:39], a[124:127]
 ds_read_b64_tr_b16 v[88:89], v15 offset:20480
 v_mfma_f32_16x16x32_bf16 a[120:123], v[92:95], v[32:35], a[120:123]
 ds_read_b64_tr_b16 v[90:91], v15 offset:20992
 buffer_load_dwordx4 v12, s[24:27], s70 offen offset:3072 lds
 s_add_u32 s70, s70, s71
 s_waitcnt lgkmcnt(12)
 v_mfma_f32_16x16x32_bf16 a[0:3], v[64:67], v[48:51], a[0:3]
 s_add_u32 m0, s72, s76
 ds_read_b64_tr_b16 v[92:93], v16 offset:20480
 v_mfma_f32_16x16x32_bf16 a[4:7], v[64:67], v[52:55], a[4:7]
 s_waitcnt lgkmcnt(11)
 ds_read_b64_tr_b16 v[94:95], v16 offset:20992
 buffer_load_dwordx4 v3, s[20:23], s69 offen offset:2048 lds
 v_mfma_f32_16x16x32_bf16 a[12:15], v[68:71], v[52:55], a[12:15]
 ds_read_b64_tr_b16 v[64:65], v13 offset:24576
 v_mfma_f32_16x16x32_bf16 a[8:11], v[68:71], v[48:51], a[8:11]
 s_waitcnt lgkmcnt(11)
 ds_read_b64_tr_b16 v[66:67], v13 offset:25088
 v_add_u32 v17, s74, v19
 v_mfma_f32_16x16x32_bf16 a[16:19], v[72:75], v[48:51], a[16:19]
 ds_read_b64_tr_b16 v[68:69], v14 offset:24576
 v_mfma_f32_16x16x32_bf16 a[20:23], v[72:75], v[52:55], a[20:23]
 s_waitcnt lgkmcnt(11)
 ds_read_b64_tr_b16 v[70:71], v14 offset:25088
 buffer_load_dwordx4 v4, s[20:23], s69 offen offset:3072 lds
 v_mfma_f32_16x16x32_bf16 a[28:31], v[76:79], v[52:55], a[28:31]
 ds_read_b64_tr_b16 v[72:73], v15 offset:24576
 v_mfma_f32_16x16x32_bf16 a[24:27], v[76:79], v[48:51], a[24:27]
 s_waitcnt lgkmcnt(11)
 ds_read_b64_tr_b16 v[74:75], v15 offset:25088
 v_mfma_f32_16x16x32_bf16 a[32:35], v[80:83], v[48:51], a[32:35]
 ds_read_b64_tr_b16 v[76:77], v16 offset:24576
 v_mfma_f32_16x16x32_bf16 a[36:39], v[80:83], v[52:55], a[36:39]
 s_waitcnt lgkmcnt(11)
 ds_read_b64_tr_b16 v[78:79], v16 offset:25088
 v_mfma_f32_16x16x32_bf16 a[44:47], v[84:87], v[52:55], a[44:47]
 ds_read_b64_tr_b16 v[80:81], v13 offset:28672
 v_mfma_f32_16x16x32_bf16 a[40:43], v[84:87], v[48:51], a[40:43]
 s_waitcnt lgkmcnt(11)
 ds_read_b64_tr_b16 v[82:83], v13 offset:29184
 v_mfma_f32_16x16x32_bf16 a[48:51], v[88:91], v[48:51], a[48:51]
 s_add_u32 s69, s69, 128
 ds_read_b64_tr_b16 v[84:85], v14 offset:28672
 v_mfma_f32_16x16x32_bf16 a[52:55], v[88:91], v[52:55], a[52:55]
 s_waitcnt lgkmcnt(11)
 s_waitcnt vmcnt(16)
 ds_read_b64_tr_b16 v[86:87], v14 offset:29184
 ds_read_b128 v[32:35], v17 offset:0
 v_mfma_f32_16x16x32_bf16 a[60:63], v[92:95], v[52:55], a[60:63]
 ds_read_b64_tr_b16 v[88:89], v15 offset:28672
 v_mfma_f32_16x16x32_bf16 a[56:59], v[92:95], v[48:51], a[56:59]
 s_waitcnt lgkmcnt(12)
 ds_read_b64_tr_b16 v[90:91], v15 offset:29184
 ds_read_b128 v[36:39], v17 offset:2048
 v_mfma_f32_16x16x32_bf16 a[64:67], v[64:67], v[48:51], a[64:67]
 ds_read_b64_tr_b16 v[92:93], v16 offset:28672
 v_mfma_f32_16x16x32_bf16 a[68:71], v[64:67], v[52:55], a[68:71]
 s_waitcnt lgkmcnt(13)
 s_waitcnt vmcnt(10)
 s_barrier
 ds_read_b64_tr_b16 v[94:95], v16 offset:29184
 v_mfma_f32_16x16x32_bf16 a[76:79], v[68:71], v[52:55], a[76:79]
 s_add_u32 m0, s78, 0
 ds_read_b64_tr_b16 v[64:65], v108 offset:0
 v_mfma_f32_16x16x32_bf16 a[72:75], v[68:71], v[48:51], a[72:75]
 s_waitcnt lgkmcnt(13)
 ds_read_b64_tr_b16 v[66:67], v108 offset:512
 buffer_load_dwordx4 v9, s[24:27], s70 offen offset:0 lds
 v_mfma_f32_16x16x32_bf16 a[80:83], v[72:75], v[48:51], a[80:83]
 s_mov_b32 s75, s72
 ds_read_b64_tr_b16 v[68:69], v109 offset:0
 v_mfma_f32_16x16x32_bf16 a[84:87], v[72:75], v[52:55], a[84:87]
 s_waitcnt lgkmcnt(13)
 ds_read_b64_tr_b16 v[70:71], v109 offset:512
 v_mfma_f32_16x16x32_bf16 a[92:95], v[76:79], v[52:55], a[92:95]
 s_mov_b32 s72, s73
 ds_read_b64_tr_b16 v[72:73], v110 offset:0
 v_mfma_f32_16x16x32_bf16 a[88:91], v[76:79], v[48:51], a[88:91]
 s_waitcnt lgkmcnt(13)
 ds_read_b64_tr_b16 v[74:75], v110 offset:512
 buffer_load_dwordx4 v10, s[24:27], s70 offen offset:1024 lds
 v_mfma_f32_16x16x32_bf16 a[96:99], v[80:83], v[48:51], a[96:99]
 s_mov_b32 s73, s74
 ds_read_b64_tr_b16 v[76:77], v111 offset:0
 v_mfma_f32_16x16x32_bf16 a[100:103], v[80:83], v[52:55], a[100:103]
 s_waitcnt lgkmcnt(13)
 ds_read_b64_tr_b16 v[78:79], v111 offset:512
 v_mfma_f32_16x16x32_bf16 a[108:111], v[84:87], v[52:55], a[108:111]
 s_mov_b32 s74, s75
 ds_read_b64_tr_b16 v[80:81], v108 offset:4096
 v_mfma_f32_16x16x32_bf16 a[104:107], v[84:87], v[48:51], a[104:107]
 s_waitcnt lgkmcnt(12)
 ds_read_b64_tr_b16 v[82:83], v108 offset:4608
 buffer_load_dwordx4 v11, s[24:27], s70 offen offset:2048 lds
 v_mfma_f32_16x16x32_bf16 a[112:115], v[88:91], v[48:51], a[112:115]
 ds_read_b64_tr_b16 v[84:85], v109 offset:4096
 v_mfma_f32_16x16x32_bf16 a[116:119], v[88:91], v[52:55], a[116:119]
 s_waitcnt lgkmcnt(11)
 ds_read_b64_tr_b16 v[86:87], v109 offset:4608
 v_mfma_f32_16x16x32_bf16 a[124:127], v[92:95], v[52:55], a[124:127]
 ds_read_b64_tr_b16 v[88:89], v110 offset:4096
 v_mfma_f32_16x16x32_bf16 a[120:123], v[92:95], v[48:51], a[120:123]
 ds_read_b64_tr_b16 v[90:91], v110 offset:4608
 buffer_load_dwordx4 v12, s[24:27], s70 offen offset:3072 lds
 s_add_u32 s70, s70, s71
 s_waitcnt lgkmcnt(12)
 v_mfma_f32_16x16x32_bf16 a[0:3], v[64:67], v[32:35], a[0:3]
 ds_read_b64_tr_b16 v[92:93], v111 offset:4096
 v_mfma_f32_16x16x32_bf16 a[4:7], v[64:67], v[36:39], a[4:7]
 s_waitcnt lgkmcnt(11)
 ds_read_b64_tr_b16 v[94:95], v111 offset:4608
 v_mfma_f32_16x16x32_bf16 a[12:15], v[68:71], v[36:39], a[12:15]
 ds_read_b64_tr_b16 v[64:65], v108 offset:8192
 v_mfma_f32_16x16x32_bf16 a[8:11], v[68:71], v[32:35], a[8:11]
 s_waitcnt lgkmcnt(11)
 ds_read_b64_tr_b16 v[66:67], v108 offset:8704
 v_add_u32 v18, s73, v20
 v_mfma_f32_16x16x32_bf16 a[16:19], v[72:75], v[32:35], a[16:19]
 ds_read_b64_tr_b16 v[68:69], v109 offset:8192
 v_mfma_f32_16x16x32_bf16 a[20:23], v[72:75], v[36:39], a[20:23]
 s_waitcnt lgkmcnt(11)
 ds_read_b64_tr_b16 v[70:71], v109 offset:8704
 v_mfma_f32_16x16x32_bf16 a[28:31], v[76:79], v[36:39], a[28:31]
 ds_read_b64_tr_b16 v[72:73], v110 offset:8192
 v_mfma_f32_16x16x32_bf16 a[24:27], v[76:79], v[32:35], a[24:27]
 s_waitcnt lgkmcnt(11)
 ds_read_b64_tr_b16 v[74:75], v110 offset:8704
 v_mfma_f32_16x16x32_bf16 a[32:35], v[80:83], v[32:35], a[32:35]
 ds_read_b64_tr_b16 v[76:77], v111 offset:8192
 v_mfma_f32_16x16x32_bf16 a[36:39], v[80:83], v[36:39], a[36:39]
 s_waitcnt lgkmcnt(11)
 ds_read_b64_tr_b16 v[78:79], v111 offset:8704
 v_mfma_f32_16x16x32_bf16 a[44:47], v[84:87], v[36:39], a[44:47]
 ds_read_b64_tr_b16 v[80:81], v108 offset:12288
 v_mfma_f32_16x16x32_bf16 a[40:43], v[84:87], v[32:35], a[40:43]
 s_waitcnt lgkmcnt(11)
 ds_read_b64_tr_b16 v[82:83], v108 offset:12800
 v_mfma_f32_16x16x32_bf16 a[48:51], v[88:91], v[32:35], a[48:51]
 ds_read_b64_tr_b16 v[84:85], v109 offset:12288
 v_mfma_f32_16x16x32_bf16 a[52:55], v[88:91], v[36:39], a[52:55]
 s_waitcnt lgkmcnt(11)
 ds_read_b64_tr_b16 v[86:87], v109 offset:12800
 ds_read_b128 v[48:51], v18 offset:0
 v_mfma_f32_16x16x32_bf16 a[60:63], v[92:95], v[36:39], a[60:63]
 ds_read_b64_tr_b16 v[88:89], v110 offset:12288
 v_mfma_f32_16x16x32_bf16 a[56:59], v[92:95], v[32:35], a[56:59]
 s_waitcnt lgkmcnt(12)
 ds_read_b64_tr_b16 v[90:91], v110 offset:12800
 ds_read_b128 v[52:55], v18 offset:2048
 v_mfma_f32_16x16x32_bf16 a[64:67], v[64:67], v[32:35], a[64:67]
 ds_read_b64_tr_b16 v[92:93], v111 offset:12288
 v_mfma_f32_16x16x32_bf16 a[68:71], v[64:67], v[36:39], a[68:71]
 s_waitcnt lgkmcnt(13)
 s_waitcnt vmcnt(6)
 s_barrier
 ds_read_b64_tr_b16 v[94:95], v111 offset:12800
 v_mfma_f32_16x16x32_bf16 a[76:79], v[68:71], v[36:39], a[76:79]
 s_add_u32 m0, s78, 16384
 ds_read_b64_tr_b16 v[64:65], v108 offset:16384
 v_mfma_f32_16x16x32_bf16 a[72:75], v[68:71], v[32:35], a[72:75]
 s_waitcnt lgkmcnt(13)
 ds_read_b64_tr_b16 v[66:67], v108 offset:16896
 buffer_load_dwordx4 v9, s[24:27], s70 offen offset:0 lds
 v_mfma_f32_16x16x32_bf16 a[80:83], v[72:75], v[32:35], a[80:83]
 ds_read_b64_tr_b16 v[68:69], v109 offset:16384
 v_mfma_f32_16x16x32_bf16 a[84:87], v[72:75], v[36:39], a[84:87]
 s_waitcnt lgkmcnt(13)
 ds_read_b64_tr_b16 v[70:71], v109 offset:16896
 v_mfma_f32_16x16x32_bf16 a[92:95], v[76:79], v[36:39], a[92:95]
 ds_read_b64_tr_b16 v[72:73], v110 offset:16384
 v_mfma_f32_16x16x32_bf16 a[88:91], v[76:79], v[32:35], a[88:91]
 s_waitcnt lgkmcnt(13)
 ds_read_b64_tr_b16 v[74:75], v110 offset:16896
 buffer_load_dwordx4 v10, s[24:27], s70 offen offset:1024 lds
 v_mfma_f32_16x16x32_bf16 a[96:99], v[80:83], v[32:35], a[96:99]
 ds_read_b64_tr_b16 v[76:77], v111 offset:16384
 v_mfma_f32_16x16x32_bf16 a[100:103], v[80:83], v[36:39], a[100:103]
 s_waitcnt lgkmcnt(13)
 ds_read_b64_tr_b16 v[78:79], v111 offset:16896
 v_mfma_f32_16x16x32_bf16 a[108:111], v[84:87], v[36:39], a[108:111]
 ds_read_b64_tr_b16 v[80:81], v108 offset:20480
 v_mfma_f32_16x16x32_bf16 a[104:107], v[84:87], v[32:35], a[104:107]
 s_waitcnt lgkmcnt(12)
 ds_read_b64_tr_b16 v[82:83], v108 offset:20992
 buffer_load_dwordx4 v11, s[24:27], s70 offen offset:2048 lds
 v_mfma_f32_16x16x32_bf16 a[112:115], v[88:91], v[32:35], a[112:115]
 ds_read_b64_tr_b16 v[84:85], v109 offset:20480
 v_mfma_f32_16x16x32_bf16 a[116:119], v[88:91], v[36:39], a[116:119]
 s_waitcnt lgkmcnt(11)
 ds_read_b64_tr_b16 v[86:87], v109 offset:20992
 v_mfma_f32_16x16x32_bf16 a[124:127], v[92:95], v[36:39], a[124:127]
 ds_read_b64_tr_b16 v[88:89], v110 offset:20480
 v_mfma_f32_16x16x32_bf16 a[120:123], v[92:95], v[32:35], a[120:123]
 ds_read_b64_tr_b16 v[90:91], v110 offset:20992
 buffer_load_dwordx4 v12, s[24:27], s70 offen offset:3072 lds
 s_cmp_lg_u32 s68, 0
 s_cbranch_scc1 gated_mix__compressed_kv_cla__glu_gated_swiglu__prompt_kernel_sig11
 s_mov_b64 exec, 1
 buffer_store_dwordx2 v[28:29], v21, s[36:39], s14 offen sc1
 s_mov_b64 exec, -1
gated_mix__compressed_kv_cla__glu_gated_swiglu__prompt_kernel_sig11:
 s_add_u32 s70, s70, s71
 s_waitcnt lgkmcnt(12)
 v_mfma_f32_16x16x32_bf16 a[0:3], v[64:67], v[48:51], a[0:3]
 ds_read_b64_tr_b16 v[92:93], v111 offset:20480
 v_mfma_f32_16x16x32_bf16 a[4:7], v[64:67], v[52:55], a[4:7]
 s_waitcnt lgkmcnt(11)
 ds_read_b64_tr_b16 v[94:95], v111 offset:20992
 v_mfma_f32_16x16x32_bf16 a[12:15], v[68:71], v[52:55], a[12:15]
 ds_read_b64_tr_b16 v[64:65], v108 offset:24576
 v_mfma_f32_16x16x32_bf16 a[8:11], v[68:71], v[48:51], a[8:11]
 s_waitcnt lgkmcnt(11)
 ds_read_b64_tr_b16 v[66:67], v108 offset:25088
 v_add_u32 v17, s74, v19
 v_mfma_f32_16x16x32_bf16 a[16:19], v[72:75], v[48:51], a[16:19]
 ds_read_b64_tr_b16 v[68:69], v109 offset:24576
 v_mfma_f32_16x16x32_bf16 a[20:23], v[72:75], v[52:55], a[20:23]
 s_waitcnt lgkmcnt(11)
 ds_read_b64_tr_b16 v[70:71], v109 offset:25088
 v_mfma_f32_16x16x32_bf16 a[28:31], v[76:79], v[52:55], a[28:31]
 ds_read_b64_tr_b16 v[72:73], v110 offset:24576
 v_mfma_f32_16x16x32_bf16 a[24:27], v[76:79], v[48:51], a[24:27]
 s_waitcnt lgkmcnt(11)
 ds_read_b64_tr_b16 v[74:75], v110 offset:25088
 v_mfma_f32_16x16x32_bf16 a[32:35], v[80:83], v[48:51], a[32:35]
 ds_read_b64_tr_b16 v[76:77], v111 offset:24576
 v_mfma_f32_16x16x32_bf16 a[36:39], v[80:83], v[52:55], a[36:39]
 s_waitcnt lgkmcnt(11)
 ds_read_b64_tr_b16 v[78:79], v111 offset:25088
 v_mfma_f32_16x16x32_bf16 a[44:47], v[84:87], v[52:55], a[44:47]
 ds_read_b64_tr_b16 v[80:81], v108 offset:28672
 v_mfma_f32_16x16x32_bf16 a[40:43], v[84:87], v[48:51], a[40:43]
 s_waitcnt lgkmcnt(11)
 ds_read_b64_tr_b16 v[82:83], v108 offset:29184
 v_mfma_f32_16x16x32_bf16 a[48:51], v[88:91], v[48:51], a[48:51]
 ds_read_b64_tr_b16 v[84:85], v109 offset:28672
 v_mfma_f32_16x16x32_bf16 a[52:55], v[88:91], v[52:55], a[52:55]
 s_waitcnt lgkmcnt(11)
 s_waitcnt vmcnt(8)
 ds_read_b64_tr_b16 v[86:87], v109 offset:29184
 ds_read_b128 v[32:35], v17 offset:0
 v_mfma_f32_16x16x32_bf16 a[60:63], v[92:95], v[52:55], a[60:63]
 ds_read_b64_tr_b16 v[88:89], v110 offset:28672
 v_mfma_f32_16x16x32_bf16 a[56:59], v[92:95], v[48:51], a[56:59]
 s_waitcnt lgkmcnt(12)
 ds_read_b64_tr_b16 v[90:91], v110 offset:29184
 ds_read_b128 v[36:39], v17 offset:2048
 v_mfma_f32_16x16x32_bf16 a[64:67], v[64:67], v[48:51], a[64:67]
 ds_read_b64_tr_b16 v[92:93], v111 offset:28672
 v_mfma_f32_16x16x32_bf16 a[68:71], v[64:67], v[52:55], a[68:71]
 s_waitcnt lgkmcnt(13)
 s_waitcnt vmcnt(4)
 s_barrier
 ds_read_b64_tr_b16 v[94:95], v111 offset:29184
 v_mfma_f32_16x16x32_bf16 a[76:79], v[68:71], v[52:55], a[76:79]
 ds_read_b64_tr_b16 v[64:65], v13 offset:0
 v_mfma_f32_16x16x32_bf16 a[72:75], v[68:71], v[48:51], a[72:75]
 s_waitcnt lgkmcnt(13)
 ds_read_b64_tr_b16 v[66:67], v13 offset:512
 v_mfma_f32_16x16x32_bf16 a[80:83], v[72:75], v[48:51], a[80:83]
 s_mov_b32 s75, s72
 ds_read_b64_tr_b16 v[68:69], v14 offset:0
 v_mfma_f32_16x16x32_bf16 a[84:87], v[72:75], v[52:55], a[84:87]
 s_waitcnt lgkmcnt(13)
 ds_read_b64_tr_b16 v[70:71], v14 offset:512
 v_mfma_f32_16x16x32_bf16 a[92:95], v[76:79], v[52:55], a[92:95]
 s_mov_b32 s72, s73
 ds_read_b64_tr_b16 v[72:73], v15 offset:0
 v_mfma_f32_16x16x32_bf16 a[88:91], v[76:79], v[48:51], a[88:91]
 s_waitcnt lgkmcnt(13)
 ds_read_b64_tr_b16 v[74:75], v15 offset:512
 v_mfma_f32_16x16x32_bf16 a[96:99], v[80:83], v[48:51], a[96:99]
 s_mov_b32 s73, s74
 ds_read_b64_tr_b16 v[76:77], v16 offset:0
 v_mfma_f32_16x16x32_bf16 a[100:103], v[80:83], v[52:55], a[100:103]
 s_waitcnt lgkmcnt(13)
 ds_read_b64_tr_b16 v[78:79], v16 offset:512
 v_mfma_f32_16x16x32_bf16 a[108:111], v[84:87], v[52:55], a[108:111]
 s_mov_b32 s74, s75
 ds_read_b64_tr_b16 v[80:81], v13 offset:4096
 v_mfma_f32_16x16x32_bf16 a[104:107], v[84:87], v[48:51], a[104:107]
 s_waitcnt lgkmcnt(12)
 ds_read_b64_tr_b16 v[82:83], v13 offset:4608
 v_mfma_f32_16x16x32_bf16 a[112:115], v[88:91], v[48:51], a[112:115]
 ds_read_b64_tr_b16 v[84:85], v14 offset:4096
 v_mfma_f32_16x16x32_bf16 a[116:119], v[88:91], v[52:55], a[116:119]
 s_waitcnt lgkmcnt(11)
 ds_read_b64_tr_b16 v[86:87], v14 offset:4608
 v_mfma_f32_16x16x32_bf16 a[124:127], v[92:95], v[52:55], a[124:127]
 ds_read_b64_tr_b16 v[88:89], v15 offset:4096
 v_mfma_f32_16x16x32_bf16 a[120:123], v[92:95], v[48:51], a[120:123]
 ds_read_b64_tr_b16 v[90:91], v15 offset:4608
 s_waitcnt lgkmcnt(12)
 v_mfma_f32_16x16x32_bf16 a[0:3], v[64:67], v[32:35], a[0:3]
 ds_read_b64_tr_b16 v[92:93], v16 offset:4096
 v_mfma_f32_16x16x32_bf16 a[4:7], v[64:67], v[36:39], a[4:7]
 s_waitcnt lgkmcnt(11)
 ds_read_b64_tr_b16 v[94:95], v16 offset:4608
 s_cmp_lg_u32 s68, 0
 s_cbranch_scc1 gated_mix__compressed_kv_cla__glu_gated_swiglu__prompt_kernel_np12
 buffer_load_dwordx2 v[22:23], v30, s[36:39], 0 offen sc1
gated_mix__compressed_kv_cla__glu_gated_swiglu__prompt_kernel_np12:
 v_mfma_f32_16x16x32_bf16 a[12:15], v[68:71], v[36:39], a[12:15]
 ds_read_b64_tr_b16 v[64:65], v13 offset:8192
 v_mfma_f32_16x16x32_bf16 a[8:11], v[68:71], v[32:35], a[8:11]
 s_waitcnt lgkmcnt(11)
 ds_read_b64_tr_b16 v[66:67], v13 offset:8704
 v_add_u32 v18, s73, v20
 v_mfma_f32_16x16x32_bf16 a[16:19], v[72:75], v[32:35], a[16:19]
 ds_read_b64_tr_b16 v[68:69], v14 offset:8192
 v_mfma_f32_16x16x32_bf16 a[20:23], v[72:75], v[36:39], a[20:23]
 s_waitcnt lgkmcnt(11)
 ds_read_b64_tr_b16 v[70:71], v14 offset:8704
 v_mfma_f32_16x16x32_bf16 a[28:31], v[76:79], v[36:39], a[28:31]
 ds_read_b64_tr_b16 v[72:73], v15 offset:8192
 v_mfma_f32_16x16x32_bf16 a[24:27], v[76:79], v[32:35], a[24:27]
 s_waitcnt lgkmcnt(11)
 ds_read_b64_tr_b16 v[74:75], v15 offset:8704
 v_mfma_f32_16x16x32_bf16 a[32:35], v[80:83], v[32:35], a[32:35]
 ds_read_b64_tr_b16 v[76:77], v16 offset:8192
 v_mfma_f32_16x16x32_bf16 a[36:39], v[80:83], v[36:39], a[36:39]
 s_waitcnt lgkmcnt(11)
 ds_read_b64_tr_b16 v[78:79], v16 offset:8704
 v_mfma_f32_16x16x32_bf16 a[44:47], v[84:87], v[36:39], a[44:47]
 ds_read_b64_tr_b16 v[80:81], v13 offset:12288
 v_mfma_f32_16x16x32_bf16 a[40:43], v[84:87], v[32:35], a[40:43]
 s_waitcnt lgkmcnt(11)
 ds_read_b64_tr_b16 v[82:83], v13 offset:12800
 v_mfma_f32_16x16x32_bf16 a[48:51], v[88:91], v[32:35], a[48:51]
 ds_read_b64_tr_b16 v[84:85], v14 offset:12288
 v_mfma_f32_16x16x32_bf16 a[52:55], v[88:91], v[36:39], a[52:55]
 s_waitcnt lgkmcnt(11)
 ds_read_b64_tr_b16 v[86:87], v14 offset:12800
 ds_read_b128 v[48:51], v18 offset:0
 v_mfma_f32_16x16x32_bf16 a[60:63], v[92:95], v[36:39], a[60:63]
 ds_read_b64_tr_b16 v[88:89], v15 offset:12288
 v_mfma_f32_16x16x32_bf16 a[56:59], v[92:95], v[32:35], a[56:59]
 s_waitcnt lgkmcnt(12)
 ds_read_b64_tr_b16 v[90:91], v15 offset:12800
 ds_read_b128 v[52:55], v18 offset:2048
 v_mfma_f32_16x16x32_bf16 a[64:67], v[64:67], v[32:35], a[64:67]
 ds_read_b64_tr_b16 v[92:93], v16 offset:12288
 v_mfma_f32_16x16x32_bf16 a[68:71], v[64:67], v[36:39], a[68:71]
 s_waitcnt lgkmcnt(13)
 s_waitcnt vmcnt(0)
 s_barrier
 ds_read_b64_tr_b16 v[94:95], v16 offset:12800
 v_mfma_f32_16x16x32_bf16 a[76:79], v[68:71], v[36:39], a[76:79]
 ds_read_b64_tr_b16 v[64:65], v13 offset:16384
 v_mfma_f32_16x16x32_bf16 a[72:75], v[68:71], v[32:35], a[72:75]
 s_waitcnt lgkmcnt(13)
 ds_read_b64_tr_b16 v[66:67], v13 offset:16896
 v_mfma_f32_16x16x32_bf16 a[80:83], v[72:75], v[32:35], a[80:83]
 ds_read_b64_tr_b16 v[68:69], v14 offset:16384
 v_mfma_f32_16x16x32_bf16 a[84:87], v[72:75], v[36:39], a[84:87]
 s_waitcnt lgkmcnt(13)
 ds_read_b64_tr_b16 v[70:71], v14 offset:16896
 v_mfma_f32_16x16x32_bf16 a[92:95], v[76:79], v[36:39], a[92:95]
 ds_read_b64_tr_b16 v[72:73], v15 offset:16384
 v_mfma_f32_16x16x32_bf16 a[88:91], v[76:79], v[32:35], a[88:91]
 s_waitcnt lgkmcnt(13)
 ds_read_b64_tr_b16 v[74:75], v15 offset:16896
 v_mfma_f32_16x16x32_bf16 a[96:99], v[80:83], v[32:35], a[96:99]
 ds_read_b64_tr_b16 v[76:77], v16 offset:16384
 v_mfma_f32_16x16x32_bf16 a[100:103], v[80:83], v[36:39], a[100:103]
 s_waitcnt lgkmcnt(13)
 ds_read_b64_tr_b16 v[78:79], v16 offset:16896
 v_mfma_f32_16x16x32_bf16 a[108:111], v[84:87], v[36:39], a[108:111]
 ds_read_b64_tr_b16 v[80:81], v13 offset:20480
 v_mfma_f32_16x16x32_bf16 a[104:107], v[84:87], v[32:35], a[104:107]
 s_waitcnt lgkmcnt(12)
 ds_read_b64_tr_b16 v[82:83], v13 offset:20992
 v_mfma_f32_16x16x32_bf16 a[112:115], v[88:91], v[32:35], a[112:115]
 ds_read_b64_tr_b16 v[84:85], v14 offset:20480
 v_mfma_f32_16x16x32_bf16 a[116:119], v[88:91], v[36:39], a[116:119]
 s_waitcnt lgkmcnt(11)
 ds_read_b64_tr_b16 v[86:87], v14 offset:20992
 v_mfma_f32_16x16x32_bf16 a[124:127], v[92:95], v[36:39], a[124:127]
 ds_read_b64_tr_b16 v[88:89], v15 offset:20480
 v_mfma_f32_16x16x32_bf16 a[120:123], v[92:95], v[32:35], a[120:123]
 ds_read_b64_tr_b16 v[90:91], v15 offset:20992
 s_waitcnt lgkmcnt(12)
 v_mfma_f32_16x16x32_bf16 a[0:3], v[64:67], v[48:51], a[0:3]
 ds_read_b64_tr_b16 v[92:93], v16 offset:20480
 v_mfma_f32_16x16x32_bf16 a[4:7], v[64:67], v[52:55], a[4:7]
 s_waitcnt lgkmcnt(11)
 ds_read_b64_tr_b16 v[94:95], v16 offset:20992
 v_mfma_f32_16x16x32_bf16 a[12:15], v[68:71], v[52:55], a[12:15]
 ds_read_b64_tr_b16 v[64:65], v13 offset:24576
 v_mfma_f32_16x16x32_bf16 a[8:11], v[68:71], v[48:51], a[8:11]
 s_waitcnt lgkmcnt(11)
 ds_read_b64_tr_b16 v[66:67], v13 offset:25088
 v_mfma_f32_16x16x32_bf16 a[16:19], v[72:75], v[48:51], a[16:19]
 ds_read_b64_tr_b16 v[68:69], v14 offset:24576
 v_mfma_f32_16x16x32_bf16 a[20:23], v[72:75], v[52:55], a[20:23]
 s_waitcnt lgkmcnt(11)
 ds_read_b64_tr_b16 v[70:71], v14 offset:25088
 v_mfma_f32_16x16x32_bf16 a[28:31], v[76:79], v[52:55], a[28:31]
 ds_read_b64_tr_b16 v[72:73], v15 offset:24576
 v_mfma_f32_16x16x32_bf16 a[24:27], v[76:79], v[48:51], a[24:27]
 s_waitcnt lgkmcnt(11)
 ds_read_b64_tr_b16 v[74:75], v15 offset:25088
 v_mfma_f32_16x16x32_bf16 a[32:35], v[80:83], v[48:51], a[32:35]
 ds_read_b64_tr_b16 v[76:77], v16 offset:24576
 v_mfma_f32_16x16x32_bf16 a[36:39], v[80:83], v[52:55], a[36:39]
 s_waitcnt lgkmcnt(11)
 ds_read_b64_tr_b16 v[78:79], v16 offset:25088
 v_mfma_f32_16x16x32_bf16 a[44:47], v[84:87], v[52:55], a[44:47]
 ds_read_b64_tr_b16 v[80:81], v13 offset:28672
 v_mfma_f32_16x16x32_bf16 a[40:43], v[84:87], v[48:51], a[40:43]
 s_waitcnt lgkmcnt(11)
 ds_read_b64_tr_b16 v[82:83], v13 offset:29184
 v_mfma_f32_16x16x32_bf16 a[48:51], v[88:91], v[48:51], a[48:51]
 ds_read_b64_tr_b16 v[84:85], v14 offset:28672
 v_mfma_f32_16x16x32_bf16 a[52:55], v[88:91], v[52:55], a[52:55]
 s_waitcnt lgkmcnt(11)
 ds_read_b64_tr_b16 v[86:87], v14 offset:29184
 v_mfma_f32_16x16x32_bf16 a[60:63], v[92:95], v[52:55], a[60:63]
 ds_read_b64_tr_b16 v[88:89], v15 offset:28672
 v_mfma_f32_16x16x32_bf16 a[56:59], v[92:95], v[48:51], a[56:59]
 s_waitcnt lgkmcnt(11)
 ds_read_b64_tr_b16 v[90:91], v15 offset:29184
 v_mfma_f32_16x16x32_bf16 a[64:67], v[64:67], v[48:51], a[64:67]
 ds_read_b64_tr_b16 v[92:93], v16 offset:28672
 v_mfma_f32_16x16x32_bf16 a[68:71], v[64:67], v[52:55], a[68:71]
 s_waitcnt lgkmcnt(11)
 ds_read_b64_tr_b16 v[94:95], v16 offset:29184
 v_mfma_f32_16x16x32_bf16 a[76:79], v[68:71], v[52:55], a[76:79]
 v_mfma_f32_16x16x32_bf16 a[72:75], v[68:71], v[48:51], a[72:75]
 s_waitcnt lgkmcnt(10)
 v_mfma_f32_16x16x32_bf16 a[80:83], v[72:75], v[48:51], a[80:83]
 s_mov_b32 s75, s72
 v_mfma_f32_16x16x32_bf16 a[84:87], v[72:75], v[52:55], a[84:87]
 s_waitcnt lgkmcnt(8)
 v_mfma_f32_16x16x32_bf16 a[92:95], v[76:79], v[52:55], a[92:95]
 s_mov_b32 s72, s73
 v_mfma_f32_16x16x32_bf16 a[88:91], v[76:79], v[48:51], a[88:91]
 s_waitcnt lgkmcnt(6)
 v_mfma_f32_16x16x32_bf16 a[96:99], v[80:83], v[48:51], a[96:99]
 s_mov_b32 s73, s74
 v_mfma_f32_16x16x32_bf16 a[100:103], v[80:83], v[52:55], a[100:103]
 s_waitcnt lgkmcnt(4)
 v_mfma_f32_16x16x32_bf16 a[108:111], v[84:87], v[52:55], a[108:111]
 s_mov_b32 s74, s75
 v_mfma_f32_16x16x32_bf16 a[104:107], v[84:87], v[48:51], a[104:107]
 s_waitcnt lgkmcnt(2)
 v_mfma_f32_16x16x32_bf16 a[112:115], v[88:91], v[48:51], a[112:115]
 v_mfma_f32_16x16x32_bf16 a[116:119], v[88:91], v[52:55], a[116:119]
 s_waitcnt lgkmcnt(0)
 v_mfma_f32_16x16x32_bf16 a[124:127], v[92:95], v[52:55], a[124:127]
 v_mfma_f32_16x16x32_bf16 a[120:123], v[92:95], v[48:51], a[120:123]
 s_and_b32 s91, s2, 7
 s_lshr_b32 s92, s2, 6
 s_lshl_b32 s92, s92, 3
 s_add_u32 s91, s91, s92
 s_lshl_b32 s91, s91, 2
 s_add_u32 s91, s91, s68
 s_mul_i32 s92, s91, 14336
 v_and_b32 v32, 15, v0
 v_mul_u32_u24 v33, 896, v32
 v_add_u32 v33, v33, v24
 buffer_load_dwordx4 v[112:115], v33, s[20:23], s92 offen offset:0
 buffer_load_dwordx4 v[168:171], v24, s[48:51], 0 offen offset:0
 buffer_load_dwordx4 v[116:119], v33, s[20:23], s92 offen offset:64
 buffer_load_dwordx4 v[172:175], v24, s[48:51], 0 offen offset:64
 buffer_load_dwordx4 v[120:123], v33, s[20:23], s92 offen offset:128
 buffer_load_dwordx4 v[176:179], v24, s[48:51], 0 offen offset:128
 buffer_load_dwordx4 v[124:127], v33, s[20:23], s92 offen offset:192
 buffer_load_dwordx4 v[180:183], v24, s[48:51], 0 offen offset:192
 buffer_load_dwordx4 v[128:131], v33, s[20:23], s92 offen offset:256
 buffer_load_dwordx4 v[184:187], v24, s[48:51], 0 offen offset:256
 buffer_load_dwordx4 v[132:135], v33, s[20:23], s92 offen offset:320
 buffer_load_dwordx4 v[188:191], v24, s[48:51], 0 offen offset:320
 buffer_load_dwordx4 v[136:139], v33, s[20:23], s92 offen offset:384
 buffer_load_dwordx4 v[192:195], v24, s[48:51], 0 offen offset:384
 buffer_load_dwordx4 v[140:143], v33, s[20:23], s92 offen offset:448
 buffer_load_dwordx4 v[196:199], v24, s[48:51], 0 offen offset:448
 buffer_load_dwordx4 v[144:147], v33, s[20:23], s92 offen offset:512
 buffer_load_dwordx4 v[200:203], v24, s[48:51], 0 offen offset:512
 buffer_load_dwordx4 v[148:151], v33, s[20:23], s92 offen offset:576
 buffer_load_dwordx4 v[204:207], v24, s[48:51], 0 offen offset:576
 buffer_load_dwordx4 v[152:155], v33, s[20:23], s92 offen offset:640
 buffer_load_dwordx4 v[208:211], v24, s[48:51], 0 offen offset:640
 buffer_load_dwordx4 v[156:159], v33, s[20:23], s92 offen offset:704
 buffer_load_dwordx4 v[212:215], v24, s[48:51], 0 offen offset:704
 buffer_load_dwordx4 v[160:163], v33, s[20:23], s92 offen offset:768
 buffer_load_dwordx4 v[216:219], v24, s[48:51], 0 offen offset:768
 buffer_load_dwordx4 v[164:167], v33, s[20:23], s92 offen offset:832
 buffer_load_dwordx4 v[220:223], v24, s[48:51], 0 offen offset:832
 s_lshl_b32 s91, s91, 8
 s_add_u32 s91, s91, 53215232
 v_mov_b32 v40, v28
 v_mov_b32 v41, v29
 v_mov_b32 v43, 0
 s_waitcnt vmcnt(26)
 v_mfma_f32_16x16x32_bf16 v[36:39], v[168:171], v[112:115], 0
 s_waitcnt vmcnt(24)
 v_mfma_f32_16x16x32_bf16 v[36:39], v[172:175], v[116:119], v[36:39]
 s_waitcnt vmcnt(22)
 v_mfma_f32_16x16x32_bf16 v[36:39], v[176:179], v[120:123], v[36:39]
 s_waitcnt vmcnt(20)
 v_mfma_f32_16x16x32_bf16 v[36:39], v[180:183], v[124:127], v[36:39]
 s_waitcnt vmcnt(18)
 v_mfma_f32_16x16x32_bf16 v[36:39], v[184:187], v[128:131], v[36:39]
 s_waitcnt vmcnt(16)
 v_mfma_f32_16x16x32_bf16 v[36:39], v[188:191], v[132:135], v[36:39]
 s_waitcnt vmcnt(14)
 v_mfma_f32_16x16x32_bf16 v[36:39], v[192:195], v[136:139], v[36:39]
 s_waitcnt vmcnt(12)
 v_mfma_f32_16x16x32_bf16 v[36:39], v[196:199], v[140:143], v[36:39]
 s_waitcnt vmcnt(10)
 v_mfma_f32_16x16x32_bf16 v[36:39], v[200:203], v[144:147], v[36:39]
 s_waitcnt vmcnt(8)
 v_mfma_f32_16x16x32_bf16 v[36:39], v[204:207], v[148:151], v[36:39]
 s_waitcnt vmcnt(6)
 v_mfma_f32_16x16x32_bf16 v[36:39], v[208:211], v[152:155], v[36:39]
 s_waitcnt vmcnt(4)
 v_mfma_f32_16x16x32_bf16 v[36:39], v[212:215], v[156:159], v[36:39]
 s_waitcnt vmcnt(2)
 v_mfma_f32_16x16x32_bf16 v[36:39], v[216:219], v[160:163], v[36:39]
 s_waitcnt vmcnt(0)
 v_mfma_f32_16x16x32_bf16 v[36:39], v[220:223], v[164:167], v[36:39]
 s_nop 7
 v_mul_f32 v42, 0xbfb8aa3b, v36
 v_exp_f32 v42, v42
 s_nop 0
 v_add_f32 v42, 1.0, v42
 v_rcp_f32 v42, v42
 s_mov_b64 exec, 0xffff
 buffer_store_dwordx4 v[40:43], v21, s[36:39], s91 offen sc1
 s_mov_b64 exec, -1
 s_cmp_lg_u32 s68, 0
 s_cbranch_scc1 gated_mix__compressed_kv_cla__glu_gated_swiglu__prompt_kernel_np13
 s_waitcnt vmcnt(0)
 s_mov_b32 s99, 1048576
gated_mix__compressed_kv_cla__glu_gated_swiglu__prompt_kernel_poll14:
 v_cmp_eq_u64 vcc, v[22:23], v[28:29]
 s_nop 3
 s_and_b32 vcc_lo, vcc_lo, 0xff
 s_cmp_eq_u32 vcc_lo, 0xff
 s_cbranch_scc1 gated_mix__compressed_kv_cla__glu_gated_swiglu__prompt_kernel_ok15
 s_sub_u32 s99, s99, 1
 s_cbranch_scc1 gated_mix__compressed_kv_cla__glu_gated_swiglu__prompt_kernel_ok15
 s_sleep 12
 buffer_load_dwordx2 v[22:23], v30, s[36:39], 0 offen sc1
 s_waitcnt vmcnt(0)
 s_branch gated_mix__compressed_kv_cla__glu_gated_swiglu__prompt_kernel_poll14
gated_mix__compressed_kv_cla__glu_gated_swiglu__prompt_kernel_ok15:
gated_mix__compressed_kv_cla__glu_gated_swiglu__prompt_kernel_np13:
 s_barrier
 s_getpc_b64 s[96:97]
gated_mix__compressed_kv_cla__glu_gated_swiglu__prompt_kernel_pc16:
 s_sub_u32 s96, s96, gated_mix__compressed_kv_cla__glu_gated_swiglu__prompt_kernel_pc16-gated_mix__compressed_kv_cla__glu_gated_swiglu__prompt_kernel_pc
 s_subb_u32 s97, s97, 0
 global_load_dword v31, v27, s[96:97]
 s_lshl_b32 s91, s82, 21
 s_add_u32 s20, s36, s91
 s_addc_u32 s21, s37, 0
 s_mov_b32 s22, 2097152
 s_mov_b32 s24, s20
 s_mov_b32 s25, s21
 s_lshl_b32 s92, s68, 12
 v_add_u32 v3, s92, v21
 s_add_u32 s76, s92, 0
 s_add_u32 s77, s92, 65536
 s_lshl_b32 s91, s86, 2
 s_add_u32 s93, s91, 4
 s_add_u32 s94, s93, s85
 s_sub_u32 s95, s93, s85
 s_sub_u32 s96, s95, 8
 s_add_u32 s87, s85, 8
 s_cmp_eq_u32 s84, 0
 s_cselect_b32 s7, s94, s95
 s_cselect_b32 s8, s93, s96
 s_cselect_b32 s87, 0, s87
 s_cmp_eq_u32 s81, 0
 s_cselect_b32 s6, 8, 0
 s_cselect_b32 s17, s85, s7
 s_cselect_b32 s71, 0, 1
 s_lshl_b32 s9, s6, 15
 s_mov_b32 s11, 0
 s_mov_b32 m0, s76
 s_mov_b32 s12, 65536
 buffer_load_dwordx4 v3, s[20:23], s9 offen offset:0 sc1 lds
 buffer_load_dwordx4 v3, s[20:23], s9 offen offset:1024 sc1 lds
 buffer_load_dwordx4 v3, s[20:23], s9 offen offset:2048 sc1 lds
 buffer_load_dwordx4 v3, s[20:23], s9 offen offset:3072 sc1 lds
 s_mov_b32 s88, 1035512379
 s_mov_b32 s89, 1035512379
 v_accvgpr_read_b32 v64, a0
 v_accvgpr_read_b32 v65, a1
 v_accvgpr_read_b32 v66, a2
 v_accvgpr_read_b32 v67, a3
 v_accvgpr_read_b32 v68, a8
 v_accvgpr_read_b32 v69, a9
 v_accvgpr_read_b32 v70, a10
 v_accvgpr_read_b32 v71, a11
 v_pk_mul_f32 v[64:65], v[64:65], s[88:89]
 v_pk_mul_f32 v[66:67], v[66:67], s[88:89]
 v_pk_mul_f32 v[68:69], v[68:69], s[88:89]
 v_pk_mul_f32 v[70:71], v[70:71], s[88:89]
 v_cvt_pk_bf16_f32 v112, v64, v65
 v_cvt_pk_bf16_f32 v113, v66, v67
 v_cvt_pk_bf16_f32 v114, v68, v69
 v_cvt_pk_bf16_f32 v115, v70, v71
 s_add_u32 s10, s9, 16384
 s_mov_b32 s26, s22
 s_add_u32 s6, s6, 1
 s_sub_u32 s7, s7, 1
 s_cmp_eq_u32 s7, s8
 s_cselect_b32 s6, s87, s6
 s_cmp_gt_i32 s7, 0
 s_cselect_b32 s22, s22, 0
 s_cselect_b32 s6, s6, 0
 s_lshl_b32 s9, s6, 15
 s_add_u32 s11, s11, 16384
 s_and_b32 s11, s11, 0xffff
 s_add_u32 m0, s11, s76
 s_nop 0
 buffer_load_dwordx4 v3, s[20:23], s9 offen offset:0 sc1 lds
 v_accvgpr_read_b32 v72, a16
 v_accvgpr_read_b32 v73, a17
 v_accvgpr_read_b32 v74, a18
 v_accvgpr_read_b32 v75, a19
 v_accvgpr_read_b32 v76, a24
 v_accvgpr_read_b32 v77, a25
 v_accvgpr_read_b32 v78, a26
 v_accvgpr_read_b32 v79, a27
 v_pk_mul_f32 v[72:73], v[72:73], s[88:89]
 v_pk_mul_f32 v[74:75], v[74:75], s[88:89]
 v_pk_mul_f32 v[76:77], v[76:77], s[88:89]
 v_pk_mul_f32 v[78:79], v[78:79], s[88:89]
 v_cvt_pk_bf16_f32 v116, v72, v73
 v_cvt_pk_bf16_f32 v117, v74, v75
 v_cvt_pk_bf16_f32 v118, v76, v77
 v_cvt_pk_bf16_f32 v119, v78, v79
 buffer_load_dwordx4 v3, s[20:23], s9 offen offset:1024 sc1 lds
 buffer_load_dwordx4 v3, s[20:23], s9 offen offset:2048 sc1 lds
 v_accvgpr_read_b32 v80, a32
 v_accvgpr_read_b32 v81, a33
 v_accvgpr_read_b32 v82, a34
 v_accvgpr_read_b32 v83, a35
 v_accvgpr_read_b32 v84, a40
 v_accvgpr_read_b32 v85, a41
 v_accvgpr_read_b32 v86, a42
 v_accvgpr_read_b32 v87, a43
 v_pk_mul_f32 v[80:81], v[80:81], s[88:89]
 v_pk_mul_f32 v[82:83], v[82:83], s[88:89]
 v_pk_mul_f32 v[84:85], v[84:85], s[88:89]
 v_pk_mul_f32 v[86:87], v[86:87], s[88:89]
 v_cvt_pk_bf16_f32 v120, v80, v81
 v_cvt_pk_bf16_f32 v121, v82, v83
 v_cvt_pk_bf16_f32 v122, v84, v85
 v_cvt_pk_bf16_f32 v123, v86, v87
 buffer_load_dwordx4 v3, s[20:23], s9 offen offset:3072 sc1 lds
 v_accvgpr_read_b32 v88, a48
 v_accvgpr_read_b32 v89, a49
 v_accvgpr_read_b32 v90, a50
 v_accvgpr_read_b32 v91, a51
 v_accvgpr_read_b32 v92, a56
 v_accvgpr_read_b32 v93, a57
 v_accvgpr_read_b32 v94, a58
 v_accvgpr_read_b32 v95, a59
 v_pk_mul_f32 v[88:89], v[88:89], s[88:89]
 v_pk_mul_f32 v[90:91], v[90:91], s[88:89]
 v_pk_mul_f32 v[92:93], v[92:93], s[88:89]
 v_pk_mul_f32 v[94:95], v[94:95], s[88:89]
 v_cvt_pk_bf16_f32 v124, v88, v89
 v_cvt_pk_bf16_f32 v125, v90, v91
 v_cvt_pk_bf16_f32 v126, v92, v93
 v_cvt_pk_bf16_f32 v127, v94, v95
 s_add_u32 s12, s12, 16384
 s_cmp_eq_u32 s12, 81920
 s_cselect_b32 s12, 0, s12
 s_add_u32 m0, s12, s77
 s_nop 0
 buffer_load_dwordx4 v3, s[24:27], s10 offen offset:0 sc1 lds
 buffer_load_dwordx4 v3, s[24:27], s10 offen offset:1024 sc1 lds
 v_accvgpr_read_b32 v64, a64
 v_accvgpr_read_b32 v65, a65
 v_accvgpr_read_b32 v66, a66
 v_accvgpr_read_b32 v67, a67
 v_accvgpr_read_b32 v68, a72
 v_accvgpr_read_b32 v69, a73
 v_accvgpr_read_b32 v70, a74
 v_accvgpr_read_b32 v71, a75
 v_pk_mul_f32 v[64:65], v[64:65], s[88:89]
 v_pk_mul_f32 v[66:67], v[66:67], s[88:89]
 v_pk_mul_f32 v[68:69], v[68:69], s[88:89]
 v_pk_mul_f32 v[70:71], v[70:71], s[88:89]
 v_cvt_pk_bf16_f32 v128, v64, v65
 v_cvt_pk_bf16_f32 v129, v66, v67
 v_cvt_pk_bf16_f32 v130, v68, v69
 v_cvt_pk_bf16_f32 v131, v70, v71
 buffer_load_dwordx4 v3, s[24:27], s10 offen offset:2048 sc1 lds
 v_accvgpr_read_b32 v72, a80
 v_accvgpr_read_b32 v73, a81
 v_accvgpr_read_b32 v74, a82
 v_accvgpr_read_b32 v75, a83
 v_accvgpr_read_b32 v76, a88
 v_accvgpr_read_b32 v77, a89
 v_accvgpr_read_b32 v78, a90
 v_accvgpr_read_b32 v79, a91
 v_pk_mul_f32 v[72:73], v[72:73], s[88:89]
 v_pk_mul_f32 v[74:75], v[74:75], s[88:89]
 v_pk_mul_f32 v[76:77], v[76:77], s[88:89]
 v_pk_mul_f32 v[78:79], v[78:79], s[88:89]
 v_cvt_pk_bf16_f32 v132, v72, v73
 v_cvt_pk_bf16_f32 v133, v74, v75
 v_cvt_pk_bf16_f32 v134, v76, v77
 v_cvt_pk_bf16_f32 v135, v78, v79
 buffer_load_dwordx4 v3, s[24:27], s10 offen offset:3072 sc1 lds
 s_add_u32 s10, s9, 16384
 s_mov_b32 s26, s22
 s_add_u32 s6, s6, 1
 s_sub_u32 s7, s7, 1
 s_cmp_eq_u32 s7, s8
 s_cselect_b32 s6, s87, s6
 s_cmp_gt_i32 s7, 0
 s_cselect_b32 s22, s22, 0
 s_cselect_b32 s6, s6, 0
 s_lshl_b32 s9, s6, 15
 s_add_u32 s11, s11, 16384
 s_and_b32 s11, s11, 0xffff
 s_add_u32 m0, s11, s76
 s_nop 0
 buffer_load_dwordx4 v3, s[20:23], s9 offen offset:0 sc1 lds
 v_accvgpr_read_b32 v80, a96
 v_accvgpr_read_b32 v81, a97
 v_accvgpr_read_b32 v82, a98
 v_accvgpr_read_b32 v83, a99
 v_accvgpr_read_b32 v84, a104
 v_accvgpr_read_b32 v85, a105
 v_accvgpr_read_b32 v86, a106
 v_accvgpr_read_b32 v87, a107
 v_pk_mul_f32 v[80:81], v[80:81], s[88:89]
 v_pk_mul_f32 v[82:83], v[82:83], s[88:89]
 v_pk_mul_f32 v[84:85], v[84:85], s[88:89]
 v_pk_mul_f32 v[86:87], v[86:87], s[88:89]
 v_cvt_pk_bf16_f32 v136, v80, v81
 v_cvt_pk_bf16_f32 v137, v82, v83
 v_cvt_pk_bf16_f32 v138, v84, v85
 v_cvt_pk_bf16_f32 v139, v86, v87
 buffer_load_dwordx4 v3, s[20:23], s9 offen offset:1024 sc1 lds
 v_accvgpr_read_b32 v88, a112
 v_accvgpr_read_b32 v89, a113
 v_accvgpr_read_b32 v90, a114
 v_accvgpr_read_b32 v91, a115
 v_accvgpr_read_b32 v92, a120
 v_accvgpr_read_b32 v93, a121
 v_accvgpr_read_b32 v94, a122
 v_accvgpr_read_b32 v95, a123
 v_pk_mul_f32 v[88:89], v[88:89], s[88:89]
 v_pk_mul_f32 v[90:91], v[90:91], s[88:89]
 v_pk_mul_f32 v[92:93], v[92:93], s[88:89]
 v_pk_mul_f32 v[94:95], v[94:95], s[88:89]
 v_cvt_pk_bf16_f32 v140, v88, v89
 v_cvt_pk_bf16_f32 v141, v90, v91
 v_cvt_pk_bf16_f32 v142, v92, v93
 v_cvt_pk_bf16_f32 v143, v94, v95
 buffer_load_dwordx4 v3, s[20:23], s9 offen offset:2048 sc1 lds
 buffer_load_dwordx4 v3, s[20:23], s9 offen offset:3072 sc1 lds
 v_accvgpr_read_b32 v64, a4
 v_accvgpr_read_b32 v65, a5
 v_accvgpr_read_b32 v66, a6
 v_accvgpr_read_b32 v67, a7
 v_accvgpr_read_b32 v68, a12
 v_accvgpr_read_b32 v69, a13
 v_accvgpr_read_b32 v70, a14
 v_accvgpr_read_b32 v71, a15
 v_pk_mul_f32 v[64:65], v[64:65], s[88:89]
 v_pk_mul_f32 v[66:67], v[66:67], s[88:89]
 v_pk_mul_f32 v[68:69], v[68:69], s[88:89]
 v_pk_mul_f32 v[70:71], v[70:71], s[88:89]
 v_cvt_pk_bf16_f32 v144, v64, v65
 v_cvt_pk_bf16_f32 v145, v66, v67
 v_cvt_pk_bf16_f32 v146, v68, v69
 v_cvt_pk_bf16_f32 v147, v70, v71
 s_add_u32 s12, s12, 16384
 s_cmp_eq_u32 s12, 81920
 s_cselect_b32 s12, 0, s12
 s_add_u32 m0, s12, s77
 s_nop 0
 buffer_load_dwordx4 v3, s[24:27], s10 offen offset:0 sc1 lds
 v_accvgpr_read_b32 v72, a20
 v_accvgpr_read_b32 v73, a21
 v_accvgpr_read_b32 v74, a22
 v_accvgpr_read_b32 v75, a23
 v_accvgpr_read_b32 v76, a28
 v_accvgpr_read_b32 v77, a29
 v_accvgpr_read_b32 v78, a30
 v_accvgpr_read_b32 v79, a31
 v_pk_mul_f32 v[72:73], v[72:73], s[88:89]
 v_pk_mul_f32 v[74:75], v[74:75], s[88:89]
 v_pk_mul_f32 v[76:77], v[76:77], s[88:89]
 v_pk_mul_f32 v[78:79], v[78:79], s[88:89]
 v_cvt_pk_bf16_f32 v148, v72, v73
 v_cvt_pk_bf16_f32 v149, v74, v75
 v_cvt_pk_bf16_f32 v150, v76, v77
 v_cvt_pk_bf16_f32 v151, v78, v79
 buffer_load_dwordx4 v3, s[24:27], s10 offen offset:1024 sc1 lds
 buffer_load_dwordx4 v3, s[24:27], s10 offen offset:2048 sc1 lds
 v_accvgpr_read_b32 v80, a36
 v_accvgpr_read_b32 v81, a37
 v_accvgpr_read_b32 v82, a38
 v_accvgpr_read_b32 v83, a39
 v_accvgpr_read_b32 v84, a44
 v_accvgpr_read_b32 v85, a45
 v_accvgpr_read_b32 v86, a46
 v_accvgpr_read_b32 v87, a47
 v_pk_mul_f32 v[80:81], v[80:81], s[88:89]
 v_pk_mul_f32 v[82:83], v[82:83], s[88:89]
 v_pk_mul_f32 v[84:85], v[84:85], s[88:89]
 v_pk_mul_f32 v[86:87], v[86:87], s[88:89]
 v_cvt_pk_bf16_f32 v152, v80, v81
 v_cvt_pk_bf16_f32 v153, v82, v83
 v_cvt_pk_bf16_f32 v154, v84, v85
 v_cvt_pk_bf16_f32 v155, v86, v87
 buffer_load_dwordx4 v3, s[24:27], s10 offen offset:3072 sc1 lds
 v_accvgpr_read_b32 v88, a52
 v_accvgpr_read_b32 v89, a53
 v_accvgpr_read_b32 v90, a54
 v_accvgpr_read_b32 v91, a55
 v_accvgpr_read_b32 v92, a60
 v_accvgpr_read_b32 v93, a61
 v_accvgpr_read_b32 v94, a62
 v_accvgpr_read_b32 v95, a63
 v_pk_mul_f32 v[88:89], v[88:89], s[88:89]
 v_pk_mul_f32 v[90:91], v[90:91], s[88:89]
 v_pk_mul_f32 v[92:93], v[92:93], s[88:89]
 v_pk_mul_f32 v[94:95], v[94:95], s[88:89]
 v_cvt_pk_bf16_f32 v156, v88, v89
 v_cvt_pk_bf16_f32 v157, v90, v91
 v_cvt_pk_bf16_f32 v158, v92, v93
 v_cvt_pk_bf16_f32 v159, v94, v95
 s_add_u32 s10, s9, 16384
 s_mov_b32 s26, s22
 s_add_u32 s6, s6, 1
 s_sub_u32 s7, s7, 1
 s_cmp_eq_u32 s7, s8
 s_cselect_b32 s6, s87, s6
 s_cmp_gt_i32 s7, 0
 s_cselect_b32 s22, s22, 0
 s_cselect_b32 s6, s6, 0
 s_lshl_b32 s9, s6, 15
 s_add_u32 s11, s11, 16384
 s_and_b32 s11, s11, 0xffff
 s_add_u32 m0, s11, s76
 s_nop 0
 buffer_load_dwordx4 v3, s[20:23], s9 offen offset:0 sc1 lds
 buffer_load_dwordx4 v3, s[20:23], s9 offen offset:1024 sc1 lds
 v_accvgpr_read_b32 v64, a68
 v_accvgpr_read_b32 v65, a69
 v_accvgpr_read_b32 v66, a70
 v_accvgpr_read_b32 v67, a71
 v_accvgpr_read_b32 v68, a76
 v_accvgpr_read_b32 v69, a77
 v_accvgpr_read_b32 v70, a78
 v_accvgpr_read_b32 v71, a79
 v_pk_mul_f32 v[64:65], v[64:65], s[88:89]
 v_pk_mul_f32 v[66:67], v[66:67], s[88:89]
 v_pk_mul_f32 v[68:69], v[68:69], s[88:89]
 v_pk_mul_f32 v[70:71], v[70:71], s[88:89]
 v_cvt_pk_bf16_f32 v160, v64, v65
 v_cvt_pk_bf16_f32 v161, v66, v67
 v_cvt_pk_bf16_f32 v162, v68, v69
 v_cvt_pk_bf16_f32 v163, v70, v71
 buffer_load_dwordx4 v3, s[20:23], s9 offen offset:2048 sc1 lds
 v_accvgpr_read_b32 v72, a84
 v_accvgpr_read_b32 v73, a85
 v_accvgpr_read_b32 v74, a86
 v_accvgpr_read_b32 v75, a87
 v_accvgpr_read_b32 v76, a92
 v_accvgpr_read_b32 v77, a93
 v_accvgpr_read_b32 v78, a94
 v_accvgpr_read_b32 v79, a95
 v_pk_mul_f32 v[72:73], v[72:73], s[88:89]
 v_pk_mul_f32 v[74:75], v[74:75], s[88:89]
 v_pk_mul_f32 v[76:77], v[76:77], s[88:89]
 v_pk_mul_f32 v[78:79], v[78:79], s[88:89]
 v_cvt_pk_bf16_f32 v164, v72, v73
 v_cvt_pk_bf16_f32 v165, v74, v75
 v_cvt_pk_bf16_f32 v166, v76, v77
 v_cvt_pk_bf16_f32 v167, v78, v79
 buffer_load_dwordx4 v3, s[20:23], s9 offen offset:3072 sc1 lds
 s_add_u32 s12, s12, 16384
 s_cmp_eq_u32 s12, 81920
 s_cselect_b32 s12, 0, s12
 s_add_u32 m0, s12, s77
 s_nop 0
 buffer_load_dwordx4 v3, s[24:27], s10 offen offset:0 sc1 lds
 v_accvgpr_read_b32 v80, a100
 v_accvgpr_read_b32 v81, a101
 v_accvgpr_read_b32 v82, a102
 v_accvgpr_read_b32 v83, a103
 v_accvgpr_read_b32 v84, a108
 v_accvgpr_read_b32 v85, a109
 v_accvgpr_read_b32 v86, a110
 v_accvgpr_read_b32 v87, a111
 v_pk_mul_f32 v[80:81], v[80:81], s[88:89]
 v_pk_mul_f32 v[82:83], v[82:83], s[88:89]
 v_pk_mul_f32 v[84:85], v[84:85], s[88:89]
 v_pk_mul_f32 v[86:87], v[86:87], s[88:89]
 v_cvt_pk_bf16_f32 v168, v80, v81
 v_cvt_pk_bf16_f32 v169, v82, v83
 v_cvt_pk_bf16_f32 v170, v84, v85
 v_cvt_pk_bf16_f32 v171, v86, v87
 buffer_load_dwordx4 v3, s[24:27], s10 offen offset:1024 sc1 lds
 v_accvgpr_read_b32 v88, a116
 v_accvgpr_read_b32 v89, a117
 v_accvgpr_read_b32 v90, a118
 v_accvgpr_read_b32 v91, a119
 v_accvgpr_read_b32 v92, a124
 v_accvgpr_read_b32 v93, a125
 v_accvgpr_read_b32 v94, a126
 v_accvgpr_read_b32 v95, a127
 v_pk_mul_f32 v[88:89], v[88:89], s[88:89]
 v_pk_mul_f32 v[90:91], v[90:91], s[88:89]
 v_pk_mul_f32 v[92:93], v[92:93], s[88:89]
 v_pk_mul_f32 v[94:95], v[94:95], s[88:89]
 v_cvt_pk_bf16_f32 v172, v88, v89
 v_cvt_pk_bf16_f32 v173, v90, v91
 v_cvt_pk_bf16_f32 v174, v92, v93
 v_cvt_pk_bf16_f32 v175, v94, v95
 buffer_load_dwordx4 v3, s[24:27], s10 offen offset:2048 sc1 lds
 buffer_load_dwordx4 v3, s[24:27], s10 offen offset:3072 sc1 lds
 s_branch gated_mix__compressed_kv_cla__glu_gated_swiglu__prompt_kernel_attn
gated_mix__compressed_kv_cla__glu_gated_swiglu__prompt_kernel_qq:
 s_mov_b32 s91, 0
 s_mov_b32 s92, 32768
 s_and_b32 s93, s68, 1
 s_lshl_b32 s93, s93, 13
 s_sub_u32 s94, s92, s93
 s_sub_u32 s95, s91, s93
 v_add_u32 v108, s94, v13
 v_add_u32 v13, s95, v13
 v_add_u32 v109, s94, v14
 v_add_u32 v14, s95, v14
 v_add_u32 v110, s94, v15
 v_add_u32 v15, s95, v15
 v_add_u32 v111, s94, v16
 v_add_u32 v16, s95, v16
 s_add_u32 s87, s78, s92
 s_add_u32 s78, s78, s91
 v_add_u32 v19, s93, v19
 v_add_u32 v20, s93, v20
 v_mov_b32 v24, v254
 v_add_u32 v17, s73, v19
 s_waitcnt vmcnt(20)
 ds_read_b128 v[32:35], v17 offset:0
 ds_read_b128 v[36:39], v17 offset:2048
 ds_read_b128 v[40:43], v17 offset:4096
 ds_read_b128 v[44:47], v17 offset:6144
 ds_read_b64_tr_b16 v[64:65], v13 offset:0
 ds_read_b64_tr_b16 v[66:67], v13 offset:512
 ds_read_b64_tr_b16 v[68:69], v14 offset:0
 ds_read_b64_tr_b16 v[70:71], v14 offset:512
 ds_read_b64_tr_b16 v[72:73], v15 offset:0
 ds_read_b64_tr_b16 v[74:75], v15 offset:512
 ds_read_b64_tr_b16 v[76:77], v16 offset:0
 ds_read_b64_tr_b16 v[78:79], v16 offset:512
 ds_read_b64_tr_b16 v[80:81], v13 offset:4096
 ds_read_b64_tr_b16 v[82:83], v13 offset:4608
 ds_read_b64_tr_b16 v[84:85], v14 offset:4096
 ds_read_b64_tr_b16 v[86:87], v14 offset:4608
 ds_read_b64_tr_b16 v[88:89], v15 offset:4096
 ds_read_b64_tr_b16 v[90:91], v15 offset:4608
 s_waitcnt lgkmcnt(12)
 v_mfma_f32_16x16x32_bf16 a[0:3], v[64:67], v[32:35], 0
 ds_read_b64_tr_b16 v[92:93], v16 offset:4096
 v_mfma_f32_16x16x32_bf16 a[4:7], v[64:67], v[36:39], 0
 v_mfma_f32_16x16x32_bf16 a[8:11], v[64:67], v[40:43], 0
 ds_read_b64_tr_b16 v[94:95], v16 offset:4608
 v_mfma_f32_16x16x32_bf16 a[12:15], v[64:67], v[44:47], 0
 s_waitcnt lgkmcnt(12)
 v_mfma_f32_16x16x32_bf16 a[28:31], v[68:71], v[44:47], 0
 ds_read_b64_tr_b16 v[64:65], v13 offset:8192
 v_mfma_f32_16x16x32_bf16 a[24:27], v[68:71], v[40:43], 0
 v_add_u32 v18, s73, v20
 v_mfma_f32_16x16x32_bf16 a[20:23], v[68:71], v[36:39], 0
 ds_read_b64_tr_b16 v[66:67], v13 offset:8704
 v_mfma_f32_16x16x32_bf16 a[16:19], v[68:71], v[32:35], 0
 s_waitcnt lgkmcnt(12)
 v_mfma_f32_16x16x32_bf16 a[32:35], v[72:75], v[32:35], 0
 ds_read_b64_tr_b16 v[68:69], v14 offset:8192
 v_mfma_f32_16x16x32_bf16 a[36:39], v[72:75], v[36:39], 0
 v_mfma_f32_16x16x32_bf16 a[40:43], v[72:75], v[40:43], 0
 ds_read_b64_tr_b16 v[70:71], v14 offset:8704
 v_mfma_f32_16x16x32_bf16 a[44:47], v[72:75], v[44:47], 0
 s_waitcnt lgkmcnt(12)
 v_mfma_f32_16x16x32_bf16 a[60:63], v[76:79], v[44:47], 0
 ds_read_b64_tr_b16 v[72:73], v15 offset:8192
 v_mfma_f32_16x16x32_bf16 a[56:59], v[76:79], v[40:43], 0
 v_mfma_f32_16x16x32_bf16 a[52:55], v[76:79], v[36:39], 0
 ds_read_b64_tr_b16 v[74:75], v15 offset:8704
 v_mfma_f32_16x16x32_bf16 a[48:51], v[76:79], v[32:35], 0
 s_waitcnt lgkmcnt(12)
 v_mfma_f32_16x16x32_bf16 a[64:67], v[80:83], v[32:35], 0
 ds_read_b64_tr_b16 v[76:77], v16 offset:8192
 v_mfma_f32_16x16x32_bf16 a[68:71], v[80:83], v[36:39], 0
 v_mfma_f32_16x16x32_bf16 a[72:75], v[80:83], v[40:43], 0
 ds_read_b64_tr_b16 v[78:79], v16 offset:8704
 v_mfma_f32_16x16x32_bf16 a[76:79], v[80:83], v[44:47], 0
 s_waitcnt lgkmcnt(12)
 v_mfma_f32_16x16x32_bf16 a[92:95], v[84:87], v[44:47], 0
 ds_read_b64_tr_b16 v[80:81], v13 offset:12288
 v_mfma_f32_16x16x32_bf16 a[88:91], v[84:87], v[40:43], 0
 v_mfma_f32_16x16x32_bf16 a[84:87], v[84:87], v[36:39], 0
 ds_read_b64_tr_b16 v[82:83], v13 offset:12800
 v_mfma_f32_16x16x32_bf16 a[80:83], v[84:87], v[32:35], 0
 s_waitcnt lgkmcnt(12)
 buffer_store_dwordx4 v[112:115], v21, s[36:39], s6 offen offset:0 sc1
 v_mfma_f32_16x16x32_bf16 a[96:99], v[88:91], v[32:35], 0
 ds_read_b64_tr_b16 v[84:85], v14 offset:12288
 v_mfma_f32_16x16x32_bf16 a[100:103], v[88:91], v[36:39], 0
 ds_read_b128 v[48:51], v18 offset:0
 v_mfma_f32_16x16x32_bf16 a[104:107], v[88:91], v[40:43], 0
 ds_read_b64_tr_b16 v[86:87], v14 offset:12800
 v_mfma_f32_16x16x32_bf16 a[108:111], v[88:91], v[44:47], 0
 s_waitcnt lgkmcnt(13)
 buffer_store_dwordx4 v[116:119], v21, s[36:39], s6 offen offset:1024 sc1
 v_mfma_f32_16x16x32_bf16 a[124:127], v[92:95], v[44:47], 0
 ds_read_b64_tr_b16 v[88:89], v15 offset:12288
 v_mfma_f32_16x16x32_bf16 a[120:123], v[92:95], v[40:43], 0
 ds_read_b128 v[52:55], v18 offset:2048
 v_mfma_f32_16x16x32_bf16 a[116:119], v[92:95], v[36:39], 0
 ds_read_b64_tr_b16 v[90:91], v15 offset:12800
 v_mfma_f32_16x16x32_bf16 a[112:115], v[92:95], v[32:35], 0
 s_waitcnt lgkmcnt(14)
 ds_read_b128 v[56:59], v18 offset:4096
 v_mfma_f32_16x16x32_bf16 a[128:131], v[64:67], v[32:35], 0
 ds_read_b64_tr_b16 v[92:93], v16 offset:12288
 v_mfma_f32_16x16x32_bf16 a[132:135], v[64:67], v[36:39], 0
 ds_read_b128 v[60:63], v18 offset:6144
 v_mfma_f32_16x16x32_bf16 a[136:139], v[64:67], v[40:43], 0
 ds_read_b64_tr_b16 v[94:95], v16 offset:12800
 v_mfma_f32_16x16x32_bf16 a[140:143], v[64:67], v[44:47], 0
 s_waitcnt lgkmcnt(15)
 s_waitcnt vmcnt(18)
 s_barrier
 v_mfma_f32_16x16x32_bf16 a[156:159], v[68:71], v[44:47], 0
 ds_read_b64_tr_b16 v[64:65], v13 offset:16384
 v_mfma_f32_16x16x32_bf16 a[152:155], v[68:71], v[40:43], 0
 s_add_u32 m0, s72, s76
 v_mfma_f32_16x16x32_bf16 a[148:151], v[68:71], v[36:39], 0
 ds_read_b64_tr_b16 v[66:67], v13 offset:16896
 v_mfma_f32_16x16x32_bf16 a[144:147], v[68:71], v[32:35], 0
 s_waitcnt lgkmcnt(15)
 buffer_load_dwordx4 v1, s[20:23], s69 offen offset:0 lds
 v_mfma_f32_16x16x32_bf16 a[160:163], v[72:75], v[32:35], 0
 ds_read_b64_tr_b16 v[68:69], v14 offset:16384
 v_mfma_f32_16x16x32_bf16 a[164:167], v[72:75], v[36:39], 0
 v_mfma_f32_16x16x32_bf16 a[168:171], v[72:75], v[40:43], 0
 ds_read_b64_tr_b16 v[70:71], v14 offset:16896
 v_mfma_f32_16x16x32_bf16 a[172:175], v[72:75], v[44:47], 0
 s_waitcnt lgkmcnt(15)
 buffer_load_dwordx4 v2, s[20:23], s69 offen offset:1024 lds
 v_mfma_f32_16x16x32_bf16 a[188:191], v[76:79], v[44:47], 0
 ds_read_b64_tr_b16 v[72:73], v15 offset:16384
 v_mfma_f32_16x16x32_bf16 a[184:187], v[76:79], v[40:43], 0
 v_mfma_f32_16x16x32_bf16 a[180:183], v[76:79], v[36:39], 0
 ds_read_b64_tr_b16 v[74:75], v15 offset:16896
 v_mfma_f32_16x16x32_bf16 a[176:179], v[76:79], v[32:35], 0
 s_waitcnt lgkmcnt(15)
 buffer_load_dwordx4 v3, s[20:23], s69 offen offset:2048 lds
 v_mfma_f32_16x16x32_bf16 a[192:195], v[80:83], v[32:35], 0
 ds_read_b64_tr_b16 v[76:77], v16 offset:16384
 v_mfma_f32_16x16x32_bf16 a[196:199], v[80:83], v[36:39], 0
 v_mfma_f32_16x16x32_bf16 a[200:203], v[80:83], v[40:43], 0
 ds_read_b64_tr_b16 v[78:79], v16 offset:16896
 v_mfma_f32_16x16x32_bf16 a[204:207], v[80:83], v[44:47], 0
 s_waitcnt lgkmcnt(15)
 buffer_load_dwordx4 v4, s[20:23], s69 offen offset:3072 lds
 v_mfma_f32_16x16x32_bf16 a[220:223], v[84:87], v[44:47], 0
 ds_read_b64_tr_b16 v[80:81], v13 offset:20480
 v_mfma_f32_16x16x32_bf16 a[216:219], v[84:87], v[40:43], 0
 v_mfma_f32_16x16x32_bf16 a[212:215], v[84:87], v[36:39], 0
 ds_read_b64_tr_b16 v[82:83], v13 offset:20992
 v_mfma_f32_16x16x32_bf16 a[208:211], v[84:87], v[32:35], 0
 s_waitcnt lgkmcnt(14)
 buffer_store_dwordx4 v[120:123], v21, s[36:39], s6 offen offset:2048 sc1
 v_mfma_f32_16x16x32_bf16 a[224:227], v[88:91], v[32:35], 0
 ds_read_b64_tr_b16 v[84:85], v14 offset:20480
 v_mfma_f32_16x16x32_bf16 a[228:231], v[88:91], v[36:39], 0
 v_mfma_f32_16x16x32_bf16 a[232:235], v[88:91], v[40:43], 0
 ds_read_b64_tr_b16 v[86:87], v14 offset:20992
 v_mfma_f32_16x16x32_bf16 a[236:239], v[88:91], v[44:47], 0
 s_waitcnt lgkmcnt(12)
 buffer_store_dwordx4 v[124:127], v21, s[36:39], s6 offen offset:3072 sc1
 v_mfma_f32_16x16x32_bf16 a[252:255], v[92:95], v[44:47], 0
 ds_read_b64_tr_b16 v[88:89], v15 offset:20480
 v_mfma_f32_16x16x32_bf16 a[248:251], v[92:95], v[40:43], 0
 v_mfma_f32_16x16x32_bf16 a[244:247], v[92:95], v[36:39], 0
 ds_read_b64_tr_b16 v[90:91], v15 offset:20992
 v_mfma_f32_16x16x32_bf16 a[240:243], v[92:95], v[32:35], 0
 s_waitcnt lgkmcnt(12)
 v_mfma_f32_16x16x32_bf16 a[0:3], v[64:67], v[48:51], a[0:3]
 ds_read_b64_tr_b16 v[92:93], v16 offset:20480
 v_mfma_f32_16x16x32_bf16 a[4:7], v[64:67], v[52:55], a[4:7]
 s_add_u32 m0, s72, s77
 v_mfma_f32_16x16x32_bf16 a[8:11], v[64:67], v[56:59], a[8:11]
 ds_read_b64_tr_b16 v[94:95], v16 offset:20992
 v_mfma_f32_16x16x32_bf16 a[12:15], v[64:67], v[60:63], a[12:15]
 s_waitcnt lgkmcnt(12)
 buffer_load_dwordx4 v5, s[20:23], s69 offen offset:0 lds
 v_mfma_f32_16x16x32_bf16 a[28:31], v[68:71], v[60:63], a[28:31]
 ds_read_b64_tr_b16 v[64:65], v13 offset:24576
 v_mfma_f32_16x16x32_bf16 a[24:27], v[68:71], v[56:59], a[24:27]
 v_add_u32 v17, s74, v19
 v_mfma_f32_16x16x32_bf16 a[20:23], v[68:71], v[52:55], a[20:23]
 ds_read_b64_tr_b16 v[66:67], v13 offset:25088
 v_mfma_f32_16x16x32_bf16 a[16:19], v[68:71], v[48:51], a[16:19]
 s_waitcnt lgkmcnt(12)
 buffer_load_dwordx4 v6, s[20:23], s69 offen offset:1024 lds
 v_mfma_f32_16x16x32_bf16 a[32:35], v[72:75], v[48:51], a[32:35]
 ds_read_b64_tr_b16 v[68:69], v14 offset:24576
 v_mfma_f32_16x16x32_bf16 a[36:39], v[72:75], v[52:55], a[36:39]
 v_mfma_f32_16x16x32_bf16 a[40:43], v[72:75], v[56:59], a[40:43]
 ds_read_b64_tr_b16 v[70:71], v14 offset:25088
 v_mfma_f32_16x16x32_bf16 a[44:47], v[72:75], v[60:63], a[44:47]
 s_waitcnt lgkmcnt(12)
 buffer_load_dwordx4 v7, s[20:23], s69 offen offset:2048 lds
 v_mfma_f32_16x16x32_bf16 a[60:63], v[76:79], v[60:63], a[60:63]
 ds_read_b64_tr_b16 v[72:73], v15 offset:24576
 v_mfma_f32_16x16x32_bf16 a[56:59], v[76:79], v[56:59], a[56:59]
 v_mfma_f32_16x16x32_bf16 a[52:55], v[76:79], v[52:55], a[52:55]
 ds_read_b64_tr_b16 v[74:75], v15 offset:25088
 v_mfma_f32_16x16x32_bf16 a[48:51], v[76:79], v[48:51], a[48:51]
 s_waitcnt lgkmcnt(12)
 buffer_load_dwordx4 v8, s[20:23], s69 offen offset:3072 lds
 v_mfma_f32_16x16x32_bf16 a[64:67], v[80:83], v[48:51], a[64:67]
 ds_read_b64_tr_b16 v[76:77], v16 offset:24576
 v_mfma_f32_16x16x32_bf16 a[68:71], v[80:83], v[52:55], a[68:71]
 v_mfma_f32_16x16x32_bf16 a[72:75], v[80:83], v[56:59], a[72:75]
 ds_read_b64_tr_b16 v[78:79], v16 offset:25088
 v_mfma_f32_16x16x32_bf16 a[76:79], v[80:83], v[60:63], a[76:79]
 s_waitcnt lgkmcnt(12)
 v_mfma_f32_16x16x32_bf16 a[92:95], v[84:87], v[60:63], a[92:95]
 s_add_u32 s69, s69, 128
 ds_read_b64_tr_b16 v[80:81], v13 offset:28672
 v_mfma_f32_16x16x32_bf16 a[88:91], v[84:87], v[56:59], a[88:91]
 v_mfma_f32_16x16x32_bf16 a[84:87], v[84:87], v[52:55], a[84:87]
 ds_read_b64_tr_b16 v[82:83], v13 offset:29184
 v_mfma_f32_16x16x32_bf16 a[80:83], v[84:87], v[48:51], a[80:83]
 s_waitcnt lgkmcnt(12)
 buffer_store_dwordx4 v[128:131], v21, s[36:39], s7 offen offset:0 sc1
 v_mfma_f32_16x16x32_bf16 a[96:99], v[88:91], v[48:51], a[96:99]
 ds_read_b64_tr_b16 v[84:85], v14 offset:28672
 v_mfma_f32_16x16x32_bf16 a[100:103], v[88:91], v[52:55], a[100:103]
 s_waitcnt vmcnt(17)
 ds_read_b128 v[32:35], v17 offset:0
 v_mfma_f32_16x16x32_bf16 a[104:107], v[88:91], v[56:59], a[104:107]
 ds_read_b64_tr_b16 v[86:87], v14 offset:29184
 v_mfma_f32_16x16x32_bf16 a[108:111], v[88:91], v[60:63], a[108:111]
 s_waitcnt lgkmcnt(13)
 buffer_store_dwordx4 v[132:135], v21, s[36:39], s7 offen offset:1024 sc1
 v_mfma_f32_16x16x32_bf16 a[124:127], v[92:95], v[60:63], a[124:127]
 ds_read_b64_tr_b16 v[88:89], v15 offset:28672
 v_mfma_f32_16x16x32_bf16 a[120:123], v[92:95], v[56:59], a[120:123]
 ds_read_b128 v[36:39], v17 offset:2048
 v_mfma_f32_16x16x32_bf16 a[116:119], v[92:95], v[52:55], a[116:119]
 ds_read_b64_tr_b16 v[90:91], v15 offset:29184
 v_mfma_f32_16x16x32_bf16 a[112:115], v[92:95], v[48:51], a[112:115]
 s_waitcnt lgkmcnt(14)
 ds_read_b128 v[40:43], v17 offset:4096
 v_mfma_f32_16x16x32_bf16 a[128:131], v[64:67], v[48:51], a[128:131]
 ds_read_b64_tr_b16 v[92:93], v16 offset:28672
 v_mfma_f32_16x16x32_bf16 a[132:135], v[64:67], v[52:55], a[132:135]
 ds_read_b128 v[44:47], v17 offset:6144
 v_mfma_f32_16x16x32_bf16 a[136:139], v[64:67], v[56:59], a[136:139]
 ds_read_b64_tr_b16 v[94:95], v16 offset:29184
 v_mfma_f32_16x16x32_bf16 a[140:143], v[64:67], v[60:63], a[140:143]
 s_waitcnt lgkmcnt(15)
 s_barrier
 v_mfma_f32_16x16x32_bf16 a[156:159], v[68:71], v[60:63], a[156:159]
 s_add_u32 m0, s78, 0
 ds_read_b64_tr_b16 v[64:65], v108 offset:0
 v_mfma_f32_16x16x32_bf16 a[152:155], v[68:71], v[56:59], a[152:155]
 v_mfma_f32_16x16x32_bf16 a[148:151], v[68:71], v[52:55], a[148:151]
 ds_read_b64_tr_b16 v[66:67], v108 offset:512
 v_mfma_f32_16x16x32_bf16 a[144:147], v[68:71], v[48:51], a[144:147]
 s_waitcnt lgkmcnt(15)
 buffer_load_dwordx4 v9, s[24:27], s70 offen offset:0 lds
 v_mfma_f32_16x16x32_bf16 a[160:163], v[72:75], v[48:51], a[160:163]
 ds_read_b64_tr_b16 v[68:69], v109 offset:0
 v_mfma_f32_16x16x32_bf16 a[164:167], v[72:75], v[52:55], a[164:167]
 v_mfma_f32_16x16x32_bf16 a[168:171], v[72:75], v[56:59], a[168:171]
 ds_read_b64_tr_b16 v[70:71], v109 offset:512
 v_mfma_f32_16x16x32_bf16 a[172:175], v[72:75], v[60:63], a[172:175]
 s_waitcnt lgkmcnt(15)
 buffer_load_dwordx4 v10, s[24:27], s70 offen offset:1024 lds
 v_mfma_f32_16x16x32_bf16 a[188:191], v[76:79], v[60:63], a[188:191]
 ds_read_b64_tr_b16 v[72:73], v110 offset:0
 v_mfma_f32_16x16x32_bf16 a[184:187], v[76:79], v[56:59], a[184:187]
 v_mfma_f32_16x16x32_bf16 a[180:183], v[76:79], v[52:55], a[180:183]
 ds_read_b64_tr_b16 v[74:75], v110 offset:512
 v_mfma_f32_16x16x32_bf16 a[176:179], v[76:79], v[48:51], a[176:179]
 s_waitcnt lgkmcnt(15)
 buffer_load_dwordx4 v11, s[24:27], s70 offen offset:2048 lds
 v_mfma_f32_16x16x32_bf16 a[192:195], v[80:83], v[48:51], a[192:195]
 ds_read_b64_tr_b16 v[76:77], v111 offset:0
 v_mfma_f32_16x16x32_bf16 a[196:199], v[80:83], v[52:55], a[196:199]
 v_mfma_f32_16x16x32_bf16 a[200:203], v[80:83], v[56:59], a[200:203]
 ds_read_b64_tr_b16 v[78:79], v111 offset:512
 v_mfma_f32_16x16x32_bf16 a[204:207], v[80:83], v[60:63], a[204:207]
 s_waitcnt lgkmcnt(15)
 buffer_load_dwordx4 v12, s[24:27], s70 offen offset:3072 lds
 v_mfma_f32_16x16x32_bf16 a[220:223], v[84:87], v[60:63], a[220:223]
 ds_read_b64_tr_b16 v[80:81], v108 offset:4096
 v_mfma_f32_16x16x32_bf16 a[216:219], v[84:87], v[56:59], a[216:219]
 s_mov_b32 s75, s72
 v_mfma_f32_16x16x32_bf16 a[212:215], v[84:87], v[52:55], a[212:215]
 ds_read_b64_tr_b16 v[82:83], v108 offset:4608
 v_mfma_f32_16x16x32_bf16 a[208:211], v[84:87], v[48:51], a[208:211]
 s_waitcnt lgkmcnt(14)
 buffer_store_dwordx4 v[136:139], v21, s[36:39], s7 offen offset:2048 sc1
 v_mfma_f32_16x16x32_bf16 a[224:227], v[88:91], v[48:51], a[224:227]
 ds_read_b64_tr_b16 v[84:85], v109 offset:4096
 v_mfma_f32_16x16x32_bf16 a[228:231], v[88:91], v[52:55], a[228:231]
 s_mov_b32 s72, s73
 v_mfma_f32_16x16x32_bf16 a[232:235], v[88:91], v[56:59], a[232:235]
 ds_read_b64_tr_b16 v[86:87], v109 offset:4608
 v_mfma_f32_16x16x32_bf16 a[236:239], v[88:91], v[60:63], a[236:239]
 s_waitcnt lgkmcnt(12)
 buffer_store_dwordx4 v[140:143], v21, s[36:39], s7 offen offset:3072 sc1
 v_mfma_f32_16x16x32_bf16 a[252:255], v[92:95], v[60:63], a[252:255]
 ds_read_b64_tr_b16 v[88:89], v110 offset:4096
 v_mfma_f32_16x16x32_bf16 a[248:251], v[92:95], v[56:59], a[248:251]
 s_mov_b32 s73, s74
 v_mfma_f32_16x16x32_bf16 a[244:247], v[92:95], v[52:55], a[244:247]
 ds_read_b64_tr_b16 v[90:91], v110 offset:4608
 v_mfma_f32_16x16x32_bf16 a[240:243], v[92:95], v[48:51], a[240:243]
 s_add_u32 s70, s70, s71
 s_mov_b32 s74, s75
 s_waitcnt lgkmcnt(12)
 v_mfma_f32_16x16x32_bf16 a[0:3], v[64:67], v[32:35], a[0:3]
 ds_read_b64_tr_b16 v[92:93], v111 offset:4096
 v_mfma_f32_16x16x32_bf16 a[4:7], v[64:67], v[36:39], a[4:7]
 s_add_u32 m0, s72, s76
 v_mfma_f32_16x16x32_bf16 a[8:11], v[64:67], v[40:43], a[8:11]
 ds_read_b64_tr_b16 v[94:95], v111 offset:4608
 v_mfma_f32_16x16x32_bf16 a[12:15], v[64:67], v[44:47], a[12:15]
 s_waitcnt lgkmcnt(12)
 buffer_load_dwordx4 v1, s[20:23], s69 offen offset:0 lds
 v_mfma_f32_16x16x32_bf16 a[28:31], v[68:71], v[44:47], a[28:31]
 ds_read_b64_tr_b16 v[64:65], v108 offset:8192
 v_mfma_f32_16x16x32_bf16 a[24:27], v[68:71], v[40:43], a[24:27]
 v_add_u32 v18, s73, v20
 v_mfma_f32_16x16x32_bf16 a[20:23], v[68:71], v[36:39], a[20:23]
 ds_read_b64_tr_b16 v[66:67], v108 offset:8704
 v_mfma_f32_16x16x32_bf16 a[16:19], v[68:71], v[32:35], a[16:19]
 s_waitcnt lgkmcnt(12)
 buffer_load_dwordx4 v2, s[20:23], s69 offen offset:1024 lds
 v_mfma_f32_16x16x32_bf16 a[32:35], v[72:75], v[32:35], a[32:35]
 ds_read_b64_tr_b16 v[68:69], v109 offset:8192
 v_mfma_f32_16x16x32_bf16 a[36:39], v[72:75], v[36:39], a[36:39]
 v_mfma_f32_16x16x32_bf16 a[40:43], v[72:75], v[40:43], a[40:43]
 ds_read_b64_tr_b16 v[70:71], v109 offset:8704
 v_mfma_f32_16x16x32_bf16 a[44:47], v[72:75], v[44:47], a[44:47]
 s_waitcnt lgkmcnt(12)
 buffer_load_dwordx4 v3, s[20:23], s69 offen offset:2048 lds
 v_mfma_f32_16x16x32_bf16 a[60:63], v[76:79], v[44:47], a[60:63]
 ds_read_b64_tr_b16 v[72:73], v110 offset:8192
 v_mfma_f32_16x16x32_bf16 a[56:59], v[76:79], v[40:43], a[56:59]
 v_mfma_f32_16x16x32_bf16 a[52:55], v[76:79], v[36:39], a[52:55]
 ds_read_b64_tr_b16 v[74:75], v110 offset:8704
 v_mfma_f32_16x16x32_bf16 a[48:51], v[76:79], v[32:35], a[48:51]
 s_waitcnt lgkmcnt(12)
 buffer_load_dwordx4 v4, s[20:23], s69 offen offset:3072 lds
 v_mfma_f32_16x16x32_bf16 a[64:67], v[80:83], v[32:35], a[64:67]
 ds_read_b64_tr_b16 v[76:77], v111 offset:8192
 v_mfma_f32_16x16x32_bf16 a[68:71], v[80:83], v[36:39], a[68:71]
 v_mfma_f32_16x16x32_bf16 a[72:75], v[80:83], v[40:43], a[72:75]
 ds_read_b64_tr_b16 v[78:79], v111 offset:8704
 v_mfma_f32_16x16x32_bf16 a[76:79], v[80:83], v[44:47], a[76:79]
 s_waitcnt lgkmcnt(12)
 v_mfma_f32_16x16x32_bf16 a[92:95], v[84:87], v[44:47], a[92:95]
 ds_read_b64_tr_b16 v[80:81], v108 offset:12288
 v_mfma_f32_16x16x32_bf16 a[88:91], v[84:87], v[40:43], a[88:91]
 v_mfma_f32_16x16x32_bf16 a[84:87], v[84:87], v[36:39], a[84:87]
 ds_read_b64_tr_b16 v[82:83], v108 offset:12800
 v_mfma_f32_16x16x32_bf16 a[80:83], v[84:87], v[32:35], a[80:83]
 s_waitcnt lgkmcnt(12)
 buffer_store_dwordx4 v[144:147], v21, s[36:39], s8 offen offset:0 sc1
 v_mfma_f32_16x16x32_bf16 a[96:99], v[88:91], v[32:35], a[96:99]
 ds_read_b64_tr_b16 v[84:85], v109 offset:12288
 v_mfma_f32_16x16x32_bf16 a[100:103], v[88:91], v[36:39], a[100:103]
 ds_read_b128 v[48:51], v18 offset:0
 v_mfma_f32_16x16x32_bf16 a[104:107], v[88:91], v[40:43], a[104:107]
 ds_read_b64_tr_b16 v[86:87], v109 offset:12800
 v_mfma_f32_16x16x32_bf16 a[108:111], v[88:91], v[44:47], a[108:111]
 s_waitcnt lgkmcnt(13)
 buffer_store_dwordx4 v[148:151], v21, s[36:39], s8 offen offset:1024 sc1
 v_mfma_f32_16x16x32_bf16 a[124:127], v[92:95], v[44:47], a[124:127]
 ds_read_b64_tr_b16 v[88:89], v110 offset:12288
 v_mfma_f32_16x16x32_bf16 a[120:123], v[92:95], v[40:43], a[120:123]
 ds_read_b128 v[52:55], v18 offset:2048
 v_mfma_f32_16x16x32_bf16 a[116:119], v[92:95], v[36:39], a[116:119]
 ds_read_b64_tr_b16 v[90:91], v110 offset:12800
 v_mfma_f32_16x16x32_bf16 a[112:115], v[92:95], v[32:35], a[112:115]
 s_waitcnt lgkmcnt(14)
 ds_read_b128 v[56:59], v18 offset:4096
 v_mfma_f32_16x16x32_bf16 a[128:131], v[64:67], v[32:35], a[128:131]
 ds_read_b64_tr_b16 v[92:93], v111 offset:12288
 v_mfma_f32_16x16x32_bf16 a[132:135], v[64:67], v[36:39], a[132:135]
 ds_read_b128 v[60:63], v18 offset:6144
 v_mfma_f32_16x16x32_bf16 a[136:139], v[64:67], v[40:43], a[136:139]
 ds_read_b64_tr_b16 v[94:95], v111 offset:12800
 v_mfma_f32_16x16x32_bf16 a[140:143], v[64:67], v[44:47], a[140:143]
 s_waitcnt lgkmcnt(15)
 s_waitcnt vmcnt(26)
 s_barrier
 v_mfma_f32_16x16x32_bf16 a[156:159], v[68:71], v[44:47], a[156:159]
 s_add_u32 m0, s78, 16384
 ds_read_b64_tr_b16 v[64:65], v108 offset:16384
 v_mfma_f32_16x16x32_bf16 a[152:155], v[68:71], v[40:43], a[152:155]
 v_mfma_f32_16x16x32_bf16 a[148:151], v[68:71], v[36:39], a[148:151]
 ds_read_b64_tr_b16 v[66:67], v108 offset:16896
 v_mfma_f32_16x16x32_bf16 a[144:147], v[68:71], v[32:35], a[144:147]
 s_waitcnt lgkmcnt(15)
 buffer_load_dwordx4 v9, s[24:27], s70 offen offset:0 lds
 v_mfma_f32_16x16x32_bf16 a[160:163], v[72:75], v[32:35], a[160:163]
 ds_read_b64_tr_b16 v[68:69], v109 offset:16384
 v_mfma_f32_16x16x32_bf16 a[164:167], v[72:75], v[36:39], a[164:167]
 v_mfma_f32_16x16x32_bf16 a[168:171], v[72:75], v[40:43], a[168:171]
 ds_read_b64_tr_b16 v[70:71], v109 offset:16896
 v_mfma_f32_16x16x32_bf16 a[172:175], v[72:75], v[44:47], a[172:175]
 s_waitcnt lgkmcnt(15)
 buffer_load_dwordx4 v10, s[24:27], s70 offen offset:1024 lds
 v_mfma_f32_16x16x32_bf16 a[188:191], v[76:79], v[44:47], a[188:191]
 ds_read_b64_tr_b16 v[72:73], v110 offset:16384
 v_mfma_f32_16x16x32_bf16 a[184:187], v[76:79], v[40:43], a[184:187]
 v_mfma_f32_16x16x32_bf16 a[180:183], v[76:79], v[36:39], a[180:183]
 ds_read_b64_tr_b16 v[74:75], v110 offset:16896
 v_mfma_f32_16x16x32_bf16 a[176:179], v[76:79], v[32:35], a[176:179]
 s_waitcnt lgkmcnt(15)
 buffer_load_dwordx4 v11, s[24:27], s70 offen offset:2048 lds
 v_mfma_f32_16x16x32_bf16 a[192:195], v[80:83], v[32:35], a[192:195]
 ds_read_b64_tr_b16 v[76:77], v111 offset:16384
 v_mfma_f32_16x16x32_bf16 a[196:199], v[80:83], v[36:39], a[196:199]
 v_mfma_f32_16x16x32_bf16 a[200:203], v[80:83], v[40:43], a[200:203]
 ds_read_b64_tr_b16 v[78:79], v111 offset:16896
 v_mfma_f32_16x16x32_bf16 a[204:207], v[80:83], v[44:47], a[204:207]
 s_waitcnt lgkmcnt(15)
 buffer_load_dwordx4 v12, s[24:27], s70 offen offset:3072 lds
 v_mfma_f32_16x16x32_bf16 a[220:223], v[84:87], v[44:47], a[220:223]
 ds_read_b64_tr_b16 v[80:81], v108 offset:20480
 v_mfma_f32_16x16x32_bf16 a[216:219], v[84:87], v[40:43], a[216:219]
 v_mfma_f32_16x16x32_bf16 a[212:215], v[84:87], v[36:39], a[212:215]
 ds_read_b64_tr_b16 v[82:83], v108 offset:20992
 v_mfma_f32_16x16x32_bf16 a[208:211], v[84:87], v[32:35], a[208:211]
 s_waitcnt lgkmcnt(14)
 buffer_store_dwordx4 v[152:155], v21, s[36:39], s8 offen offset:2048 sc1
 v_mfma_f32_16x16x32_bf16 a[224:227], v[88:91], v[32:35], a[224:227]
 ds_read_b64_tr_b16 v[84:85], v109 offset:20480
 v_mfma_f32_16x16x32_bf16 a[228:231], v[88:91], v[36:39], a[228:231]
 v_mfma_f32_16x16x32_bf16 a[232:235], v[88:91], v[40:43], a[232:235]
 ds_read_b64_tr_b16 v[86:87], v109 offset:20992
 v_mfma_f32_16x16x32_bf16 a[236:239], v[88:91], v[44:47], a[236:239]
 s_waitcnt lgkmcnt(12)
 buffer_store_dwordx4 v[156:159], v21, s[36:39], s8 offen offset:3072 sc1
 v_mfma_f32_16x16x32_bf16 a[252:255], v[92:95], v[44:47], a[252:255]
 ds_read_b64_tr_b16 v[88:89], v110 offset:20480
 v_mfma_f32_16x16x32_bf16 a[248:251], v[92:95], v[40:43], a[248:251]
 v_mfma_f32_16x16x32_bf16 a[244:247], v[92:95], v[36:39], a[244:247]
 ds_read_b64_tr_b16 v[90:91], v110 offset:20992
 v_mfma_f32_16x16x32_bf16 a[240:243], v[92:95], v[32:35], a[240:243]
 s_add_u32 s70, s70, s71
 s_waitcnt lgkmcnt(12)
 v_mfma_f32_16x16x32_bf16 a[0:3], v[64:67], v[48:51], a[0:3]
 ds_read_b64_tr_b16 v[92:93], v111 offset:20480
 v_mfma_f32_16x16x32_bf16 a[4:7], v[64:67], v[52:55], a[4:7]
 s_add_u32 m0, s72, s77
 v_mfma_f32_16x16x32_bf16 a[8:11], v[64:67], v[56:59], a[8:11]
 ds_read_b64_tr_b16 v[94:95], v111 offset:20992
 v_mfma_f32_16x16x32_bf16 a[12:15], v[64:67], v[60:63], a[12:15]
 s_waitcnt lgkmcnt(12)
 buffer_load_dwordx4 v5, s[20:23], s69 offen offset:0 lds
 v_mfma_f32_16x16x32_bf16 a[28:31], v[68:71], v[60:63], a[28:31]
 ds_read_b64_tr_b16 v[64:65], v108 offset:24576
 v_mfma_f32_16x16x32_bf16 a[24:27], v[68:71], v[56:59], a[24:27]
 v_add_u32 v17, s74, v19
 v_mfma_f32_16x16x32_bf16 a[20:23], v[68:71], v[52:55], a[20:23]
 ds_read_b64_tr_b16 v[66:67], v108 offset:25088
 v_mfma_f32_16x16x32_bf16 a[16:19], v[68:71], v[48:51], a[16:19]
 s_waitcnt lgkmcnt(12)
 buffer_load_dwordx4 v6, s[20:23], s69 offen offset:1024 lds
 v_mfma_f32_16x16x32_bf16 a[32:35], v[72:75], v[48:51], a[32:35]
 ds_read_b64_tr_b16 v[68:69], v109 offset:24576
 v_mfma_f32_16x16x32_bf16 a[36:39], v[72:75], v[52:55], a[36:39]
 v_mfma_f32_16x16x32_bf16 a[40:43], v[72:75], v[56:59], a[40:43]
 ds_read_b64_tr_b16 v[70:71], v109 offset:25088
 v_mfma_f32_16x16x32_bf16 a[44:47], v[72:75], v[60:63], a[44:47]
 s_waitcnt lgkmcnt(12)
 buffer_load_dwordx4 v7, s[20:23], s69 offen offset:2048 lds
 v_mfma_f32_16x16x32_bf16 a[60:63], v[76:79], v[60:63], a[60:63]
 ds_read_b64_tr_b16 v[72:73], v110 offset:24576
 v_mfma_f32_16x16x32_bf16 a[56:59], v[76:79], v[56:59], a[56:59]
 v_mfma_f32_16x16x32_bf16 a[52:55], v[76:79], v[52:55], a[52:55]
 ds_read_b64_tr_b16 v[74:75], v110 offset:25088
 v_mfma_f32_16x16x32_bf16 a[48:51], v[76:79], v[48:51], a[48:51]
 s_waitcnt lgkmcnt(12)
 buffer_load_dwordx4 v8, s[20:23], s69 offen offset:3072 lds
 v_mfma_f32_16x16x32_bf16 a[64:67], v[80:83], v[48:51], a[64:67]
 ds_read_b64_tr_b16 v[76:77], v111 offset:24576
 v_mfma_f32_16x16x32_bf16 a[68:71], v[80:83], v[52:55], a[68:71]
 v_mfma_f32_16x16x32_bf16 a[72:75], v[80:83], v[56:59], a[72:75]
 ds_read_b64_tr_b16 v[78:79], v111 offset:25088
 v_mfma_f32_16x16x32_bf16 a[76:79], v[80:83], v[60:63], a[76:79]
 s_waitcnt lgkmcnt(12)
 v_mfma_f32_16x16x32_bf16 a[92:95], v[84:87], v[60:63], a[92:95]
 s_add_u32 s69, s69, 128
 ds_read_b64_tr_b16 v[80:81], v108 offset:28672
 v_mfma_f32_16x16x32_bf16 a[88:91], v[84:87], v[56:59], a[88:91]
 v_mfma_f32_16x16x32_bf16 a[84:87], v[84:87], v[52:55], a[84:87]
 ds_read_b64_tr_b16 v[82:83], v108 offset:29184
 v_mfma_f32_16x16x32_bf16 a[80:83], v[84:87], v[48:51], a[80:83]
 s_waitcnt lgkmcnt(12)
 buffer_store_dwordx4 v[160:163], v21, s[36:39], s9 offen offset:0 sc1
 v_mfma_f32_16x16x32_bf16 a[96:99], v[88:91], v[48:51], a[96:99]
 ds_read_b64_tr_b16 v[84:85], v109 offset:28672
 v_mfma_f32_16x16x32_bf16 a[100:103], v[88:91], v[52:55], a[100:103]
 s_waitcnt vmcnt(25)
 ds_read_b128 v[32:35], v17 offset:0
 v_mfma_f32_16x16x32_bf16 a[104:107], v[88:91], v[56:59], a[104:107]
 ds_read_b64_tr_b16 v[86:87], v109 offset:29184
 v_mfma_f32_16x16x32_bf16 a[108:111], v[88:91], v[60:63], a[108:111]
 s_waitcnt lgkmcnt(13)
 buffer_store_dwordx4 v[164:167], v21, s[36:39], s9 offen offset:1024 sc1
 v_mfma_f32_16x16x32_bf16 a[124:127], v[92:95], v[60:63], a[124:127]
 ds_read_b64_tr_b16 v[88:89], v110 offset:28672
 v_mfma_f32_16x16x32_bf16 a[120:123], v[92:95], v[56:59], a[120:123]
 ds_read_b128 v[36:39], v17 offset:2048
 v_mfma_f32_16x16x32_bf16 a[116:119], v[92:95], v[52:55], a[116:119]
 ds_read_b64_tr_b16 v[90:91], v110 offset:29184
 v_mfma_f32_16x16x32_bf16 a[112:115], v[92:95], v[48:51], a[112:115]
 s_waitcnt lgkmcnt(14)
 ds_read_b128 v[40:43], v17 offset:4096
 v_mfma_f32_16x16x32_bf16 a[128:131], v[64:67], v[48:51], a[128:131]
 ds_read_b64_tr_b16 v[92:93], v111 offset:28672
 v_mfma_f32_16x16x32_bf16 a[132:135], v[64:67], v[52:55], a[132:135]
 ds_read_b128 v[44:47], v17 offset:6144
 v_mfma_f32_16x16x32_bf16 a[136:139], v[64:67], v[56:59], a[136:139]
 ds_read_b64_tr_b16 v[94:95], v111 offset:29184
 v_mfma_f32_16x16x32_bf16 a[140:143], v[64:67], v[60:63], a[140:143]
 s_waitcnt lgkmcnt(15)
 s_waitcnt vmcnt(20)
 s_barrier
 v_mfma_f32_16x16x32_bf16 a[156:159], v[68:71], v[60:63], a[156:159]
 s_add_u32 m0, s87, 0
 ds_read_b64_tr_b16 v[64:65], v13 offset:0
 v_mfma_f32_16x16x32_bf16 a[152:155], v[68:71], v[56:59], a[152:155]
 v_mfma_f32_16x16x32_bf16 a[148:151], v[68:71], v[52:55], a[148:151]
 ds_read_b64_tr_b16 v[66:67], v13 offset:512
 v_mfma_f32_16x16x32_bf16 a[144:147], v[68:71], v[48:51], a[144:147]
 s_waitcnt lgkmcnt(15)
 buffer_load_dwordx4 v9, s[24:27], s70 offen offset:0 lds
 v_mfma_f32_16x16x32_bf16 a[160:163], v[72:75], v[48:51], a[160:163]
 ds_read_b64_tr_b16 v[68:69], v14 offset:0
 v_mfma_f32_16x16x32_bf16 a[164:167], v[72:75], v[52:55], a[164:167]
 v_mfma_f32_16x16x32_bf16 a[168:171], v[72:75], v[56:59], a[168:171]
 ds_read_b64_tr_b16 v[70:71], v14 offset:512
 v_mfma_f32_16x16x32_bf16 a[172:175], v[72:75], v[60:63], a[172:175]
 s_waitcnt lgkmcnt(15)
 buffer_load_dwordx4 v10, s[24:27], s70 offen offset:1024 lds
 v_mfma_f32_16x16x32_bf16 a[188:191], v[76:79], v[60:63], a[188:191]
 ds_read_b64_tr_b16 v[72:73], v15 offset:0
 v_mfma_f32_16x16x32_bf16 a[184:187], v[76:79], v[56:59], a[184:187]
 v_mfma_f32_16x16x32_bf16 a[180:183], v[76:79], v[52:55], a[180:183]
 ds_read_b64_tr_b16 v[74:75], v15 offset:512
 v_mfma_f32_16x16x32_bf16 a[176:179], v[76:79], v[48:51], a[176:179]
 s_waitcnt lgkmcnt(15)
 buffer_load_dwordx4 v11, s[24:27], s70 offen offset:2048 lds
 v_mfma_f32_16x16x32_bf16 a[192:195], v[80:83], v[48:51], a[192:195]
 ds_read_b64_tr_b16 v[76:77], v16 offset:0
 v_mfma_f32_16x16x32_bf16 a[196:199], v[80:83], v[52:55], a[196:199]
 v_mfma_f32_16x16x32_bf16 a[200:203], v[80:83], v[56:59], a[200:203]
 ds_read_b64_tr_b16 v[78:79], v16 offset:512
 v_mfma_f32_16x16x32_bf16 a[204:207], v[80:83], v[60:63], a[204:207]
 s_waitcnt lgkmcnt(15)
 buffer_load_dwordx4 v12, s[24:27], s70 offen offset:3072 lds
 v_mfma_f32_16x16x32_bf16 a[220:223], v[84:87], v[60:63], a[220:223]
 ds_read_b64_tr_b16 v[80:81], v13 offset:4096
 v_mfma_f32_16x16x32_bf16 a[216:219], v[84:87], v[56:59], a[216:219]
 s_mov_b32 s75, s72
 v_mfma_f32_16x16x32_bf16 a[212:215], v[84:87], v[52:55], a[212:215]
 ds_read_b64_tr_b16 v[82:83], v13 offset:4608
 v_mfma_f32_16x16x32_bf16 a[208:211], v[84:87], v[48:51], a[208:211]
 s_waitcnt lgkmcnt(14)
 buffer_store_dwordx4 v[168:171], v21, s[36:39], s9 offen offset:2048 sc1
 v_mfma_f32_16x16x32_bf16 a[224:227], v[88:91], v[48:51], a[224:227]
 ds_read_b64_tr_b16 v[84:85], v14 offset:4096
 v_mfma_f32_16x16x32_bf16 a[228:231], v[88:91], v[52:55], a[228:231]
 s_mov_b32 s72, s73
 v_mfma_f32_16x16x32_bf16 a[232:235], v[88:91], v[56:59], a[232:235]
 ds_read_b64_tr_b16 v[86:87], v14 offset:4608
 v_mfma_f32_16x16x32_bf16 a[236:239], v[88:91], v[60:63], a[236:239]
 s_waitcnt lgkmcnt(12)
 buffer_store_dwordx4 v[172:175], v21, s[36:39], s9 offen offset:3072 sc1
 v_mfma_f32_16x16x32_bf16 a[252:255], v[92:95], v[60:63], a[252:255]
 ds_read_b64_tr_b16 v[88:89], v15 offset:4096
 v_mfma_f32_16x16x32_bf16 a[248:251], v[92:95], v[56:59], a[248:251]
 s_mov_b32 s73, s74
 v_mfma_f32_16x16x32_bf16 a[244:247], v[92:95], v[52:55], a[244:247]
 ds_read_b64_tr_b16 v[90:91], v15 offset:4608
 v_mfma_f32_16x16x32_bf16 a[240:243], v[92:95], v[48:51], a[240:243]
 s_add_u32 s70, s70, s71
 s_mov_b32 s74, s75
 s_waitcnt lgkmcnt(12)
 v_mfma_f32_16x16x32_bf16 a[0:3], v[64:67], v[32:35], a[0:3]
 ds_read_b64_tr_b16 v[92:93], v16 offset:4096
 v_mfma_f32_16x16x32_bf16 a[4:7], v[64:67], v[36:39], a[4:7]
 s_add_u32 m0, s72, s76
 v_mfma_f32_16x16x32_bf16 a[8:11], v[64:67], v[40:43], a[8:11]
 ds_read_b64_tr_b16 v[94:95], v16 offset:4608
 v_mfma_f32_16x16x32_bf16 a[12:15], v[64:67], v[44:47], a[12:15]
 s_waitcnt lgkmcnt(12)
 buffer_load_dwordx4 v1, s[20:23], s69 offen offset:0 lds
 v_mfma_f32_16x16x32_bf16 a[28:31], v[68:71], v[44:47], a[28:31]
 ds_read_b64_tr_b16 v[64:65], v13 offset:8192
 v_mfma_f32_16x16x32_bf16 a[24:27], v[68:71], v[40:43], a[24:27]
 v_add_u32 v18, s73, v20
 v_mfma_f32_16x16x32_bf16 a[20:23], v[68:71], v[36:39], a[20:23]
 ds_read_b64_tr_b16 v[66:67], v13 offset:8704
 v_mfma_f32_16x16x32_bf16 a[16:19], v[68:71], v[32:35], a[16:19]
 s_waitcnt lgkmcnt(12)
 buffer_load_dwordx4 v2, s[20:23], s69 offen offset:1024 lds
 v_mfma_f32_16x16x32_bf16 a[32:35], v[72:75], v[32:35], a[32:35]
 ds_read_b64_tr_b16 v[68:69], v14 offset:8192
 v_mfma_f32_16x16x32_bf16 a[36:39], v[72:75], v[36:39], a[36:39]
 v_mfma_f32_16x16x32_bf16 a[40:43], v[72:75], v[40:43], a[40:43]
 ds_read_b64_tr_b16 v[70:71], v14 offset:8704
 v_mfma_f32_16x16x32_bf16 a[44:47], v[72:75], v[44:47], a[44:47]
 s_waitcnt lgkmcnt(12)
 buffer_load_dwordx4 v3, s[20:23], s69 offen offset:2048 lds
 v_mfma_f32_16x16x32_bf16 a[60:63], v[76:79], v[44:47], a[60:63]
 ds_read_b64_tr_b16 v[72:73], v15 offset:8192
 v_mfma_f32_16x16x32_bf16 a[56:59], v[76:79], v[40:43], a[56:59]
 v_mfma_f32_16x16x32_bf16 a[52:55], v[76:79], v[36:39], a[52:55]
 ds_read_b64_tr_b16 v[74:75], v15 offset:8704
 v_mfma_f32_16x16x32_bf16 a[48:51], v[76:79], v[32:35], a[48:51]
 s_waitcnt lgkmcnt(12)
 buffer_load_dwordx4 v4, s[20:23], s69 offen offset:3072 lds
 v_mfma_f32_16x16x32_bf16 a[64:67], v[80:83], v[32:35], a[64:67]
 ds_read_b64_tr_b16 v[76:77], v16 offset:8192
 v_mfma_f32_16x16x32_bf16 a[68:71], v[80:83], v[36:39], a[68:71]
 v_mfma_f32_16x16x32_bf16 a[72:75], v[80:83], v[40:43], a[72:75]
 ds_read_b64_tr_b16 v[78:79], v16 offset:8704
 v_mfma_f32_16x16x32_bf16 a[76:79], v[80:83], v[44:47], a[76:79]
 s_waitcnt lgkmcnt(12)
 v_mfma_f32_16x16x32_bf16 a[92:95], v[84:87], v[44:47], a[92:95]
 ds_read_b64_tr_b16 v[80:81], v13 offset:12288
 v_mfma_f32_16x16x32_bf16 a[88:91], v[84:87], v[40:43], a[88:91]
 v_mfma_f32_16x16x32_bf16 a[84:87], v[84:87], v[36:39], a[84:87]
 ds_read_b64_tr_b16 v[82:83], v13 offset:12800
 v_mfma_f32_16x16x32_bf16 a[80:83], v[84:87], v[32:35], a[80:83]
 s_waitcnt lgkmcnt(12)
 buffer_store_dwordx4 v[176:179], v21, s[36:39], s10 offen offset:0 sc1
 v_mfma_f32_16x16x32_bf16 a[96:99], v[88:91], v[32:35], a[96:99]
 ds_read_b64_tr_b16 v[84:85], v14 offset:12288
 v_mfma_f32_16x16x32_bf16 a[100:103], v[88:91], v[36:39], a[100:103]
 ds_read_b128 v[48:51], v18 offset:0
 v_mfma_f32_16x16x32_bf16 a[104:107], v[88:91], v[40:43], a[104:107]
 ds_read_b64_tr_b16 v[86:87], v14 offset:12800
 v_mfma_f32_16x16x32_bf16 a[108:111], v[88:91], v[44:47], a[108:111]
 s_waitcnt lgkmcnt(13)
 buffer_store_dwordx4 v[180:183], v21, s[36:39], s10 offen offset:1024 sc1
 v_mfma_f32_16x16x32_bf16 a[124:127], v[92:95], v[44:47], a[124:127]
 ds_read_b64_tr_b16 v[88:89], v15 offset:12288
 v_mfma_f32_16x16x32_bf16 a[120:123], v[92:95], v[40:43], a[120:123]
 ds_read_b128 v[52:55], v18 offset:2048
 v_mfma_f32_16x16x32_bf16 a[116:119], v[92:95], v[36:39], a[116:119]
 ds_read_b64_tr_b16 v[90:91], v15 offset:12800
 v_mfma_f32_16x16x32_bf16 a[112:115], v[92:95], v[32:35], a[112:115]
 s_waitcnt lgkmcnt(14)
 ds_read_b128 v[56:59], v18 offset:4096
 v_mfma_f32_16x16x32_bf16 a[128:131], v[64:67], v[32:35], a[128:131]
 ds_read_b64_tr_b16 v[92:93], v16 offset:12288
 v_mfma_f32_16x16x32_bf16 a[132:135], v[64:67], v[36:39], a[132:135]
 ds_read_b128 v[60:63], v18 offset:6144
 v_mfma_f32_16x16x32_bf16 a[136:139], v[64:67], v[40:43], a[136:139]
 ds_read_b64_tr_b16 v[94:95], v16 offset:12800
 v_mfma_f32_16x16x32_bf16 a[140:143], v[64:67], v[44:47], a[140:143]
 s_waitcnt lgkmcnt(15)
 s_waitcnt vmcnt(20)
 s_barrier
 v_mfma_f32_16x16x32_bf16 a[156:159], v[68:71], v[44:47], a[156:159]
 s_add_u32 m0, s87, 16384
 ds_read_b64_tr_b16 v[64:65], v13 offset:16384
 v_mfma_f32_16x16x32_bf16 a[152:155], v[68:71], v[40:43], a[152:155]
 v_mfma_f32_16x16x32_bf16 a[148:151], v[68:71], v[36:39], a[148:151]
 ds_read_b64_tr_b16 v[66:67], v13 offset:16896
 v_mfma_f32_16x16x32_bf16 a[144:147], v[68:71], v[32:35], a[144:147]
 s_waitcnt lgkmcnt(15)
 buffer_load_dwordx4 v9, s[24:27], s70 offen offset:0 lds
 v_mfma_f32_16x16x32_bf16 a[160:163], v[72:75], v[32:35], a[160:163]
 ds_read_b64_tr_b16 v[68:69], v14 offset:16384
 v_mfma_f32_16x16x32_bf16 a[164:167], v[72:75], v[36:39], a[164:167]
 v_mfma_f32_16x16x32_bf16 a[168:171], v[72:75], v[40:43], a[168:171]
 ds_read_b64_tr_b16 v[70:71], v14 offset:16896
 v_mfma_f32_16x16x32_bf16 a[172:175], v[72:75], v[44:47], a[172:175]
 s_waitcnt lgkmcnt(15)
 buffer_load_dwordx4 v10, s[24:27], s70 offen offset:1024 lds
 v_mfma_f32_16x16x32_bf16 a[188:191], v[76:79], v[44:47], a[188:191]
 ds_read_b64_tr_b16 v[72:73], v15 offset:16384
 v_mfma_f32_16x16x32_bf16 a[184:187], v[76:79], v[40:43], a[184:187]
 v_mfma_f32_16x16x32_bf16 a[180:183], v[76:79], v[36:39], a[180:183]
 ds_read_b64_tr_b16 v[74:75], v15 offset:16896
 v_mfma_f32_16x16x32_bf16 a[176:179], v[76:79], v[32:35], a[176:179]
 s_waitcnt lgkmcnt(15)
 buffer_load_dwordx4 v11, s[24:27], s70 offen offset:2048 lds
 v_mfma_f32_16x16x32_bf16 a[192:195], v[80:83], v[32:35], a[192:195]
 ds_read_b64_tr_b16 v[76:77], v16 offset:16384
 v_mfma_f32_16x16x32_bf16 a[196:199], v[80:83], v[36:39], a[196:199]
 v_mfma_f32_16x16x32_bf16 a[200:203], v[80:83], v[40:43], a[200:203]
 ds_read_b64_tr_b16 v[78:79], v16 offset:16896
 v_mfma_f32_16x16x32_bf16 a[204:207], v[80:83], v[44:47], a[204:207]
 s_waitcnt lgkmcnt(15)
 buffer_load_dwordx4 v12, s[24:27], s70 offen offset:3072 lds
 v_mfma_f32_16x16x32_bf16 a[220:223], v[84:87], v[44:47], a[220:223]
 ds_read_b64_tr_b16 v[80:81], v13 offset:20480
 v_mfma_f32_16x16x32_bf16 a[216:219], v[84:87], v[40:43], a[216:219]
 v_mfma_f32_16x16x32_bf16 a[212:215], v[84:87], v[36:39], a[212:215]
 ds_read_b64_tr_b16 v[82:83], v13 offset:20992
 v_mfma_f32_16x16x32_bf16 a[208:211], v[84:87], v[32:35], a[208:211]
 s_waitcnt lgkmcnt(14)
 buffer_store_dwordx4 v[184:187], v21, s[36:39], s10 offen offset:2048 sc1
 v_mfma_f32_16x16x32_bf16 a[224:227], v[88:91], v[32:35], a[224:227]
 ds_read_b64_tr_b16 v[84:85], v14 offset:20480
 v_mfma_f32_16x16x32_bf16 a[228:231], v[88:91], v[36:39], a[228:231]
 v_mfma_f32_16x16x32_bf16 a[232:235], v[88:91], v[40:43], a[232:235]
 ds_read_b64_tr_b16 v[86:87], v14 offset:20992
 v_mfma_f32_16x16x32_bf16 a[236:239], v[88:91], v[44:47], a[236:239]
 s_waitcnt lgkmcnt(12)
 buffer_store_dwordx4 v[188:191], v21, s[36:39], s10 offen offset:3072 sc1
 v_mfma_f32_16x16x32_bf16 a[252:255], v[92:95], v[44:47], a[252:255]
 ds_read_b64_tr_b16 v[88:89], v15 offset:20480
 v_mfma_f32_16x16x32_bf16 a[248:251], v[92:95], v[40:43], a[248:251]
 v_mfma_f32_16x16x32_bf16 a[244:247], v[92:95], v[36:39], a[244:247]
 ds_read_b64_tr_b16 v[90:91], v15 offset:20992
 v_mfma_f32_16x16x32_bf16 a[240:243], v[92:95], v[32:35], a[240:243]
 s_add_u32 s70, s70, s71
 s_waitcnt lgkmcnt(12)
 v_mfma_f32_16x16x32_bf16 a[0:3], v[64:67], v[48:51], a[0:3]
 ds_read_b64_tr_b16 v[92:93], v16 offset:20480
 v_mfma_f32_16x16x32_bf16 a[4:7], v[64:67], v[52:55], a[4:7]
 s_add_u32 m0, s72, s77
 v_mfma_f32_16x16x32_bf16 a[8:11], v[64:67], v[56:59], a[8:11]
 ds_read_b64_tr_b16 v[94:95], v16 offset:20992
 v_mfma_f32_16x16x32_bf16 a[12:15], v[64:67], v[60:63], a[12:15]
 s_waitcnt lgkmcnt(12)
 buffer_load_dwordx4 v5, s[20:23], s69 offen offset:0 lds
 v_mfma_f32_16x16x32_bf16 a[28:31], v[68:71], v[60:63], a[28:31]
 ds_read_b64_tr_b16 v[64:65], v13 offset:24576
 v_mfma_f32_16x16x32_bf16 a[24:27], v[68:71], v[56:59], a[24:27]
 v_add_u32 v17, s74, v19
 v_mfma_f32_16x16x32_bf16 a[20:23], v[68:71], v[52:55], a[20:23]
 ds_read_b64_tr_b16 v[66:67], v13 offset:25088
 v_mfma_f32_16x16x32_bf16 a[16:19], v[68:71], v[48:51], a[16:19]
 s_waitcnt lgkmcnt(12)
 buffer_load_dwordx4 v6, s[20:23], s69 offen offset:1024 lds
 v_mfma_f32_16x16x32_bf16 a[32:35], v[72:75], v[48:51], a[32:35]
 ds_read_b64_tr_b16 v[68:69], v14 offset:24576
 v_mfma_f32_16x16x32_bf16 a[36:39], v[72:75], v[52:55], a[36:39]
 v_mfma_f32_16x16x32_bf16 a[40:43], v[72:75], v[56:59], a[40:43]
 ds_read_b64_tr_b16 v[70:71], v14 offset:25088
 v_mfma_f32_16x16x32_bf16 a[44:47], v[72:75], v[60:63], a[44:47]
 s_waitcnt lgkmcnt(12)
 buffer_load_dwordx4 v7, s[20:23], s69 offen offset:2048 lds
 v_mfma_f32_16x16x32_bf16 a[60:63], v[76:79], v[60:63], a[60:63]
 ds_read_b64_tr_b16 v[72:73], v15 offset:24576
 v_mfma_f32_16x16x32_bf16 a[56:59], v[76:79], v[56:59], a[56:59]
 v_mfma_f32_16x16x32_bf16 a[52:55], v[76:79], v[52:55], a[52:55]
 ds_read_b64_tr_b16 v[74:75], v15 offset:25088
 v_mfma_f32_16x16x32_bf16 a[48:51], v[76:79], v[48:51], a[48:51]
 s_waitcnt lgkmcnt(12)
 buffer_load_dwordx4 v8, s[20:23], s69 offen offset:3072 lds
 v_mfma_f32_16x16x32_bf16 a[64:67], v[80:83], v[48:51], a[64:67]
 ds_read_b64_tr_b16 v[76:77], v16 offset:24576
 v_mfma_f32_16x16x32_bf16 a[68:71], v[80:83], v[52:55], a[68:71]
 v_mfma_f32_16x16x32_bf16 a[72:75], v[80:83], v[56:59], a[72:75]
 ds_read_b64_tr_b16 v[78:79], v16 offset:25088
 v_mfma_f32_16x16x32_bf16 a[76:79], v[80:83], v[60:63], a[76:79]
 s_waitcnt lgkmcnt(12)
 v_mfma_f32_16x16x32_bf16 a[92:95], v[84:87], v[60:63], a[92:95]
 s_add_u32 s69, s69, 128
 ds_read_b64_tr_b16 v[80:81], v13 offset:28672
 v_mfma_f32_16x16x32_bf16 a[88:91], v[84:87], v[56:59], a[88:91]
 v_mfma_f32_16x16x32_bf16 a[84:87], v[84:87], v[52:55], a[84:87]
 ds_read_b64_tr_b16 v[82:83], v13 offset:29184
 v_mfma_f32_16x16x32_bf16 a[80:83], v[84:87], v[48:51], a[80:83]
 s_waitcnt lgkmcnt(12)
 buffer_store_dwordx4 v[192:195], v21, s[36:39], s11 offen offset:0 sc1
 v_mfma_f32_16x16x32_bf16 a[96:99], v[88:91], v[48:51], a[96:99]
 ds_read_b64_tr_b16 v[84:85], v14 offset:28672
 v_mfma_f32_16x16x32_bf16 a[100:103], v[88:91], v[52:55], a[100:103]
 s_waitcnt vmcnt(25)
 ds_read_b128 v[32:35], v17 offset:0
 v_mfma_f32_16x16x32_bf16 a[104:107], v[88:91], v[56:59], a[104:107]
 ds_read_b64_tr_b16 v[86:87], v14 offset:29184
 v_mfma_f32_16x16x32_bf16 a[108:111], v[88:91], v[60:63], a[108:111]
 s_waitcnt lgkmcnt(13)
 buffer_store_dwordx4 v[196:199], v21, s[36:39], s11 offen offset:1024 sc1
 v_mfma_f32_16x16x32_bf16 a[124:127], v[92:95], v[60:63], a[124:127]
 ds_read_b64_tr_b16 v[88:89], v15 offset:28672
 v_mfma_f32_16x16x32_bf16 a[120:123], v[92:95], v[56:59], a[120:123]
 ds_read_b128 v[36:39], v17 offset:2048
 v_mfma_f32_16x16x32_bf16 a[116:119], v[92:95], v[52:55], a[116:119]
 ds_read_b64_tr_b16 v[90:91], v15 offset:29184
 v_mfma_f32_16x16x32_bf16 a[112:115], v[92:95], v[48:51], a[112:115]
 s_waitcnt lgkmcnt(14)
 ds_read_b128 v[40:43], v17 offset:4096
 v_mfma_f32_16x16x32_bf16 a[128:131], v[64:67], v[48:51], a[128:131]
 ds_read_b64_tr_b16 v[92:93], v16 offset:28672
 v_mfma_f32_16x16x32_bf16 a[132:135], v[64:67], v[52:55], a[132:135]
 ds_read_b128 v[44:47], v17 offset:6144
 v_mfma_f32_16x16x32_bf16 a[136:139], v[64:67], v[56:59], a[136:139]
 ds_read_b64_tr_b16 v[94:95], v16 offset:29184
 v_mfma_f32_16x16x32_bf16 a[140:143], v[64:67], v[60:63], a[140:143]
 s_waitcnt lgkmcnt(15)
 s_waitcnt vmcnt(20)
 s_barrier
 v_mfma_f32_16x16x32_bf16 a[156:159], v[68:71], v[60:63], a[156:159]
 s_add_u32 m0, s78, 0
 ds_read_b64_tr_b16 v[64:65], v108 offset:0
 v_mfma_f32_16x16x32_bf16 a[152:155], v[68:71], v[56:59], a[152:155]
 v_mfma_f32_16x16x32_bf16 a[148:151], v[68:71], v[52:55], a[148:151]
 ds_read_b64_tr_b16 v[66:67], v108 offset:512
 v_mfma_f32_16x16x32_bf16 a[144:147], v[68:71], v[48:51], a[144:147]
 s_waitcnt lgkmcnt(15)
 buffer_load_dwordx4 v9, s[24:27], s70 offen offset:0 lds
 v_mfma_f32_16x16x32_bf16 a[160:163], v[72:75], v[48:51], a[160:163]
 ds_read_b64_tr_b16 v[68:69], v109 offset:0
 v_mfma_f32_16x16x32_bf16 a[164:167], v[72:75], v[52:55], a[164:167]
 v_mfma_f32_16x16x32_bf16 a[168:171], v[72:75], v[56:59], a[168:171]
 ds_read_b64_tr_b16 v[70:71], v109 offset:512
 v_mfma_f32_16x16x32_bf16 a[172:175], v[72:75], v[60:63], a[172:175]
 s_waitcnt lgkmcnt(15)
 buffer_load_dwordx4 v10, s[24:27], s70 offen offset:1024 lds
 v_mfma_f32_16x16x32_bf16 a[188:191], v[76:79], v[60:63], a[188:191]
 ds_read_b64_tr_b16 v[72:73], v110 offset:0
 v_mfma_f32_16x16x32_bf16 a[184:187], v[76:79], v[56:59], a[184:187]
 v_mfma_f32_16x16x32_bf16 a[180:183], v[76:79], v[52:55], a[180:183]
 ds_read_b64_tr_b16 v[74:75], v110 offset:512
 v_mfma_f32_16x16x32_bf16 a[176:179], v[76:79], v[48:51], a[176:179]
 s_waitcnt lgkmcnt(15)
 buffer_load_dwordx4 v11, s[24:27], s70 offen offset:2048 lds
 v_mfma_f32_16x16x32_bf16 a[192:195], v[80:83], v[48:51], a[192:195]
 ds_read_b64_tr_b16 v[76:77], v111 offset:0
 v_mfma_f32_16x16x32_bf16 a[196:199], v[80:83], v[52:55], a[196:199]
 v_mfma_f32_16x16x32_bf16 a[200:203], v[80:83], v[56:59], a[200:203]
 ds_read_b64_tr_b16 v[78:79], v111 offset:512
 v_mfma_f32_16x16x32_bf16 a[204:207], v[80:83], v[60:63], a[204:207]
 s_waitcnt lgkmcnt(15)
 buffer_load_dwordx4 v12, s[24:27], s70 offen offset:3072 lds
 v_mfma_f32_16x16x32_bf16 a[220:223], v[84:87], v[60:63], a[220:223]
 ds_read_b64_tr_b16 v[80:81], v108 offset:4096
 v_mfma_f32_16x16x32_bf16 a[216:219], v[84:87], v[56:59], a[216:219]
 s_mov_b32 s75, s72
 v_mfma_f32_16x16x32_bf16 a[212:215], v[84:87], v[52:55], a[212:215]
 ds_read_b64_tr_b16 v[82:83], v108 offset:4608
 v_mfma_f32_16x16x32_bf16 a[208:211], v[84:87], v[48:51], a[208:211]
 s_waitcnt lgkmcnt(14)
 buffer_store_dwordx4 v[200:203], v21, s[36:39], s11 offen offset:2048 sc1
 v_mfma_f32_16x16x32_bf16 a[224:227], v[88:91], v[48:51], a[224:227]
 ds_read_b64_tr_b16 v[84:85], v109 offset:4096
 v_mfma_f32_16x16x32_bf16 a[228:231], v[88:91], v[52:55], a[228:231]
 s_mov_b32 s72, s73
 v_mfma_f32_16x16x32_bf16 a[232:235], v[88:91], v[56:59], a[232:235]
 ds_read_b64_tr_b16 v[86:87], v109 offset:4608
 v_mfma_f32_16x16x32_bf16 a[236:239], v[88:91], v[60:63], a[236:239]
 s_waitcnt lgkmcnt(12)
 buffer_store_dwordx4 v[204:207], v21, s[36:39], s11 offen offset:3072 sc1
 v_mfma_f32_16x16x32_bf16 a[252:255], v[92:95], v[60:63], a[252:255]
 ds_read_b64_tr_b16 v[88:89], v110 offset:4096
 v_mfma_f32_16x16x32_bf16 a[248:251], v[92:95], v[56:59], a[248:251]
 s_mov_b32 s73, s74
 v_mfma_f32_16x16x32_bf16 a[244:247], v[92:95], v[52:55], a[244:247]
 ds_read_b64_tr_b16 v[90:91], v110 offset:4608
 v_mfma_f32_16x16x32_bf16 a[240:243], v[92:95], v[48:51], a[240:243]
 s_add_u32 s70, s70, s71
 s_mov_b32 s74, s75
 s_waitcnt lgkmcnt(12)
 v_mfma_f32_16x16x32_bf16 a[0:3], v[64:67], v[32:35], a[0:3]
 ds_read_b64_tr_b16 v[92:93], v111 offset:4096
 v_mfma_f32_16x16x32_bf16 a[4:7], v[64:67], v[36:39], a[4:7]
 s_add_u32 m0, s72, s76
 v_mfma_f32_16x16x32_bf16 a[8:11], v[64:67], v[40:43], a[8:11]
 ds_read_b64_tr_b16 v[94:95], v111 offset:4608
 v_mfma_f32_16x16x32_bf16 a[12:15], v[64:67], v[44:47], a[12:15]
 s_waitcnt lgkmcnt(12)
 buffer_load_dwordx4 v1, s[20:23], s69 offen offset:0 lds
 v_mfma_f32_16x16x32_bf16 a[28:31], v[68:71], v[44:47], a[28:31]
 ds_read_b64_tr_b16 v[64:65], v108 offset:8192
 v_mfma_f32_16x16x32_bf16 a[24:27], v[68:71], v[40:43], a[24:27]
 v_add_u32 v18, s73, v20
 v_mfma_f32_16x16x32_bf16 a[20:23], v[68:71], v[36:39], a[20:23]
 ds_read_b64_tr_b16 v[66:67], v108 offset:8704
 v_mfma_f32_16x16x32_bf16 a[16:19], v[68:71], v[32:35], a[16:19]
 s_waitcnt lgkmcnt(12)
 buffer_load_dwordx4 v2, s[20:23], s69 offen offset:1024 lds
 v_mfma_f32_16x16x32_bf16 a[32:35], v[72:75], v[32:35], a[32:35]
 ds_read_b64_tr_b16 v[68:69], v109 offset:8192
 v_mfma_f32_16x16x32_bf16 a[36:39], v[72:75], v[36:39], a[36:39]
 v_mfma_f32_16x16x32_bf16 a[40:43], v[72:75], v[40:43], a[40:43]
 ds_read_b64_tr_b16 v[70:71], v109 offset:8704
 v_mfma_f32_16x16x32_bf16 a[44:47], v[72:75], v[44:47], a[44:47]
 s_waitcnt lgkmcnt(12)
 buffer_load_dwordx4 v3, s[20:23], s69 offen offset:2048 lds
 v_mfma_f32_16x16x32_bf16 a[60:63], v[76:79], v[44:47], a[60:63]
 ds_read_b64_tr_b16 v[72:73], v110 offset:8192
 v_mfma_f32_16x16x32_bf16 a[56:59], v[76:79], v[40:43], a[56:59]
 v_mfma_f32_16x16x32_bf16 a[52:55], v[76:79], v[36:39], a[52:55]
 ds_read_b64_tr_b16 v[74:75], v110 offset:8704
 v_mfma_f32_16x16x32_bf16 a[48:51], v[76:79], v[32:35], a[48:51]
 s_waitcnt lgkmcnt(12)
 buffer_load_dwordx4 v4, s[20:23], s69 offen offset:3072 lds
 v_mfma_f32_16x16x32_bf16 a[64:67], v[80:83], v[32:35], a[64:67]
 ds_read_b64_tr_b16 v[76:77], v111 offset:8192
 v_mfma_f32_16x16x32_bf16 a[68:71], v[80:83], v[36:39], a[68:71]
 v_mfma_f32_16x16x32_bf16 a[72:75], v[80:83], v[40:43], a[72:75]
 ds_read_b64_tr_b16 v[78:79], v111 offset:8704
 v_mfma_f32_16x16x32_bf16 a[76:79], v[80:83], v[44:47], a[76:79]
 s_waitcnt lgkmcnt(12)
 v_mfma_f32_16x16x32_bf16 a[92:95], v[84:87], v[44:47], a[92:95]
 ds_read_b64_tr_b16 v[80:81], v108 offset:12288
 v_mfma_f32_16x16x32_bf16 a[88:91], v[84:87], v[40:43], a[88:91]
 v_mfma_f32_16x16x32_bf16 a[84:87], v[84:87], v[36:39], a[84:87]
 ds_read_b64_tr_b16 v[82:83], v108 offset:12800
 v_mfma_f32_16x16x32_bf16 a[80:83], v[84:87], v[32:35], a[80:83]
 s_waitcnt lgkmcnt(12)
 buffer_store_dwordx4 v[208:211], v21, s[36:39], s12 offen offset:0 sc1
 v_mfma_f32_16x16x32_bf16 a[96:99], v[88:91], v[32:35], a[96:99]
 ds_read_b64_tr_b16 v[84:85], v109 offset:12288
 v_mfma_f32_16x16x32_bf16 a[100:103], v[88:91], v[36:39], a[100:103]
 ds_read_b128 v[48:51], v18 offset:0
 v_mfma_f32_16x16x32_bf16 a[104:107], v[88:91], v[40:43], a[104:107]
 ds_read_b64_tr_b16 v[86:87], v109 offset:12800
 v_mfma_f32_16x16x32_bf16 a[108:111], v[88:91], v[44:47], a[108:111]
 s_waitcnt lgkmcnt(13)
 buffer_store_dwordx4 v[212:215], v21, s[36:39], s12 offen offset:1024 sc1
 v_mfma_f32_16x16x32_bf16 a[124:127], v[92:95], v[44:47], a[124:127]
 ds_read_b64_tr_b16 v[88:89], v110 offset:12288
 v_mfma_f32_16x16x32_bf16 a[120:123], v[92:95], v[40:43], a[120:123]
 ds_read_b128 v[52:55], v18 offset:2048
 v_mfma_f32_16x16x32_bf16 a[116:119], v[92:95], v[36:39], a[116:119]
 ds_read_b64_tr_b16 v[90:91], v110 offset:12800
 v_mfma_f32_16x16x32_bf16 a[112:115], v[92:95], v[32:35], a[112:115]
 s_waitcnt lgkmcnt(14)
 ds_read_b128 v[56:59], v18 offset:4096
 v_mfma_f32_16x16x32_bf16 a[128:131], v[64:67], v[32:35], a[128:131]
 ds_read_b64_tr_b16 v[92:93], v111 offset:12288
 v_mfma_f32_16x16x32_bf16 a[132:135], v[64:67], v[36:39], a[132:135]
 ds_read_b128 v[60:63], v18 offset:6144
 v_mfma_f32_16x16x32_bf16 a[136:139], v[64:67], v[40:43], a[136:139]
 ds_read_b64_tr_b16 v[94:95], v111 offset:12800
 v_mfma_f32_16x16x32_bf16 a[140:143], v[64:67], v[44:47], a[140:143]
 s_waitcnt lgkmcnt(15)
 s_waitcnt vmcnt(20)
 s_barrier
 v_mfma_f32_16x16x32_bf16 a[156:159], v[68:71], v[44:47], a[156:159]
 s_add_u32 m0, s78, 16384
 ds_read_b64_tr_b16 v[64:65], v108 offset:16384
 v_mfma_f32_16x16x32_bf16 a[152:155], v[68:71], v[40:43], a[152:155]
 v_mfma_f32_16x16x32_bf16 a[148:151], v[68:71], v[36:39], a[148:151]
 ds_read_b64_tr_b16 v[66:67], v108 offset:16896
 v_mfma_f32_16x16x32_bf16 a[144:147], v[68:71], v[32:35], a[144:147]
 s_waitcnt lgkmcnt(15)
 buffer_load_dwordx4 v9, s[24:27], s70 offen offset:0 lds
 v_mfma_f32_16x16x32_bf16 a[160:163], v[72:75], v[32:35], a[160:163]
 ds_read_b64_tr_b16 v[68:69], v109 offset:16384
 v_mfma_f32_16x16x32_bf16 a[164:167], v[72:75], v[36:39], a[164:167]
 v_mfma_f32_16x16x32_bf16 a[168:171], v[72:75], v[40:43], a[168:171]
 ds_read_b64_tr_b16 v[70:71], v109 offset:16896
 v_mfma_f32_16x16x32_bf16 a[172:175], v[72:75], v[44:47], a[172:175]
 s_waitcnt lgkmcnt(15)
 buffer_load_dwordx4 v10, s[24:27], s70 offen offset:1024 lds
 v_mfma_f32_16x16x32_bf16 a[188:191], v[76:79], v[44:47], a[188:191]
 ds_read_b64_tr_b16 v[72:73], v110 offset:16384
 v_mfma_f32_16x16x32_bf16 a[184:187], v[76:79], v[40:43], a[184:187]
 v_mfma_f32_16x16x32_bf16 a[180:183], v[76:79], v[36:39], a[180:183]
 ds_read_b64_tr_b16 v[74:75], v110 offset:16896
 v_mfma_f32_16x16x32_bf16 a[176:179], v[76:79], v[32:35], a[176:179]
 s_waitcnt lgkmcnt(15)
 buffer_load_dwordx4 v11, s[24:27], s70 offen offset:2048 lds
 v_mfma_f32_16x16x32_bf16 a[192:195], v[80:83], v[32:35], a[192:195]
 ds_read_b64_tr_b16 v[76:77], v111 offset:16384
 v_mfma_f32_16x16x32_bf16 a[196:199], v[80:83], v[36:39], a[196:199]
 v_mfma_f32_16x16x32_bf16 a[200:203], v[80:83], v[40:43], a[200:203]
 ds_read_b64_tr_b16 v[78:79], v111 offset:16896
 v_mfma_f32_16x16x32_bf16 a[204:207], v[80:83], v[44:47], a[204:207]
 s_waitcnt lgkmcnt(15)
 buffer_load_dwordx4 v12, s[24:27], s70 offen offset:3072 lds
 v_mfma_f32_16x16x32_bf16 a[220:223], v[84:87], v[44:47], a[220:223]
 ds_read_b64_tr_b16 v[80:81], v108 offset:20480
 v_mfma_f32_16x16x32_bf16 a[216:219], v[84:87], v[40:43], a[216:219]
 v_mfma_f32_16x16x32_bf16 a[212:215], v[84:87], v[36:39], a[212:215]
 ds_read_b64_tr_b16 v[82:83], v108 offset:20992
 v_mfma_f32_16x16x32_bf16 a[208:211], v[84:87], v[32:35], a[208:211]
 s_waitcnt lgkmcnt(14)
 buffer_store_dwordx4 v[216:219], v21, s[36:39], s12 offen offset:2048 sc1
 v_mfma_f32_16x16x32_bf16 a[224:227], v[88:91], v[32:35], a[224:227]
 ds_read_b64_tr_b16 v[84:85], v109 offset:20480
 v_mfma_f32_16x16x32_bf16 a[228:231], v[88:91], v[36:39], a[228:231]
 v_mfma_f32_16x16x32_bf16 a[232:235], v[88:91], v[40:43], a[232:235]
 ds_read_b64_tr_b16 v[86:87], v109 offset:20992
 v_mfma_f32_16x16x32_bf16 a[236:239], v[88:91], v[44:47], a[236:239]
 s_waitcnt lgkmcnt(12)
 buffer_store_dwordx4 v[220:223], v21, s[36:39], s12 offen offset:3072 sc1
 v_mfma_f32_16x16x32_bf16 a[252:255], v[92:95], v[44:47], a[252:255]
 ds_read_b64_tr_b16 v[88:89], v110 offset:20480
 v_mfma_f32_16x16x32_bf16 a[248:251], v[92:95], v[40:43], a[248:251]
 v_mfma_f32_16x16x32_bf16 a[244:247], v[92:95], v[36:39], a[244:247]
 ds_read_b64_tr_b16 v[90:91], v110 offset:20992
 v_mfma_f32_16x16x32_bf16 a[240:243], v[92:95], v[32:35], a[240:243]
 s_add_u32 s70, s70, s71
 s_waitcnt lgkmcnt(12)
 v_mfma_f32_16x16x32_bf16 a[0:3], v[64:67], v[48:51], a[0:3]
 ds_read_b64_tr_b16 v[92:93], v111 offset:20480
 v_mfma_f32_16x16x32_bf16 a[4:7], v[64:67], v[52:55], a[4:7]
 s_add_u32 m0, s72, s77
 v_mfma_f32_16x16x32_bf16 a[8:11], v[64:67], v[56:59], a[8:11]
 ds_read_b64_tr_b16 v[94:95], v111 offset:20992
 v_mfma_f32_16x16x32_bf16 a[12:15], v[64:67], v[60:63], a[12:15]
 s_waitcnt lgkmcnt(12)
 buffer_load_dwordx4 v5, s[20:23], s69 offen offset:0 lds
 v_mfma_f32_16x16x32_bf16 a[28:31], v[68:71], v[60:63], a[28:31]
 ds_read_b64_tr_b16 v[64:65], v108 offset:24576
 v_mfma_f32_16x16x32_bf16 a[24:27], v[68:71], v[56:59], a[24:27]
 v_add_u32 v17, s74, v19
 v_mfma_f32_16x16x32_bf16 a[20:23], v[68:71], v[52:55], a[20:23]
 ds_read_b64_tr_b16 v[66:67], v108 offset:25088
 v_mfma_f32_16x16x32_bf16 a[16:19], v[68:71], v[48:51], a[16:19]
 s_waitcnt lgkmcnt(12)
 buffer_load_dwordx4 v6, s[20:23], s69 offen offset:1024 lds
 v_mfma_f32_16x16x32_bf16 a[32:35], v[72:75], v[48:51], a[32:35]
 ds_read_b64_tr_b16 v[68:69], v109 offset:24576
 v_mfma_f32_16x16x32_bf16 a[36:39], v[72:75], v[52:55], a[36:39]
 v_mfma_f32_16x16x32_bf16 a[40:43], v[72:75], v[56:59], a[40:43]
 ds_read_b64_tr_b16 v[70:71], v109 offset:25088
 v_mfma_f32_16x16x32_bf16 a[44:47], v[72:75], v[60:63], a[44:47]
 s_waitcnt lgkmcnt(12)
 buffer_load_dwordx4 v7, s[20:23], s69 offen offset:2048 lds
 v_mfma_f32_16x16x32_bf16 a[60:63], v[76:79], v[60:63], a[60:63]
 ds_read_b64_tr_b16 v[72:73], v110 offset:24576
 v_mfma_f32_16x16x32_bf16 a[56:59], v[76:79], v[56:59], a[56:59]
 v_mfma_f32_16x16x32_bf16 a[52:55], v[76:79], v[52:55], a[52:55]
 ds_read_b64_tr_b16 v[74:75], v110 offset:25088
 v_mfma_f32_16x16x32_bf16 a[48:51], v[76:79], v[48:51], a[48:51]
 s_waitcnt lgkmcnt(12)
 buffer_load_dwordx4 v8, s[20:23], s69 offen offset:3072 lds
 v_mfma_f32_16x16x32_bf16 a[64:67], v[80:83], v[48:51], a[64:67]
 ds_read_b64_tr_b16 v[76:77], v111 offset:24576
 v_mfma_f32_16x16x32_bf16 a[68:71], v[80:83], v[52:55], a[68:71]
 v_mfma_f32_16x16x32_bf16 a[72:75], v[80:83], v[56:59], a[72:75]
 ds_read_b64_tr_b16 v[78:79], v111 offset:25088
 v_mfma_f32_16x16x32_bf16 a[76:79], v[80:83], v[60:63], a[76:79]
 s_waitcnt lgkmcnt(12)
 v_mfma_f32_16x16x32_bf16 a[92:95], v[84:87], v[60:63], a[92:95]
 s_add_u32 s69, s69, 128
 ds_read_b64_tr_b16 v[80:81], v108 offset:28672
 v_mfma_f32_16x16x32_bf16 a[88:91], v[84:87], v[56:59], a[88:91]
 v_mfma_f32_16x16x32_bf16 a[84:87], v[84:87], v[52:55], a[84:87]
 ds_read_b64_tr_b16 v[82:83], v108 offset:29184
 v_mfma_f32_16x16x32_bf16 a[80:83], v[84:87], v[48:51], a[80:83]
 s_waitcnt lgkmcnt(12)
 buffer_store_dwordx4 v[224:227], v21, s[36:39], s13 offen offset:0 sc1
 v_mfma_f32_16x16x32_bf16 a[96:99], v[88:91], v[48:51], a[96:99]
 ds_read_b64_tr_b16 v[84:85], v109 offset:28672
 v_mfma_f32_16x16x32_bf16 a[100:103], v[88:91], v[52:55], a[100:103]
 s_waitcnt vmcnt(25)
 ds_read_b128 v[32:35], v17 offset:0
 v_mfma_f32_16x16x32_bf16 a[104:107], v[88:91], v[56:59], a[104:107]
 ds_read_b64_tr_b16 v[86:87], v109 offset:29184
 v_mfma_f32_16x16x32_bf16 a[108:111], v[88:91], v[60:63], a[108:111]
 s_waitcnt lgkmcnt(13)
 buffer_store_dwordx4 v[228:231], v21, s[36:39], s13 offen offset:1024 sc1
 v_mfma_f32_16x16x32_bf16 a[124:127], v[92:95], v[60:63], a[124:127]
 ds_read_b64_tr_b16 v[88:89], v110 offset:28672
 v_mfma_f32_16x16x32_bf16 a[120:123], v[92:95], v[56:59], a[120:123]
 ds_read_b128 v[36:39], v17 offset:2048
 v_mfma_f32_16x16x32_bf16 a[116:119], v[92:95], v[52:55], a[116:119]
 ds_read_b64_tr_b16 v[90:91], v110 offset:29184
 v_mfma_f32_16x16x32_bf16 a[112:115], v[92:95], v[48:51], a[112:115]
 s_waitcnt lgkmcnt(14)
 ds_read_b128 v[40:43], v17 offset:4096
 v_mfma_f32_16x16x32_bf16 a[128:131], v[64:67], v[48:51], a[128:131]
 ds_read_b64_tr_b16 v[92:93], v111 offset:28672
 v_mfma_f32_16x16x32_bf16 a[132:135], v[64:67], v[52:55], a[132:135]
 ds_read_b128 v[44:47], v17 offset:6144
 v_mfma_f32_16x16x32_bf16 a[136:139], v[64:67], v[56:59], a[136:139]
 ds_read_b64_tr_b16 v[94:95], v111 offset:29184
 v_mfma_f32_16x16x32_bf16 a[140:143], v[64:67], v[60:63], a[140:143]
 s_waitcnt lgkmcnt(15)
 s_waitcnt vmcnt(20)
 s_barrier
 v_mfma_f32_16x16x32_bf16 a[156:159], v[68:71], v[60:63], a[156:159]
 s_add_u32 m0, s87, 0
 ds_read_b64_tr_b16 v[64:65], v13 offset:0
 v_mfma_f32_16x16x32_bf16 a[152:155], v[68:71], v[56:59], a[152:155]
 v_mfma_f32_16x16x32_bf16 a[148:151], v[68:71], v[52:55], a[148:151]
 ds_read_b64_tr_b16 v[66:67], v13 offset:512
 v_mfma_f32_16x16x32_bf16 a[144:147], v[68:71], v[48:51], a[144:147]
 s_waitcnt lgkmcnt(15)
 buffer_load_dwordx4 v9, s[24:27], s70 offen offset:0 lds
 v_mfma_f32_16x16x32_bf16 a[160:163], v[72:75], v[48:51], a[160:163]
 ds_read_b64_tr_b16 v[68:69], v14 offset:0
 v_mfma_f32_16x16x32_bf16 a[164:167], v[72:75], v[52:55], a[164:167]
 v_mfma_f32_16x16x32_bf16 a[168:171], v[72:75], v[56:59], a[168:171]
 ds_read_b64_tr_b16 v[70:71], v14 offset:512
 v_mfma_f32_16x16x32_bf16 a[172:175], v[72:75], v[60:63], a[172:175]
 s_waitcnt lgkmcnt(15)
 buffer_load_dwordx4 v10, s[24:27], s70 offen offset:1024 lds
 v_mfma_f32_16x16x32_bf16 a[188:191], v[76:79], v[60:63], a[188:191]
 ds_read_b64_tr_b16 v[72:73], v15 offset:0
 v_mfma_f32_16x16x32_bf16 a[184:187], v[76:79], v[56:59], a[184:187]
 v_mfma_f32_16x16x32_bf16 a[180:183], v[76:79], v[52:55], a[180:183]
 ds_read_b64_tr_b16 v[74:75], v15 offset:512
 v_mfma_f32_16x16x32_bf16 a[176:179], v[76:79], v[48:51], a[176:179]
 s_waitcnt lgkmcnt(15)
 buffer_load_dwordx4 v11, s[24:27], s70 offen offset:2048 lds
 v_mfma_f32_16x16x32_bf16 a[192:195], v[80:83], v[48:51], a[192:195]
 ds_read_b64_tr_b16 v[76:77], v16 offset:0
 v_mfma_f32_16x16x32_bf16 a[196:199], v[80:83], v[52:55], a[196:199]
 v_mfma_f32_16x16x32_bf16 a[200:203], v[80:83], v[56:59], a[200:203]
 ds_read_b64_tr_b16 v[78:79], v16 offset:512
 v_mfma_f32_16x16x32_bf16 a[204:207], v[80:83], v[60:63], a[204:207]
 s_waitcnt lgkmcnt(15)
 buffer_load_dwordx4 v12, s[24:27], s70 offen offset:3072 lds
 v_mfma_f32_16x16x32_bf16 a[220:223], v[84:87], v[60:63], a[220:223]
 ds_read_b64_tr_b16 v[80:81], v13 offset:4096
 v_mfma_f32_16x16x32_bf16 a[216:219], v[84:87], v[56:59], a[216:219]
 s_mov_b32 s75, s72
 v_mfma_f32_16x16x32_bf16 a[212:215], v[84:87], v[52:55], a[212:215]
 ds_read_b64_tr_b16 v[82:83], v13 offset:4608
 v_mfma_f32_16x16x32_bf16 a[208:211], v[84:87], v[48:51], a[208:211]
 s_waitcnt lgkmcnt(14)
 buffer_store_dwordx4 v[232:235], v21, s[36:39], s13 offen offset:2048 sc1
 v_mfma_f32_16x16x32_bf16 a[224:227], v[88:91], v[48:51], a[224:227]
 ds_read_b64_tr_b16 v[84:85], v14 offset:4096
 v_mfma_f32_16x16x32_bf16 a[228:231], v[88:91], v[52:55], a[228:231]
 s_mov_b32 s72, s73
 v_mfma_f32_16x16x32_bf16 a[232:235], v[88:91], v[56:59], a[232:235]
 ds_read_b64_tr_b16 v[86:87], v14 offset:4608
 v_mfma_f32_16x16x32_bf16 a[236:239], v[88:91], v[60:63], a[236:239]
 s_waitcnt lgkmcnt(12)
 buffer_store_dwordx4 v[236:239], v21, s[36:39], s13 offen offset:3072 sc1
 v_mfma_f32_16x16x32_bf16 a[252:255], v[92:95], v[60:63], a[252:255]
 ds_read_b64_tr_b16 v[88:89], v15 offset:4096
 v_mfma_f32_16x16x32_bf16 a[248:251], v[92:95], v[56:59], a[248:251]
 s_mov_b32 s73, s74
 v_mfma_f32_16x16x32_bf16 a[244:247], v[92:95], v[52:55], a[244:247]
 ds_read_b64_tr_b16 v[90:91], v15 offset:4608
 v_mfma_f32_16x16x32_bf16 a[240:243], v[92:95], v[48:51], a[240:243]
 s_add_u32 s70, s70, s71
 s_mov_b32 s74, s75
 s_waitcnt lgkmcnt(12)
 v_mfma_f32_16x16x32_bf16 a[0:3], v[64:67], v[32:35], a[0:3]
 ds_read_b64_tr_b16 v[92:93], v16 offset:4096
 v_mfma_f32_16x16x32_bf16 a[4:7], v[64:67], v[36:39], a[4:7]
 s_add_u32 m0, s72, s76
 v_mfma_f32_16x16x32_bf16 a[8:11], v[64:67], v[40:43], a[8:11]
 ds_read_b64_tr_b16 v[94:95], v16 offset:4608
 v_mfma_f32_16x16x32_bf16 a[12:15], v[64:67], v[44:47], a[12:15]
 s_waitcnt lgkmcnt(12)
 buffer_load_dwordx4 v1, s[20:23], s69 offen offset:0 lds
 v_mfma_f32_16x16x32_bf16 a[28:31], v[68:71], v[44:47], a[28:31]
 ds_read_b64_tr_b16 v[64:65], v13 offset:8192
 v_mfma_f32_16x16x32_bf16 a[24:27], v[68:71], v[40:43], a[24:27]
 v_add_u32 v18, s73, v20
 v_mfma_f32_16x16x32_bf16 a[20:23], v[68:71], v[36:39], a[20:23]
 ds_read_b64_tr_b16 v[66:67], v13 offset:8704
 v_mfma_f32_16x16x32_bf16 a[16:19], v[68:71], v[32:35], a[16:19]
 s_waitcnt lgkmcnt(12)
 buffer_load_dwordx4 v2, s[20:23], s69 offen offset:1024 lds
 v_mfma_f32_16x16x32_bf16 a[32:35], v[72:75], v[32:35], a[32:35]
 ds_read_b64_tr_b16 v[68:69], v14 offset:8192
 v_mfma_f32_16x16x32_bf16 a[36:39], v[72:75], v[36:39], a[36:39]
 v_mfma_f32_16x16x32_bf16 a[40:43], v[72:75], v[40:43], a[40:43]
 ds_read_b64_tr_b16 v[70:71], v14 offset:8704
 v_mfma_f32_16x16x32_bf16 a[44:47], v[72:75], v[44:47], a[44:47]
 s_waitcnt lgkmcnt(12)
 buffer_load_dwordx4 v3, s[20:23], s69 offen offset:2048 lds
 v_mfma_f32_16x16x32_bf16 a[60:63], v[76:79], v[44:47], a[60:63]
 ds_read_b64_tr_b16 v[72:73], v15 offset:8192
 v_mfma_f32_16x16x32_bf16 a[56:59], v[76:79], v[40:43], a[56:59]
 v_mfma_f32_16x16x32_bf16 a[52:55], v[76:79], v[36:39], a[52:55]
 ds_read_b64_tr_b16 v[74:75], v15 offset:8704
 v_mfma_f32_16x16x32_bf16 a[48:51], v[76:79], v[32:35], a[48:51]
 s_waitcnt lgkmcnt(12)
 buffer_load_dwordx4 v4, s[20:23], s69 offen offset:3072 lds
 v_mfma_f32_16x16x32_bf16 a[64:67], v[80:83], v[32:35], a[64:67]
 ds_read_b64_tr_b16 v[76:77], v16 offset:8192
 v_mfma_f32_16x16x32_bf16 a[68:71], v[80:83], v[36:39], a[68:71]
 v_mfma_f32_16x16x32_bf16 a[72:75], v[80:83], v[40:43], a[72:75]
 ds_read_b64_tr_b16 v[78:79], v16 offset:8704
 v_mfma_f32_16x16x32_bf16 a[76:79], v[80:83], v[44:47], a[76:79]
 s_waitcnt lgkmcnt(12)
 v_mfma_f32_16x16x32_bf16 a[92:95], v[84:87], v[44:47], a[92:95]
 ds_read_b64_tr_b16 v[80:81], v13 offset:12288
 v_mfma_f32_16x16x32_bf16 a[88:91], v[84:87], v[40:43], a[88:91]
 v_mfma_f32_16x16x32_bf16 a[84:87], v[84:87], v[36:39], a[84:87]
 ds_read_b64_tr_b16 v[82:83], v13 offset:12800
 v_mfma_f32_16x16x32_bf16 a[80:83], v[84:87], v[32:35], a[80:83]
 s_waitcnt lgkmcnt(12)
 v_mfma_f32_16x16x32_bf16 a[96:99], v[88:91], v[32:35], a[96:99]
 ds_read_b64_tr_b16 v[84:85], v14 offset:12288
 v_mfma_f32_16x16x32_bf16 a[100:103], v[88:91], v[36:39], a[100:103]
 ds_read_b128 v[48:51], v18 offset:0
 v_mfma_f32_16x16x32_bf16 a[104:107], v[88:91], v[40:43], a[104:107]
 ds_read_b64_tr_b16 v[86:87], v14 offset:12800
 v_mfma_f32_16x16x32_bf16 a[108:111], v[88:91], v[44:47], a[108:111]
 s_waitcnt lgkmcnt(13)
 v_mfma_f32_16x16x32_bf16 a[124:127], v[92:95], v[44:47], a[124:127]
 ds_read_b64_tr_b16 v[88:89], v15 offset:12288
 v_mfma_f32_16x16x32_bf16 a[120:123], v[92:95], v[40:43], a[120:123]
 ds_read_b128 v[52:55], v18 offset:2048
 v_mfma_f32_16x16x32_bf16 a[116:119], v[92:95], v[36:39], a[116:119]
 ds_read_b64_tr_b16 v[90:91], v15 offset:12800
 v_mfma_f32_16x16x32_bf16 a[112:115], v[92:95], v[32:35], a[112:115]
 s_waitcnt lgkmcnt(14)
 ds_read_b128 v[56:59], v18 offset:4096
 v_mfma_f32_16x16x32_bf16 a[128:131], v[64:67], v[32:35], a[128:131]
 ds_read_b64_tr_b16 v[92:93], v16 offset:12288
 v_mfma_f32_16x16x32_bf16 a[132:135], v[64:67], v[36:39], a[132:135]
 ds_read_b128 v[60:63], v18 offset:6144
 v_mfma_f32_16x16x32_bf16 a[136:139], v[64:67], v[40:43], a[136:139]
 ds_read_b64_tr_b16 v[94:95], v16 offset:12800
 v_mfma_f32_16x16x32_bf16 a[140:143], v[64:67], v[44:47], a[140:143]
 s_waitcnt lgkmcnt(15)
 s_waitcnt vmcnt(18)
 s_barrier
 v_mfma_f32_16x16x32_bf16 a[156:159], v[68:71], v[44:47], a[156:159]
 s_add_u32 m0, s87, 16384
 ds_read_b64_tr_b16 v[64:65], v13 offset:16384
 v_mfma_f32_16x16x32_bf16 a[152:155], v[68:71], v[40:43], a[152:155]
 v_mfma_f32_16x16x32_bf16 a[148:151], v[68:71], v[36:39], a[148:151]
 ds_read_b64_tr_b16 v[66:67], v13 offset:16896
 v_mfma_f32_16x16x32_bf16 a[144:147], v[68:71], v[32:35], a[144:147]
 s_waitcnt lgkmcnt(15)
 buffer_load_dwordx4 v9, s[24:27], s70 offen offset:0 lds
 v_mfma_f32_16x16x32_bf16 a[160:163], v[72:75], v[32:35], a[160:163]
 ds_read_b64_tr_b16 v[68:69], v14 offset:16384
 v_mfma_f32_16x16x32_bf16 a[164:167], v[72:75], v[36:39], a[164:167]
 v_mfma_f32_16x16x32_bf16 a[168:171], v[72:75], v[40:43], a[168:171]
 ds_read_b64_tr_b16 v[70:71], v14 offset:16896
 v_mfma_f32_16x16x32_bf16 a[172:175], v[72:75], v[44:47], a[172:175]
 s_waitcnt lgkmcnt(15)
 buffer_load_dwordx4 v10, s[24:27], s70 offen offset:1024 lds
 v_mfma_f32_16x16x32_bf16 a[188:191], v[76:79], v[44:47], a[188:191]
 ds_read_b64_tr_b16 v[72:73], v15 offset:16384
 v_mfma_f32_16x16x32_bf16 a[184:187], v[76:79], v[40:43], a[184:187]
 v_mfma_f32_16x16x32_bf16 a[180:183], v[76:79], v[36:39], a[180:183]
 ds_read_b64_tr_b16 v[74:75], v15 offset:16896
 v_mfma_f32_16x16x32_bf16 a[176:179], v[76:79], v[32:35], a[176:179]
 s_waitcnt lgkmcnt(15)
 buffer_load_dwordx4 v11, s[24:27], s70 offen offset:2048 lds
 v_mfma_f32_16x16x32_bf16 a[192:195], v[80:83], v[32:35], a[192:195]
 ds_read_b64_tr_b16 v[76:77], v16 offset:16384
 v_mfma_f32_16x16x32_bf16 a[196:199], v[80:83], v[36:39], a[196:199]
 v_mfma_f32_16x16x32_bf16 a[200:203], v[80:83], v[40:43], a[200:203]
 ds_read_b64_tr_b16 v[78:79], v16 offset:16896
 v_mfma_f32_16x16x32_bf16 a[204:207], v[80:83], v[44:47], a[204:207]
 s_waitcnt lgkmcnt(15)
 buffer_load_dwordx4 v12, s[24:27], s70 offen offset:3072 lds
 v_mfma_f32_16x16x32_bf16 a[220:223], v[84:87], v[44:47], a[220:223]
 ds_read_b64_tr_b16 v[80:81], v13 offset:20480
 v_mfma_f32_16x16x32_bf16 a[216:219], v[84:87], v[40:43], a[216:219]
 v_mfma_f32_16x16x32_bf16 a[212:215], v[84:87], v[36:39], a[212:215]
 ds_read_b64_tr_b16 v[82:83], v13 offset:20992
 v_mfma_f32_16x16x32_bf16 a[208:211], v[84:87], v[32:35], a[208:211]
 s_waitcnt lgkmcnt(14)
 v_mfma_f32_16x16x32_bf16 a[224:227], v[88:91], v[32:35], a[224:227]
 ds_read_b64_tr_b16 v[84:85], v14 offset:20480
 v_mfma_f32_16x16x32_bf16 a[228:231], v[88:91], v[36:39], a[228:231]
 v_mfma_f32_16x16x32_bf16 a[232:235], v[88:91], v[40:43], a[232:235]
 ds_read_b64_tr_b16 v[86:87], v14 offset:20992
 v_mfma_f32_16x16x32_bf16 a[236:239], v[88:91], v[44:47], a[236:239]
 s_waitcnt lgkmcnt(12)
 v_mfma_f32_16x16x32_bf16 a[252:255], v[92:95], v[44:47], a[252:255]
 ds_read_b64_tr_b16 v[88:89], v15 offset:20480
 v_mfma_f32_16x16x32_bf16 a[248:251], v[92:95], v[40:43], a[248:251]
 v_mfma_f32_16x16x32_bf16 a[244:247], v[92:95], v[36:39], a[244:247]
 ds_read_b64_tr_b16 v[90:91], v15 offset:20992
 v_mfma_f32_16x16x32_bf16 a[240:243], v[92:95], v[32:35], a[240:243]
 s_add_u32 s70, s70, s71
 s_waitcnt lgkmcnt(12)
 v_mfma_f32_16x16x32_bf16 a[0:3], v[64:67], v[48:51], a[0:3]
 ds_read_b64_tr_b16 v[92:93], v16 offset:20480
 v_mfma_f32_16x16x32_bf16 a[4:7], v[64:67], v[52:55], a[4:7]
 s_add_u32 m0, s72, s77
 v_mfma_f32_16x16x32_bf16 a[8:11], v[64:67], v[56:59], a[8:11]
 ds_read_b64_tr_b16 v[94:95], v16 offset:20992
 v_mfma_f32_16x16x32_bf16 a[12:15], v[64:67], v[60:63], a[12:15]
 s_waitcnt lgkmcnt(12)
 buffer_load_dwordx4 v5, s[20:23], s69 offen offset:0 lds
 v_mfma_f32_16x16x32_bf16 a[28:31], v[68:71], v[60:63], a[28:31]
 ds_read_b64_tr_b16 v[64:65], v13 offset:24576
 v_mfma_f32_16x16x32_bf16 a[24:27], v[68:71], v[56:59], a[24:27]
 v_add_u32 v17, s74, v19
 v_mfma_f32_16x16x32_bf16 a[20:23], v[68:71], v[52:55], a[20:23]
 ds_read_b64_tr_b16 v[66:67], v13 offset:25088
 v_mfma_f32_16x16x32_bf16 a[16:19], v[68:71], v[48:51], a[16:19]
 s_waitcnt lgkmcnt(12)
 buffer_load_dwordx4 v6, s[20:23], s69 offen offset:1024 lds
 v_mfma_f32_16x16x32_bf16 a[32:35], v[72:75], v[48:51], a[32:35]
 ds_read_b64_tr_b16 v[68:69], v14 offset:24576
 v_mfma_f32_16x16x32_bf16 a[36:39], v[72:75], v[52:55], a[36:39]
 v_mfma_f32_16x16x32_bf16 a[40:43], v[72:75], v[56:59], a[40:43]
 ds_read_b64_tr_b16 v[70:71], v14 offset:25088
 v_mfma_f32_16x16x32_bf16 a[44:47], v[72:75], v[60:63], a[44:47]
 s_waitcnt lgkmcnt(12)
 buffer_load_dwordx4 v7, s[20:23], s69 offen offset:2048 lds
 v_mfma_f32_16x16x32_bf16 a[60:63], v[76:79], v[60:63], a[60:63]
 ds_read_b64_tr_b16 v[72:73], v15 offset:24576
 v_mfma_f32_16x16x32_bf16 a[56:59], v[76:79], v[56:59], a[56:59]
 v_mfma_f32_16x16x32_bf16 a[52:55], v[76:79], v[52:55], a[52:55]
 ds_read_b64_tr_b16 v[74:75], v15 offset:25088
 v_mfma_f32_16x16x32_bf16 a[48:51], v[76:79], v[48:51], a[48:51]
 s_waitcnt lgkmcnt(12)
 buffer_load_dwordx4 v8, s[20:23], s69 offen offset:3072 lds
 v_mfma_f32_16x16x32_bf16 a[64:67], v[80:83], v[48:51], a[64:67]
 ds_read_b64_tr_b16 v[76:77], v16 offset:24576
 v_mfma_f32_16x16x32_bf16 a[68:71], v[80:83], v[52:55], a[68:71]
 v_mfma_f32_16x16x32_bf16 a[72:75], v[80:83], v[56:59], a[72:75]
 ds_read_b64_tr_b16 v[78:79], v16 offset:25088
 v_mfma_f32_16x16x32_bf16 a[76:79], v[80:83], v[60:63], a[76:79]
 s_waitcnt lgkmcnt(12)
 v_mfma_f32_16x16x32_bf16 a[92:95], v[84:87], v[60:63], a[92:95]
 s_add_u32 s69, s69, 128
 ds_read_b64_tr_b16 v[80:81], v13 offset:28672
 v_mfma_f32_16x16x32_bf16 a[88:91], v[84:87], v[56:59], a[88:91]
 v_mfma_f32_16x16x32_bf16 a[84:87], v[84:87], v[52:55], a[84:87]
 ds_read_b64_tr_b16 v[82:83], v13 offset:29184
 v_mfma_f32_16x16x32_bf16 a[80:83], v[84:87], v[48:51], a[80:83]
 s_waitcnt lgkmcnt(12)
 v_mfma_f32_16x16x32_bf16 a[96:99], v[88:91], v[48:51], a[96:99]
 ds_read_b64_tr_b16 v[84:85], v14 offset:28672
 v_mfma_f32_16x16x32_bf16 a[100:103], v[88:91], v[52:55], a[100:103]
 s_waitcnt vmcnt(20)
 ds_read_b128 v[32:35], v17 offset:0
 v_mfma_f32_16x16x32_bf16 a[104:107], v[88:91], v[56:59], a[104:107]
 ds_read_b64_tr_b16 v[86:87], v14 offset:29184
 v_mfma_f32_16x16x32_bf16 a[108:111], v[88:91], v[60:63], a[108:111]
 s_waitcnt lgkmcnt(13)
 v_mfma_f32_16x16x32_bf16 a[124:127], v[92:95], v[60:63], a[124:127]
 ds_read_b64_tr_b16 v[88:89], v15 offset:28672
 v_mfma_f32_16x16x32_bf16 a[120:123], v[92:95], v[56:59], a[120:123]
 ds_read_b128 v[36:39], v17 offset:2048
 v_mfma_f32_16x16x32_bf16 a[116:119], v[92:95], v[52:55], a[116:119]
 ds_read_b64_tr_b16 v[90:91], v15 offset:29184
 v_mfma_f32_16x16x32_bf16 a[112:115], v[92:95], v[48:51], a[112:115]
 s_waitcnt lgkmcnt(14)
 ds_read_b128 v[40:43], v17 offset:4096
 v_mfma_f32_16x16x32_bf16 a[128:131], v[64:67], v[48:51], a[128:131]
 ds_read_b64_tr_b16 v[92:93], v16 offset:28672
 v_mfma_f32_16x16x32_bf16 a[132:135], v[64:67], v[52:55], a[132:135]
 ds_read_b128 v[44:47], v17 offset:6144
 v_mfma_f32_16x16x32_bf16 a[136:139], v[64:67], v[56:59], a[136:139]
 ds_read_b64_tr_b16 v[94:95], v16 offset:29184
 v_mfma_f32_16x16x32_bf16 a[140:143], v[64:67], v[60:63], a[140:143]
 s_waitcnt lgkmcnt(15)
 s_waitcnt vmcnt(12)
 s_barrier
 v_mfma_f32_16x16x32_bf16 a[156:159], v[68:71], v[60:63], a[156:159]
 s_add_u32 m0, s78, 0
 ds_read_b64_tr_b16 v[64:65], v108 offset:0
 v_mfma_f32_16x16x32_bf16 a[152:155], v[68:71], v[56:59], a[152:155]
 v_mfma_f32_16x16x32_bf16 a[148:151], v[68:71], v[52:55], a[148:151]
 ds_read_b64_tr_b16 v[66:67], v108 offset:512
 v_mfma_f32_16x16x32_bf16 a[144:147], v[68:71], v[48:51], a[144:147]
 s_waitcnt lgkmcnt(15)
 buffer_load_dwordx4 v9, s[24:27], s70 offen offset:0 lds
 v_mfma_f32_16x16x32_bf16 a[160:163], v[72:75], v[48:51], a[160:163]
 ds_read_b64_tr_b16 v[68:69], v109 offset:0
 v_mfma_f32_16x16x32_bf16 a[164:167], v[72:75], v[52:55], a[164:167]
 v_mfma_f32_16x16x32_bf16 a[168:171], v[72:75], v[56:59], a[168:171]
 ds_read_b64_tr_b16 v[70:71], v109 offset:512
 v_mfma_f32_16x16x32_bf16 a[172:175], v[72:75], v[60:63], a[172:175]
 s_waitcnt lgkmcnt(15)
 buffer_load_dwordx4 v10, s[24:27], s70 offen offset:1024 lds
 v_mfma_f32_16x16x32_bf16 a[188:191], v[76:79], v[60:63], a[188:191]
 ds_read_b64_tr_b16 v[72:73], v110 offset:0
 v_mfma_f32_16x16x32_bf16 a[184:187], v[76:79], v[56:59], a[184:187]
 v_mfma_f32_16x16x32_bf16 a[180:183], v[76:79], v[52:55], a[180:183]
 ds_read_b64_tr_b16 v[74:75], v110 offset:512
 v_mfma_f32_16x16x32_bf16 a[176:179], v[76:79], v[48:51], a[176:179]
 s_waitcnt lgkmcnt(15)
 buffer_load_dwordx4 v11, s[24:27], s70 offen offset:2048 lds
 v_mfma_f32_16x16x32_bf16 a[192:195], v[80:83], v[48:51], a[192:195]
 ds_read_b64_tr_b16 v[76:77], v111 offset:0
 v_mfma_f32_16x16x32_bf16 a[196:199], v[80:83], v[52:55], a[196:199]
 v_mfma_f32_16x16x32_bf16 a[200:203], v[80:83], v[56:59], a[200:203]
 ds_read_b64_tr_b16 v[78:79], v111 offset:512
 v_mfma_f32_16x16x32_bf16 a[204:207], v[80:83], v[60:63], a[204:207]
 s_waitcnt lgkmcnt(15)
 buffer_load_dwordx4 v12, s[24:27], s70 offen offset:3072 lds
 v_mfma_f32_16x16x32_bf16 a[220:223], v[84:87], v[60:63], a[220:223]
 ds_read_b64_tr_b16 v[80:81], v108 offset:4096
 v_mfma_f32_16x16x32_bf16 a[216:219], v[84:87], v[56:59], a[216:219]
 s_mov_b32 s75, s72
 v_mfma_f32_16x16x32_bf16 a[212:215], v[84:87], v[52:55], a[212:215]
 ds_read_b64_tr_b16 v[82:83], v108 offset:4608
 v_mfma_f32_16x16x32_bf16 a[208:211], v[84:87], v[48:51], a[208:211]
 s_waitcnt lgkmcnt(14)
 v_mfma_f32_16x16x32_bf16 a[224:227], v[88:91], v[48:51], a[224:227]
 ds_read_b64_tr_b16 v[84:85], v109 offset:4096
 v_mfma_f32_16x16x32_bf16 a[228:231], v[88:91], v[52:55], a[228:231]
 s_mov_b32 s72, s73
 v_mfma_f32_16x16x32_bf16 a[232:235], v[88:91], v[56:59], a[232:235]
 ds_read_b64_tr_b16 v[86:87], v109 offset:4608
 v_mfma_f32_16x16x32_bf16 a[236:239], v[88:91], v[60:63], a[236:239]
 s_waitcnt lgkmcnt(12)
 v_mfma_f32_16x16x32_bf16 a[252:255], v[92:95], v[60:63], a[252:255]
 ds_read_b64_tr_b16 v[88:89], v110 offset:4096
 v_mfma_f32_16x16x32_bf16 a[248:251], v[92:95], v[56:59], a[248:251]
 s_mov_b32 s73, s74
 v_mfma_f32_16x16x32_bf16 a[244:247], v[92:95], v[52:55], a[244:247]
 ds_read_b64_tr_b16 v[90:91], v110 offset:4608
 v_mfma_f32_16x16x32_bf16 a[240:243], v[92:95], v[48:51], a[240:243]
 s_add_u32 s70, s70, s71
 s_mov_b32 s74, s75
 s_cmp_lg_u32 s68, 0
 s_cbranch_scc1 gated_mix__compressed_kv_cla__glu_gated_swiglu__prompt_kernel_sig17
 s_mov_b64 exec, 1
 buffer_store_dwordx2 v[28:29], v21, s[36:39], s14 offen sc1
 s_mov_b64 exec, -1
gated_mix__compressed_kv_cla__glu_gated_swiglu__prompt_kernel_sig17:
 s_waitcnt lgkmcnt(12)
 v_mfma_f32_16x16x32_bf16 a[0:3], v[64:67], v[32:35], a[0:3]
 ds_read_b64_tr_b16 v[92:93], v111 offset:4096
 v_mfma_f32_16x16x32_bf16 a[4:7], v[64:67], v[36:39], a[4:7]
 v_mfma_f32_16x16x32_bf16 a[8:11], v[64:67], v[40:43], a[8:11]
 ds_read_b64_tr_b16 v[94:95], v111 offset:4608
 v_mfma_f32_16x16x32_bf16 a[12:15], v[64:67], v[44:47], a[12:15]
 s_waitcnt lgkmcnt(12)
 v_mfma_f32_16x16x32_bf16 a[28:31], v[68:71], v[44:47], a[28:31]
 ds_read_b64_tr_b16 v[64:65], v108 offset:8192
 v_mfma_f32_16x16x32_bf16 a[24:27], v[68:71], v[40:43], a[24:27]
 v_add_u32 v18, s73, v20
 v_mfma_f32_16x16x32_bf16 a[20:23], v[68:71], v[36:39], a[20:23]
 ds_read_b64_tr_b16 v[66:67], v108 offset:8704
 v_mfma_f32_16x16x32_bf16 a[16:19], v[68:71], v[32:35], a[16:19]
 s_waitcnt lgkmcnt(12)
 v_mfma_f32_16x16x32_bf16 a[32:35], v[72:75], v[32:35], a[32:35]
 ds_read_b64_tr_b16 v[68:69], v109 offset:8192
 v_mfma_f32_16x16x32_bf16 a[36:39], v[72:75], v[36:39], a[36:39]
 v_mfma_f32_16x16x32_bf16 a[40:43], v[72:75], v[40:43], a[40:43]
 ds_read_b64_tr_b16 v[70:71], v109 offset:8704
 v_mfma_f32_16x16x32_bf16 a[44:47], v[72:75], v[44:47], a[44:47]
 s_waitcnt lgkmcnt(12)
 v_mfma_f32_16x16x32_bf16 a[60:63], v[76:79], v[44:47], a[60:63]
 ds_read_b64_tr_b16 v[72:73], v110 offset:8192
 v_mfma_f32_16x16x32_bf16 a[56:59], v[76:79], v[40:43], a[56:59]
 v_mfma_f32_16x16x32_bf16 a[52:55], v[76:79], v[36:39], a[52:55]
 ds_read_b64_tr_b16 v[74:75], v110 offset:8704
 v_mfma_f32_16x16x32_bf16 a[48:51], v[76:79], v[32:35], a[48:51]
 s_waitcnt lgkmcnt(12)
 v_mfma_f32_16x16x32_bf16 a[64:67], v[80:83], v[32:35], a[64:67]
 ds_read_b64_tr_b16 v[76:77], v111 offset:8192
 v_mfma_f32_16x16x32_bf16 a[68:71], v[80:83], v[36:39], a[68:71]
 v_mfma_f32_16x16x32_bf16 a[72:75], v[80:83], v[40:43], a[72:75]
 ds_read_b64_tr_b16 v[78:79], v111 offset:8704
 v_mfma_f32_16x16x32_bf16 a[76:79], v[80:83], v[44:47], a[76:79]
 s_waitcnt lgkmcnt(12)
 v_mfma_f32_16x16x32_bf16 a[92:95], v[84:87], v[44:47], a[92:95]
 ds_read_b64_tr_b16 v[80:81], v108 offset:12288
 v_mfma_f32_16x16x32_bf16 a[88:91], v[84:87], v[40:43], a[88:91]
 v_mfma_f32_16x16x32_bf16 a[84:87], v[84:87], v[36:39], a[84:87]
 ds_read_b64_tr_b16 v[82:83], v108 offset:12800
 v_mfma_f32_16x16x32_bf16 a[80:83], v[84:87], v[32:35], a[80:83]
 s_waitcnt lgkmcnt(12)
 v_mfma_f32_16x16x32_bf16 a[96:99], v[88:91], v[32:35], a[96:99]
 ds_read_b64_tr_b16 v[84:85], v109 offset:12288
 v_mfma_f32_16x16x32_bf16 a[100:103], v[88:91], v[36:39], a[100:103]
 ds_read_b128 v[48:51], v18 offset:0
 v_mfma_f32_16x16x32_bf16 a[104:107], v[88:91], v[40:43], a[104:107]
 ds_read_b64_tr_b16 v[86:87], v109 offset:12800
 v_mfma_f32_16x16x32_bf16 a[108:111], v[88:91], v[44:47], a[108:111]
 s_waitcnt lgkmcnt(13)
 v_mfma_f32_16x16x32_bf16 a[124:127], v[92:95], v[44:47], a[124:127]
 ds_read_b64_tr_b16 v[88:89], v110 offset:12288
 v_mfma_f32_16x16x32_bf16 a[120:123], v[92:95], v[40:43], a[120:123]
 ds_read_b128 v[52:55], v18 offset:2048
 v_mfma_f32_16x16x32_bf16 a[116:119], v[92:95], v[36:39], a[116:119]
 ds_read_b64_tr_b16 v[90:91], v110 offset:12800
 v_mfma_f32_16x16x32_bf16 a[112:115], v[92:95], v[32:35], a[112:115]
 s_waitcnt lgkmcnt(14)
 ds_read_b128 v[56:59], v18 offset:4096
 v_mfma_f32_16x16x32_bf16 a[128:131], v[64:67], v[32:35], a[128:131]
 ds_read_b64_tr_b16 v[92:93], v111 offset:12288
 v_mfma_f32_16x16x32_bf16 a[132:135], v[64:67], v[36:39], a[132:135]
 ds_read_b128 v[60:63], v18 offset:6144
 v_mfma_f32_16x16x32_bf16 a[136:139], v[64:67], v[40:43], a[136:139]
 ds_read_b64_tr_b16 v[94:95], v111 offset:12800
 v_mfma_f32_16x16x32_bf16 a[140:143], v[64:67], v[44:47], a[140:143]
 s_waitcnt lgkmcnt(15)
 s_waitcnt vmcnt(8)
 s_barrier
 v_mfma_f32_16x16x32_bf16 a[156:159], v[68:71], v[44:47], a[156:159]
 s_add_u32 m0, s78, 16384
 ds_read_b64_tr_b16 v[64:65], v108 offset:16384
 v_mfma_f32_16x16x32_bf16 a[152:155], v[68:71], v[40:43], a[152:155]
 v_mfma_f32_16x16x32_bf16 a[148:151], v[68:71], v[36:39], a[148:151]
 ds_read_b64_tr_b16 v[66:67], v108 offset:16896
 v_mfma_f32_16x16x32_bf16 a[144:147], v[68:71], v[32:35], a[144:147]
 s_waitcnt lgkmcnt(15)
 buffer_load_dwordx4 v9, s[24:27], s70 offen offset:0 lds
 v_mfma_f32_16x16x32_bf16 a[160:163], v[72:75], v[32:35], a[160:163]
 ds_read_b64_tr_b16 v[68:69], v109 offset:16384
 v_mfma_f32_16x16x32_bf16 a[164:167], v[72:75], v[36:39], a[164:167]
 v_mfma_f32_16x16x32_bf16 a[168:171], v[72:75], v[40:43], a[168:171]
 ds_read_b64_tr_b16 v[70:71], v109 offset:16896
 v_mfma_f32_16x16x32_bf16 a[172:175], v[72:75], v[44:47], a[172:175]
 s_waitcnt lgkmcnt(15)
 buffer_load_dwordx4 v10, s[24:27], s70 offen offset:1024 lds
 v_mfma_f32_16x16x32_bf16 a[188:191], v[76:79], v[44:47], a[188:191]
 ds_read_b64_tr_b16 v[72:73], v110 offset:16384
 v_mfma_f32_16x16x32_bf16 a[184:187], v[76:79], v[40:43], a[184:187]
 v_mfma_f32_16x16x32_bf16 a[180:183], v[76:79], v[36:39], a[180:183]
 ds_read_b64_tr_b16 v[74:75], v110 offset:16896
 v_mfma_f32_16x16x32_bf16 a[176:179], v[76:79], v[32:35], a[176:179]
 s_waitcnt lgkmcnt(15)
 buffer_load_dwordx4 v11, s[24:27], s70 offen offset:2048 lds
 v_mfma_f32_16x16x32_bf16 a[192:195], v[80:83], v[32:35], a[192:195]
 ds_read_b64_tr_b16 v[76:77], v111 offset:16384
 v_mfma_f32_16x16x32_bf16 a[196:199], v[80:83], v[36:39], a[196:199]
 v_mfma_f32_16x16x32_bf16 a[200:203], v[80:83], v[40:43], a[200:203]
 ds_read_b64_tr_b16 v[78:79], v111 offset:16896
 v_mfma_f32_16x16x32_bf16 a[204:207], v[80:83], v[44:47], a[204:207]
 s_waitcnt lgkmcnt(15)
 buffer_load_dwordx4 v12, s[24:27], s70 offen offset:3072 lds
 v_mfma_f32_16x16x32_bf16 a[220:223], v[84:87], v[44:47], a[220:223]
 ds_read_b64_tr_b16 v[80:81], v108 offset:20480
 v_mfma_f32_16x16x32_bf16 a[216:219], v[84:87], v[40:43], a[216:219]
 v_mfma_f32_16x16x32_bf16 a[212:215], v[84:87], v[36:39], a[212:215]
 ds_read_b64_tr_b16 v[82:83], v108 offset:20992
 v_mfma_f32_16x16x32_bf16 a[208:211], v[84:87], v[32:35], a[208:211]
 s_waitcnt lgkmcnt(14)
 v_mfma_f32_16x16x32_bf16 a[224:227], v[88:91], v[32:35], a[224:227]
 ds_read_b64_tr_b16 v[84:85], v109 offset:20480
 v_mfma_f32_16x16x32_bf16 a[228:231], v[88:91], v[36:39], a[228:231]
 v_mfma_f32_16x16x32_bf16 a[232:235], v[88:91], v[40:43], a[232:235]
 ds_read_b64_tr_b16 v[86:87], v109 offset:20992
 v_mfma_f32_16x16x32_bf16 a[236:239], v[88:91], v[44:47], a[236:239]
 s_waitcnt lgkmcnt(12)
 v_mfma_f32_16x16x32_bf16 a[252:255], v[92:95], v[44:47], a[252:255]
 ds_read_b64_tr_b16 v[88:89], v110 offset:20480
 v_mfma_f32_16x16x32_bf16 a[248:251], v[92:95], v[40:43], a[248:251]
 v_mfma_f32_16x16x32_bf16 a[244:247], v[92:95], v[36:39], a[244:247]
 ds_read_b64_tr_b16 v[90:91], v110 offset:20992
 v_mfma_f32_16x16x32_bf16 a[240:243], v[92:95], v[32:35], a[240:243]
 s_add_u32 s70, s70, s71
 s_waitcnt lgkmcnt(12)
 v_mfma_f32_16x16x32_bf16 a[0:3], v[64:67], v[48:51], a[0:3]
 ds_read_b64_tr_b16 v[92:93], v111 offset:20480
 v_mfma_f32_16x16x32_bf16 a[4:7], v[64:67], v[52:55], a[4:7]
 v_mfma_f32_16x16x32_bf16 a[8:11], v[64:67], v[56:59], a[8:11]
 ds_read_b64_tr_b16 v[94:95], v111 offset:20992
 v_mfma_f32_16x16x32_bf16 a[12:15], v[64:67], v[60:63], a[12:15]
 s_waitcnt lgkmcnt(12)
 v_mfma_f32_16x16x32_bf16 a[28:31], v[68:71], v[60:63], a[28:31]
 ds_read_b64_tr_b16 v[64:65], v108 offset:24576
 v_mfma_f32_16x16x32_bf16 a[24:27], v[68:71], v[56:59], a[24:27]
 v_add_u32 v17, s74, v19
 v_mfma_f32_16x16x32_bf16 a[20:23], v[68:71], v[52:55], a[20:23]
 ds_read_b64_tr_b16 v[66:67], v108 offset:25088
 v_mfma_f32_16x16x32_bf16 a[16:19], v[68:71], v[48:51], a[16:19]
 s_waitcnt lgkmcnt(12)
 v_mfma_f32_16x16x32_bf16 a[32:35], v[72:75], v[48:51], a[32:35]
 ds_read_b64_tr_b16 v[68:69], v109 offset:24576
 v_mfma_f32_16x16x32_bf16 a[36:39], v[72:75], v[52:55], a[36:39]
 v_mfma_f32_16x16x32_bf16 a[40:43], v[72:75], v[56:59], a[40:43]
 ds_read_b64_tr_b16 v[70:71], v109 offset:25088
 v_mfma_f32_16x16x32_bf16 a[44:47], v[72:75], v[60:63], a[44:47]
 s_waitcnt lgkmcnt(12)
 v_mfma_f32_16x16x32_bf16 a[60:63], v[76:79], v[60:63], a[60:63]
 ds_read_b64_tr_b16 v[72:73], v110 offset:24576
 v_mfma_f32_16x16x32_bf16 a[56:59], v[76:79], v[56:59], a[56:59]
 v_mfma_f32_16x16x32_bf16 a[52:55], v[76:79], v[52:55], a[52:55]
 ds_read_b64_tr_b16 v[74:75], v110 offset:25088
 v_mfma_f32_16x16x32_bf16 a[48:51], v[76:79], v[48:51], a[48:51]
 s_waitcnt lgkmcnt(12)
 v_mfma_f32_16x16x32_bf16 a[64:67], v[80:83], v[48:51], a[64:67]
 ds_read_b64_tr_b16 v[76:77], v111 offset:24576
 v_mfma_f32_16x16x32_bf16 a[68:71], v[80:83], v[52:55], a[68:71]
 v_mfma_f32_16x16x32_bf16 a[72:75], v[80:83], v[56:59], a[72:75]
 ds_read_b64_tr_b16 v[78:79], v111 offset:25088
 v_mfma_f32_16x16x32_bf16 a[76:79], v[80:83], v[60:63], a[76:79]
 s_waitcnt lgkmcnt(12)
 v_mfma_f32_16x16x32_bf16 a[92:95], v[84:87], v[60:63], a[92:95]
 ds_read_b64_tr_b16 v[80:81], v108 offset:28672
 v_mfma_f32_16x16x32_bf16 a[88:91], v[84:87], v[56:59], a[88:91]
 v_mfma_f32_16x16x32_bf16 a[84:87], v[84:87], v[52:55], a[84:87]
 ds_read_b64_tr_b16 v[82:83], v108 offset:29184
 v_mfma_f32_16x16x32_bf16 a[80:83], v[84:87], v[48:51], a[80:83]
 s_waitcnt lgkmcnt(12)
 v_mfma_f32_16x16x32_bf16 a[96:99], v[88:91], v[48:51], a[96:99]
 ds_read_b64_tr_b16 v[84:85], v109 offset:28672
 v_mfma_f32_16x16x32_bf16 a[100:103], v[88:91], v[52:55], a[100:103]
 s_waitcnt vmcnt(8)
 ds_read_b128 v[32:35], v17 offset:0
 v_mfma_f32_16x16x32_bf16 a[104:107], v[88:91], v[56:59], a[104:107]
 ds_read_b64_tr_b16 v[86:87], v109 offset:29184
 v_mfma_f32_16x16x32_bf16 a[108:111], v[88:91], v[60:63], a[108:111]
 s_waitcnt lgkmcnt(13)
 v_mfma_f32_16x16x32_bf16 a[124:127], v[92:95], v[60:63], a[124:127]
 ds_read_b64_tr_b16 v[88:89], v110 offset:28672
 v_mfma_f32_16x16x32_bf16 a[120:123], v[92:95], v[56:59], a[120:123]
 ds_read_b128 v[36:39], v17 offset:2048
 v_mfma_f32_16x16x32_bf16 a[116:119], v[92:95], v[52:55], a[116:119]
 ds_read_b64_tr_b16 v[90:91], v110 offset:29184
 v_mfma_f32_16x16x32_bf16 a[112:115], v[92:95], v[48:51], a[112:115]
 s_waitcnt lgkmcnt(14)
 ds_read_b128 v[40:43], v17 offset:4096
 v_mfma_f32_16x16x32_bf16 a[128:131], v[64:67], v[48:51], a[128:131]
 ds_read_b64_tr_b16 v[92:93], v111 offset:28672
 v_mfma_f32_16x16x32_bf16 a[132:135], v[64:67], v[52:55], a[132:135]
 ds_read_b128 v[44:47], v17 offset:6144
 v_mfma_f32_16x16x32_bf16 a[136:139], v[64:67], v[56:59], a[136:139]
 ds_read_b64_tr_b16 v[94:95], v111 offset:29184
 v_mfma_f32_16x16x32_bf16 a[140:143], v[64:67], v[60:63], a[140:143]
 s_waitcnt lgkmcnt(15)
 s_waitcnt vmcnt(4)
 s_barrier
 v_mfma_f32_16x16x32_bf16 a[156:159], v[68:71], v[60:63], a[156:159]
 ds_read_b64_tr_b16 v[64:65], v13 offset:0
 v_mfma_f32_16x16x32_bf16 a[152:155], v[68:71], v[56:59], a[152:155]
 v_mfma_f32_16x16x32_bf16 a[148:151], v[68:71], v[52:55], a[148:151]
 ds_read_b64_tr_b16 v[66:67], v13 offset:512
 v_mfma_f32_16x16x32_bf16 a[144:147], v[68:71], v[48:51], a[144:147]
 s_waitcnt lgkmcnt(15)
 v_mfma_f32_16x16x32_bf16 a[160:163], v[72:75], v[48:51], a[160:163]
 ds_read_b64_tr_b16 v[68:69], v14 offset:0
 v_mfma_f32_16x16x32_bf16 a[164:167], v[72:75], v[52:55], a[164:167]
 v_mfma_f32_16x16x32_bf16 a[168:171], v[72:75], v[56:59], a[168:171]
 ds_read_b64_tr_b16 v[70:71], v14 offset:512
 v_mfma_f32_16x16x32_bf16 a[172:175], v[72:75], v[60:63], a[172:175]
 s_waitcnt lgkmcnt(15)
 v_mfma_f32_16x16x32_bf16 a[188:191], v[76:79], v[60:63], a[188:191]
 ds_read_b64_tr_b16 v[72:73], v15 offset:0
 v_mfma_f32_16x16x32_bf16 a[184:187], v[76:79], v[56:59], a[184:187]
 v_mfma_f32_16x16x32_bf16 a[180:183], v[76:79], v[52:55], a[180:183]
 ds_read_b64_tr_b16 v[74:75], v15 offset:512
 v_mfma_f32_16x16x32_bf16 a[176:179], v[76:79], v[48:51], a[176:179]
 s_waitcnt lgkmcnt(15)
 v_mfma_f32_16x16x32_bf16 a[192:195], v[80:83], v[48:51], a[192:195]
 ds_read_b64_tr_b16 v[76:77], v16 offset:0
 v_mfma_f32_16x16x32_bf16 a[196:199], v[80:83], v[52:55], a[196:199]
 v_mfma_f32_16x16x32_bf16 a[200:203], v[80:83], v[56:59], a[200:203]
 ds_read_b64_tr_b16 v[78:79], v16 offset:512
 v_mfma_f32_16x16x32_bf16 a[204:207], v[80:83], v[60:63], a[204:207]
 s_waitcnt lgkmcnt(15)
 v_mfma_f32_16x16x32_bf16 a[220:223], v[84:87], v[60:63], a[220:223]
 ds_read_b64_tr_b16 v[80:81], v13 offset:4096
 v_mfma_f32_16x16x32_bf16 a[216:219], v[84:87], v[56:59], a[216:219]
 s_mov_b32 s75, s72
 v_mfma_f32_16x16x32_bf16 a[212:215], v[84:87], v[52:55], a[212:215]
 ds_read_b64_tr_b16 v[82:83], v13 offset:4608
 v_mfma_f32_16x16x32_bf16 a[208:211], v[84:87], v[48:51], a[208:211]
 s_waitcnt lgkmcnt(14)
 v_mfma_f32_16x16x32_bf16 a[224:227], v[88:91], v[48:51], a[224:227]
 ds_read_b64_tr_b16 v[84:85], v14 offset:4096
 v_mfma_f32_16x16x32_bf16 a[228:231], v[88:91], v[52:55], a[228:231]
 s_mov_b32 s72, s73
 v_mfma_f32_16x16x32_bf16 a[232:235], v[88:91], v[56:59], a[232:235]
 ds_read_b64_tr_b16 v[86:87], v14 offset:4608
 v_mfma_f32_16x16x32_bf16 a[236:239], v[88:91], v[60:63], a[236:239]
 s_waitcnt lgkmcnt(12)
 v_mfma_f32_16x16x32_bf16 a[252:255], v[92:95], v[60:63], a[252:255]
 ds_read_b64_tr_b16 v[88:89], v15 offset:4096
 v_mfma_f32_16x16x32_bf16 a[248:251], v[92:95], v[56:59], a[248:251]
 s_mov_b32 s73, s74
 v_mfma_f32_16x16x32_bf16 a[244:247], v[92:95], v[52:55], a[244:247]
 ds_read_b64_tr_b16 v[90:91], v15 offset:4608
 v_mfma_f32_16x16x32_bf16 a[240:243], v[92:95], v[48:51], a[240:243]
 s_mov_b32 s74, s75
 s_waitcnt lgkmcnt(12)
 v_mfma_f32_16x16x32_bf16 a[0:3], v[64:67], v[32:35], a[0:3]
 ds_read_b64_tr_b16 v[92:93], v16 offset:4096
 v_mfma_f32_16x16x32_bf16 a[4:7], v[64:67], v[36:39], a[4:7]
 s_waitcnt lgkmcnt(11)
 ds_read_b64_tr_b16 v[94:95], v16 offset:4608
 v_add_u32 v18, s73, v20
 v_mfma_f32_16x16x32_bf16 a[20:23], v[68:71], v[36:39], a[20:23]
 ds_read_b64_tr_b16 v[64:65], v13 offset:8192
 v_mfma_f32_16x16x32_bf16 a[16:19], v[68:71], v[32:35], a[16:19]
 s_waitcnt lgkmcnt(11)
 ds_read_b64_tr_b16 v[66:67], v13 offset:8704
 ds_read_b128 v[48:51], v18 offset:0
 v_mfma_f32_16x16x32_bf16 a[32:35], v[72:75], v[32:35], a[32:35]
 ds_read_b64_tr_b16 v[68:69], v14 offset:8192
 v_mfma_f32_16x16x32_bf16 a[36:39], v[72:75], v[36:39], a[36:39]
 s_waitcnt lgkmcnt(12)
 ds_read_b64_tr_b16 v[70:71], v14 offset:8704
 ds_read_b128 v[52:55], v18 offset:2048
 v_mfma_f32_16x16x32_bf16 a[52:55], v[76:79], v[36:39], a[52:55]
 ds_read_b64_tr_b16 v[72:73], v15 offset:8192
 v_mfma_f32_16x16x32_bf16 a[48:51], v[76:79], v[32:35], a[48:51]
 s_waitcnt lgkmcnt(13)
 ds_read_b64_tr_b16 v[74:75], v15 offset:8704
 ds_read_b128 v[56:59], v18 offset:4096
 v_mfma_f32_16x16x32_bf16 a[64:67], v[80:83], v[32:35], a[64:67]
 ds_read_b64_tr_b16 v[76:77], v16 offset:8192
 v_mfma_f32_16x16x32_bf16 a[68:71], v[80:83], v[36:39], a[68:71]
 s_waitcnt lgkmcnt(14)
 ds_read_b64_tr_b16 v[78:79], v16 offset:8704
 ds_read_b128 v[60:63], v18 offset:6144
 v_mfma_f32_16x16x32_bf16 a[84:87], v[84:87], v[36:39], a[84:87]
 ds_read_b64_tr_b16 v[80:81], v13 offset:12288
 v_mfma_f32_16x16x32_bf16 a[80:83], v[84:87], v[32:35], a[80:83]
 s_waitcnt lgkmcnt(15)
 ds_read_b64_tr_b16 v[82:83], v13 offset:12800
 v_mfma_f32_16x16x32_bf16 a[96:99], v[88:91], v[32:35], a[96:99]
 ds_read_b64_tr_b16 v[84:85], v14 offset:12288
 v_mfma_f32_16x16x32_bf16 a[100:103], v[88:91], v[36:39], a[100:103]
 s_waitcnt lgkmcnt(15)
 ds_read_b64_tr_b16 v[86:87], v14 offset:12800
 s_cmp_lg_u32 s68, 0
 s_cbranch_scc1 gated_mix__compressed_kv_cla__glu_gated_swiglu__prompt_kernel_np18
 buffer_load_dwordx2 v[22:23], v30, s[36:39], 0 offen sc1
gated_mix__compressed_kv_cla__glu_gated_swiglu__prompt_kernel_np18:
 v_mfma_f32_16x16x32_bf16 a[116:119], v[92:95], v[36:39], a[116:119]
 ds_read_b64_tr_b16 v[88:89], v15 offset:12288
 v_mfma_f32_16x16x32_bf16 a[112:115], v[92:95], v[32:35], a[112:115]
 s_waitcnt lgkmcnt(15)
 ds_read_b64_tr_b16 v[90:91], v15 offset:12800
 v_mfma_f32_16x16x32_bf16 a[128:131], v[64:67], v[32:35], a[128:131]
 ds_read_b64_tr_b16 v[92:93], v16 offset:12288
 v_mfma_f32_16x16x32_bf16 a[132:135], v[64:67], v[36:39], a[132:135]
 s_waitcnt lgkmcnt(14)
 s_waitcnt vmcnt(0)
 s_barrier
 ds_read_b64_tr_b16 v[94:95], v16 offset:12800
 v_mfma_f32_16x16x32_bf16 a[148:151], v[68:71], v[36:39], a[148:151]
 ds_read_b64_tr_b16 v[64:65], v13 offset:16384
 v_mfma_f32_16x16x32_bf16 a[144:147], v[68:71], v[32:35], a[144:147]
 s_waitcnt lgkmcnt(13)
 ds_read_b64_tr_b16 v[66:67], v13 offset:16896
 v_mfma_f32_16x16x32_bf16 a[160:163], v[72:75], v[32:35], a[160:163]
 s_add_u32 s95, s55, 0
 ds_read_b64_tr_b16 v[68:69], v14 offset:16384
 v_mfma_f32_16x16x32_bf16 a[164:167], v[72:75], v[36:39], a[164:167]
 s_waitcnt lgkmcnt(12)
 ds_read_b64_tr_b16 v[70:71], v14 offset:16896
 v_mfma_f32_16x16x32_bf16 a[180:183], v[76:79], v[36:39], a[180:183]
 s_add_u32 s96, s55, 4096
 ds_read_b64_tr_b16 v[72:73], v15 offset:16384
 v_mfma_f32_16x16x32_bf16 a[176:179], v[76:79], v[32:35], a[176:179]
 s_waitcnt lgkmcnt(11)
 ds_read_b64_tr_b16 v[74:75], v15 offset:16896
 v_mfma_f32_16x16x32_bf16 a[192:195], v[80:83], v[32:35], a[192:195]
 s_add_u32 s97, s55, 8192
 ds_read_b64_tr_b16 v[76:77], v16 offset:16384
 v_mfma_f32_16x16x32_bf16 a[196:199], v[80:83], v[36:39], a[196:199]
 s_waitcnt lgkmcnt(11)
 ds_read_b64_tr_b16 v[78:79], v16 offset:16896
 v_mfma_f32_16x16x32_bf16 a[212:215], v[84:87], v[36:39], a[212:215]
 s_add_u32 s98, s55, 12288
 ds_read_b64_tr_b16 v[80:81], v13 offset:20480
 v_mfma_f32_16x16x32_bf16 a[208:211], v[84:87], v[32:35], a[208:211]
 s_waitcnt lgkmcnt(11)
 ds_read_b64_tr_b16 v[82:83], v13 offset:20992
 v_mfma_f32_16x16x32_bf16 a[224:227], v[88:91], v[32:35], a[224:227]
 s_add_u32 s94, s55, 16384
 ds_read_b64_tr_b16 v[84:85], v14 offset:20480
 v_mfma_f32_16x16x32_bf16 a[228:231], v[88:91], v[36:39], a[228:231]
 s_waitcnt lgkmcnt(11)
 ds_read_b64_tr_b16 v[86:87], v14 offset:20992
 v_mfma_f32_16x16x32_bf16 a[244:247], v[92:95], v[36:39], a[244:247]
 ds_read_b64_tr_b16 v[88:89], v15 offset:20480
 v_mfma_f32_16x16x32_bf16 a[240:243], v[92:95], v[32:35], a[240:243]
 s_waitcnt lgkmcnt(11)
 ds_read_b64_tr_b16 v[90:91], v15 offset:20992
 v_mfma_f32_16x16x32_bf16 a[0:3], v[64:67], v[48:51], a[0:3]
 ds_read_b64_tr_b16 v[92:93], v16 offset:20480
 v_mfma_f32_16x16x32_bf16 a[4:7], v[64:67], v[52:55], a[4:7]
 s_waitcnt lgkmcnt(11)
 ds_read_b64_tr_b16 v[94:95], v16 offset:20992
 v_mfma_f32_16x16x32_bf16 a[20:23], v[68:71], v[52:55], a[20:23]
 ds_read_b64_tr_b16 v[64:65], v13 offset:24576
 v_mfma_f32_16x16x32_bf16 a[16:19], v[68:71], v[48:51], a[16:19]
 s_waitcnt lgkmcnt(11)
 ds_read_b64_tr_b16 v[66:67], v13 offset:25088
 v_mfma_f32_16x16x32_bf16 a[32:35], v[72:75], v[48:51], a[32:35]
 ds_read_b64_tr_b16 v[68:69], v14 offset:24576
 v_mfma_f32_16x16x32_bf16 a[36:39], v[72:75], v[52:55], a[36:39]
 s_waitcnt lgkmcnt(11)
 ds_read_b64_tr_b16 v[70:71], v14 offset:25088
 v_mfma_f32_16x16x32_bf16 a[52:55], v[76:79], v[52:55], a[52:55]
 ds_read_b64_tr_b16 v[72:73], v15 offset:24576
 v_mfma_f32_16x16x32_bf16 a[48:51], v[76:79], v[48:51], a[48:51]
 s_waitcnt lgkmcnt(11)
 ds_read_b64_tr_b16 v[74:75], v15 offset:25088
 v_mfma_f32_16x16x32_bf16 a[64:67], v[80:83], v[48:51], a[64:67]
 ds_read_b64_tr_b16 v[76:77], v16 offset:24576
 v_accvgpr_read_b32 v224, a0
 v_accvgpr_read_b32 v225, a1
 v_accvgpr_read_b32 v226, a2
 v_accvgpr_read_b32 v227, a3
 v_mfma_f32_16x16x32_bf16 a[68:71], v[80:83], v[52:55], a[68:71]
 s_waitcnt lgkmcnt(11)
 ds_read_b64_tr_b16 v[78:79], v16 offset:25088
 v_accvgpr_read_b32 v228, a16
 v_accvgpr_read_b32 v229, a17
 v_accvgpr_read_b32 v230, a18
 v_accvgpr_read_b32 v231, a19
 v_mfma_f32_16x16x32_bf16 a[84:87], v[84:87], v[52:55], a[84:87]
 ds_read_b64_tr_b16 v[80:81], v13 offset:28672
 v_mul_f32 v224, 1035512379, v224
 v_mul_f32 v225, 1035512379, v225
 v_mul_f32 v226, 1035512379, v226
 v_mul_f32 v227, 1035512379, v227
 v_mfma_f32_16x16x32_bf16 a[80:83], v[84:87], v[48:51], a[80:83]
 s_waitcnt lgkmcnt(11)
 ds_read_b64_tr_b16 v[82:83], v13 offset:29184
 v_mul_f32 v228, 1035512379, v228
 v_mul_f32 v229, 1035512379, v229
 v_mul_f32 v230, 1035512379, v230
 v_mul_f32 v231, 1035512379, v231
 v_mfma_f32_16x16x32_bf16 a[96:99], v[88:91], v[48:51], a[96:99]
 ds_read_b64_tr_b16 v[84:85], v14 offset:28672
 v_cvt_pk_bf16_f32 v112, v224, v225
 v_cvt_pk_bf16_f32 v113, v226, v227
 v_cvt_pk_bf16_f32 v114, v228, v229
 v_cvt_pk_bf16_f32 v115, v230, v231
 v_mfma_f32_16x16x32_bf16 a[100:103], v[88:91], v[52:55], a[100:103]
 s_waitcnt lgkmcnt(11)
 ds_read_b64_tr_b16 v[86:87], v14 offset:29184
 buffer_store_dwordx4 v[112:115], v21, s[36:39], s95 offen offset:0 sc1
 v_accvgpr_read_b32 v232, a4
 v_accvgpr_read_b32 v233, a5
 v_mfma_f32_16x16x32_bf16 a[116:119], v[92:95], v[52:55], a[116:119]
 ds_read_b64_tr_b16 v[88:89], v15 offset:28672
 v_accvgpr_read_b32 v234, a6
 v_accvgpr_read_b32 v235, a7
 v_accvgpr_read_b32 v236, a20
 v_accvgpr_read_b32 v237, a21
 v_mfma_f32_16x16x32_bf16 a[112:115], v[92:95], v[48:51], a[112:115]
 s_waitcnt lgkmcnt(11)
 ds_read_b64_tr_b16 v[90:91], v15 offset:29184
 v_accvgpr_read_b32 v238, a22
 v_accvgpr_read_b32 v239, a23
 v_mul_f32 v232, 1035512379, v232
 v_mul_f32 v233, 1035512379, v233
 v_mfma_f32_16x16x32_bf16 a[128:131], v[64:67], v[48:51], a[128:131]
 ds_read_b64_tr_b16 v[92:93], v16 offset:28672
 v_mul_f32 v234, 1035512379, v234
 v_mul_f32 v235, 1035512379, v235
 v_mul_f32 v236, 1035512379, v236
 v_mul_f32 v237, 1035512379, v237
 v_mfma_f32_16x16x32_bf16 a[132:135], v[64:67], v[52:55], a[132:135]
 s_waitcnt lgkmcnt(11)
 ds_read_b64_tr_b16 v[94:95], v16 offset:29184
 v_mul_f32 v238, 1035512379, v238
 v_mul_f32 v239, 1035512379, v239
 v_cvt_pk_bf16_f32 v144, v232, v233
 v_cvt_pk_bf16_f32 v145, v234, v235
 v_mfma_f32_16x16x32_bf16 a[148:151], v[68:71], v[52:55], a[148:151]
 ds_read_b64_tr_b16 v[64:65], v13 offset:0
 v_cvt_pk_bf16_f32 v146, v236, v237
 v_cvt_pk_bf16_f32 v147, v238, v239
 buffer_store_dwordx4 v[144:147], v21, s[36:39], s97 offen offset:0 sc1
 v_mfma_f32_16x16x32_bf16 a[144:147], v[68:71], v[48:51], a[144:147]
 s_waitcnt lgkmcnt(11)
 ds_read_b64_tr_b16 v[66:67], v13 offset:512
 v_accvgpr_read_b32 v224, a32
 v_accvgpr_read_b32 v225, a33
 v_accvgpr_read_b32 v226, a34
 v_accvgpr_read_b32 v227, a35
 v_mfma_f32_16x16x32_bf16 a[160:163], v[72:75], v[48:51], a[160:163]
 ds_read_b64_tr_b16 v[68:69], v14 offset:0
 v_accvgpr_read_b32 v228, a48
 v_accvgpr_read_b32 v229, a49
 v_accvgpr_read_b32 v230, a50
 v_accvgpr_read_b32 v231, a51
 v_mfma_f32_16x16x32_bf16 a[164:167], v[72:75], v[52:55], a[164:167]
 s_waitcnt lgkmcnt(11)
 ds_read_b64_tr_b16 v[70:71], v14 offset:512
 v_mul_f32 v224, 1035512379, v224
 v_mul_f32 v225, 1035512379, v225
 v_mul_f32 v226, 1035512379, v226
 v_mul_f32 v227, 1035512379, v227
 v_mfma_f32_16x16x32_bf16 a[180:183], v[76:79], v[52:55], a[180:183]
 ds_read_b64_tr_b16 v[72:73], v15 offset:0
 v_mul_f32 v228, 1035512379, v228
 v_mul_f32 v229, 1035512379, v229
 v_mul_f32 v230, 1035512379, v230
 v_mul_f32 v231, 1035512379, v231
 v_mfma_f32_16x16x32_bf16 a[176:179], v[76:79], v[48:51], a[176:179]
 s_waitcnt lgkmcnt(11)
 ds_read_b64_tr_b16 v[74:75], v15 offset:512
 v_cvt_pk_bf16_f32 v116, v224, v225
 v_cvt_pk_bf16_f32 v117, v226, v227
 v_cvt_pk_bf16_f32 v118, v228, v229
 v_cvt_pk_bf16_f32 v119, v230, v231
 v_mfma_f32_16x16x32_bf16 a[192:195], v[80:83], v[48:51], a[192:195]
 ds_read_b64_tr_b16 v[76:77], v16 offset:0
 buffer_store_dwordx4 v[116:119], v21, s[36:39], s95 offen offset:1024 sc1
 v_accvgpr_read_b32 v232, a36
 v_accvgpr_read_b32 v233, a37
 v_mfma_f32_16x16x32_bf16 a[196:199], v[80:83], v[52:55], a[196:199]
 s_waitcnt lgkmcnt(11)
 ds_read_b64_tr_b16 v[78:79], v16 offset:512
 v_accvgpr_read_b32 v234, a38
 v_accvgpr_read_b32 v235, a39
 v_accvgpr_read_b32 v236, a52
 v_accvgpr_read_b32 v237, a53
 v_mfma_f32_16x16x32_bf16 a[212:215], v[84:87], v[52:55], a[212:215]
 ds_read_b64_tr_b16 v[80:81], v13 offset:4096
 v_accvgpr_read_b32 v238, a54
 v_accvgpr_read_b32 v239, a55
 v_mul_f32 v232, 1035512379, v232
 v_mul_f32 v233, 1035512379, v233
 v_mfma_f32_16x16x32_bf16 a[208:211], v[84:87], v[48:51], a[208:211]
 s_waitcnt lgkmcnt(11)
 ds_read_b64_tr_b16 v[82:83], v13 offset:4608
 v_mul_f32 v234, 1035512379, v234
 v_mul_f32 v235, 1035512379, v235
 v_mul_f32 v236, 1035512379, v236
 v_mul_f32 v237, 1035512379, v237
 v_mfma_f32_16x16x32_bf16 a[224:227], v[88:91], v[48:51], a[224:227]
 ds_read_b64_tr_b16 v[84:85], v14 offset:4096
 v_mul_f32 v238, 1035512379, v238
 v_mul_f32 v239, 1035512379, v239
 v_cvt_pk_bf16_f32 v148, v232, v233
 v_cvt_pk_bf16_f32 v149, v234, v235
 v_mfma_f32_16x16x32_bf16 a[228:231], v[88:91], v[52:55], a[228:231]
 s_waitcnt lgkmcnt(11)
 ds_read_b64_tr_b16 v[86:87], v14 offset:4608
 v_cvt_pk_bf16_f32 v150, v236, v237
 v_cvt_pk_bf16_f32 v151, v238, v239
 buffer_store_dwordx4 v[148:151], v21, s[36:39], s97 offen offset:1024 sc1
 v_mfma_f32_16x16x32_bf16 a[244:247], v[92:95], v[52:55], a[244:247]
 ds_read_b64_tr_b16 v[88:89], v15 offset:4096
 v_accvgpr_read_b32 v224, a64
 v_accvgpr_read_b32 v225, a65
 v_accvgpr_read_b32 v226, a66
 v_accvgpr_read_b32 v227, a67
 v_mfma_f32_16x16x32_bf16 a[240:243], v[92:95], v[48:51], a[240:243]
 s_waitcnt lgkmcnt(11)
 ds_read_b64_tr_b16 v[90:91], v15 offset:4608
 v_accvgpr_read_b32 v228, a80
 v_accvgpr_read_b32 v229, a81
 v_accvgpr_read_b32 v230, a82
 v_accvgpr_read_b32 v231, a83
 v_mfma_f32_16x16x32_bf16 a[8:11], v[64:67], v[40:43], a[8:11]
 ds_read_b64_tr_b16 v[92:93], v16 offset:4096
 v_mul_f32 v224, 1035512379, v224
 v_mul_f32 v225, 1035512379, v225
 v_mul_f32 v226, 1035512379, v226
 v_mul_f32 v227, 1035512379, v227
 v_mfma_f32_16x16x32_bf16 a[12:15], v[64:67], v[44:47], a[12:15]
 s_waitcnt lgkmcnt(11)
 ds_read_b64_tr_b16 v[94:95], v16 offset:4608
 v_mul_f32 v228, 1035512379, v228
 v_mul_f32 v229, 1035512379, v229
 v_mul_f32 v230, 1035512379, v230
 v_mul_f32 v231, 1035512379, v231
 v_mfma_f32_16x16x32_bf16 a[28:31], v[68:71], v[44:47], a[28:31]
 ds_read_b64_tr_b16 v[64:65], v13 offset:8192
 v_cvt_pk_bf16_f32 v120, v224, v225
 v_cvt_pk_bf16_f32 v121, v226, v227
 v_cvt_pk_bf16_f32 v122, v228, v229
 v_cvt_pk_bf16_f32 v123, v230, v231
 v_mfma_f32_16x16x32_bf16 a[24:27], v[68:71], v[40:43], a[24:27]
 s_waitcnt lgkmcnt(11)
 ds_read_b64_tr_b16 v[66:67], v13 offset:8704
 buffer_store_dwordx4 v[120:123], v21, s[36:39], s95 offen offset:2048 sc1
 v_accvgpr_read_b32 v232, a68
 v_accvgpr_read_b32 v233, a69
 v_mfma_f32_16x16x32_bf16 a[40:43], v[72:75], v[40:43], a[40:43]
 ds_read_b64_tr_b16 v[68:69], v14 offset:8192
 v_accvgpr_read_b32 v234, a70
 v_accvgpr_read_b32 v235, a71
 v_accvgpr_read_b32 v236, a84
 v_accvgpr_read_b32 v237, a85
 v_mfma_f32_16x16x32_bf16 a[44:47], v[72:75], v[44:47], a[44:47]
 s_waitcnt lgkmcnt(11)
 ds_read_b64_tr_b16 v[70:71], v14 offset:8704
 v_accvgpr_read_b32 v238, a86
 v_accvgpr_read_b32 v239, a87
 v_mul_f32 v232, 1035512379, v232
 v_mul_f32 v233, 1035512379, v233
 v_mfma_f32_16x16x32_bf16 a[60:63], v[76:79], v[44:47], a[60:63]
 ds_read_b64_tr_b16 v[72:73], v15 offset:8192
 v_mul_f32 v234, 1035512379, v234
 v_mul_f32 v235, 1035512379, v235
 v_mul_f32 v236, 1035512379, v236
 v_mul_f32 v237, 1035512379, v237
 v_mfma_f32_16x16x32_bf16 a[56:59], v[76:79], v[40:43], a[56:59]
 s_waitcnt lgkmcnt(11)
 ds_read_b64_tr_b16 v[74:75], v15 offset:8704
 v_mul_f32 v238, 1035512379, v238
 v_mul_f32 v239, 1035512379, v239
 v_cvt_pk_bf16_f32 v152, v232, v233
 v_cvt_pk_bf16_f32 v153, v234, v235
 v_mfma_f32_16x16x32_bf16 a[72:75], v[80:83], v[40:43], a[72:75]
 ds_read_b64_tr_b16 v[76:77], v16 offset:8192
 v_cvt_pk_bf16_f32 v154, v236, v237
 v_cvt_pk_bf16_f32 v155, v238, v239
 buffer_store_dwordx4 v[152:155], v21, s[36:39], s97 offen offset:2048 sc1
 v_mfma_f32_16x16x32_bf16 a[76:79], v[80:83], v[44:47], a[76:79]
 s_waitcnt lgkmcnt(11)
 ds_read_b64_tr_b16 v[78:79], v16 offset:8704
 v_accvgpr_read_b32 v224, a96
 v_accvgpr_read_b32 v225, a97
 v_accvgpr_read_b32 v226, a98
 v_accvgpr_read_b32 v227, a99
 v_mfma_f32_16x16x32_bf16 a[92:95], v[84:87], v[44:47], a[92:95]
 ds_read_b64_tr_b16 v[80:81], v13 offset:12288
 v_accvgpr_read_b32 v228, a112
 v_accvgpr_read_b32 v229, a113
 v_accvgpr_read_b32 v230, a114
 v_accvgpr_read_b32 v231, a115
 v_mfma_f32_16x16x32_bf16 a[88:91], v[84:87], v[40:43], a[88:91]
 s_waitcnt lgkmcnt(11)
 ds_read_b64_tr_b16 v[82:83], v13 offset:12800
 v_mul_f32 v224, 1035512379, v224
 v_mul_f32 v225, 1035512379, v225
 v_mul_f32 v226, 1035512379, v226
 v_mul_f32 v227, 1035512379, v227
 v_mfma_f32_16x16x32_bf16 a[104:107], v[88:91], v[40:43], a[104:107]
 ds_read_b64_tr_b16 v[84:85], v14 offset:12288
 v_mul_f32 v228, 1035512379, v228
 v_mul_f32 v229, 1035512379, v229
 v_mul_f32 v230, 1035512379, v230
 v_mul_f32 v231, 1035512379, v231
 v_mfma_f32_16x16x32_bf16 a[108:111], v[88:91], v[44:47], a[108:111]
 s_waitcnt lgkmcnt(11)
 ds_read_b64_tr_b16 v[86:87], v14 offset:12800
 v_cvt_pk_bf16_f32 v124, v224, v225
 v_cvt_pk_bf16_f32 v125, v226, v227
 v_cvt_pk_bf16_f32 v126, v228, v229
 v_cvt_pk_bf16_f32 v127, v230, v231
 v_mfma_f32_16x16x32_bf16 a[124:127], v[92:95], v[44:47], a[124:127]
 ds_read_b64_tr_b16 v[88:89], v15 offset:12288
 buffer_store_dwordx4 v[124:127], v21, s[36:39], s95 offen offset:3072 sc1
 v_accvgpr_read_b32 v232, a100
 v_accvgpr_read_b32 v233, a101
 v_mfma_f32_16x16x32_bf16 a[120:123], v[92:95], v[40:43], a[120:123]
 s_waitcnt lgkmcnt(11)
 ds_read_b64_tr_b16 v[90:91], v15 offset:12800
 v_accvgpr_read_b32 v234, a102
 v_accvgpr_read_b32 v235, a103
 v_accvgpr_read_b32 v236, a116
 v_accvgpr_read_b32 v237, a117
 v_mfma_f32_16x16x32_bf16 a[136:139], v[64:67], v[40:43], a[136:139]
 ds_read_b64_tr_b16 v[92:93], v16 offset:12288
 v_accvgpr_read_b32 v238, a118
 v_accvgpr_read_b32 v239, a119
 v_mul_f32 v232, 1035512379, v232
 v_mul_f32 v233, 1035512379, v233
 v_mfma_f32_16x16x32_bf16 a[140:143], v[64:67], v[44:47], a[140:143]
 s_waitcnt lgkmcnt(11)
 ds_read_b64_tr_b16 v[94:95], v16 offset:12800
 v_mul_f32 v234, 1035512379, v234
 v_mul_f32 v235, 1035512379, v235
 v_mul_f32 v236, 1035512379, v236
 v_mul_f32 v237, 1035512379, v237
 v_mfma_f32_16x16x32_bf16 a[156:159], v[68:71], v[44:47], a[156:159]
 ds_read_b64_tr_b16 v[64:65], v13 offset:16384
 v_mul_f32 v238, 1035512379, v238
 v_mul_f32 v239, 1035512379, v239
 v_cvt_pk_bf16_f32 v156, v232, v233
 v_cvt_pk_bf16_f32 v157, v234, v235
 v_mfma_f32_16x16x32_bf16 a[152:155], v[68:71], v[40:43], a[152:155]
 s_waitcnt lgkmcnt(11)
 ds_read_b64_tr_b16 v[66:67], v13 offset:16896
 v_cvt_pk_bf16_f32 v158, v236, v237
 v_cvt_pk_bf16_f32 v159, v238, v239
 buffer_store_dwordx4 v[156:159], v21, s[36:39], s97 offen offset:3072 sc1
 v_mfma_f32_16x16x32_bf16 a[168:171], v[72:75], v[40:43], a[168:171]
 ds_read_b64_tr_b16 v[68:69], v14 offset:16384
 v_accvgpr_read_b32 v224, a128
 v_accvgpr_read_b32 v225, a129
 v_accvgpr_read_b32 v226, a130
 v_accvgpr_read_b32 v227, a131
 v_mfma_f32_16x16x32_bf16 a[172:175], v[72:75], v[44:47], a[172:175]
 s_waitcnt lgkmcnt(11)
 ds_read_b64_tr_b16 v[70:71], v14 offset:16896
 v_accvgpr_read_b32 v228, a144
 v_accvgpr_read_b32 v229, a145
 v_accvgpr_read_b32 v230, a146
 v_accvgpr_read_b32 v231, a147
 v_mfma_f32_16x16x32_bf16 a[188:191], v[76:79], v[44:47], a[188:191]
 ds_read_b64_tr_b16 v[72:73], v15 offset:16384
 v_mul_f32 v224, 1035512379, v224
 v_mul_f32 v225, 1035512379, v225
 v_mul_f32 v226, 1035512379, v226
 v_mul_f32 v227, 1035512379, v227
 v_mfma_f32_16x16x32_bf16 a[184:187], v[76:79], v[40:43], a[184:187]
 s_waitcnt lgkmcnt(11)
 ds_read_b64_tr_b16 v[74:75], v15 offset:16896
 v_mul_f32 v228, 1035512379, v228
 v_mul_f32 v229, 1035512379, v229
 v_mul_f32 v230, 1035512379, v230
 v_mul_f32 v231, 1035512379, v231
 v_mfma_f32_16x16x32_bf16 a[200:203], v[80:83], v[40:43], a[200:203]
 ds_read_b64_tr_b16 v[76:77], v16 offset:16384
 v_cvt_pk_bf16_f32 v128, v224, v225
 v_cvt_pk_bf16_f32 v129, v226, v227
 v_cvt_pk_bf16_f32 v130, v228, v229
 v_cvt_pk_bf16_f32 v131, v230, v231
 v_mfma_f32_16x16x32_bf16 a[204:207], v[80:83], v[44:47], a[204:207]
 s_waitcnt lgkmcnt(11)
 ds_read_b64_tr_b16 v[78:79], v16 offset:16896
 buffer_store_dwordx4 v[128:131], v21, s[36:39], s96 offen offset:0 sc1
 v_accvgpr_read_b32 v232, a132
 v_accvgpr_read_b32 v233, a133
 v_mfma_f32_16x16x32_bf16 a[220:223], v[84:87], v[44:47], a[220:223]
 ds_read_b64_tr_b16 v[80:81], v13 offset:20480
 v_accvgpr_read_b32 v234, a134
 v_accvgpr_read_b32 v235, a135
 v_accvgpr_read_b32 v236, a148
 v_accvgpr_read_b32 v237, a149
 v_mfma_f32_16x16x32_bf16 a[216:219], v[84:87], v[40:43], a[216:219]
 s_waitcnt lgkmcnt(11)
 ds_read_b64_tr_b16 v[82:83], v13 offset:20992
 v_accvgpr_read_b32 v238, a150
 v_accvgpr_read_b32 v239, a151
 v_mul_f32 v232, 1035512379, v232
 v_mul_f32 v233, 1035512379, v233
 v_mfma_f32_16x16x32_bf16 a[232:235], v[88:91], v[40:43], a[232:235]
 ds_read_b64_tr_b16 v[84:85], v14 offset:20480
 v_mul_f32 v234, 1035512379, v234
 v_mul_f32 v235, 1035512379, v235
 v_mul_f32 v236, 1035512379, v236
 v_mul_f32 v237, 1035512379, v237
 v_mfma_f32_16x16x32_bf16 a[236:239], v[88:91], v[44:47], a[236:239]
 s_waitcnt lgkmcnt(11)
 ds_read_b64_tr_b16 v[86:87], v14 offset:20992
 v_mul_f32 v238, 1035512379, v238
 v_mul_f32 v239, 1035512379, v239
 v_cvt_pk_bf16_f32 v160, v232, v233
 v_cvt_pk_bf16_f32 v161, v234, v235
 v_mfma_f32_16x16x32_bf16 a[252:255], v[92:95], v[44:47], a[252:255]
 ds_read_b64_tr_b16 v[88:89], v15 offset:20480
 v_cvt_pk_bf16_f32 v162, v236, v237
 v_cvt_pk_bf16_f32 v163, v238, v239
 buffer_store_dwordx4 v[160:163], v21, s[36:39], s98 offen offset:0 sc1
 v_mfma_f32_16x16x32_bf16 a[248:251], v[92:95], v[40:43], a[248:251]
 s_waitcnt lgkmcnt(11)
 ds_read_b64_tr_b16 v[90:91], v15 offset:20992
 v_accvgpr_read_b32 v224, a160
 v_accvgpr_read_b32 v225, a161
 v_accvgpr_read_b32 v226, a162
 v_accvgpr_read_b32 v227, a163
 v_mfma_f32_16x16x32_bf16 a[8:11], v[64:67], v[56:59], a[8:11]
 ds_read_b64_tr_b16 v[92:93], v16 offset:20480
 v_accvgpr_read_b32 v228, a176
 v_accvgpr_read_b32 v229, a177
 v_accvgpr_read_b32 v230, a178
 v_accvgpr_read_b32 v231, a179
 v_mfma_f32_16x16x32_bf16 a[12:15], v[64:67], v[60:63], a[12:15]
 s_waitcnt lgkmcnt(11)
 ds_read_b64_tr_b16 v[94:95], v16 offset:20992
 v_mul_f32 v224, 1035512379, v224
 v_mul_f32 v225, 1035512379, v225
 v_mul_f32 v226, 1035512379, v226
 v_mul_f32 v227, 1035512379, v227
 v_mfma_f32_16x16x32_bf16 a[28:31], v[68:71], v[60:63], a[28:31]
 ds_read_b64_tr_b16 v[64:65], v13 offset:24576
 v_mul_f32 v228, 1035512379, v228
 v_mul_f32 v229, 1035512379, v229
 v_mul_f32 v230, 1035512379, v230
 v_mul_f32 v231, 1035512379, v231
 v_mfma_f32_16x16x32_bf16 a[24:27], v[68:71], v[56:59], a[24:27]
 s_waitcnt lgkmcnt(11)
 ds_read_b64_tr_b16 v[66:67], v13 offset:25088
 v_cvt_pk_bf16_f32 v132, v224, v225
 v_cvt_pk_bf16_f32 v133, v226, v227
 v_cvt_pk_bf16_f32 v134, v228, v229
 v_cvt_pk_bf16_f32 v135, v230, v231
 v_mfma_f32_16x16x32_bf16 a[40:43], v[72:75], v[56:59], a[40:43]
 ds_read_b64_tr_b16 v[68:69], v14 offset:24576
 buffer_store_dwordx4 v[132:135], v21, s[36:39], s96 offen offset:1024 sc1
 v_accvgpr_read_b32 v232, a164
 v_accvgpr_read_b32 v233, a165
 v_mfma_f32_16x16x32_bf16 a[44:47], v[72:75], v[60:63], a[44:47]
 s_waitcnt lgkmcnt(11)
 ds_read_b64_tr_b16 v[70:71], v14 offset:25088
 v_accvgpr_read_b32 v234, a166
 v_accvgpr_read_b32 v235, a167
 v_accvgpr_read_b32 v236, a180
 v_accvgpr_read_b32 v237, a181
 v_mfma_f32_16x16x32_bf16 a[60:63], v[76:79], v[60:63], a[60:63]
 ds_read_b64_tr_b16 v[72:73], v15 offset:24576
 v_accvgpr_read_b32 v238, a182
 v_accvgpr_read_b32 v239, a183
 v_mul_f32 v232, 1035512379, v232
 v_mul_f32 v233, 1035512379, v233
 v_mfma_f32_16x16x32_bf16 a[56:59], v[76:79], v[56:59], a[56:59]
 s_waitcnt lgkmcnt(11)
 ds_read_b64_tr_b16 v[74:75], v15 offset:25088
 v_mul_f32 v234, 1035512379, v234
 v_mul_f32 v235, 1035512379, v235
 v_mul_f32 v236, 1035512379, v236
 v_mul_f32 v237, 1035512379, v237
 v_mfma_f32_16x16x32_bf16 a[72:75], v[80:83], v[56:59], a[72:75]
 ds_read_b64_tr_b16 v[76:77], v16 offset:24576
 v_mul_f32 v238, 1035512379, v238
 v_mul_f32 v239, 1035512379, v239
 v_cvt_pk_bf16_f32 v164, v232, v233
 v_cvt_pk_bf16_f32 v165, v234, v235
 v_mfma_f32_16x16x32_bf16 a[76:79], v[80:83], v[60:63], a[76:79]
 s_waitcnt lgkmcnt(11)
 ds_read_b64_tr_b16 v[78:79], v16 offset:25088
 v_cvt_pk_bf16_f32 v166, v236, v237
 v_cvt_pk_bf16_f32 v167, v238, v239
 buffer_store_dwordx4 v[164:167], v21, s[36:39], s98 offen offset:1024 sc1
 v_mfma_f32_16x16x32_bf16 a[92:95], v[84:87], v[60:63], a[92:95]
 ds_read_b64_tr_b16 v[80:81], v13 offset:28672
 v_accvgpr_read_b32 v224, a192
 v_accvgpr_read_b32 v225, a193
 v_accvgpr_read_b32 v226, a194
 v_accvgpr_read_b32 v227, a195
 v_mfma_f32_16x16x32_bf16 a[88:91], v[84:87], v[56:59], a[88:91]
 s_waitcnt lgkmcnt(11)
 ds_read_b64_tr_b16 v[82:83], v13 offset:29184
 v_accvgpr_read_b32 v228, a208
 v_accvgpr_read_b32 v229, a209
 v_accvgpr_read_b32 v230, a210
 v_accvgpr_read_b32 v231, a211
 v_mfma_f32_16x16x32_bf16 a[104:107], v[88:91], v[56:59], a[104:107]
 ds_read_b64_tr_b16 v[84:85], v14 offset:28672
 v_mul_f32 v224, 1035512379, v224
 v_mul_f32 v225, 1035512379, v225
 v_mul_f32 v226, 1035512379, v226
 v_mul_f32 v227, 1035512379, v227
 v_mfma_f32_16x16x32_bf16 a[108:111], v[88:91], v[60:63], a[108:111]
 s_waitcnt lgkmcnt(11)
 ds_read_b64_tr_b16 v[86:87], v14 offset:29184
 v_mul_f32 v228, 1035512379, v228
 v_mul_f32 v229, 1035512379, v229
 v_mul_f32 v230, 1035512379, v230
 v_mul_f32 v231, 1035512379, v231
 v_mfma_f32_16x16x32_bf16 a[124:127], v[92:95], v[60:63], a[124:127]
 ds_read_b64_tr_b16 v[88:89], v15 offset:28672
 v_cvt_pk_bf16_f32 v136, v224, v225
 v_cvt_pk_bf16_f32 v137, v226, v227
 v_cvt_pk_bf16_f32 v138, v228, v229
 v_cvt_pk_bf16_f32 v139, v230, v231
 v_mfma_f32_16x16x32_bf16 a[120:123], v[92:95], v[56:59], a[120:123]
 s_waitcnt lgkmcnt(11)
 ds_read_b64_tr_b16 v[90:91], v15 offset:29184
 buffer_store_dwordx4 v[136:139], v21, s[36:39], s96 offen offset:2048 sc1
 v_accvgpr_read_b32 v232, a196
 v_accvgpr_read_b32 v233, a197
 v_mfma_f32_16x16x32_bf16 a[136:139], v[64:67], v[56:59], a[136:139]
 ds_read_b64_tr_b16 v[92:93], v16 offset:28672
 v_accvgpr_read_b32 v234, a198
 v_accvgpr_read_b32 v235, a199
 v_accvgpr_read_b32 v236, a212
 v_accvgpr_read_b32 v237, a213
 v_mfma_f32_16x16x32_bf16 a[140:143], v[64:67], v[60:63], a[140:143]
 s_waitcnt lgkmcnt(11)
 ds_read_b64_tr_b16 v[94:95], v16 offset:29184
 v_accvgpr_read_b32 v238, a214
 v_accvgpr_read_b32 v239, a215
 v_mul_f32 v232, 1035512379, v232
 v_mul_f32 v233, 1035512379, v233
 v_mfma_f32_16x16x32_bf16 a[156:159], v[68:71], v[60:63], a[156:159]
 v_mul_f32 v234, 1035512379, v234
 v_mul_f32 v235, 1035512379, v235
 v_mul_f32 v236, 1035512379, v236
 v_mul_f32 v237, 1035512379, v237
 v_mfma_f32_16x16x32_bf16 a[152:155], v[68:71], v[56:59], a[152:155]
 s_waitcnt lgkmcnt(10)
 v_mul_f32 v238, 1035512379, v238
 v_mul_f32 v239, 1035512379, v239
 v_cvt_pk_bf16_f32 v168, v232, v233
 v_cvt_pk_bf16_f32 v169, v234, v235
 v_mfma_f32_16x16x32_bf16 a[168:171], v[72:75], v[56:59], a[168:171]
 v_cvt_pk_bf16_f32 v170, v236, v237
 v_cvt_pk_bf16_f32 v171, v238, v239
 buffer_store_dwordx4 v[168:171], v21, s[36:39], s98 offen offset:2048 sc1
 v_mfma_f32_16x16x32_bf16 a[172:175], v[72:75], v[60:63], a[172:175]
 s_waitcnt lgkmcnt(8)
 v_accvgpr_read_b32 v224, a224
 v_accvgpr_read_b32 v225, a225
 v_accvgpr_read_b32 v226, a226
 v_accvgpr_read_b32 v227, a227
 v_mfma_f32_16x16x32_bf16 a[188:191], v[76:79], v[60:63], a[188:191]
 v_accvgpr_read_b32 v228, a240
 v_accvgpr_read_b32 v229, a241
 v_accvgpr_read_b32 v230, a242
 v_accvgpr_read_b32 v231, a243
 v_mfma_f32_16x16x32_bf16 a[184:187], v[76:79], v[56:59], a[184:187]
 s_waitcnt lgkmcnt(6)
 v_mul_f32 v224, 1035512379, v224
 v_mul_f32 v225, 1035512379, v225
 v_mul_f32 v226, 1035512379, v226
 v_mul_f32 v227, 1035512379, v227
 v_mfma_f32_16x16x32_bf16 a[200:203], v[80:83], v[56:59], a[200:203]
 v_mul_f32 v228, 1035512379, v228
 v_mul_f32 v229, 1035512379, v229
 v_mul_f32 v230, 1035512379, v230
 v_mul_f32 v231, 1035512379, v231
 v_mfma_f32_16x16x32_bf16 a[204:207], v[80:83], v[60:63], a[204:207]
 s_waitcnt lgkmcnt(4)
 v_cvt_pk_bf16_f32 v140, v224, v225
 v_cvt_pk_bf16_f32 v141, v226, v227
 v_cvt_pk_bf16_f32 v142, v228, v229
 v_cvt_pk_bf16_f32 v143, v230, v231
 v_mfma_f32_16x16x32_bf16 a[220:223], v[84:87], v[60:63], a[220:223]
 buffer_store_dwordx4 v[140:143], v21, s[36:39], s96 offen offset:3072 sc1
 v_accvgpr_read_b32 v232, a228
 v_accvgpr_read_b32 v233, a229
 v_mfma_f32_16x16x32_bf16 a[216:219], v[84:87], v[56:59], a[216:219]
 s_waitcnt lgkmcnt(2)
 v_accvgpr_read_b32 v234, a230
 v_accvgpr_read_b32 v235, a231
 v_accvgpr_read_b32 v236, a244
 v_accvgpr_read_b32 v237, a245
 v_mfma_f32_16x16x32_bf16 a[232:235], v[88:91], v[56:59], a[232:235]
 v_accvgpr_read_b32 v238, a246
 v_accvgpr_read_b32 v239, a247
 v_mul_f32 v232, 1035512379, v232
 v_mul_f32 v233, 1035512379, v233
 v_mfma_f32_16x16x32_bf16 a[236:239], v[88:91], v[60:63], a[236:239]
 s_waitcnt lgkmcnt(0)
 v_mul_f32 v234, 1035512379, v234
 v_mul_f32 v235, 1035512379, v235
 v_mul_f32 v236, 1035512379, v236
 v_mul_f32 v237, 1035512379, v237
 v_mfma_f32_16x16x32_bf16 a[252:255], v[92:95], v[60:63], a[252:255]
 v_mul_f32 v238, 1035512379, v238
 v_mul_f32 v239, 1035512379, v239
 v_cvt_pk_bf16_f32 v172, v232, v233
 v_cvt_pk_bf16_f32 v173, v234, v235
 v_mfma_f32_16x16x32_bf16 a[248:251], v[92:95], v[56:59], a[248:251]
 v_cvt_pk_bf16_f32 v174, v236, v237
 v_cvt_pk_bf16_f32 v175, v238, v239
 buffer_store_dwordx4 v[172:175], v21, s[36:39], s98 offen offset:3072 sc1
 s_cmp_lg_u32 s68, 0
 s_cbranch_scc1 gated_mix__compressed_kv_cla__glu_gated_swiglu__prompt_kernel_np19
 s_waitcnt vmcnt(16)
 s_mov_b32 s99, 1048576
gated_mix__compressed_kv_cla__glu_gated_swiglu__prompt_kernel_poll20:
 v_cmp_eq_u64 vcc, v[22:23], v[28:29]
 s_nop 3
 s_and_b32 vcc_lo, vcc_lo, 0xff
 s_cmp_eq_u32 vcc_lo, 0xff
 s_cbranch_scc1 gated_mix__compressed_kv_cla__glu_gated_swiglu__prompt_kernel_ok21
 s_sub_u32 s99, s99, 1
 s_cbranch_scc1 gated_mix__compressed_kv_cla__glu_gated_swiglu__prompt_kernel_ok21
 s_sleep 12
 buffer_load_dwordx2 v[22:23], v30, s[36:39], 0 offen sc1
 s_waitcnt vmcnt(0)
 s_branch gated_mix__compressed_kv_cla__glu_gated_swiglu__prompt_kernel_poll20
gated_mix__compressed_kv_cla__glu_gated_swiglu__prompt_kernel_ok21:
gated_mix__compressed_kv_cla__glu_gated_swiglu__prompt_kernel_np19:
 s_barrier
 s_getpc_b64 s[96:97]
gated_mix__compressed_kv_cla__glu_gated_swiglu__prompt_kernel_pc22:
 s_sub_u32 s96, s96, gated_mix__compressed_kv_cla__glu_gated_swiglu__prompt_kernel_pc22-gated_mix__compressed_kv_cla__glu_gated_swiglu__prompt_kernel_pc
 s_subb_u32 s97, s97, 0
 global_load_dword v31, v27, s[96:97]
 s_lshl_b32 s91, s82, 21
 s_add_u32 s20, s36, s91
 s_addc_u32 s21, s37, 0
 s_mov_b32 s22, 2097152
 s_mov_b32 s24, s20
 s_mov_b32 s25, s21
 s_lshl_b32 s92, s68, 12
 v_add_u32 v3, s92, v21
 s_add_u32 s76, s92, 0
 s_add_u32 s77, s92, 65536
 s_lshl_b32 s91, s86, 2
 s_add_u32 s93, s91, 4
 s_add_u32 s94, s93, s85
 s_sub_u32 s95, s93, s85
 s_sub_u32 s96, s95, 8
 s_add_u32 s87, s85, 8
 s_cmp_eq_u32 s84, 0
 s_cselect_b32 s7, s94, s95
 s_cselect_b32 s8, s93, s96
 s_cselect_b32 s87, 0, s87
 s_cmp_eq_u32 s81, 0
 s_cselect_b32 s6, 8, 0
 s_cselect_b32 s17, s85, s7
 s_cselect_b32 s71, 0, 1
 s_lshl_b32 s9, s6, 15
 s_mov_b32 s11, 0
 s_mov_b32 m0, s76
 s_mov_b32 s12, 65536
 buffer_load_dwordx4 v3, s[20:23], s9 offen offset:0 sc1 lds
 buffer_load_dwordx4 v3, s[20:23], s9 offen offset:1024 sc1 lds
 buffer_load_dwordx4 v3, s[20:23], s9 offen offset:2048 sc1 lds
 buffer_load_dwordx4 v3, s[20:23], s9 offen offset:3072 sc1 lds
 s_mov_b32 s88, 1035512379
 s_mov_b32 s89, 1035512379
 v_accvgpr_read_b32 v64, a8
 v_accvgpr_read_b32 v65, a9
 v_accvgpr_read_b32 v66, a10
 v_accvgpr_read_b32 v67, a11
 v_accvgpr_read_b32 v68, a24
 v_accvgpr_read_b32 v69, a25
 v_accvgpr_read_b32 v70, a26
 v_accvgpr_read_b32 v71, a27
 v_pk_mul_f32 v[64:65], v[64:65], s[88:89]
 v_pk_mul_f32 v[66:67], v[66:67], s[88:89]
 v_pk_mul_f32 v[68:69], v[68:69], s[88:89]
 v_pk_mul_f32 v[70:71], v[70:71], s[88:89]
 v_cvt_pk_bf16_f32 v176, v64, v65
 v_cvt_pk_bf16_f32 v177, v66, v67
 v_cvt_pk_bf16_f32 v178, v68, v69
 v_cvt_pk_bf16_f32 v179, v70, v71
 s_add_u32 s10, s9, 16384
 s_mov_b32 s26, s22
 s_add_u32 s6, s6, 1
 s_sub_u32 s7, s7, 1
 s_cmp_eq_u32 s7, s8
 s_cselect_b32 s6, s87, s6
 s_cmp_gt_i32 s7, 0
 s_cselect_b32 s22, s22, 0
 s_cselect_b32 s6, s6, 0
 s_lshl_b32 s9, s6, 15
 s_add_u32 s11, s11, 16384
 s_and_b32 s11, s11, 0xffff
 s_add_u32 m0, s11, s76
 s_nop 0
 buffer_load_dwordx4 v3, s[20:23], s9 offen offset:0 sc1 lds
 v_accvgpr_read_b32 v72, a40
 v_accvgpr_read_b32 v73, a41
 v_accvgpr_read_b32 v74, a42
 v_accvgpr_read_b32 v75, a43
 v_accvgpr_read_b32 v76, a56
 v_accvgpr_read_b32 v77, a57
 v_accvgpr_read_b32 v78, a58
 v_accvgpr_read_b32 v79, a59
 v_pk_mul_f32 v[72:73], v[72:73], s[88:89]
 v_pk_mul_f32 v[74:75], v[74:75], s[88:89]
 v_pk_mul_f32 v[76:77], v[76:77], s[88:89]
 v_pk_mul_f32 v[78:79], v[78:79], s[88:89]
 v_cvt_pk_bf16_f32 v180, v72, v73
 v_cvt_pk_bf16_f32 v181, v74, v75
 v_cvt_pk_bf16_f32 v182, v76, v77
 v_cvt_pk_bf16_f32 v183, v78, v79
 buffer_load_dwordx4 v3, s[20:23], s9 offen offset:1024 sc1 lds
 buffer_load_dwordx4 v3, s[20:23], s9 offen offset:2048 sc1 lds
 v_accvgpr_read_b32 v80, a72
 v_accvgpr_read_b32 v81, a73
 v_accvgpr_read_b32 v82, a74
 v_accvgpr_read_b32 v83, a75
 v_accvgpr_read_b32 v84, a88
 v_accvgpr_read_b32 v85, a89
 v_accvgpr_read_b32 v86, a90
 v_accvgpr_read_b32 v87, a91
 v_pk_mul_f32 v[80:81], v[80:81], s[88:89]
 v_pk_mul_f32 v[82:83], v[82:83], s[88:89]
 v_pk_mul_f32 v[84:85], v[84:85], s[88:89]
 v_pk_mul_f32 v[86:87], v[86:87], s[88:89]
 v_cvt_pk_bf16_f32 v184, v80, v81
 v_cvt_pk_bf16_f32 v185, v82, v83
 v_cvt_pk_bf16_f32 v186, v84, v85
 v_cvt_pk_bf16_f32 v187, v86, v87
 buffer_load_dwordx4 v3, s[20:23], s9 offen offset:3072 sc1 lds
 v_accvgpr_read_b32 v88, a104
 v_accvgpr_read_b32 v89, a105
 v_accvgpr_read_b32 v90, a106
 v_accvgpr_read_b32 v91, a107
 v_accvgpr_read_b32 v92, a120
 v_accvgpr_read_b32 v93, a121
 v_accvgpr_read_b32 v94, a122
 v_accvgpr_read_b32 v95, a123
 v_pk_mul_f32 v[88:89], v[88:89], s[88:89]
 v_pk_mul_f32 v[90:91], v[90:91], s[88:89]
 v_pk_mul_f32 v[92:93], v[92:93], s[88:89]
 v_pk_mul_f32 v[94:95], v[94:95], s[88:89]
 v_cvt_pk_bf16_f32 v188, v88, v89
 v_cvt_pk_bf16_f32 v189, v90, v91
 v_cvt_pk_bf16_f32 v190, v92, v93
 v_cvt_pk_bf16_f32 v191, v94, v95
 s_add_u32 s12, s12, 16384
 s_cmp_eq_u32 s12, 81920
 s_cselect_b32 s12, 0, s12
 s_add_u32 m0, s12, s77
 s_nop 0
 buffer_load_dwordx4 v3, s[24:27], s10 offen offset:0 sc1 lds
 buffer_load_dwordx4 v3, s[24:27], s10 offen offset:1024 sc1 lds
 s_waitcnt vmcnt(10)
 s_barrier
 s_cmp_lg_u32 s68, 0
 s_cbranch_scc1 gated_mix__compressed_kv_cla__glu_gated_swiglu__prompt_kernel_sig23
 s_mov_b64 exec, 1
 buffer_store_dwordx2 v[28:29], v21, s[36:39], s54 offen sc1
 s_mov_b64 exec, -1
gated_mix__compressed_kv_cla__glu_gated_swiglu__prompt_kernel_sig23:
 v_accvgpr_read_b32 v64, a136
 v_accvgpr_read_b32 v65, a137
 v_accvgpr_read_b32 v66, a138
 v_accvgpr_read_b32 v67, a139
 v_accvgpr_read_b32 v68, a152
 v_accvgpr_read_b32 v69, a153
 v_accvgpr_read_b32 v70, a154
 v_accvgpr_read_b32 v71, a155
 v_pk_mul_f32 v[64:65], v[64:65], s[88:89]
 v_pk_mul_f32 v[66:67], v[66:67], s[88:89]
 v_pk_mul_f32 v[68:69], v[68:69], s[88:89]
 v_pk_mul_f32 v[70:71], v[70:71], s[88:89]
 v_cvt_pk_bf16_f32 v192, v64, v65
 v_cvt_pk_bf16_f32 v193, v66, v67
 v_cvt_pk_bf16_f32 v194, v68, v69
 v_cvt_pk_bf16_f32 v195, v70, v71
 buffer_load_dwordx4 v3, s[24:27], s10 offen offset:2048 sc1 lds
 v_accvgpr_read_b32 v72, a168
 v_accvgpr_read_b32 v73, a169
 v_accvgpr_read_b32 v74, a170
 v_accvgpr_read_b32 v75, a171
 v_accvgpr_read_b32 v76, a184
 v_accvgpr_read_b32 v77, a185
 v_accvgpr_read_b32 v78, a186
 v_accvgpr_read_b32 v79, a187
 v_pk_mul_f32 v[72:73], v[72:73], s[88:89]
 v_pk_mul_f32 v[74:75], v[74:75], s[88:89]
 v_pk_mul_f32 v[76:77], v[76:77], s[88:89]
 v_pk_mul_f32 v[78:79], v[78:79], s[88:89]
 v_cvt_pk_bf16_f32 v196, v72, v73
 v_cvt_pk_bf16_f32 v197, v74, v75
 v_cvt_pk_bf16_f32 v198, v76, v77
 v_cvt_pk_bf16_f32 v199, v78, v79
 buffer_load_dwordx4 v3, s[24:27], s10 offen offset:3072 sc1 lds
 s_add_u32 s10, s9, 16384
 s_mov_b32 s26, s22
 s_add_u32 s6, s6, 1
 s_sub_u32 s7, s7, 1
 s_cmp_eq_u32 s7, s8
 s_cselect_b32 s6, s87, s6
 s_cmp_gt_i32 s7, 0
 s_cselect_b32 s22, s22, 0
 s_cselect_b32 s6, s6, 0
 s_lshl_b32 s9, s6, 15
 s_add_u32 s11, s11, 16384
 s_and_b32 s11, s11, 0xffff
 s_add_u32 m0, s11, s76
 s_nop 0
 buffer_load_dwordx4 v3, s[20:23], s9 offen offset:0 sc1 lds
 v_accvgpr_read_b32 v80, a200
 v_accvgpr_read_b32 v81, a201
 v_accvgpr_read_b32 v82, a202
 v_accvgpr_read_b32 v83, a203
 v_accvgpr_read_b32 v84, a216
 v_accvgpr_read_b32 v85, a217
 v_accvgpr_read_b32 v86, a218
 v_accvgpr_read_b32 v87, a219
 v_pk_mul_f32 v[80:81], v[80:81], s[88:89]
 v_pk_mul_f32 v[82:83], v[82:83], s[88:89]
 v_pk_mul_f32 v[84:85], v[84:85], s[88:89]
 v_pk_mul_f32 v[86:87], v[86:87], s[88:89]
 v_cvt_pk_bf16_f32 v200, v80, v81
 v_cvt_pk_bf16_f32 v201, v82, v83
 v_cvt_pk_bf16_f32 v202, v84, v85
 v_cvt_pk_bf16_f32 v203, v86, v87
 buffer_load_dwordx4 v3, s[20:23], s9 offen offset:1024 sc1 lds
 v_accvgpr_read_b32 v88, a232
 v_accvgpr_read_b32 v89, a233
 v_accvgpr_read_b32 v90, a234
 v_accvgpr_read_b32 v91, a235
 v_accvgpr_read_b32 v92, a248
 v_accvgpr_read_b32 v93, a249
 v_accvgpr_read_b32 v94, a250
 v_accvgpr_read_b32 v95, a251
 v_pk_mul_f32 v[88:89], v[88:89], s[88:89]
 v_pk_mul_f32 v[90:91], v[90:91], s[88:89]
 v_pk_mul_f32 v[92:93], v[92:93], s[88:89]
 v_pk_mul_f32 v[94:95], v[94:95], s[88:89]
 v_cvt_pk_bf16_f32 v204, v88, v89
 v_cvt_pk_bf16_f32 v205, v90, v91
 v_cvt_pk_bf16_f32 v206, v92, v93
 v_cvt_pk_bf16_f32 v207, v94, v95
 buffer_load_dwordx4 v3, s[20:23], s9 offen offset:2048 sc1 lds
 buffer_load_dwordx4 v3, s[20:23], s9 offen offset:3072 sc1 lds
 v_accvgpr_read_b32 v64, a12
 v_accvgpr_read_b32 v65, a13
 v_accvgpr_read_b32 v66, a14
 v_accvgpr_read_b32 v67, a15
 v_accvgpr_read_b32 v68, a28
 v_accvgpr_read_b32 v69, a29
 v_accvgpr_read_b32 v70, a30
 v_accvgpr_read_b32 v71, a31
 v_pk_mul_f32 v[64:65], v[64:65], s[88:89]
 v_pk_mul_f32 v[66:67], v[66:67], s[88:89]
 v_pk_mul_f32 v[68:69], v[68:69], s[88:89]
 v_pk_mul_f32 v[70:71], v[70:71], s[88:89]
 v_cvt_pk_bf16_f32 v208, v64, v65
 v_cvt_pk_bf16_f32 v209, v66, v67
 v_cvt_pk_bf16_f32 v210, v68, v69
 v_cvt_pk_bf16_f32 v211, v70, v71
 s_add_u32 s12, s12, 16384
 s_cmp_eq_u32 s12, 81920
 s_cselect_b32 s12, 0, s12
 s_add_u32 m0, s12, s77
 s_nop 0
 buffer_load_dwordx4 v3, s[24:27], s10 offen offset:0 sc1 lds
 v_accvgpr_read_b32 v72, a44
 v_accvgpr_read_b32 v73, a45
 v_accvgpr_read_b32 v74, a46
 v_accvgpr_read_b32 v75, a47
 v_accvgpr_read_b32 v76, a60
 v_accvgpr_read_b32 v77, a61
 v_accvgpr_read_b32 v78, a62
 v_accvgpr_read_b32 v79, a63
 v_pk_mul_f32 v[72:73], v[72:73], s[88:89]
 v_pk_mul_f32 v[74:75], v[74:75], s[88:89]
 v_pk_mul_f32 v[76:77], v[76:77], s[88:89]
 v_pk_mul_f32 v[78:79], v[78:79], s[88:89]
 v_cvt_pk_bf16_f32 v212, v72, v73
 v_cvt_pk_bf16_f32 v213, v74, v75
 v_cvt_pk_bf16_f32 v214, v76, v77
 v_cvt_pk_bf16_f32 v215, v78, v79
 buffer_load_dwordx4 v3, s[24:27], s10 offen offset:1024 sc1 lds
 buffer_load_dwordx4 v3, s[24:27], s10 offen offset:2048 sc1 lds
 v_accvgpr_read_b32 v80, a76
 v_accvgpr_read_b32 v81, a77
 v_accvgpr_read_b32 v82, a78
 v_accvgpr_read_b32 v83, a79
 v_accvgpr_read_b32 v84, a92
 v_accvgpr_read_b32 v85, a93
 v_accvgpr_read_b32 v86, a94
 v_accvgpr_read_b32 v87, a95
 v_pk_mul_f32 v[80:81], v[80:81], s[88:89]
 v_pk_mul_f32 v[82:83], v[82:83], s[88:89]
 v_pk_mul_f32 v[84:85], v[84:85], s[88:89]
 v_pk_mul_f32 v[86:87], v[86:87], s[88:89]
 v_cvt_pk_bf16_f32 v216, v80, v81
 v_cvt_pk_bf16_f32 v217, v82, v83
 v_cvt_pk_bf16_f32 v218, v84, v85
 v_cvt_pk_bf16_f32 v219, v86, v87
 buffer_load_dwordx4 v3, s[24:27], s10 offen offset:3072 sc1 lds
 v_accvgpr_read_b32 v88, a108
 v_accvgpr_read_b32 v89, a109
 v_accvgpr_read_b32 v90, a110
 v_accvgpr_read_b32 v91, a111
 v_accvgpr_read_b32 v92, a124
 v_accvgpr_read_b32 v93, a125
 v_accvgpr_read_b32 v94, a126
 v_accvgpr_read_b32 v95, a127
 v_pk_mul_f32 v[88:89], v[88:89], s[88:89]
 v_pk_mul_f32 v[90:91], v[90:91], s[88:89]
 v_pk_mul_f32 v[92:93], v[92:93], s[88:89]
 v_pk_mul_f32 v[94:95], v[94:95], s[88:89]
 v_cvt_pk_bf16_f32 v220, v88, v89
 v_cvt_pk_bf16_f32 v221, v90, v91
 v_cvt_pk_bf16_f32 v222, v92, v93
 v_cvt_pk_bf16_f32 v223, v94, v95
 s_add_u32 s10, s9, 16384
 s_mov_b32 s26, s22
 s_add_u32 s6, s6, 1
 s_sub_u32 s7, s7, 1
 s_cmp_eq_u32 s7, s8
 s_cselect_b32 s6, s87, s6
 s_cmp_gt_i32 s7, 0
 s_cselect_b32 s22, s22, 0
 s_cselect_b32 s6, s6, 0
 s_lshl_b32 s9, s6, 15
 s_add_u32 s11, s11, 16384
 s_and_b32 s11, s11, 0xffff
 s_add_u32 m0, s11, s76
 s_nop 0
 buffer_load_dwordx4 v3, s[20:23], s9 offen offset:0 sc1 lds
 buffer_load_dwordx4 v3, s[20:23], s9 offen offset:1024 sc1 lds
 v_accvgpr_read_b32 v64, a140
 v_accvgpr_read_b32 v65, a141
 v_accvgpr_read_b32 v66, a142
 v_accvgpr_read_b32 v67, a143
 v_accvgpr_read_b32 v68, a156
 v_accvgpr_read_b32 v69, a157
 v_accvgpr_read_b32 v70, a158
 v_accvgpr_read_b32 v71, a159
 v_pk_mul_f32 v[64:65], v[64:65], s[88:89]
 v_pk_mul_f32 v[66:67], v[66:67], s[88:89]
 v_pk_mul_f32 v[68:69], v[68:69], s[88:89]
 v_pk_mul_f32 v[70:71], v[70:71], s[88:89]
 v_cvt_pk_bf16_f32 v224, v64, v65
 v_cvt_pk_bf16_f32 v225, v66, v67
 v_cvt_pk_bf16_f32 v226, v68, v69
 v_cvt_pk_bf16_f32 v227, v70, v71
 buffer_load_dwordx4 v3, s[20:23], s9 offen offset:2048 sc1 lds
 v_accvgpr_read_b32 v72, a172
 v_accvgpr_read_b32 v73, a173
 v_accvgpr_read_b32 v74, a174
 v_accvgpr_read_b32 v75, a175
 v_accvgpr_read_b32 v76, a188
 v_accvgpr_read_b32 v77, a189
 v_accvgpr_read_b32 v78, a190
 v_accvgpr_read_b32 v79, a191
 v_pk_mul_f32 v[72:73], v[72:73], s[88:89]
 v_pk_mul_f32 v[74:75], v[74:75], s[88:89]
 v_pk_mul_f32 v[76:77], v[76:77], s[88:89]
 v_pk_mul_f32 v[78:79], v[78:79], s[88:89]
 v_cvt_pk_bf16_f32 v228, v72, v73
 v_cvt_pk_bf16_f32 v229, v74, v75
 v_cvt_pk_bf16_f32 v230, v76, v77
 v_cvt_pk_bf16_f32 v231, v78, v79
 buffer_load_dwordx4 v3, s[20:23], s9 offen offset:3072 sc1 lds
 s_add_u32 s12, s12, 16384
 s_cmp_eq_u32 s12, 81920
 s_cselect_b32 s12, 0, s12
 s_add_u32 m0, s12, s77
 s_nop 0
 buffer_load_dwordx4 v3, s[24:27], s10 offen offset:0 sc1 lds
 v_accvgpr_read_b32 v80, a204
 v_accvgpr_read_b32 v81, a205
 v_accvgpr_read_b32 v82, a206
 v_accvgpr_read_b32 v83, a207
 v_accvgpr_read_b32 v84, a220
 v_accvgpr_read_b32 v85, a221
 v_accvgpr_read_b32 v86, a222
 v_accvgpr_read_b32 v87, a223
 v_pk_mul_f32 v[80:81], v[80:81], s[88:89]
 v_pk_mul_f32 v[82:83], v[82:83], s[88:89]
 v_pk_mul_f32 v[84:85], v[84:85], s[88:89]
 v_pk_mul_f32 v[86:87], v[86:87], s[88:89]
 v_cvt_pk_bf16_f32 v232, v80, v81
 v_cvt_pk_bf16_f32 v233, v82, v83
 v_cvt_pk_bf16_f32 v234, v84, v85
 v_cvt_pk_bf16_f32 v235, v86, v87
 buffer_load_dwordx4 v3, s[24:27], s10 offen offset:1024 sc1 lds
 v_accvgpr_read_b32 v88, a236
 v_accvgpr_read_b32 v89, a237
 v_accvgpr_read_b32 v90, a238
 v_accvgpr_read_b32 v91, a239
 v_accvgpr_read_b32 v92, a252
 v_accvgpr_read_b32 v93, a253
 v_accvgpr_read_b32 v94, a254
 v_accvgpr_read_b32 v95, a255
 v_pk_mul_f32 v[88:89], v[88:89], s[88:89]
 v_pk_mul_f32 v[90:91], v[90:91], s[88:89]
 v_pk_mul_f32 v[92:93], v[92:93], s[88:89]
 v_pk_mul_f32 v[94:95], v[94:95], s[88:89]
 v_cvt_pk_bf16_f32 v236, v88, v89
 v_cvt_pk_bf16_f32 v237, v90, v91
 v_cvt_pk_bf16_f32 v238, v92, v93
 v_cvt_pk_bf16_f32 v239, v94, v95
 buffer_load_dwordx4 v3, s[24:27], s10 offen offset:2048 sc1 lds
 buffer_load_dwordx4 v3, s[24:27], s10 offen offset:3072 sc1 lds
gated_mix__compressed_kv_cla__glu_gated_swiglu__prompt_kernel_attn:
 v_mov_b32 v104, 0
 v_mov_b32 v105, 0
 v_mov_b32 v106, 0
 v_mov_b32 v107, 0
 s_mov_b32 s13, 0
 s_mov_b32 s14, 65536
 v_add_u32 v1, 0, v21
 v_add_u32 v2, 65536, v21
 v_mfma_f32_32x32x16_bf16 a[0:15], v[104:107], v[104:107], 0
 s_mov_b32 s79, 1166016512
 s_mov_b32 s80, 4048155338
 s_mov_b32 s70, -1
 s_mov_b32 s3, -1
 s_cmp_gt_u32 s85, 24
 s_cselect_b32 s78, 18, -1
 s_cmp_eq_u32 s81, 1
 s_cselect_b32 s78, 3, s78
 s_cmp_eq_u32 s86, 8
 s_cselect_b32 s78, 24, s78
 s_sub_u32 s4, s78, 2
 s_lshl_b32 s91, s82, 3
 s_add_u32 s91, s91, s83
 s_lshl_b32 s72, s91, 2
 s_add_u32 s72, s72, s68
 v_mfma_f32_32x32x16_bf16 a[16:31], v[104:107], v[104:107], 0
 s_mul_i32 s72, s72, 20480
 s_add_u32 s72, s72, 41943040
 s_mul_i32 s74, s91, 384
 s_add_u32 s74, s74, 52690944
 s_lshl_b32 s97, s84, 3
 s_add_u32 s97, s97, s83
 s_mov_b32 s98, s85
 s_lshr_b32 s92, s82, 2
 s_lshl_b32 s92, s92, 1
 s_and_b32 s93, s82, 1
 s_add_u32 s92, s92, s93
 s_mul_i32 s93, s92, 3
 s_add_u32 s93, s93, 32
 s_lshl_b32 s92, s92, 2
 v_mfma_f32_32x32x16_bf16 a[32:47], v[104:107], v[104:107], 0
 s_bitcmp0_b32 s82, 1
 s_cselect_b32 s84, s92, s93
 s_cselect_b32 s85, 4, 3
 s_cmp_lt_u32 s68, s85
 s_cselect_b32 s62, 1605632, 0
 s_lshr_b32 s92, s86, 1
 s_mul_i32 s92, s92, 14
 s_add_u32 s94, s84, s85
 s_sub_u32 s94, s94, 1
 s_lshr_b32 s94, s94, 2
 s_add_u32 s94, s94, s92
 s_mul_i32 s94, s94, 384
 s_add_u32 s94, s94, 52559872
 v_mfma_f32_32x32x16_bf16 a[48:63], v[104:107], v[104:107], 0
 s_lshr_b32 s93, s84, 2
 s_add_u32 s92, s92, s93
 s_mul_i32 s92, s92, 384
 s_add_u32 s92, s92, 52559872
 s_cmp_eq_u32 s81, 1
 s_cselect_b32 s93, s74, s92
 v_mov_b32 v30, s93
 s_mov_b32 exec_hi, 0
 v_mov_b32 v30, s92
 s_mov_b32 exec_lo, 0xffff
 v_mov_b32 v30, s94
 s_mov_b64 exec, -1
 v_mfma_f32_32x32x16_bf16 a[64:79], v[104:107], v[104:107], 0
 s_mov_b32 s92, s97
 s_lshl_b32 s93, s82, 4
 s_add_u32 s93, s93, s92
 s_mul_i32 s93, s93, 14336
 s_mul_i32 s94, s68, 5120
 s_add_u32 s93, s93, s94
 s_mul_i32 s95, s85, 1792
 s_mul_i32 s94, s92, s95
 s_mul_i32 s96, s84, 28672
 s_add_u32 s94, s94, s96
 v_mfma_f32_32x32x16_bf16 a[80:95], v[104:107], v[104:107], 0
 s_cmp_eq_u32 s68, 2
 s_movk_i32 s5, 5120
 s_cselect_b32 s5, 4096, s5
 s_cmp_eq_u32 s68, 3
 s_cselect_b32 s5, s95, s5
 s_cselect_b32 s93, s94, s93
 s_cselect_b32 s40, s60, s56
 s_cselect_b32 s41, s61, s57
 s_add_u32 s40, s40, s93
 s_addc_u32 s41, s41, 0
 s_mov_b32 s42, 0
 v_lshlrev_b32 v14, 3, v21
 s_mov_b32 s88, 0
 s_mov_b32 s89, 0
 v_mfma_f32_32x32x16_bf16 a[96:111], v[104:107], v[104:107], 0
 v_and_b32 v88, 63, v0
 v_and_b32 v89, 15, v88
 v_lshrrev_b32 v88, 4, v88
 v_lshlrev_b32 v88, 2, v88
 v_add_u32 v90, 0, v88
 v_cmp_le_u32 s[28:29], v90, v89
 v_add_u32 v90, 1, v88
 v_cmp_le_u32 s[30:31], v90, v89
 v_add_u32 v90, 2, v88
 v_cmp_le_u32 s[32:33], v90, v89
 v_add_u32 v90, 3, v88
 v_cmp_le_u32 s[34:35], v90, v89
 v_mfma_f32_32x32x16_bf16 a[112:127], v[104:107], v[104:107], 0
 v_and_b32 v92, 63, v0
 v_lshrrev_b32 v93, 3, v92
 v_mul_u32_u24 v93, 896, v93
 v_bfe_u32 v94, v92, 1, 2
 v_lshrrev_b32 v95, 4, v92
 v_xor_b32 v94, v94, v95
 v_lshl_add_u32 v93, v94, 5, v93
 v_and_b32 v94, 1, v92
 v_lshl_add_u32 v10, v94, 4, v93
 v_add_u32 v11, 6144, v10
 v_add_u32 v12, 12288, v10
 v_add_u32 v13, 18432, v10
 s_cmp_eq_u32 s81, 1
 s_cbranch_scc1 gated_mix__compressed_kv_cla__glu_gated_swiglu__prompt_kernel_go1
 s_waitcnt vmcnt(24)
 s_barrier
 s_branch gated_mix__compressed_kv_cla__glu_gated_swiglu__prompt_kernel_go
gated_mix__compressed_kv_cla__glu_gated_swiglu__prompt_kernel_go1:
 s_mov_b32 s70, 15
 s_mov_b32 s3, 6
 s_waitcnt vmcnt(0)
 s_barrier
 s_cmp_lg_u32 s68, 0
 s_cbranch_scc1 gated_mix__compressed_kv_cla__glu_gated_swiglu__prompt_kernel_sig24
 s_mov_b64 exec, 1
 buffer_store_dwordx2 v[28:29], v21, s[36:39], s52 offen sc1
 s_mov_b64 exec, -1
gated_mix__compressed_kv_cla__glu_gated_swiglu__prompt_kernel_sig24:
 s_mov_b32 s52, 0
 s_mov_b32 s54, 2
gated_mix__compressed_kv_cla__glu_gated_swiglu__prompt_kernel_go:
gated_mix__compressed_kv_cla__glu_gated_swiglu__prompt_kernel_piece:
 s_sub_u32 s91, s17, 3
 s_add_u32 s91, s91, s68
 s_cmp_eq_u32 s71, 0
 s_cselect_b32 s16, s17, s91
 s_cselect_b32 s69, 0, s91
 s_sub_u32 s69, s69, 2
 ds_read_b128 a[192:195], v1 offset:0
 ds_read_b128 a[196:199], v1 offset:1024
 ds_read_b128 a[200:203], v1 offset:2048
 ds_read_b128 a[204:207], v1 offset:3072
 ds_read_b128 a[208:211], v1 offset:4096
 ds_read_b128 a[212:215], v1 offset:5120
 ds_read_b128 a[216:219], v1 offset:6144
 ds_read_b128 a[220:223], v1 offset:7168
 ds_read_b128 a[224:227], v1 offset:8192
 ds_read_b128 a[228:231], v1 offset:9216
 ds_read_b128 a[232:235], v1 offset:10240
 ds_read_b128 a[236:239], v1 offset:11264
 ds_read_b128 a[240:243], v1 offset:12288
 ds_read_b128 a[244:247], v1 offset:13312
 ds_read_b128 a[248:251], v1 offset:14336
 ds_read_b128 a[252:255], v1 offset:15360
 v_mov_b32 v4, 0
 v_mov_b32 v5, 0
 v_mov_b32 v72, 0
 v_mov_b32 v73, 0
 v_mov_b32 v74, 0
 v_mov_b32 v75, 0
 v_mov_b32 v76, 0
 v_mov_b32 v77, 0
 v_mov_b32 v78, 0
 v_mov_b32 v79, 0
 v_mov_b32 v80, 0
 v_mov_b32 v81, 0
 v_mov_b32 v82, 0
 v_mov_b32 v83, 0
 v_mov_b32 v84, 0
 v_mov_b32 v85, 0
 v_mov_b32 v86, 0
 v_mov_b32 v87, 0
 s_waitcnt lgkmcnt(12)
 s_cmp_lg_u32 s69, -1
 s_cbranch_scc1 gated_mix__compressed_kv_cla__glu_gated_swiglu__prompt_kernel_nomask0
 buffer_load_dwordx2 v[22:23], v30, s[36:39], 0 offen sc1
 v_mov_b32 v80, s80
 v_mov_b32 v81, s80
 v_mov_b32 v82, s80
 v_mov_b32 v83, s80
 v_mov_b32 v88, s80
 v_cndmask_b32 v72, v88, v72, s[28:29]
 v_cndmask_b32 v84, v88, v84, s[28:29]
 v_cndmask_b32 v73, v88, v73, s[30:31]
 v_cndmask_b32 v85, v88, v85, s[30:31]
 v_cndmask_b32 v74, v88, v74, s[32:33]
 v_cndmask_b32 v86, v88, v86, s[32:33]
 v_cndmask_b32 v75, v88, v75, s[34:35]
 v_cndmask_b32 v87, v88, v87, s[34:35]
 s_nop 1
gated_mix__compressed_kv_cla__glu_gated_swiglu__prompt_kernel_nomask0:
 v_mfma_f32_16x16x32_bf16 v[32:35], a[192:195], v[112:115], v[72:75]
 v_mfma_f32_16x16x32_bf16 v[36:39], a[192:195], v[144:147], v[76:79]
 v_mfma_f32_16x16x32_bf16 v[36:39], a[196:199], v[148:151], v[36:39]
 v_mfma_f32_16x16x32_bf16 v[32:35], a[196:199], v[116:119], v[32:35]
 v_mfma_f32_16x16x32_bf16 v[32:35], a[200:203], v[120:123], v[32:35]
 v_mfma_f32_16x16x32_bf16 v[36:39], a[200:203], v[152:155], v[36:39]
 v_mfma_f32_16x16x32_bf16 v[36:39], a[204:207], v[156:159], v[36:39]
 v_mfma_f32_16x16x32_bf16 v[32:35], a[204:207], v[124:127], v[32:35]
 s_waitcnt lgkmcnt(8)
 v_mfma_f32_16x16x32_bf16 v[32:35], a[208:211], v[128:131], v[32:35]
 v_mfma_f32_16x16x32_bf16 v[36:39], a[208:211], v[160:163], v[36:39]
 v_mfma_f32_16x16x32_bf16 v[36:39], a[212:215], v[164:167], v[36:39]
 v_mfma_f32_16x16x32_bf16 v[32:35], a[212:215], v[132:135], v[32:35]
 v_mfma_f32_16x16x32_bf16 v[32:35], a[216:219], v[136:139], v[32:35]
 v_mfma_f32_16x16x32_bf16 v[36:39], a[216:219], v[168:171], v[36:39]
 v_mfma_f32_16x16x32_bf16 v[36:39], a[220:223], v[172:175], v[36:39]
 v_mfma_f32_16x16x32_bf16 v[32:35], a[220:223], v[140:143], v[32:35]
 s_waitcnt lgkmcnt(4)
 v_mfma_f32_16x16x32_bf16 v[40:43], a[224:227], v[112:115], v[80:83]
 v_mfma_f32_16x16x32_bf16 v[44:47], a[224:227], v[144:147], v[84:87]
 v_mfma_f32_16x16x32_bf16 v[44:47], a[228:231], v[148:151], v[44:47]
 v_mfma_f32_16x16x32_bf16 v[40:43], a[228:231], v[116:119], v[40:43]
 v_mfma_f32_16x16x32_bf16 v[40:43], a[232:235], v[120:123], v[40:43]
 v_mfma_f32_16x16x32_bf16 v[44:47], a[232:235], v[152:155], v[44:47]
 v_mfma_f32_16x16x32_bf16 v[44:47], a[236:239], v[156:159], v[44:47]
 v_mfma_f32_16x16x32_bf16 v[40:43], a[236:239], v[124:127], v[40:43]
 s_waitcnt lgkmcnt(0)
 v_mfma_f32_16x16x32_bf16 v[40:43], a[240:243], v[128:131], v[40:43]
 v_mfma_f32_16x16x32_bf16 v[44:47], a[240:243], v[160:163], v[44:47]
 s_add_u32 s13, s13, 16384
 v_mfma_f32_16x16x32_bf16 v[44:47], a[244:247], v[164:167], v[44:47]
 s_and_b32 s13, s13, 0xffff
 v_mfma_f32_16x16x32_bf16 v[40:43], a[244:247], v[132:135], v[40:43]
 v_add_u32 v1, s13, v21
 v_mfma_f32_16x16x32_bf16 v[40:43], a[248:251], v[136:139], v[40:43]
 v_mfma_f32_16x16x32_bf16 v[44:47], a[248:251], v[168:171], v[44:47]
 v_mfma_f32_16x16x32_bf16 v[44:47], a[252:255], v[172:175], v[44:47]
 v_mfma_f32_16x16x32_bf16 v[40:43], a[252:255], v[140:143], v[40:43]
 s_waitcnt vmcnt(16)
 s_barrier
 ds_read_b128 a[192:195], v1 offset:0
 ds_read_b128 a[196:199], v1 offset:1024
 ds_read_b128 a[200:203], v1 offset:2048
 ds_read_b128 a[204:207], v1 offset:3072
 ds_read_b128 a[208:211], v1 offset:4096
 ds_read_b128 a[212:215], v1 offset:5120
 ds_read_b128 a[216:219], v1 offset:6144
 ds_read_b128 a[220:223], v1 offset:7168
 buffer_load_dword v31, off, s[48:51], 0
 buffer_load_dword v31, off, s[48:51], 0
 s_add_u32 s10, s9, 16384
 s_mov_b32 s26, s22
 s_add_u32 s6, s6, 1
 s_sub_u32 s7, s7, 1
 s_cmp_eq_u32 s7, s8
 s_cselect_b32 s6, s87, s6
 s_cmp_gt_i32 s7, 0
 s_cselect_b32 s22, s22, 0
 s_cselect_b32 s6, s6, 0
 s_lshl_b32 s9, s6, 15
 s_add_u32 s11, s11, 16384
 s_and_b32 s11, s11, 0xffff
 s_add_u32 m0, s11, s76
 s_nop 0
 buffer_load_dwordx4 v3, s[20:23], s9 offen offset:0 sc1 lds
 buffer_load_dwordx4 v3, s[20:23], s9 offen offset:1024 sc1 lds
 buffer_load_dwordx4 v3, s[20:23], s9 offen offset:2048 sc1 lds
 buffer_load_dwordx4 v3, s[20:23], s9 offen offset:3072 sc1 lds
 s_add_u32 s12, s12, 16384
 s_cmp_eq_u32 s12, 81920
 s_cselect_b32 s12, 0, s12
 s_add_u32 m0, s12, s77
 s_nop 0
 v_max3_f32 v88, v32, v33, v34
 v_max3_f32 v88, v88, v35, v40
 v_max3_f32 v88, v88, v41, v42
 v_max_f32 v88, v88, v43
 v_max3_f32 v89, v36, v37, v38
 v_max3_f32 v89, v89, v39, v44
 v_max3_f32 v89, v89, v45, v46
 v_max_f32 v89, v89, v47
 v_mov_b32 v90, v88
 s_nop 1
 v_permlane32_swap_b32 v88, v90
 v_max_f32 v88, v88, v90
 v_mov_b32 v90, v88
 s_nop 1
 v_permlane16_swap_b32 v88, v90
 v_max_f32 v88, v88, v90
 v_sub_f32 v4, v4, v88
 v_mov_b32 v90, v89
 s_nop 1
 v_permlane32_swap_b32 v89, v90
 v_max_f32 v89, v89, v90
 v_mov_b32 v90, v89
 s_nop 1
 v_permlane16_swap_b32 v89, v90
 v_max_f32 v89, v89, v90
 v_sub_f32 v5, v5, v89
 v_sub_f32 v32, v32, v88
 v_mov_b32 v72, v4
 v_sub_f32 v33, v33, v88
 v_mov_b32 v73, v4
 v_sub_f32 v34, v34, v88
 v_mov_b32 v74, v4
 v_sub_f32 v35, v35, v88
 v_mov_b32 v75, v4
 v_sub_f32 v36, v36, v89
 v_mov_b32 v76, v5
 v_sub_f32 v37, v37, v89
 v_mov_b32 v77, v5
 v_sub_f32 v38, v38, v89
 v_mov_b32 v78, v5
 v_sub_f32 v39, v39, v89
 v_mov_b32 v79, v5
 v_sub_f32 v40, v40, v88
 v_mov_b32 v80, v4
 v_sub_f32 v41, v41, v88
 v_mov_b32 v81, v4
 v_sub_f32 v42, v42, v88
 v_mov_b32 v82, v4
 v_sub_f32 v43, v43, v88
 v_mov_b32 v83, v4
 v_sub_f32 v44, v44, v89
 v_mov_b32 v84, v5
 v_sub_f32 v45, v45, v89
 v_mov_b32 v85, v5
 v_sub_f32 v46, v46, v89
 v_mov_b32 v86, v5
 v_sub_f32 v47, v47, v89
 v_mov_b32 v87, v5
 v_exp_f32 v48, v32
 v_exp_f32 v49, v33
 v_exp_f32 v50, v34
 v_exp_f32 v51, v35
 v_exp_f32 v52, v36
 v_exp_f32 v53, v37
 v_exp_f32 v54, v38
 v_exp_f32 v55, v39
 v_exp_f32 v56, v40
 v_exp_f32 v57, v41
 v_exp_f32 v58, v42
 v_exp_f32 v59, v43
 v_exp_f32 v60, v44
 v_exp_f32 v61, v45
 v_exp_f32 v62, v46
 v_exp_f32 v63, v47
 v_add_f32 v8, v48, v49
 v_add_f32 v8, v8, v50
 v_add_f32 v8, v8, v51
 v_add_f32 v8, v8, v56
 v_add_f32 v8, v8, v57
 v_add_f32 v8, v8, v58
 v_add_f32 v8, v8, v59
 v_add_f32 v9, v52, v53
 v_add_f32 v9, v9, v54
 v_add_f32 v9, v9, v55
 v_add_f32 v9, v9, v60
 v_add_f32 v9, v9, v61
 v_add_f32 v9, v9, v62
 v_add_f32 v9, v9, v63
 v_mov_b32 v6, 0
 v_mov_b32 v7, 0
 s_mov_b32 s15, 0
 s_cmp_eq_u32 s16, 1
 s_cbranch_scc1 gated_mix__compressed_kv_cla__glu_gated_swiglu__prompt_kernel_final
 s_waitcnt lgkmcnt(4)
 s_branch gated_mix__compressed_kv_cla__glu_gated_swiglu__prompt_kernel_event
.p2align 3
gated_mix__compressed_kv_cla__glu_gated_swiglu__prompt_kernel_loop:
 v_mfma_f32_16x16x32_bf16 v[32:35], a[192:195], v[112:115], v[72:75]
 s_add_u32 m0, s12, s77
 ds_read_b128 a[224:227], v1 offset:8192
 v_add_f32 v6, v6, v8
 v_mfma_f32_16x16x32_bf16 v[36:39], a[192:195], v[144:147], v[76:79]
 s_add_u32 s13, s13, 16384
 v_add_f32 v7, v7, v9
 v_mfma_f32_16x16x32_bf16 v[36:39], a[196:199], v[148:151], v[36:39]
 s_and_b32 s13, s13, 0xffff
 ds_read_b128 a[228:231], v1 offset:9216
 v_cvt_pk_bf16_f32 v64, v48, v49
 v_mfma_f32_16x16x32_bf16 v[32:35], a[196:199], v[116:119], v[32:35]
 buffer_load_dwordx4 v3, s[24:27], s10 offen offset:0 sc1 lds
 v_mfma_f32_16x16x32_bf16 v[32:35], a[200:203], v[120:123], v[32:35]
 s_add_u32 s14, s14, 16384
 ds_read_b128 a[232:235], v1 offset:10240
 v_cvt_pk_bf16_f32 v65, v50, v51
 v_mfma_f32_16x16x32_bf16 v[36:39], a[200:203], v[152:155], v[36:39]
 s_cmp_eq_u32 s14, 147456
 v_mfma_f32_16x16x32_bf16 v[36:39], a[204:207], v[156:159], v[36:39]
 s_cselect_b32 s14, 65536, s14
 ds_read_b128 a[236:239], v1 offset:11264
 v_cvt_pk_bf16_f32 v68, v52, v53
 v_mfma_f32_16x16x32_bf16 v[32:35], a[204:207], v[124:127], v[32:35]
 s_waitcnt lgkmcnt(4)
 buffer_load_dwordx4 v3, s[24:27], s10 offen offset:1024 sc1 lds
 v_mfma_f32_16x16x32_bf16 v[32:35], a[208:211], v[128:131], v[32:35]
 ds_read_b128 a[240:243], v1 offset:12288
 v_cvt_pk_bf16_f32 v69, v54, v55
 v_mfma_f32_16x16x32_bf16 v[36:39], a[208:211], v[160:163], v[36:39]
 v_add_u32 v14, s88, v14
 v_mfma_f32_16x16x32_bf16 v[36:39], a[212:215], v[164:167], v[36:39]
 ds_read_b128 a[244:247], v1 offset:13312
 v_cvt_pk_bf16_f32 v66, v56, v57
 v_mfma_f32_16x16x32_bf16 v[32:35], a[212:215], v[132:135], v[32:35]
 buffer_load_dwordx4 v3, s[24:27], s10 offen offset:2048 sc1 lds
 v_mfma_f32_16x16x32_bf16 v[32:35], a[216:219], v[136:139], v[32:35]
 ds_read_b128 a[248:251], v1 offset:14336
 v_cvt_pk_bf16_f32 v67, v58, v59
 v_mfma_f32_16x16x32_bf16 v[36:39], a[216:219], v[168:171], v[36:39]
 v_mfma_f32_16x16x32_bf16 v[36:39], a[220:223], v[172:175], v[36:39]
 ds_read_b128 a[252:255], v1 offset:15360
 v_cvt_pk_bf16_f32 v70, v60, v61
 v_mfma_f32_16x16x32_bf16 v[32:35], a[220:223], v[140:143], v[32:35]
 s_waitcnt lgkmcnt(4)
 buffer_load_dwordx4 v3, s[24:27], s10 offen offset:3072 sc1 lds
 v_mfma_f32_16x16x32_bf16 v[40:43], a[224:227], v[112:115], v[80:83]
 s_add_u32 s10, s9, 16384
 ds_read_b128 a[192:195], v2 offset:0
 v_cvt_pk_bf16_f32 v71, v62, v63
 v_mfma_f32_16x16x32_bf16 v[44:47], a[224:227], v[144:147], v[84:87]
 s_mov_b32 s26, s22
 v_exp_f32 v48, v32
 v_mfma_f32_16x16x32_bf16 v[44:47], a[228:231], v[148:151], v[44:47]
 s_add_u32 s6, s6, 1
 ds_read_b128 a[196:199], v2 offset:1024
 v_add_u32 v1, s13, v21
 v_mfma_f32_16x16x32_bf16 v[40:43], a[228:231], v[116:119], v[40:43]
 s_sub_u32 s7, s7, 1
 v_exp_f32 v49, v33
 v_mfma_f32_16x16x32_bf16 v[40:43], a[232:235], v[120:123], v[40:43]
 s_cmp_eq_u32 s7, s8
 ds_read_b128 a[200:203], v2 offset:2048
 v_add_f32 v8, v48, v49
 v_mfma_f32_16x16x32_bf16 v[44:47], a[232:235], v[152:155], v[44:47]
 s_cselect_b32 s6, s87, s6
 v_exp_f32 v50, v34
 v_mfma_f32_16x16x32_bf16 v[44:47], a[236:239], v[156:159], v[44:47]
 s_cmp_gt_i32 s7, 0
 ds_read_b128 a[204:207], v2 offset:3072
 v_add_f32 v8, v8, v50
 v_mfma_f32_16x16x32_bf16 v[40:43], a[236:239], v[124:127], v[40:43]
 s_waitcnt lgkmcnt(4)
 v_exp_f32 v51, v35
 v_mfma_f32_16x16x32_bf16 v[40:43], a[240:243], v[128:131], v[40:43]
 s_cselect_b32 s22, s22, 0
 ds_read_b128 a[208:211], v2 offset:4096
 v_add_f32 v8, v8, v51
 v_mfma_f32_16x16x32_bf16 v[44:47], a[240:243], v[160:163], v[44:47]
 s_cselect_b32 s6, s6, 0
 v_exp_f32 v52, v36
 v_mfma_f32_16x16x32_bf16 v[44:47], a[244:247], v[164:167], v[44:47]
 s_lshl_b32 s9, s6, 15
 ds_read_b128 a[212:215], v2 offset:5120
 buffer_load_dword v31, v14, s[40:43], 0 offen
 v_mfma_f32_16x16x32_bf16 v[40:43], a[244:247], v[132:135], v[40:43]
 s_add_u32 s11, s11, 16384
 v_exp_f32 v53, v37
 v_mfma_f32_16x16x32_bf16 v[40:43], a[248:251], v[136:139], v[40:43]
 s_and_b32 s11, s11, 0xffff
 ds_read_b128 a[216:219], v2 offset:6144
 v_add_f32 v9, v52, v53
 v_mfma_f32_16x16x32_bf16 v[44:47], a[248:251], v[168:171], v[44:47]
 s_add_u32 m0, s11, s76
 v_exp_f32 v54, v38
 v_mfma_f32_16x16x32_bf16 v[44:47], a[252:255], v[172:175], v[44:47]
 s_add_u32 s12, s12, 16384
 ds_read_b128 a[220:223], v2 offset:7168
 v_add_f32 v9, v9, v54
 v_mfma_f32_16x16x32_bf16 v[40:43], a[252:255], v[140:143], v[40:43]
 s_waitcnt lgkmcnt(4)
 v_exp_f32 v55, v39
 v_mfma_f32_16x16x32_bf16 a[0:3], a[192:195], v[64:67], a[0:3]
 s_cmp_eq_u32 s12, 81920
 ds_read_b128 a[224:227], v2 offset:8192
 v_add_f32 v9, v9, v55
 v_mfma_f32_16x16x32_bf16 a[4:7], a[192:195], v[68:71], a[4:7]
 s_cselect_b32 s12, 0, s12
 v_exp_f32 v56, v40
 v_mfma_f32_16x16x32_bf16 a[12:15], a[196:199], v[68:71], a[12:15]
 s_mov_b32 s88, s89
 ds_read_b128 a[228:231], v2 offset:9216
 v_add_f32 v8, v8, v56
 v_mfma_f32_16x16x32_bf16 a[8:11], a[196:199], v[64:67], a[8:11]
 s_cmp_lt_i32 s7, 16
 v_exp_f32 v57, v41
 v_mfma_f32_16x16x32_bf16 a[16:19], a[200:203], v[64:67], a[16:19]
 s_cselect_b32 s42, s5, 0
 ds_read_b128 a[232:235], v2 offset:10240
 v_add_f32 v8, v8, v57
 v_mfma_f32_16x16x32_bf16 a[20:23], a[200:203], v[68:71], a[20:23]
 s_cselect_b32 s89, 8192, 0
 v_exp_f32 v58, v42
 v_mfma_f32_16x16x32_bf16 a[28:31], a[204:207], v[68:71], a[28:31]
 ds_read_b128 a[236:239], v2 offset:11264
 v_add_f32 v8, v8, v58
 v_mfma_f32_16x16x32_bf16 a[24:27], a[204:207], v[64:67], a[24:27]
 s_waitcnt lgkmcnt(4)
 v_exp_f32 v59, v43
 v_mfma_f32_16x16x32_bf16 a[32:35], a[208:211], v[64:67], a[32:35]
 ds_read_b128 a[240:243], v2 offset:12288
 v_add_f32 v8, v8, v59
 v_mfma_f32_16x16x32_bf16 a[36:39], a[208:211], v[68:71], a[36:39]
 v_exp_f32 v60, v44
 v_mfma_f32_16x16x32_bf16 a[44:47], a[212:215], v[68:71], a[44:47]
 ds_read_b128 a[244:247], v2 offset:13312
 v_add_f32 v9, v9, v60
 v_mfma_f32_16x16x32_bf16 a[40:43], a[212:215], v[64:67], a[40:43]
 v_exp_f32 v61, v45
 v_mfma_f32_16x16x32_bf16 a[48:51], a[216:219], v[64:67], a[48:51]
 ds_read_b128 a[248:251], v2 offset:14336
 v_add_f32 v9, v9, v61
 v_mfma_f32_16x16x32_bf16 a[52:55], a[216:219], v[68:71], a[52:55]
 v_exp_f32 v62, v46
 v_mfma_f32_16x16x32_bf16 a[60:63], a[220:223], v[68:71], a[60:63]
 ds_read_b128 a[252:255], v2 offset:15360
 v_add_f32 v9, v9, v62
 v_mfma_f32_16x16x32_bf16 a[56:59], a[220:223], v[64:67], a[56:59]
 s_waitcnt lgkmcnt(4)
 s_waitcnt vmcnt(19)
 s_barrier
 v_mfma_f32_16x16x32_bf16 a[64:67], a[224:227], v[64:67], a[64:67]
 ds_read_b128 a[192:195], v1 offset:0
 v_add_u32 v2, s14, v21
 v_mfma_f32_16x16x32_bf16 a[68:71], a[224:227], v[68:71], a[68:71]
 v_exp_f32 v63, v47
 v_mfma_f32_16x16x32_bf16 a[76:79], a[228:231], v[68:71], a[76:79]
 ds_read_b128 a[196:199], v1 offset:1024
 v_add_f32 v9, v9, v63
 v_mfma_f32_16x16x32_bf16 a[72:75], a[228:231], v[64:67], a[72:75]
 buffer_load_dwordx4 v3, s[20:23], s9 offen offset:0 sc1 lds
 v_mfma_f32_16x16x32_bf16 a[80:83], a[232:235], v[64:67], a[80:83]
 ds_read_b128 a[200:203], v1 offset:2048
 v_max_f32 v88, v8, v9
 v_mfma_f32_16x16x32_bf16 a[84:87], a[232:235], v[68:71], a[84:87]
 v_mfma_f32_16x16x32_bf16 a[92:95], a[236:239], v[68:71], a[92:95]
 ds_read_b128 a[204:207], v1 offset:3072
 v_cmp_nge_f32 vcc, s79, v88
 v_mfma_f32_16x16x32_bf16 a[88:91], a[236:239], v[64:67], a[88:91]
 s_waitcnt lgkmcnt(4)
 buffer_load_dwordx4 v3, s[20:23], s9 offen offset:1024 sc1 lds
 v_mfma_f32_16x16x32_bf16 a[96:99], a[240:243], v[64:67], a[96:99]
 ds_read_b128 a[208:211], v1 offset:4096
 v_mfma_f32_16x16x32_bf16 a[100:103], a[240:243], v[68:71], a[100:103]
 v_mfma_f32_16x16x32_bf16 a[108:111], a[244:247], v[68:71], a[108:111]
 ds_read_b128 a[212:215], v1 offset:5120
 v_mfma_f32_16x16x32_bf16 a[104:107], a[244:247], v[64:67], a[104:107]
 buffer_load_dwordx4 v3, s[20:23], s9 offen offset:2048 sc1 lds
 v_mfma_f32_16x16x32_bf16 a[112:115], a[248:251], v[64:67], a[112:115]
 ds_read_b128 a[216:219], v1 offset:6144
 v_mfma_f32_16x16x32_bf16 a[116:119], a[248:251], v[68:71], a[116:119]
 s_sub_u32 s73, s73, 1
 v_mfma_f32_16x16x32_bf16 a[124:127], a[252:255], v[68:71], a[124:127]
 ds_read_b128 a[220:223], v1 offset:7168
 v_mfma_f32_16x16x32_bf16 a[120:123], a[252:255], v[64:67], a[120:123]
 s_waitcnt lgkmcnt(4)
 buffer_load_dwordx4 v3, s[20:23], s9 offen offset:3072 sc1 lds
 s_cbranch_vccnz gated_mix__compressed_kv_cla__glu_gated_swiglu__prompt_kernel_slow
gated_mix__compressed_kv_cla__glu_gated_swiglu__prompt_kernel_join:
 s_cbranch_scc0 gated_mix__compressed_kv_cla__glu_gated_swiglu__prompt_kernel_loop
 s_mov_b32 s15, s75
 s_cmp_eq_u32 s15, s70
 s_cbranch_scc0 gated_mix__compressed_kv_cla__glu_gated_swiglu__prompt_kernel_noflag
 s_cmp_eq_u32 s81, 1
 s_cselect_b32 s92, s53, s74
 s_cmp_lg_u32 s68, 3
 s_cbranch_scc1 gated_mix__compressed_kv_cla__glu_gated_swiglu__prompt_kernel_sig25
 s_mov_b64 exec, 1
 buffer_store_dwordx2 v[28:29], v21, s[36:39], s92 offen sc1
 s_mov_b64 exec, -1
gated_mix__compressed_kv_cla__glu_gated_swiglu__prompt_kernel_sig25:
gated_mix__compressed_kv_cla__glu_gated_swiglu__prompt_kernel_noflag:
 s_cmp_eq_u32 s15, s4
 s_cbranch_scc0 gated_mix__compressed_kv_cla__glu_gated_swiglu__prompt_kernel_nolp
 s_mul_i32 s92, s82, 4352
 s_add_u32 s92, s92, 52432896
 v_and_b32 v108, 15, v0
 v_lshl_add_u32 v108, v108, 3, s92
 buffer_load_dwordx2 v[22:23], v108, s[36:39], 0 offen sc1
gated_mix__compressed_kv_cla__glu_gated_swiglu__prompt_kernel_nolp:
 s_cmp_lg_u32 s15, s3
 s_cbranch_scc1 gated_mix__compressed_kv_cla__glu_gated_swiglu__prompt_kernel_nod
 s_cmp_lg_u32 s52, 0
 s_cbranch_scc1 gated_mix__compressed_kv_cla__glu_gated_swiglu__prompt_kernel_dd0
 buffer_store_dwordx4 v[176:179], v21, s[36:39], s18 offen offset:0 sc1
 buffer_store_dwordx4 v[180:183], v21, s[36:39], s18 offen offset:1024 sc1
 s_add_u32 s18, s18, s19
 buffer_store_dwordx4 v[184:187], v21, s[36:39], s18 offen offset:0 sc1
 buffer_store_dwordx4 v[188:191], v21, s[36:39], s18 offen offset:1024 sc1
 s_add_u32 s18, s18, s19
 s_add_u32 s3, s3, s54
 s_mov_b32 s52, 1
 s_branch gated_mix__compressed_kv_cla__glu_gated_swiglu__prompt_kernel_nod
gated_mix__compressed_kv_cla__glu_gated_swiglu__prompt_kernel_dd0:
 s_cmp_lg_u32 s52, 1
 s_cbranch_scc1 gated_mix__compressed_kv_cla__glu_gated_swiglu__prompt_kernel_dd1
 buffer_store_dwordx4 v[192:195], v21, s[36:39], s18 offen offset:0 sc1
 buffer_store_dwordx4 v[196:199], v21, s[36:39], s18 offen offset:1024 sc1
 s_add_u32 s18, s18, s19
 buffer_store_dwordx4 v[200:203], v21, s[36:39], s18 offen offset:0 sc1
 buffer_store_dwordx4 v[204:207], v21, s[36:39], s18 offen offset:1024 sc1
 s_add_u32 s18, s18, s19
 s_add_u32 s3, s3, s54
 s_mov_b32 s52, 2
 s_branch gated_mix__compressed_kv_cla__glu_gated_swiglu__prompt_kernel_nod
gated_mix__compressed_kv_cla__glu_gated_swiglu__prompt_kernel_dd1:
 s_cmp_lg_u32 s52, 2
 s_cbranch_scc1 gated_mix__compressed_kv_cla__glu_gated_swiglu__prompt_kernel_dd2
 buffer_store_dwordx4 v[208:211], v21, s[36:39], s18 offen offset:0 sc1
 buffer_store_dwordx4 v[212:215], v21, s[36:39], s18 offen offset:1024 sc1
 s_add_u32 s18, s18, s19
 buffer_store_dwordx4 v[216:219], v21, s[36:39], s18 offen offset:0 sc1
 buffer_store_dwordx4 v[220:223], v21, s[36:39], s18 offen offset:1024 sc1
 s_add_u32 s18, s18, s19
 s_add_u32 s3, s3, s54
 s_mov_b32 s52, 3
 s_branch gated_mix__compressed_kv_cla__glu_gated_swiglu__prompt_kernel_nod
gated_mix__compressed_kv_cla__glu_gated_swiglu__prompt_kernel_dd2:
 buffer_store_dwordx4 v[224:227], v21, s[36:39], s18 offen offset:0 sc1
 buffer_store_dwordx4 v[228:231], v21, s[36:39], s18 offen offset:1024 sc1
 s_add_u32 s18, s18, s19
 buffer_store_dwordx4 v[232:235], v21, s[36:39], s18 offen offset:0 sc1
 buffer_store_dwordx4 v[236:239], v21, s[36:39], s18 offen offset:1024 sc1
 s_add_u32 s18, s18, s19
gated_mix__compressed_kv_cla__glu_gated_swiglu__prompt_kernel_nod:
 s_cmp_eq_u32 s15, s78
 s_cbranch_scc0 gated_mix__compressed_kv_cla__glu_gated_swiglu__prompt_kernel_nolate
 s_waitcnt vmcnt(16)
 s_mov_b32 s99, 1048576
gated_mix__compressed_kv_cla__glu_gated_swiglu__prompt_kernel_poll26:
 v_cmp_eq_u64 vcc, v[22:23], v[28:29]
 s_nop 3
 s_and_b32 vcc_lo, vcc_lo, 0xffff
 s_cmp_eq_u32 vcc_lo, 0xffff
 s_cbranch_scc1 gated_mix__compressed_kv_cla__glu_gated_swiglu__prompt_kernel_ok27
 s_sub_u32 s99, s99, 1
 s_cbranch_scc1 gated_mix__compressed_kv_cla__glu_gated_swiglu__prompt_kernel_ok27
 s_sleep 12
 buffer_load_dwordx2 v[22:23], v108, s[36:39], 0 offen sc1
 s_waitcnt vmcnt(0)
 s_branch gated_mix__compressed_kv_cla__glu_gated_swiglu__prompt_kernel_poll26
gated_mix__compressed_kv_cla__glu_gated_swiglu__prompt_kernel_ok27:
gated_mix__compressed_kv_cla__glu_gated_swiglu__prompt_kernel_nolate:
 s_add_u32 s91, s15, 1
 s_cmp_ge_u32 s91, s16
 s_cbranch_scc1 gated_mix__compressed_kv_cla__glu_gated_swiglu__prompt_kernel_final
gated_mix__compressed_kv_cla__glu_gated_swiglu__prompt_kernel_event:
 s_cmp_lg_u32 s15, s69
 s_cbranch_scc1 gated_mix__compressed_kv_cla__glu_gated_swiglu__prompt_kernel_nomask1
 s_getpc_b64 s[96:97]
gated_mix__compressed_kv_cla__glu_gated_swiglu__prompt_kernel_pc28:
 s_sub_u32 s96, s96, gated_mix__compressed_kv_cla__glu_gated_swiglu__prompt_kernel_pc28-gated_mix__compressed_kv_cla__glu_gated_swiglu__prompt_kernel_pc
 s_subb_u32 s97, s97, 0
 global_load_dword v31, v27, s[96:97]
 buffer_load_dwordx2 v[22:23], v30, s[36:39], 0 offen sc1
 v_mov_b32 v80, s80
 v_mov_b32 v81, s80
 v_mov_b32 v82, s80
 v_mov_b32 v83, s80
 v_mov_b32 v88, s80
 v_cndmask_b32 v72, v88, v72, s[28:29]
 v_cndmask_b32 v84, v88, v84, s[28:29]
 v_cndmask_b32 v73, v88, v73, s[30:31]
 v_cndmask_b32 v85, v88, v85, s[30:31]
 v_cndmask_b32 v74, v88, v74, s[32:33]
 v_cndmask_b32 v86, v88, v86, s[32:33]
 v_cndmask_b32 v75, v88, v75, s[34:35]
 v_cndmask_b32 v87, v88, v87, s[34:35]
 s_nop 1
gated_mix__compressed_kv_cla__glu_gated_swiglu__prompt_kernel_nomask1:
 s_sub_u32 s75, s16, 1
 s_cmp_gt_i32 s69, s15
 s_cselect_b32 s91, s69, s75
 s_min_u32 s75, s75, s91
 s_cmp_gt_i32 s70, s15
 s_cselect_b32 s91, s70, s75
 s_min_u32 s75, s75, s91
 s_cmp_gt_i32 s78, s15
 s_cselect_b32 s91, s78, s75
 s_min_u32 s75, s75, s91
 s_cmp_gt_i32 s4, s15
 s_cselect_b32 s91, s4, s75
 s_min_u32 s75, s75, s91
 s_cmp_gt_i32 s3, s15
 s_cselect_b32 s91, s3, s75
 s_min_u32 s75, s75, s91
 s_sub_u32 s73, s75, s15
 s_sub_u32 s73, s73, 1
 s_branch gated_mix__compressed_kv_cla__glu_gated_swiglu__prompt_kernel_loop
gated_mix__compressed_kv_cla__glu_gated_swiglu__prompt_kernel_final:
 s_waitcnt lgkmcnt(0)
 ds_read_b128 a[192:195], v2 offset:0
 ds_read_b128 a[196:199], v2 offset:1024
 ds_read_b128 a[200:203], v2 offset:2048
 ds_read_b128 a[204:207], v2 offset:3072
 ds_read_b128 a[208:211], v2 offset:4096
 ds_read_b128 a[212:215], v2 offset:5120
 ds_read_b128 a[216:219], v2 offset:6144
 ds_read_b128 a[220:223], v2 offset:7168
 ds_read_b128 a[224:227], v2 offset:8192
 ds_read_b128 a[228:231], v2 offset:9216
 ds_read_b128 a[232:235], v2 offset:10240
 ds_read_b128 a[236:239], v2 offset:11264
 ds_read_b128 a[240:243], v2 offset:12288
 ds_read_b128 a[244:247], v2 offset:13312
 ds_read_b128 a[248:251], v2 offset:14336
 ds_read_b128 a[252:255], v2 offset:15360
 s_cmp_eq_u32 s71, 0
 s_cbranch_scc1 gated_mix__compressed_kv_cla__glu_gated_swiglu__prompt_kernel_final1
 s_waitcnt vmcnt(4)
 v_cmp_eq_u64 vcc, v[22:23], v[28:29]
 s_mov_b32 s75, 0
 s_nop 2
 s_cmp_eq_u64 vcc, -1
 s_cbranch_scc0 gated_mix__compressed_kv_cla__glu_gated_swiglu__prompt_kernel_final1
 s_mov_b32 s75, 1
 s_cmp_lg_u32 s81, 1
 s_cbranch_scc1 gated_mix__compressed_kv_cla__glu_gated_swiglu__prompt_kernel_noparta
 s_add_u32 s94, s72, 16384
 buffer_load_dwordx4 v[240:243], v21, s[36:39], s94 offen sc1
 s_add_u32 s90, s72, 0
 buffer_load_dwordx4 v[176:179], v21, s[36:39], s90 offen offset:0 sc1
 buffer_load_dwordx4 v[180:183], v21, s[36:39], s90 offen offset:1024 sc1
 buffer_load_dwordx4 v[184:187], v21, s[36:39], s90 offen offset:2048 sc1
 buffer_load_dwordx4 v[188:191], v21, s[36:39], s90 offen offset:3072 sc1
 s_add_u32 s90, s72, 4096
 buffer_load_dwordx4 v[192:195], v21, s[36:39], s90 offen offset:0 sc1
 buffer_load_dwordx4 v[196:199], v21, s[36:39], s90 offen offset:1024 sc1
 buffer_load_dwordx4 v[200:203], v21, s[36:39], s90 offen offset:2048 sc1
 buffer_load_dwordx4 v[204:207], v21, s[36:39], s90 offen offset:3072 sc1
 s_add_u32 s90, s72, 8192
 buffer_load_dwordx4 v[208:211], v21, s[36:39], s90 offen offset:0 sc1
 buffer_load_dwordx4 v[212:215], v21, s[36:39], s90 offen offset:1024 sc1
 buffer_load_dwordx4 v[216:219], v21, s[36:39], s90 offen offset:2048 sc1
 buffer_load_dwordx4 v[220:223], v21, s[36:39], s90 offen offset:3072 sc1
 s_add_u32 s90, s72, 12288
 buffer_load_dwordx4 v[224:227], v21, s[36:39], s90 offen offset:0 sc1
 buffer_load_dwordx4 v[228:231], v21, s[36:39], s90 offen offset:1024 sc1
 buffer_load_dwordx4 v[232:235], v21, s[36:39], s90 offen offset:2048 sc1
 buffer_load_dwordx4 v[236:239], v21, s[36:39], s90 offen offset:3072 sc1
gated_mix__compressed_kv_cla__glu_gated_swiglu__prompt_kernel_noparta:
 s_lshl_b32 s93, s86, 3
 s_lshl_b32 s94, s68, 1
 s_add_u32 s93, s93, s94
 s_mul_i32 s94, s93, 57344
 s_lshl_b32 s96, s84, 10
 s_add_u32 s94, s94, s96
 s_add_u32 s94, s94, 33554432
 s_lshl_b32 s55, s93, 8
 s_add_u32 s55, s55, 53215232
 v_and_b32 v109, 0xf0, v21
 buffer_load_dwordx4 v[244:247], v109, s[36:39], s55 offen offset:0 sc1
 buffer_load_dwordx4 v[248:251], v109, s[36:39], s55 offen offset:256 sc1
 buffer_load_dwordx4 a[128:131], v21, s[64:67], s94 offen offset:0 sc1
 buffer_load_dwordx4 a[132:135], v21, s[64:67], s94 offen offset:1024 sc1
 buffer_load_dwordx4 a[136:139], v21, s[64:67], s94 offen offset:2048 sc1
 s_lshl_b32 s96, s85, 10
 s_add_u32 s96, s96, s94
 s_sub_u32 s96, s96, 1024
 buffer_load_dwordx4 a[140:143], v21, s[64:67], s96 offen sc1
 s_add_u32 s94, s94, 57344
 buffer_load_dwordx4 a[144:147], v21, s[64:67], s94 offen offset:0 sc1
 buffer_load_dwordx4 a[148:151], v21, s[64:67], s94 offen offset:1024 sc1
 buffer_load_dwordx4 a[152:155], v21, s[64:67], s94 offen offset:2048 sc1
 s_lshl_b32 s96, s85, 10
 s_add_u32 s96, s96, s94
 s_sub_u32 s96, s96, 1024
 buffer_load_dwordx4 a[156:159], v21, s[64:67], s96 offen sc1
gated_mix__compressed_kv_cla__glu_gated_swiglu__prompt_kernel_final1:
 s_add_u32 m0, s12, s77
 s_nop 0
 buffer_load_dwordx4 v3, s[24:27], s10 offen offset:0 sc1 lds
 buffer_load_dwordx4 v3, s[24:27], s10 offen offset:1024 sc1 lds
 buffer_load_dwordx4 v3, s[24:27], s10 offen offset:2048 sc1 lds
 buffer_load_dwordx4 v3, s[24:27], s10 offen offset:3072 sc1 lds
 v_cvt_pk_bf16_f32 v64, v48, v49
 v_cvt_pk_bf16_f32 v65, v50, v51
 v_cvt_pk_bf16_f32 v68, v52, v53
 v_cvt_pk_bf16_f32 v69, v54, v55
 v_cvt_pk_bf16_f32 v66, v56, v57
 v_cvt_pk_bf16_f32 v67, v58, v59
 v_cvt_pk_bf16_f32 v70, v60, v61
 v_cvt_pk_bf16_f32 v71, v62, v63
 v_add_f32 v6, v6, v8
 v_add_f32 v7, v7, v9
 s_waitcnt lgkmcnt(12)
 v_mfma_f32_16x16x32_bf16 a[0:3], a[192:195], v[64:67], a[0:3]
 v_mov_b32 v112, v176
 v_mov_b32 v113, v177
 v_mfma_f32_16x16x32_bf16 a[4:7], a[192:195], v[68:71], a[4:7]
 v_mov_b32 v114, v178
 v_mov_b32 v115, v179
 v_mfma_f32_16x16x32_bf16 a[12:15], a[196:199], v[68:71], a[12:15]
 v_mov_b32 v116, v180
 v_mov_b32 v117, v181
 v_mfma_f32_16x16x32_bf16 a[8:11], a[196:199], v[64:67], a[8:11]
 v_mov_b32 v118, v182
 v_mov_b32 v119, v183
 v_mfma_f32_16x16x32_bf16 a[16:19], a[200:203], v[64:67], a[16:19]
 v_mov_b32 v120, v184
 v_mov_b32 v121, v185
 v_mfma_f32_16x16x32_bf16 a[20:23], a[200:203], v[68:71], a[20:23]
 v_mov_b32 v122, v186
 v_mov_b32 v123, v187
 v_mfma_f32_16x16x32_bf16 a[28:31], a[204:207], v[68:71], a[28:31]
 v_mov_b32 v124, v188
 v_mov_b32 v125, v189
 v_mfma_f32_16x16x32_bf16 a[24:27], a[204:207], v[64:67], a[24:27]
 s_waitcnt lgkmcnt(8)
 v_mov_b32 v126, v190
 v_mov_b32 v127, v191
 v_mfma_f32_16x16x32_bf16 a[32:35], a[208:211], v[64:67], a[32:35]
 v_mov_b32 v128, v192
 v_mov_b32 v129, v193
 v_mfma_f32_16x16x32_bf16 a[36:39], a[208:211], v[68:71], a[36:39]
 v_mov_b32 v130, v194
 v_mov_b32 v131, v195
 v_mfma_f32_16x16x32_bf16 a[44:47], a[212:215], v[68:71], a[44:47]
 v_mov_b32 v132, v196
 v_mov_b32 v133, v197
 v_mfma_f32_16x16x32_bf16 a[40:43], a[212:215], v[64:67], a[40:43]
 v_mov_b32 v134, v198
 v_mov_b32 v135, v199
 v_mfma_f32_16x16x32_bf16 a[48:51], a[216:219], v[64:67], a[48:51]
 v_mov_b32 v136, v200
 v_mov_b32 v137, v201
 v_mfma_f32_16x16x32_bf16 a[52:55], a[216:219], v[68:71], a[52:55]
 v_mov_b32 v138, v202
 v_mov_b32 v139, v203
 v_mfma_f32_16x16x32_bf16 a[60:63], a[220:223], v[68:71], a[60:63]
 v_mov_b32 v140, v204
 v_mov_b32 v141, v205
 v_mfma_f32_16x16x32_bf16 a[56:59], a[220:223], v[64:67], a[56:59]
 s_waitcnt lgkmcnt(4)
 v_mov_b32 v142, v206
 v_mov_b32 v143, v207
 v_mfma_f32_16x16x32_bf16 a[64:67], a[224:227], v[64:67], a[64:67]
 v_mov_b32 v144, v208
 v_mov_b32 v145, v209
 v_mfma_f32_16x16x32_bf16 a[68:71], a[224:227], v[68:71], a[68:71]
 v_mov_b32 v146, v210
 v_mov_b32 v147, v211
 v_mfma_f32_16x16x32_bf16 a[76:79], a[228:231], v[68:71], a[76:79]
 v_mov_b32 v148, v212
 v_mov_b32 v149, v213
 v_mfma_f32_16x16x32_bf16 a[72:75], a[228:231], v[64:67], a[72:75]
 v_mov_b32 v150, v214
 v_mov_b32 v151, v215
 v_mfma_f32_16x16x32_bf16 a[80:83], a[232:235], v[64:67], a[80:83]
 v_mov_b32 v152, v216
 v_mov_b32 v153, v217
 v_mfma_f32_16x16x32_bf16 a[84:87], a[232:235], v[68:71], a[84:87]
 v_mov_b32 v154, v218
 v_mov_b32 v155, v219
 v_mfma_f32_16x16x32_bf16 a[92:95], a[236:239], v[68:71], a[92:95]
 v_mov_b32 v156, v220
 v_mov_b32 v157, v221
 v_mfma_f32_16x16x32_bf16 a[88:91], a[236:239], v[64:67], a[88:91]
 s_waitcnt lgkmcnt(0)
 v_mov_b32 v158, v222
 v_mov_b32 v159, v223
 v_mfma_f32_16x16x32_bf16 a[96:99], a[240:243], v[64:67], a[96:99]
 v_mov_b32 v160, v224
 v_mov_b32 v161, v225
 v_mfma_f32_16x16x32_bf16 a[100:103], a[240:243], v[68:71], a[100:103]
 s_add_u32 s14, s14, 16384
 v_mov_b32 v162, v226
 v_mov_b32 v163, v227
 v_mfma_f32_16x16x32_bf16 a[108:111], a[244:247], v[68:71], a[108:111]
 s_cmp_eq_u32 s14, 147456
 v_mov_b32 v164, v228
 v_mov_b32 v165, v229
 v_mfma_f32_16x16x32_bf16 a[104:107], a[244:247], v[64:67], a[104:107]
 s_cselect_b32 s14, 65536, s14
 v_mov_b32 v166, v230
 v_mov_b32 v167, v231
 v_mfma_f32_16x16x32_bf16 a[112:115], a[248:251], v[64:67], a[112:115]
 v_mov_b32 v168, v232
 v_mov_b32 v169, v233
 v_mfma_f32_16x16x32_bf16 a[116:119], a[248:251], v[68:71], a[116:119]
 v_mov_b32 v170, v234
 v_mov_b32 v171, v235
 v_mfma_f32_16x16x32_bf16 a[124:127], a[252:255], v[68:71], a[124:127]
 v_mov_b32 v172, v236
 v_mov_b32 v173, v237
 v_mfma_f32_16x16x32_bf16 a[120:123], a[252:255], v[64:67], a[120:123]
 v_mov_b32 v174, v238
 v_mov_b32 v175, v239
 v_add_u32 v2, s14, v21
 s_add_u32 s15, s15, 1
gated_mix__compressed_kv_cla__glu_gated_swiglu__prompt_kernel_idle:
 s_cmp_ge_u32 s15, s17
 s_cbranch_scc1 gated_mix__compressed_kv_cla__glu_gated_swiglu__prompt_kernel_idledone
 s_waitcnt vmcnt(16)
 s_barrier
 s_add_u32 s10, s9, 16384
 s_mov_b32 s26, s22
 s_add_u32 s6, s6, 1
 s_sub_u32 s7, s7, 1
 s_cmp_eq_u32 s7, s8
 s_cselect_b32 s6, s87, s6
 s_cmp_gt_i32 s7, 0
 s_cselect_b32 s22, s22, 0
 s_cselect_b32 s6, s6, 0
 s_lshl_b32 s9, s6, 15
 s_add_u32 s11, s11, 16384
 s_and_b32 s11, s11, 0xffff
 s_add_u32 m0, s11, s76
 s_nop 0
 buffer_load_dwordx4 v3, s[20:23], s9 offen offset:0 sc1 lds
 buffer_load_dwordx4 v3, s[20:23], s9 offen offset:1024 sc1 lds
 buffer_load_dwordx4 v3, s[20:23], s9 offen offset:2048 sc1 lds
 buffer_load_dwordx4 v3, s[20:23], s9 offen offset:3072 sc1 lds
 s_add_u32 s12, s12, 16384
 s_cmp_eq_u32 s12, 81920
 s_cselect_b32 s12, 0, s12
 s_add_u32 m0, s12, s77
 s_nop 0
 buffer_load_dwordx4 v3, s[24:27], s10 offen offset:0 sc1 lds
 buffer_load_dwordx4 v3, s[24:27], s10 offen offset:1024 sc1 lds
 buffer_load_dwordx4 v3, s[24:27], s10 offen offset:2048 sc1 lds
 buffer_load_dwordx4 v3, s[24:27], s10 offen offset:3072 sc1 lds
 s_add_u32 s15, s15, 1
 s_branch gated_mix__compressed_kv_cla__glu_gated_swiglu__prompt_kernel_idle
gated_mix__compressed_kv_cla__glu_gated_swiglu__prompt_kernel_idledone:
 v_mov_b32 v90, v6
 s_nop 1
 v_permlane32_swap_b32 v6, v90
 v_add_f32 v6, v6, v90
 v_mov_b32 v90, v6
 s_nop 1
 v_permlane16_swap_b32 v6, v90
 v_add_f32 v6, v6, v90
 v_mov_b32 v90, v7
 s_nop 1
 v_permlane32_swap_b32 v7, v90
 v_add_f32 v7, v7, v90
 v_mov_b32 v90, v7
 s_nop 1
 v_permlane16_swap_b32 v7, v90
 v_add_f32 v7, v7, v90
 s_cmp_lg_u32 s71, 0
 s_cbranch_scc1 gated_mix__compressed_kv_cla__glu_gated_swiglu__prompt_kernel_last
 v_rcp_f32 v8, v6
 v_rcp_f32 v9, v7
 v_mov_b32 v92, v4
 v_mov_b32 v93, v6
 v_mov_b32 v94, v5
 v_mov_b32 v95, v7
 s_add_u32 s94, s72, 16384
 buffer_store_dwordx4 v[92:95], v21, s[36:39], s94 offen sc1
 v_accvgpr_read_b32 v32, a0
 v_accvgpr_read_b32 v33, a1
 v_accvgpr_read_b32 v34, a2
 v_accvgpr_read_b32 v35, a3
 v_accvgpr_read_b32 v36, a8
 v_accvgpr_read_b32 v37, a9
 v_accvgpr_read_b32 v38, a10
 v_accvgpr_read_b32 v39, a11
 v_pk_mul_f32 v[32:33], v[32:33], v[8:9] op_sel:[0,0] op_sel_hi:[1,0]
 v_pk_mul_f32 v[34:35], v[34:35], v[8:9] op_sel:[0,0] op_sel_hi:[1,0]
 v_pk_mul_f32 v[36:37], v[36:37], v[8:9] op_sel:[0,0] op_sel_hi:[1,0]
 v_pk_mul_f32 v[38:39], v[38:39], v[8:9] op_sel:[0,0] op_sel_hi:[1,0]
 v_cvt_pk_bf16_f32 v176, v32, v33
 v_cvt_pk_bf16_f32 v177, v34, v35
 v_cvt_pk_bf16_f32 v178, v36, v37
 v_cvt_pk_bf16_f32 v179, v38, v39
 v_accvgpr_read_b32 v40, a16
 v_accvgpr_read_b32 v41, a17
 v_accvgpr_read_b32 v42, a18
 v_accvgpr_read_b32 v43, a19
 v_accvgpr_read_b32 v44, a24
 v_accvgpr_read_b32 v45, a25
 v_accvgpr_read_b32 v46, a26
 v_accvgpr_read_b32 v47, a27
 v_pk_mul_f32 v[40:41], v[40:41], v[8:9] op_sel:[0,0] op_sel_hi:[1,0]
 v_pk_mul_f32 v[42:43], v[42:43], v[8:9] op_sel:[0,0] op_sel_hi:[1,0]
 v_pk_mul_f32 v[44:45], v[44:45], v[8:9] op_sel:[0,0] op_sel_hi:[1,0]
 v_pk_mul_f32 v[46:47], v[46:47], v[8:9] op_sel:[0,0] op_sel_hi:[1,0]
 v_cvt_pk_bf16_f32 v180, v40, v41
 v_cvt_pk_bf16_f32 v181, v42, v43
 v_cvt_pk_bf16_f32 v182, v44, v45
 v_cvt_pk_bf16_f32 v183, v46, v47
 v_accvgpr_read_b32 v48, a32
 v_accvgpr_read_b32 v49, a33
 v_accvgpr_read_b32 v50, a34
 v_accvgpr_read_b32 v51, a35
 v_accvgpr_read_b32 v52, a40
 v_accvgpr_read_b32 v53, a41
 v_accvgpr_read_b32 v54, a42
 v_accvgpr_read_b32 v55, a43
 v_pk_mul_f32 v[48:49], v[48:49], v[8:9] op_sel:[0,0] op_sel_hi:[1,0]
 v_pk_mul_f32 v[50:51], v[50:51], v[8:9] op_sel:[0,0] op_sel_hi:[1,0]
 v_pk_mul_f32 v[52:53], v[52:53], v[8:9] op_sel:[0,0] op_sel_hi:[1,0]
 v_pk_mul_f32 v[54:55], v[54:55], v[8:9] op_sel:[0,0] op_sel_hi:[1,0]
 v_cvt_pk_bf16_f32 v184, v48, v49
 v_cvt_pk_bf16_f32 v185, v50, v51
 v_cvt_pk_bf16_f32 v186, v52, v53
 v_cvt_pk_bf16_f32 v187, v54, v55
 v_accvgpr_read_b32 v56, a48
 v_accvgpr_read_b32 v57, a49
 v_accvgpr_read_b32 v58, a50
 v_accvgpr_read_b32 v59, a51
 v_accvgpr_read_b32 v60, a56
 v_accvgpr_read_b32 v61, a57
 v_accvgpr_read_b32 v62, a58
 v_accvgpr_read_b32 v63, a59
 v_pk_mul_f32 v[56:57], v[56:57], v[8:9] op_sel:[0,0] op_sel_hi:[1,0]
 v_pk_mul_f32 v[58:59], v[58:59], v[8:9] op_sel:[0,0] op_sel_hi:[1,0]
 v_pk_mul_f32 v[60:61], v[60:61], v[8:9] op_sel:[0,0] op_sel_hi:[1,0]
 v_pk_mul_f32 v[62:63], v[62:63], v[8:9] op_sel:[0,0] op_sel_hi:[1,0]
 v_cvt_pk_bf16_f32 v188, v56, v57
 v_cvt_pk_bf16_f32 v189, v58, v59
 v_cvt_pk_bf16_f32 v190, v60, v61
 v_cvt_pk_bf16_f32 v191, v62, v63
 s_mov_b32 s18, s72
 s_movk_i32 s19, 2048
 buffer_store_dwordx4 v[176:179], v21, s[36:39], s18 offen offset:0 sc1
 buffer_store_dwordx4 v[180:183], v21, s[36:39], s18 offen offset:1024 sc1
 s_add_u32 s18, s18, s19
 buffer_store_dwordx4 v[184:187], v21, s[36:39], s18 offen offset:0 sc1
 buffer_store_dwordx4 v[188:191], v21, s[36:39], s18 offen offset:1024 sc1
 s_add_u32 s18, s18, s19
 v_accvgpr_read_b32 v32, a64
 v_accvgpr_read_b32 v33, a65
 v_accvgpr_read_b32 v34, a66
 v_accvgpr_read_b32 v35, a67
 v_accvgpr_read_b32 v36, a72
 v_accvgpr_read_b32 v37, a73
 v_accvgpr_read_b32 v38, a74
 v_accvgpr_read_b32 v39, a75
 v_pk_mul_f32 v[32:33], v[32:33], v[8:9] op_sel:[0,0] op_sel_hi:[1,0]
 v_pk_mul_f32 v[34:35], v[34:35], v[8:9] op_sel:[0,0] op_sel_hi:[1,0]
 v_pk_mul_f32 v[36:37], v[36:37], v[8:9] op_sel:[0,0] op_sel_hi:[1,0]
 v_pk_mul_f32 v[38:39], v[38:39], v[8:9] op_sel:[0,0] op_sel_hi:[1,0]
 v_cvt_pk_bf16_f32 v192, v32, v33
 v_cvt_pk_bf16_f32 v193, v34, v35
 v_cvt_pk_bf16_f32 v194, v36, v37
 v_cvt_pk_bf16_f32 v195, v38, v39
 v_accvgpr_read_b32 v40, a80
 v_accvgpr_read_b32 v41, a81
 v_accvgpr_read_b32 v42, a82
 v_accvgpr_read_b32 v43, a83
 v_accvgpr_read_b32 v44, a88
 v_accvgpr_read_b32 v45, a89
 v_accvgpr_read_b32 v46, a90
 v_accvgpr_read_b32 v47, a91
 v_pk_mul_f32 v[40:41], v[40:41], v[8:9] op_sel:[0,0] op_sel_hi:[1,0]
 v_pk_mul_f32 v[42:43], v[42:43], v[8:9] op_sel:[0,0] op_sel_hi:[1,0]
 v_pk_mul_f32 v[44:45], v[44:45], v[8:9] op_sel:[0,0] op_sel_hi:[1,0]
 v_pk_mul_f32 v[46:47], v[46:47], v[8:9] op_sel:[0,0] op_sel_hi:[1,0]
 v_cvt_pk_bf16_f32 v196, v40, v41
 v_cvt_pk_bf16_f32 v197, v42, v43
 v_cvt_pk_bf16_f32 v198, v44, v45
 v_cvt_pk_bf16_f32 v199, v46, v47
 v_accvgpr_read_b32 v48, a96
 v_accvgpr_read_b32 v49, a97
 v_accvgpr_read_b32 v50, a98
 v_accvgpr_read_b32 v51, a99
 v_accvgpr_read_b32 v52, a104
 v_accvgpr_read_b32 v53, a105
 v_accvgpr_read_b32 v54, a106
 v_accvgpr_read_b32 v55, a107
 v_pk_mul_f32 v[48:49], v[48:49], v[8:9] op_sel:[0,0] op_sel_hi:[1,0]
 v_pk_mul_f32 v[50:51], v[50:51], v[8:9] op_sel:[0,0] op_sel_hi:[1,0]
 v_pk_mul_f32 v[52:53], v[52:53], v[8:9] op_sel:[0,0] op_sel_hi:[1,0]
 v_pk_mul_f32 v[54:55], v[54:55], v[8:9] op_sel:[0,0] op_sel_hi:[1,0]
 v_cvt_pk_bf16_f32 v200, v48, v49
 v_cvt_pk_bf16_f32 v201, v50, v51
 v_cvt_pk_bf16_f32 v202, v52, v53
 v_cvt_pk_bf16_f32 v203, v54, v55
 v_accvgpr_read_b32 v56, a112
 v_accvgpr_read_b32 v57, a113
 v_accvgpr_read_b32 v58, a114
 v_accvgpr_read_b32 v59, a115
 v_accvgpr_read_b32 v60, a120
 v_accvgpr_read_b32 v61, a121
 v_accvgpr_read_b32 v62, a122
 v_accvgpr_read_b32 v63, a123
 v_pk_mul_f32 v[56:57], v[56:57], v[8:9] op_sel:[0,0] op_sel_hi:[1,0]
 v_pk_mul_f32 v[58:59], v[58:59], v[8:9] op_sel:[0,0] op_sel_hi:[1,0]
 v_pk_mul_f32 v[60:61], v[60:61], v[8:9] op_sel:[0,0] op_sel_hi:[1,0]
 v_pk_mul_f32 v[62:63], v[62:63], v[8:9] op_sel:[0,0] op_sel_hi:[1,0]
 v_cvt_pk_bf16_f32 v204, v56, v57
 v_cvt_pk_bf16_f32 v205, v58, v59
 v_cvt_pk_bf16_f32 v206, v60, v61
 v_cvt_pk_bf16_f32 v207, v62, v63
 buffer_store_dwordx4 v[192:195], v21, s[36:39], s18 offen offset:0 sc1
 buffer_store_dwordx4 v[196:199], v21, s[36:39], s18 offen offset:1024 sc1
 s_add_u32 s18, s18, s19
 buffer_store_dwordx4 v[200:203], v21, s[36:39], s18 offen offset:0 sc1
 buffer_store_dwordx4 v[204:207], v21, s[36:39], s18 offen offset:1024 sc1
 s_add_u32 s18, s18, s19
gated_mix__compressed_kv_cla__glu_gated_swiglu__prompt_kernel_later7:
 v_accvgpr_read_b32 v32, a4
 v_accvgpr_read_b32 v33, a5
 v_accvgpr_read_b32 v34, a6
 v_accvgpr_read_b32 v35, a7
 v_accvgpr_read_b32 v36, a12
 v_accvgpr_read_b32 v37, a13
 v_accvgpr_read_b32 v38, a14
 v_accvgpr_read_b32 v39, a15
 v_pk_mul_f32 v[32:33], v[32:33], v[8:9] op_sel:[0,1] op_sel_hi:[1,1]
 v_pk_mul_f32 v[34:35], v[34:35], v[8:9] op_sel:[0,1] op_sel_hi:[1,1]
 v_pk_mul_f32 v[36:37], v[36:37], v[8:9] op_sel:[0,1] op_sel_hi:[1,1]
 v_pk_mul_f32 v[38:39], v[38:39], v[8:9] op_sel:[0,1] op_sel_hi:[1,1]
 v_cvt_pk_bf16_f32 v208, v32, v33
 v_cvt_pk_bf16_f32 v209, v34, v35
 v_cvt_pk_bf16_f32 v210, v36, v37
 v_cvt_pk_bf16_f32 v211, v38, v39
 v_accvgpr_read_b32 v40, a20
 v_accvgpr_read_b32 v41, a21
 v_accvgpr_read_b32 v42, a22
 v_accvgpr_read_b32 v43, a23
 v_accvgpr_read_b32 v44, a28
 v_accvgpr_read_b32 v45, a29
 v_accvgpr_read_b32 v46, a30
 v_accvgpr_read_b32 v47, a31
 v_pk_mul_f32 v[40:41], v[40:41], v[8:9] op_sel:[0,1] op_sel_hi:[1,1]
 v_pk_mul_f32 v[42:43], v[42:43], v[8:9] op_sel:[0,1] op_sel_hi:[1,1]
 v_pk_mul_f32 v[44:45], v[44:45], v[8:9] op_sel:[0,1] op_sel_hi:[1,1]
 v_pk_mul_f32 v[46:47], v[46:47], v[8:9] op_sel:[0,1] op_sel_hi:[1,1]
 v_cvt_pk_bf16_f32 v212, v40, v41
 v_cvt_pk_bf16_f32 v213, v42, v43
 v_cvt_pk_bf16_f32 v214, v44, v45
 v_cvt_pk_bf16_f32 v215, v46, v47
 v_accvgpr_read_b32 v48, a36
 v_accvgpr_read_b32 v49, a37
 v_accvgpr_read_b32 v50, a38
 v_accvgpr_read_b32 v51, a39
 v_accvgpr_read_b32 v52, a44
 v_accvgpr_read_b32 v53, a45
 v_accvgpr_read_b32 v54, a46
 v_accvgpr_read_b32 v55, a47
 v_pk_mul_f32 v[48:49], v[48:49], v[8:9] op_sel:[0,1] op_sel_hi:[1,1]
 v_pk_mul_f32 v[50:51], v[50:51], v[8:9] op_sel:[0,1] op_sel_hi:[1,1]
 v_pk_mul_f32 v[52:53], v[52:53], v[8:9] op_sel:[0,1] op_sel_hi:[1,1]
 v_pk_mul_f32 v[54:55], v[54:55], v[8:9] op_sel:[0,1] op_sel_hi:[1,1]
 v_cvt_pk_bf16_f32 v216, v48, v49
 v_cvt_pk_bf16_f32 v217, v50, v51
 v_cvt_pk_bf16_f32 v218, v52, v53
 v_cvt_pk_bf16_f32 v219, v54, v55
 v_accvgpr_read_b32 v56, a52
 v_accvgpr_read_b32 v57, a53
 v_accvgpr_read_b32 v58, a54
 v_accvgpr_read_b32 v59, a55
 v_accvgpr_read_b32 v60, a60
 v_accvgpr_read_b32 v61, a61
 v_accvgpr_read_b32 v62, a62
 v_accvgpr_read_b32 v63, a63
 v_pk_mul_f32 v[56:57], v[56:57], v[8:9] op_sel:[0,1] op_sel_hi:[1,1]
 v_pk_mul_f32 v[58:59], v[58:59], v[8:9] op_sel:[0,1] op_sel_hi:[1,1]
 v_pk_mul_f32 v[60:61], v[60:61], v[8:9] op_sel:[0,1] op_sel_hi:[1,1]
 v_pk_mul_f32 v[62:63], v[62:63], v[8:9] op_sel:[0,1] op_sel_hi:[1,1]
 v_cvt_pk_bf16_f32 v220, v56, v57
 v_cvt_pk_bf16_f32 v221, v58, v59
 v_cvt_pk_bf16_f32 v222, v60, v61
 v_cvt_pk_bf16_f32 v223, v62, v63
 buffer_store_dwordx4 v[208:211], v21, s[36:39], s18 offen offset:0 sc1
 buffer_store_dwordx4 v[212:215], v21, s[36:39], s18 offen offset:1024 sc1
 s_add_u32 s18, s18, s19
 buffer_store_dwordx4 v[216:219], v21, s[36:39], s18 offen offset:0 sc1
 buffer_store_dwordx4 v[220:223], v21, s[36:39], s18 offen offset:1024 sc1
 s_add_u32 s18, s18, s19
gated_mix__compressed_kv_cla__glu_gated_swiglu__prompt_kernel_later11:
 v_accvgpr_read_b32 v32, a68
 v_accvgpr_read_b32 v33, a69
 v_accvgpr_read_b32 v34, a70
 v_accvgpr_read_b32 v35, a71
 v_accvgpr_read_b32 v36, a76
 v_accvgpr_read_b32 v37, a77
 v_accvgpr_read_b32 v38, a78
 v_accvgpr_read_b32 v39, a79
 v_pk_mul_f32 v[32:33], v[32:33], v[8:9] op_sel:[0,1] op_sel_hi:[1,1]
 v_pk_mul_f32 v[34:35], v[34:35], v[8:9] op_sel:[0,1] op_sel_hi:[1,1]
 v_pk_mul_f32 v[36:37], v[36:37], v[8:9] op_sel:[0,1] op_sel_hi:[1,1]
 v_pk_mul_f32 v[38:39], v[38:39], v[8:9] op_sel:[0,1] op_sel_hi:[1,1]
 v_cvt_pk_bf16_f32 v224, v32, v33
 v_cvt_pk_bf16_f32 v225, v34, v35
 v_cvt_pk_bf16_f32 v226, v36, v37
 v_cvt_pk_bf16_f32 v227, v38, v39
 v_accvgpr_read_b32 v40, a84
 v_accvgpr_read_b32 v41, a85
 v_accvgpr_read_b32 v42, a86
 v_accvgpr_read_b32 v43, a87
 v_accvgpr_read_b32 v44, a92
 v_accvgpr_read_b32 v45, a93
 v_accvgpr_read_b32 v46, a94
 v_accvgpr_read_b32 v47, a95
 v_pk_mul_f32 v[40:41], v[40:41], v[8:9] op_sel:[0,1] op_sel_hi:[1,1]
 v_pk_mul_f32 v[42:43], v[42:43], v[8:9] op_sel:[0,1] op_sel_hi:[1,1]
 v_pk_mul_f32 v[44:45], v[44:45], v[8:9] op_sel:[0,1] op_sel_hi:[1,1]
 v_pk_mul_f32 v[46:47], v[46:47], v[8:9] op_sel:[0,1] op_sel_hi:[1,1]
 v_cvt_pk_bf16_f32 v228, v40, v41
 v_cvt_pk_bf16_f32 v229, v42, v43
 v_cvt_pk_bf16_f32 v230, v44, v45
 v_cvt_pk_bf16_f32 v231, v46, v47
 v_accvgpr_read_b32 v48, a100
 v_accvgpr_read_b32 v49, a101
 v_accvgpr_read_b32 v50, a102
 v_accvgpr_read_b32 v51, a103
 v_accvgpr_read_b32 v52, a108
 v_accvgpr_read_b32 v53, a109
 v_accvgpr_read_b32 v54, a110
 v_accvgpr_read_b32 v55, a111
 v_pk_mul_f32 v[48:49], v[48:49], v[8:9] op_sel:[0,1] op_sel_hi:[1,1]
 v_pk_mul_f32 v[50:51], v[50:51], v[8:9] op_sel:[0,1] op_sel_hi:[1,1]
 v_pk_mul_f32 v[52:53], v[52:53], v[8:9] op_sel:[0,1] op_sel_hi:[1,1]
 v_pk_mul_f32 v[54:55], v[54:55], v[8:9] op_sel:[0,1] op_sel_hi:[1,1]
 v_cvt_pk_bf16_f32 v232, v48, v49
 v_cvt_pk_bf16_f32 v233, v50, v51
 v_cvt_pk_bf16_f32 v234, v52, v53
 v_cvt_pk_bf16_f32 v235, v54, v55
 v_accvgpr_read_b32 v56, a116
 v_accvgpr_read_b32 v57, a117
 v_accvgpr_read_b32 v58, a118
 v_accvgpr_read_b32 v59, a119
 v_accvgpr_read_b32 v60, a124
 v_accvgpr_read_b32 v61, a125
 v_accvgpr_read_b32 v62, a126
 v_accvgpr_read_b32 v63, a127
 v_pk_mul_f32 v[56:57], v[56:57], v[8:9] op_sel:[0,1] op_sel_hi:[1,1]
 v_pk_mul_f32 v[58:59], v[58:59], v[8:9] op_sel:[0,1] op_sel_hi:[1,1]
 v_pk_mul_f32 v[60:61], v[60:61], v[8:9] op_sel:[0,1] op_sel_hi:[1,1]
 v_pk_mul_f32 v[62:63], v[62:63], v[8:9] op_sel:[0,1] op_sel_hi:[1,1]
 v_cvt_pk_bf16_f32 v236, v56, v57
 v_cvt_pk_bf16_f32 v237, v58, v59
 v_cvt_pk_bf16_f32 v238, v60, v61
 v_cvt_pk_bf16_f32 v239, v62, v63
 buffer_store_dwordx4 v[224:227], v21, s[36:39], s18 offen offset:0 sc1
 buffer_store_dwordx4 v[228:231], v21, s[36:39], s18 offen offset:1024 sc1
 s_add_u32 s18, s18, s19
 buffer_store_dwordx4 v[232:235], v21, s[36:39], s18 offen offset:0 sc1
 buffer_store_dwordx4 v[236:239], v21, s[36:39], s18 offen offset:1024 sc1
 s_add_u32 s18, s18, s19
gated_mix__compressed_kv_cla__glu_gated_swiglu__prompt_kernel_later15:
 v_mov_b32 v104, 0
 v_mov_b32 v105, 0
 v_mov_b32 v106, 0
 v_mov_b32 v107, 0
 s_nop 1
 v_mfma_f32_32x32x16_bf16 a[0:15], v[104:107], v[104:107], 0
 v_mfma_f32_32x32x16_bf16 a[16:31], v[104:107], v[104:107], 0
 v_mfma_f32_32x32x16_bf16 a[32:47], v[104:107], v[104:107], 0
 v_mfma_f32_32x32x16_bf16 a[48:63], v[104:107], v[104:107], 0
 v_mfma_f32_32x32x16_bf16 a[64:79], v[104:107], v[104:107], 0
 v_mfma_f32_32x32x16_bf16 a[80:95], v[104:107], v[104:107], 0
 v_mfma_f32_32x32x16_bf16 a[96:111], v[104:107], v[104:107], 0
 v_mfma_f32_32x32x16_bf16 a[112:127], v[104:107], v[104:107], 0
 s_nop 7
 s_nop 3
 s_mov_b32 s71, 1
 s_mov_b32 s17, s8
 s_mov_b32 s78, -1
 s_mov_b32 s4, -1
 s_cmp_ge_u32 s8, 1000
 s_cselect_b32 s70, 7, 2
 s_cselect_b32 s3, 2, -1
 s_mov_b32 s52, 1
 s_mov_b32 s54, 1
 s_branch gated_mix__compressed_kv_cla__glu_gated_swiglu__prompt_kernel_piece
gated_mix__compressed_kv_cla__glu_gated_swiglu__prompt_kernel_last:
 s_cmp_lg_u32 s75, 0
 s_cbranch_scc1 gated_mix__compressed_kv_cla__glu_gated_swiglu__prompt_kernel_loaded
 buffer_load_dwordx2 v[22:23], v30, s[36:39], 0 offen sc1
 s_waitcnt vmcnt(0)
 s_mov_b32 s99, 1048576
gated_mix__compressed_kv_cla__glu_gated_swiglu__prompt_kernel_poll29:
 v_cmp_eq_u64 vcc, v[22:23], v[28:29]
 s_nop 3
 s_cmp_eq_u64 vcc, -1
 s_cbranch_scc1 gated_mix__compressed_kv_cla__glu_gated_swiglu__prompt_kernel_ok30
 s_sub_u32 s99, s99, 1
 s_cbranch_scc1 gated_mix__compressed_kv_cla__glu_gated_swiglu__prompt_kernel_ok30
 s_sleep 12
 buffer_load_dwordx2 v[22:23], v30, s[36:39], 0 offen sc1
 s_waitcnt vmcnt(0)
 s_branch gated_mix__compressed_kv_cla__glu_gated_swiglu__prompt_kernel_poll29
gated_mix__compressed_kv_cla__glu_gated_swiglu__prompt_kernel_ok30:
 s_cmp_lg_u32 s81, 1
 s_cbranch_scc1 gated_mix__compressed_kv_cla__glu_gated_swiglu__prompt_kernel_nopartb
 s_add_u32 s94, s72, 16384
 buffer_load_dwordx4 v[240:243], v21, s[36:39], s94 offen sc1
 s_add_u32 s90, s72, 0
 buffer_load_dwordx4 v[176:179], v21, s[36:39], s90 offen offset:0 sc1
 buffer_load_dwordx4 v[180:183], v21, s[36:39], s90 offen offset:1024 sc1
 buffer_load_dwordx4 v[184:187], v21, s[36:39], s90 offen offset:2048 sc1
 buffer_load_dwordx4 v[188:191], v21, s[36:39], s90 offen offset:3072 sc1
 s_add_u32 s90, s72, 4096
 buffer_load_dwordx4 v[192:195], v21, s[36:39], s90 offen offset:0 sc1
 buffer_load_dwordx4 v[196:199], v21, s[36:39], s90 offen offset:1024 sc1
 buffer_load_dwordx4 v[200:203], v21, s[36:39], s90 offen offset:2048 sc1
 buffer_load_dwordx4 v[204:207], v21, s[36:39], s90 offen offset:3072 sc1
 s_add_u32 s90, s72, 8192
 buffer_load_dwordx4 v[208:211], v21, s[36:39], s90 offen offset:0 sc1
 buffer_load_dwordx4 v[212:215], v21, s[36:39], s90 offen offset:1024 sc1
 buffer_load_dwordx4 v[216:219], v21, s[36:39], s90 offen offset:2048 sc1
 buffer_load_dwordx4 v[220:223], v21, s[36:39], s90 offen offset:3072 sc1
 s_add_u32 s90, s72, 12288
 buffer_load_dwordx4 v[224:227], v21, s[36:39], s90 offen offset:0 sc1
 buffer_load_dwordx4 v[228:231], v21, s[36:39], s90 offen offset:1024 sc1
 buffer_load_dwordx4 v[232:235], v21, s[36:39], s90 offen offset:2048 sc1
 buffer_load_dwordx4 v[236:239], v21, s[36:39], s90 offen offset:3072 sc1
gated_mix__compressed_kv_cla__glu_gated_swiglu__prompt_kernel_nopartb:
 s_lshl_b32 s93, s86, 3
 s_lshl_b32 s94, s68, 1
 s_add_u32 s93, s93, s94
 s_mul_i32 s94, s93, 57344
 s_lshl_b32 s96, s84, 10
 s_add_u32 s94, s94, s96
 s_add_u32 s94, s94, 33554432
 s_lshl_b32 s55, s93, 8
 s_add_u32 s55, s55, 53215232
 v_and_b32 v109, 0xf0, v21
 buffer_load_dwordx4 v[244:247], v109, s[36:39], s55 offen offset:0 sc1
 buffer_load_dwordx4 v[248:251], v109, s[36:39], s55 offen offset:256 sc1
 buffer_load_dwordx4 a[128:131], v21, s[64:67], s94 offen offset:0 sc1
 buffer_load_dwordx4 a[132:135], v21, s[64:67], s94 offen offset:1024 sc1
 buffer_load_dwordx4 a[136:139], v21, s[64:67], s94 offen offset:2048 sc1
 s_lshl_b32 s96, s85, 10
 s_add_u32 s96, s96, s94
 s_sub_u32 s96, s96, 1024
 buffer_load_dwordx4 a[140:143], v21, s[64:67], s96 offen sc1
 s_add_u32 s94, s94, 57344
 buffer_load_dwordx4 a[144:147], v21, s[64:67], s94 offen offset:0 sc1
 buffer_load_dwordx4 a[148:151], v21, s[64:67], s94 offen offset:1024 sc1
 buffer_load_dwordx4 a[152:155], v21, s[64:67], s94 offen offset:2048 sc1
 s_lshl_b32 s96, s85, 10
 s_add_u32 s96, s96, s94
 s_sub_u32 s96, s96, 1024
 buffer_load_dwordx4 a[156:159], v21, s[64:67], s96 offen sc1
 s_waitcnt vmcnt(0)
gated_mix__compressed_kv_cla__glu_gated_swiglu__prompt_kernel_loaded:
 s_lshl_b32 s93, s86, 3
 s_lshl_b32 s94, s68, 1
 s_add_u32 s93, s93, s94
 s_mul_i32 s8, s93, 229376
 s_lshl_b32 s96, s82, 10
 s_add_u32 s8, s8, s96
 s_add_u32 s8, s8, 54525952
 s_add_u32 s9, s8, 229376
 s_lshl_b32 s96, s68, 5
 s_lshl_b32 s6, s82, 8
 s_add_u32 s6, s6, s96
 s_mul_i32 s6, s6, 896
 s_lshl_b32 s7, s84, 5
 s_add_u32 s7, s7, s96
 s_mul_i32 s7, s7, 896
 s_waitcnt vmcnt(4)
 s_mov_b32 s99, 1048576
gated_mix__compressed_kv_cla__glu_gated_swiglu__prompt_kernel_gtop:
 v_cmp_eq_u64 vcc, v[244:245], v[28:29]
 v_cmp_eq_u64 s[96:97], v[248:249], v[28:29]
 s_nop 3
 s_and_b64 vcc, vcc, s[96:97]
 s_cmp_eq_u64 vcc, -1
 s_cbranch_scc1 gated_mix__compressed_kv_cla__glu_gated_swiglu__prompt_kernel_gok
 s_sub_u32 s99, s99, 1
 s_cbranch_scc1 gated_mix__compressed_kv_cla__glu_gated_swiglu__prompt_kernel_gok
 s_sleep 12
 buffer_load_dwordx4 v[244:247], v109, s[36:39], s55 offen offset:0 sc1
 buffer_load_dwordx4 v[248:251], v109, s[36:39], s55 offen offset:256 sc1
 s_waitcnt vmcnt(0)
 s_branch gated_mix__compressed_kv_cla__glu_gated_swiglu__prompt_kernel_gtop
gated_mix__compressed_kv_cla__glu_gated_swiglu__prompt_kernel_gok:
 v_mov_b32 v252, v246
 v_mov_b32 v253, v250
 s_cmp_eq_u32 s81, 1
 s_cbranch_scc1 gated_mix__compressed_kv_cla__glu_gated_swiglu__prompt_kernel_merge
 v_rcp_f32 v8, v6
 s_nop 0
 v_mul_f32 v8, v8, v252
 v_rcp_f32 v9, v7
 s_nop 0
 v_mul_f32 v9, v9, v253
 s_add_u32 m0, s76, 0
 s_add_u32 s91, s7, 0
 buffer_load_dwordx4 v10, s[60:63], s91 offen offset:0 lds
 v_accvgpr_read_b32 v32, a0
 v_accvgpr_read_b32 v33, a1
 v_accvgpr_read_b32 v34, a2
 v_accvgpr_read_b32 v35, a3
 v_accvgpr_read_b32 v36, a8
 v_accvgpr_read_b32 v37, a9
 v_accvgpr_read_b32 v38, a10
 v_accvgpr_read_b32 v39, a11
 v_pk_mul_f32 v[32:33], v[32:33], v[8:9] op_sel:[0,0] op_sel_hi:[1,0]
 v_pk_mul_f32 v[34:35], v[34:35], v[8:9] op_sel:[0,0] op_sel_hi:[1,0]
 v_pk_mul_f32 v[36:37], v[36:37], v[8:9] op_sel:[0,0] op_sel_hi:[1,0]
 v_pk_mul_f32 v[38:39], v[38:39], v[8:9] op_sel:[0,0] op_sel_hi:[1,0]
 v_cvt_pk_bf16_f32 v112, v32, v33
 v_cvt_pk_bf16_f32 v113, v34, v35
 v_cvt_pk_bf16_f32 v114, v36, v37
 v_cvt_pk_bf16_f32 v115, v38, v39
 buffer_load_dwordx4 v11, s[60:63], s91 offen offset:1024 lds
 v_accvgpr_read_b32 v40, a16
 v_accvgpr_read_b32 v41, a17
 v_accvgpr_read_b32 v42, a18
 v_accvgpr_read_b32 v43, a19
 v_accvgpr_read_b32 v44, a24
 v_accvgpr_read_b32 v45, a25
 v_accvgpr_read_b32 v46, a26
 v_accvgpr_read_b32 v47, a27
 v_pk_mul_f32 v[40:41], v[40:41], v[8:9] op_sel:[0,0] op_sel_hi:[1,0]
 v_pk_mul_f32 v[42:43], v[42:43], v[8:9] op_sel:[0,0] op_sel_hi:[1,0]
 v_pk_mul_f32 v[44:45], v[44:45], v[8:9] op_sel:[0,0] op_sel_hi:[1,0]
 v_pk_mul_f32 v[46:47], v[46:47], v[8:9] op_sel:[0,0] op_sel_hi:[1,0]
 v_cvt_pk_bf16_f32 v116, v40, v41
 v_cvt_pk_bf16_f32 v117, v42, v43
 v_cvt_pk_bf16_f32 v118, v44, v45
 v_cvt_pk_bf16_f32 v119, v46, v47
 buffer_load_dwordx4 v12, s[60:63], s91 offen offset:2048 lds
 v_accvgpr_read_b32 v48, a32
 v_accvgpr_read_b32 v49, a33
 v_accvgpr_read_b32 v50, a34
 v_accvgpr_read_b32 v51, a35
 v_accvgpr_read_b32 v52, a40
 v_accvgpr_read_b32 v53, a41
 v_accvgpr_read_b32 v54, a42
 v_accvgpr_read_b32 v55, a43
 v_pk_mul_f32 v[48:49], v[48:49], v[8:9] op_sel:[0,0] op_sel_hi:[1,0]
 v_pk_mul_f32 v[50:51], v[50:51], v[8:9] op_sel:[0,0] op_sel_hi:[1,0]
 v_pk_mul_f32 v[52:53], v[52:53], v[8:9] op_sel:[0,0] op_sel_hi:[1,0]
 v_pk_mul_f32 v[54:55], v[54:55], v[8:9] op_sel:[0,0] op_sel_hi:[1,0]
 v_cvt_pk_bf16_f32 v120, v48, v49
 v_cvt_pk_bf16_f32 v121, v50, v51
 v_cvt_pk_bf16_f32 v122, v52, v53
 v_cvt_pk_bf16_f32 v123, v54, v55
 buffer_load_dwordx4 v13, s[60:63], s91 offen offset:3072 lds
 v_accvgpr_read_b32 v56, a48
 v_accvgpr_read_b32 v57, a49
 v_accvgpr_read_b32 v58, a50
 v_accvgpr_read_b32 v59, a51
 v_accvgpr_read_b32 v60, a56
 v_accvgpr_read_b32 v61, a57
 v_accvgpr_read_b32 v62, a58
 v_accvgpr_read_b32 v63, a59
 v_pk_mul_f32 v[56:57], v[56:57], v[8:9] op_sel:[0,0] op_sel_hi:[1,0]
 v_pk_mul_f32 v[58:59], v[58:59], v[8:9] op_sel:[0,0] op_sel_hi:[1,0]
 v_pk_mul_f32 v[60:61], v[60:61], v[8:9] op_sel:[0,0] op_sel_hi:[1,0]
 v_pk_mul_f32 v[62:63], v[62:63], v[8:9] op_sel:[0,0] op_sel_hi:[1,0]
 v_cvt_pk_bf16_f32 v124, v56, v57
 v_cvt_pk_bf16_f32 v125, v58, v59
 v_cvt_pk_bf16_f32 v126, v60, v61
 v_cvt_pk_bf16_f32 v127, v62, v63
 s_add_u32 m0, s76, 16384
 s_add_u32 s91, s6, 0
 buffer_load_dwordx4 v10, s[56:59], s91 offen offset:0 lds
 v_accvgpr_read_b32 v32, a64
 v_accvgpr_read_b32 v33, a65
 v_accvgpr_read_b32 v34, a66
 v_accvgpr_read_b32 v35, a67
 v_accvgpr_read_b32 v36, a72
 v_accvgpr_read_b32 v37, a73
 v_accvgpr_read_b32 v38, a74
 v_accvgpr_read_b32 v39, a75
 v_pk_mul_f32 v[32:33], v[32:33], v[8:9] op_sel:[0,0] op_sel_hi:[1,0]
 v_pk_mul_f32 v[34:35], v[34:35], v[8:9] op_sel:[0,0] op_sel_hi:[1,0]
 v_pk_mul_f32 v[36:37], v[36:37], v[8:9] op_sel:[0,0] op_sel_hi:[1,0]
 v_pk_mul_f32 v[38:39], v[38:39], v[8:9] op_sel:[0,0] op_sel_hi:[1,0]
 v_cvt_pk_bf16_f32 v128, v32, v33
 v_cvt_pk_bf16_f32 v129, v34, v35
 v_cvt_pk_bf16_f32 v130, v36, v37
 v_cvt_pk_bf16_f32 v131, v38, v39
 buffer_load_dwordx4 v11, s[56:59], s91 offen offset:1024 lds
 v_accvgpr_read_b32 v40, a80
 v_accvgpr_read_b32 v41, a81
 v_accvgpr_read_b32 v42, a82
 v_accvgpr_read_b32 v43, a83
 v_accvgpr_read_b32 v44, a88
 v_accvgpr_read_b32 v45, a89
 v_accvgpr_read_b32 v46, a90
 v_accvgpr_read_b32 v47, a91
 v_pk_mul_f32 v[40:41], v[40:41], v[8:9] op_sel:[0,0] op_sel_hi:[1,0]
 v_pk_mul_f32 v[42:43], v[42:43], v[8:9] op_sel:[0,0] op_sel_hi:[1,0]
 v_pk_mul_f32 v[44:45], v[44:45], v[8:9] op_sel:[0,0] op_sel_hi:[1,0]
 v_pk_mul_f32 v[46:47], v[46:47], v[8:9] op_sel:[0,0] op_sel_hi:[1,0]
 v_cvt_pk_bf16_f32 v132, v40, v41
 v_cvt_pk_bf16_f32 v133, v42, v43
 v_cvt_pk_bf16_f32 v134, v44, v45
 v_cvt_pk_bf16_f32 v135, v46, v47
 buffer_load_dwordx4 v12, s[56:59], s91 offen offset:2048 lds
 v_accvgpr_read_b32 v48, a96
 v_accvgpr_read_b32 v49, a97
 v_accvgpr_read_b32 v50, a98
 v_accvgpr_read_b32 v51, a99
 v_accvgpr_read_b32 v52, a104
 v_accvgpr_read_b32 v53, a105
 v_accvgpr_read_b32 v54, a106
 v_accvgpr_read_b32 v55, a107
 v_pk_mul_f32 v[48:49], v[48:49], v[8:9] op_sel:[0,0] op_sel_hi:[1,0]
 v_pk_mul_f32 v[50:51], v[50:51], v[8:9] op_sel:[0,0] op_sel_hi:[1,0]
 v_pk_mul_f32 v[52:53], v[52:53], v[8:9] op_sel:[0,0] op_sel_hi:[1,0]
 v_pk_mul_f32 v[54:55], v[54:55], v[8:9] op_sel:[0,0] op_sel_hi:[1,0]
 v_cvt_pk_bf16_f32 v136, v48, v49
 v_cvt_pk_bf16_f32 v137, v50, v51
 v_cvt_pk_bf16_f32 v138, v52, v53
 v_cvt_pk_bf16_f32 v139, v54, v55
 buffer_load_dwordx4 v13, s[56:59], s91 offen offset:3072 lds
 v_accvgpr_read_b32 v56, a112
 v_accvgpr_read_b32 v57, a113
 v_accvgpr_read_b32 v58, a114
 v_accvgpr_read_b32 v59, a115
 v_accvgpr_read_b32 v60, a120
 v_accvgpr_read_b32 v61, a121
 v_accvgpr_read_b32 v62, a122
 v_accvgpr_read_b32 v63, a123
 v_pk_mul_f32 v[56:57], v[56:57], v[8:9] op_sel:[0,0] op_sel_hi:[1,0]
 v_pk_mul_f32 v[58:59], v[58:59], v[8:9] op_sel:[0,0] op_sel_hi:[1,0]
 v_pk_mul_f32 v[60:61], v[60:61], v[8:9] op_sel:[0,0] op_sel_hi:[1,0]
 v_pk_mul_f32 v[62:63], v[62:63], v[8:9] op_sel:[0,0] op_sel_hi:[1,0]
 v_cvt_pk_bf16_f32 v140, v56, v57
 v_cvt_pk_bf16_f32 v141, v58, v59
 v_cvt_pk_bf16_f32 v142, v60, v61
 v_cvt_pk_bf16_f32 v143, v62, v63
 s_add_u32 m0, s76, 32768
 s_add_u32 s91, s6, 114688
 buffer_load_dwordx4 v10, s[56:59], s91 offen offset:0 lds
 v_accvgpr_read_b32 v32, a4
 v_accvgpr_read_b32 v33, a5
 v_accvgpr_read_b32 v34, a6
 v_accvgpr_read_b32 v35, a7
 v_accvgpr_read_b32 v36, a12
 v_accvgpr_read_b32 v37, a13
 v_accvgpr_read_b32 v38, a14
 v_accvgpr_read_b32 v39, a15
 v_pk_mul_f32 v[32:33], v[32:33], v[8:9] op_sel:[0,1] op_sel_hi:[1,1]
 v_pk_mul_f32 v[34:35], v[34:35], v[8:9] op_sel:[0,1] op_sel_hi:[1,1]
 v_pk_mul_f32 v[36:37], v[36:37], v[8:9] op_sel:[0,1] op_sel_hi:[1,1]
 v_pk_mul_f32 v[38:39], v[38:39], v[8:9] op_sel:[0,1] op_sel_hi:[1,1]
 v_cvt_pk_bf16_f32 v144, v32, v33
 v_cvt_pk_bf16_f32 v145, v34, v35
 v_cvt_pk_bf16_f32 v146, v36, v37
 v_cvt_pk_bf16_f32 v147, v38, v39
 buffer_load_dwordx4 v11, s[56:59], s91 offen offset:1024 lds
 v_accvgpr_read_b32 v40, a20
 v_accvgpr_read_b32 v41, a21
 v_accvgpr_read_b32 v42, a22
 v_accvgpr_read_b32 v43, a23
 v_accvgpr_read_b32 v44, a28
 v_accvgpr_read_b32 v45, a29
 v_accvgpr_read_b32 v46, a30
 v_accvgpr_read_b32 v47, a31
 v_pk_mul_f32 v[40:41], v[40:41], v[8:9] op_sel:[0,1] op_sel_hi:[1,1]
 v_pk_mul_f32 v[42:43], v[42:43], v[8:9] op_sel:[0,1] op_sel_hi:[1,1]
 v_pk_mul_f32 v[44:45], v[44:45], v[8:9] op_sel:[0,1] op_sel_hi:[1,1]
 v_pk_mul_f32 v[46:47], v[46:47], v[8:9] op_sel:[0,1] op_sel_hi:[1,1]
 v_cvt_pk_bf16_f32 v148, v40, v41
 v_cvt_pk_bf16_f32 v149, v42, v43
 v_cvt_pk_bf16_f32 v150, v44, v45
 v_cvt_pk_bf16_f32 v151, v46, v47
 buffer_load_dwordx4 v12, s[56:59], s91 offen offset:2048 lds
 v_accvgpr_read_b32 v48, a36
 v_accvgpr_read_b32 v49, a37
 v_accvgpr_read_b32 v50, a38
 v_accvgpr_read_b32 v51, a39
 v_accvgpr_read_b32 v52, a44
 v_accvgpr_read_b32 v53, a45
 v_accvgpr_read_b32 v54, a46
 v_accvgpr_read_b32 v55, a47
 v_pk_mul_f32 v[48:49], v[48:49], v[8:9] op_sel:[0,1] op_sel_hi:[1,1]
 v_pk_mul_f32 v[50:51], v[50:51], v[8:9] op_sel:[0,1] op_sel_hi:[1,1]
 v_pk_mul_f32 v[52:53], v[52:53], v[8:9] op_sel:[0,1] op_sel_hi:[1,1]
 v_pk_mul_f32 v[54:55], v[54:55], v[8:9] op_sel:[0,1] op_sel_hi:[1,1]
 v_cvt_pk_bf16_f32 v152, v48, v49
 v_cvt_pk_bf16_f32 v153, v50, v51
 v_cvt_pk_bf16_f32 v154, v52, v53
 v_cvt_pk_bf16_f32 v155, v54, v55
 buffer_load_dwordx4 v13, s[56:59], s91 offen offset:3072 lds
 v_accvgpr_read_b32 v56, a52
 v_accvgpr_read_b32 v57, a53
 v_accvgpr_read_b32 v58, a54
 v_accvgpr_read_b32 v59, a55
 v_accvgpr_read_b32 v60, a60
 v_accvgpr_read_b32 v61, a61
 v_accvgpr_read_b32 v62, a62
 v_accvgpr_read_b32 v63, a63
 v_pk_mul_f32 v[56:57], v[56:57], v[8:9] op_sel:[0,1] op_sel_hi:[1,1]
 v_pk_mul_f32 v[58:59], v[58:59], v[8:9] op_sel:[0,1] op_sel_hi:[1,1]
 v_pk_mul_f32 v[60:61], v[60:61], v[8:9] op_sel:[0,1] op_sel_hi:[1,1]
 v_pk_mul_f32 v[62:63], v[62:63], v[8:9] op_sel:[0,1] op_sel_hi:[1,1]
 v_cvt_pk_bf16_f32 v156, v56, v57
 v_cvt_pk_bf16_f32 v157, v58, v59
 v_cvt_pk_bf16_f32 v158, v60, v61
 v_cvt_pk_bf16_f32 v159, v62, v63
 s_add_u32 m0, s76, 49152
 s_add_u32 s91, s7, 128
 buffer_load_dwordx4 v10, s[60:63], s91 offen offset:0 lds
 v_accvgpr_read_b32 v32, a68
 v_accvgpr_read_b32 v33, a69
 v_accvgpr_read_b32 v34, a70
 v_accvgpr_read_b32 v35, a71
 v_accvgpr_read_b32 v36, a76
 v_accvgpr_read_b32 v37, a77
 v_accvgpr_read_b32 v38, a78
 v_accvgpr_read_b32 v39, a79
 v_pk_mul_f32 v[32:33], v[32:33], v[8:9] op_sel:[0,1] op_sel_hi:[1,1]
 v_pk_mul_f32 v[34:35], v[34:35], v[8:9] op_sel:[0,1] op_sel_hi:[1,1]
 v_pk_mul_f32 v[36:37], v[36:37], v[8:9] op_sel:[0,1] op_sel_hi:[1,1]
 v_pk_mul_f32 v[38:39], v[38:39], v[8:9] op_sel:[0,1] op_sel_hi:[1,1]
 v_cvt_pk_bf16_f32 v160, v32, v33
 v_cvt_pk_bf16_f32 v161, v34, v35
 v_cvt_pk_bf16_f32 v162, v36, v37
 v_cvt_pk_bf16_f32 v163, v38, v39
 buffer_load_dwordx4 v11, s[60:63], s91 offen offset:1024 lds
 v_accvgpr_read_b32 v40, a84
 v_accvgpr_read_b32 v41, a85
 v_accvgpr_read_b32 v42, a86
 v_accvgpr_read_b32 v43, a87
 v_accvgpr_read_b32 v44, a92
 v_accvgpr_read_b32 v45, a93
 v_accvgpr_read_b32 v46, a94
 v_accvgpr_read_b32 v47, a95
 v_pk_mul_f32 v[40:41], v[40:41], v[8:9] op_sel:[0,1] op_sel_hi:[1,1]
 v_pk_mul_f32 v[42:43], v[42:43], v[8:9] op_sel:[0,1] op_sel_hi:[1,1]
 v_pk_mul_f32 v[44:45], v[44:45], v[8:9] op_sel:[0,1] op_sel_hi:[1,1]
 v_pk_mul_f32 v[46:47], v[46:47], v[8:9] op_sel:[0,1] op_sel_hi:[1,1]
 v_cvt_pk_bf16_f32 v164, v40, v41
 v_cvt_pk_bf16_f32 v165, v42, v43
 v_cvt_pk_bf16_f32 v166, v44, v45
 v_cvt_pk_bf16_f32 v167, v46, v47
 buffer_load_dwordx4 v12, s[60:63], s91 offen offset:2048 lds
 v_accvgpr_read_b32 v48, a100
 v_accvgpr_read_b32 v49, a101
 v_accvgpr_read_b32 v50, a102
 v_accvgpr_read_b32 v51, a103
 v_accvgpr_read_b32 v52, a108
 v_accvgpr_read_b32 v53, a109
 v_accvgpr_read_b32 v54, a110
 v_accvgpr_read_b32 v55, a111
 v_pk_mul_f32 v[48:49], v[48:49], v[8:9] op_sel:[0,1] op_sel_hi:[1,1]
 v_pk_mul_f32 v[50:51], v[50:51], v[8:9] op_sel:[0,1] op_sel_hi:[1,1]
 v_pk_mul_f32 v[52:53], v[52:53], v[8:9] op_sel:[0,1] op_sel_hi:[1,1]
 v_pk_mul_f32 v[54:55], v[54:55], v[8:9] op_sel:[0,1] op_sel_hi:[1,1]
 v_cvt_pk_bf16_f32 v168, v48, v49
 v_cvt_pk_bf16_f32 v169, v50, v51
 v_cvt_pk_bf16_f32 v170, v52, v53
 v_cvt_pk_bf16_f32 v171, v54, v55
 buffer_load_dwordx4 v13, s[60:63], s91 offen offset:3072 lds
 v_accvgpr_read_b32 v56, a116
 v_accvgpr_read_b32 v57, a117
 v_accvgpr_read_b32 v58, a118
 v_accvgpr_read_b32 v59, a119
 v_accvgpr_read_b32 v60, a124
 v_accvgpr_read_b32 v61, a125
 v_accvgpr_read_b32 v62, a126
 v_accvgpr_read_b32 v63, a127
 v_pk_mul_f32 v[56:57], v[56:57], v[8:9] op_sel:[0,1] op_sel_hi:[1,1]
 v_pk_mul_f32 v[58:59], v[58:59], v[8:9] op_sel:[0,1] op_sel_hi:[1,1]
 v_pk_mul_f32 v[60:61], v[60:61], v[8:9] op_sel:[0,1] op_sel_hi:[1,1]
 v_pk_mul_f32 v[62:63], v[62:63], v[8:9] op_sel:[0,1] op_sel_hi:[1,1]
 v_cvt_pk_bf16_f32 v172, v56, v57
 v_cvt_pk_bf16_f32 v173, v58, v59
 v_cvt_pk_bf16_f32 v174, v60, v61
 v_cvt_pk_bf16_f32 v175, v62, v63
 s_branch gated_mix__compressed_kv_cla__glu_gated_swiglu__prompt_kernel_p4
gated_mix__compressed_kv_cla__glu_gated_swiglu__prompt_kernel_merge:
 v_min_f32 v88, v4, v240
 v_sub_f32 v98, v88, v4
 v_sub_f32 v100, v88, v240
 v_exp_f32 v98, v98
 v_exp_f32 v100, v100
 s_nop 0
 v_mul_f32 v100, v100, v241
 v_fma_f32 v88, v6, v98, v100
 v_rcp_f32 v88, v88
 s_nop 0
 v_mul_f32 v88, v88, v252
 v_mul_f32 v98, v98, v88
 v_mul_f32 v100, v100, v88
 v_min_f32 v88, v5, v242
 v_sub_f32 v99, v88, v5
 v_sub_f32 v101, v88, v242
 v_exp_f32 v99, v99
 v_exp_f32 v101, v101
 s_nop 0
 v_mul_f32 v101, v101, v243
 v_fma_f32 v88, v7, v99, v101
 v_rcp_f32 v88, v88
 s_nop 0
 v_mul_f32 v88, v88, v253
 v_mul_f32 v99, v99, v88
 v_mul_f32 v101, v101, v88
 s_add_u32 m0, s76, 0
 s_add_u32 s91, s7, 0
 buffer_load_dwordx4 v10, s[60:63], s91 offen offset:0 lds
 v_accvgpr_read_b32 v32, a0
 v_accvgpr_read_b32 v33, a1
 v_accvgpr_read_b32 v34, a2
 v_accvgpr_read_b32 v35, a3
 v_accvgpr_read_b32 v36, a8
 v_accvgpr_read_b32 v37, a9
 v_accvgpr_read_b32 v38, a10
 v_accvgpr_read_b32 v39, a11
 v_lshlrev_b32 v64, 16, v176
 v_and_b32 v65, 0xffff0000, v176
 v_lshlrev_b32 v66, 16, v177
 v_and_b32 v67, 0xffff0000, v177
 v_lshlrev_b32 v68, 16, v178
 v_and_b32 v69, 0xffff0000, v178
 v_lshlrev_b32 v70, 16, v179
 v_and_b32 v71, 0xffff0000, v179
 v_pk_mul_f32 v[32:33], v[32:33], v[98:99] op_sel:[0,0] op_sel_hi:[1,0]
 v_pk_mul_f32 v[34:35], v[34:35], v[98:99] op_sel:[0,0] op_sel_hi:[1,0]
 v_pk_mul_f32 v[36:37], v[36:37], v[98:99] op_sel:[0,0] op_sel_hi:[1,0]
 v_pk_mul_f32 v[38:39], v[38:39], v[98:99] op_sel:[0,0] op_sel_hi:[1,0]
 v_pk_fma_f32 v[32:33], v[64:65], v[100:101], v[32:33] op_sel:[0,0,0] op_sel_hi:[1,0,1]
 v_pk_fma_f32 v[34:35], v[66:67], v[100:101], v[34:35] op_sel:[0,0,0] op_sel_hi:[1,0,1]
 v_pk_fma_f32 v[36:37], v[68:69], v[100:101], v[36:37] op_sel:[0,0,0] op_sel_hi:[1,0,1]
 v_pk_fma_f32 v[38:39], v[70:71], v[100:101], v[38:39] op_sel:[0,0,0] op_sel_hi:[1,0,1]
 v_cvt_pk_bf16_f32 v112, v32, v33
 v_cvt_pk_bf16_f32 v113, v34, v35
 v_cvt_pk_bf16_f32 v114, v36, v37
 v_cvt_pk_bf16_f32 v115, v38, v39
 buffer_load_dwordx4 v11, s[60:63], s91 offen offset:1024 lds
 v_accvgpr_read_b32 v40, a16
 v_accvgpr_read_b32 v41, a17
 v_accvgpr_read_b32 v42, a18
 v_accvgpr_read_b32 v43, a19
 v_accvgpr_read_b32 v44, a24
 v_accvgpr_read_b32 v45, a25
 v_accvgpr_read_b32 v46, a26
 v_accvgpr_read_b32 v47, a27
 v_lshlrev_b32 v72, 16, v180
 v_and_b32 v73, 0xffff0000, v180
 v_lshlrev_b32 v74, 16, v181
 v_and_b32 v75, 0xffff0000, v181
 v_lshlrev_b32 v76, 16, v182
 v_and_b32 v77, 0xffff0000, v182
 v_lshlrev_b32 v78, 16, v183
 v_and_b32 v79, 0xffff0000, v183
 v_pk_mul_f32 v[40:41], v[40:41], v[98:99] op_sel:[0,0] op_sel_hi:[1,0]
 v_pk_mul_f32 v[42:43], v[42:43], v[98:99] op_sel:[0,0] op_sel_hi:[1,0]
 v_pk_mul_f32 v[44:45], v[44:45], v[98:99] op_sel:[0,0] op_sel_hi:[1,0]
 v_pk_mul_f32 v[46:47], v[46:47], v[98:99] op_sel:[0,0] op_sel_hi:[1,0]
 v_pk_fma_f32 v[40:41], v[72:73], v[100:101], v[40:41] op_sel:[0,0,0] op_sel_hi:[1,0,1]
 v_pk_fma_f32 v[42:43], v[74:75], v[100:101], v[42:43] op_sel:[0,0,0] op_sel_hi:[1,0,1]
 v_pk_fma_f32 v[44:45], v[76:77], v[100:101], v[44:45] op_sel:[0,0,0] op_sel_hi:[1,0,1]
 v_pk_fma_f32 v[46:47], v[78:79], v[100:101], v[46:47] op_sel:[0,0,0] op_sel_hi:[1,0,1]
 v_cvt_pk_bf16_f32 v116, v40, v41
 v_cvt_pk_bf16_f32 v117, v42, v43
 v_cvt_pk_bf16_f32 v118, v44, v45
 v_cvt_pk_bf16_f32 v119, v46, v47
 buffer_load_dwordx4 v12, s[60:63], s91 offen offset:2048 lds
 v_accvgpr_read_b32 v48, a32
 v_accvgpr_read_b32 v49, a33
 v_accvgpr_read_b32 v50, a34
 v_accvgpr_read_b32 v51, a35
 v_accvgpr_read_b32 v52, a40
 v_accvgpr_read_b32 v53, a41
 v_accvgpr_read_b32 v54, a42
 v_accvgpr_read_b32 v55, a43
 v_lshlrev_b32 v80, 16, v184
 v_and_b32 v81, 0xffff0000, v184
 v_lshlrev_b32 v82, 16, v185
 v_and_b32 v83, 0xffff0000, v185
 v_lshlrev_b32 v84, 16, v186
 v_and_b32 v85, 0xffff0000, v186
 v_lshlrev_b32 v86, 16, v187
 v_and_b32 v87, 0xffff0000, v187
 v_pk_mul_f32 v[48:49], v[48:49], v[98:99] op_sel:[0,0] op_sel_hi:[1,0]
 v_pk_mul_f32 v[50:51], v[50:51], v[98:99] op_sel:[0,0] op_sel_hi:[1,0]
 v_pk_mul_f32 v[52:53], v[52:53], v[98:99] op_sel:[0,0] op_sel_hi:[1,0]
 v_pk_mul_f32 v[54:55], v[54:55], v[98:99] op_sel:[0,0] op_sel_hi:[1,0]
 v_pk_fma_f32 v[48:49], v[80:81], v[100:101], v[48:49] op_sel:[0,0,0] op_sel_hi:[1,0,1]
 v_pk_fma_f32 v[50:51], v[82:83], v[100:101], v[50:51] op_sel:[0,0,0] op_sel_hi:[1,0,1]
 v_pk_fma_f32 v[52:53], v[84:85], v[100:101], v[52:53] op_sel:[0,0,0] op_sel_hi:[1,0,1]
 v_pk_fma_f32 v[54:55], v[86:87], v[100:101], v[54:55] op_sel:[0,0,0] op_sel_hi:[1,0,1]
 v_cvt_pk_bf16_f32 v120, v48, v49
 v_cvt_pk_bf16_f32 v121, v50, v51
 v_cvt_pk_bf16_f32 v122, v52, v53
 v_cvt_pk_bf16_f32 v123, v54, v55
 buffer_load_dwordx4 v13, s[60:63], s91 offen offset:3072 lds
 v_accvgpr_read_b32 v56, a48
 v_accvgpr_read_b32 v57, a49
 v_accvgpr_read_b32 v58, a50
 v_accvgpr_read_b32 v59, a51
 v_accvgpr_read_b32 v60, a56
 v_accvgpr_read_b32 v61, a57
 v_accvgpr_read_b32 v62, a58
 v_accvgpr_read_b32 v63, a59
 v_lshlrev_b32 v64, 16, v188
 v_and_b32 v65, 0xffff0000, v188
 v_lshlrev_b32 v66, 16, v189
 v_and_b32 v67, 0xffff0000, v189
 v_lshlrev_b32 v68, 16, v190
 v_and_b32 v69, 0xffff0000, v190
 v_lshlrev_b32 v70, 16, v191
 v_and_b32 v71, 0xffff0000, v191
 v_pk_mul_f32 v[56:57], v[56:57], v[98:99] op_sel:[0,0] op_sel_hi:[1,0]
 v_pk_mul_f32 v[58:59], v[58:59], v[98:99] op_sel:[0,0] op_sel_hi:[1,0]
 v_pk_mul_f32 v[60:61], v[60:61], v[98:99] op_sel:[0,0] op_sel_hi:[1,0]
 v_pk_mul_f32 v[62:63], v[62:63], v[98:99] op_sel:[0,0] op_sel_hi:[1,0]
 v_pk_fma_f32 v[56:57], v[64:65], v[100:101], v[56:57] op_sel:[0,0,0] op_sel_hi:[1,0,1]
 v_pk_fma_f32 v[58:59], v[66:67], v[100:101], v[58:59] op_sel:[0,0,0] op_sel_hi:[1,0,1]
 v_pk_fma_f32 v[60:61], v[68:69], v[100:101], v[60:61] op_sel:[0,0,0] op_sel_hi:[1,0,1]
 v_pk_fma_f32 v[62:63], v[70:71], v[100:101], v[62:63] op_sel:[0,0,0] op_sel_hi:[1,0,1]
 v_cvt_pk_bf16_f32 v124, v56, v57
 v_cvt_pk_bf16_f32 v125, v58, v59
 v_cvt_pk_bf16_f32 v126, v60, v61
 v_cvt_pk_bf16_f32 v127, v62, v63
 s_add_u32 m0, s76, 16384
 s_add_u32 s91, s6, 0
 buffer_load_dwordx4 v10, s[56:59], s91 offen offset:0 lds
 v_accvgpr_read_b32 v32, a64
 v_accvgpr_read_b32 v33, a65
 v_accvgpr_read_b32 v34, a66
 v_accvgpr_read_b32 v35, a67
 v_accvgpr_read_b32 v36, a72
 v_accvgpr_read_b32 v37, a73
 v_accvgpr_read_b32 v38, a74
 v_accvgpr_read_b32 v39, a75
 v_lshlrev_b32 v72, 16, v192
 v_and_b32 v73, 0xffff0000, v192
 v_lshlrev_b32 v74, 16, v193
 v_and_b32 v75, 0xffff0000, v193
 v_lshlrev_b32 v76, 16, v194
 v_and_b32 v77, 0xffff0000, v194
 v_lshlrev_b32 v78, 16, v195
 v_and_b32 v79, 0xffff0000, v195
 v_pk_mul_f32 v[32:33], v[32:33], v[98:99] op_sel:[0,0] op_sel_hi:[1,0]
 v_pk_mul_f32 v[34:35], v[34:35], v[98:99] op_sel:[0,0] op_sel_hi:[1,0]
 v_pk_mul_f32 v[36:37], v[36:37], v[98:99] op_sel:[0,0] op_sel_hi:[1,0]
 v_pk_mul_f32 v[38:39], v[38:39], v[98:99] op_sel:[0,0] op_sel_hi:[1,0]
 v_pk_fma_f32 v[32:33], v[72:73], v[100:101], v[32:33] op_sel:[0,0,0] op_sel_hi:[1,0,1]
 v_pk_fma_f32 v[34:35], v[74:75], v[100:101], v[34:35] op_sel:[0,0,0] op_sel_hi:[1,0,1]
 v_pk_fma_f32 v[36:37], v[76:77], v[100:101], v[36:37] op_sel:[0,0,0] op_sel_hi:[1,0,1]
 v_pk_fma_f32 v[38:39], v[78:79], v[100:101], v[38:39] op_sel:[0,0,0] op_sel_hi:[1,0,1]
 v_cvt_pk_bf16_f32 v128, v32, v33
 v_cvt_pk_bf16_f32 v129, v34, v35
 v_cvt_pk_bf16_f32 v130, v36, v37
 v_cvt_pk_bf16_f32 v131, v38, v39
 buffer_load_dwordx4 v11, s[56:59], s91 offen offset:1024 lds
 v_accvgpr_read_b32 v40, a80
 v_accvgpr_read_b32 v41, a81
 v_accvgpr_read_b32 v42, a82
 v_accvgpr_read_b32 v43, a83
 v_accvgpr_read_b32 v44, a88
 v_accvgpr_read_b32 v45, a89
 v_accvgpr_read_b32 v46, a90
 v_accvgpr_read_b32 v47, a91
 v_lshlrev_b32 v80, 16, v196
 v_and_b32 v81, 0xffff0000, v196
 v_lshlrev_b32 v82, 16, v197
 v_and_b32 v83, 0xffff0000, v197
 v_lshlrev_b32 v84, 16, v198
 v_and_b32 v85, 0xffff0000, v198
 v_lshlrev_b32 v86, 16, v199
 v_and_b32 v87, 0xffff0000, v199
 v_pk_mul_f32 v[40:41], v[40:41], v[98:99] op_sel:[0,0] op_sel_hi:[1,0]
 v_pk_mul_f32 v[42:43], v[42:43], v[98:99] op_sel:[0,0] op_sel_hi:[1,0]
 v_pk_mul_f32 v[44:45], v[44:45], v[98:99] op_sel:[0,0] op_sel_hi:[1,0]
 v_pk_mul_f32 v[46:47], v[46:47], v[98:99] op_sel:[0,0] op_sel_hi:[1,0]
 v_pk_fma_f32 v[40:41], v[80:81], v[100:101], v[40:41] op_sel:[0,0,0] op_sel_hi:[1,0,1]
 v_pk_fma_f32 v[42:43], v[82:83], v[100:101], v[42:43] op_sel:[0,0,0] op_sel_hi:[1,0,1]
 v_pk_fma_f32 v[44:45], v[84:85], v[100:101], v[44:45] op_sel:[0,0,0] op_sel_hi:[1,0,1]
 v_pk_fma_f32 v[46:47], v[86:87], v[100:101], v[46:47] op_sel:[0,0,0] op_sel_hi:[1,0,1]
 v_cvt_pk_bf16_f32 v132, v40, v41
 v_cvt_pk_bf16_f32 v133, v42, v43
 v_cvt_pk_bf16_f32 v134, v44, v45
 v_cvt_pk_bf16_f32 v135, v46, v47
 buffer_load_dwordx4 v12, s[56:59], s91 offen offset:2048 lds
 v_accvgpr_read_b32 v48, a96
 v_accvgpr_read_b32 v49, a97
 v_accvgpr_read_b32 v50, a98
 v_accvgpr_read_b32 v51, a99
 v_accvgpr_read_b32 v52, a104
 v_accvgpr_read_b32 v53, a105
 v_accvgpr_read_b32 v54, a106
 v_accvgpr_read_b32 v55, a107
 v_lshlrev_b32 v64, 16, v200
 v_and_b32 v65, 0xffff0000, v200
 v_lshlrev_b32 v66, 16, v201
 v_and_b32 v67, 0xffff0000, v201
 v_lshlrev_b32 v68, 16, v202
 v_and_b32 v69, 0xffff0000, v202
 v_lshlrev_b32 v70, 16, v203
 v_and_b32 v71, 0xffff0000, v203
 v_pk_mul_f32 v[48:49], v[48:49], v[98:99] op_sel:[0,0] op_sel_hi:[1,0]
 v_pk_mul_f32 v[50:51], v[50:51], v[98:99] op_sel:[0,0] op_sel_hi:[1,0]
 v_pk_mul_f32 v[52:53], v[52:53], v[98:99] op_sel:[0,0] op_sel_hi:[1,0]
 v_pk_mul_f32 v[54:55], v[54:55], v[98:99] op_sel:[0,0] op_sel_hi:[1,0]
 v_pk_fma_f32 v[48:49], v[64:65], v[100:101], v[48:49] op_sel:[0,0,0] op_sel_hi:[1,0,1]
 v_pk_fma_f32 v[50:51], v[66:67], v[100:101], v[50:51] op_sel:[0,0,0] op_sel_hi:[1,0,1]
 v_pk_fma_f32 v[52:53], v[68:69], v[100:101], v[52:53] op_sel:[0,0,0] op_sel_hi:[1,0,1]
 v_pk_fma_f32 v[54:55], v[70:71], v[100:101], v[54:55] op_sel:[0,0,0] op_sel_hi:[1,0,1]
 v_cvt_pk_bf16_f32 v136, v48, v49
 v_cvt_pk_bf16_f32 v137, v50, v51
 v_cvt_pk_bf16_f32 v138, v52, v53
 v_cvt_pk_bf16_f32 v139, v54, v55
 buffer_load_dwordx4 v13, s[56:59], s91 offen offset:3072 lds
 v_accvgpr_read_b32 v56, a112
 v_accvgpr_read_b32 v57, a113
 v_accvgpr_read_b32 v58, a114
 v_accvgpr_read_b32 v59, a115
 v_accvgpr_read_b32 v60, a120
 v_accvgpr_read_b32 v61, a121
 v_accvgpr_read_b32 v62, a122
 v_accvgpr_read_b32 v63, a123
 v_lshlrev_b32 v72, 16, v204
 v_and_b32 v73, 0xffff0000, v204
 v_lshlrev_b32 v74, 16, v205
 v_and_b32 v75, 0xffff0000, v205
 v_lshlrev_b32 v76, 16, v206
 v_and_b32 v77, 0xffff0000, v206
 v_lshlrev_b32 v78, 16, v207
 v_and_b32 v79, 0xffff0000, v207
 v_pk_mul_f32 v[56:57], v[56:57], v[98:99] op_sel:[0,0] op_sel_hi:[1,0]
 v_pk_mul_f32 v[58:59], v[58:59], v[98:99] op_sel:[0,0] op_sel_hi:[1,0]
 v_pk_mul_f32 v[60:61], v[60:61], v[98:99] op_sel:[0,0] op_sel_hi:[1,0]
 v_pk_mul_f32 v[62:63], v[62:63], v[98:99] op_sel:[0,0] op_sel_hi:[1,0]
 v_pk_fma_f32 v[56:57], v[72:73], v[100:101], v[56:57] op_sel:[0,0,0] op_sel_hi:[1,0,1]
 v_pk_fma_f32 v[58:59], v[74:75], v[100:101], v[58:59] op_sel:[0,0,0] op_sel_hi:[1,0,1]
 v_pk_fma_f32 v[60:61], v[76:77], v[100:101], v[60:61] op_sel:[0,0,0] op_sel_hi:[1,0,1]
 v_pk_fma_f32 v[62:63], v[78:79], v[100:101], v[62:63] op_sel:[0,0,0] op_sel_hi:[1,0,1]
 v_cvt_pk_bf16_f32 v140, v56, v57
 v_cvt_pk_bf16_f32 v141, v58, v59
 v_cvt_pk_bf16_f32 v142, v60, v61
 v_cvt_pk_bf16_f32 v143, v62, v63
 s_add_u32 m0, s76, 32768
 s_add_u32 s91, s6, 114688
 buffer_load_dwordx4 v10, s[56:59], s91 offen offset:0 lds
 v_accvgpr_read_b32 v32, a4
 v_accvgpr_read_b32 v33, a5
 v_accvgpr_read_b32 v34, a6
 v_accvgpr_read_b32 v35, a7
 v_accvgpr_read_b32 v36, a12
 v_accvgpr_read_b32 v37, a13
 v_accvgpr_read_b32 v38, a14
 v_accvgpr_read_b32 v39, a15
 v_lshlrev_b32 v80, 16, v208
 v_and_b32 v81, 0xffff0000, v208
 v_lshlrev_b32 v82, 16, v209
 v_and_b32 v83, 0xffff0000, v209
 v_lshlrev_b32 v84, 16, v210
 v_and_b32 v85, 0xffff0000, v210
 v_lshlrev_b32 v86, 16, v211
 v_and_b32 v87, 0xffff0000, v211
 v_pk_mul_f32 v[32:33], v[32:33], v[98:99] op_sel:[0,1] op_sel_hi:[1,1]
 v_pk_mul_f32 v[34:35], v[34:35], v[98:99] op_sel:[0,1] op_sel_hi:[1,1]
 v_pk_mul_f32 v[36:37], v[36:37], v[98:99] op_sel:[0,1] op_sel_hi:[1,1]
 v_pk_mul_f32 v[38:39], v[38:39], v[98:99] op_sel:[0,1] op_sel_hi:[1,1]
 v_pk_fma_f32 v[32:33], v[80:81], v[100:101], v[32:33] op_sel:[0,1,0] op_sel_hi:[1,1,1]
 v_pk_fma_f32 v[34:35], v[82:83], v[100:101], v[34:35] op_sel:[0,1,0] op_sel_hi:[1,1,1]
 v_pk_fma_f32 v[36:37], v[84:85], v[100:101], v[36:37] op_sel:[0,1,0] op_sel_hi:[1,1,1]
 v_pk_fma_f32 v[38:39], v[86:87], v[100:101], v[38:39] op_sel:[0,1,0] op_sel_hi:[1,1,1]
 v_cvt_pk_bf16_f32 v144, v32, v33
 v_cvt_pk_bf16_f32 v145, v34, v35
 v_cvt_pk_bf16_f32 v146, v36, v37
 v_cvt_pk_bf16_f32 v147, v38, v39
 buffer_load_dwordx4 v11, s[56:59], s91 offen offset:1024 lds
 v_accvgpr_read_b32 v40, a20
 v_accvgpr_read_b32 v41, a21
 v_accvgpr_read_b32 v42, a22
 v_accvgpr_read_b32 v43, a23
 v_accvgpr_read_b32 v44, a28
 v_accvgpr_read_b32 v45, a29
 v_accvgpr_read_b32 v46, a30
 v_accvgpr_read_b32 v47, a31
 v_lshlrev_b32 v64, 16, v212
 v_and_b32 v65, 0xffff0000, v212
 v_lshlrev_b32 v66, 16, v213
 v_and_b32 v67, 0xffff0000, v213
 v_lshlrev_b32 v68, 16, v214
 v_and_b32 v69, 0xffff0000, v214
 v_lshlrev_b32 v70, 16, v215
 v_and_b32 v71, 0xffff0000, v215
 v_pk_mul_f32 v[40:41], v[40:41], v[98:99] op_sel:[0,1] op_sel_hi:[1,1]
 v_pk_mul_f32 v[42:43], v[42:43], v[98:99] op_sel:[0,1] op_sel_hi:[1,1]
 v_pk_mul_f32 v[44:45], v[44:45], v[98:99] op_sel:[0,1] op_sel_hi:[1,1]
 v_pk_mul_f32 v[46:47], v[46:47], v[98:99] op_sel:[0,1] op_sel_hi:[1,1]
 v_pk_fma_f32 v[40:41], v[64:65], v[100:101], v[40:41] op_sel:[0,1,0] op_sel_hi:[1,1,1]
 v_pk_fma_f32 v[42:43], v[66:67], v[100:101], v[42:43] op_sel:[0,1,0] op_sel_hi:[1,1,1]
 v_pk_fma_f32 v[44:45], v[68:69], v[100:101], v[44:45] op_sel:[0,1,0] op_sel_hi:[1,1,1]
 v_pk_fma_f32 v[46:47], v[70:71], v[100:101], v[46:47] op_sel:[0,1,0] op_sel_hi:[1,1,1]
 v_cvt_pk_bf16_f32 v148, v40, v41
 v_cvt_pk_bf16_f32 v149, v42, v43
 v_cvt_pk_bf16_f32 v150, v44, v45
 v_cvt_pk_bf16_f32 v151, v46, v47
 buffer_load_dwordx4 v12, s[56:59], s91 offen offset:2048 lds
 v_accvgpr_read_b32 v48, a36
 v_accvgpr_read_b32 v49, a37
 v_accvgpr_read_b32 v50, a38
 v_accvgpr_read_b32 v51, a39
 v_accvgpr_read_b32 v52, a44
 v_accvgpr_read_b32 v53, a45
 v_accvgpr_read_b32 v54, a46
 v_accvgpr_read_b32 v55, a47
 v_lshlrev_b32 v72, 16, v216
 v_and_b32 v73, 0xffff0000, v216
 v_lshlrev_b32 v74, 16, v217
 v_and_b32 v75, 0xffff0000, v217
 v_lshlrev_b32 v76, 16, v218
 v_and_b32 v77, 0xffff0000, v218
 v_lshlrev_b32 v78, 16, v219
 v_and_b32 v79, 0xffff0000, v219
 v_pk_mul_f32 v[48:49], v[48:49], v[98:99] op_sel:[0,1] op_sel_hi:[1,1]
 v_pk_mul_f32 v[50:51], v[50:51], v[98:99] op_sel:[0,1] op_sel_hi:[1,1]
 v_pk_mul_f32 v[52:53], v[52:53], v[98:99] op_sel:[0,1] op_sel_hi:[1,1]
 v_pk_mul_f32 v[54:55], v[54:55], v[98:99] op_sel:[0,1] op_sel_hi:[1,1]
 v_pk_fma_f32 v[48:49], v[72:73], v[100:101], v[48:49] op_sel:[0,1,0] op_sel_hi:[1,1,1]
 v_pk_fma_f32 v[50:51], v[74:75], v[100:101], v[50:51] op_sel:[0,1,0] op_sel_hi:[1,1,1]
 v_pk_fma_f32 v[52:53], v[76:77], v[100:101], v[52:53] op_sel:[0,1,0] op_sel_hi:[1,1,1]
 v_pk_fma_f32 v[54:55], v[78:79], v[100:101], v[54:55] op_sel:[0,1,0] op_sel_hi:[1,1,1]
 v_cvt_pk_bf16_f32 v152, v48, v49
 v_cvt_pk_bf16_f32 v153, v50, v51
 v_cvt_pk_bf16_f32 v154, v52, v53
 v_cvt_pk_bf16_f32 v155, v54, v55
 buffer_load_dwordx4 v13, s[56:59], s91 offen offset:3072 lds
 v_accvgpr_read_b32 v56, a52
 v_accvgpr_read_b32 v57, a53
 v_accvgpr_read_b32 v58, a54
 v_accvgpr_read_b32 v59, a55
 v_accvgpr_read_b32 v60, a60
 v_accvgpr_read_b32 v61, a61
 v_accvgpr_read_b32 v62, a62
 v_accvgpr_read_b32 v63, a63
 v_lshlrev_b32 v80, 16, v220
 v_and_b32 v81, 0xffff0000, v220
 v_lshlrev_b32 v82, 16, v221
 v_and_b32 v83, 0xffff0000, v221
 v_lshlrev_b32 v84, 16, v222
 v_and_b32 v85, 0xffff0000, v222
 v_lshlrev_b32 v86, 16, v223
 v_and_b32 v87, 0xffff0000, v223
 v_pk_mul_f32 v[56:57], v[56:57], v[98:99] op_sel:[0,1] op_sel_hi:[1,1]
 v_pk_mul_f32 v[58:59], v[58:59], v[98:99] op_sel:[0,1] op_sel_hi:[1,1]
 v_pk_mul_f32 v[60:61], v[60:61], v[98:99] op_sel:[0,1] op_sel_hi:[1,1]
 v_pk_mul_f32 v[62:63], v[62:63], v[98:99] op_sel:[0,1] op_sel_hi:[1,1]
 v_pk_fma_f32 v[56:57], v[80:81], v[100:101], v[56:57] op_sel:[0,1,0] op_sel_hi:[1,1,1]
 v_pk_fma_f32 v[58:59], v[82:83], v[100:101], v[58:59] op_sel:[0,1,0] op_sel_hi:[1,1,1]
 v_pk_fma_f32 v[60:61], v[84:85], v[100:101], v[60:61] op_sel:[0,1,0] op_sel_hi:[1,1,1]
 v_pk_fma_f32 v[62:63], v[86:87], v[100:101], v[62:63] op_sel:[0,1,0] op_sel_hi:[1,1,1]
 v_cvt_pk_bf16_f32 v156, v56, v57
 v_cvt_pk_bf16_f32 v157, v58, v59
 v_cvt_pk_bf16_f32 v158, v60, v61
 v_cvt_pk_bf16_f32 v159, v62, v63
 s_add_u32 m0, s76, 49152
 s_add_u32 s91, s7, 128
 buffer_load_dwordx4 v10, s[60:63], s91 offen offset:0 lds
 v_accvgpr_read_b32 v32, a68
 v_accvgpr_read_b32 v33, a69
 v_accvgpr_read_b32 v34, a70
 v_accvgpr_read_b32 v35, a71
 v_accvgpr_read_b32 v36, a76
 v_accvgpr_read_b32 v37, a77
 v_accvgpr_read_b32 v38, a78
 v_accvgpr_read_b32 v39, a79
 v_lshlrev_b32 v64, 16, v224
 v_and_b32 v65, 0xffff0000, v224
 v_lshlrev_b32 v66, 16, v225
 v_and_b32 v67, 0xffff0000, v225
 v_lshlrev_b32 v68, 16, v226
 v_and_b32 v69, 0xffff0000, v226
 v_lshlrev_b32 v70, 16, v227
 v_and_b32 v71, 0xffff0000, v227
 v_pk_mul_f32 v[32:33], v[32:33], v[98:99] op_sel:[0,1] op_sel_hi:[1,1]
 v_pk_mul_f32 v[34:35], v[34:35], v[98:99] op_sel:[0,1] op_sel_hi:[1,1]
 v_pk_mul_f32 v[36:37], v[36:37], v[98:99] op_sel:[0,1] op_sel_hi:[1,1]
 v_pk_mul_f32 v[38:39], v[38:39], v[98:99] op_sel:[0,1] op_sel_hi:[1,1]
 v_pk_fma_f32 v[32:33], v[64:65], v[100:101], v[32:33] op_sel:[0,1,0] op_sel_hi:[1,1,1]
 v_pk_fma_f32 v[34:35], v[66:67], v[100:101], v[34:35] op_sel:[0,1,0] op_sel_hi:[1,1,1]
 v_pk_fma_f32 v[36:37], v[68:69], v[100:101], v[36:37] op_sel:[0,1,0] op_sel_hi:[1,1,1]
 v_pk_fma_f32 v[38:39], v[70:71], v[100:101], v[38:39] op_sel:[0,1,0] op_sel_hi:[1,1,1]
 v_cvt_pk_bf16_f32 v160, v32, v33
 v_cvt_pk_bf16_f32 v161, v34, v35
 v_cvt_pk_bf16_f32 v162, v36, v37
 v_cvt_pk_bf16_f32 v163, v38, v39
 buffer_load_dwordx4 v11, s[60:63], s91 offen offset:1024 lds
 v_accvgpr_read_b32 v40, a84
 v_accvgpr_read_b32 v41, a85
 v_accvgpr_read_b32 v42, a86
 v_accvgpr_read_b32 v43, a87
 v_accvgpr_read_b32 v44, a92
 v_accvgpr_read_b32 v45, a93
 v_accvgpr_read_b32 v46, a94
 v_accvgpr_read_b32 v47, a95
 v_lshlrev_b32 v72, 16, v228
 v_and_b32 v73, 0xffff0000, v228
 v_lshlrev_b32 v74, 16, v229
 v_and_b32 v75, 0xffff0000, v229
 v_lshlrev_b32 v76, 16, v230
 v_and_b32 v77, 0xffff0000, v230
 v_lshlrev_b32 v78, 16, v231
 v_and_b32 v79, 0xffff0000, v231
 v_pk_mul_f32 v[40:41], v[40:41], v[98:99] op_sel:[0,1] op_sel_hi:[1,1]
 v_pk_mul_f32 v[42:43], v[42:43], v[98:99] op_sel:[0,1] op_sel_hi:[1,1]
 v_pk_mul_f32 v[44:45], v[44:45], v[98:99] op_sel:[0,1] op_sel_hi:[1,1]
 v_pk_mul_f32 v[46:47], v[46:47], v[98:99] op_sel:[0,1] op_sel_hi:[1,1]
 v_pk_fma_f32 v[40:41], v[72:73], v[100:101], v[40:41] op_sel:[0,1,0] op_sel_hi:[1,1,1]
 v_pk_fma_f32 v[42:43], v[74:75], v[100:101], v[42:43] op_sel:[0,1,0] op_sel_hi:[1,1,1]
 v_pk_fma_f32 v[44:45], v[76:77], v[100:101], v[44:45] op_sel:[0,1,0] op_sel_hi:[1,1,1]
 v_pk_fma_f32 v[46:47], v[78:79], v[100:101], v[46:47] op_sel:[0,1,0] op_sel_hi:[1,1,1]
 v_cvt_pk_bf16_f32 v164, v40, v41
 v_cvt_pk_bf16_f32 v165, v42, v43
 v_cvt_pk_bf16_f32 v166, v44, v45
 v_cvt_pk_bf16_f32 v167, v46, v47
 buffer_load_dwordx4 v12, s[60:63], s91 offen offset:2048 lds
 v_accvgpr_read_b32 v48, a100
 v_accvgpr_read_b32 v49, a101
 v_accvgpr_read_b32 v50, a102
 v_accvgpr_read_b32 v51, a103
 v_accvgpr_read_b32 v52, a108
 v_accvgpr_read_b32 v53, a109
 v_accvgpr_read_b32 v54, a110
 v_accvgpr_read_b32 v55, a111
 v_lshlrev_b32 v80, 16, v232
 v_and_b32 v81, 0xffff0000, v232
 v_lshlrev_b32 v82, 16, v233
 v_and_b32 v83, 0xffff0000, v233
 v_lshlrev_b32 v84, 16, v234
 v_and_b32 v85, 0xffff0000, v234
 v_lshlrev_b32 v86, 16, v235
 v_and_b32 v87, 0xffff0000, v235
 v_pk_mul_f32 v[48:49], v[48:49], v[98:99] op_sel:[0,1] op_sel_hi:[1,1]
 v_pk_mul_f32 v[50:51], v[50:51], v[98:99] op_sel:[0,1] op_sel_hi:[1,1]
 v_pk_mul_f32 v[52:53], v[52:53], v[98:99] op_sel:[0,1] op_sel_hi:[1,1]
 v_pk_mul_f32 v[54:55], v[54:55], v[98:99] op_sel:[0,1] op_sel_hi:[1,1]
 v_pk_fma_f32 v[48:49], v[80:81], v[100:101], v[48:49] op_sel:[0,1,0] op_sel_hi:[1,1,1]
 v_pk_fma_f32 v[50:51], v[82:83], v[100:101], v[50:51] op_sel:[0,1,0] op_sel_hi:[1,1,1]
 v_pk_fma_f32 v[52:53], v[84:85], v[100:101], v[52:53] op_sel:[0,1,0] op_sel_hi:[1,1,1]
 v_pk_fma_f32 v[54:55], v[86:87], v[100:101], v[54:55] op_sel:[0,1,0] op_sel_hi:[1,1,1]
 v_cvt_pk_bf16_f32 v168, v48, v49
 v_cvt_pk_bf16_f32 v169, v50, v51
 v_cvt_pk_bf16_f32 v170, v52, v53
 v_cvt_pk_bf16_f32 v171, v54, v55
 buffer_load_dwordx4 v13, s[60:63], s91 offen offset:3072 lds
 v_accvgpr_read_b32 v56, a116
 v_accvgpr_read_b32 v57, a117
 v_accvgpr_read_b32 v58, a118
 v_accvgpr_read_b32 v59, a119
 v_accvgpr_read_b32 v60, a124
 v_accvgpr_read_b32 v61, a125
 v_accvgpr_read_b32 v62, a126
 v_accvgpr_read_b32 v63, a127
 v_lshlrev_b32 v64, 16, v236
 v_and_b32 v65, 0xffff0000, v236
 v_lshlrev_b32 v66, 16, v237
 v_and_b32 v67, 0xffff0000, v237
 v_lshlrev_b32 v68, 16, v238
 v_and_b32 v69, 0xffff0000, v238
 v_lshlrev_b32 v70, 16, v239
 v_and_b32 v71, 0xffff0000, v239
 v_pk_mul_f32 v[56:57], v[56:57], v[98:99] op_sel:[0,1] op_sel_hi:[1,1]
 v_pk_mul_f32 v[58:59], v[58:59], v[98:99] op_sel:[0,1] op_sel_hi:[1,1]
 v_pk_mul_f32 v[60:61], v[60:61], v[98:99] op_sel:[0,1] op_sel_hi:[1,1]
 v_pk_mul_f32 v[62:63], v[62:63], v[98:99] op_sel:[0,1] op_sel_hi:[1,1]
 v_pk_fma_f32 v[56:57], v[64:65], v[100:101], v[56:57] op_sel:[0,1,0] op_sel_hi:[1,1,1]
 v_pk_fma_f32 v[58:59], v[66:67], v[100:101], v[58:59] op_sel:[0,1,0] op_sel_hi:[1,1,1]
 v_pk_fma_f32 v[60:61], v[68:69], v[100:101], v[60:61] op_sel:[0,1,0] op_sel_hi:[1,1,1]
 v_pk_fma_f32 v[62:63], v[70:71], v[100:101], v[62:63] op_sel:[0,1,0] op_sel_hi:[1,1,1]
 v_cvt_pk_bf16_f32 v172, v56, v57
 v_cvt_pk_bf16_f32 v173, v58, v59
 v_cvt_pk_bf16_f32 v174, v60, v61
 v_cvt_pk_bf16_f32 v175, v62, v63
gated_mix__compressed_kv_cla__glu_gated_swiglu__prompt_kernel_p4:
 v_and_b32 v22, 63, v0
 v_lshrrev_b32 v23, 2, v22
 v_lshlrev_b32 v24, 7, v23
 v_bfe_u32 v23, v22, 3, 2
 v_lshl_add_u32 v24, v23, 5, v24
 v_and_b32 v23, 3, v22
 v_lshl_add_u32 v24, v23, 3, v24
 v_xor_b32 v176, 0, v24
 v_add_u32 v180, 65536, v176
 v_add_u32 v184, 131072, v176
 v_xor_b32 v177, 32, v24
 v_add_u32 v181, 65536, v177
 v_add_u32 v185, 131072, v177
 v_xor_b32 v178, 64, v24
 v_add_u32 v182, 65536, v178
 v_add_u32 v186, 131072, v178
 v_xor_b32 v179, 96, v24
 v_add_u32 v183, 65536, v179
 v_add_u32 v187, 131072, v179
 v_sub_f32 v192, 1.0, v252
 v_sub_f32 v193, 1.0, v253
 s_load_dwordx2 s[40:41], s[0:1], 88
 s_waitcnt lgkmcnt(0)
 s_cmp_eq_u32 s85, 3
 s_cbranch_scc1 gated_mix__compressed_kv_cla__glu_gated_swiglu__prompt_kernel_p4s
 s_waitcnt vmcnt(12)
 s_barrier
 ds_read_b64_tr_b16 a[192:193], v176 offset:0
 ds_read_b64_tr_b16 a[194:195], v176 offset:2048
 ds_read_b64_tr_b16 a[196:197], v176 offset:4096
 ds_read_b64_tr_b16 a[198:199], v176 offset:6144
 ds_read_b64_tr_b16 a[200:201], v176 offset:8192
 ds_read_b64_tr_b16 a[202:203], v176 offset:10240
 ds_read_b64_tr_b16 a[204:205], v176 offset:12288
 ds_read_b64_tr_b16 a[206:207], v176 offset:14336
 ds_read_b64_tr_b16 a[208:209], v177 offset:0
 ds_read_b64_tr_b16 a[210:211], v177 offset:2048
 ds_read_b64_tr_b16 a[212:213], v177 offset:4096
 ds_read_b64_tr_b16 a[214:215], v177 offset:6144
 ds_read_b64_tr_b16 a[216:217], v177 offset:8192
 ds_read_b64_tr_b16 a[218:219], v177 offset:10240
 s_waitcnt lgkmcnt(12)
 v_mfma_f32_16x16x32_bf16 v[32:35], a[192:195], a[128:131], 0
 s_add_u32 m0, s76, 65536
 s_add_u32 s91, s6, 128
 ds_read_b64_tr_b16 a[220:221], v177 offset:12288
 v_mfma_f32_16x16x32_bf16 v[36:39], a[192:195], a[144:147], 0
 s_waitcnt lgkmcnt(11)
 ds_read_b64_tr_b16 a[222:223], v177 offset:14336
 buffer_load_dwordx4 v10, s[56:59], s91 offen offset:0 lds
 v_mfma_f32_16x16x32_bf16 v[36:39], a[196:199], a[148:151], v[36:39]
 ds_read_b64_tr_b16 a[224:225], v178 offset:0
 v_mfma_f32_16x16x32_bf16 v[32:35], a[196:199], a[132:135], v[32:35]
 s_waitcnt lgkmcnt(11)
 ds_read_b64_tr_b16 a[226:227], v178 offset:2048
 v_mfma_f32_16x16x32_bf16 v[32:35], a[200:203], a[136:139], v[32:35]
 ds_read_b64_tr_b16 a[228:229], v178 offset:4096
 buffer_load_dwordx4 v11, s[56:59], s91 offen offset:1024 lds
 v_mfma_f32_16x16x32_bf16 v[36:39], a[200:203], a[152:155], v[36:39]
 s_waitcnt lgkmcnt(11)
 ds_read_b64_tr_b16 a[230:231], v178 offset:6144
 v_mfma_f32_16x16x32_bf16 v[36:39], a[204:207], a[156:159], v[36:39]
 ds_read_b64_tr_b16 a[232:233], v178 offset:8192
 v_mfma_f32_16x16x32_bf16 v[32:35], a[204:207], a[140:143], v[32:35]
 s_waitcnt lgkmcnt(11)
 ds_read_b64_tr_b16 a[234:235], v178 offset:10240
 v_mfma_f32_16x16x32_bf16 v[40:43], a[208:211], a[128:131], 0
 ds_read_b64_tr_b16 a[236:237], v178 offset:12288
 buffer_load_dwordx4 v12, s[56:59], s91 offen offset:2048 lds
 v_mfma_f32_16x16x32_bf16 v[44:47], a[208:211], a[144:147], 0
 s_waitcnt lgkmcnt(11)
 ds_read_b64_tr_b16 a[238:239], v178 offset:14336
 v_mfma_f32_16x16x32_bf16 v[44:47], a[212:215], a[148:151], v[44:47]
 ds_read_b64_tr_b16 a[240:241], v179 offset:0
 v_mfma_f32_16x16x32_bf16 v[40:43], a[212:215], a[132:135], v[40:43]
 s_waitcnt lgkmcnt(11)
 ds_read_b64_tr_b16 a[242:243], v179 offset:2048
 v_mfma_f32_16x16x32_bf16 v[40:43], a[216:219], a[136:139], v[40:43]
 ds_read_b64_tr_b16 a[244:245], v179 offset:4096
 buffer_load_dwordx4 v13, s[56:59], s91 offen offset:3072 lds
 v_mfma_f32_16x16x32_bf16 v[44:47], a[216:219], a[152:155], v[44:47]
 s_waitcnt lgkmcnt(11)
 ds_read_b64_tr_b16 a[246:247], v179 offset:6144
 v_mul_f32 v32, v32, v192
 v_mfma_f32_16x16x32_bf16 v[44:47], a[220:223], a[156:159], v[44:47]
 ds_read_b64_tr_b16 a[248:249], v179 offset:8192
 v_mul_f32 v33, v33, v192
 v_mfma_f32_16x16x32_bf16 v[40:43], a[220:223], a[140:143], v[40:43]
 s_waitcnt lgkmcnt(11)
 s_add_u32 m0, s76, 81920
 s_add_u32 s91, s6, 114816
 ds_read_b64_tr_b16 a[250:251], v179 offset:10240
 v_mul_f32 v34, v34, v192
 v_mfma_f32_16x16x32_bf16 v[48:51], a[224:227], a[128:131], 0
 ds_read_b64_tr_b16 a[252:253], v179 offset:12288
 buffer_load_dwordx4 v10, s[56:59], s91 offen offset:0 lds
 v_mfma_f32_16x16x32_bf16 v[52:55], a[224:227], a[144:147], 0
 s_waitcnt lgkmcnt(11)
 s_waitcnt vmcnt(5)
 s_barrier
 ds_read_b64_tr_b16 a[254:255], v179 offset:14336
 v_mfma_f32_16x16x32_bf16 v[52:55], a[228:231], a[148:151], v[52:55]
 ds_read_b64_tr_b16 a[192:193], v176 offset:16384
 v_mul_f32 v35, v35, v192
 v_mfma_f32_16x16x32_bf16 v[48:51], a[228:231], a[132:135], v[48:51]
 s_waitcnt lgkmcnt(11)
 ds_read_b64_tr_b16 a[194:195], v176 offset:18432
 v_mul_f32 v36, v36, v193
 v_mfma_f32_16x16x32_bf16 v[48:51], a[232:235], a[136:139], v[48:51]
 ds_read_b64_tr_b16 a[196:197], v176 offset:20480
 buffer_load_dwordx4 v11, s[56:59], s91 offen offset:1024 lds
 v_mfma_f32_16x16x32_bf16 v[52:55], a[232:235], a[152:155], v[52:55]
 s_waitcnt lgkmcnt(11)
 ds_read_b64_tr_b16 a[198:199], v176 offset:22528
 v_mul_f32 v37, v37, v193
 v_mfma_f32_16x16x32_bf16 v[52:55], a[236:239], a[156:159], v[52:55]
 ds_read_b64_tr_b16 a[200:201], v176 offset:24576
 v_mul_f32 v38, v38, v193
 v_mfma_f32_16x16x32_bf16 v[48:51], a[236:239], a[140:143], v[48:51]
 s_waitcnt lgkmcnt(11)
 ds_read_b64_tr_b16 a[202:203], v176 offset:26624
 v_mul_f32 v39, v39, v193
 v_mfma_f32_16x16x32_bf16 v[56:59], a[240:243], a[128:131], 0
 ds_read_b64_tr_b16 a[204:205], v176 offset:28672
 buffer_load_dwordx4 v12, s[56:59], s91 offen offset:2048 lds
 v_mfma_f32_16x16x32_bf16 v[60:63], a[240:243], a[144:147], 0
 s_waitcnt lgkmcnt(11)
 ds_read_b64_tr_b16 a[206:207], v176 offset:30720
 v_mul_f32 v40, v40, v192
 v_mfma_f32_16x16x32_bf16 v[60:63], a[244:247], a[148:151], v[60:63]
 ds_read_b64_tr_b16 a[208:209], v176 offset:32768
 v_mul_f32 v41, v41, v192
 v_mfma_f32_16x16x32_bf16 v[56:59], a[244:247], a[132:135], v[56:59]
 s_waitcnt lgkmcnt(11)
 ds_read_b64_tr_b16 a[210:211], v176 offset:34816
 buffer_load_dwordx4 v13, s[56:59], s91 offen offset:3072 lds
 v_mfma_f32_16x16x32_bf16 v[56:59], a[248:251], a[136:139], v[56:59]
 ds_read_b64_tr_b16 a[212:213], v176 offset:36864
 v_mul_f32 v42, v42, v192
 v_mfma_f32_16x16x32_bf16 v[60:63], a[248:251], a[152:155], v[60:63]
 s_waitcnt lgkmcnt(11)
 ds_read_b64_tr_b16 a[214:215], v176 offset:38912
 v_mul_f32 v43, v43, v192
 v_mfma_f32_16x16x32_bf16 v[60:63], a[252:255], a[156:159], v[60:63]
 s_add_u32 m0, s76, 98304
 s_add_u32 s91, s7, 256
 ds_read_b64_tr_b16 a[216:217], v176 offset:40960
 v_mul_f32 v44, v44, v193
 v_mfma_f32_16x16x32_bf16 v[56:59], a[252:255], a[140:143], v[56:59]
 s_waitcnt lgkmcnt(11)
 ds_read_b64_tr_b16 a[218:219], v176 offset:43008
 buffer_load_dwordx4 v10, s[60:63], s91 offen offset:0 lds
 v_mfma_f32_16x16x32_bf16 v[32:35], a[192:195], v[112:115], v[32:35]
 ds_read_b64_tr_b16 a[220:221], v176 offset:45056
 v_mul_f32 v45, v45, v193
 v_mfma_f32_16x16x32_bf16 v[36:39], a[192:195], v[144:147], v[36:39]
 s_waitcnt lgkmcnt(11)
 ds_read_b64_tr_b16 a[222:223], v176 offset:47104
 v_mul_f32 v46, v46, v193
 v_mfma_f32_16x16x32_bf16 v[36:39], a[196:199], v[148:151], v[36:39]
 ds_read_b64_tr_b16 a[224:225], v177 offset:16384
 v_mul_f32 v47, v47, v193
 v_mfma_f32_16x16x32_bf16 v[32:35], a[196:199], v[116:119], v[32:35]
 s_waitcnt lgkmcnt(11)
 ds_read_b64_tr_b16 a[226:227], v177 offset:18432
 buffer_load_dwordx4 v11, s[60:63], s91 offen offset:1024 lds
 v_mfma_f32_16x16x32_bf16 v[32:35], a[200:203], v[120:123], v[32:35]
 ds_read_b64_tr_b16 a[228:229], v177 offset:20480
 v_mul_f32 v48, v48, v192
 v_mfma_f32_16x16x32_bf16 v[36:39], a[200:203], v[152:155], v[36:39]
 s_waitcnt lgkmcnt(11)
 ds_read_b64_tr_b16 a[230:231], v177 offset:22528
 v_mul_f32 v49, v49, v192
 v_mfma_f32_16x16x32_bf16 v[36:39], a[204:207], v[156:159], v[36:39]
 ds_read_b64_tr_b16 a[232:233], v177 offset:24576
 v_mul_f32 v50, v50, v192
 v_mfma_f32_16x16x32_bf16 v[32:35], a[204:207], v[124:127], v[32:35]
 s_waitcnt lgkmcnt(11)
 ds_read_b64_tr_b16 a[234:235], v177 offset:26624
 buffer_load_dwordx4 v12, s[60:63], s91 offen offset:2048 lds
 v_mfma_f32_16x16x32_bf16 v[32:35], a[208:211], v[128:131], v[32:35]
 ds_read_b64_tr_b16 a[236:237], v177 offset:28672
 v_mul_f32 v51, v51, v192
 v_mfma_f32_16x16x32_bf16 v[36:39], a[208:211], v[160:163], v[36:39]
 s_waitcnt lgkmcnt(11)
 ds_read_b64_tr_b16 a[238:239], v177 offset:30720
 v_mul_f32 v52, v52, v193
 v_mfma_f32_16x16x32_bf16 v[36:39], a[212:215], v[164:167], v[36:39]
 ds_read_b64_tr_b16 a[240:241], v177 offset:32768
 v_mul_f32 v53, v53, v193
 v_mfma_f32_16x16x32_bf16 v[32:35], a[212:215], v[132:135], v[32:35]
 s_waitcnt lgkmcnt(11)
 ds_read_b64_tr_b16 a[242:243], v177 offset:34816
 buffer_load_dwordx4 v13, s[60:63], s91 offen offset:3072 lds
 v_mfma_f32_16x16x32_bf16 v[32:35], a[216:219], v[136:139], v[32:35]
 ds_read_b64_tr_b16 a[244:245], v177 offset:36864
 v_mul_f32 v54, v54, v193
 v_mfma_f32_16x16x32_bf16 v[36:39], a[216:219], v[168:171], v[36:39]
 s_waitcnt lgkmcnt(11)
 ds_read_b64_tr_b16 a[246:247], v177 offset:38912
 v_mul_f32 v55, v55, v193
 v_mfma_f32_16x16x32_bf16 v[36:39], a[220:223], v[172:175], v[36:39]
 s_add_u32 m0, s76, 114688
 s_add_u32 s91, s6, 256
 ds_read_b64_tr_b16 a[248:249], v177 offset:40960
 v_mul_f32 v56, v56, v192
 v_mfma_f32_16x16x32_bf16 v[32:35], a[220:223], v[140:143], v[32:35]
 s_waitcnt lgkmcnt(11)
 ds_read_b64_tr_b16 a[250:251], v177 offset:43008
 buffer_load_dwordx4 v10, s[56:59], s91 offen offset:0 lds
 v_mfma_f32_16x16x32_bf16 v[40:43], a[224:227], v[112:115], v[40:43]
 ds_read_b64_tr_b16 a[252:253], v177 offset:45056
 v_mul_f32 v57, v57, v192
 v_mfma_f32_16x16x32_bf16 v[44:47], a[224:227], v[144:147], v[44:47]
 s_waitcnt lgkmcnt(11)
 ds_read_b64_tr_b16 a[254:255], v177 offset:47104
 v_mul_f32 v58, v58, v192
 v_mfma_f32_16x16x32_bf16 v[44:47], a[228:231], v[148:151], v[44:47]
 ds_read_b64_tr_b16 a[192:193], v178 offset:16384
 buffer_load_dwordx4 v11, s[56:59], s91 offen offset:1024 lds
 v_mfma_f32_16x16x32_bf16 v[40:43], a[228:231], v[116:119], v[40:43]
 s_waitcnt lgkmcnt(11)
 ds_read_b64_tr_b16 a[194:195], v178 offset:18432
 v_mul_f32 v59, v59, v192
 v_mfma_f32_16x16x32_bf16 v[40:43], a[232:235], v[120:123], v[40:43]
 ds_read_b64_tr_b16 a[196:197], v178 offset:20480
 v_mul_f32 v60, v60, v193
 v_mfma_f32_16x16x32_bf16 v[44:47], a[232:235], v[152:155], v[44:47]
 s_waitcnt lgkmcnt(11)
 ds_read_b64_tr_b16 a[198:199], v178 offset:22528
 v_mul_f32 v61, v61, v193
 v_mfma_f32_16x16x32_bf16 v[44:47], a[236:239], v[156:159], v[44:47]
 ds_read_b64_tr_b16 a[200:201], v178 offset:24576
 buffer_load_dwordx4 v12, s[56:59], s91 offen offset:2048 lds
 v_mfma_f32_16x16x32_bf16 v[40:43], a[236:239], v[124:127], v[40:43]
 s_waitcnt lgkmcnt(11)
 ds_read_b64_tr_b16 a[202:203], v178 offset:26624
 v_mul_f32 v62, v62, v193
 v_mfma_f32_16x16x32_bf16 v[40:43], a[240:243], v[128:131], v[40:43]
 ds_read_b64_tr_b16 a[204:205], v178 offset:28672
 v_mul_f32 v63, v63, v193
 v_mfma_f32_16x16x32_bf16 v[44:47], a[240:243], v[160:163], v[44:47]
 s_waitcnt lgkmcnt(11)
 ds_read_b64_tr_b16 a[206:207], v178 offset:30720
 v_mfma_f32_16x16x32_bf16 v[44:47], a[244:247], v[164:167], v[44:47]
 ds_read_b64_tr_b16 a[208:209], v178 offset:32768
 buffer_load_dwordx4 v13, s[56:59], s91 offen offset:3072 lds
 v_mfma_f32_16x16x32_bf16 v[40:43], a[244:247], v[132:135], v[40:43]
 s_waitcnt lgkmcnt(11)
 ds_read_b64_tr_b16 a[210:211], v178 offset:34816
 v_mfma_f32_16x16x32_bf16 v[40:43], a[248:251], v[136:139], v[40:43]
 ds_read_b64_tr_b16 a[212:213], v178 offset:36864
 v_mfma_f32_16x16x32_bf16 v[44:47], a[248:251], v[168:171], v[44:47]
 s_waitcnt lgkmcnt(11)
 s_add_u32 m0, s76, 131072
 s_add_u32 s91, s6, 114944
 ds_read_b64_tr_b16 a[214:215], v178 offset:38912
 v_mfma_f32_16x16x32_bf16 v[44:47], a[252:255], v[172:175], v[44:47]
 ds_read_b64_tr_b16 a[216:217], v178 offset:40960
 buffer_load_dwordx4 v10, s[56:59], s91 offen offset:0 lds
 v_mfma_f32_16x16x32_bf16 v[40:43], a[252:255], v[140:143], v[40:43]
 s_waitcnt lgkmcnt(11)
 ds_read_b64_tr_b16 a[218:219], v178 offset:43008
 v_mfma_f32_16x16x32_bf16 v[48:51], a[192:195], v[112:115], v[48:51]
 ds_read_b64_tr_b16 a[220:221], v178 offset:45056
 v_mfma_f32_16x16x32_bf16 v[52:55], a[192:195], v[144:147], v[52:55]
 s_waitcnt lgkmcnt(11)
 ds_read_b64_tr_b16 a[222:223], v178 offset:47104
 v_mfma_f32_16x16x32_bf16 v[52:55], a[196:199], v[148:151], v[52:55]
 ds_read_b64_tr_b16 a[224:225], v179 offset:16384
 buffer_load_dwordx4 v11, s[56:59], s91 offen offset:1024 lds
 v_mfma_f32_16x16x32_bf16 v[48:51], a[196:199], v[116:119], v[48:51]
 s_waitcnt lgkmcnt(11)
 ds_read_b64_tr_b16 a[226:227], v179 offset:18432
 v_mfma_f32_16x16x32_bf16 v[48:51], a[200:203], v[120:123], v[48:51]
 ds_read_b64_tr_b16 a[228:229], v179 offset:20480
 v_cvt_pk_bf16_f32 v64, v32, v33
 v_mfma_f32_16x16x32_bf16 v[52:55], a[200:203], v[152:155], v[52:55]
 s_waitcnt lgkmcnt(11)
 ds_read_b64_tr_b16 a[230:231], v179 offset:22528
 v_cvt_pk_bf16_f32 v65, v34, v35
 v_mfma_f32_16x16x32_bf16 v[52:55], a[204:207], v[156:159], v[52:55]
 ds_read_b64_tr_b16 a[232:233], v179 offset:24576
 buffer_load_dwordx4 v12, s[56:59], s91 offen offset:2048 lds
 v_mfma_f32_16x16x32_bf16 v[48:51], a[204:207], v[124:127], v[48:51]
 s_waitcnt lgkmcnt(11)
 ds_read_b64_tr_b16 a[234:235], v179 offset:26624
 v_cvt_pk_bf16_f32 v66, v40, v41
 v_mfma_f32_16x16x32_bf16 v[48:51], a[208:211], v[128:131], v[48:51]
 ds_read_b64_tr_b16 a[236:237], v179 offset:28672
 v_cvt_pk_bf16_f32 v67, v42, v43
 v_mfma_f32_16x16x32_bf16 v[52:55], a[208:211], v[160:163], v[52:55]
 s_waitcnt lgkmcnt(11)
 ds_read_b64_tr_b16 a[238:239], v179 offset:30720
 buffer_load_dwordx4 v13, s[56:59], s91 offen offset:3072 lds
 v_mfma_f32_16x16x32_bf16 v[52:55], a[212:215], v[164:167], v[52:55]
 s_add_u32 s92, s8, 0
 ds_read_b64_tr_b16 a[240:241], v179 offset:32768
 buffer_store_dwordx4 v[64:67], v21, s[36:39], s92 offen sc1
 v_mfma_f32_16x16x32_bf16 v[48:51], a[212:215], v[132:135], v[48:51]
 s_waitcnt lgkmcnt(11)
 ds_read_b64_tr_b16 a[242:243], v179 offset:34816
 v_cvt_pk_bf16_f32 v68, v36, v37
 v_mfma_f32_16x16x32_bf16 v[48:51], a[216:219], v[136:139], v[48:51]
 s_add_u32 m0, s76, 147456
 s_add_u32 s91, s7, 384
 ds_read_b64_tr_b16 a[244:245], v179 offset:36864
 v_cvt_pk_bf16_f32 v69, v38, v39
 v_mfma_f32_16x16x32_bf16 v[52:55], a[216:219], v[168:171], v[52:55]
 s_waitcnt lgkmcnt(11)
 ds_read_b64_tr_b16 a[246:247], v179 offset:38912
 buffer_load_dwordx4 v10, s[60:63], s91 offen offset:0 lds
 v_mfma_f32_16x16x32_bf16 v[52:55], a[220:223], v[172:175], v[52:55]
 ds_read_b64_tr_b16 a[248:249], v179 offset:40960
 v_cvt_pk_bf16_f32 v70, v44, v45
 v_mfma_f32_16x16x32_bf16 v[48:51], a[220:223], v[140:143], v[48:51]
 s_waitcnt lgkmcnt(11)
 ds_read_b64_tr_b16 a[250:251], v179 offset:43008
 v_cvt_pk_bf16_f32 v71, v46, v47
 v_mfma_f32_16x16x32_bf16 v[56:59], a[224:227], v[112:115], v[56:59]
 s_add_u32 s92, s9, 0
 ds_read_b64_tr_b16 a[252:253], v179 offset:45056
 buffer_store_dwordx4 v[68:71], v21, s[36:39], s92 offen sc1
 v_mfma_f32_16x16x32_bf16 v[60:63], a[224:227], v[144:147], v[60:63]
 s_waitcnt lgkmcnt(11)
 ds_read_b64_tr_b16 a[254:255], v179 offset:47104
 buffer_load_dwordx4 v11, s[60:63], s91 offen offset:1024 lds
 v_mfma_f32_16x16x32_bf16 v[60:63], a[228:231], v[148:151], v[60:63]
 ds_read_b64_tr_b16 a[192:193], v176 offset:49152
 v_mfma_f32_16x16x32_bf16 v[56:59], a[228:231], v[116:119], v[56:59]
 s_waitcnt lgkmcnt(11)
 ds_read_b64_tr_b16 a[194:195], v176 offset:51200
 v_mfma_f32_16x16x32_bf16 v[56:59], a[232:235], v[120:123], v[56:59]
 ds_read_b64_tr_b16 a[196:197], v176 offset:53248
 v_mfma_f32_16x16x32_bf16 v[60:63], a[232:235], v[152:155], v[60:63]
 s_waitcnt lgkmcnt(11)
 ds_read_b64_tr_b16 a[198:199], v176 offset:55296
 buffer_load_dwordx4 v12, s[60:63], s91 offen offset:2048 lds
 v_mfma_f32_16x16x32_bf16 v[60:63], a[236:239], v[156:159], v[60:63]
 ds_read_b64_tr_b16 a[200:201], v176 offset:57344
 v_mfma_f32_16x16x32_bf16 v[56:59], a[236:239], v[124:127], v[56:59]
 s_waitcnt lgkmcnt(11)
 ds_read_b64_tr_b16 a[202:203], v176 offset:59392
 v_mfma_f32_16x16x32_bf16 v[56:59], a[240:243], v[128:131], v[56:59]
 ds_read_b64_tr_b16 a[204:205], v176 offset:61440
 v_mfma_f32_16x16x32_bf16 v[60:63], a[240:243], v[160:163], v[60:63]
 s_waitcnt lgkmcnt(11)
 ds_read_b64_tr_b16 a[206:207], v176 offset:63488
 buffer_load_dwordx4 v13, s[60:63], s91 offen offset:3072 lds
 v_mfma_f32_16x16x32_bf16 v[60:63], a[244:247], v[164:167], v[60:63]
 ds_read_b64_tr_b16 a[208:209], v177 offset:49152
 v_mfma_f32_16x16x32_bf16 v[56:59], a[244:247], v[132:135], v[56:59]
 s_waitcnt lgkmcnt(11)
 ds_read_b64_tr_b16 a[210:211], v177 offset:51200
 v_mfma_f32_16x16x32_bf16 v[56:59], a[248:251], v[136:139], v[56:59]
 ds_read_b64_tr_b16 a[212:213], v177 offset:53248
 v_mfma_f32_16x16x32_bf16 v[60:63], a[248:251], v[168:171], v[60:63]
 s_waitcnt lgkmcnt(11)
 ds_read_b64_tr_b16 a[214:215], v177 offset:55296
 v_mfma_f32_16x16x32_bf16 v[60:63], a[252:255], v[172:175], v[60:63]
 ds_read_b64_tr_b16 a[216:217], v177 offset:57344
 v_mfma_f32_16x16x32_bf16 v[56:59], a[252:255], v[140:143], v[56:59]
 ds_read_b64_tr_b16 a[218:219], v177 offset:59392
 s_waitcnt lgkmcnt(12)
 v_mfma_f32_16x16x32_bf16 v[32:35], a[192:195], a[128:131], 0
 ds_read_b64_tr_b16 a[220:221], v177 offset:61440
 v_mfma_f32_16x16x32_bf16 v[36:39], a[192:195], a[144:147], 0
 s_waitcnt lgkmcnt(11)
 ds_read_b64_tr_b16 a[222:223], v177 offset:63488
 v_mfma_f32_16x16x32_bf16 v[36:39], a[196:199], a[148:151], v[36:39]
 ds_read_b64_tr_b16 a[224:225], v178 offset:49152
 v_mfma_f32_16x16x32_bf16 v[32:35], a[196:199], a[132:135], v[32:35]
 s_waitcnt lgkmcnt(11)
 ds_read_b64_tr_b16 a[226:227], v178 offset:51200
 v_cvt_pk_bf16_f32 v72, v48, v49
 v_mfma_f32_16x16x32_bf16 v[32:35], a[200:203], a[136:139], v[32:35]
 ds_read_b64_tr_b16 a[228:229], v178 offset:53248
 v_cvt_pk_bf16_f32 v73, v50, v51
 v_mfma_f32_16x16x32_bf16 v[36:39], a[200:203], a[152:155], v[36:39]
 s_waitcnt lgkmcnt(11)
 ds_read_b64_tr_b16 a[230:231], v178 offset:55296
 v_cvt_pk_bf16_f32 v74, v56, v57
 v_mfma_f32_16x16x32_bf16 v[36:39], a[204:207], a[156:159], v[36:39]
 ds_read_b64_tr_b16 a[232:233], v178 offset:57344
 v_cvt_pk_bf16_f32 v75, v58, v59
 v_mfma_f32_16x16x32_bf16 v[32:35], a[204:207], a[140:143], v[32:35]
 s_waitcnt lgkmcnt(11)
 s_add_u32 s92, s8, 16384
 ds_read_b64_tr_b16 a[234:235], v178 offset:59392
 buffer_store_dwordx4 v[72:75], v21, s[36:39], s92 offen sc1
 v_mfma_f32_16x16x32_bf16 v[40:43], a[208:211], a[128:131], 0
 ds_read_b64_tr_b16 a[236:237], v178 offset:61440
 v_cvt_pk_bf16_f32 v76, v52, v53
 v_mfma_f32_16x16x32_bf16 v[44:47], a[208:211], a[144:147], 0
 s_waitcnt lgkmcnt(11)
 ds_read_b64_tr_b16 a[238:239], v178 offset:63488
 v_cvt_pk_bf16_f32 v77, v54, v55
 v_mfma_f32_16x16x32_bf16 v[44:47], a[212:215], a[148:151], v[44:47]
 ds_read_b64_tr_b16 a[240:241], v179 offset:49152
 v_cvt_pk_bf16_f32 v78, v60, v61
 v_mfma_f32_16x16x32_bf16 v[40:43], a[212:215], a[132:135], v[40:43]
 s_waitcnt lgkmcnt(11)
 ds_read_b64_tr_b16 a[242:243], v179 offset:51200
 v_cvt_pk_bf16_f32 v79, v62, v63
 v_mfma_f32_16x16x32_bf16 v[40:43], a[216:219], a[136:139], v[40:43]
 ds_read_b64_tr_b16 a[244:245], v179 offset:53248
 v_mfma_f32_16x16x32_bf16 v[44:47], a[216:219], a[152:155], v[44:47]
 s_waitcnt lgkmcnt(11)
 ds_read_b64_tr_b16 a[246:247], v179 offset:55296
 v_mul_f32 v32, v32, v192
 v_mfma_f32_16x16x32_bf16 v[44:47], a[220:223], a[156:159], v[44:47]
 s_add_u32 s92, s9, 16384
 ds_read_b64_tr_b16 a[248:249], v179 offset:57344
 buffer_store_dwordx4 v[76:79], v21, s[36:39], s92 offen sc1
 v_mfma_f32_16x16x32_bf16 v[40:43], a[220:223], a[140:143], v[40:43]
 s_waitcnt lgkmcnt(11)
 ds_read_b64_tr_b16 a[250:251], v179 offset:59392
 v_mul_f32 v33, v33, v192
 v_mfma_f32_16x16x32_bf16 v[48:51], a[224:227], a[128:131], 0
 ds_read_b64_tr_b16 a[252:253], v179 offset:61440
 v_mul_f32 v34, v34, v192
 v_mfma_f32_16x16x32_bf16 v[52:55], a[224:227], a[144:147], 0
 s_waitcnt lgkmcnt(11)
 s_waitcnt vmcnt(16)
 s_barrier
 ds_read_b64_tr_b16 a[254:255], v179 offset:63488
 v_mfma_f32_16x16x32_bf16 v[52:55], a[228:231], a[148:151], v[52:55]
 s_add_u32 m0, s76, 0
 s_add_u32 s91, s6, 384
 ds_read_b64_tr_b16 a[192:193], v180 offset:0
 v_mul_f32 v35, v35, v192
 v_mfma_f32_16x16x32_bf16 v[48:51], a[228:231], a[132:135], v[48:51]
 s_waitcnt lgkmcnt(11)
 ds_read_b64_tr_b16 a[194:195], v180 offset:2048
 buffer_load_dwordx4 v10, s[56:59], s91 offen offset:0 lds
 v_mfma_f32_16x16x32_bf16 v[48:51], a[232:235], a[136:139], v[48:51]
 s_lshl_b32 s94, s86, 2
 ds_read_b64_tr_b16 a[196:197], v180 offset:4096
 v_mul_f32 v36, v36, v193
 v_mfma_f32_16x16x32_bf16 v[52:55], a[232:235], a[152:155], v[52:55]
 s_waitcnt lgkmcnt(11)
 ds_read_b64_tr_b16 a[198:199], v180 offset:6144
 v_mul_f32 v37, v37, v193
 v_mfma_f32_16x16x32_bf16 v[52:55], a[236:239], a[156:159], v[52:55]
 s_add_u32 s95, s94, s68
 ds_read_b64_tr_b16 a[200:201], v180 offset:8192
 v_mul_f32 v38, v38, v193
 v_mfma_f32_16x16x32_bf16 v[48:51], a[236:239], a[140:143], v[48:51]
 s_waitcnt lgkmcnt(11)
 ds_read_b64_tr_b16 a[202:203], v180 offset:10240
 v_mul_f32 v39, v39, v193
 v_mfma_f32_16x16x32_bf16 v[56:59], a[240:243], a[128:131], 0
 s_mul_i32 s95, s95, 384
 ds_read_b64_tr_b16 a[204:205], v180 offset:12288
 v_mul_f32 v40, v40, v192
 v_mfma_f32_16x16x32_bf16 v[60:63], a[240:243], a[144:147], 0
 s_waitcnt lgkmcnt(11)
 ds_read_b64_tr_b16 a[206:207], v180 offset:14336
 buffer_load_dwordx4 v11, s[56:59], s91 offen offset:1024 lds
 v_mfma_f32_16x16x32_bf16 v[60:63], a[244:247], a[148:151], v[60:63]
 s_lshl_b32 s96, s82, 3
 ds_read_b64_tr_b16 a[208:209], v180 offset:16384
 v_mul_f32 v41, v41, v192
 v_mfma_f32_16x16x32_bf16 v[56:59], a[244:247], a[132:135], v[56:59]
 s_waitcnt lgkmcnt(11)
 ds_read_b64_tr_b16 a[210:211], v180 offset:18432
 v_mul_f32 v42, v42, v192
 v_mfma_f32_16x16x32_bf16 v[56:59], a[248:251], a[136:139], v[56:59]
 s_add_u32 s95, s95, s96
 ds_read_b64_tr_b16 a[212:213], v180 offset:20480
 v_mul_f32 v43, v43, v192
 v_mfma_f32_16x16x32_bf16 v[60:63], a[248:251], a[152:155], v[60:63]
 s_waitcnt lgkmcnt(11)
 ds_read_b64_tr_b16 a[214:215], v180 offset:22528
 v_mul_f32 v44, v44, v193
 v_mfma_f32_16x16x32_bf16 v[60:63], a[252:255], a[156:159], v[60:63]
 s_add_u32 s13, s95, 52822016
 ds_read_b64_tr_b16 a[216:217], v180 offset:24576
 v_mul_f32 v45, v45, v193
 v_mfma_f32_16x16x32_bf16 v[56:59], a[252:255], a[140:143], v[56:59]
 s_waitcnt lgkmcnt(11)
 ds_read_b64_tr_b16 a[218:219], v180 offset:26624
 buffer_load_dwordx4 v12, s[56:59], s91 offen offset:2048 lds
 v_mfma_f32_16x16x32_bf16 v[32:35], a[192:195], v[112:115], v[32:35]
 s_lshr_b32 s95, s82, 2
 ds_read_b64_tr_b16 a[220:221], v180 offset:28672
 v_mul_f32 v46, v46, v193
 v_mfma_f32_16x16x32_bf16 v[36:39], a[192:195], v[144:147], v[36:39]
 s_waitcnt lgkmcnt(11)
 ds_read_b64_tr_b16 a[222:223], v180 offset:30720
 v_mul_f32 v47, v47, v193
 v_mfma_f32_16x16x32_bf16 v[36:39], a[196:199], v[148:151], v[36:39]
 s_add_u32 s94, s94, s95
 ds_read_b64_tr_b16 a[224:225], v181 offset:0
 v_mul_f32 v48, v48, v192
 v_mfma_f32_16x16x32_bf16 v[32:35], a[196:199], v[116:119], v[32:35]
 s_waitcnt lgkmcnt(11)
 ds_read_b64_tr_b16 a[226:227], v181 offset:2048
 v_mul_f32 v49, v49, v192
 v_mfma_f32_16x16x32_bf16 v[32:35], a[200:203], v[120:123], v[32:35]
 s_mul_i32 s94, s94, 384
 ds_read_b64_tr_b16 a[228:229], v181 offset:4096
 v_mul_f32 v50, v50, v192
 v_mfma_f32_16x16x32_bf16 v[36:39], a[200:203], v[152:155], v[36:39]
 s_waitcnt lgkmcnt(11)
 ds_read_b64_tr_b16 a[230:231], v181 offset:6144
 buffer_load_dwordx4 v13, s[56:59], s91 offen offset:3072 lds
 v_mfma_f32_16x16x32_bf16 v[36:39], a[204:207], v[156:159], v[36:39]
 s_add_u32 s94, s94, 52822016
 ds_read_b64_tr_b16 a[232:233], v181 offset:8192
 v_mul_f32 v51, v51, v192
 v_mfma_f32_16x16x32_bf16 v[32:35], a[204:207], v[124:127], v[32:35]
 s_waitcnt lgkmcnt(11)
 ds_read_b64_tr_b16 a[234:235], v181 offset:10240
 v_mul_f32 v52, v52, v193
 v_mfma_f32_16x16x32_bf16 v[32:35], a[208:211], v[128:131], v[32:35]
 ds_read_b64_tr_b16 a[236:237], v181 offset:12288
 v_mul_f32 v53, v53, v193
 v_mfma_f32_16x16x32_bf16 v[36:39], a[208:211], v[160:163], v[36:39]
 s_waitcnt lgkmcnt(11)
 ds_read_b64_tr_b16 a[238:239], v181 offset:14336
 v_mul_f32 v54, v54, v193
 v_mfma_f32_16x16x32_bf16 v[36:39], a[212:215], v[164:167], v[36:39]
 s_add_u32 m0, s76, 16384
 s_add_u32 s91, s6, 115072
 ds_read_b64_tr_b16 a[240:241], v181 offset:16384
 v_mul_f32 v55, v55, v193
 v_mfma_f32_16x16x32_bf16 v[32:35], a[212:215], v[132:135], v[32:35]
 s_waitcnt lgkmcnt(11)
 ds_read_b64_tr_b16 a[242:243], v181 offset:18432
 buffer_load_dwordx4 v10, s[56:59], s91 offen offset:0 lds
 v_mfma_f32_16x16x32_bf16 v[32:35], a[216:219], v[136:139], v[32:35]
 ds_read_b64_tr_b16 a[244:245], v181 offset:20480
 v_mul_f32 v56, v56, v192
 v_mfma_f32_16x16x32_bf16 v[36:39], a[216:219], v[168:171], v[36:39]
 s_waitcnt lgkmcnt(11)
 ds_read_b64_tr_b16 a[246:247], v181 offset:22528
 v_mul_f32 v57, v57, v192
 v_mfma_f32_16x16x32_bf16 v[36:39], a[220:223], v[172:175], v[36:39]
 ds_read_b64_tr_b16 a[248:249], v181 offset:24576
 v_mul_f32 v58, v58, v192
 v_mfma_f32_16x16x32_bf16 v[32:35], a[220:223], v[140:143], v[32:35]
 s_waitcnt lgkmcnt(11)
 ds_read_b64_tr_b16 a[250:251], v181 offset:26624
 v_mul_f32 v59, v59, v192
 v_mfma_f32_16x16x32_bf16 v[40:43], a[224:227], v[112:115], v[40:43]
 ds_read_b64_tr_b16 a[252:253], v181 offset:28672
 v_mul_f32 v60, v60, v193
 v_mfma_f32_16x16x32_bf16 v[44:47], a[224:227], v[144:147], v[44:47]
 s_waitcnt lgkmcnt(11)
 ds_read_b64_tr_b16 a[254:255], v181 offset:30720
 buffer_load_dwordx4 v11, s[56:59], s91 offen offset:1024 lds
 v_mfma_f32_16x16x32_bf16 v[44:47], a[228:231], v[148:151], v[44:47]
 ds_read_b64_tr_b16 a[192:193], v182 offset:0
 v_mul_f32 v61, v61, v193
 v_mfma_f32_16x16x32_bf16 v[40:43], a[228:231], v[116:119], v[40:43]
 s_waitcnt lgkmcnt(11)
 ds_read_b64_tr_b16 a[194:195], v182 offset:2048
 v_mul_f32 v62, v62, v193
 v_mfma_f32_16x16x32_bf16 v[40:43], a[232:235], v[120:123], v[40:43]
 ds_read_b64_tr_b16 a[196:197], v182 offset:4096
 v_mul_f32 v63, v63, v193
 v_mfma_f32_16x16x32_bf16 v[44:47], a[232:235], v[152:155], v[44:47]
 s_waitcnt lgkmcnt(11)
 ds_read_b64_tr_b16 a[198:199], v182 offset:6144
 v_and_b32 v30, 15, v0
 v_mfma_f32_16x16x32_bf16 v[44:47], a[236:239], v[156:159], v[44:47]
 ds_read_b64_tr_b16 a[200:201], v182 offset:8192
 v_lshl_add_u32 v30, v30, 3, s94
 v_mfma_f32_16x16x32_bf16 v[40:43], a[236:239], v[124:127], v[40:43]
 s_waitcnt lgkmcnt(11)
 ds_read_b64_tr_b16 a[202:203], v182 offset:10240
 buffer_load_dwordx4 v12, s[56:59], s91 offen offset:2048 lds
 v_mfma_f32_16x16x32_bf16 v[40:43], a[240:243], v[128:131], v[40:43]
 ds_read_b64_tr_b16 a[204:205], v182 offset:12288
 v_and_b32 v90, 16, v0
 v_mfma_f32_16x16x32_bf16 v[44:47], a[240:243], v[160:163], v[44:47]
 s_waitcnt lgkmcnt(11)
 ds_read_b64_tr_b16 a[206:207], v182 offset:14336
 v_lshl_add_u32 v30, v90, 3, v30
 v_mfma_f32_16x16x32_bf16 v[44:47], a[244:247], v[164:167], v[44:47]
 s_lshl_b32 s96, s86, 3
 ds_read_b64_tr_b16 a[208:209], v182 offset:16384
 v_mfma_f32_16x16x32_bf16 v[40:43], a[244:247], v[132:135], v[40:43]
 s_waitcnt lgkmcnt(11)
 ds_read_b64_tr_b16 a[210:211], v182 offset:18432
 v_mfma_f32_16x16x32_bf16 v[40:43], a[248:251], v[136:139], v[40:43]
 s_lshr_b32 s97, s82, 1
 ds_read_b64_tr_b16 a[212:213], v182 offset:20480
 v_mfma_f32_16x16x32_bf16 v[44:47], a[248:251], v[168:171], v[44:47]
 s_waitcnt lgkmcnt(11)
 ds_read_b64_tr_b16 a[214:215], v182 offset:22528
 buffer_load_dwordx4 v13, s[56:59], s91 offen offset:3072 lds
 v_mfma_f32_16x16x32_bf16 v[44:47], a[252:255], v[172:175], v[44:47]
 s_add_u32 s96, s96, s97
 ds_read_b64_tr_b16 a[216:217], v182 offset:24576
 v_mfma_f32_16x16x32_bf16 v[40:43], a[252:255], v[140:143], v[40:43]
 s_waitcnt lgkmcnt(11)
 ds_read_b64_tr_b16 a[218:219], v182 offset:26624
 v_mfma_f32_16x16x32_bf16 v[48:51], a[192:195], v[112:115], v[48:51]
 s_and_b32 s97, s82, 1
 ds_read_b64_tr_b16 a[220:221], v182 offset:28672
 v_mfma_f32_16x16x32_bf16 v[52:55], a[192:195], v[144:147], v[52:55]
 s_waitcnt lgkmcnt(11)
 ds_read_b64_tr_b16 a[222:223], v182 offset:30720
 v_mfma_f32_16x16x32_bf16 v[52:55], a[196:199], v[148:151], v[52:55]
 s_add_u32 m0, s76, 32768
 s_add_u32 s91, s7, 512
 s_lshl_b32 s98, s68, 1
 ds_read_b64_tr_b16 a[224:225], v183 offset:0
 v_mfma_f32_16x16x32_bf16 v[48:51], a[196:199], v[116:119], v[48:51]
 s_waitcnt lgkmcnt(11)
 ds_read_b64_tr_b16 a[226:227], v183 offset:2048
 buffer_load_dwordx4 v10, s[60:63], s91 offen offset:0 lds
 v_mfma_f32_16x16x32_bf16 v[48:51], a[200:203], v[120:123], v[48:51]
 s_add_u32 s97, s97, s98
 ds_read_b64_tr_b16 a[228:229], v183 offset:4096
 v_cvt_pk_bf16_f32 v64, v32, v33
 v_mfma_f32_16x16x32_bf16 v[52:55], a[200:203], v[152:155], v[52:55]
 s_waitcnt lgkmcnt(11)
 ds_read_b64_tr_b16 a[230:231], v183 offset:6144
 v_cvt_pk_bf16_f32 v65, v34, v35
 v_mfma_f32_16x16x32_bf16 v[52:55], a[204:207], v[156:159], v[52:55]
 s_mul_i32 s98, s96, 14
 ds_read_b64_tr_b16 a[232:233], v183 offset:8192
 v_cvt_pk_bf16_f32 v66, v40, v41
 v_mfma_f32_16x16x32_bf16 v[48:51], a[204:207], v[124:127], v[48:51]
 s_waitcnt lgkmcnt(11)
 ds_read_b64_tr_b16 a[234:235], v183 offset:10240
 v_cvt_pk_bf16_f32 v67, v42, v43
 v_mfma_f32_16x16x32_bf16 v[48:51], a[208:211], v[128:131], v[48:51]
 s_add_u32 s92, s8, 32768
 s_add_u32 s98, s98, s97
 ds_read_b64_tr_b16 a[236:237], v183 offset:12288
 buffer_store_dwordx4 v[64:67], v21, s[36:39], s92 offen sc1
 v_mfma_f32_16x16x32_bf16 v[52:55], a[208:211], v[160:163], v[52:55]
 s_waitcnt lgkmcnt(11)
 ds_read_b64_tr_b16 a[238:239], v183 offset:14336
 buffer_load_dwordx4 v11, s[60:63], s91 offen offset:1024 lds
 v_mfma_f32_16x16x32_bf16 v[52:55], a[212:215], v[164:167], v[52:55]
 s_lshl_b32 s98, s98, 14
 ds_read_b64_tr_b16 a[240:241], v183 offset:16384
 v_cvt_pk_bf16_f32 v68, v36, v37
 v_mfma_f32_16x16x32_bf16 v[48:51], a[212:215], v[132:135], v[48:51]
 s_waitcnt lgkmcnt(11)
 ds_read_b64_tr_b16 a[242:243], v183 offset:18432
 v_cvt_pk_bf16_f32 v69, v38, v39
 v_mfma_f32_16x16x32_bf16 v[48:51], a[216:219], v[136:139], v[48:51]
 s_add_u32 s14, s98, 54525952
 ds_read_b64_tr_b16 a[244:245], v183 offset:20480
 v_cvt_pk_bf16_f32 v70, v44, v45
 v_mfma_f32_16x16x32_bf16 v[52:55], a[216:219], v[168:171], v[52:55]
 s_waitcnt lgkmcnt(11)
 ds_read_b64_tr_b16 a[246:247], v183 offset:22528
 v_cvt_pk_bf16_f32 v71, v46, v47
 v_mfma_f32_16x16x32_bf16 v[52:55], a[220:223], v[172:175], v[52:55]
 s_add_u32 s92, s9, 32768
 s_add_u32 s15, s14, 98304
 ds_read_b64_tr_b16 a[248:249], v183 offset:24576
 buffer_store_dwordx4 v[68:71], v21, s[36:39], s92 offen sc1
 v_mfma_f32_16x16x32_bf16 v[48:51], a[220:223], v[140:143], v[48:51]
 s_waitcnt lgkmcnt(11)
 ds_read_b64_tr_b16 a[250:251], v183 offset:26624
 buffer_load_dwordx4 v12, s[60:63], s91 offen offset:2048 lds
 v_mfma_f32_16x16x32_bf16 v[56:59], a[224:227], v[112:115], v[56:59]
 s_mul_i32 s12, s96, 14336
 ds_read_b64_tr_b16 a[252:253], v183 offset:28672
 v_mfma_f32_16x16x32_bf16 v[60:63], a[224:227], v[144:147], v[60:63]
 s_waitcnt lgkmcnt(11)
 ds_read_b64_tr_b16 a[254:255], v183 offset:30720
 v_mfma_f32_16x16x32_bf16 v[60:63], a[228:231], v[148:151], v[60:63]
 s_lshl_b32 s97, s97, 6
 ds_read_b64_tr_b16 a[192:193], v180 offset:32768
 v_mfma_f32_16x16x32_bf16 v[56:59], a[228:231], v[116:119], v[56:59]
 s_waitcnt lgkmcnt(11)
 ds_read_b64_tr_b16 a[194:195], v180 offset:34816
 v_mfma_f32_16x16x32_bf16 v[56:59], a[232:235], v[120:123], v[56:59]
 s_add_u32 s12, s12, s97
 ds_read_b64_tr_b16 a[196:197], v180 offset:36864
 v_mfma_f32_16x16x32_bf16 v[60:63], a[232:235], v[152:155], v[60:63]
 s_waitcnt lgkmcnt(11)
 ds_read_b64_tr_b16 a[198:199], v180 offset:38912
 buffer_load_dwordx4 v13, s[60:63], s91 offen offset:3072 lds
 v_mfma_f32_16x16x32_bf16 v[60:63], a[236:239], v[156:159], v[60:63]
 ds_read_b64_tr_b16 a[200:201], v180 offset:40960
 s_cmp_lt_u32 s68, 3
 s_cselect_b32 s66, s38, 0
 s_cselect_b32 s16, 1835008, 0
 s_mov_b32 s10, 0xffff0000
 s_cselect_b32 s10, -1, s10
 v_mfma_f32_16x16x32_bf16 v[56:59], a[236:239], v[124:127], v[56:59]
 s_waitcnt lgkmcnt(11)
 ds_read_b64_tr_b16 a[202:203], v180 offset:43008
 v_mfma_f32_16x16x32_bf16 v[56:59], a[240:243], v[128:131], v[56:59]
 s_mov_b32 s48, s36
 ds_read_b64_tr_b16 a[204:205], v180 offset:45056
 v_mfma_f32_16x16x32_bf16 v[60:63], a[240:243], v[160:163], v[60:63]
 s_waitcnt lgkmcnt(11)
 ds_read_b64_tr_b16 a[206:207], v180 offset:47104
 v_mfma_f32_16x16x32_bf16 v[60:63], a[244:247], v[164:167], v[60:63]
 s_mov_b32 s49, s37
 ds_read_b64_tr_b16 a[208:209], v181 offset:32768
 v_mfma_f32_16x16x32_bf16 v[56:59], a[244:247], v[132:135], v[56:59]
 s_waitcnt lgkmcnt(11)
 ds_read_b64_tr_b16 a[210:211], v181 offset:34816
 v_and_b32 v94, 15, v0
 v_mfma_f32_16x16x32_bf16 v[56:59], a[248:251], v[136:139], v[56:59]
 ds_read_b64_tr_b16 a[212:213], v181 offset:36864
 v_bfe_u32 v95, v0, 4, 2
 v_mfma_f32_16x16x32_bf16 v[60:63], a[248:251], v[168:171], v[60:63]
 s_waitcnt lgkmcnt(11)
 ds_read_b64_tr_b16 a[214:215], v181 offset:38912
 v_mul_u32_u24 v90, 896, v94
 v_mfma_f32_16x16x32_bf16 v[60:63], a[252:255], v[172:175], v[60:63]
 ds_read_b64_tr_b16 a[216:217], v181 offset:40960
 v_lshl_add_u32 v90, v95, 4, v90
 v_mfma_f32_16x16x32_bf16 v[56:59], a[252:255], v[140:143], v[56:59]
 ds_read_b64_tr_b16 a[218:219], v181 offset:43008
 s_waitcnt lgkmcnt(12)
 v_mfma_f32_16x16x32_bf16 v[32:35], a[192:195], a[128:131], 0
 ds_read_b64_tr_b16 a[220:221], v181 offset:45056
 v_mfma_f32_16x16x32_bf16 v[36:39], a[192:195], a[144:147], 0
 s_waitcnt lgkmcnt(11)
 ds_read_b64_tr_b16 a[222:223], v181 offset:47104
 v_mfma_f32_16x16x32_bf16 v[36:39], a[196:199], a[148:151], v[36:39]
 ds_read_b64_tr_b16 a[224:225], v182 offset:32768
 v_mfma_f32_16x16x32_bf16 v[32:35], a[196:199], a[132:135], v[32:35]
 s_waitcnt lgkmcnt(11)
 ds_read_b64_tr_b16 a[226:227], v182 offset:34816
 v_cvt_pk_bf16_f32 v72, v48, v49
 v_mfma_f32_16x16x32_bf16 v[32:35], a[200:203], a[136:139], v[32:35]
 ds_read_b64_tr_b16 a[228:229], v182 offset:36864
 v_cvt_pk_bf16_f32 v73, v50, v51
 v_mfma_f32_16x16x32_bf16 v[36:39], a[200:203], a[152:155], v[36:39]
 s_waitcnt lgkmcnt(11)
 ds_read_b64_tr_b16 a[230:231], v182 offset:38912
 v_cvt_pk_bf16_f32 v74, v56, v57
 v_mfma_f32_16x16x32_bf16 v[36:39], a[204:207], a[156:159], v[36:39]
 ds_read_b64_tr_b16 a[232:233], v182 offset:40960
 v_cvt_pk_bf16_f32 v75, v58, v59
 v_mfma_f32_16x16x32_bf16 v[32:35], a[204:207], a[140:143], v[32:35]
 s_waitcnt lgkmcnt(11)
 s_add_u32 s92, s8, 49152
 ds_read_b64_tr_b16 a[234:235], v182 offset:43008
 buffer_store_dwordx4 v[72:75], v21, s[36:39], s92 offen sc1
 v_mfma_f32_16x16x32_bf16 v[40:43], a[208:211], a[128:131], 0
 ds_read_b64_tr_b16 a[236:237], v182 offset:45056
 v_cvt_pk_bf16_f32 v76, v52, v53
 v_mfma_f32_16x16x32_bf16 v[44:47], a[208:211], a[144:147], 0
 s_waitcnt lgkmcnt(11)
 ds_read_b64_tr_b16 a[238:239], v182 offset:47104
 v_cvt_pk_bf16_f32 v77, v54, v55
 v_mfma_f32_16x16x32_bf16 v[44:47], a[212:215], a[148:151], v[44:47]
 ds_read_b64_tr_b16 a[240:241], v183 offset:32768
 v_cvt_pk_bf16_f32 v78, v60, v61
 v_mfma_f32_16x16x32_bf16 v[40:43], a[212:215], a[132:135], v[40:43]
 s_waitcnt lgkmcnt(11)
 ds_read_b64_tr_b16 a[242:243], v183 offset:34816
 v_cvt_pk_bf16_f32 v79, v62, v63
 v_mfma_f32_16x16x32_bf16 v[40:43], a[216:219], a[136:139], v[40:43]
 ds_read_b64_tr_b16 a[244:245], v183 offset:36864
 v_mfma_f32_16x16x32_bf16 v[44:47], a[216:219], a[152:155], v[44:47]
 s_waitcnt lgkmcnt(11)
 ds_read_b64_tr_b16 a[246:247], v183 offset:38912
 v_mul_f32 v32, v32, v192
 v_mfma_f32_16x16x32_bf16 v[44:47], a[220:223], a[156:159], v[44:47]
 s_add_u32 s92, s9, 49152
 ds_read_b64_tr_b16 a[248:249], v183 offset:40960
 buffer_store_dwordx4 v[76:79], v21, s[36:39], s92 offen sc1
 v_mfma_f32_16x16x32_bf16 v[40:43], a[220:223], a[140:143], v[40:43]
 s_waitcnt lgkmcnt(11)
 ds_read_b64_tr_b16 a[250:251], v183 offset:43008
 v_mul_f32 v33, v33, v192
 v_mfma_f32_16x16x32_bf16 v[48:51], a[224:227], a[128:131], 0
 ds_read_b64_tr_b16 a[252:253], v183 offset:45056
 v_mul_f32 v34, v34, v192
 v_mfma_f32_16x16x32_bf16 v[52:55], a[224:227], a[144:147], 0
 s_waitcnt lgkmcnt(11)
 s_waitcnt vmcnt(18)
 s_barrier
 ds_read_b64_tr_b16 a[254:255], v183 offset:47104
 v_mfma_f32_16x16x32_bf16 v[52:55], a[228:231], a[148:151], v[52:55]
 s_add_u32 m0, s76, 49152
 s_add_u32 s91, s6, 512
 ds_read_b64_tr_b16 a[192:193], v180 offset:49152
 v_mul_f32 v35, v35, v192
 v_mfma_f32_16x16x32_bf16 v[48:51], a[228:231], a[132:135], v[48:51]
 s_waitcnt lgkmcnt(11)
 ds_read_b64_tr_b16 a[194:195], v180 offset:51200
 buffer_load_dwordx4 v10, s[56:59], s91 offen offset:0 lds
 v_mfma_f32_16x16x32_bf16 v[48:51], a[232:235], a[136:139], v[48:51]
 ds_read_b64_tr_b16 a[196:197], v180 offset:53248
 v_mul_f32 v36, v36, v193
 v_mfma_f32_16x16x32_bf16 v[52:55], a[232:235], a[152:155], v[52:55]
 s_waitcnt lgkmcnt(11)
 ds_read_b64_tr_b16 a[198:199], v180 offset:55296
 v_mul_f32 v37, v37, v193
 v_mfma_f32_16x16x32_bf16 v[52:55], a[236:239], a[156:159], v[52:55]
 ds_read_b64_tr_b16 a[200:201], v180 offset:57344
 v_mul_f32 v38, v38, v193
 v_mfma_f32_16x16x32_bf16 v[48:51], a[236:239], a[140:143], v[48:51]
 s_waitcnt lgkmcnt(11)
 ds_read_b64_tr_b16 a[202:203], v180 offset:59392
 v_mul_f32 v39, v39, v193
 v_mfma_f32_16x16x32_bf16 v[56:59], a[240:243], a[128:131], 0
 ds_read_b64_tr_b16 a[204:205], v180 offset:61440
 v_mul_f32 v40, v40, v192
 v_mfma_f32_16x16x32_bf16 v[60:63], a[240:243], a[144:147], 0
 s_waitcnt lgkmcnt(11)
 ds_read_b64_tr_b16 a[206:207], v180 offset:63488
 buffer_load_dwordx4 v11, s[56:59], s91 offen offset:1024 lds
 v_mfma_f32_16x16x32_bf16 v[60:63], a[244:247], a[148:151], v[60:63]
 ds_read_b64_tr_b16 a[208:209], v184 offset:0
 v_mul_f32 v41, v41, v192
 v_mfma_f32_16x16x32_bf16 v[56:59], a[244:247], a[132:135], v[56:59]
 s_waitcnt lgkmcnt(11)
 ds_read_b64_tr_b16 a[210:211], v184 offset:2048
 v_mul_f32 v42, v42, v192
 v_mfma_f32_16x16x32_bf16 v[56:59], a[248:251], a[136:139], v[56:59]
 ds_read_b64_tr_b16 a[212:213], v184 offset:4096
 v_mul_f32 v43, v43, v192
 v_mfma_f32_16x16x32_bf16 v[60:63], a[248:251], a[152:155], v[60:63]
 s_waitcnt lgkmcnt(11)
 ds_read_b64_tr_b16 a[214:215], v184 offset:6144
 v_mul_f32 v44, v44, v193
 v_mfma_f32_16x16x32_bf16 v[60:63], a[252:255], a[156:159], v[60:63]
 ds_read_b64_tr_b16 a[216:217], v184 offset:8192
 v_mul_f32 v45, v45, v193
 v_mfma_f32_16x16x32_bf16 v[56:59], a[252:255], a[140:143], v[56:59]
 s_waitcnt lgkmcnt(11)
 ds_read_b64_tr_b16 a[218:219], v184 offset:10240
 buffer_load_dwordx4 v12, s[56:59], s91 offen offset:2048 lds
 v_mfma_f32_16x16x32_bf16 v[32:35], a[192:195], v[112:115], v[32:35]
 ds_read_b64_tr_b16 a[220:221], v184 offset:12288
 v_mul_f32 v46, v46, v193
 v_mfma_f32_16x16x32_bf16 v[36:39], a[192:195], v[144:147], v[36:39]
 s_waitcnt lgkmcnt(11)
 ds_read_b64_tr_b16 a[222:223], v184 offset:14336
 v_mul_f32 v47, v47, v193
 v_mfma_f32_16x16x32_bf16 v[36:39], a[196:199], v[148:151], v[36:39]
 ds_read_b64_tr_b16 a[224:225], v181 offset:49152
 v_mul_f32 v48, v48, v192
 v_mfma_f32_16x16x32_bf16 v[32:35], a[196:199], v[116:119], v[32:35]
 s_waitcnt lgkmcnt(11)
 ds_read_b64_tr_b16 a[226:227], v181 offset:51200
 v_mul_f32 v49, v49, v192
 v_mfma_f32_16x16x32_bf16 v[32:35], a[200:203], v[120:123], v[32:35]
 ds_read_b64_tr_b16 a[228:229], v181 offset:53248
 v_mul_f32 v50, v50, v192
 v_mfma_f32_16x16x32_bf16 v[36:39], a[200:203], v[152:155], v[36:39]
 s_waitcnt lgkmcnt(11)
 ds_read_b64_tr_b16 a[230:231], v181 offset:55296
 buffer_load_dwordx4 v13, s[56:59], s91 offen offset:3072 lds
 v_mfma_f32_16x16x32_bf16 v[36:39], a[204:207], v[156:159], v[36:39]
 ds_read_b64_tr_b16 a[232:233], v181 offset:57344
 v_mul_f32 v51, v51, v192
 v_mfma_f32_16x16x32_bf16 v[32:35], a[204:207], v[124:127], v[32:35]
 s_waitcnt lgkmcnt(11)
 ds_read_b64_tr_b16 a[234:235], v181 offset:59392
 v_mul_f32 v52, v52, v193
 v_mfma_f32_16x16x32_bf16 v[32:35], a[208:211], v[128:131], v[32:35]
 ds_read_b64_tr_b16 a[236:237], v181 offset:61440
 v_mul_f32 v53, v53, v193
 v_mfma_f32_16x16x32_bf16 v[36:39], a[208:211], v[160:163], v[36:39]
 s_waitcnt lgkmcnt(11)
 ds_read_b64_tr_b16 a[238:239], v181 offset:63488
 v_mul_f32 v54, v54, v193
 v_mfma_f32_16x16x32_bf16 v[36:39], a[212:215], v[164:167], v[36:39]
 s_add_u32 m0, s76, 65536
 s_add_u32 s91, s6, 115200
 ds_read_b64_tr_b16 a[240:241], v185 offset:0
 v_mul_f32 v55, v55, v193
 v_mfma_f32_16x16x32_bf16 v[32:35], a[212:215], v[132:135], v[32:35]
 s_waitcnt lgkmcnt(11)
 ds_read_b64_tr_b16 a[242:243], v185 offset:2048
 buffer_load_dwordx4 v10, s[56:59], s91 offen offset:0 lds
 v_mfma_f32_16x16x32_bf16 v[32:35], a[216:219], v[136:139], v[32:35]
 ds_read_b64_tr_b16 a[244:245], v185 offset:4096
 v_mul_f32 v56, v56, v192
 v_mfma_f32_16x16x32_bf16 v[36:39], a[216:219], v[168:171], v[36:39]
 s_waitcnt lgkmcnt(11)
 ds_read_b64_tr_b16 a[246:247], v185 offset:6144
 v_mul_f32 v57, v57, v192
 v_mfma_f32_16x16x32_bf16 v[36:39], a[220:223], v[172:175], v[36:39]
 ds_read_b64_tr_b16 a[248:249], v185 offset:8192
 v_mul_f32 v58, v58, v192
 v_mfma_f32_16x16x32_bf16 v[32:35], a[220:223], v[140:143], v[32:35]
 s_waitcnt lgkmcnt(11)
 ds_read_b64_tr_b16 a[250:251], v185 offset:10240
 v_mul_f32 v59, v59, v192
 v_mfma_f32_16x16x32_bf16 v[40:43], a[224:227], v[112:115], v[40:43]
 ds_read_b64_tr_b16 a[252:253], v185 offset:12288
 v_mul_f32 v60, v60, v193
 v_mfma_f32_16x16x32_bf16 v[44:47], a[224:227], v[144:147], v[44:47]
 s_waitcnt lgkmcnt(11)
 ds_read_b64_tr_b16 a[254:255], v185 offset:14336
 buffer_load_dwordx4 v11, s[56:59], s91 offen offset:1024 lds
 v_mfma_f32_16x16x32_bf16 v[44:47], a[228:231], v[148:151], v[44:47]
 ds_read_b64_tr_b16 a[192:193], v182 offset:49152
 v_mul_f32 v61, v61, v193
 v_mfma_f32_16x16x32_bf16 v[40:43], a[228:231], v[116:119], v[40:43]
 s_waitcnt lgkmcnt(11)
 ds_read_b64_tr_b16 a[194:195], v182 offset:51200
 v_mul_f32 v62, v62, v193
 v_mfma_f32_16x16x32_bf16 v[40:43], a[232:235], v[120:123], v[40:43]
 ds_read_b64_tr_b16 a[196:197], v182 offset:53248
 v_mul_f32 v63, v63, v193
 v_mfma_f32_16x16x32_bf16 v[44:47], a[232:235], v[152:155], v[44:47]
 s_waitcnt lgkmcnt(11)
 ds_read_b64_tr_b16 a[198:199], v182 offset:55296
 v_lshrrev_b32 v96, 2, v94
 v_mfma_f32_16x16x32_bf16 v[44:47], a[236:239], v[156:159], v[44:47]
 ds_read_b64_tr_b16 a[200:201], v182 offset:57344
 v_and_b32 v97, 3, v94
 v_mfma_f32_16x16x32_bf16 v[40:43], a[236:239], v[124:127], v[40:43]
 s_waitcnt lgkmcnt(11)
 ds_read_b64_tr_b16 a[202:203], v182 offset:59392
 buffer_load_dwordx4 v12, s[56:59], s91 offen offset:2048 lds
 v_mfma_f32_16x16x32_bf16 v[40:43], a[240:243], v[128:131], v[40:43]
 ds_read_b64_tr_b16 a[204:205], v182 offset:61440
 v_and_b32 v98, 1, v94
 v_mfma_f32_16x16x32_bf16 v[44:47], a[240:243], v[160:163], v[44:47]
 s_waitcnt lgkmcnt(11)
 ds_read_b64_tr_b16 a[206:207], v182 offset:63488
 v_lshlrev_b32 v98, 4, v98
 v_mfma_f32_16x16x32_bf16 v[44:47], a[244:247], v[164:167], v[44:47]
 ds_read_b64_tr_b16 a[208:209], v186 offset:0
 v_mov_b32 v99, 0x3f80
 v_mfma_f32_16x16x32_bf16 v[40:43], a[244:247], v[132:135], v[40:43]
 s_waitcnt lgkmcnt(11)
 ds_read_b64_tr_b16 a[210:211], v186 offset:2048
 v_lshlrev_b32 v98, v98, v99
 v_mfma_f32_16x16x32_bf16 v[40:43], a[248:251], v[136:139], v[40:43]
 ds_read_b64_tr_b16 a[212:213], v186 offset:4096
 v_lshrrev_b32 v99, 1, v96
 v_mfma_f32_16x16x32_bf16 v[44:47], a[248:251], v[168:171], v[44:47]
 s_waitcnt lgkmcnt(11)
 ds_read_b64_tr_b16 a[214:215], v186 offset:6144
 buffer_load_dwordx4 v13, s[56:59], s91 offen offset:3072 lds
 v_mfma_f32_16x16x32_bf16 v[44:47], a[252:255], v[172:175], v[44:47]
 ds_read_b64_tr_b16 a[216:217], v186 offset:8192
 v_lshrrev_b32 v97, 1, v97
 v_mfma_f32_16x16x32_bf16 v[40:43], a[252:255], v[140:143], v[40:43]
 s_waitcnt lgkmcnt(11)
 ds_read_b64_tr_b16 a[218:219], v186 offset:10240
 v_lshl_add_u32 v97, v99, 1, v97
 v_mfma_f32_16x16x32_bf16 v[48:51], a[192:195], v[112:115], v[48:51]
 ds_read_b64_tr_b16 a[220:221], v186 offset:12288
 v_and_b32 v96, 1, v96
 v_mfma_f32_16x16x32_bf16 v[52:55], a[192:195], v[144:147], v[52:55]
 s_waitcnt lgkmcnt(11)
 ds_read_b64_tr_b16 a[222:223], v186 offset:14336
 v_lshlrev_b32 v96, 1, v96
 v_mfma_f32_16x16x32_bf16 v[52:55], a[196:199], v[148:151], v[52:55]
 s_add_u32 m0, s76, 81920
 s_add_u32 s91, s7, 640
 ds_read_b64_tr_b16 a[224:225], v183 offset:49152
 v_add_u32 v99, 0, v96
 v_mfma_f32_16x16x32_bf16 v[48:51], a[196:199], v[116:119], v[48:51]
 s_waitcnt lgkmcnt(11)
 ds_read_b64_tr_b16 a[226:227], v183 offset:51200
 buffer_load_dwordx4 v10, s[60:63], s91 offen offset:0 lds
 v_mfma_f32_16x16x32_bf16 v[48:51], a[200:203], v[120:123], v[48:51]
 ds_read_b64_tr_b16 a[228:229], v183 offset:53248
 v_cvt_pk_bf16_f32 v64, v32, v33
 v_mfma_f32_16x16x32_bf16 v[52:55], a[200:203], v[152:155], v[52:55]
 s_waitcnt lgkmcnt(11)
 ds_read_b64_tr_b16 a[230:231], v183 offset:55296
 v_cvt_pk_bf16_f32 v65, v34, v35
 v_mfma_f32_16x16x32_bf16 v[52:55], a[204:207], v[156:159], v[52:55]
 ds_read_b64_tr_b16 a[232:233], v183 offset:57344
 v_cvt_pk_bf16_f32 v66, v40, v41
 v_mfma_f32_16x16x32_bf16 v[48:51], a[204:207], v[124:127], v[48:51]
 s_waitcnt lgkmcnt(11)
 ds_read_b64_tr_b16 a[234:235], v183 offset:59392
 v_cvt_pk_bf16_f32 v67, v42, v43
 v_mfma_f32_16x16x32_bf16 v[48:51], a[208:211], v[128:131], v[48:51]
 s_add_u32 s92, s8, 65536
 ds_read_b64_tr_b16 a[236:237], v183 offset:61440
 buffer_store_dwordx4 v[64:67], v21, s[36:39], s92 offen sc1
 v_mfma_f32_16x16x32_bf16 v[52:55], a[208:211], v[160:163], v[52:55]
 s_waitcnt lgkmcnt(11)
 ds_read_b64_tr_b16 a[238:239], v183 offset:63488
 buffer_load_dwordx4 v11, s[60:63], s91 offen offset:1024 lds
 v_mfma_f32_16x16x32_bf16 v[52:55], a[212:215], v[164:167], v[52:55]
 ds_read_b64_tr_b16 a[240:241], v187 offset:0
 v_cvt_pk_bf16_f32 v68, v36, v37
 v_mfma_f32_16x16x32_bf16 v[48:51], a[212:215], v[132:135], v[48:51]
 s_waitcnt lgkmcnt(11)
 ds_read_b64_tr_b16 a[242:243], v187 offset:2048
 v_cvt_pk_bf16_f32 v69, v38, v39
 v_mfma_f32_16x16x32_bf16 v[48:51], a[216:219], v[136:139], v[48:51]
 ds_read_b64_tr_b16 a[244:245], v187 offset:4096
 v_cvt_pk_bf16_f32 v70, v44, v45
 v_mfma_f32_16x16x32_bf16 v[52:55], a[216:219], v[168:171], v[52:55]
 s_waitcnt lgkmcnt(11)
 ds_read_b64_tr_b16 a[246:247], v187 offset:6144
 v_cvt_pk_bf16_f32 v71, v46, v47
 v_mfma_f32_16x16x32_bf16 v[52:55], a[220:223], v[172:175], v[52:55]
 s_add_u32 s92, s9, 65536
 ds_read_b64_tr_b16 a[248:249], v187 offset:8192
 buffer_store_dwordx4 v[68:71], v21, s[36:39], s92 offen sc1
 v_mfma_f32_16x16x32_bf16 v[48:51], a[220:223], v[140:143], v[48:51]
 s_waitcnt lgkmcnt(11)
 ds_read_b64_tr_b16 a[250:251], v187 offset:10240
 buffer_load_dwordx4 v12, s[60:63], s91 offen offset:2048 lds
 v_mfma_f32_16x16x32_bf16 v[56:59], a[224:227], v[112:115], v[56:59]
 ds_read_b64_tr_b16 a[252:253], v187 offset:12288
 v_cmp_eq_u32 vcc, v99, v95
 v_mfma_f32_16x16x32_bf16 v[60:63], a[224:227], v[144:147], v[60:63]
 s_waitcnt lgkmcnt(11)
 ds_read_b64_tr_b16 a[254:255], v187 offset:14336
 v_cndmask_b32 v99, 0, v98, vcc
 v_mfma_f32_16x16x32_bf16 v[60:63], a[228:231], v[148:151], v[60:63]
 ds_read_b64_tr_b16 a[192:193], v184 offset:16384
 v_cmp_eq_u32 vcc, 0, v97
 v_mfma_f32_16x16x32_bf16 v[56:59], a[228:231], v[116:119], v[56:59]
 s_waitcnt lgkmcnt(11)
 ds_read_b64_tr_b16 a[194:195], v184 offset:18432
 v_cndmask_b32 v80, 0, v99, vcc
 v_mfma_f32_16x16x32_bf16 v[56:59], a[232:235], v[120:123], v[56:59]
 ds_read_b64_tr_b16 a[196:197], v184 offset:20480
 v_cmp_eq_u32 vcc, 1, v97
 v_mfma_f32_16x16x32_bf16 v[60:63], a[232:235], v[152:155], v[60:63]
 s_waitcnt lgkmcnt(11)
 ds_read_b64_tr_b16 a[198:199], v184 offset:22528
 buffer_load_dwordx4 v13, s[60:63], s91 offen offset:3072 lds
 v_mfma_f32_16x16x32_bf16 v[60:63], a[236:239], v[156:159], v[60:63]
 ds_read_b64_tr_b16 a[200:201], v184 offset:24576
 v_cndmask_b32 v81, 0, v99, vcc
 v_mfma_f32_16x16x32_bf16 v[56:59], a[236:239], v[124:127], v[56:59]
 s_waitcnt lgkmcnt(11)
 ds_read_b64_tr_b16 a[202:203], v184 offset:26624
 v_cmp_eq_u32 vcc, 2, v97
 v_mfma_f32_16x16x32_bf16 v[56:59], a[240:243], v[128:131], v[56:59]
 ds_read_b64_tr_b16 a[204:205], v184 offset:28672
 v_cndmask_b32 v82, 0, v99, vcc
 v_mfma_f32_16x16x32_bf16 v[60:63], a[240:243], v[160:163], v[60:63]
 s_waitcnt lgkmcnt(11)
 ds_read_b64_tr_b16 a[206:207], v184 offset:30720
 v_cmp_eq_u32 vcc, 3, v97
 v_mfma_f32_16x16x32_bf16 v[60:63], a[244:247], v[164:167], v[60:63]
 ds_read_b64_tr_b16 a[208:209], v185 offset:16384
 v_cndmask_b32 v83, 0, v99, vcc
 v_mfma_f32_16x16x32_bf16 v[56:59], a[244:247], v[132:135], v[56:59]
 s_waitcnt lgkmcnt(11)
 ds_read_b64_tr_b16 a[210:211], v185 offset:18432
 v_add_u32 v99, 1, v96
 v_mfma_f32_16x16x32_bf16 v[56:59], a[248:251], v[136:139], v[56:59]
 ds_read_b64_tr_b16 a[212:213], v185 offset:20480
 v_cmp_eq_u32 vcc, v99, v95
 v_mfma_f32_16x16x32_bf16 v[60:63], a[248:251], v[168:171], v[60:63]
 s_waitcnt lgkmcnt(11)
 ds_read_b64_tr_b16 a[214:215], v185 offset:22528
 v_cndmask_b32 v99, 0, v98, vcc
 v_mfma_f32_16x16x32_bf16 v[60:63], a[252:255], v[172:175], v[60:63]
 ds_read_b64_tr_b16 a[216:217], v185 offset:24576
 v_cmp_eq_u32 vcc, 0, v97
 v_mfma_f32_16x16x32_bf16 v[56:59], a[252:255], v[140:143], v[56:59]
 ds_read_b64_tr_b16 a[218:219], v185 offset:26624
 s_waitcnt lgkmcnt(12)
 v_mfma_f32_16x16x32_bf16 v[32:35], a[192:195], a[128:131], 0
 ds_read_b64_tr_b16 a[220:221], v185 offset:28672
 v_mfma_f32_16x16x32_bf16 v[36:39], a[192:195], a[144:147], 0
 s_waitcnt lgkmcnt(11)
 ds_read_b64_tr_b16 a[222:223], v185 offset:30720
 v_mfma_f32_16x16x32_bf16 v[36:39], a[196:199], a[148:151], v[36:39]
 ds_read_b64_tr_b16 a[224:225], v186 offset:16384
 v_mfma_f32_16x16x32_bf16 v[32:35], a[196:199], a[132:135], v[32:35]
 s_waitcnt lgkmcnt(11)
 ds_read_b64_tr_b16 a[226:227], v186 offset:18432
 v_cvt_pk_bf16_f32 v72, v48, v49
 v_mfma_f32_16x16x32_bf16 v[32:35], a[200:203], a[136:139], v[32:35]
 ds_read_b64_tr_b16 a[228:229], v186 offset:20480
 v_cvt_pk_bf16_f32 v73, v50, v51
 v_mfma_f32_16x16x32_bf16 v[36:39], a[200:203], a[152:155], v[36:39]
 s_waitcnt lgkmcnt(11)
 ds_read_b64_tr_b16 a[230:231], v186 offset:22528
 v_cvt_pk_bf16_f32 v74, v56, v57
 v_mfma_f32_16x16x32_bf16 v[36:39], a[204:207], a[156:159], v[36:39]
 ds_read_b64_tr_b16 a[232:233], v186 offset:24576
 v_cvt_pk_bf16_f32 v75, v58, v59
 v_mfma_f32_16x16x32_bf16 v[32:35], a[204:207], a[140:143], v[32:35]
 s_waitcnt lgkmcnt(11)
 s_add_u32 s92, s8, 81920
 ds_read_b64_tr_b16 a[234:235], v186 offset:26624
 buffer_store_dwordx4 v[72:75], v21, s[36:39], s92 offen sc1
 v_mfma_f32_16x16x32_bf16 v[40:43], a[208:211], a[128:131], 0
 ds_read_b64_tr_b16 a[236:237], v186 offset:28672
 v_cvt_pk_bf16_f32 v76, v52, v53
 v_mfma_f32_16x16x32_bf16 v[44:47], a[208:211], a[144:147], 0
 s_waitcnt lgkmcnt(11)
 ds_read_b64_tr_b16 a[238:239], v186 offset:30720
 v_cvt_pk_bf16_f32 v77, v54, v55
 v_mfma_f32_16x16x32_bf16 v[44:47], a[212:215], a[148:151], v[44:47]
 ds_read_b64_tr_b16 a[240:241], v187 offset:16384
 v_cvt_pk_bf16_f32 v78, v60, v61
 v_mfma_f32_16x16x32_bf16 v[40:43], a[212:215], a[132:135], v[40:43]
 s_waitcnt lgkmcnt(11)
 ds_read_b64_tr_b16 a[242:243], v187 offset:18432
 v_cvt_pk_bf16_f32 v79, v62, v63
 v_mfma_f32_16x16x32_bf16 v[40:43], a[216:219], a[136:139], v[40:43]
 ds_read_b64_tr_b16 a[244:245], v187 offset:20480
 v_mfma_f32_16x16x32_bf16 v[44:47], a[216:219], a[152:155], v[44:47]
 s_waitcnt lgkmcnt(11)
 ds_read_b64_tr_b16 a[246:247], v187 offset:22528
 v_mul_f32 v32, v32, v192
 v_mfma_f32_16x16x32_bf16 v[44:47], a[220:223], a[156:159], v[44:47]
 s_add_u32 s92, s9, 81920
 ds_read_b64_tr_b16 a[248:249], v187 offset:24576
 buffer_store_dwordx4 v[76:79], v21, s[36:39], s92 offen sc1
 v_mfma_f32_16x16x32_bf16 v[40:43], a[220:223], a[140:143], v[40:43]
 s_waitcnt lgkmcnt(11)
 ds_read_b64_tr_b16 a[250:251], v187 offset:26624
 v_mul_f32 v33, v33, v192
 v_mfma_f32_16x16x32_bf16 v[48:51], a[224:227], a[128:131], 0
 ds_read_b64_tr_b16 a[252:253], v187 offset:28672
 v_mul_f32 v34, v34, v192
 v_mfma_f32_16x16x32_bf16 v[52:55], a[224:227], a[144:147], 0
 s_waitcnt lgkmcnt(11)
 s_waitcnt vmcnt(18)
 s_barrier
 ds_read_b64_tr_b16 a[254:255], v187 offset:30720
 v_mfma_f32_16x16x32_bf16 v[52:55], a[228:231], a[148:151], v[52:55]
 s_add_u32 m0, s76, 98304
 s_add_u32 s91, s6, 640
 ds_read_b64_tr_b16 a[192:193], v176 offset:0
 v_mul_f32 v35, v35, v192
 v_mfma_f32_16x16x32_bf16 v[48:51], a[228:231], a[132:135], v[48:51]
 s_waitcnt lgkmcnt(11)
 ds_read_b64_tr_b16 a[194:195], v176 offset:2048
 buffer_load_dwordx4 v10, s[56:59], s91 offen offset:0 lds
 v_mfma_f32_16x16x32_bf16 v[48:51], a[232:235], a[136:139], v[48:51]
 ds_read_b64_tr_b16 a[196:197], v176 offset:4096
 v_mul_f32 v36, v36, v193
 v_mfma_f32_16x16x32_bf16 v[52:55], a[232:235], a[152:155], v[52:55]
 s_waitcnt lgkmcnt(11)
 ds_read_b64_tr_b16 a[198:199], v176 offset:6144
 v_mul_f32 v37, v37, v193
 v_mfma_f32_16x16x32_bf16 v[52:55], a[236:239], a[156:159], v[52:55]
 ds_read_b64_tr_b16 a[200:201], v176 offset:8192
 v_mul_f32 v38, v38, v193
 v_mfma_f32_16x16x32_bf16 v[48:51], a[236:239], a[140:143], v[48:51]
 s_waitcnt lgkmcnt(11)
 ds_read_b64_tr_b16 a[202:203], v176 offset:10240
 v_mul_f32 v39, v39, v193
 v_mfma_f32_16x16x32_bf16 v[56:59], a[240:243], a[128:131], 0
 ds_read_b64_tr_b16 a[204:205], v176 offset:12288
 v_mul_f32 v40, v40, v192
 v_mfma_f32_16x16x32_bf16 v[60:63], a[240:243], a[144:147], 0
 s_waitcnt lgkmcnt(11)
 ds_read_b64_tr_b16 a[206:207], v176 offset:14336
 buffer_load_dwordx4 v11, s[56:59], s91 offen offset:1024 lds
 v_mfma_f32_16x16x32_bf16 v[60:63], a[244:247], a[148:151], v[60:63]
 ds_read_b64_tr_b16 a[208:209], v176 offset:16384
 v_mul_f32 v41, v41, v192
 v_mfma_f32_16x16x32_bf16 v[56:59], a[244:247], a[132:135], v[56:59]
 s_waitcnt lgkmcnt(11)
 ds_read_b64_tr_b16 a[210:211], v176 offset:18432
 v_mul_f32 v42, v42, v192
 v_mfma_f32_16x16x32_bf16 v[56:59], a[248:251], a[136:139], v[56:59]
 ds_read_b64_tr_b16 a[212:213], v176 offset:20480
 v_mul_f32 v43, v43, v192
 v_mfma_f32_16x16x32_bf16 v[60:63], a[248:251], a[152:155], v[60:63]
 s_waitcnt lgkmcnt(11)
 ds_read_b64_tr_b16 a[214:215], v176 offset:22528
 v_mul_f32 v44, v44, v193
 v_mfma_f32_16x16x32_bf16 v[60:63], a[252:255], a[156:159], v[60:63]
 ds_read_b64_tr_b16 a[216:217], v176 offset:24576
 v_mul_f32 v45, v45, v193
 v_mfma_f32_16x16x32_bf16 v[56:59], a[252:255], a[140:143], v[56:59]
 s_waitcnt lgkmcnt(11)
 ds_read_b64_tr_b16 a[218:219], v176 offset:26624
 buffer_load_dwordx4 v12, s[56:59], s91 offen offset:2048 lds
 v_mfma_f32_16x16x32_bf16 v[32:35], a[192:195], v[112:115], v[32:35]
 ds_read_b64_tr_b16 a[220:221], v176 offset:28672
 v_mul_f32 v46, v46, v193
 v_mfma_f32_16x16x32_bf16 v[36:39], a[192:195], v[144:147], v[36:39]
 s_waitcnt lgkmcnt(11)
 ds_read_b64_tr_b16 a[222:223], v176 offset:30720
 v_mul_f32 v47, v47, v193
 v_mfma_f32_16x16x32_bf16 v[36:39], a[196:199], v[148:151], v[36:39]
 ds_read_b64_tr_b16 a[224:225], v177 offset:0
 v_mul_f32 v48, v48, v192
 v_mfma_f32_16x16x32_bf16 v[32:35], a[196:199], v[116:119], v[32:35]
 s_waitcnt lgkmcnt(11)
 ds_read_b64_tr_b16 a[226:227], v177 offset:2048
 v_mul_f32 v49, v49, v192
 v_mfma_f32_16x16x32_bf16 v[32:35], a[200:203], v[120:123], v[32:35]
 ds_read_b64_tr_b16 a[228:229], v177 offset:4096
 v_mul_f32 v50, v50, v192
 v_mfma_f32_16x16x32_bf16 v[36:39], a[200:203], v[152:155], v[36:39]
 s_waitcnt lgkmcnt(11)
 ds_read_b64_tr_b16 a[230:231], v177 offset:6144
 buffer_load_dwordx4 v13, s[56:59], s91 offen offset:3072 lds
 v_mfma_f32_16x16x32_bf16 v[36:39], a[204:207], v[156:159], v[36:39]
 ds_read_b64_tr_b16 a[232:233], v177 offset:8192
 v_mul_f32 v51, v51, v192
 v_mfma_f32_16x16x32_bf16 v[32:35], a[204:207], v[124:127], v[32:35]
 s_waitcnt lgkmcnt(11)
 ds_read_b64_tr_b16 a[234:235], v177 offset:10240
 v_mul_f32 v52, v52, v193
 v_mfma_f32_16x16x32_bf16 v[32:35], a[208:211], v[128:131], v[32:35]
 ds_read_b64_tr_b16 a[236:237], v177 offset:12288
 v_mul_f32 v53, v53, v193
 v_mfma_f32_16x16x32_bf16 v[36:39], a[208:211], v[160:163], v[36:39]
 s_waitcnt lgkmcnt(11)
 ds_read_b64_tr_b16 a[238:239], v177 offset:14336
 v_mul_f32 v54, v54, v193
 v_mfma_f32_16x16x32_bf16 v[36:39], a[212:215], v[164:167], v[36:39]
 s_add_u32 m0, s76, 114688
 s_add_u32 s91, s6, 115328
 ds_read_b64_tr_b16 a[240:241], v177 offset:16384
 v_mul_f32 v55, v55, v193
 v_mfma_f32_16x16x32_bf16 v[32:35], a[212:215], v[132:135], v[32:35]
 s_waitcnt lgkmcnt(11)
 ds_read_b64_tr_b16 a[242:243], v177 offset:18432
 buffer_load_dwordx4 v10, s[56:59], s91 offen offset:0 lds
 v_mfma_f32_16x16x32_bf16 v[32:35], a[216:219], v[136:139], v[32:35]
 ds_read_b64_tr_b16 a[244:245], v177 offset:20480
 v_mul_f32 v56, v56, v192
 v_mfma_f32_16x16x32_bf16 v[36:39], a[216:219], v[168:171], v[36:39]
 s_waitcnt lgkmcnt(11)
 ds_read_b64_tr_b16 a[246:247], v177 offset:22528
 v_mul_f32 v57, v57, v192
 v_mfma_f32_16x16x32_bf16 v[36:39], a[220:223], v[172:175], v[36:39]
 ds_read_b64_tr_b16 a[248:249], v177 offset:24576
 v_mul_f32 v58, v58, v192
 v_mfma_f32_16x16x32_bf16 v[32:35], a[220:223], v[140:143], v[32:35]
 s_waitcnt lgkmcnt(11)
 ds_read_b64_tr_b16 a[250:251], v177 offset:26624
 v_mul_f32 v59, v59, v192
 v_mfma_f32_16x16x32_bf16 v[40:43], a[224:227], v[112:115], v[40:43]
 ds_read_b64_tr_b16 a[252:253], v177 offset:28672
 v_mul_f32 v60, v60, v193
 v_mfma_f32_16x16x32_bf16 v[44:47], a[224:227], v[144:147], v[44:47]
 s_waitcnt lgkmcnt(11)
 ds_read_b64_tr_b16 a[254:255], v177 offset:30720
 buffer_load_dwordx4 v11, s[56:59], s91 offen offset:1024 lds
 v_mfma_f32_16x16x32_bf16 v[44:47], a[228:231], v[148:151], v[44:47]
 ds_read_b64_tr_b16 a[192:193], v178 offset:0
 v_mul_f32 v61, v61, v193
 v_mfma_f32_16x16x32_bf16 v[40:43], a[228:231], v[116:119], v[40:43]
 s_waitcnt lgkmcnt(11)
 ds_read_b64_tr_b16 a[194:195], v178 offset:2048
 v_mul_f32 v62, v62, v193
 v_mfma_f32_16x16x32_bf16 v[40:43], a[232:235], v[120:123], v[40:43]
 ds_read_b64_tr_b16 a[196:197], v178 offset:4096
 v_mul_f32 v63, v63, v193
 v_mfma_f32_16x16x32_bf16 v[44:47], a[232:235], v[152:155], v[44:47]
 s_waitcnt lgkmcnt(11)
 ds_read_b64_tr_b16 a[198:199], v178 offset:6144
 v_cndmask_b32 v84, 0, v99, vcc
 v_mfma_f32_16x16x32_bf16 v[44:47], a[236:239], v[156:159], v[44:47]
 ds_read_b64_tr_b16 a[200:201], v178 offset:8192
 v_cmp_eq_u32 vcc, 1, v97
 v_mfma_f32_16x16x32_bf16 v[40:43], a[236:239], v[124:127], v[40:43]
 s_waitcnt lgkmcnt(11)
 ds_read_b64_tr_b16 a[202:203], v178 offset:10240
 buffer_load_dwordx4 v12, s[56:59], s91 offen offset:2048 lds
 v_mfma_f32_16x16x32_bf16 v[40:43], a[240:243], v[128:131], v[40:43]
 ds_read_b64_tr_b16 a[204:205], v178 offset:12288
 v_cndmask_b32 v85, 0, v99, vcc
 v_mfma_f32_16x16x32_bf16 v[44:47], a[240:243], v[160:163], v[44:47]
 s_waitcnt lgkmcnt(11)
 ds_read_b64_tr_b16 a[206:207], v178 offset:14336
 v_cmp_eq_u32 vcc, 2, v97
 v_mfma_f32_16x16x32_bf16 v[44:47], a[244:247], v[164:167], v[44:47]
 ds_read_b64_tr_b16 a[208:209], v178 offset:16384
 v_cndmask_b32 v86, 0, v99, vcc
 v_mfma_f32_16x16x32_bf16 v[40:43], a[244:247], v[132:135], v[40:43]
 s_waitcnt lgkmcnt(11)
 ds_read_b64_tr_b16 a[210:211], v178 offset:18432
 v_cmp_eq_u32 vcc, 3, v97
 v_mfma_f32_16x16x32_bf16 v[40:43], a[248:251], v[136:139], v[40:43]
 ds_read_b64_tr_b16 a[212:213], v178 offset:20480
 v_cndmask_b32 v87, 0, v99, vcc
 v_mfma_f32_16x16x32_bf16 v[44:47], a[248:251], v[168:171], v[44:47]
 s_waitcnt lgkmcnt(11)
 ds_read_b64_tr_b16 a[214:215], v178 offset:22528
 buffer_load_dwordx4 v13, s[56:59], s91 offen offset:3072 lds
 v_mfma_f32_16x16x32_bf16 v[44:47], a[252:255], v[172:175], v[44:47]
 ds_read_b64_tr_b16 a[216:217], v178 offset:24576
 v_mfma_f32_16x16x32_bf16 v[40:43], a[252:255], v[140:143], v[40:43]
 s_waitcnt lgkmcnt(11)
 ds_read_b64_tr_b16 a[218:219], v178 offset:26624
 v_mfma_f32_16x16x32_bf16 v[48:51], a[192:195], v[112:115], v[48:51]
 ds_read_b64_tr_b16 a[220:221], v178 offset:28672
 v_mfma_f32_16x16x32_bf16 v[52:55], a[192:195], v[144:147], v[52:55]
 s_waitcnt lgkmcnt(11)
 ds_read_b64_tr_b16 a[222:223], v178 offset:30720
 v_mfma_f32_16x16x32_bf16 v[52:55], a[196:199], v[148:151], v[52:55]
 s_add_u32 m0, s76, 131072
 s_add_u32 s91, s7, 768
 ds_read_b64_tr_b16 a[224:225], v179 offset:0
 v_mfma_f32_16x16x32_bf16 v[48:51], a[196:199], v[116:119], v[48:51]
 s_waitcnt lgkmcnt(11)
 ds_read_b64_tr_b16 a[226:227], v179 offset:2048
 buffer_load_dwordx4 v10, s[60:63], s91 offen offset:0 lds
 v_mfma_f32_16x16x32_bf16 v[48:51], a[200:203], v[120:123], v[48:51]
 ds_read_b64_tr_b16 a[228:229], v179 offset:4096
 v_cvt_pk_bf16_f32 v64, v32, v33
 v_mfma_f32_16x16x32_bf16 v[52:55], a[200:203], v[152:155], v[52:55]
 s_waitcnt lgkmcnt(11)
 ds_read_b64_tr_b16 a[230:231], v179 offset:6144
 v_cvt_pk_bf16_f32 v65, v34, v35
 v_mfma_f32_16x16x32_bf16 v[52:55], a[204:207], v[156:159], v[52:55]
 ds_read_b64_tr_b16 a[232:233], v179 offset:8192
 v_cvt_pk_bf16_f32 v66, v40, v41
 v_mfma_f32_16x16x32_bf16 v[48:51], a[204:207], v[124:127], v[48:51]
 s_waitcnt lgkmcnt(11)
 ds_read_b64_tr_b16 a[234:235], v179 offset:10240
 v_cvt_pk_bf16_f32 v67, v42, v43
 v_mfma_f32_16x16x32_bf16 v[48:51], a[208:211], v[128:131], v[48:51]
 s_add_u32 s92, s8, 98304
 ds_read_b64_tr_b16 a[236:237], v179 offset:12288
 buffer_store_dwordx4 v[64:67], v21, s[36:39], s92 offen sc1
 v_mfma_f32_16x16x32_bf16 v[52:55], a[208:211], v[160:163], v[52:55]
 s_waitcnt lgkmcnt(11)
 ds_read_b64_tr_b16 a[238:239], v179 offset:14336
 buffer_load_dwordx4 v11, s[60:63], s91 offen offset:1024 lds
 v_mfma_f32_16x16x32_bf16 v[52:55], a[212:215], v[164:167], v[52:55]
 ds_read_b64_tr_b16 a[240:241], v179 offset:16384
 v_cvt_pk_bf16_f32 v68, v36, v37
 v_mfma_f32_16x16x32_bf16 v[48:51], a[212:215], v[132:135], v[48:51]
 s_waitcnt lgkmcnt(11)
 ds_read_b64_tr_b16 a[242:243], v179 offset:18432
 v_cvt_pk_bf16_f32 v69, v38, v39
 v_mfma_f32_16x16x32_bf16 v[48:51], a[216:219], v[136:139], v[48:51]
 ds_read_b64_tr_b16 a[244:245], v179 offset:20480
 v_cvt_pk_bf16_f32 v70, v44, v45
 v_mfma_f32_16x16x32_bf16 v[52:55], a[216:219], v[168:171], v[52:55]
 s_waitcnt lgkmcnt(11)
 ds_read_b64_tr_b16 a[246:247], v179 offset:22528
 v_cvt_pk_bf16_f32 v71, v46, v47
 v_mfma_f32_16x16x32_bf16 v[52:55], a[220:223], v[172:175], v[52:55]
 s_add_u32 s92, s9, 98304
 ds_read_b64_tr_b16 a[248:249], v179 offset:24576
 buffer_store_dwordx4 v[68:71], v21, s[36:39], s92 offen sc1
 v_mfma_f32_16x16x32_bf16 v[48:51], a[220:223], v[140:143], v[48:51]
 s_waitcnt lgkmcnt(11)
 ds_read_b64_tr_b16 a[250:251], v179 offset:26624
 buffer_load_dwordx4 v12, s[60:63], s91 offen offset:2048 lds
 v_mfma_f32_16x16x32_bf16 v[56:59], a[224:227], v[112:115], v[56:59]
 ds_read_b64_tr_b16 a[252:253], v179 offset:28672
 v_mfma_f32_16x16x32_bf16 v[60:63], a[224:227], v[144:147], v[60:63]
 s_waitcnt lgkmcnt(11)
 ds_read_b64_tr_b16 a[254:255], v179 offset:30720
 v_mfma_f32_16x16x32_bf16 v[60:63], a[228:231], v[148:151], v[60:63]
 ds_read_b64_tr_b16 a[192:193], v176 offset:32768
 v_mfma_f32_16x16x32_bf16 v[56:59], a[228:231], v[116:119], v[56:59]
 s_waitcnt lgkmcnt(11)
 ds_read_b64_tr_b16 a[194:195], v176 offset:34816
 v_mfma_f32_16x16x32_bf16 v[56:59], a[232:235], v[120:123], v[56:59]
 ds_read_b64_tr_b16 a[196:197], v176 offset:36864
 v_mfma_f32_16x16x32_bf16 v[60:63], a[232:235], v[152:155], v[60:63]
 s_waitcnt lgkmcnt(11)
 ds_read_b64_tr_b16 a[198:199], v176 offset:38912
 buffer_load_dwordx4 v13, s[60:63], s91 offen offset:3072 lds
 v_mfma_f32_16x16x32_bf16 v[60:63], a[236:239], v[156:159], v[60:63]
 ds_read_b64_tr_b16 a[200:201], v176 offset:40960
 v_mfma_f32_16x16x32_bf16 v[56:59], a[236:239], v[124:127], v[56:59]
 s_waitcnt lgkmcnt(11)
 ds_read_b64_tr_b16 a[202:203], v176 offset:43008
 v_mfma_f32_16x16x32_bf16 v[56:59], a[240:243], v[128:131], v[56:59]
 ds_read_b64_tr_b16 a[204:205], v176 offset:45056
 v_mfma_f32_16x16x32_bf16 v[60:63], a[240:243], v[160:163], v[60:63]
 s_waitcnt lgkmcnt(11)
 ds_read_b64_tr_b16 a[206:207], v176 offset:47104
 v_mfma_f32_16x16x32_bf16 v[60:63], a[244:247], v[164:167], v[60:63]
 ds_read_b64_tr_b16 a[208:209], v177 offset:32768
 v_mfma_f32_16x16x32_bf16 v[56:59], a[244:247], v[132:135], v[56:59]
 s_waitcnt lgkmcnt(11)
 ds_read_b64_tr_b16 a[210:211], v177 offset:34816
 v_mfma_f32_16x16x32_bf16 v[56:59], a[248:251], v[136:139], v[56:59]
 ds_read_b64_tr_b16 a[212:213], v177 offset:36864
 v_mfma_f32_16x16x32_bf16 v[60:63], a[248:251], v[168:171], v[60:63]
 s_waitcnt lgkmcnt(11)
 ds_read_b64_tr_b16 a[214:215], v177 offset:38912
 v_mfma_f32_16x16x32_bf16 v[60:63], a[252:255], v[172:175], v[60:63]
 ds_read_b64_tr_b16 a[216:217], v177 offset:40960
 v_mfma_f32_16x16x32_bf16 v[56:59], a[252:255], v[140:143], v[56:59]
 ds_read_b64_tr_b16 a[218:219], v177 offset:43008
 s_waitcnt lgkmcnt(12)
 v_mfma_f32_16x16x32_bf16 v[32:35], a[192:195], a[128:131], 0
 ds_read_b64_tr_b16 a[220:221], v177 offset:45056
 v_mfma_f32_16x16x32_bf16 v[36:39], a[192:195], a[144:147], 0
 s_waitcnt lgkmcnt(11)
 ds_read_b64_tr_b16 a[222:223], v177 offset:47104
 v_mfma_f32_16x16x32_bf16 v[36:39], a[196:199], a[148:151], v[36:39]
 ds_read_b64_tr_b16 a[224:225], v178 offset:32768
 v_mfma_f32_16x16x32_bf16 v[32:35], a[196:199], a[132:135], v[32:35]
 s_waitcnt lgkmcnt(11)
 ds_read_b64_tr_b16 a[226:227], v178 offset:34816
 v_cvt_pk_bf16_f32 v72, v48, v49
 v_mfma_f32_16x16x32_bf16 v[32:35], a[200:203], a[136:139], v[32:35]
 ds_read_b64_tr_b16 a[228:229], v178 offset:36864
 v_cvt_pk_bf16_f32 v73, v50, v51
 v_mfma_f32_16x16x32_bf16 v[36:39], a[200:203], a[152:155], v[36:39]
 s_waitcnt lgkmcnt(11)
 ds_read_b64_tr_b16 a[230:231], v178 offset:38912
 v_cvt_pk_bf16_f32 v74, v56, v57
 v_mfma_f32_16x16x32_bf16 v[36:39], a[204:207], a[156:159], v[36:39]
 ds_read_b64_tr_b16 a[232:233], v178 offset:40960
 v_cvt_pk_bf16_f32 v75, v58, v59
 v_mfma_f32_16x16x32_bf16 v[32:35], a[204:207], a[140:143], v[32:35]
 s_waitcnt lgkmcnt(11)
 s_add_u32 s92, s8, 114688
 ds_read_b64_tr_b16 a[234:235], v178 offset:43008
 buffer_store_dwordx4 v[72:75], v21, s[36:39], s92 offen sc1
 v_mfma_f32_16x16x32_bf16 v[40:43], a[208:211], a[128:131], 0
 ds_read_b64_tr_b16 a[236:237], v178 offset:45056
 v_cvt_pk_bf16_f32 v76, v52, v53
 v_mfma_f32_16x16x32_bf16 v[44:47], a[208:211], a[144:147], 0
 s_waitcnt lgkmcnt(11)
 ds_read_b64_tr_b16 a[238:239], v178 offset:47104
 v_cvt_pk_bf16_f32 v77, v54, v55
 v_mfma_f32_16x16x32_bf16 v[44:47], a[212:215], a[148:151], v[44:47]
 ds_read_b64_tr_b16 a[240:241], v179 offset:32768
 v_cvt_pk_bf16_f32 v78, v60, v61
 v_mfma_f32_16x16x32_bf16 v[40:43], a[212:215], a[132:135], v[40:43]
 s_waitcnt lgkmcnt(11)
 ds_read_b64_tr_b16 a[242:243], v179 offset:34816
 v_cvt_pk_bf16_f32 v79, v62, v63
 v_mfma_f32_16x16x32_bf16 v[40:43], a[216:219], a[136:139], v[40:43]
 ds_read_b64_tr_b16 a[244:245], v179 offset:36864
 v_mfma_f32_16x16x32_bf16 v[44:47], a[216:219], a[152:155], v[44:47]
 s_waitcnt lgkmcnt(11)
 ds_read_b64_tr_b16 a[246:247], v179 offset:38912
 v_mul_f32 v32, v32, v192
 v_mfma_f32_16x16x32_bf16 v[44:47], a[220:223], a[156:159], v[44:47]
 s_add_u32 s92, s9, 114688
 ds_read_b64_tr_b16 a[248:249], v179 offset:40960
 buffer_store_dwordx4 v[76:79], v21, s[36:39], s92 offen sc1
 v_mfma_f32_16x16x32_bf16 v[40:43], a[220:223], a[140:143], v[40:43]
 s_waitcnt lgkmcnt(11)
 ds_read_b64_tr_b16 a[250:251], v179 offset:43008
 v_mul_f32 v33, v33, v192
 v_mfma_f32_16x16x32_bf16 v[48:51], a[224:227], a[128:131], 0
 ds_read_b64_tr_b16 a[252:253], v179 offset:45056
 v_mul_f32 v34, v34, v192
 v_mfma_f32_16x16x32_bf16 v[52:55], a[224:227], a[144:147], 0
 s_waitcnt lgkmcnt(11)
 s_waitcnt vmcnt(18)
 s_barrier
 ds_read_b64_tr_b16 a[254:255], v179 offset:47104
 v_mfma_f32_16x16x32_bf16 v[52:55], a[228:231], a[148:151], v[52:55]
 s_add_u32 m0, s76, 147456
 s_add_u32 s91, s6, 768
 ds_read_b64_tr_b16 a[192:193], v176 offset:49152
 v_mul_f32 v35, v35, v192
 v_mfma_f32_16x16x32_bf16 v[48:51], a[228:231], a[132:135], v[48:51]
 s_waitcnt lgkmcnt(11)
 ds_read_b64_tr_b16 a[194:195], v176 offset:51200
 buffer_load_dwordx4 v10, s[56:59], s91 offen offset:0 lds
 v_mfma_f32_16x16x32_bf16 v[48:51], a[232:235], a[136:139], v[48:51]
 ds_read_b64_tr_b16 a[196:197], v176 offset:53248
 v_mul_f32 v36, v36, v193
 v_mfma_f32_16x16x32_bf16 v[52:55], a[232:235], a[152:155], v[52:55]
 s_waitcnt lgkmcnt(11)
 ds_read_b64_tr_b16 a[198:199], v176 offset:55296
 v_mul_f32 v37, v37, v193
 v_mfma_f32_16x16x32_bf16 v[52:55], a[236:239], a[156:159], v[52:55]
 ds_read_b64_tr_b16 a[200:201], v176 offset:57344
 v_mul_f32 v38, v38, v193
 v_mfma_f32_16x16x32_bf16 v[48:51], a[236:239], a[140:143], v[48:51]
 s_waitcnt lgkmcnt(11)
 ds_read_b64_tr_b16 a[202:203], v176 offset:59392
 v_mul_f32 v39, v39, v193
 v_mfma_f32_16x16x32_bf16 v[56:59], a[240:243], a[128:131], 0
 ds_read_b64_tr_b16 a[204:205], v176 offset:61440
 v_mul_f32 v40, v40, v192
 v_mfma_f32_16x16x32_bf16 v[60:63], a[240:243], a[144:147], 0
 s_waitcnt lgkmcnt(11)
 ds_read_b64_tr_b16 a[206:207], v176 offset:63488
 buffer_load_dwordx4 v11, s[56:59], s91 offen offset:1024 lds
 v_mfma_f32_16x16x32_bf16 v[60:63], a[244:247], a[148:151], v[60:63]
 ds_read_b64_tr_b16 a[208:209], v180 offset:0
 v_mul_f32 v41, v41, v192
 v_mfma_f32_16x16x32_bf16 v[56:59], a[244:247], a[132:135], v[56:59]
 s_waitcnt lgkmcnt(11)
 ds_read_b64_tr_b16 a[210:211], v180 offset:2048
 v_mul_f32 v42, v42, v192
 v_mfma_f32_16x16x32_bf16 v[56:59], a[248:251], a[136:139], v[56:59]
 ds_read_b64_tr_b16 a[212:213], v180 offset:4096
 v_mul_f32 v43, v43, v192
 v_mfma_f32_16x16x32_bf16 v[60:63], a[248:251], a[152:155], v[60:63]
 s_waitcnt lgkmcnt(11)
 ds_read_b64_tr_b16 a[214:215], v180 offset:6144
 v_mul_f32 v44, v44, v193
 v_mfma_f32_16x16x32_bf16 v[60:63], a[252:255], a[156:159], v[60:63]
 ds_read_b64_tr_b16 a[216:217], v180 offset:8192
 v_mul_f32 v45, v45, v193
 v_mfma_f32_16x16x32_bf16 v[56:59], a[252:255], a[140:143], v[56:59]
 s_waitcnt lgkmcnt(11)
 ds_read_b64_tr_b16 a[218:219], v180 offset:10240
 buffer_load_dwordx4 v12, s[56:59], s91 offen offset:2048 lds
 v_mfma_f32_16x16x32_bf16 v[32:35], a[192:195], v[112:115], v[32:35]
 ds_read_b64_tr_b16 a[220:221], v180 offset:12288
 v_mul_f32 v46, v46, v193
 v_mfma_f32_16x16x32_bf16 v[36:39], a[192:195], v[144:147], v[36:39]
 s_waitcnt lgkmcnt(11)
 ds_read_b64_tr_b16 a[222:223], v180 offset:14336
 v_mul_f32 v47, v47, v193
 v_mfma_f32_16x16x32_bf16 v[36:39], a[196:199], v[148:151], v[36:39]
 ds_read_b64_tr_b16 a[224:225], v177 offset:49152
 v_mul_f32 v48, v48, v192
 v_mfma_f32_16x16x32_bf16 v[32:35], a[196:199], v[116:119], v[32:35]
 s_waitcnt lgkmcnt(11)
 ds_read_b64_tr_b16 a[226:227], v177 offset:51200
 v_mul_f32 v49, v49, v192
 v_mfma_f32_16x16x32_bf16 v[32:35], a[200:203], v[120:123], v[32:35]
 ds_read_b64_tr_b16 a[228:229], v177 offset:53248
 v_mul_f32 v50, v50, v192
 v_mfma_f32_16x16x32_bf16 v[36:39], a[200:203], v[152:155], v[36:39]
 s_waitcnt lgkmcnt(11)
 ds_read_b64_tr_b16 a[230:231], v177 offset:55296
 buffer_load_dwordx4 v13, s[56:59], s91 offen offset:3072 lds
 v_mfma_f32_16x16x32_bf16 v[36:39], a[204:207], v[156:159], v[36:39]
 ds_read_b64_tr_b16 a[232:233], v177 offset:57344
 v_mul_f32 v51, v51, v192
 v_mfma_f32_16x16x32_bf16 v[32:35], a[204:207], v[124:127], v[32:35]
 s_waitcnt lgkmcnt(11)
 ds_read_b64_tr_b16 a[234:235], v177 offset:59392
 v_mul_f32 v52, v52, v193
 v_mfma_f32_16x16x32_bf16 v[32:35], a[208:211], v[128:131], v[32:35]
 ds_read_b64_tr_b16 a[236:237], v177 offset:61440
 v_mul_f32 v53, v53, v193
 v_mfma_f32_16x16x32_bf16 v[36:39], a[208:211], v[160:163], v[36:39]
 s_waitcnt lgkmcnt(11)
 ds_read_b64_tr_b16 a[238:239], v177 offset:63488
 v_mul_f32 v54, v54, v193
 v_mfma_f32_16x16x32_bf16 v[36:39], a[212:215], v[164:167], v[36:39]
 s_add_u32 m0, s76, 0
 s_add_u32 s91, s6, 115456
 ds_read_b64_tr_b16 a[240:241], v181 offset:0
 v_mul_f32 v55, v55, v193
 v_mfma_f32_16x16x32_bf16 v[32:35], a[212:215], v[132:135], v[32:35]
 s_waitcnt lgkmcnt(11)
 ds_read_b64_tr_b16 a[242:243], v181 offset:2048
 buffer_load_dwordx4 v10, s[56:59], s91 offen offset:0 lds
 v_mfma_f32_16x16x32_bf16 v[32:35], a[216:219], v[136:139], v[32:35]
 ds_read_b64_tr_b16 a[244:245], v181 offset:4096
 v_mul_f32 v56, v56, v192
 v_mfma_f32_16x16x32_bf16 v[36:39], a[216:219], v[168:171], v[36:39]
 s_waitcnt lgkmcnt(11)
 ds_read_b64_tr_b16 a[246:247], v181 offset:6144
 v_mul_f32 v57, v57, v192
 v_mfma_f32_16x16x32_bf16 v[36:39], a[220:223], v[172:175], v[36:39]
 ds_read_b64_tr_b16 a[248:249], v181 offset:8192
 v_mul_f32 v58, v58, v192
 v_mfma_f32_16x16x32_bf16 v[32:35], a[220:223], v[140:143], v[32:35]
 s_waitcnt lgkmcnt(11)
 ds_read_b64_tr_b16 a[250:251], v181 offset:10240
 v_mul_f32 v59, v59, v192
 v_mfma_f32_16x16x32_bf16 v[40:43], a[224:227], v[112:115], v[40:43]
 ds_read_b64_tr_b16 a[252:253], v181 offset:12288
 v_mul_f32 v60, v60, v193
 v_mfma_f32_16x16x32_bf16 v[44:47], a[224:227], v[144:147], v[44:47]
 s_waitcnt lgkmcnt(11)
 ds_read_b64_tr_b16 a[254:255], v181 offset:14336
 buffer_load_dwordx4 v11, s[56:59], s91 offen offset:1024 lds
 v_mfma_f32_16x16x32_bf16 v[44:47], a[228:231], v[148:151], v[44:47]
 ds_read_b64_tr_b16 a[192:193], v178 offset:49152
 v_mul_f32 v61, v61, v193
 v_mfma_f32_16x16x32_bf16 v[40:43], a[228:231], v[116:119], v[40:43]
 s_waitcnt lgkmcnt(11)
 ds_read_b64_tr_b16 a[194:195], v178 offset:51200
 v_mul_f32 v62, v62, v193
 v_mfma_f32_16x16x32_bf16 v[40:43], a[232:235], v[120:123], v[40:43]
 ds_read_b64_tr_b16 a[196:197], v178 offset:53248
 v_mul_f32 v63, v63, v193
 v_mfma_f32_16x16x32_bf16 v[44:47], a[232:235], v[152:155], v[44:47]
 s_waitcnt lgkmcnt(11)
 ds_read_b64_tr_b16 a[198:199], v178 offset:55296
 v_mfma_f32_16x16x32_bf16 v[44:47], a[236:239], v[156:159], v[44:47]
 ds_read_b64_tr_b16 a[200:201], v178 offset:57344
 v_mfma_f32_16x16x32_bf16 v[40:43], a[236:239], v[124:127], v[40:43]
 s_waitcnt lgkmcnt(11)
 ds_read_b64_tr_b16 a[202:203], v178 offset:59392
 buffer_load_dwordx4 v12, s[56:59], s91 offen offset:2048 lds
 v_mfma_f32_16x16x32_bf16 v[40:43], a[240:243], v[128:131], v[40:43]
 ds_read_b64_tr_b16 a[204:205], v178 offset:61440
 v_mfma_f32_16x16x32_bf16 v[44:47], a[240:243], v[160:163], v[44:47]
 s_waitcnt lgkmcnt(11)
 ds_read_b64_tr_b16 a[206:207], v178 offset:63488
 v_mfma_f32_16x16x32_bf16 v[44:47], a[244:247], v[164:167], v[44:47]
 ds_read_b64_tr_b16 a[208:209], v182 offset:0
 v_mfma_f32_16x16x32_bf16 v[40:43], a[244:247], v[132:135], v[40:43]
 s_waitcnt lgkmcnt(11)
 ds_read_b64_tr_b16 a[210:211], v182 offset:2048
 v_mfma_f32_16x16x32_bf16 v[40:43], a[248:251], v[136:139], v[40:43]
 ds_read_b64_tr_b16 a[212:213], v182 offset:4096
 v_mfma_f32_16x16x32_bf16 v[44:47], a[248:251], v[168:171], v[44:47]
 s_waitcnt lgkmcnt(11)
 ds_read_b64_tr_b16 a[214:215], v182 offset:6144
 buffer_load_dwordx4 v13, s[56:59], s91 offen offset:3072 lds
 v_mfma_f32_16x16x32_bf16 v[44:47], a[252:255], v[172:175], v[44:47]
 s_waitcnt vmcnt(24)
 ds_read_b64_tr_b16 a[216:217], v182 offset:8192
 v_mfma_f32_16x16x32_bf16 v[40:43], a[252:255], v[140:143], v[40:43]
 s_waitcnt lgkmcnt(11)
 ds_read_b64_tr_b16 a[218:219], v182 offset:10240
 s_mov_b64 exec, 1
 buffer_store_dwordx2 v[28:29], v21, s[36:39], s13 offen offset:0 sc1
 s_mov_b64 exec, -1
 v_mfma_f32_16x16x32_bf16 v[48:51], a[192:195], v[112:115], v[48:51]
 ds_read_b64_tr_b16 a[220:221], v182 offset:12288
 v_mfma_f32_16x16x32_bf16 v[52:55], a[192:195], v[144:147], v[52:55]
 s_waitcnt lgkmcnt(11)
 ds_read_b64_tr_b16 a[222:223], v182 offset:14336
 v_mfma_f32_16x16x32_bf16 v[52:55], a[196:199], v[148:151], v[52:55]
 ds_read_b64_tr_b16 a[224:225], v179 offset:49152
 v_mfma_f32_16x16x32_bf16 v[48:51], a[196:199], v[116:119], v[48:51]
 s_waitcnt lgkmcnt(11)
 ds_read_b64_tr_b16 a[226:227], v179 offset:51200
 v_mfma_f32_16x16x32_bf16 v[48:51], a[200:203], v[120:123], v[48:51]
 ds_read_b64_tr_b16 a[228:229], v179 offset:53248
 v_cvt_pk_bf16_f32 v64, v32, v33
 v_mfma_f32_16x16x32_bf16 v[52:55], a[200:203], v[152:155], v[52:55]
 s_waitcnt lgkmcnt(11)
 ds_read_b64_tr_b16 a[230:231], v179 offset:55296
 v_cvt_pk_bf16_f32 v65, v34, v35
 v_mfma_f32_16x16x32_bf16 v[52:55], a[204:207], v[156:159], v[52:55]
 ds_read_b64_tr_b16 a[232:233], v179 offset:57344
 v_cvt_pk_bf16_f32 v66, v40, v41
 v_mfma_f32_16x16x32_bf16 v[48:51], a[204:207], v[124:127], v[48:51]
 s_waitcnt lgkmcnt(11)
 ds_read_b64_tr_b16 a[234:235], v179 offset:59392
 v_cvt_pk_bf16_f32 v67, v42, v43
 v_mfma_f32_16x16x32_bf16 v[48:51], a[208:211], v[128:131], v[48:51]
 s_add_u32 s92, s8, 131072
 ds_read_b64_tr_b16 a[236:237], v179 offset:61440
 buffer_store_dwordx4 v[64:67], v21, s[36:39], s92 offen sc1
 v_mfma_f32_16x16x32_bf16 v[52:55], a[208:211], v[160:163], v[52:55]
 s_waitcnt lgkmcnt(11)
 ds_read_b64_tr_b16 a[238:239], v179 offset:63488
 v_cvt_pk_bf16_f32 v68, v36, v37
 v_mfma_f32_16x16x32_bf16 v[52:55], a[212:215], v[164:167], v[52:55]
 ds_read_b64_tr_b16 a[240:241], v183 offset:0
 v_cvt_pk_bf16_f32 v69, v38, v39
 v_mfma_f32_16x16x32_bf16 v[48:51], a[212:215], v[132:135], v[48:51]
 s_waitcnt lgkmcnt(11)
 ds_read_b64_tr_b16 a[242:243], v183 offset:2048
 v_cvt_pk_bf16_f32 v70, v44, v45
 v_mfma_f32_16x16x32_bf16 v[48:51], a[216:219], v[136:139], v[48:51]
 ds_read_b64_tr_b16 a[244:245], v183 offset:4096
 v_cvt_pk_bf16_f32 v71, v46, v47
 v_mfma_f32_16x16x32_bf16 v[52:55], a[216:219], v[168:171], v[52:55]
 s_waitcnt lgkmcnt(11)
 s_add_u32 s92, s9, 131072
 ds_read_b64_tr_b16 a[246:247], v183 offset:6144
 buffer_store_dwordx4 v[68:71], v21, s[36:39], s92 offen sc1
 v_mfma_f32_16x16x32_bf16 v[52:55], a[220:223], v[172:175], v[52:55]
 ds_read_b64_tr_b16 a[248:249], v183 offset:8192
 v_mfma_f32_16x16x32_bf16 v[48:51], a[220:223], v[140:143], v[48:51]
 s_waitcnt lgkmcnt(11)
 ds_read_b64_tr_b16 a[250:251], v183 offset:10240
 v_mfma_f32_16x16x32_bf16 v[56:59], a[224:227], v[112:115], v[56:59]
 ds_read_b64_tr_b16 a[252:253], v183 offset:12288
 v_mfma_f32_16x16x32_bf16 v[60:63], a[224:227], v[144:147], v[60:63]
 s_waitcnt lgkmcnt(11)
 ds_read_b64_tr_b16 a[254:255], v183 offset:14336
 v_mfma_f32_16x16x32_bf16 v[60:63], a[228:231], v[148:151], v[60:63]
 ds_read_b64_tr_b16 a[192:193], v180 offset:16384
 v_mfma_f32_16x16x32_bf16 v[56:59], a[228:231], v[116:119], v[56:59]
 s_waitcnt lgkmcnt(11)
 ds_read_b64_tr_b16 a[194:195], v180 offset:18432
 v_mfma_f32_16x16x32_bf16 v[56:59], a[232:235], v[120:123], v[56:59]
 ds_read_b64_tr_b16 a[196:197], v180 offset:20480
 v_mfma_f32_16x16x32_bf16 v[60:63], a[232:235], v[152:155], v[60:63]
 s_waitcnt lgkmcnt(11)
 ds_read_b64_tr_b16 a[198:199], v180 offset:22528
 v_mfma_f32_16x16x32_bf16 v[60:63], a[236:239], v[156:159], v[60:63]
 ds_read_b64_tr_b16 a[200:201], v180 offset:24576
 v_mfma_f32_16x16x32_bf16 v[56:59], a[236:239], v[124:127], v[56:59]
 s_waitcnt lgkmcnt(11)
 ds_read_b64_tr_b16 a[202:203], v180 offset:26624
 v_mfma_f32_16x16x32_bf16 v[56:59], a[240:243], v[128:131], v[56:59]
 ds_read_b64_tr_b16 a[204:205], v180 offset:28672
 v_mfma_f32_16x16x32_bf16 v[60:63], a[240:243], v[160:163], v[60:63]
 s_waitcnt lgkmcnt(11)
 ds_read_b64_tr_b16 a[206:207], v180 offset:30720
 v_mfma_f32_16x16x32_bf16 v[60:63], a[244:247], v[164:167], v[60:63]
 ds_read_b64_tr_b16 a[208:209], v181 offset:16384
 v_mfma_f32_16x16x32_bf16 v[56:59], a[244:247], v[132:135], v[56:59]
 s_waitcnt lgkmcnt(11)
 ds_read_b64_tr_b16 a[210:211], v181 offset:18432
 v_mfma_f32_16x16x32_bf16 v[56:59], a[248:251], v[136:139], v[56:59]
 ds_read_b64_tr_b16 a[212:213], v181 offset:20480
 v_mfma_f32_16x16x32_bf16 v[60:63], a[248:251], v[168:171], v[60:63]
 s_waitcnt lgkmcnt(11)
 ds_read_b64_tr_b16 a[214:215], v181 offset:22528
 v_mfma_f32_16x16x32_bf16 v[60:63], a[252:255], v[172:175], v[60:63]
 ds_read_b64_tr_b16 a[216:217], v181 offset:24576
 v_mfma_f32_16x16x32_bf16 v[56:59], a[252:255], v[140:143], v[56:59]
 ds_read_b64_tr_b16 a[218:219], v181 offset:26624
 s_waitcnt lgkmcnt(12)
 v_mfma_f32_16x16x32_bf16 v[32:35], a[192:195], a[128:131], 0
 ds_read_b64_tr_b16 a[220:221], v181 offset:28672
 v_mfma_f32_16x16x32_bf16 v[36:39], a[192:195], a[144:147], 0
 s_waitcnt lgkmcnt(11)
 ds_read_b64_tr_b16 a[222:223], v181 offset:30720
 v_mfma_f32_16x16x32_bf16 v[36:39], a[196:199], a[148:151], v[36:39]
 ds_read_b64_tr_b16 a[224:225], v182 offset:16384
 v_mfma_f32_16x16x32_bf16 v[32:35], a[196:199], a[132:135], v[32:35]
 s_waitcnt lgkmcnt(11)
 ds_read_b64_tr_b16 a[226:227], v182 offset:18432
 v_cvt_pk_bf16_f32 v72, v48, v49
 v_mfma_f32_16x16x32_bf16 v[32:35], a[200:203], a[136:139], v[32:35]
 ds_read_b64_tr_b16 a[228:229], v182 offset:20480
 v_cvt_pk_bf16_f32 v73, v50, v51
 v_mfma_f32_16x16x32_bf16 v[36:39], a[200:203], a[152:155], v[36:39]
 s_waitcnt lgkmcnt(11)
 ds_read_b64_tr_b16 a[230:231], v182 offset:22528
 v_cvt_pk_bf16_f32 v74, v56, v57
 v_mfma_f32_16x16x32_bf16 v[36:39], a[204:207], a[156:159], v[36:39]
 ds_read_b64_tr_b16 a[232:233], v182 offset:24576
 v_cvt_pk_bf16_f32 v75, v58, v59
 v_mfma_f32_16x16x32_bf16 v[32:35], a[204:207], a[140:143], v[32:35]
 s_waitcnt lgkmcnt(11)
 s_add_u32 s92, s8, 147456
 ds_read_b64_tr_b16 a[234:235], v182 offset:26624
 buffer_store_dwordx4 v[72:75], v21, s[36:39], s92 offen sc1
 v_mfma_f32_16x16x32_bf16 v[40:43], a[208:211], a[128:131], 0
 ds_read_b64_tr_b16 a[236:237], v182 offset:28672
 v_cvt_pk_bf16_f32 v76, v52, v53
 v_mfma_f32_16x16x32_bf16 v[44:47], a[208:211], a[144:147], 0
 s_waitcnt lgkmcnt(11)
 ds_read_b64_tr_b16 a[238:239], v182 offset:30720
 v_cvt_pk_bf16_f32 v77, v54, v55
 v_mfma_f32_16x16x32_bf16 v[44:47], a[212:215], a[148:151], v[44:47]
 ds_read_b64_tr_b16 a[240:241], v183 offset:16384
 v_cvt_pk_bf16_f32 v78, v60, v61
 v_mfma_f32_16x16x32_bf16 v[40:43], a[212:215], a[132:135], v[40:43]
 s_waitcnt lgkmcnt(11)
 ds_read_b64_tr_b16 a[242:243], v183 offset:18432
 v_cvt_pk_bf16_f32 v79, v62, v63
 v_mfma_f32_16x16x32_bf16 v[40:43], a[216:219], a[136:139], v[40:43]
 ds_read_b64_tr_b16 a[244:245], v183 offset:20480
 v_mfma_f32_16x16x32_bf16 v[44:47], a[216:219], a[152:155], v[44:47]
 s_waitcnt lgkmcnt(11)
 ds_read_b64_tr_b16 a[246:247], v183 offset:22528
 v_mul_f32 v32, v32, v192
 v_mfma_f32_16x16x32_bf16 v[44:47], a[220:223], a[156:159], v[44:47]
 s_add_u32 s92, s9, 147456
 ds_read_b64_tr_b16 a[248:249], v183 offset:24576
 buffer_store_dwordx4 v[76:79], v21, s[36:39], s92 offen sc1
 v_mfma_f32_16x16x32_bf16 v[40:43], a[220:223], a[140:143], v[40:43]
 s_waitcnt lgkmcnt(11)
 ds_read_b64_tr_b16 a[250:251], v183 offset:26624
 v_mul_f32 v33, v33, v192
 v_mfma_f32_16x16x32_bf16 v[48:51], a[224:227], a[128:131], 0
 ds_read_b64_tr_b16 a[252:253], v183 offset:28672
 v_mul_f32 v34, v34, v192
 v_mfma_f32_16x16x32_bf16 v[52:55], a[224:227], a[144:147], 0
 s_waitcnt lgkmcnt(11)
 s_waitcnt vmcnt(15)
 s_barrier
 ds_read_b64_tr_b16 a[254:255], v183 offset:30720
 v_mfma_f32_16x16x32_bf16 v[52:55], a[228:231], a[148:151], v[52:55]
 ds_read_b64_tr_b16 a[192:193], v180 offset:32768
 v_mul_f32 v35, v35, v192
 v_mfma_f32_16x16x32_bf16 v[48:51], a[228:231], a[132:135], v[48:51]
 s_waitcnt lgkmcnt(11)
 ds_read_b64_tr_b16 a[194:195], v180 offset:34816
 v_mul_f32 v36, v36, v193
 v_mfma_f32_16x16x32_bf16 v[48:51], a[232:235], a[136:139], v[48:51]
 ds_read_b64_tr_b16 a[196:197], v180 offset:36864
 v_mul_f32 v37, v37, v193
 v_mfma_f32_16x16x32_bf16 v[52:55], a[232:235], a[152:155], v[52:55]
 s_waitcnt lgkmcnt(11)
 ds_read_b64_tr_b16 a[198:199], v180 offset:38912
 v_mul_f32 v38, v38, v193
 v_mfma_f32_16x16x32_bf16 v[52:55], a[236:239], a[156:159], v[52:55]
 ds_read_b64_tr_b16 a[200:201], v180 offset:40960
 v_mul_f32 v39, v39, v193
 v_mfma_f32_16x16x32_bf16 v[48:51], a[236:239], a[140:143], v[48:51]
 s_waitcnt lgkmcnt(11)
 ds_read_b64_tr_b16 a[202:203], v180 offset:43008
 v_mul_f32 v40, v40, v192
 v_mfma_f32_16x16x32_bf16 v[56:59], a[240:243], a[128:131], 0
 ds_read_b64_tr_b16 a[204:205], v180 offset:45056
 v_mul_f32 v41, v41, v192
 v_mfma_f32_16x16x32_bf16 v[60:63], a[240:243], a[144:147], 0
 s_waitcnt lgkmcnt(11)
 ds_read_b64_tr_b16 a[206:207], v180 offset:47104
 v_mul_f32 v42, v42, v192
 v_mfma_f32_16x16x32_bf16 v[60:63], a[244:247], a[148:151], v[60:63]
 ds_read_b64_tr_b16 a[208:209], v180 offset:49152
 v_mul_f32 v43, v43, v192
 v_mfma_f32_16x16x32_bf16 v[56:59], a[244:247], a[132:135], v[56:59]
 s_waitcnt lgkmcnt(11)
 ds_read_b64_tr_b16 a[210:211], v180 offset:51200
 v_mul_f32 v44, v44, v193
 v_mfma_f32_16x16x32_bf16 v[56:59], a[248:251], a[136:139], v[56:59]
 ds_read_b64_tr_b16 a[212:213], v180 offset:53248
 v_mul_f32 v45, v45, v193
 v_mfma_f32_16x16x32_bf16 v[60:63], a[248:251], a[152:155], v[60:63]
 s_waitcnt lgkmcnt(11)
 ds_read_b64_tr_b16 a[214:215], v180 offset:55296
 v_mul_f32 v46, v46, v193
 v_mfma_f32_16x16x32_bf16 v[60:63], a[252:255], a[156:159], v[60:63]
 ds_read_b64_tr_b16 a[216:217], v180 offset:57344
 v_mul_f32 v47, v47, v193
 v_mfma_f32_16x16x32_bf16 v[56:59], a[252:255], a[140:143], v[56:59]
 s_waitcnt lgkmcnt(11)
 ds_read_b64_tr_b16 a[218:219], v180 offset:59392
 v_mul_f32 v48, v48, v192
 v_mfma_f32_16x16x32_bf16 v[32:35], a[192:195], v[112:115], v[32:35]
 ds_read_b64_tr_b16 a[220:221], v180 offset:61440
 v_mul_f32 v49, v49, v192
 v_mfma_f32_16x16x32_bf16 v[36:39], a[192:195], v[144:147], v[36:39]
 s_waitcnt lgkmcnt(11)
 ds_read_b64_tr_b16 a[222:223], v180 offset:63488
 v_mul_f32 v50, v50, v192
 v_mfma_f32_16x16x32_bf16 v[36:39], a[196:199], v[148:151], v[36:39]
 ds_read_b64_tr_b16 a[224:225], v181 offset:32768
 v_mul_f32 v51, v51, v192
 v_mfma_f32_16x16x32_bf16 v[32:35], a[196:199], v[116:119], v[32:35]
 s_waitcnt lgkmcnt(11)
 ds_read_b64_tr_b16 a[226:227], v181 offset:34816
 v_mul_f32 v52, v52, v193
 v_mfma_f32_16x16x32_bf16 v[32:35], a[200:203], v[120:123], v[32:35]
 ds_read_b64_tr_b16 a[228:229], v181 offset:36864
 v_mul_f32 v53, v53, v193
 v_mfma_f32_16x16x32_bf16 v[36:39], a[200:203], v[152:155], v[36:39]
 s_waitcnt lgkmcnt(11)
 ds_read_b64_tr_b16 a[230:231], v181 offset:38912
 v_mul_f32 v54, v54, v193
 v_mfma_f32_16x16x32_bf16 v[36:39], a[204:207], v[156:159], v[36:39]
 ds_read_b64_tr_b16 a[232:233], v181 offset:40960
 v_mul_f32 v55, v55, v193
 v_mfma_f32_16x16x32_bf16 v[32:35], a[204:207], v[124:127], v[32:35]
 s_waitcnt lgkmcnt(11)
 ds_read_b64_tr_b16 a[234:235], v181 offset:43008
 v_mul_f32 v56, v56, v192
 v_mfma_f32_16x16x32_bf16 v[32:35], a[208:211], v[128:131], v[32:35]
 ds_read_b64_tr_b16 a[236:237], v181 offset:45056
 v_mul_f32 v57, v57, v192
 v_mfma_f32_16x16x32_bf16 v[36:39], a[208:211], v[160:163], v[36:39]
 s_waitcnt lgkmcnt(11)
 ds_read_b64_tr_b16 a[238:239], v181 offset:47104
 v_mul_f32 v58, v58, v192
 v_mfma_f32_16x16x32_bf16 v[36:39], a[212:215], v[164:167], v[36:39]
 ds_read_b64_tr_b16 a[240:241], v181 offset:49152
 v_mul_f32 v59, v59, v192
 v_mfma_f32_16x16x32_bf16 v[32:35], a[212:215], v[132:135], v[32:35]
 s_waitcnt lgkmcnt(11)
 ds_read_b64_tr_b16 a[242:243], v181 offset:51200
 v_mul_f32 v60, v60, v193
 v_mfma_f32_16x16x32_bf16 v[32:35], a[216:219], v[136:139], v[32:35]
 ds_read_b64_tr_b16 a[244:245], v181 offset:53248
 v_mul_f32 v61, v61, v193
 v_mfma_f32_16x16x32_bf16 v[36:39], a[216:219], v[168:171], v[36:39]
 s_waitcnt lgkmcnt(11)
 ds_read_b64_tr_b16 a[246:247], v181 offset:55296
 v_mul_f32 v62, v62, v193
 v_mfma_f32_16x16x32_bf16 v[36:39], a[220:223], v[172:175], v[36:39]
 ds_read_b64_tr_b16 a[248:249], v181 offset:57344
 v_mul_f32 v63, v63, v193
 v_mfma_f32_16x16x32_bf16 v[32:35], a[220:223], v[140:143], v[32:35]
 s_waitcnt lgkmcnt(11)
 ds_read_b64_tr_b16 a[250:251], v181 offset:59392
 v_mfma_f32_16x16x32_bf16 v[40:43], a[224:227], v[112:115], v[40:43]
 ds_read_b64_tr_b16 a[252:253], v181 offset:61440
 v_mfma_f32_16x16x32_bf16 v[44:47], a[224:227], v[144:147], v[44:47]
 s_waitcnt lgkmcnt(11)
 ds_read_b64_tr_b16 a[254:255], v181 offset:63488
 v_mfma_f32_16x16x32_bf16 v[44:47], a[228:231], v[148:151], v[44:47]
 ds_read_b64_tr_b16 a[192:193], v182 offset:32768
 v_mfma_f32_16x16x32_bf16 v[40:43], a[228:231], v[116:119], v[40:43]
 s_waitcnt lgkmcnt(11)
 ds_read_b64_tr_b16 a[194:195], v182 offset:34816
 v_mfma_f32_16x16x32_bf16 v[40:43], a[232:235], v[120:123], v[40:43]
 ds_read_b64_tr_b16 a[196:197], v182 offset:36864
 v_mfma_f32_16x16x32_bf16 v[44:47], a[232:235], v[152:155], v[44:47]
 s_waitcnt lgkmcnt(11)
 ds_read_b64_tr_b16 a[198:199], v182 offset:38912
 v_mfma_f32_16x16x32_bf16 v[44:47], a[236:239], v[156:159], v[44:47]
 ds_read_b64_tr_b16 a[200:201], v182 offset:40960
 v_mfma_f32_16x16x32_bf16 v[40:43], a[236:239], v[124:127], v[40:43]
 s_waitcnt lgkmcnt(11)
 ds_read_b64_tr_b16 a[202:203], v182 offset:43008
 v_mfma_f32_16x16x32_bf16 v[40:43], a[240:243], v[128:131], v[40:43]
 ds_read_b64_tr_b16 a[204:205], v182 offset:45056
 v_mfma_f32_16x16x32_bf16 v[44:47], a[240:243], v[160:163], v[44:47]
 s_waitcnt lgkmcnt(11)
 ds_read_b64_tr_b16 a[206:207], v182 offset:47104
 v_mfma_f32_16x16x32_bf16 v[44:47], a[244:247], v[164:167], v[44:47]
 ds_read_b64_tr_b16 a[208:209], v182 offset:49152
 v_mfma_f32_16x16x32_bf16 v[40:43], a[244:247], v[132:135], v[40:43]
 s_waitcnt lgkmcnt(11)
 ds_read_b64_tr_b16 a[210:211], v182 offset:51200
 v_mfma_f32_16x16x32_bf16 v[40:43], a[248:251], v[136:139], v[40:43]
 ds_read_b64_tr_b16 a[212:213], v182 offset:53248
 v_mfma_f32_16x16x32_bf16 v[44:47], a[248:251], v[168:171], v[44:47]
 s_waitcnt lgkmcnt(11)
 ds_read_b64_tr_b16 a[214:215], v182 offset:55296
 v_mfma_f32_16x16x32_bf16 v[44:47], a[252:255], v[172:175], v[44:47]
 ds_read_b64_tr_b16 a[216:217], v182 offset:57344
 v_mfma_f32_16x16x32_bf16 v[40:43], a[252:255], v[140:143], v[40:43]
 s_waitcnt lgkmcnt(11)
 ds_read_b64_tr_b16 a[218:219], v182 offset:59392
 v_mfma_f32_16x16x32_bf16 v[48:51], a[192:195], v[112:115], v[48:51]
 ds_read_b64_tr_b16 a[220:221], v182 offset:61440
 v_mfma_f32_16x16x32_bf16 v[52:55], a[192:195], v[144:147], v[52:55]
 s_waitcnt lgkmcnt(11)
 ds_read_b64_tr_b16 a[222:223], v182 offset:63488
 v_mfma_f32_16x16x32_bf16 v[52:55], a[196:199], v[148:151], v[52:55]
 ds_read_b64_tr_b16 a[224:225], v183 offset:32768
 v_mfma_f32_16x16x32_bf16 v[48:51], a[196:199], v[116:119], v[48:51]
 s_waitcnt lgkmcnt(11)
 ds_read_b64_tr_b16 a[226:227], v183 offset:34816
 v_mfma_f32_16x16x32_bf16 v[48:51], a[200:203], v[120:123], v[48:51]
 ds_read_b64_tr_b16 a[228:229], v183 offset:36864
 v_cvt_pk_bf16_f32 v64, v32, v33
 v_mfma_f32_16x16x32_bf16 v[52:55], a[200:203], v[152:155], v[52:55]
 s_waitcnt lgkmcnt(11)
 ds_read_b64_tr_b16 a[230:231], v183 offset:38912
 v_cvt_pk_bf16_f32 v65, v34, v35
 v_mfma_f32_16x16x32_bf16 v[52:55], a[204:207], v[156:159], v[52:55]
 ds_read_b64_tr_b16 a[232:233], v183 offset:40960
 v_cvt_pk_bf16_f32 v66, v40, v41
 v_mfma_f32_16x16x32_bf16 v[48:51], a[204:207], v[124:127], v[48:51]
 s_waitcnt lgkmcnt(11)
 ds_read_b64_tr_b16 a[234:235], v183 offset:43008
 v_cvt_pk_bf16_f32 v67, v42, v43
 v_mfma_f32_16x16x32_bf16 v[48:51], a[208:211], v[128:131], v[48:51]
 s_add_u32 s92, s8, 163840
 ds_read_b64_tr_b16 a[236:237], v183 offset:45056
 buffer_store_dwordx4 v[64:67], v21, s[36:39], s92 offen sc1
 v_mfma_f32_16x16x32_bf16 v[52:55], a[208:211], v[160:163], v[52:55]
 s_waitcnt lgkmcnt(11)
 ds_read_b64_tr_b16 a[238:239], v183 offset:47104
 v_cvt_pk_bf16_f32 v68, v36, v37
 v_mfma_f32_16x16x32_bf16 v[52:55], a[212:215], v[164:167], v[52:55]
 ds_read_b64_tr_b16 a[240:241], v183 offset:49152
 v_cvt_pk_bf16_f32 v69, v38, v39
 v_mfma_f32_16x16x32_bf16 v[48:51], a[212:215], v[132:135], v[48:51]
 s_waitcnt lgkmcnt(11)
 ds_read_b64_tr_b16 a[242:243], v183 offset:51200
 v_cvt_pk_bf16_f32 v70, v44, v45
 v_mfma_f32_16x16x32_bf16 v[48:51], a[216:219], v[136:139], v[48:51]
 ds_read_b64_tr_b16 a[244:245], v183 offset:53248
 v_cvt_pk_bf16_f32 v71, v46, v47
 v_mfma_f32_16x16x32_bf16 v[52:55], a[216:219], v[168:171], v[52:55]
 s_waitcnt lgkmcnt(11)
 s_add_u32 s92, s9, 163840
 ds_read_b64_tr_b16 a[246:247], v183 offset:55296
 buffer_store_dwordx4 v[68:71], v21, s[36:39], s92 offen sc1
 v_mfma_f32_16x16x32_bf16 v[52:55], a[220:223], v[172:175], v[52:55]
 ds_read_b64_tr_b16 a[248:249], v183 offset:57344
 v_mfma_f32_16x16x32_bf16 v[48:51], a[220:223], v[140:143], v[48:51]
 s_waitcnt lgkmcnt(11)
 ds_read_b64_tr_b16 a[250:251], v183 offset:59392
 v_mfma_f32_16x16x32_bf16 v[56:59], a[224:227], v[112:115], v[56:59]
 ds_read_b64_tr_b16 a[252:253], v183 offset:61440
 v_mfma_f32_16x16x32_bf16 v[60:63], a[224:227], v[144:147], v[60:63]
 s_waitcnt lgkmcnt(11)
 ds_read_b64_tr_b16 a[254:255], v183 offset:63488
 v_mfma_f32_16x16x32_bf16 v[60:63], a[228:231], v[148:151], v[60:63]
 ds_read_b64_tr_b16 a[192:193], v184 offset:0
 v_mfma_f32_16x16x32_bf16 v[56:59], a[228:231], v[116:119], v[56:59]
 s_waitcnt lgkmcnt(11)
 ds_read_b64_tr_b16 a[194:195], v184 offset:2048
 v_mfma_f32_16x16x32_bf16 v[56:59], a[232:235], v[120:123], v[56:59]
 ds_read_b64_tr_b16 a[196:197], v184 offset:4096
 v_mfma_f32_16x16x32_bf16 v[60:63], a[232:235], v[152:155], v[60:63]
 s_waitcnt lgkmcnt(11)
 ds_read_b64_tr_b16 a[198:199], v184 offset:6144
 v_mfma_f32_16x16x32_bf16 v[60:63], a[236:239], v[156:159], v[60:63]
 ds_read_b64_tr_b16 a[200:201], v184 offset:8192
 v_mfma_f32_16x16x32_bf16 v[56:59], a[236:239], v[124:127], v[56:59]
 s_waitcnt lgkmcnt(11)
 ds_read_b64_tr_b16 a[202:203], v184 offset:10240
 v_mfma_f32_16x16x32_bf16 v[56:59], a[240:243], v[128:131], v[56:59]
 ds_read_b64_tr_b16 a[204:205], v184 offset:12288
 v_mfma_f32_16x16x32_bf16 v[60:63], a[240:243], v[160:163], v[60:63]
 s_waitcnt lgkmcnt(11)
 ds_read_b64_tr_b16 a[206:207], v184 offset:14336
 v_mfma_f32_16x16x32_bf16 v[60:63], a[244:247], v[164:167], v[60:63]
 ds_read_b64_tr_b16 a[208:209], v185 offset:0
 v_mfma_f32_16x16x32_bf16 v[56:59], a[244:247], v[132:135], v[56:59]
 s_waitcnt lgkmcnt(11)
 ds_read_b64_tr_b16 a[210:211], v185 offset:2048
 v_mfma_f32_16x16x32_bf16 v[56:59], a[248:251], v[136:139], v[56:59]
 ds_read_b64_tr_b16 a[212:213], v185 offset:4096
 v_mfma_f32_16x16x32_bf16 v[60:63], a[248:251], v[168:171], v[60:63]
 s_waitcnt lgkmcnt(11)
 ds_read_b64_tr_b16 a[214:215], v185 offset:6144
 v_mfma_f32_16x16x32_bf16 v[60:63], a[252:255], v[172:175], v[60:63]
 ds_read_b64_tr_b16 a[216:217], v185 offset:8192
 v_mfma_f32_16x16x32_bf16 v[56:59], a[252:255], v[140:143], v[56:59]
 ds_read_b64_tr_b16 a[218:219], v185 offset:10240
 s_waitcnt lgkmcnt(12)
 v_mfma_f32_16x16x32_bf16 v[32:35], a[192:195], a[128:131], 0
 ds_read_b64_tr_b16 a[220:221], v185 offset:12288
 v_mfma_f32_16x16x32_bf16 v[36:39], a[192:195], a[144:147], 0
 s_waitcnt lgkmcnt(11)
 ds_read_b64_tr_b16 a[222:223], v185 offset:14336
 v_mfma_f32_16x16x32_bf16 v[36:39], a[196:199], a[148:151], v[36:39]
 ds_read_b64_tr_b16 a[224:225], v186 offset:0
 v_mfma_f32_16x16x32_bf16 v[32:35], a[196:199], a[132:135], v[32:35]
 s_waitcnt lgkmcnt(11)
 ds_read_b64_tr_b16 a[226:227], v186 offset:2048
 v_cvt_pk_bf16_f32 v72, v48, v49
 v_mfma_f32_16x16x32_bf16 v[32:35], a[200:203], a[136:139], v[32:35]
 ds_read_b64_tr_b16 a[228:229], v186 offset:4096
 v_cvt_pk_bf16_f32 v73, v50, v51
 v_mfma_f32_16x16x32_bf16 v[36:39], a[200:203], a[152:155], v[36:39]
 s_waitcnt lgkmcnt(11)
 ds_read_b64_tr_b16 a[230:231], v186 offset:6144
 v_cvt_pk_bf16_f32 v74, v56, v57
 v_mfma_f32_16x16x32_bf16 v[36:39], a[204:207], a[156:159], v[36:39]
 ds_read_b64_tr_b16 a[232:233], v186 offset:8192
 v_cvt_pk_bf16_f32 v75, v58, v59
 v_mfma_f32_16x16x32_bf16 v[32:35], a[204:207], a[140:143], v[32:35]
 s_waitcnt lgkmcnt(11)
 s_add_u32 s92, s8, 180224
 ds_read_b64_tr_b16 a[234:235], v186 offset:10240
 buffer_store_dwordx4 v[72:75], v21, s[36:39], s92 offen sc1
 v_mfma_f32_16x16x32_bf16 v[40:43], a[208:211], a[128:131], 0
 ds_read_b64_tr_b16 a[236:237], v186 offset:12288
 v_cvt_pk_bf16_f32 v76, v52, v53
 v_mfma_f32_16x16x32_bf16 v[44:47], a[208:211], a[144:147], 0
 s_waitcnt lgkmcnt(11)
 ds_read_b64_tr_b16 a[238:239], v186 offset:14336
 v_cvt_pk_bf16_f32 v77, v54, v55
 v_mfma_f32_16x16x32_bf16 v[44:47], a[212:215], a[148:151], v[44:47]
 ds_read_b64_tr_b16 a[240:241], v187 offset:0
 v_cvt_pk_bf16_f32 v78, v60, v61
 v_mfma_f32_16x16x32_bf16 v[40:43], a[212:215], a[132:135], v[40:43]
 s_waitcnt lgkmcnt(11)
 ds_read_b64_tr_b16 a[242:243], v187 offset:2048
 v_cvt_pk_bf16_f32 v79, v62, v63
 v_mfma_f32_16x16x32_bf16 v[40:43], a[216:219], a[136:139], v[40:43]
 ds_read_b64_tr_b16 a[244:245], v187 offset:4096
 v_mfma_f32_16x16x32_bf16 v[44:47], a[216:219], a[152:155], v[44:47]
 s_waitcnt lgkmcnt(11)
 ds_read_b64_tr_b16 a[246:247], v187 offset:6144
 v_mul_f32 v32, v32, v192
 v_mfma_f32_16x16x32_bf16 v[44:47], a[220:223], a[156:159], v[44:47]
 s_add_u32 s92, s9, 180224
 ds_read_b64_tr_b16 a[248:249], v187 offset:8192
 buffer_store_dwordx4 v[76:79], v21, s[36:39], s92 offen sc1
 v_mfma_f32_16x16x32_bf16 v[40:43], a[220:223], a[140:143], v[40:43]
 s_waitcnt lgkmcnt(11)
 ds_read_b64_tr_b16 a[250:251], v187 offset:10240
 v_mul_f32 v33, v33, v192
 v_mfma_f32_16x16x32_bf16 v[48:51], a[224:227], a[128:131], 0
 ds_read_b64_tr_b16 a[252:253], v187 offset:12288
 v_mul_f32 v34, v34, v192
 v_mfma_f32_16x16x32_bf16 v[52:55], a[224:227], a[144:147], 0
 s_waitcnt lgkmcnt(11)
 s_waitcnt vmcnt(9)
 s_barrier
 ds_read_b64_tr_b16 a[254:255], v187 offset:14336
 v_mfma_f32_16x16x32_bf16 v[52:55], a[228:231], a[148:151], v[52:55]
 ds_read_b64_tr_b16 a[192:193], v184 offset:16384
 v_mul_f32 v35, v35, v192
 v_mfma_f32_16x16x32_bf16 v[48:51], a[228:231], a[132:135], v[48:51]
 s_waitcnt lgkmcnt(11)
 ds_read_b64_tr_b16 a[194:195], v184 offset:18432
 v_mul_f32 v36, v36, v193
 v_mfma_f32_16x16x32_bf16 v[48:51], a[232:235], a[136:139], v[48:51]
 ds_read_b64_tr_b16 a[196:197], v184 offset:20480
 v_mul_f32 v37, v37, v193
 v_mfma_f32_16x16x32_bf16 v[52:55], a[232:235], a[152:155], v[52:55]
 s_waitcnt lgkmcnt(11)
 ds_read_b64_tr_b16 a[198:199], v184 offset:22528
 v_mul_f32 v38, v38, v193
 v_mfma_f32_16x16x32_bf16 v[52:55], a[236:239], a[156:159], v[52:55]
 ds_read_b64_tr_b16 a[200:201], v184 offset:24576
 v_mul_f32 v39, v39, v193
 v_mfma_f32_16x16x32_bf16 v[48:51], a[236:239], a[140:143], v[48:51]
 s_waitcnt lgkmcnt(11)
 ds_read_b64_tr_b16 a[202:203], v184 offset:26624
 v_mul_f32 v40, v40, v192
 v_mfma_f32_16x16x32_bf16 v[56:59], a[240:243], a[128:131], 0
 ds_read_b64_tr_b16 a[204:205], v184 offset:28672
 v_mul_f32 v41, v41, v192
 v_mfma_f32_16x16x32_bf16 v[60:63], a[240:243], a[144:147], 0
 s_waitcnt lgkmcnt(11)
 ds_read_b64_tr_b16 a[206:207], v184 offset:30720
 v_mul_f32 v42, v42, v192
 v_mfma_f32_16x16x32_bf16 v[60:63], a[244:247], a[148:151], v[60:63]
 ds_read_b64_tr_b16 a[208:209], v176 offset:0
 v_mul_f32 v43, v43, v192
 v_mfma_f32_16x16x32_bf16 v[56:59], a[244:247], a[132:135], v[56:59]
 s_waitcnt lgkmcnt(11)
 ds_read_b64_tr_b16 a[210:211], v176 offset:2048
 v_mul_f32 v44, v44, v193
 v_mfma_f32_16x16x32_bf16 v[56:59], a[248:251], a[136:139], v[56:59]
 ds_read_b64_tr_b16 a[212:213], v176 offset:4096
 v_mul_f32 v45, v45, v193
 v_mfma_f32_16x16x32_bf16 v[60:63], a[248:251], a[152:155], v[60:63]
 s_waitcnt lgkmcnt(11)
 ds_read_b64_tr_b16 a[214:215], v176 offset:6144
 v_mul_f32 v46, v46, v193
 v_mfma_f32_16x16x32_bf16 v[60:63], a[252:255], a[156:159], v[60:63]
 ds_read_b64_tr_b16 a[216:217], v176 offset:8192
 v_mul_f32 v47, v47, v193
 v_mfma_f32_16x16x32_bf16 v[56:59], a[252:255], a[140:143], v[56:59]
 s_waitcnt lgkmcnt(11)
 ds_read_b64_tr_b16 a[218:219], v176 offset:10240
 v_mul_f32 v48, v48, v192
 v_mfma_f32_16x16x32_bf16 v[32:35], a[192:195], v[112:115], v[32:35]
 ds_read_b64_tr_b16 a[220:221], v176 offset:12288
 v_mul_f32 v49, v49, v192
 v_mfma_f32_16x16x32_bf16 v[36:39], a[192:195], v[144:147], v[36:39]
 s_waitcnt lgkmcnt(11)
 ds_read_b64_tr_b16 a[222:223], v176 offset:14336
 v_mul_f32 v50, v50, v192
 v_mfma_f32_16x16x32_bf16 v[36:39], a[196:199], v[148:151], v[36:39]
 ds_read_b64_tr_b16 a[224:225], v185 offset:16384
 v_mul_f32 v51, v51, v192
 v_mfma_f32_16x16x32_bf16 v[32:35], a[196:199], v[116:119], v[32:35]
 s_waitcnt lgkmcnt(11)
 ds_read_b64_tr_b16 a[226:227], v185 offset:18432
 v_mul_f32 v52, v52, v193
 v_mfma_f32_16x16x32_bf16 v[32:35], a[200:203], v[120:123], v[32:35]
 ds_read_b64_tr_b16 a[228:229], v185 offset:20480
 v_mul_f32 v53, v53, v193
 v_mfma_f32_16x16x32_bf16 v[36:39], a[200:203], v[152:155], v[36:39]
 s_waitcnt lgkmcnt(11)
 ds_read_b64_tr_b16 a[230:231], v185 offset:22528
 v_mul_f32 v54, v54, v193
 v_mfma_f32_16x16x32_bf16 v[36:39], a[204:207], v[156:159], v[36:39]
 ds_read_b64_tr_b16 a[232:233], v185 offset:24576
 v_mul_f32 v55, v55, v193
 v_mfma_f32_16x16x32_bf16 v[32:35], a[204:207], v[124:127], v[32:35]
 s_waitcnt lgkmcnt(11)
 ds_read_b64_tr_b16 a[234:235], v185 offset:26624
 v_mul_f32 v56, v56, v192
 v_mfma_f32_16x16x32_bf16 v[32:35], a[208:211], v[128:131], v[32:35]
 ds_read_b64_tr_b16 a[236:237], v185 offset:28672
 v_mul_f32 v57, v57, v192
 v_mfma_f32_16x16x32_bf16 v[36:39], a[208:211], v[160:163], v[36:39]
 s_waitcnt lgkmcnt(11)
 ds_read_b64_tr_b16 a[238:239], v185 offset:30720
 v_mul_f32 v58, v58, v192
 v_mfma_f32_16x16x32_bf16 v[36:39], a[212:215], v[164:167], v[36:39]
 ds_read_b64_tr_b16 a[240:241], v177 offset:0
 v_mul_f32 v59, v59, v192
 v_mfma_f32_16x16x32_bf16 v[32:35], a[212:215], v[132:135], v[32:35]
 s_waitcnt lgkmcnt(11)
 ds_read_b64_tr_b16 a[242:243], v177 offset:2048
 v_mul_f32 v60, v60, v193
 v_mfma_f32_16x16x32_bf16 v[32:35], a[216:219], v[136:139], v[32:35]
 ds_read_b64_tr_b16 a[244:245], v177 offset:4096
 v_mul_f32 v61, v61, v193
 v_mfma_f32_16x16x32_bf16 v[36:39], a[216:219], v[168:171], v[36:39]
 s_waitcnt lgkmcnt(11)
 ds_read_b64_tr_b16 a[246:247], v177 offset:6144
 v_mul_f32 v62, v62, v193
 v_mfma_f32_16x16x32_bf16 v[36:39], a[220:223], v[172:175], v[36:39]
 ds_read_b64_tr_b16 a[248:249], v177 offset:8192
 v_mul_f32 v63, v63, v193
 v_mfma_f32_16x16x32_bf16 v[32:35], a[220:223], v[140:143], v[32:35]
 s_waitcnt lgkmcnt(11)
 ds_read_b64_tr_b16 a[250:251], v177 offset:10240
 v_mfma_f32_16x16x32_bf16 v[40:43], a[224:227], v[112:115], v[40:43]
 ds_read_b64_tr_b16 a[252:253], v177 offset:12288
 v_mfma_f32_16x16x32_bf16 v[44:47], a[224:227], v[144:147], v[44:47]
 s_waitcnt lgkmcnt(11)
 ds_read_b64_tr_b16 a[254:255], v177 offset:14336
 v_mfma_f32_16x16x32_bf16 v[44:47], a[228:231], v[148:151], v[44:47]
 ds_read_b64_tr_b16 a[192:193], v186 offset:16384
 v_mfma_f32_16x16x32_bf16 v[40:43], a[228:231], v[116:119], v[40:43]
 s_waitcnt lgkmcnt(11)
 ds_read_b64_tr_b16 a[194:195], v186 offset:18432
 v_mfma_f32_16x16x32_bf16 v[40:43], a[232:235], v[120:123], v[40:43]
 ds_read_b64_tr_b16 a[196:197], v186 offset:20480
 v_mfma_f32_16x16x32_bf16 v[44:47], a[232:235], v[152:155], v[44:47]
 s_waitcnt lgkmcnt(11)
 ds_read_b64_tr_b16 a[198:199], v186 offset:22528
 v_mfma_f32_16x16x32_bf16 v[44:47], a[236:239], v[156:159], v[44:47]
 ds_read_b64_tr_b16 a[200:201], v186 offset:24576
 v_mfma_f32_16x16x32_bf16 v[40:43], a[236:239], v[124:127], v[40:43]
 s_waitcnt lgkmcnt(11)
 ds_read_b64_tr_b16 a[202:203], v186 offset:26624
 v_mfma_f32_16x16x32_bf16 v[40:43], a[240:243], v[128:131], v[40:43]
 ds_read_b64_tr_b16 a[204:205], v186 offset:28672
 v_mfma_f32_16x16x32_bf16 v[44:47], a[240:243], v[160:163], v[44:47]
 s_waitcnt lgkmcnt(11)
 ds_read_b64_tr_b16 a[206:207], v186 offset:30720
 v_mfma_f32_16x16x32_bf16 v[44:47], a[244:247], v[164:167], v[44:47]
 ds_read_b64_tr_b16 a[208:209], v178 offset:0
 v_mfma_f32_16x16x32_bf16 v[40:43], a[244:247], v[132:135], v[40:43]
 s_waitcnt lgkmcnt(11)
 ds_read_b64_tr_b16 a[210:211], v178 offset:2048
 v_mfma_f32_16x16x32_bf16 v[40:43], a[248:251], v[136:139], v[40:43]
 ds_read_b64_tr_b16 a[212:213], v178 offset:4096
 v_mfma_f32_16x16x32_bf16 v[44:47], a[248:251], v[168:171], v[44:47]
 s_waitcnt lgkmcnt(11)
 ds_read_b64_tr_b16 a[214:215], v178 offset:6144
 v_mfma_f32_16x16x32_bf16 v[44:47], a[252:255], v[172:175], v[44:47]
 ds_read_b64_tr_b16 a[216:217], v178 offset:8192
 v_mfma_f32_16x16x32_bf16 v[40:43], a[252:255], v[140:143], v[40:43]
 s_waitcnt lgkmcnt(11)
 ds_read_b64_tr_b16 a[218:219], v178 offset:10240
 v_mfma_f32_16x16x32_bf16 v[48:51], a[192:195], v[112:115], v[48:51]
 ds_read_b64_tr_b16 a[220:221], v178 offset:12288
 v_mfma_f32_16x16x32_bf16 v[52:55], a[192:195], v[144:147], v[52:55]
 s_waitcnt lgkmcnt(11)
 ds_read_b64_tr_b16 a[222:223], v178 offset:14336
 v_mfma_f32_16x16x32_bf16 v[52:55], a[196:199], v[148:151], v[52:55]
 ds_read_b64_tr_b16 a[224:225], v187 offset:16384
 v_mfma_f32_16x16x32_bf16 v[48:51], a[196:199], v[116:119], v[48:51]
 s_waitcnt lgkmcnt(11)
 ds_read_b64_tr_b16 a[226:227], v187 offset:18432
 v_mfma_f32_16x16x32_bf16 v[48:51], a[200:203], v[120:123], v[48:51]
 ds_read_b64_tr_b16 a[228:229], v187 offset:20480
 v_cvt_pk_bf16_f32 v64, v32, v33
 v_mfma_f32_16x16x32_bf16 v[52:55], a[200:203], v[152:155], v[52:55]
 s_waitcnt lgkmcnt(11)
 ds_read_b64_tr_b16 a[230:231], v187 offset:22528
 v_cvt_pk_bf16_f32 v65, v34, v35
 v_mfma_f32_16x16x32_bf16 v[52:55], a[204:207], v[156:159], v[52:55]
 ds_read_b64_tr_b16 a[232:233], v187 offset:24576
 v_cvt_pk_bf16_f32 v66, v40, v41
 v_mfma_f32_16x16x32_bf16 v[48:51], a[204:207], v[124:127], v[48:51]
 s_waitcnt lgkmcnt(11)
 ds_read_b64_tr_b16 a[234:235], v187 offset:26624
 v_cvt_pk_bf16_f32 v67, v42, v43
 v_mfma_f32_16x16x32_bf16 v[48:51], a[208:211], v[128:131], v[48:51]
 s_add_u32 s92, s8, 196608
 ds_read_b64_tr_b16 a[236:237], v187 offset:28672
 buffer_store_dwordx4 v[64:67], v21, s[36:39], s92 offen sc1
 v_mfma_f32_16x16x32_bf16 v[52:55], a[208:211], v[160:163], v[52:55]
 s_waitcnt lgkmcnt(11)
 ds_read_b64_tr_b16 a[238:239], v187 offset:30720
 v_cvt_pk_bf16_f32 v68, v36, v37
 v_mfma_f32_16x16x32_bf16 v[52:55], a[212:215], v[164:167], v[52:55]
 ds_read_b64_tr_b16 a[240:241], v179 offset:0
 v_cvt_pk_bf16_f32 v69, v38, v39
 v_mfma_f32_16x16x32_bf16 v[48:51], a[212:215], v[132:135], v[48:51]
 s_waitcnt lgkmcnt(11)
 ds_read_b64_tr_b16 a[242:243], v179 offset:2048
 v_cvt_pk_bf16_f32 v70, v44, v45
 v_mfma_f32_16x16x32_bf16 v[48:51], a[216:219], v[136:139], v[48:51]
 ds_read_b64_tr_b16 a[244:245], v179 offset:4096
 v_cvt_pk_bf16_f32 v71, v46, v47
 v_mfma_f32_16x16x32_bf16 v[52:55], a[216:219], v[168:171], v[52:55]
 s_waitcnt lgkmcnt(11)
 s_add_u32 s92, s9, 196608
 ds_read_b64_tr_b16 a[246:247], v179 offset:6144
 buffer_store_dwordx4 v[68:71], v21, s[36:39], s92 offen sc1
 v_mfma_f32_16x16x32_bf16 v[52:55], a[220:223], v[172:175], v[52:55]
 ds_read_b64_tr_b16 a[248:249], v179 offset:8192
 v_mfma_f32_16x16x32_bf16 v[48:51], a[220:223], v[140:143], v[48:51]
 s_waitcnt lgkmcnt(11)
 ds_read_b64_tr_b16 a[250:251], v179 offset:10240
 v_mfma_f32_16x16x32_bf16 v[56:59], a[224:227], v[112:115], v[56:59]
 ds_read_b64_tr_b16 a[252:253], v179 offset:12288
 v_mfma_f32_16x16x32_bf16 v[60:63], a[224:227], v[144:147], v[60:63]
 s_waitcnt lgkmcnt(11)
 ds_read_b64_tr_b16 a[254:255], v179 offset:14336
 v_mfma_f32_16x16x32_bf16 v[60:63], a[228:231], v[148:151], v[60:63]
 v_mfma_f32_16x16x32_bf16 v[56:59], a[228:231], v[116:119], v[56:59]
 s_waitcnt lgkmcnt(10)
 v_mfma_f32_16x16x32_bf16 v[56:59], a[232:235], v[120:123], v[56:59]
 buffer_load_dwordx2 v[22:23], v30, s[36:39], 0 offen sc1
 v_mfma_f32_16x16x32_bf16 v[60:63], a[232:235], v[152:155], v[60:63]
 s_waitcnt lgkmcnt(8)
 v_mfma_f32_16x16x32_bf16 v[60:63], a[236:239], v[156:159], v[60:63]
 v_mfma_f32_16x16x32_bf16 v[56:59], a[236:239], v[124:127], v[56:59]
 s_waitcnt lgkmcnt(6)
 v_mfma_f32_16x16x32_bf16 v[56:59], a[240:243], v[128:131], v[56:59]
 v_mfma_f32_16x16x32_bf16 v[60:63], a[240:243], v[160:163], v[60:63]
 s_waitcnt lgkmcnt(4)
 v_mfma_f32_16x16x32_bf16 v[60:63], a[244:247], v[164:167], v[60:63]
 v_mfma_f32_16x16x32_bf16 v[56:59], a[244:247], v[132:135], v[56:59]
 s_waitcnt lgkmcnt(2)
 v_mfma_f32_16x16x32_bf16 v[56:59], a[248:251], v[136:139], v[56:59]
 v_mfma_f32_16x16x32_bf16 v[60:63], a[248:251], v[168:171], v[60:63]
 s_waitcnt lgkmcnt(0)
 v_mfma_f32_16x16x32_bf16 v[60:63], a[252:255], v[172:175], v[60:63]
 v_mfma_f32_16x16x32_bf16 v[56:59], a[252:255], v[140:143], v[56:59]
 s_nop 7
 v_cvt_pk_bf16_f32 v72, v48, v49
 v_cvt_pk_bf16_f32 v73, v50, v51
 v_cvt_pk_bf16_f32 v74, v56, v57
 v_cvt_pk_bf16_f32 v75, v58, v59
 s_add_u32 s92, s8, 212992
 buffer_store_dwordx4 v[72:75], v21, s[36:39], s92 offen sc1
 v_cvt_pk_bf16_f32 v76, v52, v53
 v_cvt_pk_bf16_f32 v77, v54, v55
 v_cvt_pk_bf16_f32 v78, v60, v61
 v_cvt_pk_bf16_f32 v79, v62, v63
 s_add_u32 s92, s9, 212992
 buffer_store_dwordx4 v[76:79], v21, s[36:39], s92 offen sc1
 s_branch gated_mix__compressed_kv_cla__glu_gated_swiglu__prompt_kernel_p4e
gated_mix__compressed_kv_cla__glu_gated_swiglu__prompt_kernel_p4s:
 s_waitcnt vmcnt(12)
 s_barrier
 ds_read_b64_tr_b16 a[192:193], v176 offset:0
 ds_read_b64_tr_b16 a[194:195], v176 offset:2048
 ds_read_b64_tr_b16 a[196:197], v176 offset:4096
 ds_read_b64_tr_b16 a[198:199], v176 offset:6144
 ds_read_b64_tr_b16 a[200:201], v176 offset:8192
 ds_read_b64_tr_b16 a[202:203], v176 offset:10240
 ds_read_b64_tr_b16 a[204:205], v177 offset:0
 ds_read_b64_tr_b16 a[206:207], v177 offset:2048
 ds_read_b64_tr_b16 a[208:209], v177 offset:4096
 ds_read_b64_tr_b16 a[210:211], v177 offset:6144
 ds_read_b64_tr_b16 a[212:213], v177 offset:8192
 ds_read_b64_tr_b16 a[214:215], v177 offset:10240
 ds_read_b64_tr_b16 a[216:217], v178 offset:0
 ds_read_b64_tr_b16 a[218:219], v178 offset:2048
 s_waitcnt lgkmcnt(12)
 v_mfma_f32_16x16x32_bf16 v[32:35], a[192:195], a[128:131], 0
 s_add_u32 m0, s76, 65536
 s_add_u32 s91, s6, 128
 ds_read_b64_tr_b16 a[220:221], v178 offset:4096
 v_mfma_f32_16x16x32_bf16 v[36:39], a[192:195], a[144:147], 0
 s_waitcnt lgkmcnt(11)
 ds_read_b64_tr_b16 a[222:223], v178 offset:6144
 buffer_load_dwordx4 v10, s[56:59], s91 offen offset:0 lds
 v_mfma_f32_16x16x32_bf16 v[36:39], a[196:199], a[148:151], v[36:39]
 ds_read_b64_tr_b16 a[224:225], v178 offset:8192
 v_mfma_f32_16x16x32_bf16 v[32:35], a[196:199], a[132:135], v[32:35]
 s_waitcnt lgkmcnt(11)
 ds_read_b64_tr_b16 a[226:227], v178 offset:10240
 v_mfma_f32_16x16x32_bf16 v[32:35], a[200:203], a[136:139], v[32:35]
 ds_read_b64_tr_b16 a[228:229], v179 offset:0
 buffer_load_dwordx4 v11, s[56:59], s91 offen offset:1024 lds
 v_mfma_f32_16x16x32_bf16 v[36:39], a[200:203], a[152:155], v[36:39]
 s_waitcnt lgkmcnt(11)
 ds_read_b64_tr_b16 a[230:231], v179 offset:2048
 v_mfma_f32_16x16x32_bf16 v[44:47], a[204:207], a[144:147], 0
 ds_read_b64_tr_b16 a[232:233], v179 offset:4096
 v_mfma_f32_16x16x32_bf16 v[40:43], a[204:207], a[128:131], 0
 s_waitcnt lgkmcnt(11)
 ds_read_b64_tr_b16 a[234:235], v179 offset:6144
 v_mfma_f32_16x16x32_bf16 v[40:43], a[208:211], a[132:135], v[40:43]
 ds_read_b64_tr_b16 a[236:237], v179 offset:8192
 buffer_load_dwordx4 v12, s[56:59], s91 offen offset:2048 lds
 v_mfma_f32_16x16x32_bf16 v[44:47], a[208:211], a[148:151], v[44:47]
 s_waitcnt lgkmcnt(11)
 s_waitcnt vmcnt(3)
 s_barrier
 ds_read_b64_tr_b16 a[238:239], v179 offset:10240
 v_mfma_f32_16x16x32_bf16 v[44:47], a[212:215], a[152:155], v[44:47]
 ds_read_b64_tr_b16 a[240:241], v176 offset:16384
 v_mfma_f32_16x16x32_bf16 v[40:43], a[212:215], a[136:139], v[40:43]
 s_waitcnt lgkmcnt(11)
 ds_read_b64_tr_b16 a[242:243], v176 offset:18432
 buffer_load_dwordx4 v13, s[56:59], s91 offen offset:3072 lds
 v_mfma_f32_16x16x32_bf16 v[48:51], a[216:219], a[128:131], 0
 ds_read_b64_tr_b16 a[244:245], v176 offset:20480
 v_mul_f32 v32, v32, v192
 v_mfma_f32_16x16x32_bf16 v[52:55], a[216:219], a[144:147], 0
 s_waitcnt lgkmcnt(11)
 ds_read_b64_tr_b16 a[246:247], v176 offset:22528
 v_mul_f32 v33, v33, v192
 v_mfma_f32_16x16x32_bf16 v[52:55], a[220:223], a[148:151], v[52:55]
 s_add_u32 m0, s76, 81920
 s_add_u32 s91, s6, 114816
 ds_read_b64_tr_b16 a[248:249], v176 offset:24576
 v_mul_f32 v34, v34, v192
 v_mfma_f32_16x16x32_bf16 v[48:51], a[220:223], a[132:135], v[48:51]
 s_waitcnt lgkmcnt(11)
 ds_read_b64_tr_b16 a[250:251], v176 offset:26624
 buffer_load_dwordx4 v10, s[56:59], s91 offen offset:0 lds
 v_mfma_f32_16x16x32_bf16 v[48:51], a[224:227], a[136:139], v[48:51]
 ds_read_b64_tr_b16 a[252:253], v176 offset:28672
 v_mul_f32 v35, v35, v192
 v_mfma_f32_16x16x32_bf16 v[52:55], a[224:227], a[152:155], v[52:55]
 s_waitcnt lgkmcnt(11)
 ds_read_b64_tr_b16 a[254:255], v176 offset:30720
 v_mul_f32 v36, v36, v193
 v_mfma_f32_16x16x32_bf16 v[60:63], a[228:231], a[144:147], 0
 ds_read_b64_tr_b16 a[192:193], v176 offset:32768
 buffer_load_dwordx4 v11, s[56:59], s91 offen offset:1024 lds
 v_mfma_f32_16x16x32_bf16 v[56:59], a[228:231], a[128:131], 0
 s_waitcnt lgkmcnt(11)
 ds_read_b64_tr_b16 a[194:195], v176 offset:34816
 v_mul_f32 v37, v37, v193
 v_mfma_f32_16x16x32_bf16 v[56:59], a[232:235], a[132:135], v[56:59]
 ds_read_b64_tr_b16 a[196:197], v176 offset:36864
 v_mul_f32 v38, v38, v193
 v_mfma_f32_16x16x32_bf16 v[60:63], a[232:235], a[148:151], v[60:63]
 s_waitcnt lgkmcnt(11)
 ds_read_b64_tr_b16 a[198:199], v176 offset:38912
 v_mul_f32 v39, v39, v193
 v_mfma_f32_16x16x32_bf16 v[60:63], a[236:239], a[152:155], v[60:63]
 ds_read_b64_tr_b16 a[200:201], v176 offset:40960
 buffer_load_dwordx4 v12, s[56:59], s91 offen offset:2048 lds
 v_mfma_f32_16x16x32_bf16 v[56:59], a[236:239], a[136:139], v[56:59]
 s_waitcnt lgkmcnt(11)
 ds_read_b64_tr_b16 a[202:203], v176 offset:43008
 v_mul_f32 v40, v40, v192
 v_mfma_f32_16x16x32_bf16 v[32:35], a[240:243], v[112:115], v[32:35]
 ds_read_b64_tr_b16 a[204:205], v176 offset:45056
 v_mul_f32 v41, v41, v192
 v_mfma_f32_16x16x32_bf16 v[36:39], a[240:243], v[144:147], v[36:39]
 s_waitcnt lgkmcnt(11)
 ds_read_b64_tr_b16 a[206:207], v176 offset:47104
 buffer_load_dwordx4 v13, s[56:59], s91 offen offset:3072 lds
 v_mfma_f32_16x16x32_bf16 v[36:39], a[244:247], v[148:151], v[36:39]
 ds_read_b64_tr_b16 a[208:209], v177 offset:16384
 v_mul_f32 v42, v42, v192
 v_mfma_f32_16x16x32_bf16 v[32:35], a[244:247], v[116:119], v[32:35]
 s_waitcnt lgkmcnt(11)
 ds_read_b64_tr_b16 a[210:211], v177 offset:18432
 v_mul_f32 v43, v43, v192
 v_mfma_f32_16x16x32_bf16 v[32:35], a[248:251], v[120:123], v[32:35]
 s_add_u32 m0, s76, 98304
 s_add_u32 s91, s7, 256
 ds_read_b64_tr_b16 a[212:213], v177 offset:20480
 v_mul_f32 v44, v44, v193
 v_mfma_f32_16x16x32_bf16 v[36:39], a[248:251], v[152:155], v[36:39]
 s_waitcnt lgkmcnt(11)
 ds_read_b64_tr_b16 a[214:215], v177 offset:22528
 buffer_load_dwordx4 v10, s[60:63], s91 offen offset:0 lds
 v_mfma_f32_16x16x32_bf16 v[36:39], a[252:255], v[156:159], v[36:39]
 ds_read_b64_tr_b16 a[216:217], v177 offset:24576
 v_mul_f32 v45, v45, v193
 v_mfma_f32_16x16x32_bf16 v[32:35], a[252:255], v[124:127], v[32:35]
 s_waitcnt lgkmcnt(11)
 ds_read_b64_tr_b16 a[218:219], v177 offset:26624
 v_mul_f32 v46, v46, v193
 v_mfma_f32_16x16x32_bf16 v[32:35], a[192:195], v[128:131], v[32:35]
 ds_read_b64_tr_b16 a[220:221], v177 offset:28672
 buffer_load_dwordx4 v11, s[60:63], s91 offen offset:1024 lds
 v_mfma_f32_16x16x32_bf16 v[36:39], a[192:195], v[160:163], v[36:39]
 s_waitcnt lgkmcnt(11)
 ds_read_b64_tr_b16 a[222:223], v177 offset:30720
 v_mul_f32 v47, v47, v193
 v_mfma_f32_16x16x32_bf16 v[36:39], a[196:199], v[164:167], v[36:39]
 ds_read_b64_tr_b16 a[224:225], v177 offset:32768
 v_mul_f32 v48, v48, v192
 v_mfma_f32_16x16x32_bf16 v[32:35], a[196:199], v[132:135], v[32:35]
 s_waitcnt lgkmcnt(11)
 ds_read_b64_tr_b16 a[226:227], v177 offset:34816
 v_mul_f32 v49, v49, v192
 v_mfma_f32_16x16x32_bf16 v[32:35], a[200:203], v[136:139], v[32:35]
 ds_read_b64_tr_b16 a[228:229], v177 offset:36864
 buffer_load_dwordx4 v12, s[60:63], s91 offen offset:2048 lds
 v_mfma_f32_16x16x32_bf16 v[36:39], a[200:203], v[168:171], v[36:39]
 s_waitcnt lgkmcnt(11)
 ds_read_b64_tr_b16 a[230:231], v177 offset:38912
 v_mul_f32 v50, v50, v192
 v_mfma_f32_16x16x32_bf16 v[36:39], a[204:207], v[172:175], v[36:39]
 ds_read_b64_tr_b16 a[232:233], v177 offset:40960
 v_mul_f32 v51, v51, v192
 v_mfma_f32_16x16x32_bf16 v[32:35], a[204:207], v[140:143], v[32:35]
 s_waitcnt lgkmcnt(11)
 ds_read_b64_tr_b16 a[234:235], v177 offset:43008
 buffer_load_dwordx4 v13, s[60:63], s91 offen offset:3072 lds
 v_mfma_f32_16x16x32_bf16 v[40:43], a[208:211], v[112:115], v[40:43]
 ds_read_b64_tr_b16 a[236:237], v177 offset:45056
 v_mul_f32 v52, v52, v193
 v_mfma_f32_16x16x32_bf16 v[44:47], a[208:211], v[144:147], v[44:47]
 s_waitcnt lgkmcnt(11)
 ds_read_b64_tr_b16 a[238:239], v177 offset:47104
 v_mul_f32 v53, v53, v193
 v_mfma_f32_16x16x32_bf16 v[44:47], a[212:215], v[148:151], v[44:47]
 s_add_u32 m0, s76, 114688
 s_add_u32 s91, s6, 256
 ds_read_b64_tr_b16 a[240:241], v178 offset:16384
 v_mul_f32 v54, v54, v193
 v_mfma_f32_16x16x32_bf16 v[40:43], a[212:215], v[116:119], v[40:43]
 s_waitcnt lgkmcnt(11)
 ds_read_b64_tr_b16 a[242:243], v178 offset:18432
 buffer_load_dwordx4 v10, s[56:59], s91 offen offset:0 lds
 v_mfma_f32_16x16x32_bf16 v[40:43], a[216:219], v[120:123], v[40:43]
 ds_read_b64_tr_b16 a[244:245], v178 offset:20480
 v_mul_f32 v55, v55, v193
 v_mfma_f32_16x16x32_bf16 v[44:47], a[216:219], v[152:155], v[44:47]
 s_waitcnt lgkmcnt(11)
 ds_read_b64_tr_b16 a[246:247], v178 offset:22528
 v_mul_f32 v56, v56, v192
 v_mfma_f32_16x16x32_bf16 v[44:47], a[220:223], v[156:159], v[44:47]
 ds_read_b64_tr_b16 a[248:249], v178 offset:24576
 buffer_load_dwordx4 v11, s[56:59], s91 offen offset:1024 lds
 v_mfma_f32_16x16x32_bf16 v[40:43], a[220:223], v[124:127], v[40:43]
 s_waitcnt lgkmcnt(11)
 ds_read_b64_tr_b16 a[250:251], v178 offset:26624
 v_mul_f32 v57, v57, v192
 v_mfma_f32_16x16x32_bf16 v[40:43], a[224:227], v[128:131], v[40:43]
 ds_read_b64_tr_b16 a[252:253], v178 offset:28672
 v_mul_f32 v58, v58, v192
 v_mfma_f32_16x16x32_bf16 v[44:47], a[224:227], v[160:163], v[44:47]
 s_waitcnt lgkmcnt(11)
 ds_read_b64_tr_b16 a[254:255], v178 offset:30720
 v_mul_f32 v59, v59, v192
 v_mfma_f32_16x16x32_bf16 v[44:47], a[228:231], v[164:167], v[44:47]
 ds_read_b64_tr_b16 a[192:193], v178 offset:32768
 buffer_load_dwordx4 v12, s[56:59], s91 offen offset:2048 lds
 v_mfma_f32_16x16x32_bf16 v[40:43], a[228:231], v[132:135], v[40:43]
 s_waitcnt lgkmcnt(11)
 ds_read_b64_tr_b16 a[194:195], v178 offset:34816
 v_mul_f32 v60, v60, v193
 v_mfma_f32_16x16x32_bf16 v[40:43], a[232:235], v[136:139], v[40:43]
 ds_read_b64_tr_b16 a[196:197], v178 offset:36864
 v_mul_f32 v61, v61, v193
 v_mfma_f32_16x16x32_bf16 v[44:47], a[232:235], v[168:171], v[44:47]
 s_waitcnt lgkmcnt(11)
 ds_read_b64_tr_b16 a[198:199], v178 offset:38912
 buffer_load_dwordx4 v13, s[56:59], s91 offen offset:3072 lds
 v_mfma_f32_16x16x32_bf16 v[44:47], a[236:239], v[172:175], v[44:47]
 ds_read_b64_tr_b16 a[200:201], v178 offset:40960
 v_mul_f32 v62, v62, v193
 v_mfma_f32_16x16x32_bf16 v[40:43], a[236:239], v[140:143], v[40:43]
 s_waitcnt lgkmcnt(11)
 ds_read_b64_tr_b16 a[202:203], v178 offset:43008
 v_mul_f32 v63, v63, v193
 v_mfma_f32_16x16x32_bf16 v[48:51], a[240:243], v[112:115], v[48:51]
 s_add_u32 m0, s76, 131072
 s_add_u32 s91, s6, 114944
 ds_read_b64_tr_b16 a[204:205], v178 offset:45056
 v_mfma_f32_16x16x32_bf16 v[52:55], a[240:243], v[144:147], v[52:55]
 s_waitcnt lgkmcnt(11)
 ds_read_b64_tr_b16 a[206:207], v178 offset:47104
 buffer_load_dwordx4 v10, s[56:59], s91 offen offset:0 lds
 v_mfma_f32_16x16x32_bf16 v[52:55], a[244:247], v[148:151], v[52:55]
 ds_read_b64_tr_b16 a[208:209], v179 offset:16384
 v_mfma_f32_16x16x32_bf16 v[48:51], a[244:247], v[116:119], v[48:51]
 s_waitcnt lgkmcnt(11)
 ds_read_b64_tr_b16 a[210:211], v179 offset:18432
 v_mfma_f32_16x16x32_bf16 v[48:51], a[248:251], v[120:123], v[48:51]
 ds_read_b64_tr_b16 a[212:213], v179 offset:20480
 buffer_load_dwordx4 v11, s[56:59], s91 offen offset:1024 lds
 v_mfma_f32_16x16x32_bf16 v[52:55], a[248:251], v[152:155], v[52:55]
 s_waitcnt lgkmcnt(11)
 ds_read_b64_tr_b16 a[214:215], v179 offset:22528
 v_cvt_pk_bf16_f32 v64, v32, v33
 v_mfma_f32_16x16x32_bf16 v[52:55], a[252:255], v[156:159], v[52:55]
 ds_read_b64_tr_b16 a[216:217], v179 offset:24576
 v_cvt_pk_bf16_f32 v65, v34, v35
 v_mfma_f32_16x16x32_bf16 v[48:51], a[252:255], v[124:127], v[48:51]
 s_waitcnt lgkmcnt(11)
 ds_read_b64_tr_b16 a[218:219], v179 offset:26624
 v_cvt_pk_bf16_f32 v66, v40, v41
 v_mfma_f32_16x16x32_bf16 v[48:51], a[192:195], v[128:131], v[48:51]
 ds_read_b64_tr_b16 a[220:221], v179 offset:28672
 buffer_load_dwordx4 v12, s[56:59], s91 offen offset:2048 lds
 v_mfma_f32_16x16x32_bf16 v[52:55], a[192:195], v[160:163], v[52:55]
 s_waitcnt lgkmcnt(11)
 ds_read_b64_tr_b16 a[222:223], v179 offset:30720
 v_cvt_pk_bf16_f32 v67, v42, v43
 v_mfma_f32_16x16x32_bf16 v[52:55], a[196:199], v[164:167], v[52:55]
 s_add_u32 s92, s8, 0
 ds_read_b64_tr_b16 a[224:225], v179 offset:32768
 buffer_store_dwordx4 v[64:67], v21, s[36:39], s92 offen sc1
 v_mfma_f32_16x16x32_bf16 v[48:51], a[196:199], v[132:135], v[48:51]
 s_waitcnt lgkmcnt(11)
 ds_read_b64_tr_b16 a[226:227], v179 offset:34816
 buffer_load_dwordx4 v13, s[56:59], s91 offen offset:3072 lds
 v_mfma_f32_16x16x32_bf16 v[48:51], a[200:203], v[136:139], v[48:51]
 ds_read_b64_tr_b16 a[228:229], v179 offset:36864
 v_cvt_pk_bf16_f32 v68, v36, v37
 v_mfma_f32_16x16x32_bf16 v[52:55], a[200:203], v[168:171], v[52:55]
 s_waitcnt lgkmcnt(11)
 ds_read_b64_tr_b16 a[230:231], v179 offset:38912
 v_cvt_pk_bf16_f32 v69, v38, v39
 v_mfma_f32_16x16x32_bf16 v[52:55], a[204:207], v[172:175], v[52:55]
 s_add_u32 m0, s76, 147456
 s_add_u32 s91, s7, 384
 ds_read_b64_tr_b16 a[232:233], v179 offset:40960
 v_cvt_pk_bf16_f32 v70, v44, v45
 v_mfma_f32_16x16x32_bf16 v[48:51], a[204:207], v[140:143], v[48:51]
 s_waitcnt lgkmcnt(11)
 ds_read_b64_tr_b16 a[234:235], v179 offset:43008
 buffer_load_dwordx4 v10, s[60:63], s91 offen offset:0 lds
 v_mfma_f32_16x16x32_bf16 v[56:59], a[208:211], v[112:115], v[56:59]
 ds_read_b64_tr_b16 a[236:237], v179 offset:45056
 v_cvt_pk_bf16_f32 v71, v46, v47
 v_mfma_f32_16x16x32_bf16 v[60:63], a[208:211], v[144:147], v[60:63]
 s_waitcnt lgkmcnt(11)
 s_add_u32 s92, s9, 0
 ds_read_b64_tr_b16 a[238:239], v179 offset:47104
 buffer_store_dwordx4 v[68:71], v21, s[36:39], s92 offen sc1
 v_mfma_f32_16x16x32_bf16 v[60:63], a[212:215], v[148:151], v[60:63]
 ds_read_b64_tr_b16 a[240:241], v176 offset:49152
 buffer_load_dwordx4 v11, s[60:63], s91 offen offset:1024 lds
 v_mfma_f32_16x16x32_bf16 v[56:59], a[212:215], v[116:119], v[56:59]
 s_waitcnt lgkmcnt(11)
 ds_read_b64_tr_b16 a[242:243], v176 offset:51200
 v_mfma_f32_16x16x32_bf16 v[56:59], a[216:219], v[120:123], v[56:59]
 ds_read_b64_tr_b16 a[244:245], v176 offset:53248
 v_mfma_f32_16x16x32_bf16 v[60:63], a[216:219], v[152:155], v[60:63]
 s_waitcnt lgkmcnt(11)
 ds_read_b64_tr_b16 a[246:247], v176 offset:55296
 v_mfma_f32_16x16x32_bf16 v[60:63], a[220:223], v[156:159], v[60:63]
 ds_read_b64_tr_b16 a[248:249], v176 offset:57344
 buffer_load_dwordx4 v12, s[60:63], s91 offen offset:2048 lds
 v_mfma_f32_16x16x32_bf16 v[56:59], a[220:223], v[124:127], v[56:59]
 s_waitcnt lgkmcnt(11)
 ds_read_b64_tr_b16 a[250:251], v176 offset:59392
 v_mfma_f32_16x16x32_bf16 v[56:59], a[224:227], v[128:131], v[56:59]
 ds_read_b64_tr_b16 a[252:253], v177 offset:49152
 v_mfma_f32_16x16x32_bf16 v[60:63], a[224:227], v[160:163], v[60:63]
 s_waitcnt lgkmcnt(11)
 ds_read_b64_tr_b16 a[254:255], v177 offset:51200
 buffer_load_dwordx4 v13, s[60:63], s91 offen offset:3072 lds
 v_mfma_f32_16x16x32_bf16 v[60:63], a[228:231], v[164:167], v[60:63]
 ds_read_b64_tr_b16 a[192:193], v177 offset:53248
 v_mfma_f32_16x16x32_bf16 v[56:59], a[228:231], v[132:135], v[56:59]
 s_waitcnt lgkmcnt(11)
 ds_read_b64_tr_b16 a[194:195], v177 offset:55296
 v_mfma_f32_16x16x32_bf16 v[56:59], a[232:235], v[136:139], v[56:59]
 ds_read_b64_tr_b16 a[196:197], v177 offset:57344
 v_mfma_f32_16x16x32_bf16 v[60:63], a[232:235], v[168:171], v[60:63]
 s_waitcnt lgkmcnt(11)
 ds_read_b64_tr_b16 a[198:199], v177 offset:59392
 v_mfma_f32_16x16x32_bf16 v[60:63], a[236:239], v[172:175], v[60:63]
 ds_read_b64_tr_b16 a[200:201], v178 offset:49152
 v_mfma_f32_16x16x32_bf16 v[56:59], a[236:239], v[140:143], v[56:59]
 ds_read_b64_tr_b16 a[202:203], v178 offset:51200
 s_waitcnt lgkmcnt(12)
 v_mfma_f32_16x16x32_bf16 v[32:35], a[240:243], a[128:131], 0
 ds_read_b64_tr_b16 a[204:205], v178 offset:53248
 v_mfma_f32_16x16x32_bf16 v[36:39], a[240:243], a[144:147], 0
 s_waitcnt lgkmcnt(11)
 ds_read_b64_tr_b16 a[206:207], v178 offset:55296
 v_cvt_pk_bf16_f32 v72, v48, v49
 v_mfma_f32_16x16x32_bf16 v[36:39], a[244:247], a[148:151], v[36:39]
 ds_read_b64_tr_b16 a[208:209], v178 offset:57344
 v_cvt_pk_bf16_f32 v73, v50, v51
 v_mfma_f32_16x16x32_bf16 v[32:35], a[244:247], a[132:135], v[32:35]
 s_waitcnt lgkmcnt(11)
 ds_read_b64_tr_b16 a[210:211], v178 offset:59392
 v_cvt_pk_bf16_f32 v74, v56, v57
 v_mfma_f32_16x16x32_bf16 v[32:35], a[248:251], a[136:139], v[32:35]
 ds_read_b64_tr_b16 a[212:213], v179 offset:49152
 v_cvt_pk_bf16_f32 v75, v58, v59
 v_mfma_f32_16x16x32_bf16 v[36:39], a[248:251], a[152:155], v[36:39]
 s_waitcnt lgkmcnt(11)
 s_add_u32 s92, s8, 16384
 ds_read_b64_tr_b16 a[214:215], v179 offset:51200
 buffer_store_dwordx4 v[72:75], v21, s[36:39], s92 offen sc1
 v_mfma_f32_16x16x32_bf16 v[44:47], a[252:255], a[144:147], 0
 ds_read_b64_tr_b16 a[216:217], v179 offset:53248
 v_cvt_pk_bf16_f32 v76, v52, v53
 v_mfma_f32_16x16x32_bf16 v[40:43], a[252:255], a[128:131], 0
 s_waitcnt lgkmcnt(11)
 ds_read_b64_tr_b16 a[218:219], v179 offset:55296
 v_cvt_pk_bf16_f32 v77, v54, v55
 v_mfma_f32_16x16x32_bf16 v[40:43], a[192:195], a[132:135], v[40:43]
 ds_read_b64_tr_b16 a[220:221], v179 offset:57344
 v_cvt_pk_bf16_f32 v78, v60, v61
 v_mfma_f32_16x16x32_bf16 v[44:47], a[192:195], a[148:151], v[44:47]
 s_waitcnt lgkmcnt(11)
 s_waitcnt vmcnt(15)
 s_barrier
 ds_read_b64_tr_b16 a[222:223], v179 offset:59392
 v_mfma_f32_16x16x32_bf16 v[44:47], a[196:199], a[152:155], v[44:47]
 ds_read_b64_tr_b16 a[224:225], v180 offset:0
 v_cvt_pk_bf16_f32 v79, v62, v63
 v_mfma_f32_16x16x32_bf16 v[40:43], a[196:199], a[136:139], v[40:43]
 s_waitcnt lgkmcnt(11)
 s_add_u32 s92, s9, 16384
 ds_read_b64_tr_b16 a[226:227], v180 offset:2048
 buffer_store_dwordx4 v[76:79], v21, s[36:39], s92 offen sc1
 v_mfma_f32_16x16x32_bf16 v[48:51], a[200:203], a[128:131], 0
 s_lshl_b32 s94, s86, 2
 ds_read_b64_tr_b16 a[228:229], v180 offset:4096
 v_mul_f32 v32, v32, v192
 v_mfma_f32_16x16x32_bf16 v[52:55], a[200:203], a[144:147], 0
 s_waitcnt lgkmcnt(11)
 ds_read_b64_tr_b16 a[230:231], v180 offset:6144
 v_mul_f32 v33, v33, v192
 v_mfma_f32_16x16x32_bf16 v[52:55], a[204:207], a[148:151], v[52:55]
 s_add_u32 s95, s94, s68
 ds_read_b64_tr_b16 a[232:233], v180 offset:8192
 v_mul_f32 v34, v34, v192
 v_mfma_f32_16x16x32_bf16 v[48:51], a[204:207], a[132:135], v[48:51]
 s_waitcnt lgkmcnt(11)
 ds_read_b64_tr_b16 a[234:235], v180 offset:10240
 v_mul_f32 v35, v35, v192
 v_mfma_f32_16x16x32_bf16 v[48:51], a[208:211], a[136:139], v[48:51]
 s_mul_i32 s95, s95, 384
 ds_read_b64_tr_b16 a[236:237], v180 offset:12288
 v_mul_f32 v36, v36, v193
 v_mfma_f32_16x16x32_bf16 v[52:55], a[208:211], a[152:155], v[52:55]
 s_waitcnt lgkmcnt(11)
 ds_read_b64_tr_b16 a[238:239], v180 offset:14336
 v_mul_f32 v37, v37, v193
 v_mfma_f32_16x16x32_bf16 v[60:63], a[212:215], a[144:147], 0
 s_add_u32 m0, s76, 0
 s_add_u32 s91, s6, 384
 s_lshl_b32 s96, s82, 3
 ds_read_b64_tr_b16 a[240:241], v180 offset:16384
 v_mul_f32 v38, v38, v193
 v_mfma_f32_16x16x32_bf16 v[56:59], a[212:215], a[128:131], 0
 s_waitcnt lgkmcnt(11)
 ds_read_b64_tr_b16 a[242:243], v180 offset:18432
 buffer_load_dwordx4 v10, s[56:59], s91 offen offset:0 lds
 v_mfma_f32_16x16x32_bf16 v[56:59], a[216:219], a[132:135], v[56:59]
 s_add_u32 s95, s95, s96
 ds_read_b64_tr_b16 a[244:245], v180 offset:20480
 v_mul_f32 v39, v39, v193
 v_mfma_f32_16x16x32_bf16 v[60:63], a[216:219], a[148:151], v[60:63]
 s_waitcnt lgkmcnt(11)
 ds_read_b64_tr_b16 a[246:247], v180 offset:22528
 v_mul_f32 v40, v40, v192
 v_mfma_f32_16x16x32_bf16 v[60:63], a[220:223], a[152:155], v[60:63]
 s_add_u32 s13, s95, 52822016
 ds_read_b64_tr_b16 a[248:249], v180 offset:24576
 v_mul_f32 v41, v41, v192
 v_mfma_f32_16x16x32_bf16 v[56:59], a[220:223], a[136:139], v[56:59]
 s_waitcnt lgkmcnt(11)
 ds_read_b64_tr_b16 a[250:251], v180 offset:26624
 v_mul_f32 v42, v42, v192
 v_mfma_f32_16x16x32_bf16 v[32:35], a[224:227], v[112:115], v[32:35]
 s_lshr_b32 s95, s82, 2
 ds_read_b64_tr_b16 a[252:253], v180 offset:28672
 v_mul_f32 v43, v43, v192
 v_mfma_f32_16x16x32_bf16 v[36:39], a[224:227], v[144:147], v[36:39]
 s_waitcnt lgkmcnt(11)
 ds_read_b64_tr_b16 a[254:255], v180 offset:30720
 buffer_load_dwordx4 v11, s[56:59], s91 offen offset:1024 lds
 v_mfma_f32_16x16x32_bf16 v[36:39], a[228:231], v[148:151], v[36:39]
 s_add_u32 s94, s94, s95
 ds_read_b64_tr_b16 a[192:193], v181 offset:0
 v_mul_f32 v44, v44, v193
 v_mfma_f32_16x16x32_bf16 v[32:35], a[228:231], v[116:119], v[32:35]
 s_waitcnt lgkmcnt(11)
 ds_read_b64_tr_b16 a[194:195], v181 offset:2048
 v_mul_f32 v45, v45, v193
 v_mfma_f32_16x16x32_bf16 v[32:35], a[232:235], v[120:123], v[32:35]
 s_mul_i32 s94, s94, 384
 ds_read_b64_tr_b16 a[196:197], v181 offset:4096
 v_mul_f32 v46, v46, v193
 v_mfma_f32_16x16x32_bf16 v[36:39], a[232:235], v[152:155], v[36:39]
 s_waitcnt lgkmcnt(11)
 ds_read_b64_tr_b16 a[198:199], v181 offset:6144
 v_mul_f32 v47, v47, v193
 v_mfma_f32_16x16x32_bf16 v[36:39], a[236:239], v[156:159], v[36:39]
 s_add_u32 s94, s94, 52822016
 ds_read_b64_tr_b16 a[200:201], v181 offset:8192
 buffer_load_dwordx4 v12, s[56:59], s91 offen offset:2048 lds
 v_mfma_f32_16x16x32_bf16 v[32:35], a[236:239], v[124:127], v[32:35]
 s_waitcnt lgkmcnt(11)
 ds_read_b64_tr_b16 a[202:203], v181 offset:10240
 v_mul_f32 v48, v48, v192
 v_mfma_f32_16x16x32_bf16 v[32:35], a[240:243], v[128:131], v[32:35]
 ds_read_b64_tr_b16 a[204:205], v181 offset:12288
 v_mul_f32 v49, v49, v192
 v_mfma_f32_16x16x32_bf16 v[36:39], a[240:243], v[160:163], v[36:39]
 s_waitcnt lgkmcnt(11)
 ds_read_b64_tr_b16 a[206:207], v181 offset:14336
 v_mul_f32 v50, v50, v192
 v_mfma_f32_16x16x32_bf16 v[36:39], a[244:247], v[164:167], v[36:39]
 ds_read_b64_tr_b16 a[208:209], v181 offset:16384
 v_mul_f32 v51, v51, v192
 v_mfma_f32_16x16x32_bf16 v[32:35], a[244:247], v[132:135], v[32:35]
 s_waitcnt lgkmcnt(11)
 ds_read_b64_tr_b16 a[210:211], v181 offset:18432
 buffer_load_dwordx4 v13, s[56:59], s91 offen offset:3072 lds
 v_mfma_f32_16x16x32_bf16 v[32:35], a[248:251], v[136:139], v[32:35]
 ds_read_b64_tr_b16 a[212:213], v181 offset:20480
 v_mul_f32 v52, v52, v193
 v_mfma_f32_16x16x32_bf16 v[36:39], a[248:251], v[168:171], v[36:39]
 s_waitcnt lgkmcnt(11)
 ds_read_b64_tr_b16 a[214:215], v181 offset:22528
 v_mul_f32 v53, v53, v193
 v_mfma_f32_16x16x32_bf16 v[36:39], a[252:255], v[172:175], v[36:39]
 ds_read_b64_tr_b16 a[216:217], v181 offset:24576
 v_mul_f32 v54, v54, v193
 v_mfma_f32_16x16x32_bf16 v[32:35], a[252:255], v[140:143], v[32:35]
 s_waitcnt lgkmcnt(11)
 ds_read_b64_tr_b16 a[218:219], v181 offset:26624
 v_mul_f32 v55, v55, v193
 v_mfma_f32_16x16x32_bf16 v[40:43], a[192:195], v[112:115], v[40:43]
 s_add_u32 m0, s76, 16384
 s_add_u32 s91, s6, 115072
 ds_read_b64_tr_b16 a[220:221], v181 offset:28672
 v_mul_f32 v56, v56, v192
 v_mfma_f32_16x16x32_bf16 v[44:47], a[192:195], v[144:147], v[44:47]
 s_waitcnt lgkmcnt(11)
 ds_read_b64_tr_b16 a[222:223], v181 offset:30720
 buffer_load_dwordx4 v10, s[56:59], s91 offen offset:0 lds
 v_mfma_f32_16x16x32_bf16 v[44:47], a[196:199], v[148:151], v[44:47]
 ds_read_b64_tr_b16 a[224:225], v182 offset:0
 v_mul_f32 v57, v57, v192
 v_mfma_f32_16x16x32_bf16 v[40:43], a[196:199], v[116:119], v[40:43]
 s_waitcnt lgkmcnt(11)
 ds_read_b64_tr_b16 a[226:227], v182 offset:2048
 v_mul_f32 v58, v58, v192
 v_mfma_f32_16x16x32_bf16 v[40:43], a[200:203], v[120:123], v[40:43]
 ds_read_b64_tr_b16 a[228:229], v182 offset:4096
 v_mul_f32 v59, v59, v192
 v_mfma_f32_16x16x32_bf16 v[44:47], a[200:203], v[152:155], v[44:47]
 s_waitcnt lgkmcnt(11)
 ds_read_b64_tr_b16 a[230:231], v182 offset:6144
 v_mul_f32 v60, v60, v193
 v_mfma_f32_16x16x32_bf16 v[44:47], a[204:207], v[156:159], v[44:47]
 ds_read_b64_tr_b16 a[232:233], v182 offset:8192
 buffer_load_dwordx4 v11, s[56:59], s91 offen offset:1024 lds
 v_mfma_f32_16x16x32_bf16 v[40:43], a[204:207], v[124:127], v[40:43]
 s_waitcnt lgkmcnt(11)
 ds_read_b64_tr_b16 a[234:235], v182 offset:10240
 v_mul_f32 v61, v61, v193
 v_mfma_f32_16x16x32_bf16 v[40:43], a[208:211], v[128:131], v[40:43]
 ds_read_b64_tr_b16 a[236:237], v182 offset:12288
 v_mul_f32 v62, v62, v193
 v_mfma_f32_16x16x32_bf16 v[44:47], a[208:211], v[160:163], v[44:47]
 s_waitcnt lgkmcnt(11)
 ds_read_b64_tr_b16 a[238:239], v182 offset:14336
 v_mul_f32 v63, v63, v193
 v_mfma_f32_16x16x32_bf16 v[44:47], a[212:215], v[164:167], v[44:47]
 ds_read_b64_tr_b16 a[240:241], v182 offset:16384
 v_and_b32 v30, 15, v0
 v_mfma_f32_16x16x32_bf16 v[40:43], a[212:215], v[132:135], v[40:43]
 s_waitcnt lgkmcnt(11)
 ds_read_b64_tr_b16 a[242:243], v182 offset:18432
 buffer_load_dwordx4 v12, s[56:59], s91 offen offset:2048 lds
 v_mfma_f32_16x16x32_bf16 v[40:43], a[216:219], v[136:139], v[40:43]
 ds_read_b64_tr_b16 a[244:245], v182 offset:20480
 v_lshl_add_u32 v30, v30, 3, s94
 v_mfma_f32_16x16x32_bf16 v[44:47], a[216:219], v[168:171], v[44:47]
 s_waitcnt lgkmcnt(11)
 ds_read_b64_tr_b16 a[246:247], v182 offset:22528
 v_and_b32 v90, 16, v0
 v_mfma_f32_16x16x32_bf16 v[44:47], a[220:223], v[172:175], v[44:47]
 ds_read_b64_tr_b16 a[248:249], v182 offset:24576
 v_lshl_add_u32 v30, v90, 3, v30
 v_mfma_f32_16x16x32_bf16 v[40:43], a[220:223], v[140:143], v[40:43]
 s_waitcnt lgkmcnt(11)
 ds_read_b64_tr_b16 a[250:251], v182 offset:26624
 v_mfma_f32_16x16x32_bf16 v[48:51], a[224:227], v[112:115], v[48:51]
 s_lshl_b32 s96, s86, 3
 ds_read_b64_tr_b16 a[252:253], v182 offset:28672
 v_mfma_f32_16x16x32_bf16 v[52:55], a[224:227], v[144:147], v[52:55]
 s_waitcnt lgkmcnt(11)
 ds_read_b64_tr_b16 a[254:255], v182 offset:30720
 buffer_load_dwordx4 v13, s[56:59], s91 offen offset:3072 lds
 v_mfma_f32_16x16x32_bf16 v[52:55], a[228:231], v[148:151], v[52:55]
 s_lshr_b32 s97, s82, 1
 ds_read_b64_tr_b16 a[192:193], v183 offset:0
 v_mfma_f32_16x16x32_bf16 v[48:51], a[228:231], v[116:119], v[48:51]
 s_waitcnt lgkmcnt(11)
 ds_read_b64_tr_b16 a[194:195], v183 offset:2048
 v_mfma_f32_16x16x32_bf16 v[48:51], a[232:235], v[120:123], v[48:51]
 s_add_u32 s96, s96, s97
 ds_read_b64_tr_b16 a[196:197], v183 offset:4096
 v_cvt_pk_bf16_f32 v64, v32, v33
 v_mfma_f32_16x16x32_bf16 v[52:55], a[232:235], v[152:155], v[52:55]
 s_waitcnt lgkmcnt(11)
 s_add_u32 m0, s76, 32768
 s_add_u32 s91, s7, 512
 ds_read_b64_tr_b16 a[198:199], v183 offset:6144
 v_cvt_pk_bf16_f32 v65, v34, v35
 v_mfma_f32_16x16x32_bf16 v[52:55], a[236:239], v[156:159], v[52:55]
 s_and_b32 s97, s82, 1
 ds_read_b64_tr_b16 a[200:201], v183 offset:8192
 buffer_load_dwordx4 v10, s[60:63], s91 offen offset:0 lds
 v_mfma_f32_16x16x32_bf16 v[48:51], a[236:239], v[124:127], v[48:51]
 s_waitcnt lgkmcnt(11)
 ds_read_b64_tr_b16 a[202:203], v183 offset:10240
 v_cvt_pk_bf16_f32 v66, v40, v41
 v_mfma_f32_16x16x32_bf16 v[48:51], a[240:243], v[128:131], v[48:51]
 s_lshl_b32 s98, s68, 1
 ds_read_b64_tr_b16 a[204:205], v183 offset:12288
 v_cvt_pk_bf16_f32 v67, v42, v43
 v_mfma_f32_16x16x32_bf16 v[52:55], a[240:243], v[160:163], v[52:55]
 s_waitcnt lgkmcnt(11)
 s_add_u32 s92, s8, 32768
 ds_read_b64_tr_b16 a[206:207], v183 offset:14336
 buffer_store_dwordx4 v[64:67], v21, s[36:39], s92 offen sc1
 v_mfma_f32_16x16x32_bf16 v[52:55], a[244:247], v[164:167], v[52:55]
 s_add_u32 s97, s97, s98
 ds_read_b64_tr_b16 a[208:209], v183 offset:16384
 v_cvt_pk_bf16_f32 v68, v36, v37
 v_mfma_f32_16x16x32_bf16 v[48:51], a[244:247], v[132:135], v[48:51]
 s_waitcnt lgkmcnt(11)
 ds_read_b64_tr_b16 a[210:211], v183 offset:18432
 buffer_load_dwordx4 v11, s[60:63], s91 offen offset:1024 lds
 v_mfma_f32_16x16x32_bf16 v[48:51], a[248:251], v[136:139], v[48:51]
 s_mul_i32 s98, s96, 14
 ds_read_b64_tr_b16 a[212:213], v183 offset:20480
 v_cvt_pk_bf16_f32 v69, v38, v39
 v_mfma_f32_16x16x32_bf16 v[52:55], a[248:251], v[168:171], v[52:55]
 s_waitcnt lgkmcnt(11)
 ds_read_b64_tr_b16 a[214:215], v183 offset:22528
 v_cvt_pk_bf16_f32 v70, v44, v45
 v_mfma_f32_16x16x32_bf16 v[52:55], a[252:255], v[172:175], v[52:55]
 s_add_u32 s98, s98, s97
 ds_read_b64_tr_b16 a[216:217], v183 offset:24576
 v_cvt_pk_bf16_f32 v71, v46, v47
 v_mfma_f32_16x16x32_bf16 v[48:51], a[252:255], v[140:143], v[48:51]
 s_waitcnt lgkmcnt(11)
 s_add_u32 s92, s9, 32768
 ds_read_b64_tr_b16 a[218:219], v183 offset:26624
 buffer_store_dwordx4 v[68:71], v21, s[36:39], s92 offen sc1
 v_mfma_f32_16x16x32_bf16 v[56:59], a[192:195], v[112:115], v[56:59]
 s_lshl_b32 s98, s98, 14
 ds_read_b64_tr_b16 a[220:221], v183 offset:28672
 v_mfma_f32_16x16x32_bf16 v[60:63], a[192:195], v[144:147], v[60:63]
 s_waitcnt lgkmcnt(11)
 ds_read_b64_tr_b16 a[222:223], v183 offset:30720
 buffer_load_dwordx4 v12, s[60:63], s91 offen offset:2048 lds
 v_mfma_f32_16x16x32_bf16 v[60:63], a[196:199], v[148:151], v[60:63]
 s_add_u32 s14, s98, 54525952
 ds_read_b64_tr_b16 a[224:225], v180 offset:32768
 v_mfma_f32_16x16x32_bf16 v[56:59], a[196:199], v[116:119], v[56:59]
 s_waitcnt lgkmcnt(11)
 ds_read_b64_tr_b16 a[226:227], v180 offset:34816
 v_mfma_f32_16x16x32_bf16 v[56:59], a[200:203], v[120:123], v[56:59]
 s_add_u32 s15, s14, 98304
 ds_read_b64_tr_b16 a[228:229], v180 offset:36864
 v_mfma_f32_16x16x32_bf16 v[60:63], a[200:203], v[152:155], v[60:63]
 s_waitcnt lgkmcnt(11)
 ds_read_b64_tr_b16 a[230:231], v180 offset:38912
 v_mfma_f32_16x16x32_bf16 v[60:63], a[204:207], v[156:159], v[60:63]
 s_mul_i32 s12, s96, 14336
 ds_read_b64_tr_b16 a[232:233], v180 offset:40960
 buffer_load_dwordx4 v13, s[60:63], s91 offen offset:3072 lds
 v_mfma_f32_16x16x32_bf16 v[56:59], a[204:207], v[124:127], v[56:59]
 s_waitcnt lgkmcnt(11)
 ds_read_b64_tr_b16 a[234:235], v180 offset:43008
 v_mfma_f32_16x16x32_bf16 v[56:59], a[208:211], v[128:131], v[56:59]
 s_lshl_b32 s97, s97, 6
 ds_read_b64_tr_b16 a[236:237], v181 offset:32768
 v_mfma_f32_16x16x32_bf16 v[60:63], a[208:211], v[160:163], v[60:63]
 s_waitcnt lgkmcnt(11)
 ds_read_b64_tr_b16 a[238:239], v181 offset:34816
 v_mfma_f32_16x16x32_bf16 v[60:63], a[212:215], v[164:167], v[60:63]
 s_add_u32 s12, s12, s97
 ds_read_b64_tr_b16 a[240:241], v181 offset:36864
 v_mfma_f32_16x16x32_bf16 v[56:59], a[212:215], v[132:135], v[56:59]
 s_waitcnt lgkmcnt(11)
 ds_read_b64_tr_b16 a[242:243], v181 offset:38912
 v_mfma_f32_16x16x32_bf16 v[56:59], a[216:219], v[136:139], v[56:59]
 ds_read_b64_tr_b16 a[244:245], v181 offset:40960
 s_cmp_lt_u32 s68, 3
 s_cselect_b32 s66, s38, 0
 s_cselect_b32 s16, 1835008, 0
 s_mov_b32 s10, 0xffff0000
 s_cselect_b32 s10, -1, s10
 v_mfma_f32_16x16x32_bf16 v[60:63], a[216:219], v[168:171], v[60:63]
 s_waitcnt lgkmcnt(11)
 ds_read_b64_tr_b16 a[246:247], v181 offset:43008
 v_mfma_f32_16x16x32_bf16 v[60:63], a[220:223], v[172:175], v[60:63]
 s_mov_b32 s48, s36
 ds_read_b64_tr_b16 a[248:249], v182 offset:32768
 v_mfma_f32_16x16x32_bf16 v[56:59], a[220:223], v[140:143], v[56:59]
 ds_read_b64_tr_b16 a[250:251], v182 offset:34816
 s_waitcnt lgkmcnt(12)
 v_mfma_f32_16x16x32_bf16 v[32:35], a[224:227], a[128:131], 0
 ds_read_b64_tr_b16 a[252:253], v182 offset:36864
 v_mfma_f32_16x16x32_bf16 v[36:39], a[224:227], a[144:147], 0
 s_waitcnt lgkmcnt(11)
 ds_read_b64_tr_b16 a[254:255], v182 offset:38912
 v_cvt_pk_bf16_f32 v72, v48, v49
 v_mfma_f32_16x16x32_bf16 v[36:39], a[228:231], a[148:151], v[36:39]
 ds_read_b64_tr_b16 a[192:193], v182 offset:40960
 v_cvt_pk_bf16_f32 v73, v50, v51
 v_mfma_f32_16x16x32_bf16 v[32:35], a[228:231], a[132:135], v[32:35]
 s_waitcnt lgkmcnt(11)
 ds_read_b64_tr_b16 a[194:195], v182 offset:43008
 v_cvt_pk_bf16_f32 v74, v56, v57
 v_mfma_f32_16x16x32_bf16 v[32:35], a[232:235], a[136:139], v[32:35]
 ds_read_b64_tr_b16 a[196:197], v183 offset:32768
 v_cvt_pk_bf16_f32 v75, v58, v59
 v_mfma_f32_16x16x32_bf16 v[36:39], a[232:235], a[152:155], v[36:39]
 s_waitcnt lgkmcnt(11)
 s_add_u32 s92, s8, 49152
 ds_read_b64_tr_b16 a[198:199], v183 offset:34816
 buffer_store_dwordx4 v[72:75], v21, s[36:39], s92 offen sc1
 v_mfma_f32_16x16x32_bf16 v[44:47], a[236:239], a[144:147], 0
 ds_read_b64_tr_b16 a[200:201], v183 offset:36864
 v_cvt_pk_bf16_f32 v76, v52, v53
 v_mfma_f32_16x16x32_bf16 v[40:43], a[236:239], a[128:131], 0
 s_waitcnt lgkmcnt(11)
 ds_read_b64_tr_b16 a[202:203], v183 offset:38912
 v_cvt_pk_bf16_f32 v77, v54, v55
 v_mfma_f32_16x16x32_bf16 v[40:43], a[240:243], a[132:135], v[40:43]
 ds_read_b64_tr_b16 a[204:205], v183 offset:40960
 v_cvt_pk_bf16_f32 v78, v60, v61
 v_mfma_f32_16x16x32_bf16 v[44:47], a[240:243], a[148:151], v[44:47]
 s_waitcnt lgkmcnt(11)
 s_waitcnt vmcnt(17)
 s_barrier
 ds_read_b64_tr_b16 a[206:207], v183 offset:43008
 v_mfma_f32_16x16x32_bf16 v[44:47], a[244:247], a[152:155], v[44:47]
 ds_read_b64_tr_b16 a[208:209], v180 offset:49152
 v_cvt_pk_bf16_f32 v79, v62, v63
 v_mfma_f32_16x16x32_bf16 v[40:43], a[244:247], a[136:139], v[40:43]
 s_waitcnt lgkmcnt(11)
 s_add_u32 s92, s9, 49152
 ds_read_b64_tr_b16 a[210:211], v180 offset:51200
 buffer_store_dwordx4 v[76:79], v21, s[36:39], s92 offen sc1
 v_mfma_f32_16x16x32_bf16 v[48:51], a[248:251], a[128:131], 0
 s_mov_b32 s49, s37
 ds_read_b64_tr_b16 a[212:213], v180 offset:53248
 v_mul_f32 v32, v32, v192
 v_mfma_f32_16x16x32_bf16 v[52:55], a[248:251], a[144:147], 0
 s_waitcnt lgkmcnt(11)
 ds_read_b64_tr_b16 a[214:215], v180 offset:55296
 v_mul_f32 v33, v33, v192
 v_mfma_f32_16x16x32_bf16 v[52:55], a[252:255], a[148:151], v[52:55]
 ds_read_b64_tr_b16 a[216:217], v180 offset:57344
 v_mul_f32 v34, v34, v192
 v_mfma_f32_16x16x32_bf16 v[48:51], a[252:255], a[132:135], v[48:51]
 s_waitcnt lgkmcnt(11)
 ds_read_b64_tr_b16 a[218:219], v180 offset:59392
 v_mul_f32 v35, v35, v192
 v_mfma_f32_16x16x32_bf16 v[48:51], a[192:195], a[136:139], v[48:51]
 ds_read_b64_tr_b16 a[220:221], v180 offset:61440
 v_mul_f32 v36, v36, v193
 v_mfma_f32_16x16x32_bf16 v[52:55], a[192:195], a[152:155], v[52:55]
 s_waitcnt lgkmcnt(11)
 ds_read_b64_tr_b16 a[222:223], v180 offset:63488
 v_mul_f32 v37, v37, v193
 v_mfma_f32_16x16x32_bf16 v[60:63], a[196:199], a[144:147], 0
 s_add_u32 m0, s76, 49152
 s_add_u32 s91, s6, 512
 ds_read_b64_tr_b16 a[224:225], v184 offset:0
 v_mul_f32 v38, v38, v193
 v_mfma_f32_16x16x32_bf16 v[56:59], a[196:199], a[128:131], 0
 s_waitcnt lgkmcnt(11)
 ds_read_b64_tr_b16 a[226:227], v184 offset:2048
 buffer_load_dwordx4 v10, s[56:59], s91 offen offset:0 lds
 v_mfma_f32_16x16x32_bf16 v[56:59], a[200:203], a[132:135], v[56:59]
 ds_read_b64_tr_b16 a[228:229], v184 offset:4096
 v_mul_f32 v39, v39, v193
 v_mfma_f32_16x16x32_bf16 v[60:63], a[200:203], a[148:151], v[60:63]
 s_waitcnt lgkmcnt(11)
 ds_read_b64_tr_b16 a[230:231], v184 offset:6144
 v_mul_f32 v40, v40, v192
 v_mfma_f32_16x16x32_bf16 v[60:63], a[204:207], a[152:155], v[60:63]
 ds_read_b64_tr_b16 a[232:233], v184 offset:8192
 v_mul_f32 v41, v41, v192
 v_mfma_f32_16x16x32_bf16 v[56:59], a[204:207], a[136:139], v[56:59]
 s_waitcnt lgkmcnt(11)
 ds_read_b64_tr_b16 a[234:235], v184 offset:10240
 v_mul_f32 v42, v42, v192
 v_mfma_f32_16x16x32_bf16 v[32:35], a[208:211], v[112:115], v[32:35]
 ds_read_b64_tr_b16 a[236:237], v184 offset:12288
 v_mul_f32 v43, v43, v192
 v_mfma_f32_16x16x32_bf16 v[36:39], a[208:211], v[144:147], v[36:39]
 s_waitcnt lgkmcnt(11)
 ds_read_b64_tr_b16 a[238:239], v184 offset:14336
 buffer_load_dwordx4 v11, s[56:59], s91 offen offset:1024 lds
 v_mfma_f32_16x16x32_bf16 v[36:39], a[212:215], v[148:151], v[36:39]
 ds_read_b64_tr_b16 a[240:241], v181 offset:49152
 v_mul_f32 v44, v44, v193
 v_mfma_f32_16x16x32_bf16 v[32:35], a[212:215], v[116:119], v[32:35]
 s_waitcnt lgkmcnt(11)
 ds_read_b64_tr_b16 a[242:243], v181 offset:51200
 v_mul_f32 v45, v45, v193
 v_mfma_f32_16x16x32_bf16 v[32:35], a[216:219], v[120:123], v[32:35]
 ds_read_b64_tr_b16 a[244:245], v181 offset:53248
 v_mul_f32 v46, v46, v193
 v_mfma_f32_16x16x32_bf16 v[36:39], a[216:219], v[152:155], v[36:39]
 s_waitcnt lgkmcnt(11)
 ds_read_b64_tr_b16 a[246:247], v181 offset:55296
 v_mul_f32 v47, v47, v193
 v_mfma_f32_16x16x32_bf16 v[36:39], a[220:223], v[156:159], v[36:39]
 ds_read_b64_tr_b16 a[248:249], v181 offset:57344
 buffer_load_dwordx4 v12, s[56:59], s91 offen offset:2048 lds
 v_mfma_f32_16x16x32_bf16 v[32:35], a[220:223], v[124:127], v[32:35]
 s_waitcnt lgkmcnt(11)
 ds_read_b64_tr_b16 a[250:251], v181 offset:59392
 v_mul_f32 v48, v48, v192
 v_mfma_f32_16x16x32_bf16 v[32:35], a[224:227], v[128:131], v[32:35]
 ds_read_b64_tr_b16 a[252:253], v181 offset:61440
 v_mul_f32 v49, v49, v192
 v_mfma_f32_16x16x32_bf16 v[36:39], a[224:227], v[160:163], v[36:39]
 s_waitcnt lgkmcnt(11)
 ds_read_b64_tr_b16 a[254:255], v181 offset:63488
 v_mul_f32 v50, v50, v192
 v_mfma_f32_16x16x32_bf16 v[36:39], a[228:231], v[164:167], v[36:39]
 ds_read_b64_tr_b16 a[192:193], v185 offset:0
 v_mul_f32 v51, v51, v192
 v_mfma_f32_16x16x32_bf16 v[32:35], a[228:231], v[132:135], v[32:35]
 s_waitcnt lgkmcnt(11)
 ds_read_b64_tr_b16 a[194:195], v185 offset:2048
 buffer_load_dwordx4 v13, s[56:59], s91 offen offset:3072 lds
 v_mfma_f32_16x16x32_bf16 v[32:35], a[232:235], v[136:139], v[32:35]
 ds_read_b64_tr_b16 a[196:197], v185 offset:4096
 v_mul_f32 v52, v52, v193
 v_mfma_f32_16x16x32_bf16 v[36:39], a[232:235], v[168:171], v[36:39]
 s_waitcnt lgkmcnt(11)
 ds_read_b64_tr_b16 a[198:199], v185 offset:6144
 v_mul_f32 v53, v53, v193
 v_mfma_f32_16x16x32_bf16 v[36:39], a[236:239], v[172:175], v[36:39]
 ds_read_b64_tr_b16 a[200:201], v185 offset:8192
 v_mul_f32 v54, v54, v193
 v_mfma_f32_16x16x32_bf16 v[32:35], a[236:239], v[140:143], v[32:35]
 s_waitcnt lgkmcnt(11)
 ds_read_b64_tr_b16 a[202:203], v185 offset:10240
 v_mul_f32 v55, v55, v193
 v_mfma_f32_16x16x32_bf16 v[40:43], a[240:243], v[112:115], v[40:43]
 s_add_u32 m0, s76, 65536
 s_add_u32 s91, s6, 115200
 ds_read_b64_tr_b16 a[204:205], v185 offset:12288
 v_mul_f32 v56, v56, v192
 v_mfma_f32_16x16x32_bf16 v[44:47], a[240:243], v[144:147], v[44:47]
 s_waitcnt lgkmcnt(11)
 ds_read_b64_tr_b16 a[206:207], v185 offset:14336
 buffer_load_dwordx4 v10, s[56:59], s91 offen offset:0 lds
 v_mfma_f32_16x16x32_bf16 v[44:47], a[244:247], v[148:151], v[44:47]
 ds_read_b64_tr_b16 a[208:209], v182 offset:49152
 v_mul_f32 v57, v57, v192
 v_mfma_f32_16x16x32_bf16 v[40:43], a[244:247], v[116:119], v[40:43]
 s_waitcnt lgkmcnt(11)
 ds_read_b64_tr_b16 a[210:211], v182 offset:51200
 v_mul_f32 v58, v58, v192
 v_mfma_f32_16x16x32_bf16 v[40:43], a[248:251], v[120:123], v[40:43]
 ds_read_b64_tr_b16 a[212:213], v182 offset:53248
 v_mul_f32 v59, v59, v192
 v_mfma_f32_16x16x32_bf16 v[44:47], a[248:251], v[152:155], v[44:47]
 s_waitcnt lgkmcnt(11)
 ds_read_b64_tr_b16 a[214:215], v182 offset:55296
 v_mul_f32 v60, v60, v193
 v_mfma_f32_16x16x32_bf16 v[44:47], a[252:255], v[156:159], v[44:47]
 ds_read_b64_tr_b16 a[216:217], v182 offset:57344
 buffer_load_dwordx4 v11, s[56:59], s91 offen offset:1024 lds
 v_mfma_f32_16x16x32_bf16 v[40:43], a[252:255], v[124:127], v[40:43]
 s_waitcnt lgkmcnt(11)
 ds_read_b64_tr_b16 a[218:219], v182 offset:59392
 v_mul_f32 v61, v61, v193
 v_mfma_f32_16x16x32_bf16 v[40:43], a[192:195], v[128:131], v[40:43]
 ds_read_b64_tr_b16 a[220:221], v182 offset:61440
 v_mul_f32 v62, v62, v193
 v_mfma_f32_16x16x32_bf16 v[44:47], a[192:195], v[160:163], v[44:47]
 s_waitcnt lgkmcnt(11)
 ds_read_b64_tr_b16 a[222:223], v182 offset:63488
 v_mul_f32 v63, v63, v193
 v_mfma_f32_16x16x32_bf16 v[44:47], a[196:199], v[164:167], v[44:47]
 ds_read_b64_tr_b16 a[224:225], v186 offset:0
 v_and_b32 v94, 15, v0
 v_mfma_f32_16x16x32_bf16 v[40:43], a[196:199], v[132:135], v[40:43]
 s_waitcnt lgkmcnt(11)
 ds_read_b64_tr_b16 a[226:227], v186 offset:2048
 buffer_load_dwordx4 v12, s[56:59], s91 offen offset:2048 lds
 v_mfma_f32_16x16x32_bf16 v[40:43], a[200:203], v[136:139], v[40:43]
 ds_read_b64_tr_b16 a[228:229], v186 offset:4096
 v_bfe_u32 v95, v0, 4, 2
 v_mfma_f32_16x16x32_bf16 v[44:47], a[200:203], v[168:171], v[44:47]
 s_waitcnt lgkmcnt(11)
 ds_read_b64_tr_b16 a[230:231], v186 offset:6144
 v_mul_u32_u24 v90, 896, v94
 v_mfma_f32_16x16x32_bf16 v[44:47], a[204:207], v[172:175], v[44:47]
 ds_read_b64_tr_b16 a[232:233], v186 offset:8192
 v_lshl_add_u32 v90, v95, 4, v90
 v_mfma_f32_16x16x32_bf16 v[40:43], a[204:207], v[140:143], v[40:43]
 s_waitcnt lgkmcnt(11)
 ds_read_b64_tr_b16 a[234:235], v186 offset:10240
 v_lshrrev_b32 v96, 2, v94
 v_mfma_f32_16x16x32_bf16 v[48:51], a[208:211], v[112:115], v[48:51]
 ds_read_b64_tr_b16 a[236:237], v186 offset:12288
 v_and_b32 v97, 3, v94
 v_mfma_f32_16x16x32_bf16 v[52:55], a[208:211], v[144:147], v[52:55]
 s_waitcnt lgkmcnt(11)
 ds_read_b64_tr_b16 a[238:239], v186 offset:14336
 buffer_load_dwordx4 v13, s[56:59], s91 offen offset:3072 lds
 v_mfma_f32_16x16x32_bf16 v[52:55], a[212:215], v[148:151], v[52:55]
 ds_read_b64_tr_b16 a[240:241], v183 offset:49152
 v_and_b32 v98, 1, v94
 v_mfma_f32_16x16x32_bf16 v[48:51], a[212:215], v[116:119], v[48:51]
 s_waitcnt lgkmcnt(11)
 ds_read_b64_tr_b16 a[242:243], v183 offset:51200
 v_lshlrev_b32 v98, 4, v98
 v_mfma_f32_16x16x32_bf16 v[48:51], a[216:219], v[120:123], v[48:51]
 ds_read_b64_tr_b16 a[244:245], v183 offset:53248
 v_cvt_pk_bf16_f32 v64, v32, v33
 v_mfma_f32_16x16x32_bf16 v[52:55], a[216:219], v[152:155], v[52:55]
 s_waitcnt lgkmcnt(11)
 s_add_u32 m0, s76, 81920
 s_add_u32 s91, s7, 640
 ds_read_b64_tr_b16 a[246:247], v183 offset:55296
 v_cvt_pk_bf16_f32 v65, v34, v35
 v_mfma_f32_16x16x32_bf16 v[52:55], a[220:223], v[156:159], v[52:55]
 ds_read_b64_tr_b16 a[248:249], v183 offset:57344
 buffer_load_dwordx4 v10, s[60:63], s91 offen offset:0 lds
 v_mfma_f32_16x16x32_bf16 v[48:51], a[220:223], v[124:127], v[48:51]
 s_waitcnt lgkmcnt(11)
 ds_read_b64_tr_b16 a[250:251], v183 offset:59392
 v_cvt_pk_bf16_f32 v66, v40, v41
 v_mfma_f32_16x16x32_bf16 v[48:51], a[224:227], v[128:131], v[48:51]
 ds_read_b64_tr_b16 a[252:253], v183 offset:61440
 v_cvt_pk_bf16_f32 v67, v42, v43
 v_mfma_f32_16x16x32_bf16 v[52:55], a[224:227], v[160:163], v[52:55]
 s_waitcnt lgkmcnt(11)
 s_add_u32 s92, s8, 65536
 ds_read_b64_tr_b16 a[254:255], v183 offset:63488
 buffer_store_dwordx4 v[64:67], v21, s[36:39], s92 offen sc1
 v_mfma_f32_16x16x32_bf16 v[52:55], a[228:231], v[164:167], v[52:55]
 ds_read_b64_tr_b16 a[192:193], v187 offset:0
 v_cvt_pk_bf16_f32 v68, v36, v37
 v_mfma_f32_16x16x32_bf16 v[48:51], a[228:231], v[132:135], v[48:51]
 s_waitcnt lgkmcnt(11)
 ds_read_b64_tr_b16 a[194:195], v187 offset:2048
 buffer_load_dwordx4 v11, s[60:63], s91 offen offset:1024 lds
 v_mfma_f32_16x16x32_bf16 v[48:51], a[232:235], v[136:139], v[48:51]
 ds_read_b64_tr_b16 a[196:197], v187 offset:4096
 v_cvt_pk_bf16_f32 v69, v38, v39
 v_mfma_f32_16x16x32_bf16 v[52:55], a[232:235], v[168:171], v[52:55]
 s_waitcnt lgkmcnt(11)
 ds_read_b64_tr_b16 a[198:199], v187 offset:6144
 v_cvt_pk_bf16_f32 v70, v44, v45
 v_mfma_f32_16x16x32_bf16 v[52:55], a[236:239], v[172:175], v[52:55]
 ds_read_b64_tr_b16 a[200:201], v187 offset:8192
 v_cvt_pk_bf16_f32 v71, v46, v47
 v_mfma_f32_16x16x32_bf16 v[48:51], a[236:239], v[140:143], v[48:51]
 s_waitcnt lgkmcnt(11)
 s_add_u32 s92, s9, 65536
 ds_read_b64_tr_b16 a[202:203], v187 offset:10240
 buffer_store_dwordx4 v[68:71], v21, s[36:39], s92 offen sc1
 v_mfma_f32_16x16x32_bf16 v[56:59], a[240:243], v[112:115], v[56:59]
 ds_read_b64_tr_b16 a[204:205], v187 offset:12288
 v_mov_b32 v99, 0x3f80
 v_mfma_f32_16x16x32_bf16 v[60:63], a[240:243], v[144:147], v[60:63]
 s_waitcnt lgkmcnt(11)
 ds_read_b64_tr_b16 a[206:207], v187 offset:14336
 buffer_load_dwordx4 v12, s[60:63], s91 offen offset:2048 lds
 v_mfma_f32_16x16x32_bf16 v[60:63], a[244:247], v[148:151], v[60:63]
 ds_read_b64_tr_b16 a[208:209], v184 offset:16384
 v_lshlrev_b32 v98, v98, v99
 v_mfma_f32_16x16x32_bf16 v[56:59], a[244:247], v[116:119], v[56:59]
 s_waitcnt lgkmcnt(11)
 ds_read_b64_tr_b16 a[210:211], v184 offset:18432
 v_lshrrev_b32 v99, 1, v96
 v_mfma_f32_16x16x32_bf16 v[56:59], a[248:251], v[120:123], v[56:59]
 ds_read_b64_tr_b16 a[212:213], v184 offset:20480
 v_lshrrev_b32 v97, 1, v97
 v_mfma_f32_16x16x32_bf16 v[60:63], a[248:251], v[152:155], v[60:63]
 s_waitcnt lgkmcnt(11)
 ds_read_b64_tr_b16 a[214:215], v184 offset:22528
 v_lshl_add_u32 v97, v99, 1, v97
 v_mfma_f32_16x16x32_bf16 v[60:63], a[252:255], v[156:159], v[60:63]
 ds_read_b64_tr_b16 a[216:217], v184 offset:24576
 buffer_load_dwordx4 v13, s[60:63], s91 offen offset:3072 lds
 v_mfma_f32_16x16x32_bf16 v[56:59], a[252:255], v[124:127], v[56:59]
 s_waitcnt lgkmcnt(11)
 ds_read_b64_tr_b16 a[218:219], v184 offset:26624
 v_and_b32 v96, 1, v96
 v_mfma_f32_16x16x32_bf16 v[56:59], a[192:195], v[128:131], v[56:59]
 ds_read_b64_tr_b16 a[220:221], v185 offset:16384
 v_lshlrev_b32 v96, 1, v96
 v_mfma_f32_16x16x32_bf16 v[60:63], a[192:195], v[160:163], v[60:63]
 s_waitcnt lgkmcnt(11)
 ds_read_b64_tr_b16 a[222:223], v185 offset:18432
 v_add_u32 v99, 0, v96
 v_mfma_f32_16x16x32_bf16 v[60:63], a[196:199], v[164:167], v[60:63]
 ds_read_b64_tr_b16 a[224:225], v185 offset:20480
 v_cmp_eq_u32 vcc, v99, v95
 v_mfma_f32_16x16x32_bf16 v[56:59], a[196:199], v[132:135], v[56:59]
 s_waitcnt lgkmcnt(11)
 ds_read_b64_tr_b16 a[226:227], v185 offset:22528
 v_cndmask_b32 v99, 0, v98, vcc
 v_mfma_f32_16x16x32_bf16 v[56:59], a[200:203], v[136:139], v[56:59]
 ds_read_b64_tr_b16 a[228:229], v185 offset:24576
 v_cmp_eq_u32 vcc, 0, v97
 v_mfma_f32_16x16x32_bf16 v[60:63], a[200:203], v[168:171], v[60:63]
 s_waitcnt lgkmcnt(11)
 ds_read_b64_tr_b16 a[230:231], v185 offset:26624
 v_cndmask_b32 v80, 0, v99, vcc
 v_mfma_f32_16x16x32_bf16 v[60:63], a[204:207], v[172:175], v[60:63]
 ds_read_b64_tr_b16 a[232:233], v186 offset:16384
 v_cmp_eq_u32 vcc, 1, v97
 v_mfma_f32_16x16x32_bf16 v[56:59], a[204:207], v[140:143], v[56:59]
 ds_read_b64_tr_b16 a[234:235], v186 offset:18432
 s_waitcnt lgkmcnt(12)
 v_mfma_f32_16x16x32_bf16 v[32:35], a[208:211], a[128:131], 0
 ds_read_b64_tr_b16 a[236:237], v186 offset:20480
 v_mfma_f32_16x16x32_bf16 v[36:39], a[208:211], a[144:147], 0
 s_waitcnt lgkmcnt(11)
 ds_read_b64_tr_b16 a[238:239], v186 offset:22528
 v_cvt_pk_bf16_f32 v72, v48, v49
 v_mfma_f32_16x16x32_bf16 v[36:39], a[212:215], a[148:151], v[36:39]
 ds_read_b64_tr_b16 a[240:241], v186 offset:24576
 v_cvt_pk_bf16_f32 v73, v50, v51
 v_mfma_f32_16x16x32_bf16 v[32:35], a[212:215], a[132:135], v[32:35]
 s_waitcnt lgkmcnt(11)
 ds_read_b64_tr_b16 a[242:243], v186 offset:26624
 v_cvt_pk_bf16_f32 v74, v56, v57
 v_mfma_f32_16x16x32_bf16 v[32:35], a[216:219], a[136:139], v[32:35]
 ds_read_b64_tr_b16 a[244:245], v187 offset:16384
 v_cvt_pk_bf16_f32 v75, v58, v59
 v_mfma_f32_16x16x32_bf16 v[36:39], a[216:219], a[152:155], v[36:39]
 s_waitcnt lgkmcnt(11)
 s_add_u32 s92, s8, 81920
 ds_read_b64_tr_b16 a[246:247], v187 offset:18432
 buffer_store_dwordx4 v[72:75], v21, s[36:39], s92 offen sc1
 v_mfma_f32_16x16x32_bf16 v[44:47], a[220:223], a[144:147], 0
 ds_read_b64_tr_b16 a[248:249], v187 offset:20480
 v_cvt_pk_bf16_f32 v76, v52, v53
 v_mfma_f32_16x16x32_bf16 v[40:43], a[220:223], a[128:131], 0
 s_waitcnt lgkmcnt(11)
 ds_read_b64_tr_b16 a[250:251], v187 offset:22528
 v_cvt_pk_bf16_f32 v77, v54, v55
 v_mfma_f32_16x16x32_bf16 v[40:43], a[224:227], a[132:135], v[40:43]
 ds_read_b64_tr_b16 a[252:253], v187 offset:24576
 v_cvt_pk_bf16_f32 v78, v60, v61
 v_mfma_f32_16x16x32_bf16 v[44:47], a[224:227], a[148:151], v[44:47]
 s_waitcnt lgkmcnt(11)
 s_waitcnt vmcnt(17)
 s_barrier
 ds_read_b64_tr_b16 a[254:255], v187 offset:26624
 v_mfma_f32_16x16x32_bf16 v[44:47], a[228:231], a[152:155], v[44:47]
 ds_read_b64_tr_b16 a[192:193], v176 offset:0
 v_cvt_pk_bf16_f32 v79, v62, v63
 v_mfma_f32_16x16x32_bf16 v[40:43], a[228:231], a[136:139], v[40:43]
 s_waitcnt lgkmcnt(11)
 s_add_u32 s92, s9, 81920
 ds_read_b64_tr_b16 a[194:195], v176 offset:2048
 buffer_store_dwordx4 v[76:79], v21, s[36:39], s92 offen sc1
 v_mfma_f32_16x16x32_bf16 v[48:51], a[232:235], a[128:131], 0
 ds_read_b64_tr_b16 a[196:197], v176 offset:4096
 v_mul_f32 v32, v32, v192
 v_mfma_f32_16x16x32_bf16 v[52:55], a[232:235], a[144:147], 0
 s_waitcnt lgkmcnt(11)
 ds_read_b64_tr_b16 a[198:199], v176 offset:6144
 v_mul_f32 v33, v33, v192
 v_mfma_f32_16x16x32_bf16 v[52:55], a[236:239], a[148:151], v[52:55]
 ds_read_b64_tr_b16 a[200:201], v176 offset:8192
 v_mul_f32 v34, v34, v192
 v_mfma_f32_16x16x32_bf16 v[48:51], a[236:239], a[132:135], v[48:51]
 s_waitcnt lgkmcnt(11)
 ds_read_b64_tr_b16 a[202:203], v176 offset:10240
 v_mul_f32 v35, v35, v192
 v_mfma_f32_16x16x32_bf16 v[48:51], a[240:243], a[136:139], v[48:51]
 ds_read_b64_tr_b16 a[204:205], v176 offset:12288
 v_mul_f32 v36, v36, v193
 v_mfma_f32_16x16x32_bf16 v[52:55], a[240:243], a[152:155], v[52:55]
 s_waitcnt lgkmcnt(11)
 ds_read_b64_tr_b16 a[206:207], v176 offset:14336
 v_mul_f32 v37, v37, v193
 v_mfma_f32_16x16x32_bf16 v[60:63], a[244:247], a[144:147], 0
 s_add_u32 m0, s76, 98304
 s_add_u32 s91, s6, 640
 ds_read_b64_tr_b16 a[208:209], v176 offset:16384
 v_mul_f32 v38, v38, v193
 v_mfma_f32_16x16x32_bf16 v[56:59], a[244:247], a[128:131], 0
 s_waitcnt lgkmcnt(11)
 ds_read_b64_tr_b16 a[210:211], v176 offset:18432
 buffer_load_dwordx4 v10, s[56:59], s91 offen offset:0 lds
 v_mfma_f32_16x16x32_bf16 v[56:59], a[248:251], a[132:135], v[56:59]
 ds_read_b64_tr_b16 a[212:213], v176 offset:20480
 v_mul_f32 v39, v39, v193
 v_mfma_f32_16x16x32_bf16 v[60:63], a[248:251], a[148:151], v[60:63]
 s_waitcnt lgkmcnt(11)
 ds_read_b64_tr_b16 a[214:215], v176 offset:22528
 v_mul_f32 v40, v40, v192
 v_mfma_f32_16x16x32_bf16 v[60:63], a[252:255], a[152:155], v[60:63]
 ds_read_b64_tr_b16 a[216:217], v176 offset:24576
 v_mul_f32 v41, v41, v192
 v_mfma_f32_16x16x32_bf16 v[56:59], a[252:255], a[136:139], v[56:59]
 s_waitcnt lgkmcnt(11)
 ds_read_b64_tr_b16 a[218:219], v176 offset:26624
 v_mul_f32 v42, v42, v192
 v_mfma_f32_16x16x32_bf16 v[32:35], a[192:195], v[112:115], v[32:35]
 ds_read_b64_tr_b16 a[220:221], v176 offset:28672
 v_mul_f32 v43, v43, v192
 v_mfma_f32_16x16x32_bf16 v[36:39], a[192:195], v[144:147], v[36:39]
 s_waitcnt lgkmcnt(11)
 ds_read_b64_tr_b16 a[222:223], v176 offset:30720
 buffer_load_dwordx4 v11, s[56:59], s91 offen offset:1024 lds
 v_mfma_f32_16x16x32_bf16 v[36:39], a[196:199], v[148:151], v[36:39]
 ds_read_b64_tr_b16 a[224:225], v177 offset:0
 v_mul_f32 v44, v44, v193
 v_mfma_f32_16x16x32_bf16 v[32:35], a[196:199], v[116:119], v[32:35]
 s_waitcnt lgkmcnt(11)
 ds_read_b64_tr_b16 a[226:227], v177 offset:2048
 v_mul_f32 v45, v45, v193
 v_mfma_f32_16x16x32_bf16 v[32:35], a[200:203], v[120:123], v[32:35]
 ds_read_b64_tr_b16 a[228:229], v177 offset:4096
 v_mul_f32 v46, v46, v193
 v_mfma_f32_16x16x32_bf16 v[36:39], a[200:203], v[152:155], v[36:39]
 s_waitcnt lgkmcnt(11)
 ds_read_b64_tr_b16 a[230:231], v177 offset:6144
 v_mul_f32 v47, v47, v193
 v_mfma_f32_16x16x32_bf16 v[36:39], a[204:207], v[156:159], v[36:39]
 ds_read_b64_tr_b16 a[232:233], v177 offset:8192
 buffer_load_dwordx4 v12, s[56:59], s91 offen offset:2048 lds
 v_mfma_f32_16x16x32_bf16 v[32:35], a[204:207], v[124:127], v[32:35]
 s_waitcnt lgkmcnt(11)
 ds_read_b64_tr_b16 a[234:235], v177 offset:10240
 v_mul_f32 v48, v48, v192
 v_mfma_f32_16x16x32_bf16 v[32:35], a[208:211], v[128:131], v[32:35]
 ds_read_b64_tr_b16 a[236:237], v177 offset:12288
 v_mul_f32 v49, v49, v192
 v_mfma_f32_16x16x32_bf16 v[36:39], a[208:211], v[160:163], v[36:39]
 s_waitcnt lgkmcnt(11)
 ds_read_b64_tr_b16 a[238:239], v177 offset:14336
 v_mul_f32 v50, v50, v192
 v_mfma_f32_16x16x32_bf16 v[36:39], a[212:215], v[164:167], v[36:39]
 ds_read_b64_tr_b16 a[240:241], v177 offset:16384
 v_mul_f32 v51, v51, v192
 v_mfma_f32_16x16x32_bf16 v[32:35], a[212:215], v[132:135], v[32:35]
 s_waitcnt lgkmcnt(11)
 ds_read_b64_tr_b16 a[242:243], v177 offset:18432
 buffer_load_dwordx4 v13, s[56:59], s91 offen offset:3072 lds
 v_mfma_f32_16x16x32_bf16 v[32:35], a[216:219], v[136:139], v[32:35]
 ds_read_b64_tr_b16 a[244:245], v177 offset:20480
 v_mul_f32 v52, v52, v193
 v_mfma_f32_16x16x32_bf16 v[36:39], a[216:219], v[168:171], v[36:39]
 s_waitcnt lgkmcnt(11)
 ds_read_b64_tr_b16 a[246:247], v177 offset:22528
 v_mul_f32 v53, v53, v193
 v_mfma_f32_16x16x32_bf16 v[36:39], a[220:223], v[172:175], v[36:39]
 ds_read_b64_tr_b16 a[248:249], v177 offset:24576
 v_mul_f32 v54, v54, v193
 v_mfma_f32_16x16x32_bf16 v[32:35], a[220:223], v[140:143], v[32:35]
 s_waitcnt lgkmcnt(11)
 ds_read_b64_tr_b16 a[250:251], v177 offset:26624
 v_mul_f32 v55, v55, v193
 v_mfma_f32_16x16x32_bf16 v[40:43], a[224:227], v[112:115], v[40:43]
 s_add_u32 m0, s76, 114688
 s_add_u32 s91, s6, 115328
 ds_read_b64_tr_b16 a[252:253], v177 offset:28672
 v_mul_f32 v56, v56, v192
 v_mfma_f32_16x16x32_bf16 v[44:47], a[224:227], v[144:147], v[44:47]
 s_waitcnt lgkmcnt(11)
 ds_read_b64_tr_b16 a[254:255], v177 offset:30720
 buffer_load_dwordx4 v10, s[56:59], s91 offen offset:0 lds
 v_mfma_f32_16x16x32_bf16 v[44:47], a[228:231], v[148:151], v[44:47]
 ds_read_b64_tr_b16 a[192:193], v178 offset:0
 v_mul_f32 v57, v57, v192
 v_mfma_f32_16x16x32_bf16 v[40:43], a[228:231], v[116:119], v[40:43]
 s_waitcnt lgkmcnt(11)
 ds_read_b64_tr_b16 a[194:195], v178 offset:2048
 v_mul_f32 v58, v58, v192
 v_mfma_f32_16x16x32_bf16 v[40:43], a[232:235], v[120:123], v[40:43]
 ds_read_b64_tr_b16 a[196:197], v178 offset:4096
 v_mul_f32 v59, v59, v192
 v_mfma_f32_16x16x32_bf16 v[44:47], a[232:235], v[152:155], v[44:47]
 s_waitcnt lgkmcnt(11)
 ds_read_b64_tr_b16 a[198:199], v178 offset:6144
 v_mul_f32 v60, v60, v193
 v_mfma_f32_16x16x32_bf16 v[44:47], a[236:239], v[156:159], v[44:47]
 ds_read_b64_tr_b16 a[200:201], v178 offset:8192
 buffer_load_dwordx4 v11, s[56:59], s91 offen offset:1024 lds
 v_mfma_f32_16x16x32_bf16 v[40:43], a[236:239], v[124:127], v[40:43]
 s_waitcnt lgkmcnt(11)
 ds_read_b64_tr_b16 a[202:203], v178 offset:10240
 v_mul_f32 v61, v61, v193
 v_mfma_f32_16x16x32_bf16 v[40:43], a[240:243], v[128:131], v[40:43]
 ds_read_b64_tr_b16 a[204:205], v178 offset:12288
 v_mul_f32 v62, v62, v193
 v_mfma_f32_16x16x32_bf16 v[44:47], a[240:243], v[160:163], v[44:47]
 s_waitcnt lgkmcnt(11)
 ds_read_b64_tr_b16 a[206:207], v178 offset:14336
 v_mul_f32 v63, v63, v193
 v_mfma_f32_16x16x32_bf16 v[44:47], a[244:247], v[164:167], v[44:47]
 ds_read_b64_tr_b16 a[208:209], v178 offset:16384
 v_cndmask_b32 v81, 0, v99, vcc
 v_mfma_f32_16x16x32_bf16 v[40:43], a[244:247], v[132:135], v[40:43]
 s_waitcnt lgkmcnt(11)
 ds_read_b64_tr_b16 a[210:211], v178 offset:18432
 buffer_load_dwordx4 v12, s[56:59], s91 offen offset:2048 lds
 v_mfma_f32_16x16x32_bf16 v[40:43], a[248:251], v[136:139], v[40:43]
 ds_read_b64_tr_b16 a[212:213], v178 offset:20480
 v_cmp_eq_u32 vcc, 2, v97
 v_mfma_f32_16x16x32_bf16 v[44:47], a[248:251], v[168:171], v[44:47]
 s_waitcnt lgkmcnt(11)
 ds_read_b64_tr_b16 a[214:215], v178 offset:22528
 v_cndmask_b32 v82, 0, v99, vcc
 v_mfma_f32_16x16x32_bf16 v[44:47], a[252:255], v[172:175], v[44:47]
 ds_read_b64_tr_b16 a[216:217], v178 offset:24576
 v_cmp_eq_u32 vcc, 3, v97
 v_mfma_f32_16x16x32_bf16 v[40:43], a[252:255], v[140:143], v[40:43]
 s_waitcnt lgkmcnt(11)
 ds_read_b64_tr_b16 a[218:219], v178 offset:26624
 v_cndmask_b32 v83, 0, v99, vcc
 v_mfma_f32_16x16x32_bf16 v[48:51], a[192:195], v[112:115], v[48:51]
 ds_read_b64_tr_b16 a[220:221], v178 offset:28672
 v_add_u32 v99, 1, v96
 v_mfma_f32_16x16x32_bf16 v[52:55], a[192:195], v[144:147], v[52:55]
 s_waitcnt lgkmcnt(11)
 ds_read_b64_tr_b16 a[222:223], v178 offset:30720
 buffer_load_dwordx4 v13, s[56:59], s91 offen offset:3072 lds
 v_mfma_f32_16x16x32_bf16 v[52:55], a[196:199], v[148:151], v[52:55]
 ds_read_b64_tr_b16 a[224:225], v179 offset:0
 v_cmp_eq_u32 vcc, v99, v95
 v_mfma_f32_16x16x32_bf16 v[48:51], a[196:199], v[116:119], v[48:51]
 s_waitcnt lgkmcnt(11)
 ds_read_b64_tr_b16 a[226:227], v179 offset:2048
 v_cndmask_b32 v99, 0, v98, vcc
 v_mfma_f32_16x16x32_bf16 v[48:51], a[200:203], v[120:123], v[48:51]
 ds_read_b64_tr_b16 a[228:229], v179 offset:4096
 v_cvt_pk_bf16_f32 v64, v32, v33
 v_mfma_f32_16x16x32_bf16 v[52:55], a[200:203], v[152:155], v[52:55]
 s_waitcnt lgkmcnt(11)
 s_add_u32 m0, s76, 131072
 s_add_u32 s91, s7, 768
 ds_read_b64_tr_b16 a[230:231], v179 offset:6144
 v_cvt_pk_bf16_f32 v65, v34, v35
 v_mfma_f32_16x16x32_bf16 v[52:55], a[204:207], v[156:159], v[52:55]
 ds_read_b64_tr_b16 a[232:233], v179 offset:8192
 buffer_load_dwordx4 v10, s[60:63], s91 offen offset:0 lds
 v_mfma_f32_16x16x32_bf16 v[48:51], a[204:207], v[124:127], v[48:51]
 s_waitcnt lgkmcnt(11)
 ds_read_b64_tr_b16 a[234:235], v179 offset:10240
 v_cvt_pk_bf16_f32 v66, v40, v41
 v_mfma_f32_16x16x32_bf16 v[48:51], a[208:211], v[128:131], v[48:51]
 ds_read_b64_tr_b16 a[236:237], v179 offset:12288
 v_cvt_pk_bf16_f32 v67, v42, v43
 v_mfma_f32_16x16x32_bf16 v[52:55], a[208:211], v[160:163], v[52:55]
 s_waitcnt lgkmcnt(11)
 s_add_u32 s92, s8, 98304
 ds_read_b64_tr_b16 a[238:239], v179 offset:14336
 buffer_store_dwordx4 v[64:67], v21, s[36:39], s92 offen sc1
 v_mfma_f32_16x16x32_bf16 v[52:55], a[212:215], v[164:167], v[52:55]
 ds_read_b64_tr_b16 a[240:241], v179 offset:16384
 v_cvt_pk_bf16_f32 v68, v36, v37
 v_mfma_f32_16x16x32_bf16 v[48:51], a[212:215], v[132:135], v[48:51]
 s_waitcnt lgkmcnt(11)
 ds_read_b64_tr_b16 a[242:243], v179 offset:18432
 buffer_load_dwordx4 v11, s[60:63], s91 offen offset:1024 lds
 v_mfma_f32_16x16x32_bf16 v[48:51], a[216:219], v[136:139], v[48:51]
 ds_read_b64_tr_b16 a[244:245], v179 offset:20480
 v_cvt_pk_bf16_f32 v69, v38, v39
 v_mfma_f32_16x16x32_bf16 v[52:55], a[216:219], v[168:171], v[52:55]
 s_waitcnt lgkmcnt(11)
 ds_read_b64_tr_b16 a[246:247], v179 offset:22528
 v_cvt_pk_bf16_f32 v70, v44, v45
 v_mfma_f32_16x16x32_bf16 v[52:55], a[220:223], v[172:175], v[52:55]
 ds_read_b64_tr_b16 a[248:249], v179 offset:24576
 v_cvt_pk_bf16_f32 v71, v46, v47
 v_mfma_f32_16x16x32_bf16 v[48:51], a[220:223], v[140:143], v[48:51]
 s_waitcnt lgkmcnt(11)
 s_add_u32 s92, s9, 98304
 ds_read_b64_tr_b16 a[250:251], v179 offset:26624
 buffer_store_dwordx4 v[68:71], v21, s[36:39], s92 offen sc1
 v_mfma_f32_16x16x32_bf16 v[56:59], a[224:227], v[112:115], v[56:59]
 ds_read_b64_tr_b16 a[252:253], v179 offset:28672
 v_cmp_eq_u32 vcc, 0, v97
 v_mfma_f32_16x16x32_bf16 v[60:63], a[224:227], v[144:147], v[60:63]
 s_waitcnt lgkmcnt(11)
 ds_read_b64_tr_b16 a[254:255], v179 offset:30720
 buffer_load_dwordx4 v12, s[60:63], s91 offen offset:2048 lds
 v_mfma_f32_16x16x32_bf16 v[60:63], a[228:231], v[148:151], v[60:63]
 ds_read_b64_tr_b16 a[192:193], v176 offset:32768
 v_cndmask_b32 v84, 0, v99, vcc
 v_mfma_f32_16x16x32_bf16 v[56:59], a[228:231], v[116:119], v[56:59]
 s_waitcnt lgkmcnt(11)
 ds_read_b64_tr_b16 a[194:195], v176 offset:34816
 v_cmp_eq_u32 vcc, 1, v97
 v_mfma_f32_16x16x32_bf16 v[56:59], a[232:235], v[120:123], v[56:59]
 ds_read_b64_tr_b16 a[196:197], v176 offset:36864
 v_cndmask_b32 v85, 0, v99, vcc
 v_mfma_f32_16x16x32_bf16 v[60:63], a[232:235], v[152:155], v[60:63]
 s_waitcnt lgkmcnt(11)
 ds_read_b64_tr_b16 a[198:199], v176 offset:38912
 v_cmp_eq_u32 vcc, 2, v97
 v_mfma_f32_16x16x32_bf16 v[60:63], a[236:239], v[156:159], v[60:63]
 ds_read_b64_tr_b16 a[200:201], v176 offset:40960
 buffer_load_dwordx4 v13, s[60:63], s91 offen offset:3072 lds
 v_mfma_f32_16x16x32_bf16 v[56:59], a[236:239], v[124:127], v[56:59]
 s_waitcnt lgkmcnt(11)
 ds_read_b64_tr_b16 a[202:203], v176 offset:43008
 v_cndmask_b32 v86, 0, v99, vcc
 v_mfma_f32_16x16x32_bf16 v[56:59], a[240:243], v[128:131], v[56:59]
 ds_read_b64_tr_b16 a[204:205], v177 offset:32768
 v_cmp_eq_u32 vcc, 3, v97
 v_mfma_f32_16x16x32_bf16 v[60:63], a[240:243], v[160:163], v[60:63]
 s_waitcnt lgkmcnt(11)
 ds_read_b64_tr_b16 a[206:207], v177 offset:34816
 v_cndmask_b32 v87, 0, v99, vcc
 v_mfma_f32_16x16x32_bf16 v[60:63], a[244:247], v[164:167], v[60:63]
 ds_read_b64_tr_b16 a[208:209], v177 offset:36864
 v_mfma_f32_16x16x32_bf16 v[56:59], a[244:247], v[132:135], v[56:59]
 s_waitcnt lgkmcnt(11)
 ds_read_b64_tr_b16 a[210:211], v177 offset:38912
 v_mfma_f32_16x16x32_bf16 v[56:59], a[248:251], v[136:139], v[56:59]
 ds_read_b64_tr_b16 a[212:213], v177 offset:40960
 v_mfma_f32_16x16x32_bf16 v[60:63], a[248:251], v[168:171], v[60:63]
 s_waitcnt lgkmcnt(11)
 ds_read_b64_tr_b16 a[214:215], v177 offset:43008
 v_mfma_f32_16x16x32_bf16 v[60:63], a[252:255], v[172:175], v[60:63]
 ds_read_b64_tr_b16 a[216:217], v178 offset:32768
 v_mfma_f32_16x16x32_bf16 v[56:59], a[252:255], v[140:143], v[56:59]
 ds_read_b64_tr_b16 a[218:219], v178 offset:34816
 s_waitcnt lgkmcnt(12)
 v_mfma_f32_16x16x32_bf16 v[32:35], a[192:195], a[128:131], 0
 ds_read_b64_tr_b16 a[220:221], v178 offset:36864
 v_mfma_f32_16x16x32_bf16 v[36:39], a[192:195], a[144:147], 0
 s_waitcnt lgkmcnt(11)
 ds_read_b64_tr_b16 a[222:223], v178 offset:38912
 v_cvt_pk_bf16_f32 v72, v48, v49
 v_mfma_f32_16x16x32_bf16 v[36:39], a[196:199], a[148:151], v[36:39]
 ds_read_b64_tr_b16 a[224:225], v178 offset:40960
 v_cvt_pk_bf16_f32 v73, v50, v51
 v_mfma_f32_16x16x32_bf16 v[32:35], a[196:199], a[132:135], v[32:35]
 s_waitcnt lgkmcnt(11)
 ds_read_b64_tr_b16 a[226:227], v178 offset:43008
 v_cvt_pk_bf16_f32 v74, v56, v57
 v_mfma_f32_16x16x32_bf16 v[32:35], a[200:203], a[136:139], v[32:35]
 ds_read_b64_tr_b16 a[228:229], v179 offset:32768
 v_cvt_pk_bf16_f32 v75, v58, v59
 v_mfma_f32_16x16x32_bf16 v[36:39], a[200:203], a[152:155], v[36:39]
 s_waitcnt lgkmcnt(11)
 s_add_u32 s92, s8, 114688
 ds_read_b64_tr_b16 a[230:231], v179 offset:34816
 buffer_store_dwordx4 v[72:75], v21, s[36:39], s92 offen sc1
 v_mfma_f32_16x16x32_bf16 v[44:47], a[204:207], a[144:147], 0
 ds_read_b64_tr_b16 a[232:233], v179 offset:36864
 v_cvt_pk_bf16_f32 v76, v52, v53
 v_mfma_f32_16x16x32_bf16 v[40:43], a[204:207], a[128:131], 0
 s_waitcnt lgkmcnt(11)
 ds_read_b64_tr_b16 a[234:235], v179 offset:38912
 v_cvt_pk_bf16_f32 v77, v54, v55
 v_mfma_f32_16x16x32_bf16 v[40:43], a[208:211], a[132:135], v[40:43]
 ds_read_b64_tr_b16 a[236:237], v179 offset:40960
 v_cvt_pk_bf16_f32 v78, v60, v61
 v_mfma_f32_16x16x32_bf16 v[44:47], a[208:211], a[148:151], v[44:47]
 s_waitcnt lgkmcnt(11)
 s_waitcnt vmcnt(17)
 s_barrier
 ds_read_b64_tr_b16 a[238:239], v179 offset:43008
 v_mfma_f32_16x16x32_bf16 v[44:47], a[212:215], a[152:155], v[44:47]
 ds_read_b64_tr_b16 a[240:241], v176 offset:49152
 v_cvt_pk_bf16_f32 v79, v62, v63
 v_mfma_f32_16x16x32_bf16 v[40:43], a[212:215], a[136:139], v[40:43]
 s_waitcnt lgkmcnt(11)
 s_add_u32 s92, s9, 114688
 ds_read_b64_tr_b16 a[242:243], v176 offset:51200
 buffer_store_dwordx4 v[76:79], v21, s[36:39], s92 offen sc1
 v_mfma_f32_16x16x32_bf16 v[48:51], a[216:219], a[128:131], 0
 ds_read_b64_tr_b16 a[244:245], v176 offset:53248
 v_mul_f32 v32, v32, v192
 v_mfma_f32_16x16x32_bf16 v[52:55], a[216:219], a[144:147], 0
 s_waitcnt lgkmcnt(11)
 ds_read_b64_tr_b16 a[246:247], v176 offset:55296
 v_mul_f32 v33, v33, v192
 v_mfma_f32_16x16x32_bf16 v[52:55], a[220:223], a[148:151], v[52:55]
 ds_read_b64_tr_b16 a[248:249], v176 offset:57344
 v_mul_f32 v34, v34, v192
 v_mfma_f32_16x16x32_bf16 v[48:51], a[220:223], a[132:135], v[48:51]
 s_waitcnt lgkmcnt(11)
 ds_read_b64_tr_b16 a[250:251], v176 offset:59392
 v_mul_f32 v35, v35, v192
 v_mfma_f32_16x16x32_bf16 v[48:51], a[224:227], a[136:139], v[48:51]
 ds_read_b64_tr_b16 a[252:253], v176 offset:61440
 v_mul_f32 v36, v36, v193
 v_mfma_f32_16x16x32_bf16 v[52:55], a[224:227], a[152:155], v[52:55]
 s_waitcnt lgkmcnt(11)
 ds_read_b64_tr_b16 a[254:255], v176 offset:63488
 v_mul_f32 v37, v37, v193
 v_mfma_f32_16x16x32_bf16 v[60:63], a[228:231], a[144:147], 0
 s_add_u32 m0, s76, 147456
 s_add_u32 s91, s6, 768
 ds_read_b64_tr_b16 a[192:193], v180 offset:0
 v_mul_f32 v38, v38, v193
 v_mfma_f32_16x16x32_bf16 v[56:59], a[228:231], a[128:131], 0
 s_waitcnt lgkmcnt(11)
 ds_read_b64_tr_b16 a[194:195], v180 offset:2048
 buffer_load_dwordx4 v10, s[56:59], s91 offen offset:0 lds
 v_mfma_f32_16x16x32_bf16 v[56:59], a[232:235], a[132:135], v[56:59]
 ds_read_b64_tr_b16 a[196:197], v180 offset:4096
 v_mul_f32 v39, v39, v193
 v_mfma_f32_16x16x32_bf16 v[60:63], a[232:235], a[148:151], v[60:63]
 s_waitcnt lgkmcnt(11)
 ds_read_b64_tr_b16 a[198:199], v180 offset:6144
 v_mul_f32 v40, v40, v192
 v_mfma_f32_16x16x32_bf16 v[60:63], a[236:239], a[152:155], v[60:63]
 ds_read_b64_tr_b16 a[200:201], v180 offset:8192
 v_mul_f32 v41, v41, v192
 v_mfma_f32_16x16x32_bf16 v[56:59], a[236:239], a[136:139], v[56:59]
 s_waitcnt lgkmcnt(11)
 ds_read_b64_tr_b16 a[202:203], v180 offset:10240
 v_mul_f32 v42, v42, v192
 v_mfma_f32_16x16x32_bf16 v[32:35], a[240:243], v[112:115], v[32:35]
 ds_read_b64_tr_b16 a[204:205], v180 offset:12288
 v_mul_f32 v43, v43, v192
 v_mfma_f32_16x16x32_bf16 v[36:39], a[240:243], v[144:147], v[36:39]
 s_waitcnt lgkmcnt(11)
 ds_read_b64_tr_b16 a[206:207], v180 offset:14336
 buffer_load_dwordx4 v11, s[56:59], s91 offen offset:1024 lds
 v_mfma_f32_16x16x32_bf16 v[36:39], a[244:247], v[148:151], v[36:39]
 ds_read_b64_tr_b16 a[208:209], v177 offset:49152
 v_mul_f32 v44, v44, v193
 v_mfma_f32_16x16x32_bf16 v[32:35], a[244:247], v[116:119], v[32:35]
 s_waitcnt lgkmcnt(11)
 ds_read_b64_tr_b16 a[210:211], v177 offset:51200
 v_mul_f32 v45, v45, v193
 v_mfma_f32_16x16x32_bf16 v[32:35], a[248:251], v[120:123], v[32:35]
 ds_read_b64_tr_b16 a[212:213], v177 offset:53248
 v_mul_f32 v46, v46, v193
 v_mfma_f32_16x16x32_bf16 v[36:39], a[248:251], v[152:155], v[36:39]
 s_waitcnt lgkmcnt(11)
 ds_read_b64_tr_b16 a[214:215], v177 offset:55296
 v_mul_f32 v47, v47, v193
 v_mfma_f32_16x16x32_bf16 v[36:39], a[252:255], v[156:159], v[36:39]
 ds_read_b64_tr_b16 a[216:217], v177 offset:57344
 buffer_load_dwordx4 v12, s[56:59], s91 offen offset:2048 lds
 v_mfma_f32_16x16x32_bf16 v[32:35], a[252:255], v[124:127], v[32:35]
 s_waitcnt lgkmcnt(11)
 ds_read_b64_tr_b16 a[218:219], v177 offset:59392
 v_mul_f32 v48, v48, v192
 v_mfma_f32_16x16x32_bf16 v[32:35], a[192:195], v[128:131], v[32:35]
 ds_read_b64_tr_b16 a[220:221], v177 offset:61440
 v_mul_f32 v49, v49, v192
 v_mfma_f32_16x16x32_bf16 v[36:39], a[192:195], v[160:163], v[36:39]
 s_waitcnt lgkmcnt(11)
 ds_read_b64_tr_b16 a[222:223], v177 offset:63488
 v_mul_f32 v50, v50, v192
 v_mfma_f32_16x16x32_bf16 v[36:39], a[196:199], v[164:167], v[36:39]
 ds_read_b64_tr_b16 a[224:225], v181 offset:0
 v_mul_f32 v51, v51, v192
 v_mfma_f32_16x16x32_bf16 v[32:35], a[196:199], v[132:135], v[32:35]
 s_waitcnt lgkmcnt(11)
 ds_read_b64_tr_b16 a[226:227], v181 offset:2048
 buffer_load_dwordx4 v13, s[56:59], s91 offen offset:3072 lds
 v_mfma_f32_16x16x32_bf16 v[32:35], a[200:203], v[136:139], v[32:35]
 ds_read_b64_tr_b16 a[228:229], v181 offset:4096
 v_mul_f32 v52, v52, v193
 v_mfma_f32_16x16x32_bf16 v[36:39], a[200:203], v[168:171], v[36:39]
 s_waitcnt lgkmcnt(11)
 ds_read_b64_tr_b16 a[230:231], v181 offset:6144
 v_mul_f32 v53, v53, v193
 v_mfma_f32_16x16x32_bf16 v[36:39], a[204:207], v[172:175], v[36:39]
 ds_read_b64_tr_b16 a[232:233], v181 offset:8192
 v_mul_f32 v54, v54, v193
 v_mfma_f32_16x16x32_bf16 v[32:35], a[204:207], v[140:143], v[32:35]
 s_waitcnt lgkmcnt(11)
 ds_read_b64_tr_b16 a[234:235], v181 offset:10240
 v_mul_f32 v55, v55, v193
 v_mfma_f32_16x16x32_bf16 v[40:43], a[208:211], v[112:115], v[40:43]
 s_add_u32 m0, s76, 0
 s_add_u32 s91, s6, 115456
 ds_read_b64_tr_b16 a[236:237], v181 offset:12288
 v_mul_f32 v56, v56, v192
 v_mfma_f32_16x16x32_bf16 v[44:47], a[208:211], v[144:147], v[44:47]
 s_waitcnt lgkmcnt(11)
 ds_read_b64_tr_b16 a[238:239], v181 offset:14336
 buffer_load_dwordx4 v10, s[56:59], s91 offen offset:0 lds
 v_mfma_f32_16x16x32_bf16 v[44:47], a[212:215], v[148:151], v[44:47]
 ds_read_b64_tr_b16 a[240:241], v178 offset:49152
 v_mul_f32 v57, v57, v192
 v_mfma_f32_16x16x32_bf16 v[40:43], a[212:215], v[116:119], v[40:43]
 s_waitcnt lgkmcnt(11)
 ds_read_b64_tr_b16 a[242:243], v178 offset:51200
 v_mul_f32 v58, v58, v192
 v_mfma_f32_16x16x32_bf16 v[40:43], a[216:219], v[120:123], v[40:43]
 ds_read_b64_tr_b16 a[244:245], v178 offset:53248
 v_mul_f32 v59, v59, v192
 v_mfma_f32_16x16x32_bf16 v[44:47], a[216:219], v[152:155], v[44:47]
 s_waitcnt lgkmcnt(11)
 ds_read_b64_tr_b16 a[246:247], v178 offset:55296
 v_mul_f32 v60, v60, v193
 v_mfma_f32_16x16x32_bf16 v[44:47], a[220:223], v[156:159], v[44:47]
 ds_read_b64_tr_b16 a[248:249], v178 offset:57344
 buffer_load_dwordx4 v11, s[56:59], s91 offen offset:1024 lds
 v_mfma_f32_16x16x32_bf16 v[40:43], a[220:223], v[124:127], v[40:43]
 s_waitcnt lgkmcnt(11)
 ds_read_b64_tr_b16 a[250:251], v178 offset:59392
 v_mul_f32 v61, v61, v193
 v_mfma_f32_16x16x32_bf16 v[40:43], a[224:227], v[128:131], v[40:43]
 ds_read_b64_tr_b16 a[252:253], v178 offset:61440
 v_mul_f32 v62, v62, v193
 v_mfma_f32_16x16x32_bf16 v[44:47], a[224:227], v[160:163], v[44:47]
 s_waitcnt lgkmcnt(11)
 ds_read_b64_tr_b16 a[254:255], v178 offset:63488
 v_mul_f32 v63, v63, v193
 v_mfma_f32_16x16x32_bf16 v[44:47], a[228:231], v[164:167], v[44:47]
 ds_read_b64_tr_b16 a[192:193], v182 offset:0
 v_mfma_f32_16x16x32_bf16 v[40:43], a[228:231], v[132:135], v[40:43]
 s_waitcnt lgkmcnt(11)
 ds_read_b64_tr_b16 a[194:195], v182 offset:2048
 buffer_load_dwordx4 v12, s[56:59], s91 offen offset:2048 lds
 v_mfma_f32_16x16x32_bf16 v[40:43], a[232:235], v[136:139], v[40:43]
 ds_read_b64_tr_b16 a[196:197], v182 offset:4096
 v_mfma_f32_16x16x32_bf16 v[44:47], a[232:235], v[168:171], v[44:47]
 s_waitcnt lgkmcnt(11)
 ds_read_b64_tr_b16 a[198:199], v182 offset:6144
 v_mfma_f32_16x16x32_bf16 v[44:47], a[236:239], v[172:175], v[44:47]
 ds_read_b64_tr_b16 a[200:201], v182 offset:8192
 v_mfma_f32_16x16x32_bf16 v[40:43], a[236:239], v[140:143], v[40:43]
 s_waitcnt lgkmcnt(11)
 ds_read_b64_tr_b16 a[202:203], v182 offset:10240
 v_mfma_f32_16x16x32_bf16 v[48:51], a[240:243], v[112:115], v[48:51]
 ds_read_b64_tr_b16 a[204:205], v182 offset:12288
 v_mfma_f32_16x16x32_bf16 v[52:55], a[240:243], v[144:147], v[52:55]
 s_waitcnt lgkmcnt(11)
 ds_read_b64_tr_b16 a[206:207], v182 offset:14336
 buffer_load_dwordx4 v13, s[56:59], s91 offen offset:3072 lds
 v_mfma_f32_16x16x32_bf16 v[52:55], a[244:247], v[148:151], v[52:55]
 ds_read_b64_tr_b16 a[208:209], v179 offset:49152
 v_mfma_f32_16x16x32_bf16 v[48:51], a[244:247], v[116:119], v[48:51]
 s_waitcnt lgkmcnt(11)
 ds_read_b64_tr_b16 a[210:211], v179 offset:51200
 v_mfma_f32_16x16x32_bf16 v[48:51], a[248:251], v[120:123], v[48:51]
 ds_read_b64_tr_b16 a[212:213], v179 offset:53248
 v_cvt_pk_bf16_f32 v64, v32, v33
 v_mfma_f32_16x16x32_bf16 v[52:55], a[248:251], v[152:155], v[52:55]
 s_waitcnt lgkmcnt(11)
 ds_read_b64_tr_b16 a[214:215], v179 offset:55296
 v_cvt_pk_bf16_f32 v65, v34, v35
 v_mfma_f32_16x16x32_bf16 v[52:55], a[252:255], v[156:159], v[52:55]
 s_waitcnt vmcnt(24)
 ds_read_b64_tr_b16 a[216:217], v179 offset:57344
 v_cvt_pk_bf16_f32 v66, v40, v41
 v_mfma_f32_16x16x32_bf16 v[48:51], a[252:255], v[124:127], v[48:51]
 s_waitcnt lgkmcnt(11)
 ds_read_b64_tr_b16 a[218:219], v179 offset:59392
 v_cvt_pk_bf16_f32 v67, v42, v43
 s_mov_b64 exec, 1
 buffer_store_dwordx2 v[28:29], v21, s[36:39], s13 offen offset:0 sc1
 s_mov_b64 exec, -1
 v_mfma_f32_16x16x32_bf16 v[48:51], a[192:195], v[128:131], v[48:51]
 s_add_u32 s92, s8, 131072
 ds_read_b64_tr_b16 a[220:221], v179 offset:61440
 buffer_store_dwordx4 v[64:67], v21, s[36:39], s92 offen sc1
 v_mfma_f32_16x16x32_bf16 v[52:55], a[192:195], v[160:163], v[52:55]
 s_waitcnt lgkmcnt(11)
 ds_read_b64_tr_b16 a[222:223], v179 offset:63488
 v_cvt_pk_bf16_f32 v68, v36, v37
 v_mfma_f32_16x16x32_bf16 v[52:55], a[196:199], v[164:167], v[52:55]
 ds_read_b64_tr_b16 a[224:225], v183 offset:0
 v_cvt_pk_bf16_f32 v69, v38, v39
 v_mfma_f32_16x16x32_bf16 v[48:51], a[196:199], v[132:135], v[48:51]
 s_waitcnt lgkmcnt(11)
 ds_read_b64_tr_b16 a[226:227], v183 offset:2048
 v_cvt_pk_bf16_f32 v70, v44, v45
 v_mfma_f32_16x16x32_bf16 v[48:51], a[200:203], v[136:139], v[48:51]
 ds_read_b64_tr_b16 a[228:229], v183 offset:4096
 v_cvt_pk_bf16_f32 v71, v46, v47
 v_mfma_f32_16x16x32_bf16 v[52:55], a[200:203], v[168:171], v[52:55]
 s_waitcnt lgkmcnt(11)
 s_add_u32 s92, s9, 131072
 ds_read_b64_tr_b16 a[230:231], v183 offset:6144
 buffer_store_dwordx4 v[68:71], v21, s[36:39], s92 offen sc1
 v_mfma_f32_16x16x32_bf16 v[52:55], a[204:207], v[172:175], v[52:55]
 ds_read_b64_tr_b16 a[232:233], v183 offset:8192
 v_mfma_f32_16x16x32_bf16 v[48:51], a[204:207], v[140:143], v[48:51]
 s_waitcnt lgkmcnt(11)
 ds_read_b64_tr_b16 a[234:235], v183 offset:10240
 v_mfma_f32_16x16x32_bf16 v[56:59], a[208:211], v[112:115], v[56:59]
 ds_read_b64_tr_b16 a[236:237], v183 offset:12288
 v_mfma_f32_16x16x32_bf16 v[60:63], a[208:211], v[144:147], v[60:63]
 s_waitcnt lgkmcnt(11)
 ds_read_b64_tr_b16 a[238:239], v183 offset:14336
 v_mfma_f32_16x16x32_bf16 v[60:63], a[212:215], v[148:151], v[60:63]
 ds_read_b64_tr_b16 a[240:241], v180 offset:16384
 v_mfma_f32_16x16x32_bf16 v[56:59], a[212:215], v[116:119], v[56:59]
 s_waitcnt lgkmcnt(11)
 ds_read_b64_tr_b16 a[242:243], v180 offset:18432
 v_mfma_f32_16x16x32_bf16 v[56:59], a[216:219], v[120:123], v[56:59]
 ds_read_b64_tr_b16 a[244:245], v180 offset:20480
 v_mfma_f32_16x16x32_bf16 v[60:63], a[216:219], v[152:155], v[60:63]
 s_waitcnt lgkmcnt(11)
 ds_read_b64_tr_b16 a[246:247], v180 offset:22528
 v_mfma_f32_16x16x32_bf16 v[60:63], a[220:223], v[156:159], v[60:63]
 ds_read_b64_tr_b16 a[248:249], v180 offset:24576
 v_mfma_f32_16x16x32_bf16 v[56:59], a[220:223], v[124:127], v[56:59]
 s_waitcnt lgkmcnt(11)
 ds_read_b64_tr_b16 a[250:251], v180 offset:26624
 v_mfma_f32_16x16x32_bf16 v[56:59], a[224:227], v[128:131], v[56:59]
 ds_read_b64_tr_b16 a[252:253], v181 offset:16384
 v_mfma_f32_16x16x32_bf16 v[60:63], a[224:227], v[160:163], v[60:63]
 s_waitcnt lgkmcnt(11)
 ds_read_b64_tr_b16 a[254:255], v181 offset:18432
 v_mfma_f32_16x16x32_bf16 v[60:63], a[228:231], v[164:167], v[60:63]
 ds_read_b64_tr_b16 a[192:193], v181 offset:20480
 v_mfma_f32_16x16x32_bf16 v[56:59], a[228:231], v[132:135], v[56:59]
 s_waitcnt lgkmcnt(11)
 ds_read_b64_tr_b16 a[194:195], v181 offset:22528
 v_mfma_f32_16x16x32_bf16 v[56:59], a[232:235], v[136:139], v[56:59]
 ds_read_b64_tr_b16 a[196:197], v181 offset:24576
 v_mfma_f32_16x16x32_bf16 v[60:63], a[232:235], v[168:171], v[60:63]
 s_waitcnt lgkmcnt(11)
 ds_read_b64_tr_b16 a[198:199], v181 offset:26624
 v_mfma_f32_16x16x32_bf16 v[60:63], a[236:239], v[172:175], v[60:63]
 ds_read_b64_tr_b16 a[200:201], v182 offset:16384
 v_mfma_f32_16x16x32_bf16 v[56:59], a[236:239], v[140:143], v[56:59]
 ds_read_b64_tr_b16 a[202:203], v182 offset:18432
 s_waitcnt lgkmcnt(12)
 v_mfma_f32_16x16x32_bf16 v[32:35], a[240:243], a[128:131], 0
 ds_read_b64_tr_b16 a[204:205], v182 offset:20480
 v_mfma_f32_16x16x32_bf16 v[36:39], a[240:243], a[144:147], 0
 s_waitcnt lgkmcnt(11)
 ds_read_b64_tr_b16 a[206:207], v182 offset:22528
 v_cvt_pk_bf16_f32 v72, v48, v49
 v_mfma_f32_16x16x32_bf16 v[36:39], a[244:247], a[148:151], v[36:39]
 ds_read_b64_tr_b16 a[208:209], v182 offset:24576
 v_cvt_pk_bf16_f32 v73, v50, v51
 v_mfma_f32_16x16x32_bf16 v[32:35], a[244:247], a[132:135], v[32:35]
 s_waitcnt lgkmcnt(11)
 ds_read_b64_tr_b16 a[210:211], v182 offset:26624
 v_cvt_pk_bf16_f32 v74, v56, v57
 v_mfma_f32_16x16x32_bf16 v[32:35], a[248:251], a[136:139], v[32:35]
 ds_read_b64_tr_b16 a[212:213], v183 offset:16384
 v_cvt_pk_bf16_f32 v75, v58, v59
 v_mfma_f32_16x16x32_bf16 v[36:39], a[248:251], a[152:155], v[36:39]
 s_waitcnt lgkmcnt(11)
 s_add_u32 s92, s8, 147456
 ds_read_b64_tr_b16 a[214:215], v183 offset:18432
 buffer_store_dwordx4 v[72:75], v21, s[36:39], s92 offen sc1
 v_mfma_f32_16x16x32_bf16 v[44:47], a[252:255], a[144:147], 0
 ds_read_b64_tr_b16 a[216:217], v183 offset:20480
 v_cvt_pk_bf16_f32 v76, v52, v53
 v_mfma_f32_16x16x32_bf16 v[40:43], a[252:255], a[128:131], 0
 s_waitcnt lgkmcnt(11)
 ds_read_b64_tr_b16 a[218:219], v183 offset:22528
 v_cvt_pk_bf16_f32 v77, v54, v55
 v_mfma_f32_16x16x32_bf16 v[40:43], a[192:195], a[132:135], v[40:43]
 ds_read_b64_tr_b16 a[220:221], v183 offset:24576
 v_cvt_pk_bf16_f32 v78, v60, v61
 v_mfma_f32_16x16x32_bf16 v[44:47], a[192:195], a[148:151], v[44:47]
 s_waitcnt lgkmcnt(11)
 s_waitcnt vmcnt(14)
 s_barrier
 ds_read_b64_tr_b16 a[222:223], v183 offset:26624
 v_mfma_f32_16x16x32_bf16 v[44:47], a[196:199], a[152:155], v[44:47]
 ds_read_b64_tr_b16 a[224:225], v180 offset:32768
 v_cvt_pk_bf16_f32 v79, v62, v63
 v_mfma_f32_16x16x32_bf16 v[40:43], a[196:199], a[136:139], v[40:43]
 s_waitcnt lgkmcnt(11)
 s_add_u32 s92, s9, 147456
 ds_read_b64_tr_b16 a[226:227], v180 offset:34816
 buffer_store_dwordx4 v[76:79], v21, s[36:39], s92 offen sc1
 v_mfma_f32_16x16x32_bf16 v[48:51], a[200:203], a[128:131], 0
 ds_read_b64_tr_b16 a[228:229], v180 offset:36864
 v_mul_f32 v32, v32, v192
 v_mfma_f32_16x16x32_bf16 v[52:55], a[200:203], a[144:147], 0
 s_waitcnt lgkmcnt(11)
 ds_read_b64_tr_b16 a[230:231], v180 offset:38912
 v_mul_f32 v33, v33, v192
 v_mfma_f32_16x16x32_bf16 v[52:55], a[204:207], a[148:151], v[52:55]
 ds_read_b64_tr_b16 a[232:233], v180 offset:40960
 v_mul_f32 v34, v34, v192
 v_mfma_f32_16x16x32_bf16 v[48:51], a[204:207], a[132:135], v[48:51]
 s_waitcnt lgkmcnt(11)
 ds_read_b64_tr_b16 a[234:235], v180 offset:43008
 v_mul_f32 v35, v35, v192
 v_mfma_f32_16x16x32_bf16 v[48:51], a[208:211], a[136:139], v[48:51]
 ds_read_b64_tr_b16 a[236:237], v180 offset:45056
 v_mul_f32 v36, v36, v193
 v_mfma_f32_16x16x32_bf16 v[52:55], a[208:211], a[152:155], v[52:55]
 s_waitcnt lgkmcnt(11)
 ds_read_b64_tr_b16 a[238:239], v180 offset:47104
 v_mul_f32 v37, v37, v193
 v_mfma_f32_16x16x32_bf16 v[60:63], a[212:215], a[144:147], 0
 ds_read_b64_tr_b16 a[240:241], v180 offset:49152
 v_mul_f32 v38, v38, v193
 v_mfma_f32_16x16x32_bf16 v[56:59], a[212:215], a[128:131], 0
 s_waitcnt lgkmcnt(11)
 ds_read_b64_tr_b16 a[242:243], v180 offset:51200
 v_mul_f32 v39, v39, v193
 v_mfma_f32_16x16x32_bf16 v[56:59], a[216:219], a[132:135], v[56:59]
 ds_read_b64_tr_b16 a[244:245], v180 offset:53248
 v_mul_f32 v40, v40, v192
 v_mfma_f32_16x16x32_bf16 v[60:63], a[216:219], a[148:151], v[60:63]
 s_waitcnt lgkmcnt(11)
 ds_read_b64_tr_b16 a[246:247], v180 offset:55296
 v_mul_f32 v41, v41, v192
 v_mfma_f32_16x16x32_bf16 v[60:63], a[220:223], a[152:155], v[60:63]
 ds_read_b64_tr_b16 a[248:249], v180 offset:57344
 v_mul_f32 v42, v42, v192
 v_mfma_f32_16x16x32_bf16 v[56:59], a[220:223], a[136:139], v[56:59]
 s_waitcnt lgkmcnt(11)
 ds_read_b64_tr_b16 a[250:251], v180 offset:59392
 v_mul_f32 v43, v43, v192
 v_mfma_f32_16x16x32_bf16 v[32:35], a[224:227], v[112:115], v[32:35]
 ds_read_b64_tr_b16 a[252:253], v180 offset:61440
 v_mul_f32 v44, v44, v193
 v_mfma_f32_16x16x32_bf16 v[36:39], a[224:227], v[144:147], v[36:39]
 s_waitcnt lgkmcnt(11)
 ds_read_b64_tr_b16 a[254:255], v180 offset:63488
 v_mul_f32 v45, v45, v193
 v_mfma_f32_16x16x32_bf16 v[36:39], a[228:231], v[148:151], v[36:39]
 ds_read_b64_tr_b16 a[192:193], v181 offset:32768
 v_mul_f32 v46, v46, v193
 v_mfma_f32_16x16x32_bf16 v[32:35], a[228:231], v[116:119], v[32:35]
 s_waitcnt lgkmcnt(11)
 ds_read_b64_tr_b16 a[194:195], v181 offset:34816
 v_mul_f32 v47, v47, v193
 v_mfma_f32_16x16x32_bf16 v[32:35], a[232:235], v[120:123], v[32:35]
 ds_read_b64_tr_b16 a[196:197], v181 offset:36864
 v_mul_f32 v48, v48, v192
 v_mfma_f32_16x16x32_bf16 v[36:39], a[232:235], v[152:155], v[36:39]
 s_waitcnt lgkmcnt(11)
 ds_read_b64_tr_b16 a[198:199], v181 offset:38912
 v_mul_f32 v49, v49, v192
 v_mfma_f32_16x16x32_bf16 v[36:39], a[236:239], v[156:159], v[36:39]
 ds_read_b64_tr_b16 a[200:201], v181 offset:40960
 v_mul_f32 v50, v50, v192
 v_mfma_f32_16x16x32_bf16 v[32:35], a[236:239], v[124:127], v[32:35]
 s_waitcnt lgkmcnt(11)
 ds_read_b64_tr_b16 a[202:203], v181 offset:43008
 v_mul_f32 v51, v51, v192
 v_mfma_f32_16x16x32_bf16 v[32:35], a[240:243], v[128:131], v[32:35]
 ds_read_b64_tr_b16 a[204:205], v181 offset:45056
 v_mul_f32 v52, v52, v193
 v_mfma_f32_16x16x32_bf16 v[36:39], a[240:243], v[160:163], v[36:39]
 s_waitcnt lgkmcnt(11)
 ds_read_b64_tr_b16 a[206:207], v181 offset:47104
 v_mul_f32 v53, v53, v193
 v_mfma_f32_16x16x32_bf16 v[36:39], a[244:247], v[164:167], v[36:39]
 ds_read_b64_tr_b16 a[208:209], v181 offset:49152
 v_mul_f32 v54, v54, v193
 v_mfma_f32_16x16x32_bf16 v[32:35], a[244:247], v[132:135], v[32:35]
 s_waitcnt lgkmcnt(11)
 ds_read_b64_tr_b16 a[210:211], v181 offset:51200
 v_mul_f32 v55, v55, v193
 v_mfma_f32_16x16x32_bf16 v[32:35], a[248:251], v[136:139], v[32:35]
 ds_read_b64_tr_b16 a[212:213], v181 offset:53248
 v_mul_f32 v56, v56, v192
 v_mfma_f32_16x16x32_bf16 v[36:39], a[248:251], v[168:171], v[36:39]
 s_waitcnt lgkmcnt(11)
 ds_read_b64_tr_b16 a[214:215], v181 offset:55296
 v_mul_f32 v57, v57, v192
 v_mfma_f32_16x16x32_bf16 v[36:39], a[252:255], v[172:175], v[36:39]
 ds_read_b64_tr_b16 a[216:217], v181 offset:57344
 v_mul_f32 v58, v58, v192
 v_mfma_f32_16x16x32_bf16 v[32:35], a[252:255], v[140:143], v[32:35]
 s_waitcnt lgkmcnt(11)
 ds_read_b64_tr_b16 a[218:219], v181 offset:59392
 v_mul_f32 v59, v59, v192
 v_mfma_f32_16x16x32_bf16 v[40:43], a[192:195], v[112:115], v[40:43]
 ds_read_b64_tr_b16 a[220:221], v181 offset:61440
 v_mul_f32 v60, v60, v193
 v_mfma_f32_16x16x32_bf16 v[44:47], a[192:195], v[144:147], v[44:47]
 s_waitcnt lgkmcnt(11)
 ds_read_b64_tr_b16 a[222:223], v181 offset:63488
 v_mul_f32 v61, v61, v193
 v_mfma_f32_16x16x32_bf16 v[44:47], a[196:199], v[148:151], v[44:47]
 ds_read_b64_tr_b16 a[224:225], v182 offset:32768
 v_mul_f32 v62, v62, v193
 v_mfma_f32_16x16x32_bf16 v[40:43], a[196:199], v[116:119], v[40:43]
 s_waitcnt lgkmcnt(11)
 ds_read_b64_tr_b16 a[226:227], v182 offset:34816
 v_mul_f32 v63, v63, v193
 v_mfma_f32_16x16x32_bf16 v[40:43], a[200:203], v[120:123], v[40:43]
 ds_read_b64_tr_b16 a[228:229], v182 offset:36864
 v_mfma_f32_16x16x32_bf16 v[44:47], a[200:203], v[152:155], v[44:47]
 s_waitcnt lgkmcnt(11)
 ds_read_b64_tr_b16 a[230:231], v182 offset:38912
 v_mfma_f32_16x16x32_bf16 v[44:47], a[204:207], v[156:159], v[44:47]
 ds_read_b64_tr_b16 a[232:233], v182 offset:40960
 v_mfma_f32_16x16x32_bf16 v[40:43], a[204:207], v[124:127], v[40:43]
 s_waitcnt lgkmcnt(11)
 ds_read_b64_tr_b16 a[234:235], v182 offset:43008
 v_mfma_f32_16x16x32_bf16 v[40:43], a[208:211], v[128:131], v[40:43]
 ds_read_b64_tr_b16 a[236:237], v182 offset:45056
 v_mfma_f32_16x16x32_bf16 v[44:47], a[208:211], v[160:163], v[44:47]
 s_waitcnt lgkmcnt(11)
 ds_read_b64_tr_b16 a[238:239], v182 offset:47104
 v_mfma_f32_16x16x32_bf16 v[44:47], a[212:215], v[164:167], v[44:47]
 ds_read_b64_tr_b16 a[240:241], v182 offset:49152
 v_mfma_f32_16x16x32_bf16 v[40:43], a[212:215], v[132:135], v[40:43]
 s_waitcnt lgkmcnt(11)
 ds_read_b64_tr_b16 a[242:243], v182 offset:51200
 v_mfma_f32_16x16x32_bf16 v[40:43], a[216:219], v[136:139], v[40:43]
 ds_read_b64_tr_b16 a[244:245], v182 offset:53248
 v_mfma_f32_16x16x32_bf16 v[44:47], a[216:219], v[168:171], v[44:47]
 s_waitcnt lgkmcnt(11)
 ds_read_b64_tr_b16 a[246:247], v182 offset:55296
 v_mfma_f32_16x16x32_bf16 v[44:47], a[220:223], v[172:175], v[44:47]
 ds_read_b64_tr_b16 a[248:249], v182 offset:57344
 v_mfma_f32_16x16x32_bf16 v[40:43], a[220:223], v[140:143], v[40:43]
 s_waitcnt lgkmcnt(11)
 ds_read_b64_tr_b16 a[250:251], v182 offset:59392
 v_mfma_f32_16x16x32_bf16 v[48:51], a[224:227], v[112:115], v[48:51]
 ds_read_b64_tr_b16 a[252:253], v182 offset:61440
 v_mfma_f32_16x16x32_bf16 v[52:55], a[224:227], v[144:147], v[52:55]
 s_waitcnt lgkmcnt(11)
 ds_read_b64_tr_b16 a[254:255], v182 offset:63488
 v_mfma_f32_16x16x32_bf16 v[52:55], a[228:231], v[148:151], v[52:55]
 ds_read_b64_tr_b16 a[192:193], v183 offset:32768
 v_mfma_f32_16x16x32_bf16 v[48:51], a[228:231], v[116:119], v[48:51]
 s_waitcnt lgkmcnt(11)
 ds_read_b64_tr_b16 a[194:195], v183 offset:34816
 v_mfma_f32_16x16x32_bf16 v[48:51], a[232:235], v[120:123], v[48:51]
 ds_read_b64_tr_b16 a[196:197], v183 offset:36864
 v_cvt_pk_bf16_f32 v64, v32, v33
 v_mfma_f32_16x16x32_bf16 v[52:55], a[232:235], v[152:155], v[52:55]
 s_waitcnt lgkmcnt(11)
 ds_read_b64_tr_b16 a[198:199], v183 offset:38912
 v_cvt_pk_bf16_f32 v65, v34, v35
 v_mfma_f32_16x16x32_bf16 v[52:55], a[236:239], v[156:159], v[52:55]
 ds_read_b64_tr_b16 a[200:201], v183 offset:40960
 v_cvt_pk_bf16_f32 v66, v40, v41
 v_mfma_f32_16x16x32_bf16 v[48:51], a[236:239], v[124:127], v[48:51]
 s_waitcnt lgkmcnt(11)
 ds_read_b64_tr_b16 a[202:203], v183 offset:43008
 v_cvt_pk_bf16_f32 v67, v42, v43
 v_mfma_f32_16x16x32_bf16 v[48:51], a[240:243], v[128:131], v[48:51]
 s_add_u32 s92, s8, 163840
 ds_read_b64_tr_b16 a[204:205], v183 offset:45056
 buffer_store_dwordx4 v[64:67], v21, s[36:39], s92 offen sc1
 v_mfma_f32_16x16x32_bf16 v[52:55], a[240:243], v[160:163], v[52:55]
 s_waitcnt lgkmcnt(11)
 ds_read_b64_tr_b16 a[206:207], v183 offset:47104
 v_cvt_pk_bf16_f32 v68, v36, v37
 v_mfma_f32_16x16x32_bf16 v[52:55], a[244:247], v[164:167], v[52:55]
 ds_read_b64_tr_b16 a[208:209], v183 offset:49152
 v_cvt_pk_bf16_f32 v69, v38, v39
 v_mfma_f32_16x16x32_bf16 v[48:51], a[244:247], v[132:135], v[48:51]
 s_waitcnt lgkmcnt(11)
 ds_read_b64_tr_b16 a[210:211], v183 offset:51200
 v_cvt_pk_bf16_f32 v70, v44, v45
 v_mfma_f32_16x16x32_bf16 v[48:51], a[248:251], v[136:139], v[48:51]
 ds_read_b64_tr_b16 a[212:213], v183 offset:53248
 v_cvt_pk_bf16_f32 v71, v46, v47
 v_mfma_f32_16x16x32_bf16 v[52:55], a[248:251], v[168:171], v[52:55]
 s_waitcnt lgkmcnt(11)
 s_add_u32 s92, s9, 163840
 ds_read_b64_tr_b16 a[214:215], v183 offset:55296
 buffer_store_dwordx4 v[68:71], v21, s[36:39], s92 offen sc1
 v_mfma_f32_16x16x32_bf16 v[52:55], a[252:255], v[172:175], v[52:55]
 ds_read_b64_tr_b16 a[216:217], v183 offset:57344
 v_mfma_f32_16x16x32_bf16 v[48:51], a[252:255], v[140:143], v[48:51]
 s_waitcnt lgkmcnt(11)
 ds_read_b64_tr_b16 a[218:219], v183 offset:59392
 v_mfma_f32_16x16x32_bf16 v[56:59], a[192:195], v[112:115], v[56:59]
 ds_read_b64_tr_b16 a[220:221], v183 offset:61440
 v_mfma_f32_16x16x32_bf16 v[60:63], a[192:195], v[144:147], v[60:63]
 s_waitcnt lgkmcnt(11)
 ds_read_b64_tr_b16 a[222:223], v183 offset:63488
 v_mfma_f32_16x16x32_bf16 v[60:63], a[196:199], v[148:151], v[60:63]
 ds_read_b64_tr_b16 a[224:225], v184 offset:0
 v_mfma_f32_16x16x32_bf16 v[56:59], a[196:199], v[116:119], v[56:59]
 s_waitcnt lgkmcnt(11)
 ds_read_b64_tr_b16 a[226:227], v184 offset:2048
 v_mfma_f32_16x16x32_bf16 v[56:59], a[200:203], v[120:123], v[56:59]
 ds_read_b64_tr_b16 a[228:229], v184 offset:4096
 v_mfma_f32_16x16x32_bf16 v[60:63], a[200:203], v[152:155], v[60:63]
 s_waitcnt lgkmcnt(11)
 ds_read_b64_tr_b16 a[230:231], v184 offset:6144
 v_mfma_f32_16x16x32_bf16 v[60:63], a[204:207], v[156:159], v[60:63]
 ds_read_b64_tr_b16 a[232:233], v184 offset:8192
 v_mfma_f32_16x16x32_bf16 v[56:59], a[204:207], v[124:127], v[56:59]
 s_waitcnt lgkmcnt(11)
 ds_read_b64_tr_b16 a[234:235], v184 offset:10240
 v_mfma_f32_16x16x32_bf16 v[56:59], a[208:211], v[128:131], v[56:59]
 ds_read_b64_tr_b16 a[236:237], v185 offset:0
 v_mfma_f32_16x16x32_bf16 v[60:63], a[208:211], v[160:163], v[60:63]
 s_waitcnt lgkmcnt(11)
 ds_read_b64_tr_b16 a[238:239], v185 offset:2048
 v_mfma_f32_16x16x32_bf16 v[60:63], a[212:215], v[164:167], v[60:63]
 ds_read_b64_tr_b16 a[240:241], v185 offset:4096
 v_mfma_f32_16x16x32_bf16 v[56:59], a[212:215], v[132:135], v[56:59]
 s_waitcnt lgkmcnt(11)
 ds_read_b64_tr_b16 a[242:243], v185 offset:6144
 v_mfma_f32_16x16x32_bf16 v[56:59], a[216:219], v[136:139], v[56:59]
 ds_read_b64_tr_b16 a[244:245], v185 offset:8192
 v_mfma_f32_16x16x32_bf16 v[60:63], a[216:219], v[168:171], v[60:63]
 s_waitcnt lgkmcnt(11)
 ds_read_b64_tr_b16 a[246:247], v185 offset:10240
 v_mfma_f32_16x16x32_bf16 v[60:63], a[220:223], v[172:175], v[60:63]
 ds_read_b64_tr_b16 a[248:249], v186 offset:0
 v_mfma_f32_16x16x32_bf16 v[56:59], a[220:223], v[140:143], v[56:59]
 ds_read_b64_tr_b16 a[250:251], v186 offset:2048
 s_waitcnt lgkmcnt(12)
 v_mfma_f32_16x16x32_bf16 v[32:35], a[224:227], a[128:131], 0
 ds_read_b64_tr_b16 a[252:253], v186 offset:4096
 v_mfma_f32_16x16x32_bf16 v[36:39], a[224:227], a[144:147], 0
 s_waitcnt lgkmcnt(11)
 ds_read_b64_tr_b16 a[254:255], v186 offset:6144
 v_cvt_pk_bf16_f32 v72, v48, v49
 v_mfma_f32_16x16x32_bf16 v[36:39], a[228:231], a[148:151], v[36:39]
 ds_read_b64_tr_b16 a[192:193], v186 offset:8192
 v_cvt_pk_bf16_f32 v73, v50, v51
 v_mfma_f32_16x16x32_bf16 v[32:35], a[228:231], a[132:135], v[32:35]
 s_waitcnt lgkmcnt(11)
 ds_read_b64_tr_b16 a[194:195], v186 offset:10240
 v_cvt_pk_bf16_f32 v74, v56, v57
 v_mfma_f32_16x16x32_bf16 v[32:35], a[232:235], a[136:139], v[32:35]
 ds_read_b64_tr_b16 a[196:197], v187 offset:0
 v_cvt_pk_bf16_f32 v75, v58, v59
 v_mfma_f32_16x16x32_bf16 v[36:39], a[232:235], a[152:155], v[36:39]
 s_waitcnt lgkmcnt(11)
 s_add_u32 s92, s8, 180224
 ds_read_b64_tr_b16 a[198:199], v187 offset:2048
 buffer_store_dwordx4 v[72:75], v21, s[36:39], s92 offen sc1
 v_mfma_f32_16x16x32_bf16 v[44:47], a[236:239], a[144:147], 0
 ds_read_b64_tr_b16 a[200:201], v187 offset:4096
 v_cvt_pk_bf16_f32 v76, v52, v53
 v_mfma_f32_16x16x32_bf16 v[40:43], a[236:239], a[128:131], 0
 s_waitcnt lgkmcnt(11)
 ds_read_b64_tr_b16 a[202:203], v187 offset:6144
 v_cvt_pk_bf16_f32 v77, v54, v55
 v_mfma_f32_16x16x32_bf16 v[40:43], a[240:243], a[132:135], v[40:43]
 ds_read_b64_tr_b16 a[204:205], v187 offset:8192
 v_cvt_pk_bf16_f32 v78, v60, v61
 v_mfma_f32_16x16x32_bf16 v[44:47], a[240:243], a[148:151], v[44:47]
 s_waitcnt lgkmcnt(11)
 s_waitcnt vmcnt(8)
 s_barrier
 ds_read_b64_tr_b16 a[206:207], v187 offset:10240
 v_mfma_f32_16x16x32_bf16 v[44:47], a[244:247], a[152:155], v[44:47]
 ds_read_b64_tr_b16 a[208:209], v184 offset:16384
 v_cvt_pk_bf16_f32 v79, v62, v63
 v_mfma_f32_16x16x32_bf16 v[40:43], a[244:247], a[136:139], v[40:43]
 s_waitcnt lgkmcnt(11)
 s_add_u32 s92, s9, 180224
 ds_read_b64_tr_b16 a[210:211], v184 offset:18432
 buffer_store_dwordx4 v[76:79], v21, s[36:39], s92 offen sc1
 v_mfma_f32_16x16x32_bf16 v[48:51], a[248:251], a[128:131], 0
 ds_read_b64_tr_b16 a[212:213], v184 offset:20480
 v_mul_f32 v32, v32, v192
 v_mfma_f32_16x16x32_bf16 v[52:55], a[248:251], a[144:147], 0
 s_waitcnt lgkmcnt(11)
 ds_read_b64_tr_b16 a[214:215], v184 offset:22528
 v_mul_f32 v33, v33, v192
 v_mfma_f32_16x16x32_bf16 v[52:55], a[252:255], a[148:151], v[52:55]
 ds_read_b64_tr_b16 a[216:217], v184 offset:24576
 v_mul_f32 v34, v34, v192
 v_mfma_f32_16x16x32_bf16 v[48:51], a[252:255], a[132:135], v[48:51]
 s_waitcnt lgkmcnt(11)
 ds_read_b64_tr_b16 a[218:219], v184 offset:26624
 v_mul_f32 v35, v35, v192
 v_mfma_f32_16x16x32_bf16 v[48:51], a[192:195], a[136:139], v[48:51]
 ds_read_b64_tr_b16 a[220:221], v184 offset:28672
 v_mul_f32 v36, v36, v193
 v_mfma_f32_16x16x32_bf16 v[52:55], a[192:195], a[152:155], v[52:55]
 s_waitcnt lgkmcnt(11)
 ds_read_b64_tr_b16 a[222:223], v184 offset:30720
 v_mul_f32 v37, v37, v193
 v_mfma_f32_16x16x32_bf16 v[60:63], a[196:199], a[144:147], 0
 ds_read_b64_tr_b16 a[224:225], v176 offset:0
 v_mul_f32 v38, v38, v193
 v_mfma_f32_16x16x32_bf16 v[56:59], a[196:199], a[128:131], 0
 s_waitcnt lgkmcnt(11)
 ds_read_b64_tr_b16 a[226:227], v176 offset:2048
 v_mul_f32 v39, v39, v193
 v_mfma_f32_16x16x32_bf16 v[56:59], a[200:203], a[132:135], v[56:59]
 ds_read_b64_tr_b16 a[228:229], v176 offset:4096
 v_mul_f32 v40, v40, v192
 v_mfma_f32_16x16x32_bf16 v[60:63], a[200:203], a[148:151], v[60:63]
 s_waitcnt lgkmcnt(11)
 ds_read_b64_tr_b16 a[230:231], v176 offset:6144
 v_mul_f32 v41, v41, v192
 v_mfma_f32_16x16x32_bf16 v[60:63], a[204:207], a[152:155], v[60:63]
 ds_read_b64_tr_b16 a[232:233], v176 offset:8192
 v_mul_f32 v42, v42, v192
 v_mfma_f32_16x16x32_bf16 v[56:59], a[204:207], a[136:139], v[56:59]
 s_waitcnt lgkmcnt(11)
 ds_read_b64_tr_b16 a[234:235], v176 offset:10240
 v_mul_f32 v43, v43, v192
 v_mfma_f32_16x16x32_bf16 v[32:35], a[208:211], v[112:115], v[32:35]
 ds_read_b64_tr_b16 a[236:237], v176 offset:12288
 v_mul_f32 v44, v44, v193
 v_mfma_f32_16x16x32_bf16 v[36:39], a[208:211], v[144:147], v[36:39]
 s_waitcnt lgkmcnt(11)
 ds_read_b64_tr_b16 a[238:239], v176 offset:14336
 v_mul_f32 v45, v45, v193
 v_mfma_f32_16x16x32_bf16 v[36:39], a[212:215], v[148:151], v[36:39]
 ds_read_b64_tr_b16 a[240:241], v185 offset:16384
 v_mul_f32 v46, v46, v193
 v_mfma_f32_16x16x32_bf16 v[32:35], a[212:215], v[116:119], v[32:35]
 s_waitcnt lgkmcnt(11)
 ds_read_b64_tr_b16 a[242:243], v185 offset:18432
 v_mul_f32 v47, v47, v193
 v_mfma_f32_16x16x32_bf16 v[32:35], a[216:219], v[120:123], v[32:35]
 ds_read_b64_tr_b16 a[244:245], v185 offset:20480
 v_mul_f32 v48, v48, v192
 v_mfma_f32_16x16x32_bf16 v[36:39], a[216:219], v[152:155], v[36:39]
 s_waitcnt lgkmcnt(11)
 ds_read_b64_tr_b16 a[246:247], v185 offset:22528
 v_mul_f32 v49, v49, v192
 v_mfma_f32_16x16x32_bf16 v[36:39], a[220:223], v[156:159], v[36:39]
 ds_read_b64_tr_b16 a[248:249], v185 offset:24576
 v_mul_f32 v50, v50, v192
 v_mfma_f32_16x16x32_bf16 v[32:35], a[220:223], v[124:127], v[32:35]
 s_waitcnt lgkmcnt(11)
 ds_read_b64_tr_b16 a[250:251], v185 offset:26624
 v_mul_f32 v51, v51, v192
 v_mfma_f32_16x16x32_bf16 v[32:35], a[224:227], v[128:131], v[32:35]
 ds_read_b64_tr_b16 a[252:253], v185 offset:28672
 v_mul_f32 v52, v52, v193
 v_mfma_f32_16x16x32_bf16 v[36:39], a[224:227], v[160:163], v[36:39]
 s_waitcnt lgkmcnt(11)
 ds_read_b64_tr_b16 a[254:255], v185 offset:30720
 v_mul_f32 v53, v53, v193
 v_mfma_f32_16x16x32_bf16 v[36:39], a[228:231], v[164:167], v[36:39]
 ds_read_b64_tr_b16 a[192:193], v177 offset:0
 v_mul_f32 v54, v54, v193
 v_mfma_f32_16x16x32_bf16 v[32:35], a[228:231], v[132:135], v[32:35]
 s_waitcnt lgkmcnt(11)
 ds_read_b64_tr_b16 a[194:195], v177 offset:2048
 v_mul_f32 v55, v55, v193
 v_mfma_f32_16x16x32_bf16 v[32:35], a[232:235], v[136:139], v[32:35]
 ds_read_b64_tr_b16 a[196:197], v177 offset:4096
 v_mul_f32 v56, v56, v192
 v_mfma_f32_16x16x32_bf16 v[36:39], a[232:235], v[168:171], v[36:39]
 s_waitcnt lgkmcnt(11)
 ds_read_b64_tr_b16 a[198:199], v177 offset:6144
 v_mul_f32 v57, v57, v192
 v_mfma_f32_16x16x32_bf16 v[36:39], a[236:239], v[172:175], v[36:39]
 ds_read_b64_tr_b16 a[200:201], v177 offset:8192
 v_mul_f32 v58, v58, v192
 v_mfma_f32_16x16x32_bf16 v[32:35], a[236:239], v[140:143], v[32:35]
 s_waitcnt lgkmcnt(11)
 ds_read_b64_tr_b16 a[202:203], v177 offset:10240
 v_mul_f32 v59, v59, v192
 v_mfma_f32_16x16x32_bf16 v[40:43], a[240:243], v[112:115], v[40:43]
 ds_read_b64_tr_b16 a[204:205], v177 offset:12288
 v_mul_f32 v60, v60, v193
 v_mfma_f32_16x16x32_bf16 v[44:47], a[240:243], v[144:147], v[44:47]
 s_waitcnt lgkmcnt(11)
 ds_read_b64_tr_b16 a[206:207], v177 offset:14336
 v_mul_f32 v61, v61, v193
 v_mfma_f32_16x16x32_bf16 v[44:47], a[244:247], v[148:151], v[44:47]
 ds_read_b64_tr_b16 a[208:209], v186 offset:16384
 v_mul_f32 v62, v62, v193
 v_mfma_f32_16x16x32_bf16 v[40:43], a[244:247], v[116:119], v[40:43]
 s_waitcnt lgkmcnt(11)
 ds_read_b64_tr_b16 a[210:211], v186 offset:18432
 v_mul_f32 v63, v63, v193
 v_mfma_f32_16x16x32_bf16 v[40:43], a[248:251], v[120:123], v[40:43]
 ds_read_b64_tr_b16 a[212:213], v186 offset:20480
 v_mfma_f32_16x16x32_bf16 v[44:47], a[248:251], v[152:155], v[44:47]
 s_waitcnt lgkmcnt(11)
 ds_read_b64_tr_b16 a[214:215], v186 offset:22528
 v_mfma_f32_16x16x32_bf16 v[44:47], a[252:255], v[156:159], v[44:47]
 ds_read_b64_tr_b16 a[216:217], v186 offset:24576
 v_mfma_f32_16x16x32_bf16 v[40:43], a[252:255], v[124:127], v[40:43]
 s_waitcnt lgkmcnt(11)
 ds_read_b64_tr_b16 a[218:219], v186 offset:26624
 v_mfma_f32_16x16x32_bf16 v[40:43], a[192:195], v[128:131], v[40:43]
 ds_read_b64_tr_b16 a[220:221], v186 offset:28672
 v_mfma_f32_16x16x32_bf16 v[44:47], a[192:195], v[160:163], v[44:47]
 s_waitcnt lgkmcnt(11)
 ds_read_b64_tr_b16 a[222:223], v186 offset:30720
 v_mfma_f32_16x16x32_bf16 v[44:47], a[196:199], v[164:167], v[44:47]
 ds_read_b64_tr_b16 a[224:225], v178 offset:0
 v_mfma_f32_16x16x32_bf16 v[40:43], a[196:199], v[132:135], v[40:43]
 s_waitcnt lgkmcnt(11)
 ds_read_b64_tr_b16 a[226:227], v178 offset:2048
 v_mfma_f32_16x16x32_bf16 v[40:43], a[200:203], v[136:139], v[40:43]
 ds_read_b64_tr_b16 a[228:229], v178 offset:4096
 v_mfma_f32_16x16x32_bf16 v[44:47], a[200:203], v[168:171], v[44:47]
 s_waitcnt lgkmcnt(11)
 ds_read_b64_tr_b16 a[230:231], v178 offset:6144
 v_mfma_f32_16x16x32_bf16 v[44:47], a[204:207], v[172:175], v[44:47]
 ds_read_b64_tr_b16 a[232:233], v178 offset:8192
 v_mfma_f32_16x16x32_bf16 v[40:43], a[204:207], v[140:143], v[40:43]
 s_waitcnt lgkmcnt(11)
 ds_read_b64_tr_b16 a[234:235], v178 offset:10240
 v_mfma_f32_16x16x32_bf16 v[48:51], a[208:211], v[112:115], v[48:51]
 ds_read_b64_tr_b16 a[236:237], v178 offset:12288
 v_mfma_f32_16x16x32_bf16 v[52:55], a[208:211], v[144:147], v[52:55]
 s_waitcnt lgkmcnt(11)
 ds_read_b64_tr_b16 a[238:239], v178 offset:14336
 v_mfma_f32_16x16x32_bf16 v[52:55], a[212:215], v[148:151], v[52:55]
 ds_read_b64_tr_b16 a[240:241], v187 offset:16384
 v_mfma_f32_16x16x32_bf16 v[48:51], a[212:215], v[116:119], v[48:51]
 s_waitcnt lgkmcnt(11)
 ds_read_b64_tr_b16 a[242:243], v187 offset:18432
 v_mfma_f32_16x16x32_bf16 v[48:51], a[216:219], v[120:123], v[48:51]
 ds_read_b64_tr_b16 a[244:245], v187 offset:20480
 v_cvt_pk_bf16_f32 v64, v32, v33
 v_mfma_f32_16x16x32_bf16 v[52:55], a[216:219], v[152:155], v[52:55]
 s_waitcnt lgkmcnt(11)
 ds_read_b64_tr_b16 a[246:247], v187 offset:22528
 v_cvt_pk_bf16_f32 v65, v34, v35
 v_mfma_f32_16x16x32_bf16 v[52:55], a[220:223], v[156:159], v[52:55]
 ds_read_b64_tr_b16 a[248:249], v187 offset:24576
 v_cvt_pk_bf16_f32 v66, v40, v41
 v_mfma_f32_16x16x32_bf16 v[48:51], a[220:223], v[124:127], v[48:51]
 s_waitcnt lgkmcnt(11)
 ds_read_b64_tr_b16 a[250:251], v187 offset:26624
 v_cvt_pk_bf16_f32 v67, v42, v43
 v_mfma_f32_16x16x32_bf16 v[48:51], a[224:227], v[128:131], v[48:51]
 s_add_u32 s92, s8, 196608
 ds_read_b64_tr_b16 a[252:253], v187 offset:28672
 buffer_store_dwordx4 v[64:67], v21, s[36:39], s92 offen sc1
 v_mfma_f32_16x16x32_bf16 v[52:55], a[224:227], v[160:163], v[52:55]
 s_waitcnt lgkmcnt(11)
 ds_read_b64_tr_b16 a[254:255], v187 offset:30720
 v_cvt_pk_bf16_f32 v68, v36, v37
 v_mfma_f32_16x16x32_bf16 v[52:55], a[228:231], v[164:167], v[52:55]
 ds_read_b64_tr_b16 a[192:193], v179 offset:0
 v_cvt_pk_bf16_f32 v69, v38, v39
 v_mfma_f32_16x16x32_bf16 v[48:51], a[228:231], v[132:135], v[48:51]
 s_waitcnt lgkmcnt(11)
 ds_read_b64_tr_b16 a[194:195], v179 offset:2048
 v_cvt_pk_bf16_f32 v70, v44, v45
 v_mfma_f32_16x16x32_bf16 v[48:51], a[232:235], v[136:139], v[48:51]
 ds_read_b64_tr_b16 a[196:197], v179 offset:4096
 v_cvt_pk_bf16_f32 v71, v46, v47
 v_mfma_f32_16x16x32_bf16 v[52:55], a[232:235], v[168:171], v[52:55]
 s_waitcnt lgkmcnt(11)
 s_add_u32 s92, s9, 196608
 ds_read_b64_tr_b16 a[198:199], v179 offset:6144
 buffer_store_dwordx4 v[68:71], v21, s[36:39], s92 offen sc1
 v_mfma_f32_16x16x32_bf16 v[52:55], a[236:239], v[172:175], v[52:55]
 ds_read_b64_tr_b16 a[200:201], v179 offset:8192
 v_mfma_f32_16x16x32_bf16 v[48:51], a[236:239], v[140:143], v[48:51]
 s_waitcnt lgkmcnt(11)
 ds_read_b64_tr_b16 a[202:203], v179 offset:10240
 v_mfma_f32_16x16x32_bf16 v[56:59], a[240:243], v[112:115], v[56:59]
 ds_read_b64_tr_b16 a[204:205], v179 offset:12288
 v_mfma_f32_16x16x32_bf16 v[60:63], a[240:243], v[144:147], v[60:63]
 s_waitcnt lgkmcnt(11)
 ds_read_b64_tr_b16 a[206:207], v179 offset:14336
 v_mfma_f32_16x16x32_bf16 v[60:63], a[244:247], v[148:151], v[60:63]
 v_mfma_f32_16x16x32_bf16 v[56:59], a[244:247], v[116:119], v[56:59]
 s_waitcnt lgkmcnt(10)
 v_mfma_f32_16x16x32_bf16 v[56:59], a[248:251], v[120:123], v[56:59]
 v_mfma_f32_16x16x32_bf16 v[60:63], a[248:251], v[152:155], v[60:63]
 s_waitcnt lgkmcnt(8)
 v_mfma_f32_16x16x32_bf16 v[60:63], a[252:255], v[156:159], v[60:63]
 v_mfma_f32_16x16x32_bf16 v[56:59], a[252:255], v[124:127], v[56:59]
 s_waitcnt lgkmcnt(6)
 v_mfma_f32_16x16x32_bf16 v[56:59], a[192:195], v[128:131], v[56:59]
 v_mfma_f32_16x16x32_bf16 v[60:63], a[192:195], v[160:163], v[60:63]
 s_waitcnt lgkmcnt(4)
 v_mfma_f32_16x16x32_bf16 v[60:63], a[196:199], v[164:167], v[60:63]
 v_mfma_f32_16x16x32_bf16 v[56:59], a[196:199], v[132:135], v[56:59]
 s_waitcnt lgkmcnt(2)
 v_mfma_f32_16x16x32_bf16 v[56:59], a[200:203], v[136:139], v[56:59]
 buffer_load_dwordx2 v[22:23], v30, s[36:39], 0 offen sc1
 v_mfma_f32_16x16x32_bf16 v[60:63], a[200:203], v[168:171], v[60:63]
 s_waitcnt lgkmcnt(0)
 v_mfma_f32_16x16x32_bf16 v[60:63], a[204:207], v[172:175], v[60:63]
 v_mfma_f32_16x16x32_bf16 v[56:59], a[204:207], v[140:143], v[56:59]
 s_nop 7
 v_cvt_pk_bf16_f32 v72, v48, v49
 v_cvt_pk_bf16_f32 v73, v50, v51
 v_cvt_pk_bf16_f32 v74, v56, v57
 v_cvt_pk_bf16_f32 v75, v58, v59
 s_add_u32 s92, s8, 212992
 buffer_store_dwordx4 v[72:75], v21, s[36:39], s92 offen sc1
 v_cvt_pk_bf16_f32 v76, v52, v53
 v_cvt_pk_bf16_f32 v77, v54, v55
 v_cvt_pk_bf16_f32 v78, v60, v61
 v_cvt_pk_bf16_f32 v79, v62, v63
 s_add_u32 s92, s9, 212992
 buffer_store_dwordx4 v[76:79], v21, s[36:39], s92 offen sc1
gated_mix__compressed_kv_cla__glu_gated_swiglu__prompt_kernel_p4e:
 s_mov_b32 s99, 1048576
 s_waitcnt vmcnt(0)
 s_mov_b64 exec, 1
 buffer_store_dwordx2 v[28:29], v21, s[36:39], s13 offen offset:128 sc1
 s_mov_b64 exec, -1
 s_barrier
 s_cmp_eq_u32 s68, 3
 s_cselect_b32 s13, 1, 0
 v_cmp_eq_u64 vcc, v[22:23], v[28:29]
 s_nop 3
 s_and_b32 s11, vcc_lo, s10
 s_lshl_b32 s91, 0x10001, s82
 s_or_b32 s11, s11, s91
 s_and_b32 s11, s11, s10
 s_andn2_b32 s10, s10, s11
 s_add_u32 s91, s14, 0
 s_bitcmp1_b32 s11, 0
 s_cselect_b32 s50, s38, 0
 buffer_load_dwordx4 a[0:3], v21, s[48:51], s91 offen offset:0 sc1 nt
 s_bitcmp1_b32 s11, 1
 s_cselect_b32 s50, s38, 0
 buffer_load_dwordx4 a[4:7], v21, s[48:51], s91 offen offset:1024 sc1 nt
 s_bitcmp1_b32 s11, 2
 s_cselect_b32 s50, s38, 0
 buffer_load_dwordx4 a[8:11], v21, s[48:51], s91 offen offset:2048 sc1 nt
 s_bitcmp1_b32 s11, 3
 s_cselect_b32 s50, s38, 0
 buffer_load_dwordx4 a[12:15], v21, s[48:51], s91 offen offset:3072 sc1 nt
 s_add_u32 s91, s14, 4096
 s_bitcmp1_b32 s11, 4
 s_cselect_b32 s50, s38, 0
 buffer_load_dwordx4 a[16:19], v21, s[48:51], s91 offen offset:0 sc1 nt
 s_bitcmp1_b32 s11, 5
 s_cselect_b32 s50, s38, 0
 buffer_load_dwordx4 a[20:23], v21, s[48:51], s91 offen offset:1024 sc1 nt
 s_bitcmp1_b32 s11, 6
 s_cselect_b32 s50, s38, 0
 buffer_load_dwordx4 a[24:27], v21, s[48:51], s91 offen offset:2048 sc1 nt
 s_bitcmp1_b32 s11, 7
 s_cselect_b32 s50, s38, 0
 buffer_load_dwordx4 a[28:31], v21, s[48:51], s91 offen offset:3072 sc1 nt
 s_add_u32 s91, s14, 8192
 s_bitcmp1_b32 s11, 8
 s_cselect_b32 s50, s38, 0
 buffer_load_dwordx4 a[32:35], v21, s[48:51], s91 offen offset:0 sc1 nt
 s_bitcmp1_b32 s11, 9
 s_cselect_b32 s50, s38, 0
 buffer_load_dwordx4 a[36:39], v21, s[48:51], s91 offen offset:1024 sc1 nt
 s_bitcmp1_b32 s11, 10
 s_cselect_b32 s50, s38, 0
 buffer_load_dwordx4 a[40:43], v21, s[48:51], s91 offen offset:2048 sc1 nt
 s_bitcmp1_b32 s11, 11
 s_cselect_b32 s50, s38, 0
 buffer_load_dwordx4 a[44:47], v21, s[48:51], s91 offen offset:3072 sc1 nt
 s_add_u32 s91, s14, 12288
 s_bitcmp1_b32 s11, 12
 s_cselect_b32 s50, s38, 0
 buffer_load_dwordx4 a[48:51], v21, s[48:51], s91 offen offset:0 sc1 nt
 s_bitcmp1_b32 s11, 13
 s_cselect_b32 s50, s38, 0
 buffer_load_dwordx4 a[52:55], v21, s[48:51], s91 offen offset:1024 sc1 nt
 s_bitcmp1_b32 s11, 14
 s_cselect_b32 s50, s38, 0
 buffer_load_dwordx4 a[56:59], v21, s[48:51], s91 offen offset:2048 sc1 nt
 s_bitcmp1_b32 s11, 15
 s_cselect_b32 s50, s38, 0
 buffer_load_dwordx4 a[60:63], v21, s[48:51], s91 offen offset:3072 sc1 nt
 s_add_u32 s91, s15, 0
 s_bitcmp1_b32 s11, 16
 s_cselect_b32 s50, s38, 0
 buffer_load_dwordx4 a[64:67], v21, s[48:51], s91 offen offset:0 sc1 nt
 s_bitcmp1_b32 s11, 17
 s_cselect_b32 s50, s38, 0
 buffer_load_dwordx4 a[68:71], v21, s[48:51], s91 offen offset:1024 sc1 nt
 s_bitcmp1_b32 s11, 18
 s_cselect_b32 s50, s38, 0
 buffer_load_dwordx4 a[72:75], v21, s[48:51], s91 offen offset:2048 sc1 nt
 s_bitcmp1_b32 s11, 19
 s_cselect_b32 s50, s38, 0
 buffer_load_dwordx4 a[76:79], v21, s[48:51], s91 offen offset:3072 sc1 nt
 s_add_u32 s91, s15, 4096
 s_bitcmp1_b32 s11, 20
 s_cselect_b32 s50, s38, 0
 buffer_load_dwordx4 a[80:83], v21, s[48:51], s91 offen offset:0 sc1 nt
 s_bitcmp1_b32 s11, 21
 s_cselect_b32 s50, s38, 0
 buffer_load_dwordx4 a[84:87], v21, s[48:51], s91 offen offset:1024 sc1 nt
 s_bitcmp1_b32 s11, 22
 s_cselect_b32 s50, s38, 0
 buffer_load_dwordx4 a[88:91], v21, s[48:51], s91 offen offset:2048 sc1 nt
 s_bitcmp1_b32 s11, 23
 s_cselect_b32 s50, s38, 0
 buffer_load_dwordx4 a[92:95], v21, s[48:51], s91 offen offset:3072 sc1 nt
 buffer_load_dwordx2 v[22:23], v30, s[36:39], 0 offen sc1
 s_add_u32 s91, s15, 8192
 s_bitcmp1_b32 s11, 24
 s_cselect_b32 s50, s38, 0
 buffer_load_dwordx4 a[96:99], v21, s[48:51], s91 offen offset:0 sc1 nt
 s_bitcmp1_b32 s11, 25
 s_cselect_b32 s50, s38, 0
 buffer_load_dwordx4 a[100:103], v21, s[48:51], s91 offen offset:1024 sc1 nt
 s_bitcmp1_b32 s11, 26
 s_cselect_b32 s50, s38, 0
 buffer_load_dwordx4 a[104:107], v21, s[48:51], s91 offen offset:2048 sc1 nt
 s_bitcmp1_b32 s11, 27
 s_cselect_b32 s50, s38, 0
 buffer_load_dwordx4 a[108:111], v21, s[48:51], s91 offen offset:3072 sc1 nt
 s_add_u32 s91, s15, 12288
 s_bitcmp1_b32 s11, 28
 s_cselect_b32 s50, s38, 0
 buffer_load_dwordx4 a[112:115], v21, s[48:51], s91 offen offset:0 sc1 nt
 s_bitcmp1_b32 s11, 29
 s_cselect_b32 s50, s38, 0
 buffer_load_dwordx4 a[116:119], v21, s[48:51], s91 offen offset:1024 sc1 nt
 s_bitcmp1_b32 s11, 30
 s_cselect_b32 s50, s38, 0
 buffer_load_dwordx4 a[120:123], v21, s[48:51], s91 offen offset:2048 sc1 nt
 s_bitcmp1_b32 s11, 31
 s_cselect_b32 s50, s38, 0
 buffer_load_dwordx4 a[124:127], v21, s[48:51], s91 offen offset:3072 sc1 nt
 s_cmp_eq_u32 s10, 0
 s_cbranch_scc1 gated_mix__compressed_kv_cla__glu_gated_swiglu__prompt_kernel_all
 s_waitcnt vmcnt(8)
 v_cmp_eq_u64 vcc, v[22:23], v[28:29]
 s_nop 3
 s_and_b32 s11, vcc_lo, s10
 s_branch gated_mix__compressed_kv_cla__glu_gated_swiglu__prompt_kernel_take
gated_mix__compressed_kv_cla__glu_gated_swiglu__prompt_kernel_gather:
 buffer_load_dwordx2 v[22:23], v30, s[36:39], 0 offen sc1
 s_waitcnt vmcnt(0)
 v_cmp_eq_u64 vcc, v[22:23], v[28:29]
 s_nop 3
 s_and_b32 s11, vcc_lo, s10
gated_mix__compressed_kv_cla__glu_gated_swiglu__prompt_kernel_take:
 s_bitcmp1_b32 s11, 16
 s_cbranch_scc0 gated_mix__compressed_kv_cla__glu_gated_swiglu__prompt_kernel_skip16
 s_add_u32 s91, s15, 0
 buffer_load_dwordx4 a[64:67], v21, s[36:39], s91 offen offset:0 sc1 nt
gated_mix__compressed_kv_cla__glu_gated_swiglu__prompt_kernel_skip16:
 s_bitcmp1_b32 s11, 17
 s_cbranch_scc0 gated_mix__compressed_kv_cla__glu_gated_swiglu__prompt_kernel_skip17
 s_add_u32 s91, s15, 0
 buffer_load_dwordx4 a[68:71], v21, s[36:39], s91 offen offset:1024 sc1 nt
gated_mix__compressed_kv_cla__glu_gated_swiglu__prompt_kernel_skip17:
 s_bitcmp1_b32 s11, 18
 s_cbranch_scc0 gated_mix__compressed_kv_cla__glu_gated_swiglu__prompt_kernel_skip18
 s_add_u32 s91, s15, 0
 buffer_load_dwordx4 a[72:75], v21, s[36:39], s91 offen offset:2048 sc1 nt
gated_mix__compressed_kv_cla__glu_gated_swiglu__prompt_kernel_skip18:
 s_bitcmp1_b32 s11, 19
 s_cbranch_scc0 gated_mix__compressed_kv_cla__glu_gated_swiglu__prompt_kernel_skip19
 s_add_u32 s91, s15, 0
 buffer_load_dwordx4 a[76:79], v21, s[36:39], s91 offen offset:3072 sc1 nt
gated_mix__compressed_kv_cla__glu_gated_swiglu__prompt_kernel_skip19:
 s_bitcmp1_b32 s11, 20
 s_cbranch_scc0 gated_mix__compressed_kv_cla__glu_gated_swiglu__prompt_kernel_skip20
 s_add_u32 s91, s15, 4096
 buffer_load_dwordx4 a[80:83], v21, s[36:39], s91 offen offset:0 sc1 nt
gated_mix__compressed_kv_cla__glu_gated_swiglu__prompt_kernel_skip20:
 s_bitcmp1_b32 s11, 21
 s_cbranch_scc0 gated_mix__compressed_kv_cla__glu_gated_swiglu__prompt_kernel_skip21
 s_add_u32 s91, s15, 4096
 buffer_load_dwordx4 a[84:87], v21, s[36:39], s91 offen offset:1024 sc1 nt
gated_mix__compressed_kv_cla__glu_gated_swiglu__prompt_kernel_skip21:
 s_bitcmp1_b32 s11, 22
 s_cbranch_scc0 gated_mix__compressed_kv_cla__glu_gated_swiglu__prompt_kernel_skip22
 s_add_u32 s91, s15, 4096
 buffer_load_dwordx4 a[88:91], v21, s[36:39], s91 offen offset:2048 sc1 nt
gated_mix__compressed_kv_cla__glu_gated_swiglu__prompt_kernel_skip22:
 s_bitcmp1_b32 s11, 23
 s_cbranch_scc0 gated_mix__compressed_kv_cla__glu_gated_swiglu__prompt_kernel_skip23
 s_add_u32 s91, s15, 4096
 buffer_load_dwordx4 a[92:95], v21, s[36:39], s91 offen offset:3072 sc1 nt
gated_mix__compressed_kv_cla__glu_gated_swiglu__prompt_kernel_skip23:
 s_bitcmp1_b32 s11, 24
 s_cbranch_scc0 gated_mix__compressed_kv_cla__glu_gated_swiglu__prompt_kernel_skip24
 s_add_u32 s91, s15, 8192
 buffer_load_dwordx4 a[96:99], v21, s[36:39], s91 offen offset:0 sc1 nt
gated_mix__compressed_kv_cla__glu_gated_swiglu__prompt_kernel_skip24:
 s_bitcmp1_b32 s11, 25
 s_cbranch_scc0 gated_mix__compressed_kv_cla__glu_gated_swiglu__prompt_kernel_skip25
 s_add_u32 s91, s15, 8192
 buffer_load_dwordx4 a[100:103], v21, s[36:39], s91 offen offset:1024 sc1 nt
gated_mix__compressed_kv_cla__glu_gated_swiglu__prompt_kernel_skip25:
 s_bitcmp1_b32 s11, 26
 s_cbranch_scc0 gated_mix__compressed_kv_cla__glu_gated_swiglu__prompt_kernel_skip26
 s_add_u32 s91, s15, 8192
 buffer_load_dwordx4 a[104:107], v21, s[36:39], s91 offen offset:2048 sc1 nt
gated_mix__compressed_kv_cla__glu_gated_swiglu__prompt_kernel_skip26:
 s_bitcmp1_b32 s11, 27
 s_cbranch_scc0 gated_mix__compressed_kv_cla__glu_gated_swiglu__prompt_kernel_skip27
 s_add_u32 s91, s15, 8192
 buffer_load_dwordx4 a[108:111], v21, s[36:39], s91 offen offset:3072 sc1 nt
gated_mix__compressed_kv_cla__glu_gated_swiglu__prompt_kernel_skip27:
 s_bitcmp1_b32 s11, 28
 s_cbranch_scc0 gated_mix__compressed_kv_cla__glu_gated_swiglu__prompt_kernel_skip28
 s_add_u32 s91, s15, 12288
 buffer_load_dwordx4 a[112:115], v21, s[36:39], s91 offen offset:0 sc1 nt
gated_mix__compressed_kv_cla__glu_gated_swiglu__prompt_kernel_skip28:
 s_bitcmp1_b32 s11, 29
 s_cbranch_scc0 gated_mix__compressed_kv_cla__glu_gated_swiglu__prompt_kernel_skip29
 s_add_u32 s91, s15, 12288
 buffer_load_dwordx4 a[116:119], v21, s[36:39], s91 offen offset:1024 sc1 nt
gated_mix__compressed_kv_cla__glu_gated_swiglu__prompt_kernel_skip29:
 s_bitcmp1_b32 s11, 30
 s_cbranch_scc0 gated_mix__compressed_kv_cla__glu_gated_swiglu__prompt_kernel_skip30
 s_add_u32 s91, s15, 12288
 buffer_load_dwordx4 a[120:123], v21, s[36:39], s91 offen offset:2048 sc1 nt
gated_mix__compressed_kv_cla__glu_gated_swiglu__prompt_kernel_skip30:
 s_bitcmp1_b32 s11, 31
 s_cbranch_scc0 gated_mix__compressed_kv_cla__glu_gated_swiglu__prompt_kernel_skip31
 s_add_u32 s91, s15, 12288
 buffer_load_dwordx4 a[124:127], v21, s[36:39], s91 offen offset:3072 sc1 nt
gated_mix__compressed_kv_cla__glu_gated_swiglu__prompt_kernel_skip31:
 s_bitcmp1_b32 s11, 0
 s_cbranch_scc0 gated_mix__compressed_kv_cla__glu_gated_swiglu__prompt_kernel_skip0
 s_add_u32 s91, s14, 0
 buffer_load_dwordx4 a[0:3], v21, s[36:39], s91 offen offset:0 sc1 nt
gated_mix__compressed_kv_cla__glu_gated_swiglu__prompt_kernel_skip0:
 s_bitcmp1_b32 s11, 1
 s_cbranch_scc0 gated_mix__compressed_kv_cla__glu_gated_swiglu__prompt_kernel_skip1
 s_add_u32 s91, s14, 0
 buffer_load_dwordx4 a[4:7], v21, s[36:39], s91 offen offset:1024 sc1 nt
gated_mix__compressed_kv_cla__glu_gated_swiglu__prompt_kernel_skip1:
 s_bitcmp1_b32 s11, 2
 s_cbranch_scc0 gated_mix__compressed_kv_cla__glu_gated_swiglu__prompt_kernel_skip2
 s_add_u32 s91, s14, 0
 buffer_load_dwordx4 a[8:11], v21, s[36:39], s91 offen offset:2048 sc1 nt
gated_mix__compressed_kv_cla__glu_gated_swiglu__prompt_kernel_skip2:
 s_bitcmp1_b32 s11, 3
 s_cbranch_scc0 gated_mix__compressed_kv_cla__glu_gated_swiglu__prompt_kernel_skip3
 s_add_u32 s91, s14, 0
 buffer_load_dwordx4 a[12:15], v21, s[36:39], s91 offen offset:3072 sc1 nt
gated_mix__compressed_kv_cla__glu_gated_swiglu__prompt_kernel_skip3:
 s_bitcmp1_b32 s11, 4
 s_cbranch_scc0 gated_mix__compressed_kv_cla__glu_gated_swiglu__prompt_kernel_skip4
 s_add_u32 s91, s14, 4096
 buffer_load_dwordx4 a[16:19], v21, s[36:39], s91 offen offset:0 sc1 nt
gated_mix__compressed_kv_cla__glu_gated_swiglu__prompt_kernel_skip4:
 s_bitcmp1_b32 s11, 5
 s_cbranch_scc0 gated_mix__compressed_kv_cla__glu_gated_swiglu__prompt_kernel_skip5
 s_add_u32 s91, s14, 4096
 buffer_load_dwordx4 a[20:23], v21, s[36:39], s91 offen offset:1024 sc1 nt
gated_mix__compressed_kv_cla__glu_gated_swiglu__prompt_kernel_skip5:
 s_bitcmp1_b32 s11, 6
 s_cbranch_scc0 gated_mix__compressed_kv_cla__glu_gated_swiglu__prompt_kernel_skip6
 s_add_u32 s91, s14, 4096
 buffer_load_dwordx4 a[24:27], v21, s[36:39], s91 offen offset:2048 sc1 nt
gated_mix__compressed_kv_cla__glu_gated_swiglu__prompt_kernel_skip6:
 s_bitcmp1_b32 s11, 7
 s_cbranch_scc0 gated_mix__compressed_kv_cla__glu_gated_swiglu__prompt_kernel_skip7
 s_add_u32 s91, s14, 4096
 buffer_load_dwordx4 a[28:31], v21, s[36:39], s91 offen offset:3072 sc1 nt
gated_mix__compressed_kv_cla__glu_gated_swiglu__prompt_kernel_skip7:
 s_bitcmp1_b32 s11, 8
 s_cbranch_scc0 gated_mix__compressed_kv_cla__glu_gated_swiglu__prompt_kernel_skip8
 s_add_u32 s91, s14, 8192
 buffer_load_dwordx4 a[32:35], v21, s[36:39], s91 offen offset:0 sc1 nt
gated_mix__compressed_kv_cla__glu_gated_swiglu__prompt_kernel_skip8:
 s_bitcmp1_b32 s11, 9
 s_cbranch_scc0 gated_mix__compressed_kv_cla__glu_gated_swiglu__prompt_kernel_skip9
 s_add_u32 s91, s14, 8192
 buffer_load_dwordx4 a[36:39], v21, s[36:39], s91 offen offset:1024 sc1 nt
gated_mix__compressed_kv_cla__glu_gated_swiglu__prompt_kernel_skip9:
 s_bitcmp1_b32 s11, 10
 s_cbranch_scc0 gated_mix__compressed_kv_cla__glu_gated_swiglu__prompt_kernel_skip10
 s_add_u32 s91, s14, 8192
 buffer_load_dwordx4 a[40:43], v21, s[36:39], s91 offen offset:2048 sc1 nt
gated_mix__compressed_kv_cla__glu_gated_swiglu__prompt_kernel_skip10:
 s_bitcmp1_b32 s11, 11
 s_cbranch_scc0 gated_mix__compressed_kv_cla__glu_gated_swiglu__prompt_kernel_skip11
 s_add_u32 s91, s14, 8192
 buffer_load_dwordx4 a[44:47], v21, s[36:39], s91 offen offset:3072 sc1 nt
gated_mix__compressed_kv_cla__glu_gated_swiglu__prompt_kernel_skip11:
 s_bitcmp1_b32 s11, 12
 s_cbranch_scc0 gated_mix__compressed_kv_cla__glu_gated_swiglu__prompt_kernel_skip12
 s_add_u32 s91, s14, 12288
 buffer_load_dwordx4 a[48:51], v21, s[36:39], s91 offen offset:0 sc1 nt
gated_mix__compressed_kv_cla__glu_gated_swiglu__prompt_kernel_skip12:
 s_bitcmp1_b32 s11, 13
 s_cbranch_scc0 gated_mix__compressed_kv_cla__glu_gated_swiglu__prompt_kernel_skip13
 s_add_u32 s91, s14, 12288
 buffer_load_dwordx4 a[52:55], v21, s[36:39], s91 offen offset:1024 sc1 nt
gated_mix__compressed_kv_cla__glu_gated_swiglu__prompt_kernel_skip13:
 s_bitcmp1_b32 s11, 14
 s_cbranch_scc0 gated_mix__compressed_kv_cla__glu_gated_swiglu__prompt_kernel_skip14
 s_add_u32 s91, s14, 12288
 buffer_load_dwordx4 a[56:59], v21, s[36:39], s91 offen offset:2048 sc1 nt
gated_mix__compressed_kv_cla__glu_gated_swiglu__prompt_kernel_skip14:
 s_bitcmp1_b32 s11, 15
 s_cbranch_scc0 gated_mix__compressed_kv_cla__glu_gated_swiglu__prompt_kernel_skip15
 s_add_u32 s91, s14, 12288
 buffer_load_dwordx4 a[60:63], v21, s[36:39], s91 offen offset:3072 sc1 nt
gated_mix__compressed_kv_cla__glu_gated_swiglu__prompt_kernel_skip15:
 s_andn2_b32 s10, s10, s11
 s_cmp_lg_u32 s10, 0
 s_cbranch_scc0 gated_mix__compressed_kv_cla__glu_gated_swiglu__prompt_kernel_all
 s_sleep 2
 s_sub_u32 s99, s99, 1
 s_cbranch_scc0 gated_mix__compressed_kv_cla__glu_gated_swiglu__prompt_kernel_gather
 s_mov_b32 s11, s10
 s_branch gated_mix__compressed_kv_cla__glu_gated_swiglu__prompt_kernel_take
gated_mix__compressed_kv_cla__glu_gated_swiglu__prompt_kernel_all:
 s_waitcnt vmcnt(0)
 v_mfma_f32_16x16x32_bf16 v[48:51], v[80:83], a[0:3], 0
 v_mfma_f32_16x16x32_bf16 v[52:55], v[84:87], a[0:3], 0
 v_mfma_f32_16x16x32_bf16 v[56:59], v[80:83], a[64:67], 0
 v_mfma_f32_16x16x32_bf16 v[60:63], v[84:87], a[64:67], 0
 v_mfma_f32_16x16x32_bf16 v[48:51], v[80:83], a[4:7], v[48:51]
 v_mfma_f32_16x16x32_bf16 v[52:55], v[84:87], a[4:7], v[52:55]
 v_mfma_f32_16x16x32_bf16 v[56:59], v[80:83], a[68:71], v[56:59]
 v_mfma_f32_16x16x32_bf16 v[60:63], v[84:87], a[68:71], v[60:63]
 v_mfma_f32_16x16x32_bf16 v[48:51], v[80:83], a[8:11], v[48:51]
 v_mfma_f32_16x16x32_bf16 v[52:55], v[84:87], a[8:11], v[52:55]
 v_mfma_f32_16x16x32_bf16 v[56:59], v[80:83], a[72:75], v[56:59]
 v_mfma_f32_16x16x32_bf16 v[60:63], v[84:87], a[72:75], v[60:63]
 v_mfma_f32_16x16x32_bf16 v[48:51], v[80:83], a[12:15], v[48:51]
 v_mfma_f32_16x16x32_bf16 v[52:55], v[84:87], a[12:15], v[52:55]
 v_mfma_f32_16x16x32_bf16 v[56:59], v[80:83], a[76:79], v[56:59]
 v_mfma_f32_16x16x32_bf16 v[60:63], v[84:87], a[76:79], v[60:63]
 v_mfma_f32_16x16x32_bf16 v[48:51], v[80:83], a[16:19], v[48:51]
 v_mfma_f32_16x16x32_bf16 v[52:55], v[84:87], a[16:19], v[52:55]
 v_mfma_f32_16x16x32_bf16 v[56:59], v[80:83], a[80:83], v[56:59]
 v_mfma_f32_16x16x32_bf16 v[60:63], v[84:87], a[80:83], v[60:63]
 v_mfma_f32_16x16x32_bf16 v[48:51], v[80:83], a[20:23], v[48:51]
 v_mfma_f32_16x16x32_bf16 v[52:55], v[84:87], a[20:23], v[52:55]
 v_mfma_f32_16x16x32_bf16 v[56:59], v[80:83], a[84:87], v[56:59]
 v_mfma_f32_16x16x32_bf16 v[60:63], v[84:87], a[84:87], v[60:63]
 v_mfma_f32_16x16x32_bf16 v[48:51], v[80:83], a[24:27], v[48:51]
 v_mfma_f32_16x16x32_bf16 v[52:55], v[84:87], a[24:27], v[52:55]
 v_mfma_f32_16x16x32_bf16 v[56:59], v[80:83], a[88:91], v[56:59]
 v_mfma_f32_16x16x32_bf16 v[60:63], v[84:87], a[88:91], v[60:63]
 v_mfma_f32_16x16x32_bf16 v[48:51], v[80:83], a[28:31], v[48:51]
 v_mfma_f32_16x16x32_bf16 v[52:55], v[84:87], a[28:31], v[52:55]
 v_mfma_f32_16x16x32_bf16 v[56:59], v[80:83], a[92:95], v[56:59]
 v_mfma_f32_16x16x32_bf16 v[60:63], v[84:87], a[92:95], v[60:63]
 v_mfma_f32_16x16x32_bf16 v[48:51], v[80:83], a[32:35], v[48:51]
 v_mfma_f32_16x16x32_bf16 v[52:55], v[84:87], a[32:35], v[52:55]
 v_mfma_f32_16x16x32_bf16 v[56:59], v[80:83], a[96:99], v[56:59]
 v_mfma_f32_16x16x32_bf16 v[60:63], v[84:87], a[96:99], v[60:63]
 v_mfma_f32_16x16x32_bf16 v[48:51], v[80:83], a[36:39], v[48:51]
 v_mfma_f32_16x16x32_bf16 v[52:55], v[84:87], a[36:39], v[52:55]
 v_mfma_f32_16x16x32_bf16 v[56:59], v[80:83], a[100:103], v[56:59]
 v_mfma_f32_16x16x32_bf16 v[60:63], v[84:87], a[100:103], v[60:63]
 v_mfma_f32_16x16x32_bf16 v[48:51], v[80:83], a[40:43], v[48:51]
 v_mfma_f32_16x16x32_bf16 v[52:55], v[84:87], a[40:43], v[52:55]
 v_mfma_f32_16x16x32_bf16 v[56:59], v[80:83], a[104:107], v[56:59]
 v_mfma_f32_16x16x32_bf16 v[60:63], v[84:87], a[104:107], v[60:63]
 v_mfma_f32_16x16x32_bf16 v[48:51], v[80:83], a[44:47], v[48:51]
 v_mfma_f32_16x16x32_bf16 v[52:55], v[84:87], a[44:47], v[52:55]
 v_mfma_f32_16x16x32_bf16 v[56:59], v[80:83], a[108:111], v[56:59]
 v_mfma_f32_16x16x32_bf16 v[60:63], v[84:87], a[108:111], v[60:63]
 v_mfma_f32_16x16x32_bf16 v[48:51], v[80:83], a[48:51], v[48:51]
 v_mfma_f32_16x16x32_bf16 v[52:55], v[84:87], a[48:51], v[52:55]
 v_mfma_f32_16x16x32_bf16 v[56:59], v[80:83], a[112:115], v[56:59]
 v_mfma_f32_16x16x32_bf16 v[60:63], v[84:87], a[112:115], v[60:63]
 v_mfma_f32_16x16x32_bf16 v[48:51], v[80:83], a[52:55], v[48:51]
 v_mfma_f32_16x16x32_bf16 v[52:55], v[84:87], a[52:55], v[52:55]
 v_mfma_f32_16x16x32_bf16 v[56:59], v[80:83], a[116:119], v[56:59]
 v_mfma_f32_16x16x32_bf16 v[60:63], v[84:87], a[116:119], v[60:63]
 v_mfma_f32_16x16x32_bf16 v[48:51], v[80:83], a[56:59], v[48:51]
 v_mfma_f32_16x16x32_bf16 v[52:55], v[84:87], a[56:59], v[52:55]
 v_mfma_f32_16x16x32_bf16 v[56:59], v[80:83], a[120:123], v[56:59]
 v_mfma_f32_16x16x32_bf16 v[60:63], v[84:87], a[120:123], v[60:63]
 v_mfma_f32_16x16x32_bf16 v[48:51], v[80:83], a[60:63], v[48:51]
 v_mfma_f32_16x16x32_bf16 v[52:55], v[84:87], a[60:63], v[52:55]
 v_mfma_f32_16x16x32_bf16 v[56:59], v[80:83], a[124:127], v[56:59]
 v_mfma_f32_16x16x32_bf16 v[60:63], v[84:87], a[124:127], v[60:63]
 s_nop 7
 v_cvt_pk_bf16_f32 v32, v48, v49
 v_cvt_pk_bf16_f32 v33, v50, v51
 v_cvt_pk_bf16_f32 v34, v52, v53
 v_cvt_pk_bf16_f32 v35, v54, v55
 s_mov_b32 s42, s16
 buffer_store_dwordx4 v[32:35], v90, s[40:43], s12 offen offset:0 sc1
 v_cvt_pk_bf16_f32 v36, v56, v57
 v_cvt_pk_bf16_f32 v37, v58, v59
 v_cvt_pk_bf16_f32 v38, v60, v61
 v_cvt_pk_bf16_f32 v39, v62, v63
 s_mov_b32 s42, 1835008
 buffer_store_dwordx4 v[36:39], v90, s[40:43], s12 offen offset:384 sc1
gated_mix__compressed_kv_cla__glu_gated_swiglu__prompt_kernel_nosum:
 s_endpgm
gated_mix__compressed_kv_cla__glu_gated_swiglu__prompt_kernel_slow:
 s_nop 7
 v_max3_f32 v88, v32, v33, v34
 v_max3_f32 v88, v88, v35, v40
 v_max3_f32 v88, v88, v41, v42
 v_max_f32 v88, v88, v43
 v_max3_f32 v89, v36, v37, v38
 v_max3_f32 v89, v89, v39, v44
 v_max3_f32 v89, v89, v45, v46
 v_max_f32 v89, v89, v47
 v_mov_b32 v90, v88
 s_nop 1
 v_permlane32_swap_b32 v88, v90
 v_max_f32 v88, v88, v90
 v_mov_b32 v90, v88
 s_nop 1
 v_permlane16_swap_b32 v88, v90
 v_max_f32 v88, v88, v90
 v_max_f32 v88, 0, v88
 v_sub_f32 v4, v4, v88
 v_mov_b32 v90, v89
 s_nop 1
 v_permlane32_swap_b32 v89, v90
 v_max_f32 v89, v89, v90
 v_mov_b32 v90, v89
 s_nop 1
 v_permlane16_swap_b32 v89, v90
 v_max_f32 v89, v89, v90
 v_max_f32 v89, 0, v89
 v_sub_f32 v5, v5, v89
 v_sub_f32 v32, v32, v88
 v_mov_b32 v72, v4
 v_sub_f32 v33, v33, v88
 v_mov_b32 v73, v4
 v_sub_f32 v34, v34, v88
 v_mov_b32 v74, v4
 v_sub_f32 v35, v35, v88
 v_mov_b32 v75, v4
 v_sub_f32 v36, v36, v89
 v_mov_b32 v76, v5
 v_sub_f32 v37, v37, v89
 v_mov_b32 v77, v5
 v_sub_f32 v38, v38, v89
 v_mov_b32 v78, v5
 v_sub_f32 v39, v39, v89
 v_mov_b32 v79, v5
 v_sub_f32 v40, v40, v88
 v_mov_b32 v80, v4
 v_sub_f32 v41, v41, v88
 v_mov_b32 v81, v4
 v_sub_f32 v42, v42, v88
 v_mov_b32 v82, v4
 v_sub_f32 v43, v43, v88
 v_mov_b32 v83, v4
 v_sub_f32 v44, v44, v89
 v_mov_b32 v84, v5
 v_sub_f32 v45, v45, v89
 v_mov_b32 v85, v5
 v_sub_f32 v46, v46, v89
 v_mov_b32 v86, v5
 v_sub_f32 v47, v47, v89
 v_mov_b32 v87, v5
 v_exp_f32 v48, v32
 v_exp_f32 v49, v33
 v_exp_f32 v50, v34
 v_exp_f32 v51, v35
 v_exp_f32 v52, v36
 v_exp_f32 v53, v37
 v_exp_f32 v54, v38
 v_exp_f32 v55, v39
 v_exp_f32 v56, v40
 v_exp_f32 v57, v41
 v_exp_f32 v58, v42
 v_exp_f32 v59, v43
 v_exp_f32 v60, v44
 v_exp_f32 v61, v45
 v_exp_f32 v62, v46
 v_exp_f32 v63, v47
 v_exp_f32 v88, -v88
 v_exp_f32 v89, -v89
 v_add_f32 v8, v48, v49
 v_add_f32 v8, v8, v50
 v_add_f32 v8, v8, v51
 v_add_f32 v8, v8, v56
 v_add_f32 v8, v8, v57
 v_add_f32 v8, v8, v58
 v_add_f32 v8, v8, v59
 v_add_f32 v9, v52, v53
 v_add_f32 v9, v9, v54
 v_add_f32 v9, v9, v55
 v_add_f32 v9, v9, v60
 v_add_f32 v9, v9, v61
 v_add_f32 v9, v9, v62
 v_add_f32 v9, v9, v63
 v_mul_f32 v6, v6, v88
 v_mul_f32 v7, v7, v89
 v_accvgpr_read_b32 v92, a0
 v_accvgpr_read_b32 v93, a1
 v_accvgpr_read_b32 v94, a2
 v_accvgpr_read_b32 v95, a3
 v_mul_f32 v92, v92, v88
 v_mul_f32 v93, v93, v88
 v_mul_f32 v94, v94, v88
 v_mul_f32 v95, v95, v88
 v_accvgpr_write_b32 a0, v92
 v_accvgpr_write_b32 a1, v93
 v_accvgpr_write_b32 a2, v94
 v_accvgpr_write_b32 a3, v95
 v_accvgpr_read_b32 v96, a4
 v_accvgpr_read_b32 v97, a5
 v_accvgpr_read_b32 v98, a6
 v_accvgpr_read_b32 v99, a7
 v_mul_f32 v96, v96, v89
 v_mul_f32 v97, v97, v89
 v_mul_f32 v98, v98, v89
 v_mul_f32 v99, v99, v89
 v_accvgpr_write_b32 a4, v96
 v_accvgpr_write_b32 a5, v97
 v_accvgpr_write_b32 a6, v98
 v_accvgpr_write_b32 a7, v99
 v_accvgpr_read_b32 v92, a8
 v_accvgpr_read_b32 v93, a9
 v_accvgpr_read_b32 v94, a10
 v_accvgpr_read_b32 v95, a11
 v_mul_f32 v92, v92, v88
 v_mul_f32 v93, v93, v88
 v_mul_f32 v94, v94, v88
 v_mul_f32 v95, v95, v88
 v_accvgpr_write_b32 a8, v92
 v_accvgpr_write_b32 a9, v93
 v_accvgpr_write_b32 a10, v94
 v_accvgpr_write_b32 a11, v95
 v_accvgpr_read_b32 v96, a12
 v_accvgpr_read_b32 v97, a13
 v_accvgpr_read_b32 v98, a14
 v_accvgpr_read_b32 v99, a15
 v_mul_f32 v96, v96, v89
 v_mul_f32 v97, v97, v89
 v_mul_f32 v98, v98, v89
 v_mul_f32 v99, v99, v89
 v_accvgpr_write_b32 a12, v96
 v_accvgpr_write_b32 a13, v97
 v_accvgpr_write_b32 a14, v98
 v_accvgpr_write_b32 a15, v99
 v_accvgpr_read_b32 v92, a16
 v_accvgpr_read_b32 v93, a17
 v_accvgpr_read_b32 v94, a18
 v_accvgpr_read_b32 v95, a19
 v_mul_f32 v92, v92, v88
 v_mul_f32 v93, v93, v88
 v_mul_f32 v94, v94, v88
 v_mul_f32 v95, v95, v88
 v_accvgpr_write_b32 a16, v92
 v_accvgpr_write_b32 a17, v93
 v_accvgpr_write_b32 a18, v94
 v_accvgpr_write_b32 a19, v95
 v_accvgpr_read_b32 v96, a20
 v_accvgpr_read_b32 v97, a21
 v_accvgpr_read_b32 v98, a22
 v_accvgpr_read_b32 v99, a23
 v_mul_f32 v96, v96, v89
 v_mul_f32 v97, v97, v89
 v_mul_f32 v98, v98, v89
 v_mul_f32 v99, v99, v89
 v_accvgpr_write_b32 a20, v96
 v_accvgpr_write_b32 a21, v97
 v_accvgpr_write_b32 a22, v98
 v_accvgpr_write_b32 a23, v99
 v_accvgpr_read_b32 v92, a24
 v_accvgpr_read_b32 v93, a25
 v_accvgpr_read_b32 v94, a26
 v_accvgpr_read_b32 v95, a27
 v_mul_f32 v92, v92, v88
 v_mul_f32 v93, v93, v88
 v_mul_f32 v94, v94, v88
 v_mul_f32 v95, v95, v88
 v_accvgpr_write_b32 a24, v92
 v_accvgpr_write_b32 a25, v93
 v_accvgpr_write_b32 a26, v94
 v_accvgpr_write_b32 a27, v95
 v_accvgpr_read_b32 v96, a28
 v_accvgpr_read_b32 v97, a29
 v_accvgpr_read_b32 v98, a30
 v_accvgpr_read_b32 v99, a31
 v_mul_f32 v96, v96, v89
 v_mul_f32 v97, v97, v89
 v_mul_f32 v98, v98, v89
 v_mul_f32 v99, v99, v89
 v_accvgpr_write_b32 a28, v96
 v_accvgpr_write_b32 a29, v97
 v_accvgpr_write_b32 a30, v98
 v_accvgpr_write_b32 a31, v99
 v_accvgpr_read_b32 v92, a32
 v_accvgpr_read_b32 v93, a33
 v_accvgpr_read_b32 v94, a34
 v_accvgpr_read_b32 v95, a35
 v_mul_f32 v92, v92, v88
 v_mul_f32 v93, v93, v88
 v_mul_f32 v94, v94, v88
 v_mul_f32 v95, v95, v88
 v_accvgpr_write_b32 a32, v92
 v_accvgpr_write_b32 a33, v93
 v_accvgpr_write_b32 a34, v94
 v_accvgpr_write_b32 a35, v95
 v_accvgpr_read_b32 v96, a36
 v_accvgpr_read_b32 v97, a37
 v_accvgpr_read_b32 v98, a38
 v_accvgpr_read_b32 v99, a39
 v_mul_f32 v96, v96, v89
 v_mul_f32 v97, v97, v89
 v_mul_f32 v98, v98, v89
 v_mul_f32 v99, v99, v89
 v_accvgpr_write_b32 a36, v96
 v_accvgpr_write_b32 a37, v97
 v_accvgpr_write_b32 a38, v98
 v_accvgpr_write_b32 a39, v99
 v_accvgpr_read_b32 v92, a40
 v_accvgpr_read_b32 v93, a41
 v_accvgpr_read_b32 v94, a42
 v_accvgpr_read_b32 v95, a43
 v_mul_f32 v92, v92, v88
 v_mul_f32 v93, v93, v88
 v_mul_f32 v94, v94, v88
 v_mul_f32 v95, v95, v88
 v_accvgpr_write_b32 a40, v92
 v_accvgpr_write_b32 a41, v93
 v_accvgpr_write_b32 a42, v94
 v_accvgpr_write_b32 a43, v95
 v_accvgpr_read_b32 v96, a44
 v_accvgpr_read_b32 v97, a45
 v_accvgpr_read_b32 v98, a46
 v_accvgpr_read_b32 v99, a47
 v_mul_f32 v96, v96, v89
 v_mul_f32 v97, v97, v89
 v_mul_f32 v98, v98, v89
 v_mul_f32 v99, v99, v89
 v_accvgpr_write_b32 a44, v96
 v_accvgpr_write_b32 a45, v97
 v_accvgpr_write_b32 a46, v98
 v_accvgpr_write_b32 a47, v99
 v_accvgpr_read_b32 v92, a48
 v_accvgpr_read_b32 v93, a49
 v_accvgpr_read_b32 v94, a50
 v_accvgpr_read_b32 v95, a51
 v_mul_f32 v92, v92, v88
 v_mul_f32 v93, v93, v88
 v_mul_f32 v94, v94, v88
 v_mul_f32 v95, v95, v88
 v_accvgpr_write_b32 a48, v92
 v_accvgpr_write_b32 a49, v93
 v_accvgpr_write_b32 a50, v94
 v_accvgpr_write_b32 a51, v95
 v_accvgpr_read_b32 v96, a52
 v_accvgpr_read_b32 v97, a53
 v_accvgpr_read_b32 v98, a54
 v_accvgpr_read_b32 v99, a55
 v_mul_f32 v96, v96, v89
 v_mul_f32 v97, v97, v89
 v_mul_f32 v98, v98, v89
 v_mul_f32 v99, v99, v89
 v_accvgpr_write_b32 a52, v96
 v_accvgpr_write_b32 a53, v97
 v_accvgpr_write_b32 a54, v98
 v_accvgpr_write_b32 a55, v99
 v_accvgpr_read_b32 v92, a56
 v_accvgpr_read_b32 v93, a57
 v_accvgpr_read_b32 v94, a58
 v_accvgpr_read_b32 v95, a59
 v_mul_f32 v92, v92, v88
 v_mul_f32 v93, v93, v88
 v_mul_f32 v94, v94, v88
 v_mul_f32 v95, v95, v88
 v_accvgpr_write_b32 a56, v92
 v_accvgpr_write_b32 a57, v93
 v_accvgpr_write_b32 a58, v94
 v_accvgpr_write_b32 a59, v95
 v_accvgpr_read_b32 v96, a60
 v_accvgpr_read_b32 v97, a61
 v_accvgpr_read_b32 v98, a62
 v_accvgpr_read_b32 v99, a63
 v_mul_f32 v96, v96, v89
 v_mul_f32 v97, v97, v89
 v_mul_f32 v98, v98, v89
 v_mul_f32 v99, v99, v89
 v_accvgpr_write_b32 a60, v96
 v_accvgpr_write_b32 a61, v97
 v_accvgpr_write_b32 a62, v98
 v_accvgpr_write_b32 a63, v99
 v_accvgpr_read_b32 v92, a64
 v_accvgpr_read_b32 v93, a65
 v_accvgpr_read_b32 v94, a66
 v_accvgpr_read_b32 v95, a67
 v_mul_f32 v92, v92, v88
 v_mul_f32 v93, v93, v88
 v_mul_f32 v94, v94, v88
 v_mul_f32 v95, v95, v88
 v_accvgpr_write_b32 a64, v92
 v_accvgpr_write_b32 a65, v93
 v_accvgpr_write_b32 a66, v94
 v_accvgpr_write_b32 a67, v95
 v_accvgpr_read_b32 v96, a68
 v_accvgpr_read_b32 v97, a69
 v_accvgpr_read_b32 v98, a70
 v_accvgpr_read_b32 v99, a71
 v_mul_f32 v96, v96, v89
 v_mul_f32 v97, v97, v89
 v_mul_f32 v98, v98, v89
 v_mul_f32 v99, v99, v89
 v_accvgpr_write_b32 a68, v96
 v_accvgpr_write_b32 a69, v97
 v_accvgpr_write_b32 a70, v98
 v_accvgpr_write_b32 a71, v99
 v_accvgpr_read_b32 v92, a72
 v_accvgpr_read_b32 v93, a73
 v_accvgpr_read_b32 v94, a74
 v_accvgpr_read_b32 v95, a75
 v_mul_f32 v92, v92, v88
 v_mul_f32 v93, v93, v88
 v_mul_f32 v94, v94, v88
 v_mul_f32 v95, v95, v88
 v_accvgpr_write_b32 a72, v92
 v_accvgpr_write_b32 a73, v93
 v_accvgpr_write_b32 a74, v94
 v_accvgpr_write_b32 a75, v95
 v_accvgpr_read_b32 v96, a76
 v_accvgpr_read_b32 v97, a77
 v_accvgpr_read_b32 v98, a78
 v_accvgpr_read_b32 v99, a79
 v_mul_f32 v96, v96, v89
 v_mul_f32 v97, v97, v89
 v_mul_f32 v98, v98, v89
 v_mul_f32 v99, v99, v89
 v_accvgpr_write_b32 a76, v96
 v_accvgpr_write_b32 a77, v97
 v_accvgpr_write_b32 a78, v98
 v_accvgpr_write_b32 a79, v99
 v_accvgpr_read_b32 v92, a80
 v_accvgpr_read_b32 v93, a81
 v_accvgpr_read_b32 v94, a82
 v_accvgpr_read_b32 v95, a83
 v_mul_f32 v92, v92, v88
 v_mul_f32 v93, v93, v88
 v_mul_f32 v94, v94, v88
 v_mul_f32 v95, v95, v88
 v_accvgpr_write_b32 a80, v92
 v_accvgpr_write_b32 a81, v93
 v_accvgpr_write_b32 a82, v94
 v_accvgpr_write_b32 a83, v95
 v_accvgpr_read_b32 v96, a84
 v_accvgpr_read_b32 v97, a85
 v_accvgpr_read_b32 v98, a86
 v_accvgpr_read_b32 v99, a87
 v_mul_f32 v96, v96, v89
 v_mul_f32 v97, v97, v89
 v_mul_f32 v98, v98, v89
 v_mul_f32 v99, v99, v89
 v_accvgpr_write_b32 a84, v96
 v_accvgpr_write_b32 a85, v97
 v_accvgpr_write_b32 a86, v98
 v_accvgpr_write_b32 a87, v99
 v_accvgpr_read_b32 v92, a88
 v_accvgpr_read_b32 v93, a89
 v_accvgpr_read_b32 v94, a90
 v_accvgpr_read_b32 v95, a91
 v_mul_f32 v92, v92, v88
 v_mul_f32 v93, v93, v88
 v_mul_f32 v94, v94, v88
 v_mul_f32 v95, v95, v88
 v_accvgpr_write_b32 a88, v92
 v_accvgpr_write_b32 a89, v93
 v_accvgpr_write_b32 a90, v94
 v_accvgpr_write_b32 a91, v95
 v_accvgpr_read_b32 v96, a92
 v_accvgpr_read_b32 v97, a93
 v_accvgpr_read_b32 v98, a94
 v_accvgpr_read_b32 v99, a95
 v_mul_f32 v96, v96, v89
 v_mul_f32 v97, v97, v89
 v_mul_f32 v98, v98, v89
 v_mul_f32 v99, v99, v89
 v_accvgpr_write_b32 a92, v96
 v_accvgpr_write_b32 a93, v97
 v_accvgpr_write_b32 a94, v98
 v_accvgpr_write_b32 a95, v99
 v_accvgpr_read_b32 v92, a96
 v_accvgpr_read_b32 v93, a97
 v_accvgpr_read_b32 v94, a98
 v_accvgpr_read_b32 v95, a99
 v_mul_f32 v92, v92, v88
 v_mul_f32 v93, v93, v88
 v_mul_f32 v94, v94, v88
 v_mul_f32 v95, v95, v88
 v_accvgpr_write_b32 a96, v92
 v_accvgpr_write_b32 a97, v93
 v_accvgpr_write_b32 a98, v94
 v_accvgpr_write_b32 a99, v95
 v_accvgpr_read_b32 v96, a100
 v_accvgpr_read_b32 v97, a101
 v_accvgpr_read_b32 v98, a102
 v_accvgpr_read_b32 v99, a103
 v_mul_f32 v96, v96, v89
 v_mul_f32 v97, v97, v89
 v_mul_f32 v98, v98, v89
 v_mul_f32 v99, v99, v89
 v_accvgpr_write_b32 a100, v96
 v_accvgpr_write_b32 a101, v97
 v_accvgpr_write_b32 a102, v98
 v_accvgpr_write_b32 a103, v99
 v_accvgpr_read_b32 v92, a104
 v_accvgpr_read_b32 v93, a105
 v_accvgpr_read_b32 v94, a106
 v_accvgpr_read_b32 v95, a107
 v_mul_f32 v92, v92, v88
 v_mul_f32 v93, v93, v88
 v_mul_f32 v94, v94, v88
 v_mul_f32 v95, v95, v88
 v_accvgpr_write_b32 a104, v92
 v_accvgpr_write_b32 a105, v93
 v_accvgpr_write_b32 a106, v94
 v_accvgpr_write_b32 a107, v95
 v_accvgpr_read_b32 v96, a108
 v_accvgpr_read_b32 v97, a109
 v_accvgpr_read_b32 v98, a110
 v_accvgpr_read_b32 v99, a111
 v_mul_f32 v96, v96, v89
 v_mul_f32 v97, v97, v89
 v_mul_f32 v98, v98, v89
 v_mul_f32 v99, v99, v89
 v_accvgpr_write_b32 a108, v96
 v_accvgpr_write_b32 a109, v97
 v_accvgpr_write_b32 a110, v98
 v_accvgpr_write_b32 a111, v99
 v_accvgpr_read_b32 v92, a112
 v_accvgpr_read_b32 v93, a113
 v_accvgpr_read_b32 v94, a114
 v_accvgpr_read_b32 v95, a115
 v_mul_f32 v92, v92, v88
 v_mul_f32 v93, v93, v88
 v_mul_f32 v94, v94, v88
 v_mul_f32 v95, v95, v88
 v_accvgpr_write_b32 a112, v92
 v_accvgpr_write_b32 a113, v93
 v_accvgpr_write_b32 a114, v94
 v_accvgpr_write_b32 a115, v95
 v_accvgpr_read_b32 v96, a116
 v_accvgpr_read_b32 v97, a117
 v_accvgpr_read_b32 v98, a118
 v_accvgpr_read_b32 v99, a119
 v_mul_f32 v96, v96, v89
 v_mul_f32 v97, v97, v89
 v_mul_f32 v98, v98, v89
 v_mul_f32 v99, v99, v89
 v_accvgpr_write_b32 a116, v96
 v_accvgpr_write_b32 a117, v97
 v_accvgpr_write_b32 a118, v98
 v_accvgpr_write_b32 a119, v99
 v_accvgpr_read_b32 v92, a120
 v_accvgpr_read_b32 v93, a121
 v_accvgpr_read_b32 v94, a122
 v_accvgpr_read_b32 v95, a123
 v_mul_f32 v92, v92, v88
 v_mul_f32 v93, v93, v88
 v_mul_f32 v94, v94, v88
 v_mul_f32 v95, v95, v88
 v_accvgpr_write_b32 a120, v92
 v_accvgpr_write_b32 a121, v93
 v_accvgpr_write_b32 a122, v94
 v_accvgpr_write_b32 a123, v95
 v_accvgpr_read_b32 v96, a124
 v_accvgpr_read_b32 v97, a125
 v_accvgpr_read_b32 v98, a126
 v_accvgpr_read_b32 v99, a127
 v_mul_f32 v96, v96, v89
 v_mul_f32 v97, v97, v89
 v_mul_f32 v98, v98, v89
 v_mul_f32 v99, v99, v89
 v_accvgpr_write_b32 a124, v96
 v_accvgpr_write_b32 a125, v97
 v_accvgpr_write_b32 a126, v98
 v_accvgpr_write_b32 a127, v99
 s_nop 1
 s_branch gated_mix__compressed_kv_cla__glu_gated_swiglu__prompt_kernel_join
gated_mix__compressed_kv_cla__glu_gated_swiglu__prompt_kernel_exit:
 s_endpgm
gated_mix__compressed_kv_cla__glu_gated_swiglu__prompt_kernel_end:
.section .rodata,"a"
.p2align 6
.amdhsa_kernel gated_mix__compressed_kv_cla__glu_gated_swiglu__prompt_kernel
  .amdhsa_next_free_vgpr 512
  .amdhsa_next_free_sgpr 102
  .amdhsa_accum_offset 256
  .amdhsa_group_segment_fixed_size 0
  .amdhsa_kernarg_size 112
  .amdhsa_user_sgpr_count 2
  .amdhsa_user_sgpr_kernarg_segment_ptr 1
  .amdhsa_system_sgpr_workgroup_id_x 1
.end_amdhsa_kernel
```
